```python
import torch

def _softmax(x, axis=-1):
    return torch.softmax(x, dim=axis)
def _gelu(x):
    return torch.nn.functional.gelu(x, approximate="tanh")
def _silu(x):
    return torch.nn.functional.silu(x)
def _sigmoid(x):
    return torch.sigmoid(x)
def _layernorm(x, axis=-1, eps=1e-5):
    m = x.mean(dim=axis, keepdim=True)
    v = x.var(dim=axis, keepdim=True, unbiased=False)
    return (x - m) / torch.sqrt(v + eps)
def _scatter_add(tgt, idx, src, axis=0):
    return tgt.clone().index_add_(axis, idx, src)
def _segment_sum(src, seg, n):
    out = torch.zeros((n,) + src.shape[1:], dtype=src.dtype)
    return out.index_add_(0, seg, src)
def _pad(x, pw):
    flat = tuple(v for pair in reversed(pw) for v in pair)
    return torch.nn.functional.pad(x, flat)

kernel_name = 'interleave_layers__softmax_full_mha__glu_gated_swiglu__prompt'

def setup_inputs():

    _w = (lambda a: (lambda t: t.to(torch.bfloat16) if t.is_floating_point() else t)(torch.as_tensor(a)))
    def _A_setup():
        B, S, D = 1, 2048, 576
        return {
            "x": _w((lambda *s: torch.randn(*s, dtype=torch.bfloat16) * 0.05)(B, S, D)),
            "wqkv": _w((lambda *s: torch.randn(*s, dtype=torch.bfloat16) * 0.05)(D, 3 * D)),
            "wo": _w((lambda *s: torch.randn(*s, dtype=torch.bfloat16) * 0.05)(D, D)),
        }
    _A_in = _A_setup()

    def _B_setup():
        B, S, D, F = 1, 2048, 576, 4608
        return {
            "x": _w((lambda *s: torch.randn(*s, dtype=torch.bfloat16) * 0.05)(B, S, D)),
            "w1": _w((lambda *s: torch.randn(*s, dtype=torch.bfloat16) * 0.4)(D, F) * (2.0 / D) ** 0.5),
            "w3": _w((lambda *s: torch.randn(*s, dtype=torch.bfloat16) * 0.4)(D, F) * (2.0 / D) ** 0.5),
            "w2": _w((lambda *s: torch.randn(*s, dtype=torch.bfloat16) * 0.4)(F, D) * (2.0 / F) ** 0.5),
        }
    _B_in = _B_setup()

    return {
        "A_x": _A_in["x"],
        "A_wqkv": _A_in["wqkv"],
        "A_wo": _A_in["wo"],
        "B_x": _B_in["x"],
        "B_w1": _B_in["w1"],
        "B_w3": _B_in["w3"],
        "B_w2": _B_in["w2"],
    }

def reference(A_x, A_wqkv, A_wo, B_x, B_w1, B_w3, B_w2):
    def _A_ref(x, wqkv, wo):
        B, S, D = x.shape
        H = 32; Dh = D // H
        qkv = (lambda x, *d: x.permute(*d))((x @ wqkv).reshape(B, S, 3, H, Dh), 2, 0, 3, 1, 4)
        q, k, v = qkv[0], qkv[1], qkv[2]
        scale = Dh ** -0.5
        scores = torch.einsum("bhqd,bhkd->bhqk", q, k) * scale
        p = _softmax(scores, axis=-1)
        o = torch.einsum("bhqk,bhkd->bhqd", p, v)
        return (lambda x, *d: x.permute(*d))(o, 0, 2, 1, 3).reshape(B, S, D) @ wo

    def _B_ref(x, w1, w3, w2):
        gate = torch.einsum("bsd,df->bsf", x, w1)
        up = torch.einsum("bsd,df->bsf", x, w3)
        h = _silu(gate) * up
        out = torch.einsum("bsf,fd->bsd", h, w2)
        return out

    x = A_x
    x = x + _A_ref(_layernorm(x, axis=-1), A_wqkv, A_wo)
    x = x + _B_ref(_layernorm(x, axis=-1), B_w1, B_w3, B_w2)
    x = x + _A_ref(_layernorm(x, axis=-1), A_wqkv, A_wo)
    x = x + _B_ref(_layernorm(x, axis=-1), B_w1, B_w3, B_w2)
    return x
```

```asm
; @launch kernel=km_kernel grid=(256,1,1) block=(256,1,1) lds=163840
.amdgcn_target "amdgcn-amd-amdhsa--gfx950"
.text
ATB_BEGIN:
K1D_JOIN:
 s_waitcnt vmcnt(0) lgkmcnt(0)
 s_lshl_b32 s24, s87, 4
 s_add_u32 s24, s24, s86
 s_lshl_b32 s24, s24, 2
 s_add_u32 s24, s24, s41
 s_add_u32 s24, s24, 4096
 s_barrier
 s_cmp_lg_u32 s3, 0
 s_cbranch_scc1 SIG7
 s_mov_b64 exec, 1
 v_mov_b32 v30, 0
 v_mov_b32 v31, 1
 s_lshl_b32 s38, s24, 5
 s_add_u32 s38, s38, 9961472
 buffer_store_dword v31, v30, s[4:7], s38 offen sc1
 s_mov_b64 exec, -1
SIG7:
 s_and_b32 s24, s2, 7
 s_lshr_b32 s25, s2, 3
 s_lshr_b32 s80, s24, 1
 s_lshl_b32 s80, s80, 3
 s_and_b32 s27, s25, 7
 s_add_u32 s80, s80, s27
 s_and_b32 s81, s24, 1
 s_lshl_b32 s81, s81, 2
 s_lshr_b32 s28, s25, 3
 s_add_u32 s81, s81, s28
 s_lshr_b32 s82, s81, 1
 s_mul_i32 s82, s82, 9
 s_and_b32 s83, s81, 1
 s_lshl_b32 s34, s83, 2
 s_add_u32 s82, s82, s34
 s_and_b32 s84, s2, 3
 s_lshl_b32 s84, s84, 3
 s_bfe_u32 s25, s2, 0x30003
 s_add_u32 s84, s84, s25
 s_bfe_u32 s85, s2, 0x10002
 s_lshl_b32 s85, s85, 2
 s_lshr_b32 s25, s2, 6
 s_add_u32 s85, s85, s25
 s_lshl_b32 s78, s3, 10
 s_mul_i32 s76, s84, 340992
 s_add_u32 s76, s76, 58490880
 s_add_u32 s77, s76, s78
 s_mul_i32 s87, s82, 18432
 s_add_u32 s87, s87, 69402624
 s_add_u32 s87, s87, s78
 s_and_b32 s24, s2, 7
 s_lshl_b32 s24, s24, 2
 s_bfe_u32 s25, s2, 0x20003
 s_add_u32 s24, s24, s25
 s_lshr_b32 s26, s2, 5
 s_lshl_b32 s25, s26, 3
 s_lshl_b32 s27, s3, 1
 s_add_u32 s25, s25, s27
 s_lshl_b32 s29, s24, 6
 s_add_u32 s29, s29, s25
 s_lshl_b32 s27, s29, 10
 s_add_u32 s27, s27, 11010048
 s_add_u32 s27, s27, s100
 s_lshl_b32 s28, s29, 7
 s_add_u32 s28, s28, 13107200
 s_add_u32 s28, s28, s100
 s_lshl_b32 s21, s3, 10
 s_mul_i32 s20, s24, 151552
 s_add_u32 s20, s20, 13369344
 s_add_u32 s20, s20, s100
 s_add_u32 s20, s20, s21
 v_and_b32 v96, 31, v0
 v_lshlrev_b32 v97, 2, v96
 s_lshr_b32 s30, s24, 3
 s_add_u32 s31, s30, 4
 s_mul_i32 s32, s24, 18
 s_add_u32 s33, s32, 17
 s_mul_i32 s32, s32, 683
 s_lshr_b32 s32, s32, 16
 s_add_u32 s32, s32, 9
 s_mul_i32 s33, s33, 683
 s_lshr_b32 s33, s33, 16
 s_add_u32 s33, s33, 9
 v_bfe_u32 v98, v0, 4, 2
 v_mov_b32 v99, s31
 v_cmp_eq_u32 vcc, 1, v98
 s_nop 1
 v_cndmask_b32 v99, v99, 15, vcc
 v_mov_b32 v100, s32
 v_cmp_eq_u32 vcc, 2, v98
 s_nop 1
 v_cndmask_b32 v99, v99, v100, vcc
 v_mov_b32 v100, s33
 v_cmp_eq_u32 vcc, 3, v98
 s_nop 1
 v_cndmask_b32 v99, v99, v100, vcc
 v_lshlrev_b32 v99, 4, v99
 v_and_b32 v100, 15, v0
 v_add_u32 v99, v99, v100
 v_lshlrev_b32 v99, 7, v99
 s_lshl_b32 s30, s30, 4
 s_lshl_b32 s31, s26, 1
 s_add_u32 s30, s30, s31
 v_and_b32 v100, 1, v0
 s_add_u32 s31, s31, 128
 v_mov_b32 v101, s30
 v_mov_b32 v102, s31
 v_and_b32 v103, 2, v0
 v_cmp_eq_u32 vcc, 2, v103
 s_nop 1
 v_cndmask_b32 v101, v101, v102, vcc
 v_add_u32 v100, v101, v100
 v_lshlrev_b32 v100, 7, v100
 s_add_u32 s38, s41, 4096
 s_lshl_b32 s38, s38, 5
 s_add_u32 s38, s38, 9961472
 s_lshr_b32 s30, s82, 1
 s_add_u32 s30, s30, 130
 v_and_b32 v104, 3, v0
 v_min_u32 v104, 2, v104
 v_add_u32 v104, s30, v104
 v_and_b32 v105, 1, v0
 v_add_u32 v105, 148, v105
 v_and_b32 v106, 4, v0
 v_cmp_eq_u32 vcc, 4, v106
 s_nop 1
 v_cndmask_b32 v104, v104, v105, vcc
 s_lshr_b32 s30, s24, 0
 s_add_u32 s30, s30, 150
 v_mov_b32 v105, s30
 v_and_b32 v106, 8, v0
 v_cmp_eq_u32 vcc, 8, v106
 s_nop 1
 v_cndmask_b32 v104, v104, v105, vcc
 v_lshlrev_b32 v108, 7, v104
 v_add_u32 v108, 10190848, v108
 v_bfe_u32 v101, v0, 2, 1
 v_lshlrev_b32 v101, 3, v101
 v_bfe_u32 v102, v0, 3, 1
 v_lshlrev_b32 v102, 2, v102
 v_and_b32 v103, 3, v0
 v_add3_u32 v101, v101, v102, v103
 v_min_u32 v102, 18, v96
 v_cmp_gt_u32 vcc, 16, v96
 s_nop 1
 v_cndmask_b32 v101, v102, v101, vcc
 v_lshlrev_b32 v101, 4, v101
 v_bfe_u32 v102, v0, 5, 1
 v_mul_u32_u24 v102, 304, v102
 v_add_u32 v101, v101, v102
 v_cmp_lt_u32 vcc, 18, v96
 v_cmp_ne_u32 s[32:33], 22, v96
 s_nop 0
 s_and_b64 vcc, vcc, s[32:33]
 v_mov_b32 v102, 0x100000
 v_cndmask_b32 v101, v101, v102, vcc
 v_add_u32 v2, 0, v1
 v_add_u32 v6, 9216, v101
 v_add_u32 v3, 37888, v1
 v_add_u32 v7, 47104, v101
 v_add_u32 v4, 75776, v1
 v_add_u32 v8, 84992, v101
 v_add_u32 v5, 113664, v1
 v_add_u32 v9, 122880, v101
 v_accvgpr_write_b32 a8, 0
 v_accvgpr_write_b32 a9, 0
 v_accvgpr_write_b32 a10, 0
 v_accvgpr_write_b32 a11, 0
 v_accvgpr_write_b32 a12, 0
 v_accvgpr_write_b32 a13, 0
 v_accvgpr_write_b32 a14, 0
 v_accvgpr_write_b32 a15, 0
 v_accvgpr_write_b32 a16, 0
 v_accvgpr_write_b32 a17, 0
 v_accvgpr_write_b32 a18, 0
 v_accvgpr_write_b32 a19, 0
 v_accvgpr_write_b32 a20, 0
 v_accvgpr_write_b32 a21, 0
 v_accvgpr_write_b32 a22, 0
 v_accvgpr_write_b32 a23, 0
 v_accvgpr_write_b32 a24, 0
 v_accvgpr_write_b32 a25, 0
 v_accvgpr_write_b32 a26, 0
 v_accvgpr_write_b32 a27, 0
 v_accvgpr_write_b32 a28, 0
 v_accvgpr_write_b32 a29, 0
 v_accvgpr_write_b32 a30, 0
 v_accvgpr_write_b32 a31, 0
 v_accvgpr_write_b32 a32, 0
 v_accvgpr_write_b32 a33, 0
 v_accvgpr_write_b32 a34, 0
 v_accvgpr_write_b32 a35, 0
 v_accvgpr_write_b32 a36, 0
 v_accvgpr_write_b32 a37, 0
 v_accvgpr_write_b32 a38, 0
 v_accvgpr_write_b32 a39, 0
 v_accvgpr_write_b32 a40, 0
 v_accvgpr_write_b32 a41, 0
 v_accvgpr_write_b32 a42, 0
 v_accvgpr_write_b32 a43, 0
 v_accvgpr_write_b32 a44, 0
 v_accvgpr_write_b32 a45, 0
 v_accvgpr_write_b32 a46, 0
 v_accvgpr_write_b32 a47, 0
 v_accvgpr_write_b32 a48, 0
 v_accvgpr_write_b32 a49, 0
 v_accvgpr_write_b32 a50, 0
 v_accvgpr_write_b32 a51, 0
 v_accvgpr_write_b32 a52, 0
 v_accvgpr_write_b32 a53, 0
 v_accvgpr_write_b32 a54, 0
 v_accvgpr_write_b32 a55, 0
 v_accvgpr_write_b32 a56, 0
 v_accvgpr_write_b32 a57, 0
 v_accvgpr_write_b32 a58, 0
 v_accvgpr_write_b32 a59, 0
 v_accvgpr_write_b32 a60, 0
 v_accvgpr_write_b32 a61, 0
 v_accvgpr_write_b32 a62, 0
 v_accvgpr_write_b32 a63, 0
 v_accvgpr_write_b32 a64, 0
 v_accvgpr_write_b32 a65, 0
 v_accvgpr_write_b32 a66, 0
 v_accvgpr_write_b32 a67, 0
 v_accvgpr_write_b32 a68, 0
 v_accvgpr_write_b32 a69, 0
 v_accvgpr_write_b32 a70, 0
 v_accvgpr_write_b32 a71, 0
 v_mov_b32 v208, -1
 v_mov_b32 v209, -1
 v_mov_b32 v210, -1
 v_mov_b32 v211, -1
 s_mul_i32 s86, s26, 1179648
 s_mul_i32 s30, s24, 36864
 s_add_u32 s86, s86, s30
 s_add_u32 s86, s86, s21
 s_add_u32 s86, s86, 46940160
 s_cmp_lg_u32 s3, 0
 s_cbranch_scc1 ATB_PD
 s_mov_b32 s39, 0x20000
ATB_PL:
 buffer_load_dword v102, v99, s[4:7], s38 offen sc1
 buffer_load_dword v103, v100, s[4:7], s38 offen sc1
 buffer_load_dword v109, v108, s[4:7], 0 offen sc1
 s_waitcnt vmcnt(0)
 v_and_b32 v102, v102, v109
 v_and_b32 v102, v102, v103
 v_cmp_ne_u32 vcc, 1, v102
 s_nop 1
 s_and_b64 exec, exec, vcc
 s_cbranch_scc0 ATB_PX
 s_sleep 2
 s_sub_u32 s39, s39, 1
 s_cmp_lg_u32 s39, 0
 s_cbranch_scc1 ATB_PL
ATB_PX:
 s_mov_b64 exec, -1
ATB_PD:
 s_barrier
 s_add_u32 s30, s20, 0
 s_add_u32 m0, s21, 0
 s_nop 0
 buffer_load_dwordx4 v1, s[4:7], s30 offen sc1 lds
 s_add_u32 s30, s20, 4096
 s_add_u32 m0, s21, 4096
 s_nop 0
 buffer_load_dwordx4 v1, s[4:7], s30 offen sc1 lds
 s_add_u32 s30, s20, 8192
 s_add_u32 m0, s21, 8192
 s_nop 0
 buffer_load_dwordx4 v1, s[4:7], s30 offen sc1 lds
 buffer_load_dwordx4 a[0:3], v1, s[4:7], s27 offen offset:0 sc1
 buffer_load_dword v98, v97, s[4:7], s28 offen offset:0 sc1
 buffer_load_dwordx4 a[4:7], v1, s[4:7], s27 offen offset:1024 sc1
 buffer_load_dword v99, v97, s[4:7], s28 offen offset:128 sc1
 s_add_u32 s30, s20, 12288
 s_add_u32 m0, s21, 12288
 s_nop 0
 buffer_load_dwordx4 v1, s[4:7], s30 offen sc1 lds
 s_add_u32 s30, s20, 16384
 s_add_u32 m0, s21, 16384
 s_nop 0
 buffer_load_dwordx4 v1, s[4:7], s30 offen sc1 lds
 s_add_u32 s30, s20, 20480
 s_add_u32 m0, s21, 20480
 s_nop 0
 buffer_load_dwordx4 v1, s[4:7], s30 offen sc1 lds
 s_add_u32 s30, s20, 24576
 s_add_u32 m0, s21, 24576
 s_nop 0
 buffer_load_dwordx4 v1, s[4:7], s30 offen sc1 lds
 s_add_u32 s30, s20, 28672
 s_add_u32 m0, s21, 28672
 s_nop 0
 buffer_load_dwordx4 v1, s[4:7], s30 offen sc1 lds
 s_add_u32 s30, s20, 32768
 s_add_u32 m0, s21, 32768
 s_nop 0
 buffer_load_dwordx4 v1, s[4:7], s30 offen sc1 lds
 s_add_u32 s30, s20, 36864
 s_add_u32 m0, s21, 36864
 s_nop 0
 buffer_load_dwordx4 v1, s[4:7], s30 offen sc1 lds
 s_add_u32 s30, s20, 40960
 s_add_u32 m0, s21, 40960
 s_nop 0
 buffer_load_dwordx4 v1, s[4:7], s30 offen sc1 lds
 s_add_u32 s30, s20, 45056
 s_add_u32 m0, s21, 45056
 s_nop 0
 buffer_load_dwordx4 v1, s[4:7], s30 offen sc1 lds
 s_add_u32 s30, s20, 49152
 s_add_u32 m0, s21, 49152
 s_nop 0
 buffer_load_dwordx4 v1, s[4:7], s30 offen sc1 lds
 s_add_u32 s30, s20, 53248
 s_add_u32 m0, s21, 53248
 s_nop 0
 buffer_load_dwordx4 v1, s[4:7], s30 offen sc1 lds
 s_add_u32 s30, s20, 57344
 s_add_u32 m0, s21, 57344
 s_nop 0
 buffer_load_dwordx4 v1, s[4:7], s30 offen sc1 lds
 s_add_u32 s30, s20, 61440
 s_add_u32 m0, s21, 61440
 s_nop 0
 buffer_load_dwordx4 v1, s[4:7], s30 offen sc1 lds
 s_waitcnt vmcnt(13)
 v_cmp_gt_u32 vcc, 512, v1
 s_nop 1
 v_cndmask_b32 v100, 0, v98, vcc
 v_cndmask_b32 v101, v98, 0, vcc
 v_accvgpr_write_b32 a8, v100
 v_accvgpr_write_b32 a24, v101
 v_accvgpr_write_b32 a13, v100
 v_accvgpr_write_b32 a29, v101
 v_accvgpr_write_b32 a18, v100
 v_accvgpr_write_b32 a34, v101
 v_accvgpr_write_b32 a23, v100
 v_accvgpr_write_b32 a39, v101
 v_cndmask_b32 v100, 0, v99, vcc
 v_cndmask_b32 v101, v99, 0, vcc
 v_accvgpr_write_b32 a40, v100
 v_accvgpr_write_b32 a56, v101
 v_accvgpr_write_b32 a45, v100
 v_accvgpr_write_b32 a61, v101
 v_accvgpr_write_b32 a50, v100
 v_accvgpr_write_b32 a66, v101
 v_accvgpr_write_b32 a55, v100
 v_accvgpr_write_b32 a71, v101
 s_waitcnt vmcnt(11)
 s_barrier
 ds_read_b128 a[104:107], v2 offset:0
 ds_read_b128 a[140:143], v2 offset:8192
 ds_read_b128 a[108:111], v2 offset:1024
 ds_read_b128 a[116:119], v6 offset:0
 ds_read_b128 a[120:123], v6 offset:608
 s_waitcnt lgkmcnt(3)
 v_mfma_f32_32x32x16_bf16 v[48:63], a[104:107], a[0:3], 0
 v_mfma_f32_32x32x16_bf16 v[64:79], a[104:107], a[4:7], 0
 v_mfma_f32_32x32x16_bf16 v[48:63], a[140:143], a[8:11], v[48:63]
 v_mfma_f32_32x32x16_bf16 v[64:79], a[140:143], a[40:43], v[64:79]
 s_nop 10
 v_max3_f32 v100, v48, v49, v50
 v_max_f32 v100, v100, v51
 v_max3_f32 v100, v100, v52, v53
 v_max3_f32 v100, v100, v54, v55
 v_max3_f32 v100, v100, v56, v57
 v_max3_f32 v100, v100, v58, v59
 v_max3_f32 v100, v100, v60, v61
 v_max3_f32 v100, v100, v62, v63
 v_mov_b32 v103, v100
 s_nop 1
 v_permlane32_swap_b32 v100, v103
 v_max_f32 v100, v100, v103
 v_sub_f32 v16, 0, v100
 v_sub_f32 v17, 0, v100
 v_sub_f32 v18, 0, v100
 v_sub_f32 v19, 0, v100
 v_sub_f32 v20, 0, v100
 v_sub_f32 v21, 0, v100
 v_sub_f32 v22, 0, v100
 v_sub_f32 v23, 0, v100
 v_sub_f32 v24, 0, v100
 v_sub_f32 v25, 0, v100
 v_sub_f32 v26, 0, v100
 v_sub_f32 v27, 0, v100
 v_sub_f32 v28, 0, v100
 v_sub_f32 v29, 0, v100
 v_sub_f32 v30, 0, v100
 v_sub_f32 v31, 0, v100
 s_nop 1
 v_mfma_f32_32x32x16_bf16 v[48:63], a[104:107], a[0:3], v[16:31]
 v_mfma_f32_32x32x16_bf16 v[48:63], a[140:143], a[8:11], v[48:63]
 v_max3_f32 v101, v64, v65, v66
 v_max_f32 v101, v101, v67
 v_max3_f32 v101, v101, v68, v69
 v_max3_f32 v101, v101, v70, v71
 v_max3_f32 v101, v101, v72, v73
 v_max3_f32 v101, v101, v74, v75
 v_max3_f32 v101, v101, v76, v77
 v_max3_f32 v101, v101, v78, v79
 v_mov_b32 v103, v101
 s_nop 1
 v_permlane32_swap_b32 v101, v103
 v_max_f32 v101, v101, v103
 v_sub_f32 v32, 0, v101
 v_sub_f32 v33, 0, v101
 v_sub_f32 v34, 0, v101
 v_sub_f32 v35, 0, v101
 v_sub_f32 v36, 0, v101
 v_sub_f32 v37, 0, v101
 v_sub_f32 v38, 0, v101
 v_sub_f32 v39, 0, v101
 v_sub_f32 v40, 0, v101
 v_sub_f32 v41, 0, v101
 v_sub_f32 v42, 0, v101
 v_sub_f32 v43, 0, v101
 v_sub_f32 v44, 0, v101
 v_sub_f32 v45, 0, v101
 v_sub_f32 v46, 0, v101
 v_sub_f32 v47, 0, v101
 v_exp_f32 v48, v48
 v_exp_f32 v49, v49
 v_exp_f32 v50, v50
 v_exp_f32 v51, v51
 v_mfma_f32_32x32x16_bf16 v[64:79], a[104:107], a[4:7], v[32:47]
 v_exp_f32 v52, v52
 v_exp_f32 v53, v53
 ds_read_b128 a[112:115], v2 offset:2048
 v_exp_f32 v54, v54
 v_exp_f32 v55, v55
 v_cvt_pk_bf16_f32 v80, v48, v49
 v_cvt_pk_bf16_f32 v81, v50, v51
 v_mfma_f32_32x32x16_bf16 v[64:79], a[140:143], a[40:43], v[64:79]
 v_exp_f32 v56, v56
 v_exp_f32 v57, v57
 s_add_u32 s30, s20, 65536
 s_add_u32 m0, s21, 65536
 s_nop 0
 buffer_load_dwordx4 v1, s[4:7], s30 offen sc1 lds
 s_add_u32 s30, s20, 69632
 s_add_u32 m0, s21, 69632
 s_nop 0
 buffer_load_dwordx4 v1, s[4:7], s30 offen sc1 lds
 s_add_u32 s30, s20, 73728
 s_add_u32 m0, s21, 73728
 s_nop 0
 buffer_load_dwordx4 v1, s[4:7], s30 offen sc1 lds
 v_exp_f32 v58, v58
 v_exp_f32 v59, v59
 v_cvt_pk_bf16_f32 v82, v52, v53
 v_cvt_pk_bf16_f32 v83, v54, v55
 v_exp_f32 v60, v60
 v_exp_f32 v61, v61
 v_exp_f32 v62, v62
 v_exp_f32 v63, v63
 v_cvt_pk_bf16_f32 v84, v56, v57
 v_cvt_pk_bf16_f32 v85, v58, v59
 s_waitcnt lgkmcnt(1)
 v_mfma_f32_32x32x16_bf16 a[72:87], a[116:119], v[80:83], 0
 v_exp_f32 v64, v64
 v_exp_f32 v65, v65
 v_cvt_pk_bf16_f32 v86, v60, v61
 v_cvt_pk_bf16_f32 v87, v62, v63
 v_exp_f32 v66, v66
 v_exp_f32 v67, v67
 v_mfma_f32_32x32x16_bf16 v[48:63], a[108:111], a[0:3], v[16:31]
 v_exp_f32 v68, v68
 v_exp_f32 v69, v69
 ds_read_b128 a[124:127], v6 offset:1216
 v_exp_f32 v70, v70
 v_exp_f32 v71, v71
 v_cvt_pk_bf16_f32 v88, v64, v65
 v_cvt_pk_bf16_f32 v89, v66, v67
 v_mfma_f32_32x32x16_bf16 v[48:63], a[140:143], a[12:15], v[48:63]
 v_exp_f32 v72, v72
 v_exp_f32 v73, v73
 ds_read_b128 a[128:131], v6 offset:1824
 v_exp_f32 v74, v74
 v_exp_f32 v75, v75
 v_cvt_pk_bf16_f32 v90, v68, v69
 v_cvt_pk_bf16_f32 v91, v70, v71
 v_mfma_f32_32x32x16_bf16 a[72:87], a[120:123], v[84:87], a[72:87]
 v_exp_f32 v76, v76
 v_exp_f32 v77, v77
 v_exp_f32 v78, v78
 v_exp_f32 v79, v79
 v_cvt_pk_bf16_f32 v92, v72, v73
 v_cvt_pk_bf16_f32 v93, v74, v75
 v_mfma_f32_32x32x16_bf16 a[88:103], a[116:119], v[88:91], 0
 v_exp_f32 v48, v48
 v_exp_f32 v49, v49
 v_cvt_pk_bf16_f32 v94, v76, v77
 v_cvt_pk_bf16_f32 v95, v78, v79
 v_exp_f32 v50, v50
 v_exp_f32 v51, v51
 v_mfma_f32_32x32x16_bf16 v[64:79], a[108:111], a[4:7], v[32:47]
 v_exp_f32 v52, v52
 v_exp_f32 v53, v53
 ds_read_b128 a[104:107], v2 offset:3072
 v_exp_f32 v54, v54
 v_exp_f32 v55, v55
 v_cvt_pk_bf16_f32 v80, v48, v49
 v_cvt_pk_bf16_f32 v81, v50, v51
 v_mfma_f32_32x32x16_bf16 v[64:79], a[140:143], a[44:47], v[64:79]
 v_exp_f32 v56, v56
 v_exp_f32 v57, v57
 s_add_u32 s30, s20, 77824
 s_add_u32 m0, s21, 77824
 s_nop 0
 buffer_load_dwordx4 v1, s[4:7], s30 offen sc1 lds
 s_add_u32 s30, s20, 81920
 s_add_u32 m0, s21, 81920
 s_nop 0
 buffer_load_dwordx4 v1, s[4:7], s30 offen sc1 lds
 s_add_u32 s30, s20, 86016
 s_add_u32 m0, s21, 86016
 s_nop 0
 buffer_load_dwordx4 v1, s[4:7], s30 offen sc1 lds
 v_exp_f32 v58, v58
 v_exp_f32 v59, v59
 v_cvt_pk_bf16_f32 v82, v52, v53
 v_cvt_pk_bf16_f32 v83, v54, v55
 v_mfma_f32_32x32x16_bf16 a[88:103], a[120:123], v[92:95], a[88:103]
 v_exp_f32 v60, v60
 v_exp_f32 v61, v61
 v_exp_f32 v62, v62
 v_exp_f32 v63, v63
 v_cvt_pk_bf16_f32 v84, v56, v57
 v_cvt_pk_bf16_f32 v85, v58, v59
 s_waitcnt lgkmcnt(1)
 v_mfma_f32_32x32x16_bf16 a[72:87], a[124:127], v[80:83], a[72:87]
 v_exp_f32 v64, v64
 v_exp_f32 v65, v65
 v_cvt_pk_bf16_f32 v86, v60, v61
 v_cvt_pk_bf16_f32 v87, v62, v63
 v_exp_f32 v66, v66
 v_exp_f32 v67, v67
 v_mfma_f32_32x32x16_bf16 v[48:63], a[112:115], a[0:3], v[16:31]
 v_exp_f32 v68, v68
 v_exp_f32 v69, v69
 ds_read_b128 a[132:135], v6 offset:2432
 v_exp_f32 v70, v70
 v_exp_f32 v71, v71
 v_cvt_pk_bf16_f32 v88, v64, v65
 v_cvt_pk_bf16_f32 v89, v66, v67
 v_mfma_f32_32x32x16_bf16 v[48:63], a[140:143], a[16:19], v[48:63]
 v_exp_f32 v72, v72
 v_exp_f32 v73, v73
 ds_read_b128 a[136:139], v6 offset:3040
 v_exp_f32 v74, v74
 v_exp_f32 v75, v75
 v_cvt_pk_bf16_f32 v90, v68, v69
 v_cvt_pk_bf16_f32 v91, v70, v71
 v_mfma_f32_32x32x16_bf16 a[72:87], a[128:131], v[84:87], a[72:87]
 v_exp_f32 v76, v76
 v_exp_f32 v77, v77
 v_exp_f32 v78, v78
 v_exp_f32 v79, v79
 v_cvt_pk_bf16_f32 v92, v72, v73
 v_cvt_pk_bf16_f32 v93, v74, v75
 v_mfma_f32_32x32x16_bf16 a[88:103], a[124:127], v[88:91], a[88:103]
 v_exp_f32 v48, v48
 v_exp_f32 v49, v49
 v_cvt_pk_bf16_f32 v94, v76, v77
 v_cvt_pk_bf16_f32 v95, v78, v79
 v_exp_f32 v50, v50
 v_exp_f32 v51, v51
 v_mfma_f32_32x32x16_bf16 v[64:79], a[112:115], a[4:7], v[32:47]
 v_exp_f32 v52, v52
 v_exp_f32 v53, v53
 ds_read_b128 a[108:111], v2 offset:4096
 v_exp_f32 v54, v54
 v_exp_f32 v55, v55
 v_cvt_pk_bf16_f32 v80, v48, v49
 v_cvt_pk_bf16_f32 v81, v50, v51
 v_mfma_f32_32x32x16_bf16 v[64:79], a[140:143], a[48:51], v[64:79]
 v_exp_f32 v56, v56
 v_exp_f32 v57, v57
 s_add_u32 s30, s20, 90112
 s_add_u32 m0, s21, 90112
 s_nop 0
 buffer_load_dwordx4 v1, s[4:7], s30 offen sc1 lds
 s_add_u32 s30, s20, 94208
 s_add_u32 m0, s21, 94208
 s_nop 0
 buffer_load_dwordx4 v1, s[4:7], s30 offen sc1 lds
 s_add_u32 s30, s20, 98304
 s_add_u32 m0, s21, 98304
 s_nop 0
 buffer_load_dwordx4 v1, s[4:7], s30 offen sc1 lds
 v_exp_f32 v58, v58
 v_exp_f32 v59, v59
 v_cvt_pk_bf16_f32 v82, v52, v53
 v_cvt_pk_bf16_f32 v83, v54, v55
 v_mfma_f32_32x32x16_bf16 a[88:103], a[128:131], v[92:95], a[88:103]
 v_exp_f32 v60, v60
 v_exp_f32 v61, v61
 v_exp_f32 v62, v62
 v_exp_f32 v63, v63
 v_cvt_pk_bf16_f32 v84, v56, v57
 v_cvt_pk_bf16_f32 v85, v58, v59
 s_waitcnt lgkmcnt(1)
 v_mfma_f32_32x32x16_bf16 a[72:87], a[132:135], v[80:83], a[72:87]
 v_exp_f32 v64, v64
 v_exp_f32 v65, v65
 v_cvt_pk_bf16_f32 v86, v60, v61
 v_cvt_pk_bf16_f32 v87, v62, v63
 v_exp_f32 v66, v66
 v_exp_f32 v67, v67
 v_mfma_f32_32x32x16_bf16 v[48:63], a[104:107], a[0:3], v[16:31]
 v_exp_f32 v68, v68
 v_exp_f32 v69, v69
 ds_read_b128 a[116:119], v6 offset:3648
 v_exp_f32 v70, v70
 v_exp_f32 v71, v71
 v_cvt_pk_bf16_f32 v88, v64, v65
 v_cvt_pk_bf16_f32 v89, v66, v67
 v_mfma_f32_32x32x16_bf16 v[48:63], a[140:143], a[20:23], v[48:63]
 v_exp_f32 v72, v72
 v_exp_f32 v73, v73
 ds_read_b128 a[120:123], v6 offset:4256
 v_exp_f32 v74, v74
 v_exp_f32 v75, v75
 v_cvt_pk_bf16_f32 v90, v68, v69
 v_cvt_pk_bf16_f32 v91, v70, v71
 v_mfma_f32_32x32x16_bf16 a[72:87], a[136:139], v[84:87], a[72:87]
 v_exp_f32 v76, v76
 v_exp_f32 v77, v77
 v_exp_f32 v78, v78
 v_exp_f32 v79, v79
 v_cvt_pk_bf16_f32 v92, v72, v73
 v_cvt_pk_bf16_f32 v93, v74, v75
 v_mfma_f32_32x32x16_bf16 a[88:103], a[132:135], v[88:91], a[88:103]
 v_exp_f32 v48, v48
 v_exp_f32 v49, v49
 v_cvt_pk_bf16_f32 v94, v76, v77
 v_cvt_pk_bf16_f32 v95, v78, v79
 v_exp_f32 v50, v50
 v_exp_f32 v51, v51
 v_mfma_f32_32x32x16_bf16 v[64:79], a[104:107], a[4:7], v[32:47]
 v_exp_f32 v52, v52
 v_exp_f32 v53, v53
 ds_read_b128 a[112:115], v2 offset:5120
 v_exp_f32 v54, v54
 v_exp_f32 v55, v55
 v_cvt_pk_bf16_f32 v80, v48, v49
 v_cvt_pk_bf16_f32 v81, v50, v51
 v_mfma_f32_32x32x16_bf16 v[64:79], a[140:143], a[52:55], v[64:79]
 v_exp_f32 v56, v56
 v_exp_f32 v57, v57
 s_add_u32 s30, s20, 102400
 s_add_u32 m0, s21, 102400
 s_nop 0
 buffer_load_dwordx4 v1, s[4:7], s30 offen sc1 lds
 s_add_u32 s30, s20, 106496
 s_add_u32 m0, s21, 106496
 s_nop 0
 buffer_load_dwordx4 v1, s[4:7], s30 offen sc1 lds
 s_add_u32 s30, s20, 110592
 s_add_u32 m0, s21, 110592
 s_nop 0
 buffer_load_dwordx4 v1, s[4:7], s30 offen sc1 lds
 v_exp_f32 v58, v58
 v_exp_f32 v59, v59
 v_cvt_pk_bf16_f32 v82, v52, v53
 v_cvt_pk_bf16_f32 v83, v54, v55
 v_mfma_f32_32x32x16_bf16 a[88:103], a[136:139], v[92:95], a[88:103]
 v_exp_f32 v60, v60
 v_exp_f32 v61, v61
 v_exp_f32 v62, v62
 v_exp_f32 v63, v63
 v_cvt_pk_bf16_f32 v84, v56, v57
 v_cvt_pk_bf16_f32 v85, v58, v59
 s_waitcnt lgkmcnt(1)
 v_mfma_f32_32x32x16_bf16 a[72:87], a[116:119], v[80:83], a[72:87]
 v_exp_f32 v64, v64
 v_exp_f32 v65, v65
 v_cvt_pk_bf16_f32 v86, v60, v61
 v_cvt_pk_bf16_f32 v87, v62, v63
 v_exp_f32 v66, v66
 v_exp_f32 v67, v67
 v_mfma_f32_32x32x16_bf16 v[48:63], a[108:111], a[0:3], v[16:31]
 v_exp_f32 v68, v68
 v_exp_f32 v69, v69
 ds_read_b128 a[124:127], v6 offset:4864
 v_exp_f32 v70, v70
 v_exp_f32 v71, v71
 v_cvt_pk_bf16_f32 v88, v64, v65
 v_cvt_pk_bf16_f32 v89, v66, v67
 v_mfma_f32_32x32x16_bf16 v[48:63], a[140:143], a[24:27], v[48:63]
 v_exp_f32 v72, v72
 v_exp_f32 v73, v73
 ds_read_b128 a[128:131], v6 offset:5472
 v_exp_f32 v74, v74
 v_exp_f32 v75, v75
 v_cvt_pk_bf16_f32 v90, v68, v69
 v_cvt_pk_bf16_f32 v91, v70, v71
 v_mfma_f32_32x32x16_bf16 a[72:87], a[120:123], v[84:87], a[72:87]
 v_exp_f32 v76, v76
 v_exp_f32 v77, v77
 v_exp_f32 v78, v78
 v_exp_f32 v79, v79
 v_cvt_pk_bf16_f32 v92, v72, v73
 v_cvt_pk_bf16_f32 v93, v74, v75
 v_mfma_f32_32x32x16_bf16 a[88:103], a[116:119], v[88:91], a[88:103]
 v_exp_f32 v48, v48
 v_exp_f32 v49, v49
 v_cvt_pk_bf16_f32 v94, v76, v77
 v_cvt_pk_bf16_f32 v95, v78, v79
 v_exp_f32 v50, v50
 v_exp_f32 v51, v51
 v_mfma_f32_32x32x16_bf16 v[64:79], a[108:111], a[4:7], v[32:47]
 v_exp_f32 v52, v52
 v_exp_f32 v53, v53
 ds_read_b128 a[104:107], v2 offset:6144
 v_exp_f32 v54, v54
 v_exp_f32 v55, v55
 v_cvt_pk_bf16_f32 v80, v48, v49
 v_cvt_pk_bf16_f32 v81, v50, v51
 v_mfma_f32_32x32x16_bf16 v[64:79], a[140:143], a[56:59], v[64:79]
 v_exp_f32 v56, v56
 v_exp_f32 v57, v57
 s_add_u32 s30, s20, 114688
 s_add_u32 m0, s21, 114688
 s_nop 0
 buffer_load_dwordx4 v1, s[4:7], s30 offen sc1 lds
 s_add_u32 s30, s20, 118784
 s_add_u32 m0, s21, 118784
 s_nop 0
 buffer_load_dwordx4 v1, s[4:7], s30 offen sc1 lds
 s_add_u32 s30, s20, 122880
 s_add_u32 m0, s21, 122880
 s_nop 0
 buffer_load_dwordx4 v1, s[4:7], s30 offen sc1 lds
 v_exp_f32 v58, v58
 v_exp_f32 v59, v59
 v_cvt_pk_bf16_f32 v82, v52, v53
 v_cvt_pk_bf16_f32 v83, v54, v55
 v_mfma_f32_32x32x16_bf16 a[88:103], a[120:123], v[92:95], a[88:103]
 v_exp_f32 v60, v60
 v_exp_f32 v61, v61
 v_exp_f32 v62, v62
 v_exp_f32 v63, v63
 v_cvt_pk_bf16_f32 v84, v56, v57
 v_cvt_pk_bf16_f32 v85, v58, v59
 s_waitcnt lgkmcnt(1)
 v_mfma_f32_32x32x16_bf16 a[72:87], a[124:127], v[80:83], a[72:87]
 v_exp_f32 v64, v64
 v_exp_f32 v65, v65
 v_cvt_pk_bf16_f32 v86, v60, v61
 v_cvt_pk_bf16_f32 v87, v62, v63
 v_exp_f32 v66, v66
 v_exp_f32 v67, v67
 v_mfma_f32_32x32x16_bf16 v[48:63], a[112:115], a[0:3], v[16:31]
 v_exp_f32 v68, v68
 v_exp_f32 v69, v69
 ds_read_b128 a[132:135], v6 offset:6080
 v_exp_f32 v70, v70
 v_exp_f32 v71, v71
 v_cvt_pk_bf16_f32 v88, v64, v65
 v_cvt_pk_bf16_f32 v89, v66, v67
 v_mfma_f32_32x32x16_bf16 v[48:63], a[140:143], a[28:31], v[48:63]
 v_exp_f32 v72, v72
 v_exp_f32 v73, v73
 ds_read_b128 a[136:139], v6 offset:6688
 v_exp_f32 v74, v74
 v_exp_f32 v75, v75
 v_cvt_pk_bf16_f32 v90, v68, v69
 v_cvt_pk_bf16_f32 v91, v70, v71
 v_mfma_f32_32x32x16_bf16 a[72:87], a[128:131], v[84:87], a[72:87]
 v_exp_f32 v76, v76
 v_exp_f32 v77, v77
 v_exp_f32 v78, v78
 v_exp_f32 v79, v79
 v_cvt_pk_bf16_f32 v92, v72, v73
 v_cvt_pk_bf16_f32 v93, v74, v75
 v_mfma_f32_32x32x16_bf16 a[88:103], a[124:127], v[88:91], a[88:103]
 v_exp_f32 v48, v48
 v_exp_f32 v49, v49
 v_cvt_pk_bf16_f32 v94, v76, v77
 v_cvt_pk_bf16_f32 v95, v78, v79
 v_exp_f32 v50, v50
 v_exp_f32 v51, v51
 v_mfma_f32_32x32x16_bf16 v[64:79], a[112:115], a[4:7], v[32:47]
 v_exp_f32 v52, v52
 v_exp_f32 v53, v53
 ds_read_b128 a[108:111], v2 offset:7168
 v_exp_f32 v54, v54
 v_exp_f32 v55, v55
 v_cvt_pk_bf16_f32 v80, v48, v49
 v_cvt_pk_bf16_f32 v81, v50, v51
 v_mfma_f32_32x32x16_bf16 v[64:79], a[140:143], a[60:63], v[64:79]
 v_exp_f32 v56, v56
 v_exp_f32 v57, v57
 s_add_u32 s30, s20, 126976
 s_add_u32 m0, s21, 126976
 s_nop 0
 buffer_load_dwordx4 v1, s[4:7], s30 offen sc1 lds
 s_add_u32 s30, s20, 131072
 s_add_u32 m0, s21, 131072
 s_nop 0
 buffer_load_dwordx4 v1, s[4:7], s30 offen sc1 lds
 s_add_u32 s30, s20, 135168
 s_add_u32 m0, s21, 135168
 s_nop 0
 buffer_load_dwordx4 v1, s[4:7], s30 offen sc1 lds
 v_exp_f32 v58, v58
 v_exp_f32 v59, v59
 v_cvt_pk_bf16_f32 v82, v52, v53
 v_cvt_pk_bf16_f32 v83, v54, v55
 v_mfma_f32_32x32x16_bf16 a[88:103], a[128:131], v[92:95], a[88:103]
 v_exp_f32 v60, v60
 v_exp_f32 v61, v61
 v_exp_f32 v62, v62
 v_exp_f32 v63, v63
 v_cvt_pk_bf16_f32 v84, v56, v57
 v_cvt_pk_bf16_f32 v85, v58, v59
 s_waitcnt lgkmcnt(1)
 v_mfma_f32_32x32x16_bf16 a[72:87], a[132:135], v[80:83], a[72:87]
 v_exp_f32 v64, v64
 v_exp_f32 v65, v65
 v_cvt_pk_bf16_f32 v86, v60, v61
 v_cvt_pk_bf16_f32 v87, v62, v63
 v_exp_f32 v66, v66
 v_exp_f32 v67, v67
 v_mfma_f32_32x32x16_bf16 v[48:63], a[104:107], a[0:3], v[16:31]
 v_exp_f32 v68, v68
 v_exp_f32 v69, v69
 ds_read_b128 a[116:119], v6 offset:7296
 v_exp_f32 v70, v70
 v_exp_f32 v71, v71
 v_cvt_pk_bf16_f32 v88, v64, v65
 v_cvt_pk_bf16_f32 v89, v66, v67
 v_mfma_f32_32x32x16_bf16 v[48:63], a[140:143], a[32:35], v[48:63]
 v_exp_f32 v72, v72
 v_exp_f32 v73, v73
 ds_read_b128 a[120:123], v6 offset:7904
 v_exp_f32 v74, v74
 v_exp_f32 v75, v75
 v_cvt_pk_bf16_f32 v90, v68, v69
 v_cvt_pk_bf16_f32 v91, v70, v71
 v_mfma_f32_32x32x16_bf16 a[72:87], a[136:139], v[84:87], a[72:87]
 v_exp_f32 v76, v76
 v_exp_f32 v77, v77
 v_exp_f32 v78, v78
 v_exp_f32 v79, v79
 v_cvt_pk_bf16_f32 v92, v72, v73
 v_cvt_pk_bf16_f32 v93, v74, v75
 v_mfma_f32_32x32x16_bf16 a[88:103], a[132:135], v[88:91], a[88:103]
 v_exp_f32 v48, v48
 v_exp_f32 v49, v49
 v_cvt_pk_bf16_f32 v94, v76, v77
 v_cvt_pk_bf16_f32 v95, v78, v79
 v_exp_f32 v50, v50
 v_exp_f32 v51, v51
 v_mfma_f32_32x32x16_bf16 v[64:79], a[104:107], a[4:7], v[32:47]
 v_exp_f32 v52, v52
 v_exp_f32 v53, v53
 s_waitcnt vmcnt(24)
 s_barrier
 ds_read_b128 a[112:115], v2 offset:18944
 ds_read_b128 a[144:147], v2 offset:27136
 v_exp_f32 v54, v54
 v_exp_f32 v55, v55
 v_cvt_pk_bf16_f32 v80, v48, v49
 v_cvt_pk_bf16_f32 v81, v50, v51
 v_mfma_f32_32x32x16_bf16 v[64:79], a[140:143], a[64:67], v[64:79]
 v_exp_f32 v56, v56
 v_exp_f32 v57, v57
 s_add_u32 s30, s20, 139264
 s_add_u32 m0, s21, 139264
 s_nop 0
 buffer_load_dwordx4 v1, s[4:7], s30 offen sc1 lds
 s_add_u32 s30, s20, 143360
 s_add_u32 m0, s21, 143360
 s_nop 0
 buffer_load_dwordx4 v1, s[4:7], s30 offen sc1 lds
 s_add_u32 s30, s20, 147456
 s_add_u32 m0, s21, 147456
 s_nop 0
 buffer_load_dwordx4 v1, s[4:7], s30 offen sc1 lds
 v_exp_f32 v58, v58
 v_exp_f32 v59, v59
 v_cvt_pk_bf16_f32 v82, v52, v53
 v_cvt_pk_bf16_f32 v83, v54, v55
 v_mfma_f32_32x32x16_bf16 a[88:103], a[136:139], v[92:95], a[88:103]
 v_exp_f32 v60, v60
 v_exp_f32 v61, v61
 v_exp_f32 v62, v62
 v_exp_f32 v63, v63
 v_cvt_pk_bf16_f32 v84, v56, v57
 v_cvt_pk_bf16_f32 v85, v58, v59
 s_waitcnt lgkmcnt(2)
 v_mfma_f32_32x32x16_bf16 a[72:87], a[116:119], v[80:83], a[72:87]
 v_exp_f32 v64, v64
 v_exp_f32 v65, v65
 v_cvt_pk_bf16_f32 v86, v60, v61
 v_cvt_pk_bf16_f32 v87, v62, v63
 v_exp_f32 v66, v66
 v_exp_f32 v67, v67
 v_mfma_f32_32x32x16_bf16 v[48:63], a[108:111], a[0:3], v[16:31]
 v_exp_f32 v68, v68
 v_exp_f32 v69, v69
 ds_read_b128 a[124:127], v6 offset:8512
 v_exp_f32 v70, v70
 v_exp_f32 v71, v71
 v_cvt_pk_bf16_f32 v88, v64, v65
 v_cvt_pk_bf16_f32 v89, v66, v67
 v_mfma_f32_32x32x16_bf16 v[48:63], a[140:143], a[36:39], v[48:63]
 v_exp_f32 v72, v72
 v_exp_f32 v73, v73
 ds_read_b128 a[128:131], v6 offset:9120
 v_exp_f32 v74, v74
 v_exp_f32 v75, v75
 v_cvt_pk_bf16_f32 v90, v68, v69
 v_cvt_pk_bf16_f32 v91, v70, v71
 v_mfma_f32_32x32x16_bf16 a[72:87], a[120:123], v[84:87], a[72:87]
 v_exp_f32 v76, v76
 v_exp_f32 v77, v77
 v_exp_f32 v78, v78
 v_exp_f32 v79, v79
 v_cvt_pk_bf16_f32 v92, v72, v73
 v_cvt_pk_bf16_f32 v93, v74, v75
 v_mfma_f32_32x32x16_bf16 a[88:103], a[116:119], v[88:91], a[88:103]
 v_exp_f32 v48, v48
 v_exp_f32 v49, v49
 v_cvt_pk_bf16_f32 v94, v76, v77
 v_cvt_pk_bf16_f32 v95, v78, v79
 v_exp_f32 v50, v50
 v_exp_f32 v51, v51
 v_mfma_f32_32x32x16_bf16 v[64:79], a[108:111], a[4:7], v[32:47]
 v_exp_f32 v52, v52
 v_exp_f32 v53, v53
 ds_read_b128 a[104:107], v2 offset:19968
 v_exp_f32 v54, v54
 v_exp_f32 v55, v55
 v_cvt_pk_bf16_f32 v80, v48, v49
 v_cvt_pk_bf16_f32 v81, v50, v51
 v_mfma_f32_32x32x16_bf16 v[64:79], a[140:143], a[68:71], v[64:79]
 v_exp_f32 v56, v56
 v_exp_f32 v57, v57
 v_exp_f32 v58, v58
 v_exp_f32 v59, v59
 v_cvt_pk_bf16_f32 v82, v52, v53
 v_cvt_pk_bf16_f32 v83, v54, v55
 v_mfma_f32_32x32x16_bf16 a[88:103], a[120:123], v[92:95], a[88:103]
 v_exp_f32 v60, v60
 v_exp_f32 v61, v61
 v_exp_f32 v62, v62
 v_exp_f32 v63, v63
 v_cvt_pk_bf16_f32 v84, v56, v57
 v_cvt_pk_bf16_f32 v85, v58, v59
 s_waitcnt lgkmcnt(1)
 v_mfma_f32_32x32x16_bf16 a[72:87], a[124:127], v[80:83], a[72:87]
 v_exp_f32 v64, v64
 v_exp_f32 v65, v65
 v_cvt_pk_bf16_f32 v86, v60, v61
 v_cvt_pk_bf16_f32 v87, v62, v63
 v_exp_f32 v66, v66
 v_exp_f32 v67, v67
 v_mfma_f32_32x32x16_bf16 v[48:63], a[112:115], a[0:3], v[16:31]
 v_exp_f32 v68, v68
 v_exp_f32 v69, v69
 ds_read_b128 a[132:135], v6 offset:18944
 v_exp_f32 v70, v70
 v_exp_f32 v71, v71
 v_cvt_pk_bf16_f32 v88, v64, v65
 v_cvt_pk_bf16_f32 v89, v66, v67
 v_mfma_f32_32x32x16_bf16 v[48:63], a[144:147], a[8:11], v[48:63]
 v_exp_f32 v72, v72
 v_exp_f32 v73, v73
 ds_read_b128 a[136:139], v6 offset:19552
 v_exp_f32 v74, v74
 v_exp_f32 v75, v75
 v_cvt_pk_bf16_f32 v90, v68, v69
 v_cvt_pk_bf16_f32 v91, v70, v71
 v_mfma_f32_32x32x16_bf16 a[72:87], a[128:131], v[84:87], a[72:87]
 v_exp_f32 v76, v76
 v_exp_f32 v77, v77
 v_exp_f32 v78, v78
 v_exp_f32 v79, v79
 v_cvt_pk_bf16_f32 v92, v72, v73
 v_cvt_pk_bf16_f32 v93, v74, v75
 v_mfma_f32_32x32x16_bf16 a[88:103], a[124:127], v[88:91], a[88:103]
 v_exp_f32 v48, v48
 v_exp_f32 v49, v49
 v_cvt_pk_bf16_f32 v94, v76, v77
 v_cvt_pk_bf16_f32 v95, v78, v79
 v_exp_f32 v50, v50
 v_exp_f32 v51, v51
 v_mfma_f32_32x32x16_bf16 v[64:79], a[112:115], a[4:7], v[32:47]
 v_exp_f32 v52, v52
 v_exp_f32 v53, v53
 ds_read_b128 a[108:111], v2 offset:20992
 v_exp_f32 v54, v54
 v_exp_f32 v55, v55
 v_cvt_pk_bf16_f32 v80, v48, v49
 v_cvt_pk_bf16_f32 v81, v50, v51
 v_mfma_f32_32x32x16_bf16 v[64:79], a[144:147], a[40:43], v[64:79]
 v_exp_f32 v56, v56
 v_exp_f32 v57, v57
 v_exp_f32 v58, v58
 v_exp_f32 v59, v59
 v_cvt_pk_bf16_f32 v82, v52, v53
 v_cvt_pk_bf16_f32 v83, v54, v55
 v_mfma_f32_32x32x16_bf16 a[88:103], a[128:131], v[92:95], a[88:103]
 v_exp_f32 v60, v60
 v_exp_f32 v61, v61
 v_exp_f32 v62, v62
 v_exp_f32 v63, v63
 v_cvt_pk_bf16_f32 v84, v56, v57
 v_cvt_pk_bf16_f32 v85, v58, v59
 s_waitcnt lgkmcnt(1)
 v_mfma_f32_32x32x16_bf16 a[72:87], a[132:135], v[80:83], a[72:87]
 v_exp_f32 v64, v64
 v_exp_f32 v65, v65
 v_cvt_pk_bf16_f32 v86, v60, v61
 v_cvt_pk_bf16_f32 v87, v62, v63
 v_exp_f32 v66, v66
 v_exp_f32 v67, v67
 v_mfma_f32_32x32x16_bf16 v[48:63], a[104:107], a[0:3], v[16:31]
 v_exp_f32 v68, v68
 v_exp_f32 v69, v69
 ds_read_b128 a[116:119], v6 offset:20160
 v_exp_f32 v70, v70
 v_exp_f32 v71, v71
 v_cvt_pk_bf16_f32 v88, v64, v65
 v_cvt_pk_bf16_f32 v89, v66, v67
 v_mfma_f32_32x32x16_bf16 v[48:63], a[144:147], a[12:15], v[48:63]
 v_exp_f32 v72, v72
 v_exp_f32 v73, v73
 ds_read_b128 a[120:123], v6 offset:20768
 v_exp_f32 v74, v74
 v_exp_f32 v75, v75
 v_cvt_pk_bf16_f32 v90, v68, v69
 v_cvt_pk_bf16_f32 v91, v70, v71
 v_mfma_f32_32x32x16_bf16 a[72:87], a[136:139], v[84:87], a[72:87]
 v_exp_f32 v76, v76
 v_exp_f32 v77, v77
 v_exp_f32 v78, v78
 v_exp_f32 v79, v79
 v_cvt_pk_bf16_f32 v92, v72, v73
 v_cvt_pk_bf16_f32 v93, v74, v75
 v_mfma_f32_32x32x16_bf16 a[88:103], a[132:135], v[88:91], a[88:103]
 v_exp_f32 v48, v48
 v_exp_f32 v49, v49
 v_cvt_pk_bf16_f32 v94, v76, v77
 v_cvt_pk_bf16_f32 v95, v78, v79
 v_exp_f32 v50, v50
 v_exp_f32 v51, v51
 v_mfma_f32_32x32x16_bf16 v[64:79], a[104:107], a[4:7], v[32:47]
 v_exp_f32 v52, v52
 v_exp_f32 v53, v53
 ds_read_b128 a[112:115], v2 offset:22016
 v_exp_f32 v54, v54
 v_exp_f32 v55, v55
 v_cvt_pk_bf16_f32 v80, v48, v49
 v_cvt_pk_bf16_f32 v81, v50, v51
 v_mfma_f32_32x32x16_bf16 v[64:79], a[144:147], a[44:47], v[64:79]
 v_exp_f32 v56, v56
 v_exp_f32 v57, v57
 v_exp_f32 v58, v58
 v_exp_f32 v59, v59
 v_cvt_pk_bf16_f32 v82, v52, v53
 v_cvt_pk_bf16_f32 v83, v54, v55
 v_mfma_f32_32x32x16_bf16 a[88:103], a[136:139], v[92:95], a[88:103]
 v_exp_f32 v60, v60
 v_exp_f32 v61, v61
 v_exp_f32 v62, v62
 v_exp_f32 v63, v63
 v_cvt_pk_bf16_f32 v84, v56, v57
 v_cvt_pk_bf16_f32 v85, v58, v59
 s_waitcnt lgkmcnt(1)
 v_mfma_f32_32x32x16_bf16 a[72:87], a[116:119], v[80:83], a[72:87]
 v_exp_f32 v64, v64
 v_exp_f32 v65, v65
 v_cvt_pk_bf16_f32 v86, v60, v61
 v_cvt_pk_bf16_f32 v87, v62, v63
 v_exp_f32 v66, v66
 v_exp_f32 v67, v67
 v_mfma_f32_32x32x16_bf16 v[48:63], a[108:111], a[0:3], v[16:31]
 v_exp_f32 v68, v68
 v_exp_f32 v69, v69
 ds_read_b128 a[124:127], v6 offset:21376
 v_exp_f32 v70, v70
 v_exp_f32 v71, v71
 v_cvt_pk_bf16_f32 v88, v64, v65
 v_cvt_pk_bf16_f32 v89, v66, v67
 v_mfma_f32_32x32x16_bf16 v[48:63], a[144:147], a[16:19], v[48:63]
 v_exp_f32 v72, v72
 v_exp_f32 v73, v73
 ds_read_b128 a[128:131], v6 offset:21984
 v_exp_f32 v74, v74
 v_exp_f32 v75, v75
 v_cvt_pk_bf16_f32 v90, v68, v69
 v_cvt_pk_bf16_f32 v91, v70, v71
 v_mfma_f32_32x32x16_bf16 a[72:87], a[120:123], v[84:87], a[72:87]
 v_exp_f32 v76, v76
 v_exp_f32 v77, v77
 v_exp_f32 v78, v78
 v_exp_f32 v79, v79
 v_cvt_pk_bf16_f32 v92, v72, v73
 v_cvt_pk_bf16_f32 v93, v74, v75
 v_mfma_f32_32x32x16_bf16 a[88:103], a[116:119], v[88:91], a[88:103]
 v_exp_f32 v48, v48
 v_exp_f32 v49, v49
 v_cvt_pk_bf16_f32 v94, v76, v77
 v_cvt_pk_bf16_f32 v95, v78, v79
 v_exp_f32 v50, v50
 v_exp_f32 v51, v51
 v_mfma_f32_32x32x16_bf16 v[64:79], a[108:111], a[4:7], v[32:47]
 v_exp_f32 v52, v52
 v_exp_f32 v53, v53
 ds_read_b128 a[104:107], v2 offset:23040
 v_exp_f32 v54, v54
 v_exp_f32 v55, v55
 v_cvt_pk_bf16_f32 v80, v48, v49
 v_cvt_pk_bf16_f32 v81, v50, v51
 v_mfma_f32_32x32x16_bf16 v[64:79], a[144:147], a[48:51], v[64:79]
 v_exp_f32 v56, v56
 v_exp_f32 v57, v57
 v_exp_f32 v58, v58
 v_exp_f32 v59, v59
 v_cvt_pk_bf16_f32 v82, v52, v53
 v_cvt_pk_bf16_f32 v83, v54, v55
 v_mfma_f32_32x32x16_bf16 a[88:103], a[120:123], v[92:95], a[88:103]
 v_exp_f32 v60, v60
 v_exp_f32 v61, v61
 v_exp_f32 v62, v62
 v_exp_f32 v63, v63
 v_cvt_pk_bf16_f32 v84, v56, v57
 v_cvt_pk_bf16_f32 v85, v58, v59
 s_waitcnt lgkmcnt(1)
 v_mfma_f32_32x32x16_bf16 a[72:87], a[124:127], v[80:83], a[72:87]
 v_exp_f32 v64, v64
 v_exp_f32 v65, v65
 v_cvt_pk_bf16_f32 v86, v60, v61
 v_cvt_pk_bf16_f32 v87, v62, v63
 v_exp_f32 v66, v66
 v_exp_f32 v67, v67
 v_mfma_f32_32x32x16_bf16 v[48:63], a[112:115], a[0:3], v[16:31]
 v_exp_f32 v68, v68
 v_exp_f32 v69, v69
 ds_read_b128 a[132:135], v6 offset:22592
 v_exp_f32 v70, v70
 v_exp_f32 v71, v71
 v_cvt_pk_bf16_f32 v88, v64, v65
 v_cvt_pk_bf16_f32 v89, v66, v67
 v_mfma_f32_32x32x16_bf16 v[48:63], a[144:147], a[20:23], v[48:63]
 v_exp_f32 v72, v72
 v_exp_f32 v73, v73
 ds_read_b128 a[136:139], v6 offset:23200
 v_exp_f32 v74, v74
 v_exp_f32 v75, v75
 v_cvt_pk_bf16_f32 v90, v68, v69
 v_cvt_pk_bf16_f32 v91, v70, v71
 v_mfma_f32_32x32x16_bf16 a[72:87], a[128:131], v[84:87], a[72:87]
 v_exp_f32 v76, v76
 v_exp_f32 v77, v77
 v_exp_f32 v78, v78
 v_exp_f32 v79, v79
 v_cvt_pk_bf16_f32 v92, v72, v73
 v_cvt_pk_bf16_f32 v93, v74, v75
 v_mfma_f32_32x32x16_bf16 a[88:103], a[124:127], v[88:91], a[88:103]
 v_exp_f32 v48, v48
 v_exp_f32 v49, v49
 v_cvt_pk_bf16_f32 v94, v76, v77
 v_cvt_pk_bf16_f32 v95, v78, v79
 v_exp_f32 v50, v50
 v_exp_f32 v51, v51
 v_mfma_f32_32x32x16_bf16 v[64:79], a[112:115], a[4:7], v[32:47]
 v_exp_f32 v52, v52
 v_exp_f32 v53, v53
 ds_read_b128 a[108:111], v2 offset:24064
 v_exp_f32 v54, v54
 v_exp_f32 v55, v55
 v_cvt_pk_bf16_f32 v80, v48, v49
 v_cvt_pk_bf16_f32 v81, v50, v51
 v_mfma_f32_32x32x16_bf16 v[64:79], a[144:147], a[52:55], v[64:79]
 v_exp_f32 v56, v56
 v_exp_f32 v57, v57
 v_exp_f32 v58, v58
 v_exp_f32 v59, v59
 v_cvt_pk_bf16_f32 v82, v52, v53
 v_cvt_pk_bf16_f32 v83, v54, v55
 v_mfma_f32_32x32x16_bf16 a[88:103], a[128:131], v[92:95], a[88:103]
 v_exp_f32 v60, v60
 v_exp_f32 v61, v61
 v_exp_f32 v62, v62
 v_exp_f32 v63, v63
 v_cvt_pk_bf16_f32 v84, v56, v57
 v_cvt_pk_bf16_f32 v85, v58, v59
 s_waitcnt lgkmcnt(1)
 v_mfma_f32_32x32x16_bf16 a[72:87], a[132:135], v[80:83], a[72:87]
 v_exp_f32 v64, v64
 v_exp_f32 v65, v65
 v_cvt_pk_bf16_f32 v86, v60, v61
 v_cvt_pk_bf16_f32 v87, v62, v63
 v_exp_f32 v66, v66
 v_exp_f32 v67, v67
 v_mfma_f32_32x32x16_bf16 v[48:63], a[104:107], a[0:3], v[16:31]
 v_exp_f32 v68, v68
 v_exp_f32 v69, v69
 ds_read_b128 a[116:119], v6 offset:23808
 v_exp_f32 v70, v70
 v_exp_f32 v71, v71
 v_cvt_pk_bf16_f32 v88, v64, v65
 v_cvt_pk_bf16_f32 v89, v66, v67
 v_mfma_f32_32x32x16_bf16 v[48:63], a[144:147], a[24:27], v[48:63]
 v_exp_f32 v72, v72
 v_exp_f32 v73, v73
 ds_read_b128 a[120:123], v6 offset:24416
 v_exp_f32 v74, v74
 v_exp_f32 v75, v75
 v_cvt_pk_bf16_f32 v90, v68, v69
 v_cvt_pk_bf16_f32 v91, v70, v71
 v_mfma_f32_32x32x16_bf16 a[72:87], a[136:139], v[84:87], a[72:87]
 v_exp_f32 v76, v76
 v_exp_f32 v77, v77
 v_exp_f32 v78, v78
 v_exp_f32 v79, v79
 v_cvt_pk_bf16_f32 v92, v72, v73
 v_cvt_pk_bf16_f32 v93, v74, v75
 v_mfma_f32_32x32x16_bf16 a[88:103], a[132:135], v[88:91], a[88:103]
 v_exp_f32 v48, v48
 v_exp_f32 v49, v49
 v_cvt_pk_bf16_f32 v94, v76, v77
 v_cvt_pk_bf16_f32 v95, v78, v79
 v_exp_f32 v50, v50
 v_exp_f32 v51, v51
 v_mfma_f32_32x32x16_bf16 v[64:79], a[104:107], a[4:7], v[32:47]
 v_exp_f32 v52, v52
 v_exp_f32 v53, v53
 ds_read_b128 a[112:115], v2 offset:25088
 v_exp_f32 v54, v54
 v_exp_f32 v55, v55
 v_cvt_pk_bf16_f32 v80, v48, v49
 v_cvt_pk_bf16_f32 v81, v50, v51
 v_mfma_f32_32x32x16_bf16 v[64:79], a[144:147], a[56:59], v[64:79]
 v_exp_f32 v56, v56
 v_exp_f32 v57, v57
 v_exp_f32 v58, v58
 v_exp_f32 v59, v59
 v_cvt_pk_bf16_f32 v82, v52, v53
 v_cvt_pk_bf16_f32 v83, v54, v55
 v_mfma_f32_32x32x16_bf16 a[88:103], a[136:139], v[92:95], a[88:103]
 v_exp_f32 v60, v60
 v_exp_f32 v61, v61
 v_exp_f32 v62, v62
 v_exp_f32 v63, v63
 v_cvt_pk_bf16_f32 v84, v56, v57
 v_cvt_pk_bf16_f32 v85, v58, v59
 s_waitcnt lgkmcnt(1)
 v_mfma_f32_32x32x16_bf16 a[72:87], a[116:119], v[80:83], a[72:87]
 v_exp_f32 v64, v64
 v_exp_f32 v65, v65
 v_cvt_pk_bf16_f32 v86, v60, v61
 v_cvt_pk_bf16_f32 v87, v62, v63
 v_exp_f32 v66, v66
 v_exp_f32 v67, v67
 v_mfma_f32_32x32x16_bf16 v[48:63], a[108:111], a[0:3], v[16:31]
 v_exp_f32 v68, v68
 v_exp_f32 v69, v69
 ds_read_b128 a[124:127], v6 offset:25024
 v_exp_f32 v70, v70
 v_exp_f32 v71, v71
 v_cvt_pk_bf16_f32 v88, v64, v65
 v_cvt_pk_bf16_f32 v89, v66, v67
 v_mfma_f32_32x32x16_bf16 v[48:63], a[144:147], a[28:31], v[48:63]
 v_exp_f32 v72, v72
 v_exp_f32 v73, v73
 ds_read_b128 a[128:131], v6 offset:25632
 v_exp_f32 v74, v74
 v_exp_f32 v75, v75
 v_cvt_pk_bf16_f32 v90, v68, v69
 v_cvt_pk_bf16_f32 v91, v70, v71
 v_mfma_f32_32x32x16_bf16 a[72:87], a[120:123], v[84:87], a[72:87]
 v_exp_f32 v76, v76
 v_exp_f32 v77, v77
 v_exp_f32 v78, v78
 v_exp_f32 v79, v79
 v_cvt_pk_bf16_f32 v92, v72, v73
 v_cvt_pk_bf16_f32 v93, v74, v75
 v_mfma_f32_32x32x16_bf16 a[88:103], a[116:119], v[88:91], a[88:103]
 v_exp_f32 v48, v48
 v_exp_f32 v49, v49
 v_cvt_pk_bf16_f32 v94, v76, v77
 v_cvt_pk_bf16_f32 v95, v78, v79
 v_exp_f32 v50, v50
 v_exp_f32 v51, v51
 v_mfma_f32_32x32x16_bf16 v[64:79], a[108:111], a[4:7], v[32:47]
 v_exp_f32 v52, v52
 v_exp_f32 v53, v53
 ds_read_b128 a[104:107], v2 offset:26112
 v_exp_f32 v54, v54
 v_exp_f32 v55, v55
 v_cvt_pk_bf16_f32 v80, v48, v49
 v_cvt_pk_bf16_f32 v81, v50, v51
 v_mfma_f32_32x32x16_bf16 v[64:79], a[144:147], a[60:63], v[64:79]
 v_exp_f32 v56, v56
 v_exp_f32 v57, v57
 v_exp_f32 v58, v58
 v_exp_f32 v59, v59
 v_cvt_pk_bf16_f32 v82, v52, v53
 v_cvt_pk_bf16_f32 v83, v54, v55
 v_mfma_f32_32x32x16_bf16 a[88:103], a[120:123], v[92:95], a[88:103]
 v_exp_f32 v60, v60
 v_exp_f32 v61, v61
 v_exp_f32 v62, v62
 v_exp_f32 v63, v63
 v_cvt_pk_bf16_f32 v84, v56, v57
 v_cvt_pk_bf16_f32 v85, v58, v59
 s_waitcnt lgkmcnt(1)
 v_mfma_f32_32x32x16_bf16 a[72:87], a[124:127], v[80:83], a[72:87]
 v_exp_f32 v64, v64
 v_exp_f32 v65, v65
 v_cvt_pk_bf16_f32 v86, v60, v61
 v_cvt_pk_bf16_f32 v87, v62, v63
 v_exp_f32 v66, v66
 v_exp_f32 v67, v67
 v_mfma_f32_32x32x16_bf16 v[48:63], a[112:115], a[0:3], v[16:31]
 v_exp_f32 v68, v68
 v_exp_f32 v69, v69
 ds_read_b128 a[132:135], v6 offset:26240
 v_exp_f32 v70, v70
 v_exp_f32 v71, v71
 v_cvt_pk_bf16_f32 v88, v64, v65
 v_cvt_pk_bf16_f32 v89, v66, v67
 v_mfma_f32_32x32x16_bf16 v[48:63], a[144:147], a[32:35], v[48:63]
 v_exp_f32 v72, v72
 v_exp_f32 v73, v73
 ds_read_b128 a[136:139], v6 offset:26848
 v_exp_f32 v74, v74
 v_exp_f32 v75, v75
 v_cvt_pk_bf16_f32 v90, v68, v69
 v_cvt_pk_bf16_f32 v91, v70, v71
 v_mfma_f32_32x32x16_bf16 a[72:87], a[128:131], v[84:87], a[72:87]
 v_exp_f32 v76, v76
 v_exp_f32 v77, v77
 v_exp_f32 v78, v78
 v_exp_f32 v79, v79
 v_cvt_pk_bf16_f32 v92, v72, v73
 v_cvt_pk_bf16_f32 v93, v74, v75
 v_mfma_f32_32x32x16_bf16 a[88:103], a[124:127], v[88:91], a[88:103]
 v_exp_f32 v48, v48
 v_exp_f32 v49, v49
 v_cvt_pk_bf16_f32 v94, v76, v77
 v_cvt_pk_bf16_f32 v95, v78, v79
 v_exp_f32 v50, v50
 v_exp_f32 v51, v51
 v_mfma_f32_32x32x16_bf16 v[64:79], a[112:115], a[4:7], v[32:47]
 v_exp_f32 v52, v52
 v_exp_f32 v53, v53
 s_waitcnt vmcnt(0)
 s_barrier
 ds_read_b128 a[108:111], v3 offset:0
 ds_read_b128 a[140:143], v3 offset:8192
 v_exp_f32 v54, v54
 v_exp_f32 v55, v55
 v_cvt_pk_bf16_f32 v80, v48, v49
 v_cvt_pk_bf16_f32 v81, v50, v51
 v_mfma_f32_32x32x16_bf16 v[64:79], a[144:147], a[64:67], v[64:79]
 v_exp_f32 v56, v56
 v_exp_f32 v57, v57
 v_exp_f32 v58, v58
 v_exp_f32 v59, v59
 v_cvt_pk_bf16_f32 v82, v52, v53
 v_cvt_pk_bf16_f32 v83, v54, v55
 v_mfma_f32_32x32x16_bf16 a[88:103], a[128:131], v[92:95], a[88:103]
 v_exp_f32 v60, v60
 v_exp_f32 v61, v61
 v_exp_f32 v62, v62
 v_exp_f32 v63, v63
 v_cvt_pk_bf16_f32 v84, v56, v57
 v_cvt_pk_bf16_f32 v85, v58, v59
 s_waitcnt lgkmcnt(2)
 v_mfma_f32_32x32x16_bf16 a[72:87], a[132:135], v[80:83], a[72:87]
 v_exp_f32 v64, v64
 v_exp_f32 v65, v65
 v_cvt_pk_bf16_f32 v86, v60, v61
 v_cvt_pk_bf16_f32 v87, v62, v63
 v_exp_f32 v66, v66
 v_exp_f32 v67, v67
 v_mfma_f32_32x32x16_bf16 v[48:63], a[104:107], a[0:3], v[16:31]
 v_exp_f32 v68, v68
 v_exp_f32 v69, v69
 ds_read_b128 a[116:119], v6 offset:27456
 v_exp_f32 v70, v70
 v_exp_f32 v71, v71
 v_cvt_pk_bf16_f32 v88, v64, v65
 v_cvt_pk_bf16_f32 v89, v66, v67
 v_mfma_f32_32x32x16_bf16 v[48:63], a[144:147], a[36:39], v[48:63]
 v_exp_f32 v72, v72
 v_exp_f32 v73, v73
 ds_read_b128 a[120:123], v6 offset:28064
 v_exp_f32 v74, v74
 v_exp_f32 v75, v75
 v_cvt_pk_bf16_f32 v90, v68, v69
 v_cvt_pk_bf16_f32 v91, v70, v71
 v_mfma_f32_32x32x16_bf16 a[72:87], a[136:139], v[84:87], a[72:87]
 v_exp_f32 v76, v76
 v_exp_f32 v77, v77
 v_exp_f32 v78, v78
 v_exp_f32 v79, v79
 v_cvt_pk_bf16_f32 v92, v72, v73
 v_cvt_pk_bf16_f32 v93, v74, v75
 v_mfma_f32_32x32x16_bf16 a[88:103], a[132:135], v[88:91], a[88:103]
 v_exp_f32 v48, v48
 v_exp_f32 v49, v49
 v_cvt_pk_bf16_f32 v94, v76, v77
 v_cvt_pk_bf16_f32 v95, v78, v79
 v_exp_f32 v50, v50
 v_exp_f32 v51, v51
 v_mfma_f32_32x32x16_bf16 v[64:79], a[104:107], a[4:7], v[32:47]
 v_exp_f32 v52, v52
 v_exp_f32 v53, v53
 ds_read_b128 a[112:115], v3 offset:1024
 v_exp_f32 v54, v54
 v_exp_f32 v55, v55
 v_cvt_pk_bf16_f32 v80, v48, v49
 v_cvt_pk_bf16_f32 v81, v50, v51
 v_mfma_f32_32x32x16_bf16 v[64:79], a[144:147], a[68:71], v[64:79]
 v_exp_f32 v56, v56
 v_exp_f32 v57, v57
 v_exp_f32 v58, v58
 v_exp_f32 v59, v59
 v_cvt_pk_bf16_f32 v82, v52, v53
 v_cvt_pk_bf16_f32 v83, v54, v55
 v_mfma_f32_32x32x16_bf16 a[88:103], a[136:139], v[92:95], a[88:103]
 v_exp_f32 v60, v60
 v_exp_f32 v61, v61
 v_exp_f32 v62, v62
 v_exp_f32 v63, v63
 v_cvt_pk_bf16_f32 v84, v56, v57
 v_cvt_pk_bf16_f32 v85, v58, v59
 s_waitcnt lgkmcnt(1)
 v_mfma_f32_32x32x16_bf16 a[72:87], a[116:119], v[80:83], a[72:87]
 v_exp_f32 v64, v64
 v_exp_f32 v65, v65
 v_cvt_pk_bf16_f32 v86, v60, v61
 v_cvt_pk_bf16_f32 v87, v62, v63
 v_exp_f32 v66, v66
 v_exp_f32 v67, v67
 v_mfma_f32_32x32x16_bf16 v[48:63], a[108:111], a[0:3], v[16:31]
 v_exp_f32 v68, v68
 v_exp_f32 v69, v69
 ds_read_b128 a[124:127], v7 offset:0
 v_exp_f32 v70, v70
 v_exp_f32 v71, v71
 v_cvt_pk_bf16_f32 v88, v64, v65
 v_cvt_pk_bf16_f32 v89, v66, v67
 v_mfma_f32_32x32x16_bf16 v[48:63], a[140:143], a[8:11], v[48:63]
 v_exp_f32 v72, v72
 v_exp_f32 v73, v73
 ds_read_b128 a[128:131], v7 offset:608
 v_exp_f32 v74, v74
 v_exp_f32 v75, v75
 v_cvt_pk_bf16_f32 v90, v68, v69
 v_cvt_pk_bf16_f32 v91, v70, v71
 v_mfma_f32_32x32x16_bf16 a[72:87], a[120:123], v[84:87], a[72:87]
 v_exp_f32 v76, v76
 v_exp_f32 v77, v77
 v_exp_f32 v78, v78
 v_exp_f32 v79, v79
 v_cvt_pk_bf16_f32 v92, v72, v73
 v_cvt_pk_bf16_f32 v93, v74, v75
 v_mfma_f32_32x32x16_bf16 a[88:103], a[116:119], v[88:91], a[88:103]
 v_exp_f32 v48, v48
 v_exp_f32 v49, v49
 v_cvt_pk_bf16_f32 v94, v76, v77
 v_cvt_pk_bf16_f32 v95, v78, v79
 v_exp_f32 v50, v50
 v_exp_f32 v51, v51
 v_mfma_f32_32x32x16_bf16 v[64:79], a[108:111], a[4:7], v[32:47]
 v_exp_f32 v52, v52
 v_exp_f32 v53, v53
 ds_read_b128 a[104:107], v3 offset:2048
 v_exp_f32 v54, v54
 v_exp_f32 v55, v55
 v_cvt_pk_bf16_f32 v80, v48, v49
 v_cvt_pk_bf16_f32 v81, v50, v51
 v_mfma_f32_32x32x16_bf16 v[64:79], a[140:143], a[40:43], v[64:79]
 v_exp_f32 v56, v56
 v_exp_f32 v57, v57
 v_exp_f32 v58, v58
 v_exp_f32 v59, v59
 v_cvt_pk_bf16_f32 v82, v52, v53
 v_cvt_pk_bf16_f32 v83, v54, v55
 v_mfma_f32_32x32x16_bf16 a[88:103], a[120:123], v[92:95], a[88:103]
 v_exp_f32 v60, v60
 v_exp_f32 v61, v61
 v_exp_f32 v62, v62
 v_exp_f32 v63, v63
 v_cvt_pk_bf16_f32 v84, v56, v57
 v_cvt_pk_bf16_f32 v85, v58, v59
 s_waitcnt lgkmcnt(1)
 v_mfma_f32_32x32x16_bf16 a[72:87], a[124:127], v[80:83], a[72:87]
 v_exp_f32 v64, v64
 v_exp_f32 v65, v65
 v_cvt_pk_bf16_f32 v86, v60, v61
 v_cvt_pk_bf16_f32 v87, v62, v63
 v_exp_f32 v66, v66
 v_exp_f32 v67, v67
 v_mfma_f32_32x32x16_bf16 v[48:63], a[112:115], a[0:3], v[16:31]
 v_exp_f32 v68, v68
 v_exp_f32 v69, v69
 ds_read_b128 a[132:135], v7 offset:1216
 v_exp_f32 v70, v70
 v_exp_f32 v71, v71
 v_cvt_pk_bf16_f32 v88, v64, v65
 v_cvt_pk_bf16_f32 v89, v66, v67
 v_mfma_f32_32x32x16_bf16 v[48:63], a[140:143], a[12:15], v[48:63]
 v_exp_f32 v72, v72
 v_exp_f32 v73, v73
 ds_read_b128 a[136:139], v7 offset:1824
 v_exp_f32 v74, v74
 v_exp_f32 v75, v75
 v_cvt_pk_bf16_f32 v90, v68, v69
 v_cvt_pk_bf16_f32 v91, v70, v71
 v_mfma_f32_32x32x16_bf16 a[72:87], a[128:131], v[84:87], a[72:87]
 v_exp_f32 v76, v76
 v_exp_f32 v77, v77
 v_exp_f32 v78, v78
 v_exp_f32 v79, v79
 v_cvt_pk_bf16_f32 v92, v72, v73
 v_cvt_pk_bf16_f32 v93, v74, v75
 v_mfma_f32_32x32x16_bf16 a[88:103], a[124:127], v[88:91], a[88:103]
 v_exp_f32 v48, v48
 v_exp_f32 v49, v49
 v_cvt_pk_bf16_f32 v94, v76, v77
 v_cvt_pk_bf16_f32 v95, v78, v79
 v_exp_f32 v50, v50
 v_exp_f32 v51, v51
 v_mfma_f32_32x32x16_bf16 v[64:79], a[112:115], a[4:7], v[32:47]
 v_exp_f32 v52, v52
 v_exp_f32 v53, v53
 ds_read_b128 a[108:111], v3 offset:3072
 v_exp_f32 v54, v54
 v_exp_f32 v55, v55
 v_cvt_pk_bf16_f32 v80, v48, v49
 v_cvt_pk_bf16_f32 v81, v50, v51
 v_mfma_f32_32x32x16_bf16 v[64:79], a[140:143], a[44:47], v[64:79]
 v_exp_f32 v56, v56
 v_exp_f32 v57, v57
 v_exp_f32 v58, v58
 v_exp_f32 v59, v59
 v_cvt_pk_bf16_f32 v82, v52, v53
 v_cvt_pk_bf16_f32 v83, v54, v55
 v_mfma_f32_32x32x16_bf16 a[88:103], a[128:131], v[92:95], a[88:103]
 v_exp_f32 v60, v60
 v_exp_f32 v61, v61
 v_exp_f32 v62, v62
 v_exp_f32 v63, v63
 v_cvt_pk_bf16_f32 v84, v56, v57
 v_cvt_pk_bf16_f32 v85, v58, v59
 s_waitcnt lgkmcnt(1)
 v_mfma_f32_32x32x16_bf16 a[72:87], a[132:135], v[80:83], a[72:87]
 v_exp_f32 v64, v64
 v_exp_f32 v65, v65
 v_cvt_pk_bf16_f32 v86, v60, v61
 v_cvt_pk_bf16_f32 v87, v62, v63
 v_exp_f32 v66, v66
 v_exp_f32 v67, v67
 v_mfma_f32_32x32x16_bf16 v[48:63], a[104:107], a[0:3], v[16:31]
 v_exp_f32 v68, v68
 v_exp_f32 v69, v69
 ds_read_b128 a[116:119], v7 offset:2432
 v_exp_f32 v70, v70
 v_exp_f32 v71, v71
 v_cvt_pk_bf16_f32 v88, v64, v65
 v_cvt_pk_bf16_f32 v89, v66, v67
 v_mfma_f32_32x32x16_bf16 v[48:63], a[140:143], a[16:19], v[48:63]
 v_exp_f32 v72, v72
 v_exp_f32 v73, v73
 ds_read_b128 a[120:123], v7 offset:3040
 v_exp_f32 v74, v74
 v_exp_f32 v75, v75
 v_cvt_pk_bf16_f32 v90, v68, v69
 v_cvt_pk_bf16_f32 v91, v70, v71
 v_mfma_f32_32x32x16_bf16 a[72:87], a[136:139], v[84:87], a[72:87]
 v_exp_f32 v76, v76
 v_exp_f32 v77, v77
 v_exp_f32 v78, v78
 v_exp_f32 v79, v79
 v_cvt_pk_bf16_f32 v92, v72, v73
 v_cvt_pk_bf16_f32 v93, v74, v75
 v_mfma_f32_32x32x16_bf16 a[88:103], a[132:135], v[88:91], a[88:103]
 v_exp_f32 v48, v48
 v_exp_f32 v49, v49
 v_cvt_pk_bf16_f32 v94, v76, v77
 v_cvt_pk_bf16_f32 v95, v78, v79
 v_exp_f32 v50, v50
 v_exp_f32 v51, v51
 v_mfma_f32_32x32x16_bf16 v[64:79], a[104:107], a[4:7], v[32:47]
 v_exp_f32 v52, v52
 v_exp_f32 v53, v53
 ds_read_b128 a[112:115], v3 offset:4096
 v_exp_f32 v54, v54
 v_exp_f32 v55, v55
 v_cvt_pk_bf16_f32 v80, v48, v49
 v_cvt_pk_bf16_f32 v81, v50, v51
 v_mfma_f32_32x32x16_bf16 v[64:79], a[140:143], a[48:51], v[64:79]
 v_exp_f32 v56, v56
 v_exp_f32 v57, v57
 v_exp_f32 v58, v58
 v_exp_f32 v59, v59
 v_cvt_pk_bf16_f32 v82, v52, v53
 v_cvt_pk_bf16_f32 v83, v54, v55
 v_mfma_f32_32x32x16_bf16 a[88:103], a[136:139], v[92:95], a[88:103]
 v_exp_f32 v60, v60
 v_exp_f32 v61, v61
 v_exp_f32 v62, v62
 v_exp_f32 v63, v63
 v_cvt_pk_bf16_f32 v84, v56, v57
 v_cvt_pk_bf16_f32 v85, v58, v59
 s_waitcnt lgkmcnt(1)
 v_mfma_f32_32x32x16_bf16 a[72:87], a[116:119], v[80:83], a[72:87]
 v_exp_f32 v64, v64
 v_exp_f32 v65, v65
 v_cvt_pk_bf16_f32 v86, v60, v61
 v_cvt_pk_bf16_f32 v87, v62, v63
 v_exp_f32 v66, v66
 v_exp_f32 v67, v67
 v_mfma_f32_32x32x16_bf16 v[48:63], a[108:111], a[0:3], v[16:31]
 v_exp_f32 v68, v68
 v_exp_f32 v69, v69
 ds_read_b128 a[124:127], v7 offset:3648
 v_exp_f32 v70, v70
 v_exp_f32 v71, v71
 v_cvt_pk_bf16_f32 v88, v64, v65
 v_cvt_pk_bf16_f32 v89, v66, v67
 v_mfma_f32_32x32x16_bf16 v[48:63], a[140:143], a[20:23], v[48:63]
 v_exp_f32 v72, v72
 v_exp_f32 v73, v73
 ds_read_b128 a[128:131], v7 offset:4256
 v_exp_f32 v74, v74
 v_exp_f32 v75, v75
 v_cvt_pk_bf16_f32 v90, v68, v69
 v_cvt_pk_bf16_f32 v91, v70, v71
 v_mfma_f32_32x32x16_bf16 a[72:87], a[120:123], v[84:87], a[72:87]
 v_exp_f32 v76, v76
 v_exp_f32 v77, v77
 v_exp_f32 v78, v78
 v_exp_f32 v79, v79
 v_cvt_pk_bf16_f32 v92, v72, v73
 v_cvt_pk_bf16_f32 v93, v74, v75
 v_mfma_f32_32x32x16_bf16 a[88:103], a[116:119], v[88:91], a[88:103]
 v_exp_f32 v48, v48
 v_exp_f32 v49, v49
 v_cvt_pk_bf16_f32 v94, v76, v77
 v_cvt_pk_bf16_f32 v95, v78, v79
 v_exp_f32 v50, v50
 v_exp_f32 v51, v51
 v_mfma_f32_32x32x16_bf16 v[64:79], a[108:111], a[4:7], v[32:47]
 v_exp_f32 v52, v52
 v_exp_f32 v53, v53
 ds_read_b128 a[104:107], v3 offset:5120
 v_exp_f32 v54, v54
 v_exp_f32 v55, v55
 v_cvt_pk_bf16_f32 v80, v48, v49
 v_cvt_pk_bf16_f32 v81, v50, v51
 v_mfma_f32_32x32x16_bf16 v[64:79], a[140:143], a[52:55], v[64:79]
 v_exp_f32 v56, v56
 v_exp_f32 v57, v57
 v_exp_f32 v58, v58
 v_exp_f32 v59, v59
 v_cvt_pk_bf16_f32 v82, v52, v53
 v_cvt_pk_bf16_f32 v83, v54, v55
 v_mfma_f32_32x32x16_bf16 a[88:103], a[120:123], v[92:95], a[88:103]
 v_exp_f32 v60, v60
 v_exp_f32 v61, v61
 v_exp_f32 v62, v62
 v_exp_f32 v63, v63
 v_cvt_pk_bf16_f32 v84, v56, v57
 v_cvt_pk_bf16_f32 v85, v58, v59
 s_waitcnt lgkmcnt(1)
 v_mfma_f32_32x32x16_bf16 a[72:87], a[124:127], v[80:83], a[72:87]
 v_exp_f32 v64, v64
 v_exp_f32 v65, v65
 v_cvt_pk_bf16_f32 v86, v60, v61
 v_cvt_pk_bf16_f32 v87, v62, v63
 v_exp_f32 v66, v66
 v_exp_f32 v67, v67
 v_mfma_f32_32x32x16_bf16 v[48:63], a[112:115], a[0:3], v[16:31]
 v_exp_f32 v68, v68
 v_exp_f32 v69, v69
 ds_read_b128 a[132:135], v7 offset:4864
 v_exp_f32 v70, v70
 v_exp_f32 v71, v71
 v_cvt_pk_bf16_f32 v88, v64, v65
 v_cvt_pk_bf16_f32 v89, v66, v67
 v_mfma_f32_32x32x16_bf16 v[48:63], a[140:143], a[24:27], v[48:63]
 v_exp_f32 v72, v72
 v_exp_f32 v73, v73
 ds_read_b128 a[136:139], v7 offset:5472
 v_exp_f32 v74, v74
 v_exp_f32 v75, v75
 v_cvt_pk_bf16_f32 v90, v68, v69
 v_cvt_pk_bf16_f32 v91, v70, v71
 v_mfma_f32_32x32x16_bf16 a[72:87], a[128:131], v[84:87], a[72:87]
 v_exp_f32 v76, v76
 v_exp_f32 v77, v77
 v_exp_f32 v78, v78
 v_exp_f32 v79, v79
 v_cvt_pk_bf16_f32 v92, v72, v73
 v_cvt_pk_bf16_f32 v93, v74, v75
 v_mfma_f32_32x32x16_bf16 a[88:103], a[124:127], v[88:91], a[88:103]
 v_exp_f32 v48, v48
 v_exp_f32 v49, v49
 v_cvt_pk_bf16_f32 v94, v76, v77
 v_cvt_pk_bf16_f32 v95, v78, v79
 v_exp_f32 v50, v50
 v_exp_f32 v51, v51
 v_mfma_f32_32x32x16_bf16 v[64:79], a[112:115], a[4:7], v[32:47]
 v_exp_f32 v52, v52
 v_exp_f32 v53, v53
 ds_read_b128 a[108:111], v3 offset:6144
 v_exp_f32 v54, v54
 v_exp_f32 v55, v55
 v_cvt_pk_bf16_f32 v80, v48, v49
 v_cvt_pk_bf16_f32 v81, v50, v51
 v_mfma_f32_32x32x16_bf16 v[64:79], a[140:143], a[56:59], v[64:79]
 v_exp_f32 v56, v56
 v_exp_f32 v57, v57
 buffer_store_dwordx4 v[208:211], v1, s[4:7], s86 offen sc1
 s_add_u32 s86, s86, 4096
 v_exp_f32 v58, v58
 v_exp_f32 v59, v59
 v_cvt_pk_bf16_f32 v82, v52, v53
 v_cvt_pk_bf16_f32 v83, v54, v55
 v_mfma_f32_32x32x16_bf16 a[88:103], a[128:131], v[92:95], a[88:103]
 v_exp_f32 v60, v60
 v_exp_f32 v61, v61
 v_exp_f32 v62, v62
 v_exp_f32 v63, v63
 v_cvt_pk_bf16_f32 v84, v56, v57
 v_cvt_pk_bf16_f32 v85, v58, v59
 s_waitcnt lgkmcnt(1)
 v_mfma_f32_32x32x16_bf16 a[72:87], a[132:135], v[80:83], a[72:87]
 v_exp_f32 v64, v64
 v_exp_f32 v65, v65
 v_cvt_pk_bf16_f32 v86, v60, v61
 v_cvt_pk_bf16_f32 v87, v62, v63
 v_exp_f32 v66, v66
 v_exp_f32 v67, v67
 v_mfma_f32_32x32x16_bf16 v[48:63], a[104:107], a[0:3], v[16:31]
 v_exp_f32 v68, v68
 v_exp_f32 v69, v69
 ds_read_b128 a[116:119], v7 offset:6080
 v_exp_f32 v70, v70
 v_exp_f32 v71, v71
 v_cvt_pk_bf16_f32 v88, v64, v65
 v_cvt_pk_bf16_f32 v89, v66, v67
 v_mfma_f32_32x32x16_bf16 v[48:63], a[140:143], a[28:31], v[48:63]
 v_exp_f32 v72, v72
 v_exp_f32 v73, v73
 ds_read_b128 a[120:123], v7 offset:6688
 v_exp_f32 v74, v74
 v_exp_f32 v75, v75
 v_cvt_pk_bf16_f32 v90, v68, v69
 v_cvt_pk_bf16_f32 v91, v70, v71
 v_mfma_f32_32x32x16_bf16 a[72:87], a[136:139], v[84:87], a[72:87]
 v_exp_f32 v76, v76
 v_exp_f32 v77, v77
 v_exp_f32 v78, v78
 v_exp_f32 v79, v79
 v_cvt_pk_bf16_f32 v92, v72, v73
 v_cvt_pk_bf16_f32 v93, v74, v75
 v_mfma_f32_32x32x16_bf16 a[88:103], a[132:135], v[88:91], a[88:103]
 v_exp_f32 v48, v48
 v_exp_f32 v49, v49
 v_cvt_pk_bf16_f32 v94, v76, v77
 v_cvt_pk_bf16_f32 v95, v78, v79
 v_exp_f32 v50, v50
 v_exp_f32 v51, v51
 v_mfma_f32_32x32x16_bf16 v[64:79], a[104:107], a[4:7], v[32:47]
 v_exp_f32 v52, v52
 v_exp_f32 v53, v53
 ds_read_b128 a[112:115], v3 offset:7168
 v_exp_f32 v54, v54
 v_exp_f32 v55, v55
 v_cvt_pk_bf16_f32 v80, v48, v49
 v_cvt_pk_bf16_f32 v81, v50, v51
 v_mfma_f32_32x32x16_bf16 v[64:79], a[140:143], a[60:63], v[64:79]
 v_exp_f32 v56, v56
 v_exp_f32 v57, v57
 v_exp_f32 v58, v58
 v_exp_f32 v59, v59
 v_cvt_pk_bf16_f32 v82, v52, v53
 v_cvt_pk_bf16_f32 v83, v54, v55
 v_mfma_f32_32x32x16_bf16 a[88:103], a[136:139], v[92:95], a[88:103]
 v_exp_f32 v60, v60
 v_exp_f32 v61, v61
 v_exp_f32 v62, v62
 v_exp_f32 v63, v63
 v_cvt_pk_bf16_f32 v84, v56, v57
 v_cvt_pk_bf16_f32 v85, v58, v59
 s_waitcnt lgkmcnt(1)
 v_mfma_f32_32x32x16_bf16 a[72:87], a[116:119], v[80:83], a[72:87]
 v_exp_f32 v64, v64
 v_exp_f32 v65, v65
 v_cvt_pk_bf16_f32 v86, v60, v61
 v_cvt_pk_bf16_f32 v87, v62, v63
 v_exp_f32 v66, v66
 v_exp_f32 v67, v67
 v_mfma_f32_32x32x16_bf16 v[48:63], a[108:111], a[0:3], v[16:31]
 v_exp_f32 v68, v68
 v_exp_f32 v69, v69
 ds_read_b128 a[124:127], v7 offset:7296
 v_exp_f32 v70, v70
 v_exp_f32 v71, v71
 v_cvt_pk_bf16_f32 v88, v64, v65
 v_cvt_pk_bf16_f32 v89, v66, v67
 v_mfma_f32_32x32x16_bf16 v[48:63], a[140:143], a[32:35], v[48:63]
 v_exp_f32 v72, v72
 v_exp_f32 v73, v73
 ds_read_b128 a[128:131], v7 offset:7904
 v_exp_f32 v74, v74
 v_exp_f32 v75, v75
 v_cvt_pk_bf16_f32 v90, v68, v69
 v_cvt_pk_bf16_f32 v91, v70, v71
 v_mfma_f32_32x32x16_bf16 a[72:87], a[120:123], v[84:87], a[72:87]
 v_exp_f32 v76, v76
 v_exp_f32 v77, v77
 v_exp_f32 v78, v78
 v_exp_f32 v79, v79
 v_cvt_pk_bf16_f32 v92, v72, v73
 v_cvt_pk_bf16_f32 v93, v74, v75
 v_mfma_f32_32x32x16_bf16 a[88:103], a[116:119], v[88:91], a[88:103]
 v_exp_f32 v48, v48
 v_exp_f32 v49, v49
 v_cvt_pk_bf16_f32 v94, v76, v77
 v_cvt_pk_bf16_f32 v95, v78, v79
 v_exp_f32 v50, v50
 v_exp_f32 v51, v51
 v_mfma_f32_32x32x16_bf16 v[64:79], a[108:111], a[4:7], v[32:47]
 v_exp_f32 v52, v52
 v_exp_f32 v53, v53
 ds_read_b128 a[104:107], v3 offset:18944
 ds_read_b128 a[144:147], v3 offset:27136
 v_exp_f32 v54, v54
 v_exp_f32 v55, v55
 v_cvt_pk_bf16_f32 v80, v48, v49
 v_cvt_pk_bf16_f32 v81, v50, v51
 v_mfma_f32_32x32x16_bf16 v[64:79], a[140:143], a[64:67], v[64:79]
 v_exp_f32 v56, v56
 v_exp_f32 v57, v57
 buffer_store_dwordx4 v[208:211], v1, s[4:7], s86 offen sc1
 s_add_u32 s86, s86, 4096
 v_exp_f32 v58, v58
 v_exp_f32 v59, v59
 v_cvt_pk_bf16_f32 v82, v52, v53
 v_cvt_pk_bf16_f32 v83, v54, v55
 v_mfma_f32_32x32x16_bf16 a[88:103], a[120:123], v[92:95], a[88:103]
 v_exp_f32 v60, v60
 v_exp_f32 v61, v61
 v_exp_f32 v62, v62
 v_exp_f32 v63, v63
 v_cvt_pk_bf16_f32 v84, v56, v57
 v_cvt_pk_bf16_f32 v85, v58, v59
 s_waitcnt lgkmcnt(2)
 v_mfma_f32_32x32x16_bf16 a[72:87], a[124:127], v[80:83], a[72:87]
 v_exp_f32 v64, v64
 v_exp_f32 v65, v65
 v_cvt_pk_bf16_f32 v86, v60, v61
 v_cvt_pk_bf16_f32 v87, v62, v63
 v_exp_f32 v66, v66
 v_exp_f32 v67, v67
 v_mfma_f32_32x32x16_bf16 v[48:63], a[112:115], a[0:3], v[16:31]
 v_exp_f32 v68, v68
 v_exp_f32 v69, v69
 ds_read_b128 a[132:135], v7 offset:8512
 v_exp_f32 v70, v70
 v_exp_f32 v71, v71
 v_cvt_pk_bf16_f32 v88, v64, v65
 v_cvt_pk_bf16_f32 v89, v66, v67
 v_mfma_f32_32x32x16_bf16 v[48:63], a[140:143], a[36:39], v[48:63]
 v_exp_f32 v72, v72
 v_exp_f32 v73, v73
 ds_read_b128 a[136:139], v7 offset:9120
 v_exp_f32 v74, v74
 v_exp_f32 v75, v75
 v_cvt_pk_bf16_f32 v90, v68, v69
 v_cvt_pk_bf16_f32 v91, v70, v71
 v_mfma_f32_32x32x16_bf16 a[72:87], a[128:131], v[84:87], a[72:87]
 v_exp_f32 v76, v76
 v_exp_f32 v77, v77
 v_exp_f32 v78, v78
 v_exp_f32 v79, v79
 v_cvt_pk_bf16_f32 v92, v72, v73
 v_cvt_pk_bf16_f32 v93, v74, v75
 v_mfma_f32_32x32x16_bf16 a[88:103], a[124:127], v[88:91], a[88:103]
 v_exp_f32 v48, v48
 v_exp_f32 v49, v49
 v_cvt_pk_bf16_f32 v94, v76, v77
 v_cvt_pk_bf16_f32 v95, v78, v79
 v_exp_f32 v50, v50
 v_exp_f32 v51, v51
 v_mfma_f32_32x32x16_bf16 v[64:79], a[112:115], a[4:7], v[32:47]
 v_exp_f32 v52, v52
 v_exp_f32 v53, v53
 ds_read_b128 a[108:111], v3 offset:19968
 v_exp_f32 v54, v54
 v_exp_f32 v55, v55
 v_cvt_pk_bf16_f32 v80, v48, v49
 v_cvt_pk_bf16_f32 v81, v50, v51
 v_mfma_f32_32x32x16_bf16 v[64:79], a[140:143], a[68:71], v[64:79]
 v_exp_f32 v56, v56
 v_exp_f32 v57, v57
 v_exp_f32 v58, v58
 v_exp_f32 v59, v59
 v_cvt_pk_bf16_f32 v82, v52, v53
 v_cvt_pk_bf16_f32 v83, v54, v55
 v_mfma_f32_32x32x16_bf16 a[88:103], a[128:131], v[92:95], a[88:103]
 v_exp_f32 v60, v60
 v_exp_f32 v61, v61
 v_exp_f32 v62, v62
 v_exp_f32 v63, v63
 v_cvt_pk_bf16_f32 v84, v56, v57
 v_cvt_pk_bf16_f32 v85, v58, v59
 s_waitcnt lgkmcnt(1)
 v_mfma_f32_32x32x16_bf16 a[72:87], a[132:135], v[80:83], a[72:87]
 v_exp_f32 v64, v64
 v_exp_f32 v65, v65
 v_cvt_pk_bf16_f32 v86, v60, v61
 v_cvt_pk_bf16_f32 v87, v62, v63
 v_exp_f32 v66, v66
 v_exp_f32 v67, v67
 v_mfma_f32_32x32x16_bf16 v[48:63], a[104:107], a[0:3], v[16:31]
 v_exp_f32 v68, v68
 v_exp_f32 v69, v69
 ds_read_b128 a[116:119], v7 offset:18944
 v_exp_f32 v70, v70
 v_exp_f32 v71, v71
 v_cvt_pk_bf16_f32 v88, v64, v65
 v_cvt_pk_bf16_f32 v89, v66, v67
 v_mfma_f32_32x32x16_bf16 v[48:63], a[144:147], a[8:11], v[48:63]
 v_exp_f32 v72, v72
 v_exp_f32 v73, v73
 ds_read_b128 a[120:123], v7 offset:19552
 v_exp_f32 v74, v74
 v_exp_f32 v75, v75
 v_cvt_pk_bf16_f32 v90, v68, v69
 v_cvt_pk_bf16_f32 v91, v70, v71
 v_mfma_f32_32x32x16_bf16 a[72:87], a[136:139], v[84:87], a[72:87]
 v_exp_f32 v76, v76
 v_exp_f32 v77, v77
 v_exp_f32 v78, v78
 v_exp_f32 v79, v79
 v_cvt_pk_bf16_f32 v92, v72, v73
 v_cvt_pk_bf16_f32 v93, v74, v75
 v_mfma_f32_32x32x16_bf16 a[88:103], a[132:135], v[88:91], a[88:103]
 v_exp_f32 v48, v48
 v_exp_f32 v49, v49
 v_cvt_pk_bf16_f32 v94, v76, v77
 v_cvt_pk_bf16_f32 v95, v78, v79
 v_exp_f32 v50, v50
 v_exp_f32 v51, v51
 v_mfma_f32_32x32x16_bf16 v[64:79], a[104:107], a[4:7], v[32:47]
 v_exp_f32 v52, v52
 v_exp_f32 v53, v53
 ds_read_b128 a[112:115], v3 offset:20992
 v_exp_f32 v54, v54
 v_exp_f32 v55, v55
 v_cvt_pk_bf16_f32 v80, v48, v49
 v_cvt_pk_bf16_f32 v81, v50, v51
 v_mfma_f32_32x32x16_bf16 v[64:79], a[144:147], a[40:43], v[64:79]
 v_exp_f32 v56, v56
 v_exp_f32 v57, v57
 buffer_store_dwordx4 v[208:211], v1, s[4:7], s86 offen sc1
 s_add_u32 s86, s86, 4096
 v_exp_f32 v58, v58
 v_exp_f32 v59, v59
 v_cvt_pk_bf16_f32 v82, v52, v53
 v_cvt_pk_bf16_f32 v83, v54, v55
 v_mfma_f32_32x32x16_bf16 a[88:103], a[136:139], v[92:95], a[88:103]
 v_exp_f32 v60, v60
 v_exp_f32 v61, v61
 v_exp_f32 v62, v62
 v_exp_f32 v63, v63
 v_cvt_pk_bf16_f32 v84, v56, v57
 v_cvt_pk_bf16_f32 v85, v58, v59
 s_waitcnt lgkmcnt(1)
 v_mfma_f32_32x32x16_bf16 a[72:87], a[116:119], v[80:83], a[72:87]
 v_exp_f32 v64, v64
 v_exp_f32 v65, v65
 v_cvt_pk_bf16_f32 v86, v60, v61
 v_cvt_pk_bf16_f32 v87, v62, v63
 v_exp_f32 v66, v66
 v_exp_f32 v67, v67
 v_mfma_f32_32x32x16_bf16 v[48:63], a[108:111], a[0:3], v[16:31]
 v_exp_f32 v68, v68
 v_exp_f32 v69, v69
 ds_read_b128 a[124:127], v7 offset:20160
 v_exp_f32 v70, v70
 v_exp_f32 v71, v71
 v_cvt_pk_bf16_f32 v88, v64, v65
 v_cvt_pk_bf16_f32 v89, v66, v67
 v_mfma_f32_32x32x16_bf16 v[48:63], a[144:147], a[12:15], v[48:63]
 v_exp_f32 v72, v72
 v_exp_f32 v73, v73
 ds_read_b128 a[128:131], v7 offset:20768
 v_exp_f32 v74, v74
 v_exp_f32 v75, v75
 v_cvt_pk_bf16_f32 v90, v68, v69
 v_cvt_pk_bf16_f32 v91, v70, v71
 v_mfma_f32_32x32x16_bf16 a[72:87], a[120:123], v[84:87], a[72:87]
 v_exp_f32 v76, v76
 v_exp_f32 v77, v77
 v_exp_f32 v78, v78
 v_exp_f32 v79, v79
 v_cvt_pk_bf16_f32 v92, v72, v73
 v_cvt_pk_bf16_f32 v93, v74, v75
 v_mfma_f32_32x32x16_bf16 a[88:103], a[116:119], v[88:91], a[88:103]
 v_exp_f32 v48, v48
 v_exp_f32 v49, v49
 v_cvt_pk_bf16_f32 v94, v76, v77
 v_cvt_pk_bf16_f32 v95, v78, v79
 v_exp_f32 v50, v50
 v_exp_f32 v51, v51
 v_mfma_f32_32x32x16_bf16 v[64:79], a[108:111], a[4:7], v[32:47]
 v_exp_f32 v52, v52
 v_exp_f32 v53, v53
 ds_read_b128 a[104:107], v3 offset:22016
 v_exp_f32 v54, v54
 v_exp_f32 v55, v55
 v_cvt_pk_bf16_f32 v80, v48, v49
 v_cvt_pk_bf16_f32 v81, v50, v51
 v_mfma_f32_32x32x16_bf16 v[64:79], a[144:147], a[44:47], v[64:79]
 v_exp_f32 v56, v56
 v_exp_f32 v57, v57
 v_exp_f32 v58, v58
 v_exp_f32 v59, v59
 v_cvt_pk_bf16_f32 v82, v52, v53
 v_cvt_pk_bf16_f32 v83, v54, v55
 v_mfma_f32_32x32x16_bf16 a[88:103], a[120:123], v[92:95], a[88:103]
 v_exp_f32 v60, v60
 v_exp_f32 v61, v61
 v_exp_f32 v62, v62
 v_exp_f32 v63, v63
 v_cvt_pk_bf16_f32 v84, v56, v57
 v_cvt_pk_bf16_f32 v85, v58, v59
 s_waitcnt lgkmcnt(1)
 v_mfma_f32_32x32x16_bf16 a[72:87], a[124:127], v[80:83], a[72:87]
 v_exp_f32 v64, v64
 v_exp_f32 v65, v65
 v_cvt_pk_bf16_f32 v86, v60, v61
 v_cvt_pk_bf16_f32 v87, v62, v63
 v_exp_f32 v66, v66
 v_exp_f32 v67, v67
 v_mfma_f32_32x32x16_bf16 v[48:63], a[112:115], a[0:3], v[16:31]
 v_exp_f32 v68, v68
 v_exp_f32 v69, v69
 ds_read_b128 a[132:135], v7 offset:21376
 v_exp_f32 v70, v70
 v_exp_f32 v71, v71
 v_cvt_pk_bf16_f32 v88, v64, v65
 v_cvt_pk_bf16_f32 v89, v66, v67
 v_mfma_f32_32x32x16_bf16 v[48:63], a[144:147], a[16:19], v[48:63]
 v_exp_f32 v72, v72
 v_exp_f32 v73, v73
 ds_read_b128 a[136:139], v7 offset:21984
 v_exp_f32 v74, v74
 v_exp_f32 v75, v75
 v_cvt_pk_bf16_f32 v90, v68, v69
 v_cvt_pk_bf16_f32 v91, v70, v71
 v_mfma_f32_32x32x16_bf16 a[72:87], a[128:131], v[84:87], a[72:87]
 v_exp_f32 v76, v76
 v_exp_f32 v77, v77
 v_exp_f32 v78, v78
 v_exp_f32 v79, v79
 v_cvt_pk_bf16_f32 v92, v72, v73
 v_cvt_pk_bf16_f32 v93, v74, v75
 v_mfma_f32_32x32x16_bf16 a[88:103], a[124:127], v[88:91], a[88:103]
 v_exp_f32 v48, v48
 v_exp_f32 v49, v49
 v_cvt_pk_bf16_f32 v94, v76, v77
 v_cvt_pk_bf16_f32 v95, v78, v79
 v_exp_f32 v50, v50
 v_exp_f32 v51, v51
 v_mfma_f32_32x32x16_bf16 v[64:79], a[112:115], a[4:7], v[32:47]
 v_exp_f32 v52, v52
 v_exp_f32 v53, v53
 ds_read_b128 a[108:111], v3 offset:23040
 v_exp_f32 v54, v54
 v_exp_f32 v55, v55
 v_cvt_pk_bf16_f32 v80, v48, v49
 v_cvt_pk_bf16_f32 v81, v50, v51
 v_mfma_f32_32x32x16_bf16 v[64:79], a[144:147], a[48:51], v[64:79]
 v_exp_f32 v56, v56
 v_exp_f32 v57, v57
 buffer_store_dwordx4 v[208:211], v1, s[4:7], s86 offen sc1
 s_add_u32 s86, s86, 4096
 v_exp_f32 v58, v58
 v_exp_f32 v59, v59
 v_cvt_pk_bf16_f32 v82, v52, v53
 v_cvt_pk_bf16_f32 v83, v54, v55
 v_mfma_f32_32x32x16_bf16 a[88:103], a[128:131], v[92:95], a[88:103]
 v_exp_f32 v60, v60
 v_exp_f32 v61, v61
 v_exp_f32 v62, v62
 v_exp_f32 v63, v63
 v_cvt_pk_bf16_f32 v84, v56, v57
 v_cvt_pk_bf16_f32 v85, v58, v59
 s_waitcnt lgkmcnt(1)
 v_mfma_f32_32x32x16_bf16 a[72:87], a[132:135], v[80:83], a[72:87]
 v_exp_f32 v64, v64
 v_exp_f32 v65, v65
 v_cvt_pk_bf16_f32 v86, v60, v61
 v_cvt_pk_bf16_f32 v87, v62, v63
 v_exp_f32 v66, v66
 v_exp_f32 v67, v67
 v_mfma_f32_32x32x16_bf16 v[48:63], a[104:107], a[0:3], v[16:31]
 v_exp_f32 v68, v68
 v_exp_f32 v69, v69
 ds_read_b128 a[116:119], v7 offset:22592
 v_exp_f32 v70, v70
 v_exp_f32 v71, v71
 v_cvt_pk_bf16_f32 v88, v64, v65
 v_cvt_pk_bf16_f32 v89, v66, v67
 v_mfma_f32_32x32x16_bf16 v[48:63], a[144:147], a[20:23], v[48:63]
 v_exp_f32 v72, v72
 v_exp_f32 v73, v73
 ds_read_b128 a[120:123], v7 offset:23200
 v_exp_f32 v74, v74
 v_exp_f32 v75, v75
 v_cvt_pk_bf16_f32 v90, v68, v69
 v_cvt_pk_bf16_f32 v91, v70, v71
 v_mfma_f32_32x32x16_bf16 a[72:87], a[136:139], v[84:87], a[72:87]
 v_exp_f32 v76, v76
 v_exp_f32 v77, v77
 v_exp_f32 v78, v78
 v_exp_f32 v79, v79
 v_cvt_pk_bf16_f32 v92, v72, v73
 v_cvt_pk_bf16_f32 v93, v74, v75
 v_mfma_f32_32x32x16_bf16 a[88:103], a[132:135], v[88:91], a[88:103]
 v_exp_f32 v48, v48
 v_exp_f32 v49, v49
 v_cvt_pk_bf16_f32 v94, v76, v77
 v_cvt_pk_bf16_f32 v95, v78, v79
 v_exp_f32 v50, v50
 v_exp_f32 v51, v51
 v_mfma_f32_32x32x16_bf16 v[64:79], a[104:107], a[4:7], v[32:47]
 v_exp_f32 v52, v52
 v_exp_f32 v53, v53
 ds_read_b128 a[112:115], v3 offset:24064
 v_exp_f32 v54, v54
 v_exp_f32 v55, v55
 v_cvt_pk_bf16_f32 v80, v48, v49
 v_cvt_pk_bf16_f32 v81, v50, v51
 v_mfma_f32_32x32x16_bf16 v[64:79], a[144:147], a[52:55], v[64:79]
 v_exp_f32 v56, v56
 v_exp_f32 v57, v57
 v_exp_f32 v58, v58
 v_exp_f32 v59, v59
 v_cvt_pk_bf16_f32 v82, v52, v53
 v_cvt_pk_bf16_f32 v83, v54, v55
 v_mfma_f32_32x32x16_bf16 a[88:103], a[136:139], v[92:95], a[88:103]
 v_exp_f32 v60, v60
 v_exp_f32 v61, v61
 v_exp_f32 v62, v62
 v_exp_f32 v63, v63
 v_cvt_pk_bf16_f32 v84, v56, v57
 v_cvt_pk_bf16_f32 v85, v58, v59
 s_waitcnt lgkmcnt(1)
 v_mfma_f32_32x32x16_bf16 a[72:87], a[116:119], v[80:83], a[72:87]
 v_exp_f32 v64, v64
 v_exp_f32 v65, v65
 v_cvt_pk_bf16_f32 v86, v60, v61
 v_cvt_pk_bf16_f32 v87, v62, v63
 v_exp_f32 v66, v66
 v_exp_f32 v67, v67
 v_mfma_f32_32x32x16_bf16 v[48:63], a[108:111], a[0:3], v[16:31]
 v_exp_f32 v68, v68
 v_exp_f32 v69, v69
 ds_read_b128 a[124:127], v7 offset:23808
 v_exp_f32 v70, v70
 v_exp_f32 v71, v71
 v_cvt_pk_bf16_f32 v88, v64, v65
 v_cvt_pk_bf16_f32 v89, v66, v67
 v_mfma_f32_32x32x16_bf16 v[48:63], a[144:147], a[24:27], v[48:63]
 v_exp_f32 v72, v72
 v_exp_f32 v73, v73
 ds_read_b128 a[128:131], v7 offset:24416
 v_exp_f32 v74, v74
 v_exp_f32 v75, v75
 v_cvt_pk_bf16_f32 v90, v68, v69
 v_cvt_pk_bf16_f32 v91, v70, v71
 v_mfma_f32_32x32x16_bf16 a[72:87], a[120:123], v[84:87], a[72:87]
 v_exp_f32 v76, v76
 v_exp_f32 v77, v77
 v_exp_f32 v78, v78
 v_exp_f32 v79, v79
 v_cvt_pk_bf16_f32 v92, v72, v73
 v_cvt_pk_bf16_f32 v93, v74, v75
 v_mfma_f32_32x32x16_bf16 a[88:103], a[116:119], v[88:91], a[88:103]
 v_exp_f32 v48, v48
 v_exp_f32 v49, v49
 v_cvt_pk_bf16_f32 v94, v76, v77
 v_cvt_pk_bf16_f32 v95, v78, v79
 v_exp_f32 v50, v50
 v_exp_f32 v51, v51
 v_mfma_f32_32x32x16_bf16 v[64:79], a[108:111], a[4:7], v[32:47]
 v_exp_f32 v52, v52
 v_exp_f32 v53, v53
 ds_read_b128 a[104:107], v3 offset:25088
 v_exp_f32 v54, v54
 v_exp_f32 v55, v55
 v_cvt_pk_bf16_f32 v80, v48, v49
 v_cvt_pk_bf16_f32 v81, v50, v51
 v_mfma_f32_32x32x16_bf16 v[64:79], a[144:147], a[56:59], v[64:79]
 v_exp_f32 v56, v56
 v_exp_f32 v57, v57
 buffer_store_dwordx4 v[208:211], v1, s[4:7], s86 offen sc1
 s_add_u32 s86, s86, 4096
 v_exp_f32 v58, v58
 v_exp_f32 v59, v59
 v_cvt_pk_bf16_f32 v82, v52, v53
 v_cvt_pk_bf16_f32 v83, v54, v55
 v_mfma_f32_32x32x16_bf16 a[88:103], a[120:123], v[92:95], a[88:103]
 v_exp_f32 v60, v60
 v_exp_f32 v61, v61
 v_exp_f32 v62, v62
 v_exp_f32 v63, v63
 v_cvt_pk_bf16_f32 v84, v56, v57
 v_cvt_pk_bf16_f32 v85, v58, v59
 s_waitcnt lgkmcnt(1)
 v_mfma_f32_32x32x16_bf16 a[72:87], a[124:127], v[80:83], a[72:87]
 v_exp_f32 v64, v64
 v_exp_f32 v65, v65
 v_cvt_pk_bf16_f32 v86, v60, v61
 v_cvt_pk_bf16_f32 v87, v62, v63
 v_exp_f32 v66, v66
 v_exp_f32 v67, v67
 v_mfma_f32_32x32x16_bf16 v[48:63], a[112:115], a[0:3], v[16:31]
 v_exp_f32 v68, v68
 v_exp_f32 v69, v69
 ds_read_b128 a[132:135], v7 offset:25024
 v_exp_f32 v70, v70
 v_exp_f32 v71, v71
 v_cvt_pk_bf16_f32 v88, v64, v65
 v_cvt_pk_bf16_f32 v89, v66, v67
 v_mfma_f32_32x32x16_bf16 v[48:63], a[144:147], a[28:31], v[48:63]
 v_exp_f32 v72, v72
 v_exp_f32 v73, v73
 ds_read_b128 a[136:139], v7 offset:25632
 v_exp_f32 v74, v74
 v_exp_f32 v75, v75
 v_cvt_pk_bf16_f32 v90, v68, v69
 v_cvt_pk_bf16_f32 v91, v70, v71
 v_mfma_f32_32x32x16_bf16 a[72:87], a[128:131], v[84:87], a[72:87]
 v_exp_f32 v76, v76
 v_exp_f32 v77, v77
 v_exp_f32 v78, v78
 v_exp_f32 v79, v79
 v_cvt_pk_bf16_f32 v92, v72, v73
 v_cvt_pk_bf16_f32 v93, v74, v75
 v_mfma_f32_32x32x16_bf16 a[88:103], a[124:127], v[88:91], a[88:103]
 v_exp_f32 v48, v48
 v_exp_f32 v49, v49
 v_cvt_pk_bf16_f32 v94, v76, v77
 v_cvt_pk_bf16_f32 v95, v78, v79
 v_exp_f32 v50, v50
 v_exp_f32 v51, v51
 v_mfma_f32_32x32x16_bf16 v[64:79], a[112:115], a[4:7], v[32:47]
 v_exp_f32 v52, v52
 v_exp_f32 v53, v53
 ds_read_b128 a[108:111], v3 offset:26112
 v_exp_f32 v54, v54
 v_exp_f32 v55, v55
 v_cvt_pk_bf16_f32 v80, v48, v49
 v_cvt_pk_bf16_f32 v81, v50, v51
 v_mfma_f32_32x32x16_bf16 v[64:79], a[144:147], a[60:63], v[64:79]
 v_exp_f32 v56, v56
 v_exp_f32 v57, v57
 v_exp_f32 v58, v58
 v_exp_f32 v59, v59
 v_cvt_pk_bf16_f32 v82, v52, v53
 v_cvt_pk_bf16_f32 v83, v54, v55
 v_mfma_f32_32x32x16_bf16 a[88:103], a[128:131], v[92:95], a[88:103]
 v_exp_f32 v60, v60
 v_exp_f32 v61, v61
 v_exp_f32 v62, v62
 v_exp_f32 v63, v63
 v_cvt_pk_bf16_f32 v84, v56, v57
 v_cvt_pk_bf16_f32 v85, v58, v59
 s_waitcnt lgkmcnt(1)
 v_mfma_f32_32x32x16_bf16 a[72:87], a[132:135], v[80:83], a[72:87]
 v_exp_f32 v64, v64
 v_exp_f32 v65, v65
 v_cvt_pk_bf16_f32 v86, v60, v61
 v_cvt_pk_bf16_f32 v87, v62, v63
 v_exp_f32 v66, v66
 v_exp_f32 v67, v67
 v_mfma_f32_32x32x16_bf16 v[48:63], a[104:107], a[0:3], v[16:31]
 v_exp_f32 v68, v68
 v_exp_f32 v69, v69
 ds_read_b128 a[116:119], v7 offset:26240
 v_exp_f32 v70, v70
 v_exp_f32 v71, v71
 v_cvt_pk_bf16_f32 v88, v64, v65
 v_cvt_pk_bf16_f32 v89, v66, v67
 v_mfma_f32_32x32x16_bf16 v[48:63], a[144:147], a[32:35], v[48:63]
 v_exp_f32 v72, v72
 v_exp_f32 v73, v73
 ds_read_b128 a[120:123], v7 offset:26848
 v_exp_f32 v74, v74
 v_exp_f32 v75, v75
 v_cvt_pk_bf16_f32 v90, v68, v69
 v_cvt_pk_bf16_f32 v91, v70, v71
 v_mfma_f32_32x32x16_bf16 a[72:87], a[136:139], v[84:87], a[72:87]
 v_exp_f32 v76, v76
 v_exp_f32 v77, v77
 v_exp_f32 v78, v78
 v_exp_f32 v79, v79
 v_cvt_pk_bf16_f32 v92, v72, v73
 v_cvt_pk_bf16_f32 v93, v74, v75
 v_mfma_f32_32x32x16_bf16 a[88:103], a[132:135], v[88:91], a[88:103]
 v_exp_f32 v48, v48
 v_exp_f32 v49, v49
 v_cvt_pk_bf16_f32 v94, v76, v77
 v_cvt_pk_bf16_f32 v95, v78, v79
 v_exp_f32 v50, v50
 v_exp_f32 v51, v51
 v_mfma_f32_32x32x16_bf16 v[64:79], a[104:107], a[4:7], v[32:47]
 v_exp_f32 v52, v52
 v_exp_f32 v53, v53
 ds_read_b128 a[112:115], v4 offset:0
 ds_read_b128 a[140:143], v4 offset:8192
 v_exp_f32 v54, v54
 v_exp_f32 v55, v55
 v_cvt_pk_bf16_f32 v80, v48, v49
 v_cvt_pk_bf16_f32 v81, v50, v51
 v_mfma_f32_32x32x16_bf16 v[64:79], a[144:147], a[64:67], v[64:79]
 v_exp_f32 v56, v56
 v_exp_f32 v57, v57
 buffer_store_dwordx4 v[208:211], v1, s[4:7], s86 offen sc1
 s_add_u32 s86, s86, 4096
 v_exp_f32 v58, v58
 v_exp_f32 v59, v59
 v_cvt_pk_bf16_f32 v82, v52, v53
 v_cvt_pk_bf16_f32 v83, v54, v55
 v_mfma_f32_32x32x16_bf16 a[88:103], a[136:139], v[92:95], a[88:103]
 v_exp_f32 v60, v60
 v_exp_f32 v61, v61
 v_exp_f32 v62, v62
 v_exp_f32 v63, v63
 v_cvt_pk_bf16_f32 v84, v56, v57
 v_cvt_pk_bf16_f32 v85, v58, v59
 s_waitcnt lgkmcnt(2)
 v_mfma_f32_32x32x16_bf16 a[72:87], a[116:119], v[80:83], a[72:87]
 v_exp_f32 v64, v64
 v_exp_f32 v65, v65
 v_cvt_pk_bf16_f32 v86, v60, v61
 v_cvt_pk_bf16_f32 v87, v62, v63
 v_exp_f32 v66, v66
 v_exp_f32 v67, v67
 v_mfma_f32_32x32x16_bf16 v[48:63], a[108:111], a[0:3], v[16:31]
 v_exp_f32 v68, v68
 v_exp_f32 v69, v69
 ds_read_b128 a[124:127], v7 offset:27456
 v_exp_f32 v70, v70
 v_exp_f32 v71, v71
 v_cvt_pk_bf16_f32 v88, v64, v65
 v_cvt_pk_bf16_f32 v89, v66, v67
 v_mfma_f32_32x32x16_bf16 v[48:63], a[144:147], a[36:39], v[48:63]
 v_exp_f32 v72, v72
 v_exp_f32 v73, v73
 ds_read_b128 a[128:131], v7 offset:28064
 v_exp_f32 v74, v74
 v_exp_f32 v75, v75
 v_cvt_pk_bf16_f32 v90, v68, v69
 v_cvt_pk_bf16_f32 v91, v70, v71
 v_mfma_f32_32x32x16_bf16 a[72:87], a[120:123], v[84:87], a[72:87]
 v_exp_f32 v76, v76
 v_exp_f32 v77, v77
 v_exp_f32 v78, v78
 v_exp_f32 v79, v79
 v_cvt_pk_bf16_f32 v92, v72, v73
 v_cvt_pk_bf16_f32 v93, v74, v75
 v_mfma_f32_32x32x16_bf16 a[88:103], a[116:119], v[88:91], a[88:103]
 v_exp_f32 v48, v48
 v_exp_f32 v49, v49
 v_cvt_pk_bf16_f32 v94, v76, v77
 v_cvt_pk_bf16_f32 v95, v78, v79
 v_exp_f32 v50, v50
 v_exp_f32 v51, v51
 v_mfma_f32_32x32x16_bf16 v[64:79], a[108:111], a[4:7], v[32:47]
 v_exp_f32 v52, v52
 v_exp_f32 v53, v53
 ds_read_b128 a[104:107], v4 offset:1024
 v_exp_f32 v54, v54
 v_exp_f32 v55, v55
 v_cvt_pk_bf16_f32 v80, v48, v49
 v_cvt_pk_bf16_f32 v81, v50, v51
 v_mfma_f32_32x32x16_bf16 v[64:79], a[144:147], a[68:71], v[64:79]
 v_exp_f32 v56, v56
 v_exp_f32 v57, v57
 v_exp_f32 v58, v58
 v_exp_f32 v59, v59
 v_cvt_pk_bf16_f32 v82, v52, v53
 v_cvt_pk_bf16_f32 v83, v54, v55
 v_mfma_f32_32x32x16_bf16 a[88:103], a[120:123], v[92:95], a[88:103]
 v_exp_f32 v60, v60
 v_exp_f32 v61, v61
 v_exp_f32 v62, v62
 v_exp_f32 v63, v63
 v_cvt_pk_bf16_f32 v84, v56, v57
 v_cvt_pk_bf16_f32 v85, v58, v59
 s_waitcnt lgkmcnt(1)
 v_mfma_f32_32x32x16_bf16 a[72:87], a[124:127], v[80:83], a[72:87]
 v_exp_f32 v64, v64
 v_exp_f32 v65, v65
 v_cvt_pk_bf16_f32 v86, v60, v61
 v_cvt_pk_bf16_f32 v87, v62, v63
 v_exp_f32 v66, v66
 v_exp_f32 v67, v67
 v_mfma_f32_32x32x16_bf16 v[48:63], a[112:115], a[0:3], v[16:31]
 v_exp_f32 v68, v68
 v_exp_f32 v69, v69
 ds_read_b128 a[132:135], v8 offset:0
 v_exp_f32 v70, v70
 v_exp_f32 v71, v71
 v_cvt_pk_bf16_f32 v88, v64, v65
 v_cvt_pk_bf16_f32 v89, v66, v67
 v_mfma_f32_32x32x16_bf16 v[48:63], a[140:143], a[8:11], v[48:63]
 v_exp_f32 v72, v72
 v_exp_f32 v73, v73
 ds_read_b128 a[136:139], v8 offset:608
 v_exp_f32 v74, v74
 v_exp_f32 v75, v75
 v_cvt_pk_bf16_f32 v90, v68, v69
 v_cvt_pk_bf16_f32 v91, v70, v71
 v_mfma_f32_32x32x16_bf16 a[72:87], a[128:131], v[84:87], a[72:87]
 v_exp_f32 v76, v76
 v_exp_f32 v77, v77
 v_exp_f32 v78, v78
 v_exp_f32 v79, v79
 v_cvt_pk_bf16_f32 v92, v72, v73
 v_cvt_pk_bf16_f32 v93, v74, v75
 v_mfma_f32_32x32x16_bf16 a[88:103], a[124:127], v[88:91], a[88:103]
 v_exp_f32 v48, v48
 v_exp_f32 v49, v49
 v_cvt_pk_bf16_f32 v94, v76, v77
 v_cvt_pk_bf16_f32 v95, v78, v79
 v_exp_f32 v50, v50
 v_exp_f32 v51, v51
 v_mfma_f32_32x32x16_bf16 v[64:79], a[112:115], a[4:7], v[32:47]
 v_exp_f32 v52, v52
 v_exp_f32 v53, v53
 ds_read_b128 a[108:111], v4 offset:2048
 v_exp_f32 v54, v54
 v_exp_f32 v55, v55
 v_cvt_pk_bf16_f32 v80, v48, v49
 v_cvt_pk_bf16_f32 v81, v50, v51
 v_mfma_f32_32x32x16_bf16 v[64:79], a[140:143], a[40:43], v[64:79]
 v_exp_f32 v56, v56
 v_exp_f32 v57, v57
 buffer_store_dwordx4 v[208:211], v1, s[4:7], s86 offen sc1
 s_add_u32 s86, s86, 4096
 v_exp_f32 v58, v58
 v_exp_f32 v59, v59
 v_cvt_pk_bf16_f32 v82, v52, v53
 v_cvt_pk_bf16_f32 v83, v54, v55
 v_mfma_f32_32x32x16_bf16 a[88:103], a[128:131], v[92:95], a[88:103]
 v_exp_f32 v60, v60
 v_exp_f32 v61, v61
 v_exp_f32 v62, v62
 v_exp_f32 v63, v63
 v_cvt_pk_bf16_f32 v84, v56, v57
 v_cvt_pk_bf16_f32 v85, v58, v59
 s_waitcnt lgkmcnt(1)
 v_mfma_f32_32x32x16_bf16 a[72:87], a[132:135], v[80:83], a[72:87]
 v_exp_f32 v64, v64
 v_exp_f32 v65, v65
 v_cvt_pk_bf16_f32 v86, v60, v61
 v_cvt_pk_bf16_f32 v87, v62, v63
 v_exp_f32 v66, v66
 v_exp_f32 v67, v67
 v_mfma_f32_32x32x16_bf16 v[48:63], a[104:107], a[0:3], v[16:31]
 v_exp_f32 v68, v68
 v_exp_f32 v69, v69
 ds_read_b128 a[116:119], v8 offset:1216
 v_exp_f32 v70, v70
 v_exp_f32 v71, v71
 v_cvt_pk_bf16_f32 v88, v64, v65
 v_cvt_pk_bf16_f32 v89, v66, v67
 v_mfma_f32_32x32x16_bf16 v[48:63], a[140:143], a[12:15], v[48:63]
 v_exp_f32 v72, v72
 v_exp_f32 v73, v73
 ds_read_b128 a[120:123], v8 offset:1824
 v_exp_f32 v74, v74
 v_exp_f32 v75, v75
 v_cvt_pk_bf16_f32 v90, v68, v69
 v_cvt_pk_bf16_f32 v91, v70, v71
 v_mfma_f32_32x32x16_bf16 a[72:87], a[136:139], v[84:87], a[72:87]
 v_exp_f32 v76, v76
 v_exp_f32 v77, v77
 v_exp_f32 v78, v78
 v_exp_f32 v79, v79
 v_cvt_pk_bf16_f32 v92, v72, v73
 v_cvt_pk_bf16_f32 v93, v74, v75
 v_mfma_f32_32x32x16_bf16 a[88:103], a[132:135], v[88:91], a[88:103]
 v_exp_f32 v48, v48
 v_exp_f32 v49, v49
 v_cvt_pk_bf16_f32 v94, v76, v77
 v_cvt_pk_bf16_f32 v95, v78, v79
 v_exp_f32 v50, v50
 v_exp_f32 v51, v51
 v_mfma_f32_32x32x16_bf16 v[64:79], a[104:107], a[4:7], v[32:47]
 v_exp_f32 v52, v52
 v_exp_f32 v53, v53
 ds_read_b128 a[112:115], v4 offset:3072
 v_exp_f32 v54, v54
 v_exp_f32 v55, v55
 v_cvt_pk_bf16_f32 v80, v48, v49
 v_cvt_pk_bf16_f32 v81, v50, v51
 v_mfma_f32_32x32x16_bf16 v[64:79], a[140:143], a[44:47], v[64:79]
 v_exp_f32 v56, v56
 v_exp_f32 v57, v57
 v_exp_f32 v58, v58
 v_exp_f32 v59, v59
 v_cvt_pk_bf16_f32 v82, v52, v53
 v_cvt_pk_bf16_f32 v83, v54, v55
 v_mfma_f32_32x32x16_bf16 a[88:103], a[136:139], v[92:95], a[88:103]
 v_exp_f32 v60, v60
 v_exp_f32 v61, v61
 v_exp_f32 v62, v62
 v_exp_f32 v63, v63
 v_cvt_pk_bf16_f32 v84, v56, v57
 v_cvt_pk_bf16_f32 v85, v58, v59
 s_waitcnt lgkmcnt(1)
 v_mfma_f32_32x32x16_bf16 a[72:87], a[116:119], v[80:83], a[72:87]
 v_exp_f32 v64, v64
 v_exp_f32 v65, v65
 v_cvt_pk_bf16_f32 v86, v60, v61
 v_cvt_pk_bf16_f32 v87, v62, v63
 v_exp_f32 v66, v66
 v_exp_f32 v67, v67
 v_mfma_f32_32x32x16_bf16 v[48:63], a[108:111], a[0:3], v[16:31]
 v_exp_f32 v68, v68
 v_exp_f32 v69, v69
 ds_read_b128 a[124:127], v8 offset:2432
 v_exp_f32 v70, v70
 v_exp_f32 v71, v71
 v_cvt_pk_bf16_f32 v88, v64, v65
 v_cvt_pk_bf16_f32 v89, v66, v67
 v_mfma_f32_32x32x16_bf16 v[48:63], a[140:143], a[16:19], v[48:63]
 v_exp_f32 v72, v72
 v_exp_f32 v73, v73
 ds_read_b128 a[128:131], v8 offset:3040
 v_exp_f32 v74, v74
 v_exp_f32 v75, v75
 v_cvt_pk_bf16_f32 v90, v68, v69
 v_cvt_pk_bf16_f32 v91, v70, v71
 v_mfma_f32_32x32x16_bf16 a[72:87], a[120:123], v[84:87], a[72:87]
 v_exp_f32 v76, v76
 v_exp_f32 v77, v77
 v_exp_f32 v78, v78
 v_exp_f32 v79, v79
 v_cvt_pk_bf16_f32 v92, v72, v73
 v_cvt_pk_bf16_f32 v93, v74, v75
 v_mfma_f32_32x32x16_bf16 a[88:103], a[116:119], v[88:91], a[88:103]
 v_exp_f32 v48, v48
 v_exp_f32 v49, v49
 v_cvt_pk_bf16_f32 v94, v76, v77
 v_cvt_pk_bf16_f32 v95, v78, v79
 v_exp_f32 v50, v50
 v_exp_f32 v51, v51
 v_mfma_f32_32x32x16_bf16 v[64:79], a[108:111], a[4:7], v[32:47]
 v_exp_f32 v52, v52
 v_exp_f32 v53, v53
 ds_read_b128 a[104:107], v4 offset:4096
 v_exp_f32 v54, v54
 v_exp_f32 v55, v55
 v_cvt_pk_bf16_f32 v80, v48, v49
 v_cvt_pk_bf16_f32 v81, v50, v51
 v_mfma_f32_32x32x16_bf16 v[64:79], a[140:143], a[48:51], v[64:79]
 v_exp_f32 v56, v56
 v_exp_f32 v57, v57
 buffer_store_dwordx4 v[208:211], v1, s[4:7], s86 offen sc1
 s_add_u32 s86, s86, 4096
 v_exp_f32 v58, v58
 v_exp_f32 v59, v59
 v_cvt_pk_bf16_f32 v82, v52, v53
 v_cvt_pk_bf16_f32 v83, v54, v55
 v_mfma_f32_32x32x16_bf16 a[88:103], a[120:123], v[92:95], a[88:103]
 v_exp_f32 v60, v60
 v_exp_f32 v61, v61
 v_exp_f32 v62, v62
 v_exp_f32 v63, v63
 v_cvt_pk_bf16_f32 v84, v56, v57
 v_cvt_pk_bf16_f32 v85, v58, v59
 s_waitcnt lgkmcnt(1)
 v_mfma_f32_32x32x16_bf16 a[72:87], a[124:127], v[80:83], a[72:87]
 v_exp_f32 v64, v64
 v_exp_f32 v65, v65
 v_cvt_pk_bf16_f32 v86, v60, v61
 v_cvt_pk_bf16_f32 v87, v62, v63
 v_exp_f32 v66, v66
 v_exp_f32 v67, v67
 v_mfma_f32_32x32x16_bf16 v[48:63], a[112:115], a[0:3], v[16:31]
 v_exp_f32 v68, v68
 v_exp_f32 v69, v69
 ds_read_b128 a[132:135], v8 offset:3648
 v_exp_f32 v70, v70
 v_exp_f32 v71, v71
 v_cvt_pk_bf16_f32 v88, v64, v65
 v_cvt_pk_bf16_f32 v89, v66, v67
 v_mfma_f32_32x32x16_bf16 v[48:63], a[140:143], a[20:23], v[48:63]
 v_exp_f32 v72, v72
 v_exp_f32 v73, v73
 ds_read_b128 a[136:139], v8 offset:4256
 v_exp_f32 v74, v74
 v_exp_f32 v75, v75
 v_cvt_pk_bf16_f32 v90, v68, v69
 v_cvt_pk_bf16_f32 v91, v70, v71
 v_mfma_f32_32x32x16_bf16 a[72:87], a[128:131], v[84:87], a[72:87]
 v_exp_f32 v76, v76
 v_exp_f32 v77, v77
 v_exp_f32 v78, v78
 v_exp_f32 v79, v79
 v_cvt_pk_bf16_f32 v92, v72, v73
 v_cvt_pk_bf16_f32 v93, v74, v75
 v_mfma_f32_32x32x16_bf16 a[88:103], a[124:127], v[88:91], a[88:103]
 v_exp_f32 v48, v48
 v_exp_f32 v49, v49
 v_cvt_pk_bf16_f32 v94, v76, v77
 v_cvt_pk_bf16_f32 v95, v78, v79
 v_exp_f32 v50, v50
 v_exp_f32 v51, v51
 v_mfma_f32_32x32x16_bf16 v[64:79], a[112:115], a[4:7], v[32:47]
 v_exp_f32 v52, v52
 v_exp_f32 v53, v53
 ds_read_b128 a[108:111], v4 offset:5120
 v_exp_f32 v54, v54
 v_exp_f32 v55, v55
 v_cvt_pk_bf16_f32 v80, v48, v49
 v_cvt_pk_bf16_f32 v81, v50, v51
 v_mfma_f32_32x32x16_bf16 v[64:79], a[140:143], a[52:55], v[64:79]
 v_exp_f32 v56, v56
 v_exp_f32 v57, v57
 v_exp_f32 v58, v58
 v_exp_f32 v59, v59
 v_cvt_pk_bf16_f32 v82, v52, v53
 v_cvt_pk_bf16_f32 v83, v54, v55
 v_mfma_f32_32x32x16_bf16 a[88:103], a[128:131], v[92:95], a[88:103]
 v_exp_f32 v60, v60
 v_exp_f32 v61, v61
 v_exp_f32 v62, v62
 v_exp_f32 v63, v63
 v_cvt_pk_bf16_f32 v84, v56, v57
 v_cvt_pk_bf16_f32 v85, v58, v59
 s_waitcnt lgkmcnt(1)
 v_mfma_f32_32x32x16_bf16 a[72:87], a[132:135], v[80:83], a[72:87]
 v_exp_f32 v64, v64
 v_exp_f32 v65, v65
 v_cvt_pk_bf16_f32 v86, v60, v61
 v_cvt_pk_bf16_f32 v87, v62, v63
 v_exp_f32 v66, v66
 v_exp_f32 v67, v67
 v_mfma_f32_32x32x16_bf16 v[48:63], a[104:107], a[0:3], v[16:31]
 v_exp_f32 v68, v68
 v_exp_f32 v69, v69
 ds_read_b128 a[116:119], v8 offset:4864
 v_exp_f32 v70, v70
 v_exp_f32 v71, v71
 v_cvt_pk_bf16_f32 v88, v64, v65
 v_cvt_pk_bf16_f32 v89, v66, v67
 v_mfma_f32_32x32x16_bf16 v[48:63], a[140:143], a[24:27], v[48:63]
 v_exp_f32 v72, v72
 v_exp_f32 v73, v73
 ds_read_b128 a[120:123], v8 offset:5472
 v_exp_f32 v74, v74
 v_exp_f32 v75, v75
 v_cvt_pk_bf16_f32 v90, v68, v69
 v_cvt_pk_bf16_f32 v91, v70, v71
 v_mfma_f32_32x32x16_bf16 a[72:87], a[136:139], v[84:87], a[72:87]
 v_exp_f32 v76, v76
 v_exp_f32 v77, v77
 v_exp_f32 v78, v78
 v_exp_f32 v79, v79
 v_cvt_pk_bf16_f32 v92, v72, v73
 v_cvt_pk_bf16_f32 v93, v74, v75
 v_mfma_f32_32x32x16_bf16 a[88:103], a[132:135], v[88:91], a[88:103]
 v_exp_f32 v48, v48
 v_exp_f32 v49, v49
 v_cvt_pk_bf16_f32 v94, v76, v77
 v_cvt_pk_bf16_f32 v95, v78, v79
 v_exp_f32 v50, v50
 v_exp_f32 v51, v51
 v_mfma_f32_32x32x16_bf16 v[64:79], a[104:107], a[4:7], v[32:47]
 v_exp_f32 v52, v52
 v_exp_f32 v53, v53
 ds_read_b128 a[112:115], v4 offset:6144
 v_exp_f32 v54, v54
 v_exp_f32 v55, v55
 v_cvt_pk_bf16_f32 v80, v48, v49
 v_cvt_pk_bf16_f32 v81, v50, v51
 v_mfma_f32_32x32x16_bf16 v[64:79], a[140:143], a[56:59], v[64:79]
 v_exp_f32 v56, v56
 v_exp_f32 v57, v57
 buffer_store_dwordx4 v[208:211], v1, s[4:7], s86 offen sc1
 s_add_u32 s86, s86, 4096
 v_exp_f32 v58, v58
 v_exp_f32 v59, v59
 v_cvt_pk_bf16_f32 v82, v52, v53
 v_cvt_pk_bf16_f32 v83, v54, v55
 v_mfma_f32_32x32x16_bf16 a[88:103], a[136:139], v[92:95], a[88:103]
 v_exp_f32 v60, v60
 v_exp_f32 v61, v61
 v_exp_f32 v62, v62
 v_exp_f32 v63, v63
 v_cvt_pk_bf16_f32 v84, v56, v57
 v_cvt_pk_bf16_f32 v85, v58, v59
 s_waitcnt lgkmcnt(1)
 v_mfma_f32_32x32x16_bf16 a[72:87], a[116:119], v[80:83], a[72:87]
 v_exp_f32 v64, v64
 v_exp_f32 v65, v65
 v_cvt_pk_bf16_f32 v86, v60, v61
 v_cvt_pk_bf16_f32 v87, v62, v63
 v_exp_f32 v66, v66
 v_exp_f32 v67, v67
 v_mfma_f32_32x32x16_bf16 v[48:63], a[108:111], a[0:3], v[16:31]
 v_exp_f32 v68, v68
 v_exp_f32 v69, v69
 ds_read_b128 a[124:127], v8 offset:6080
 v_exp_f32 v70, v70
 v_exp_f32 v71, v71
 v_cvt_pk_bf16_f32 v88, v64, v65
 v_cvt_pk_bf16_f32 v89, v66, v67
 v_mfma_f32_32x32x16_bf16 v[48:63], a[140:143], a[28:31], v[48:63]
 v_exp_f32 v72, v72
 v_exp_f32 v73, v73
 ds_read_b128 a[128:131], v8 offset:6688
 v_exp_f32 v74, v74
 v_exp_f32 v75, v75
 v_cvt_pk_bf16_f32 v90, v68, v69
 v_cvt_pk_bf16_f32 v91, v70, v71
 v_mfma_f32_32x32x16_bf16 a[72:87], a[120:123], v[84:87], a[72:87]
 v_exp_f32 v76, v76
 v_exp_f32 v77, v77
 v_exp_f32 v78, v78
 v_exp_f32 v79, v79
 v_cvt_pk_bf16_f32 v92, v72, v73
 v_cvt_pk_bf16_f32 v93, v74, v75
 v_mfma_f32_32x32x16_bf16 a[88:103], a[116:119], v[88:91], a[88:103]
 v_exp_f32 v48, v48
 v_exp_f32 v49, v49
 v_cvt_pk_bf16_f32 v94, v76, v77
 v_cvt_pk_bf16_f32 v95, v78, v79
 v_exp_f32 v50, v50
 v_exp_f32 v51, v51
 v_mfma_f32_32x32x16_bf16 v[64:79], a[108:111], a[4:7], v[32:47]
 v_exp_f32 v52, v52
 v_exp_f32 v53, v53
 ds_read_b128 a[104:107], v4 offset:7168
 v_exp_f32 v54, v54
 v_exp_f32 v55, v55
 v_cvt_pk_bf16_f32 v80, v48, v49
 v_cvt_pk_bf16_f32 v81, v50, v51
 v_mfma_f32_32x32x16_bf16 v[64:79], a[140:143], a[60:63], v[64:79]
 v_exp_f32 v56, v56
 v_exp_f32 v57, v57
 v_exp_f32 v58, v58
 v_exp_f32 v59, v59
 v_cvt_pk_bf16_f32 v82, v52, v53
 v_cvt_pk_bf16_f32 v83, v54, v55
 v_mfma_f32_32x32x16_bf16 a[88:103], a[120:123], v[92:95], a[88:103]
 v_exp_f32 v60, v60
 v_exp_f32 v61, v61
 v_exp_f32 v62, v62
 v_exp_f32 v63, v63
 v_cvt_pk_bf16_f32 v84, v56, v57
 v_cvt_pk_bf16_f32 v85, v58, v59
 s_waitcnt lgkmcnt(1)
 v_mfma_f32_32x32x16_bf16 a[72:87], a[124:127], v[80:83], a[72:87]
 v_exp_f32 v64, v64
 v_exp_f32 v65, v65
 v_cvt_pk_bf16_f32 v86, v60, v61
 v_cvt_pk_bf16_f32 v87, v62, v63
 v_exp_f32 v66, v66
 v_exp_f32 v67, v67
 v_mfma_f32_32x32x16_bf16 v[48:63], a[112:115], a[0:3], v[16:31]
 v_exp_f32 v68, v68
 v_exp_f32 v69, v69
 ds_read_b128 a[132:135], v8 offset:7296
 v_exp_f32 v70, v70
 v_exp_f32 v71, v71
 v_cvt_pk_bf16_f32 v88, v64, v65
 v_cvt_pk_bf16_f32 v89, v66, v67
 v_mfma_f32_32x32x16_bf16 v[48:63], a[140:143], a[32:35], v[48:63]
 v_exp_f32 v72, v72
 v_exp_f32 v73, v73
 ds_read_b128 a[136:139], v8 offset:7904
 v_exp_f32 v74, v74
 v_exp_f32 v75, v75
 v_cvt_pk_bf16_f32 v90, v68, v69
 v_cvt_pk_bf16_f32 v91, v70, v71
 v_mfma_f32_32x32x16_bf16 a[72:87], a[128:131], v[84:87], a[72:87]
 v_exp_f32 v76, v76
 v_exp_f32 v77, v77
 v_exp_f32 v78, v78
 v_exp_f32 v79, v79
 v_cvt_pk_bf16_f32 v92, v72, v73
 v_cvt_pk_bf16_f32 v93, v74, v75
 v_mfma_f32_32x32x16_bf16 a[88:103], a[124:127], v[88:91], a[88:103]
 v_exp_f32 v48, v48
 v_exp_f32 v49, v49
 v_cvt_pk_bf16_f32 v94, v76, v77
 v_cvt_pk_bf16_f32 v95, v78, v79
 v_exp_f32 v50, v50
 v_exp_f32 v51, v51
 v_mfma_f32_32x32x16_bf16 v[64:79], a[112:115], a[4:7], v[32:47]
 v_exp_f32 v52, v52
 v_exp_f32 v53, v53
 ds_read_b128 a[108:111], v4 offset:18944
 ds_read_b128 a[144:147], v4 offset:27136
 v_exp_f32 v54, v54
 v_exp_f32 v55, v55
 v_cvt_pk_bf16_f32 v80, v48, v49
 v_cvt_pk_bf16_f32 v81, v50, v51
 v_mfma_f32_32x32x16_bf16 v[64:79], a[140:143], a[64:67], v[64:79]
 v_exp_f32 v56, v56
 v_exp_f32 v57, v57
 s_add_u32 s30, s87, 0
 buffer_load_dwordx4 a[156:159], v1, s[4:7], s30 offen sc1
 v_exp_f32 v58, v58
 v_exp_f32 v59, v59
 v_cvt_pk_bf16_f32 v82, v52, v53
 v_cvt_pk_bf16_f32 v83, v54, v55
 v_mfma_f32_32x32x16_bf16 a[88:103], a[128:131], v[92:95], a[88:103]
 v_exp_f32 v60, v60
 v_exp_f32 v61, v61
 v_exp_f32 v62, v62
 v_exp_f32 v63, v63
 v_cvt_pk_bf16_f32 v84, v56, v57
 v_cvt_pk_bf16_f32 v85, v58, v59
 s_waitcnt lgkmcnt(2)
 v_mfma_f32_32x32x16_bf16 a[72:87], a[132:135], v[80:83], a[72:87]
 v_exp_f32 v64, v64
 v_exp_f32 v65, v65
 v_cvt_pk_bf16_f32 v86, v60, v61
 v_cvt_pk_bf16_f32 v87, v62, v63
 v_exp_f32 v66, v66
 v_exp_f32 v67, v67
 v_mfma_f32_32x32x16_bf16 v[48:63], a[104:107], a[0:3], v[16:31]
 v_exp_f32 v68, v68
 v_exp_f32 v69, v69
 ds_read_b128 a[116:119], v8 offset:8512
 v_exp_f32 v70, v70
 v_exp_f32 v71, v71
 v_cvt_pk_bf16_f32 v88, v64, v65
 v_cvt_pk_bf16_f32 v89, v66, v67
 v_mfma_f32_32x32x16_bf16 v[48:63], a[140:143], a[36:39], v[48:63]
 v_exp_f32 v72, v72
 v_exp_f32 v73, v73
 ds_read_b128 a[120:123], v8 offset:9120
 v_exp_f32 v74, v74
 v_exp_f32 v75, v75
 v_cvt_pk_bf16_f32 v90, v68, v69
 v_cvt_pk_bf16_f32 v91, v70, v71
 v_mfma_f32_32x32x16_bf16 a[72:87], a[136:139], v[84:87], a[72:87]
 v_exp_f32 v76, v76
 v_exp_f32 v77, v77
 v_exp_f32 v78, v78
 v_exp_f32 v79, v79
 v_cvt_pk_bf16_f32 v92, v72, v73
 v_cvt_pk_bf16_f32 v93, v74, v75
 v_mfma_f32_32x32x16_bf16 a[88:103], a[132:135], v[88:91], a[88:103]
 v_exp_f32 v48, v48
 v_exp_f32 v49, v49
 v_cvt_pk_bf16_f32 v94, v76, v77
 v_cvt_pk_bf16_f32 v95, v78, v79
 v_exp_f32 v50, v50
 v_exp_f32 v51, v51
 v_mfma_f32_32x32x16_bf16 v[64:79], a[104:107], a[4:7], v[32:47]
 v_exp_f32 v52, v52
 v_exp_f32 v53, v53
 ds_read_b128 a[112:115], v4 offset:19968
 v_exp_f32 v54, v54
 v_exp_f32 v55, v55
 v_cvt_pk_bf16_f32 v80, v48, v49
 v_cvt_pk_bf16_f32 v81, v50, v51
 v_mfma_f32_32x32x16_bf16 v[64:79], a[140:143], a[68:71], v[64:79]
 v_exp_f32 v56, v56
 v_exp_f32 v57, v57
 s_add_u32 s30, s87, 18432
 buffer_load_dwordx4 a[160:163], v1, s[4:7], s30 offen sc1
 v_exp_f32 v58, v58
 v_exp_f32 v59, v59
 v_cvt_pk_bf16_f32 v82, v52, v53
 v_cvt_pk_bf16_f32 v83, v54, v55
 v_mfma_f32_32x32x16_bf16 a[88:103], a[136:139], v[92:95], a[88:103]
 v_exp_f32 v60, v60
 v_exp_f32 v61, v61
 v_exp_f32 v62, v62
 v_exp_f32 v63, v63
 v_cvt_pk_bf16_f32 v84, v56, v57
 v_cvt_pk_bf16_f32 v85, v58, v59
 s_waitcnt lgkmcnt(1)
 v_mfma_f32_32x32x16_bf16 a[72:87], a[116:119], v[80:83], a[72:87]
 v_exp_f32 v64, v64
 v_exp_f32 v65, v65
 v_cvt_pk_bf16_f32 v86, v60, v61
 v_cvt_pk_bf16_f32 v87, v62, v63
 v_exp_f32 v66, v66
 v_exp_f32 v67, v67
 v_mfma_f32_32x32x16_bf16 v[48:63], a[108:111], a[0:3], v[16:31]
 v_exp_f32 v68, v68
 v_exp_f32 v69, v69
 ds_read_b128 a[124:127], v8 offset:18944
 v_exp_f32 v70, v70
 v_exp_f32 v71, v71
 v_cvt_pk_bf16_f32 v88, v64, v65
 v_cvt_pk_bf16_f32 v89, v66, v67
 v_mfma_f32_32x32x16_bf16 v[48:63], a[144:147], a[8:11], v[48:63]
 v_exp_f32 v72, v72
 v_exp_f32 v73, v73
 ds_read_b128 a[128:131], v8 offset:19552
 v_exp_f32 v74, v74
 v_exp_f32 v75, v75
 v_cvt_pk_bf16_f32 v90, v68, v69
 v_cvt_pk_bf16_f32 v91, v70, v71
 v_mfma_f32_32x32x16_bf16 a[72:87], a[120:123], v[84:87], a[72:87]
 v_exp_f32 v76, v76
 v_exp_f32 v77, v77
 v_exp_f32 v78, v78
 v_exp_f32 v79, v79
 v_cvt_pk_bf16_f32 v92, v72, v73
 v_cvt_pk_bf16_f32 v93, v74, v75
 v_mfma_f32_32x32x16_bf16 a[88:103], a[116:119], v[88:91], a[88:103]
 v_exp_f32 v48, v48
 v_exp_f32 v49, v49
 v_cvt_pk_bf16_f32 v94, v76, v77
 v_cvt_pk_bf16_f32 v95, v78, v79
 v_exp_f32 v50, v50
 v_exp_f32 v51, v51
 v_mfma_f32_32x32x16_bf16 v[64:79], a[108:111], a[4:7], v[32:47]
 v_exp_f32 v52, v52
 v_exp_f32 v53, v53
 ds_read_b128 a[104:107], v4 offset:20992
 v_exp_f32 v54, v54
 v_exp_f32 v55, v55
 v_cvt_pk_bf16_f32 v80, v48, v49
 v_cvt_pk_bf16_f32 v81, v50, v51
 v_mfma_f32_32x32x16_bf16 v[64:79], a[144:147], a[40:43], v[64:79]
 v_exp_f32 v56, v56
 v_exp_f32 v57, v57
 s_add_u32 s30, s87, 36864
 buffer_load_dwordx4 a[164:167], v1, s[4:7], s30 offen sc1
 v_exp_f32 v58, v58
 v_exp_f32 v59, v59
 v_cvt_pk_bf16_f32 v82, v52, v53
 v_cvt_pk_bf16_f32 v83, v54, v55
 v_mfma_f32_32x32x16_bf16 a[88:103], a[120:123], v[92:95], a[88:103]
 v_exp_f32 v60, v60
 v_exp_f32 v61, v61
 v_exp_f32 v62, v62
 v_exp_f32 v63, v63
 v_cvt_pk_bf16_f32 v84, v56, v57
 v_cvt_pk_bf16_f32 v85, v58, v59
 s_waitcnt lgkmcnt(1)
 v_mfma_f32_32x32x16_bf16 a[72:87], a[124:127], v[80:83], a[72:87]
 v_exp_f32 v64, v64
 v_exp_f32 v65, v65
 v_cvt_pk_bf16_f32 v86, v60, v61
 v_cvt_pk_bf16_f32 v87, v62, v63
 v_exp_f32 v66, v66
 v_exp_f32 v67, v67
 v_mfma_f32_32x32x16_bf16 v[48:63], a[112:115], a[0:3], v[16:31]
 v_exp_f32 v68, v68
 v_exp_f32 v69, v69
 ds_read_b128 a[132:135], v8 offset:20160
 v_exp_f32 v70, v70
 v_exp_f32 v71, v71
 v_cvt_pk_bf16_f32 v88, v64, v65
 v_cvt_pk_bf16_f32 v89, v66, v67
 v_mfma_f32_32x32x16_bf16 v[48:63], a[144:147], a[12:15], v[48:63]
 v_exp_f32 v72, v72
 v_exp_f32 v73, v73
 ds_read_b128 a[136:139], v8 offset:20768
 v_exp_f32 v74, v74
 v_exp_f32 v75, v75
 v_cvt_pk_bf16_f32 v90, v68, v69
 v_cvt_pk_bf16_f32 v91, v70, v71
 v_mfma_f32_32x32x16_bf16 a[72:87], a[128:131], v[84:87], a[72:87]
 v_exp_f32 v76, v76
 v_exp_f32 v77, v77
 v_exp_f32 v78, v78
 v_exp_f32 v79, v79
 v_cvt_pk_bf16_f32 v92, v72, v73
 v_cvt_pk_bf16_f32 v93, v74, v75
 v_mfma_f32_32x32x16_bf16 a[88:103], a[124:127], v[88:91], a[88:103]
 v_exp_f32 v48, v48
 v_exp_f32 v49, v49
 v_cvt_pk_bf16_f32 v94, v76, v77
 v_cvt_pk_bf16_f32 v95, v78, v79
 v_exp_f32 v50, v50
 v_exp_f32 v51, v51
 v_mfma_f32_32x32x16_bf16 v[64:79], a[112:115], a[4:7], v[32:47]
 v_exp_f32 v52, v52
 v_exp_f32 v53, v53
 ds_read_b128 a[108:111], v4 offset:22016
 v_exp_f32 v54, v54
 v_exp_f32 v55, v55
 v_cvt_pk_bf16_f32 v80, v48, v49
 v_cvt_pk_bf16_f32 v81, v50, v51
 v_mfma_f32_32x32x16_bf16 v[64:79], a[144:147], a[44:47], v[64:79]
 v_exp_f32 v56, v56
 v_exp_f32 v57, v57
 s_add_u32 s30, s87, 55296
 buffer_load_dwordx4 a[168:171], v1, s[4:7], s30 offen sc1
 v_exp_f32 v58, v58
 v_exp_f32 v59, v59
 v_cvt_pk_bf16_f32 v82, v52, v53
 v_cvt_pk_bf16_f32 v83, v54, v55
 v_mfma_f32_32x32x16_bf16 a[88:103], a[128:131], v[92:95], a[88:103]
 v_exp_f32 v60, v60
 v_exp_f32 v61, v61
 v_exp_f32 v62, v62
 v_exp_f32 v63, v63
 v_cvt_pk_bf16_f32 v84, v56, v57
 v_cvt_pk_bf16_f32 v85, v58, v59
 s_waitcnt lgkmcnt(1)
 v_mfma_f32_32x32x16_bf16 a[72:87], a[132:135], v[80:83], a[72:87]
 v_exp_f32 v64, v64
 v_exp_f32 v65, v65
 v_cvt_pk_bf16_f32 v86, v60, v61
 v_cvt_pk_bf16_f32 v87, v62, v63
 v_exp_f32 v66, v66
 v_exp_f32 v67, v67
 v_mfma_f32_32x32x16_bf16 v[48:63], a[104:107], a[0:3], v[16:31]
 v_exp_f32 v68, v68
 v_exp_f32 v69, v69
 ds_read_b128 a[116:119], v8 offset:21376
 v_exp_f32 v70, v70
 v_exp_f32 v71, v71
 v_cvt_pk_bf16_f32 v88, v64, v65
 v_cvt_pk_bf16_f32 v89, v66, v67
 v_mfma_f32_32x32x16_bf16 v[48:63], a[144:147], a[16:19], v[48:63]
 v_exp_f32 v72, v72
 v_exp_f32 v73, v73
 ds_read_b128 a[120:123], v8 offset:21984
 v_exp_f32 v74, v74
 v_exp_f32 v75, v75
 v_cvt_pk_bf16_f32 v90, v68, v69
 v_cvt_pk_bf16_f32 v91, v70, v71
 v_mfma_f32_32x32x16_bf16 a[72:87], a[136:139], v[84:87], a[72:87]
 v_exp_f32 v76, v76
 v_exp_f32 v77, v77
 v_exp_f32 v78, v78
 v_exp_f32 v79, v79
 v_cvt_pk_bf16_f32 v92, v72, v73
 v_cvt_pk_bf16_f32 v93, v74, v75
 v_mfma_f32_32x32x16_bf16 a[88:103], a[132:135], v[88:91], a[88:103]
 v_exp_f32 v48, v48
 v_exp_f32 v49, v49
 v_cvt_pk_bf16_f32 v94, v76, v77
 v_cvt_pk_bf16_f32 v95, v78, v79
 v_exp_f32 v50, v50
 v_exp_f32 v51, v51
 v_mfma_f32_32x32x16_bf16 v[64:79], a[104:107], a[4:7], v[32:47]
 v_exp_f32 v52, v52
 v_exp_f32 v53, v53
 ds_read_b128 a[112:115], v4 offset:23040
 v_exp_f32 v54, v54
 v_exp_f32 v55, v55
 v_cvt_pk_bf16_f32 v80, v48, v49
 v_cvt_pk_bf16_f32 v81, v50, v51
 v_mfma_f32_32x32x16_bf16 v[64:79], a[144:147], a[48:51], v[64:79]
 v_exp_f32 v56, v56
 v_exp_f32 v57, v57
 s_add_u32 s30, s87, 73728
 buffer_load_dwordx4 a[172:175], v1, s[4:7], s30 offen sc1
 v_exp_f32 v58, v58
 v_exp_f32 v59, v59
 v_cvt_pk_bf16_f32 v82, v52, v53
 v_cvt_pk_bf16_f32 v83, v54, v55
 v_mfma_f32_32x32x16_bf16 a[88:103], a[136:139], v[92:95], a[88:103]
 v_exp_f32 v60, v60
 v_exp_f32 v61, v61
 v_exp_f32 v62, v62
 v_exp_f32 v63, v63
 v_cvt_pk_bf16_f32 v84, v56, v57
 v_cvt_pk_bf16_f32 v85, v58, v59
 s_waitcnt lgkmcnt(1)
 v_mfma_f32_32x32x16_bf16 a[72:87], a[116:119], v[80:83], a[72:87]
 v_exp_f32 v64, v64
 v_exp_f32 v65, v65
 v_cvt_pk_bf16_f32 v86, v60, v61
 v_cvt_pk_bf16_f32 v87, v62, v63
 v_exp_f32 v66, v66
 v_exp_f32 v67, v67
 v_mfma_f32_32x32x16_bf16 v[48:63], a[108:111], a[0:3], v[16:31]
 v_exp_f32 v68, v68
 v_exp_f32 v69, v69
 ds_read_b128 a[124:127], v8 offset:22592
 v_exp_f32 v70, v70
 v_exp_f32 v71, v71
 v_cvt_pk_bf16_f32 v88, v64, v65
 v_cvt_pk_bf16_f32 v89, v66, v67
 v_mfma_f32_32x32x16_bf16 v[48:63], a[144:147], a[20:23], v[48:63]
 v_exp_f32 v72, v72
 v_exp_f32 v73, v73
 ds_read_b128 a[128:131], v8 offset:23200
 v_exp_f32 v74, v74
 v_exp_f32 v75, v75
 v_cvt_pk_bf16_f32 v90, v68, v69
 v_cvt_pk_bf16_f32 v91, v70, v71
 v_mfma_f32_32x32x16_bf16 a[72:87], a[120:123], v[84:87], a[72:87]
 v_exp_f32 v76, v76
 v_exp_f32 v77, v77
 v_exp_f32 v78, v78
 v_exp_f32 v79, v79
 v_cvt_pk_bf16_f32 v92, v72, v73
 v_cvt_pk_bf16_f32 v93, v74, v75
 v_mfma_f32_32x32x16_bf16 a[88:103], a[116:119], v[88:91], a[88:103]
 v_exp_f32 v48, v48
 v_exp_f32 v49, v49
 v_cvt_pk_bf16_f32 v94, v76, v77
 v_cvt_pk_bf16_f32 v95, v78, v79
 v_exp_f32 v50, v50
 v_exp_f32 v51, v51
 v_mfma_f32_32x32x16_bf16 v[64:79], a[108:111], a[4:7], v[32:47]
 v_exp_f32 v52, v52
 v_exp_f32 v53, v53
 ds_read_b128 a[104:107], v4 offset:24064
 v_exp_f32 v54, v54
 v_exp_f32 v55, v55
 v_cvt_pk_bf16_f32 v80, v48, v49
 v_cvt_pk_bf16_f32 v81, v50, v51
 v_mfma_f32_32x32x16_bf16 v[64:79], a[144:147], a[52:55], v[64:79]
 v_exp_f32 v56, v56
 v_exp_f32 v57, v57
 s_add_u32 s30, s87, 4096
 buffer_load_dwordx4 a[176:179], v1, s[4:7], s30 offen sc1
 v_exp_f32 v58, v58
 v_exp_f32 v59, v59
 v_cvt_pk_bf16_f32 v82, v52, v53
 v_cvt_pk_bf16_f32 v83, v54, v55
 v_mfma_f32_32x32x16_bf16 a[88:103], a[120:123], v[92:95], a[88:103]
 v_exp_f32 v60, v60
 v_exp_f32 v61, v61
 v_exp_f32 v62, v62
 v_exp_f32 v63, v63
 v_cvt_pk_bf16_f32 v84, v56, v57
 v_cvt_pk_bf16_f32 v85, v58, v59
 s_waitcnt lgkmcnt(1)
 v_mfma_f32_32x32x16_bf16 a[72:87], a[124:127], v[80:83], a[72:87]
 v_exp_f32 v64, v64
 v_exp_f32 v65, v65
 v_cvt_pk_bf16_f32 v86, v60, v61
 v_cvt_pk_bf16_f32 v87, v62, v63
 v_exp_f32 v66, v66
 v_exp_f32 v67, v67
 v_mfma_f32_32x32x16_bf16 v[48:63], a[112:115], a[0:3], v[16:31]
 v_exp_f32 v68, v68
 v_exp_f32 v69, v69
 ds_read_b128 a[132:135], v8 offset:23808
 v_exp_f32 v70, v70
 v_exp_f32 v71, v71
 v_cvt_pk_bf16_f32 v88, v64, v65
 v_cvt_pk_bf16_f32 v89, v66, v67
 v_mfma_f32_32x32x16_bf16 v[48:63], a[144:147], a[24:27], v[48:63]
 v_exp_f32 v72, v72
 v_exp_f32 v73, v73
 ds_read_b128 a[136:139], v8 offset:24416
 v_exp_f32 v74, v74
 v_exp_f32 v75, v75
 v_cvt_pk_bf16_f32 v90, v68, v69
 v_cvt_pk_bf16_f32 v91, v70, v71
 v_mfma_f32_32x32x16_bf16 a[72:87], a[128:131], v[84:87], a[72:87]
 v_exp_f32 v76, v76
 v_exp_f32 v77, v77
 v_exp_f32 v78, v78
 v_exp_f32 v79, v79
 v_cvt_pk_bf16_f32 v92, v72, v73
 v_cvt_pk_bf16_f32 v93, v74, v75
 v_mfma_f32_32x32x16_bf16 a[88:103], a[124:127], v[88:91], a[88:103]
 v_exp_f32 v48, v48
 v_exp_f32 v49, v49
 v_cvt_pk_bf16_f32 v94, v76, v77
 v_cvt_pk_bf16_f32 v95, v78, v79
 v_exp_f32 v50, v50
 v_exp_f32 v51, v51
 v_mfma_f32_32x32x16_bf16 v[64:79], a[112:115], a[4:7], v[32:47]
 v_exp_f32 v52, v52
 v_exp_f32 v53, v53
 ds_read_b128 a[108:111], v4 offset:25088
 v_exp_f32 v54, v54
 v_exp_f32 v55, v55
 v_cvt_pk_bf16_f32 v80, v48, v49
 v_cvt_pk_bf16_f32 v81, v50, v51
 v_mfma_f32_32x32x16_bf16 v[64:79], a[144:147], a[56:59], v[64:79]
 v_exp_f32 v56, v56
 v_exp_f32 v57, v57
 s_add_u32 s30, s87, 22528
 buffer_load_dwordx4 a[180:183], v1, s[4:7], s30 offen sc1
 v_exp_f32 v58, v58
 v_exp_f32 v59, v59
 v_cvt_pk_bf16_f32 v82, v52, v53
 v_cvt_pk_bf16_f32 v83, v54, v55
 v_mfma_f32_32x32x16_bf16 a[88:103], a[128:131], v[92:95], a[88:103]
 v_exp_f32 v60, v60
 v_exp_f32 v61, v61
 v_exp_f32 v62, v62
 v_exp_f32 v63, v63
 v_cvt_pk_bf16_f32 v84, v56, v57
 v_cvt_pk_bf16_f32 v85, v58, v59
 s_waitcnt lgkmcnt(1)
 v_mfma_f32_32x32x16_bf16 a[72:87], a[132:135], v[80:83], a[72:87]
 v_exp_f32 v64, v64
 v_exp_f32 v65, v65
 v_cvt_pk_bf16_f32 v86, v60, v61
 v_cvt_pk_bf16_f32 v87, v62, v63
 v_exp_f32 v66, v66
 v_exp_f32 v67, v67
 v_mfma_f32_32x32x16_bf16 v[48:63], a[104:107], a[0:3], v[16:31]
 v_exp_f32 v68, v68
 v_exp_f32 v69, v69
 ds_read_b128 a[116:119], v8 offset:25024
 v_exp_f32 v70, v70
 v_exp_f32 v71, v71
 v_cvt_pk_bf16_f32 v88, v64, v65
 v_cvt_pk_bf16_f32 v89, v66, v67
 v_mfma_f32_32x32x16_bf16 v[48:63], a[144:147], a[28:31], v[48:63]
 v_exp_f32 v72, v72
 v_exp_f32 v73, v73
 ds_read_b128 a[120:123], v8 offset:25632
 v_exp_f32 v74, v74
 v_exp_f32 v75, v75
 v_cvt_pk_bf16_f32 v90, v68, v69
 v_cvt_pk_bf16_f32 v91, v70, v71
 v_mfma_f32_32x32x16_bf16 a[72:87], a[136:139], v[84:87], a[72:87]
 v_exp_f32 v76, v76
 v_exp_f32 v77, v77
 v_exp_f32 v78, v78
 v_exp_f32 v79, v79
 v_cvt_pk_bf16_f32 v92, v72, v73
 v_cvt_pk_bf16_f32 v93, v74, v75
 v_mfma_f32_32x32x16_bf16 a[88:103], a[132:135], v[88:91], a[88:103]
 v_exp_f32 v48, v48
 v_exp_f32 v49, v49
 v_cvt_pk_bf16_f32 v94, v76, v77
 v_cvt_pk_bf16_f32 v95, v78, v79
 v_exp_f32 v50, v50
 v_exp_f32 v51, v51
 v_mfma_f32_32x32x16_bf16 v[64:79], a[104:107], a[4:7], v[32:47]
 v_exp_f32 v52, v52
 v_exp_f32 v53, v53
 ds_read_b128 a[112:115], v4 offset:26112
 v_exp_f32 v54, v54
 v_exp_f32 v55, v55
 v_cvt_pk_bf16_f32 v80, v48, v49
 v_cvt_pk_bf16_f32 v81, v50, v51
 v_mfma_f32_32x32x16_bf16 v[64:79], a[144:147], a[60:63], v[64:79]
 v_exp_f32 v56, v56
 v_exp_f32 v57, v57
 s_add_u32 s30, s87, 40960
 buffer_load_dwordx4 a[184:187], v1, s[4:7], s30 offen sc1
 v_exp_f32 v58, v58
 v_exp_f32 v59, v59
 v_cvt_pk_bf16_f32 v82, v52, v53
 v_cvt_pk_bf16_f32 v83, v54, v55
 v_mfma_f32_32x32x16_bf16 a[88:103], a[136:139], v[92:95], a[88:103]
 v_exp_f32 v60, v60
 v_exp_f32 v61, v61
 v_exp_f32 v62, v62
 v_exp_f32 v63, v63
 v_cvt_pk_bf16_f32 v84, v56, v57
 v_cvt_pk_bf16_f32 v85, v58, v59
 s_waitcnt lgkmcnt(1)
 v_mfma_f32_32x32x16_bf16 a[72:87], a[116:119], v[80:83], a[72:87]
 v_exp_f32 v64, v64
 v_exp_f32 v65, v65
 v_cvt_pk_bf16_f32 v86, v60, v61
 v_cvt_pk_bf16_f32 v87, v62, v63
 v_exp_f32 v66, v66
 v_exp_f32 v67, v67
 v_mfma_f32_32x32x16_bf16 v[48:63], a[108:111], a[0:3], v[16:31]
 v_exp_f32 v68, v68
 v_exp_f32 v69, v69
 ds_read_b128 a[124:127], v8 offset:26240
 v_exp_f32 v70, v70
 v_exp_f32 v71, v71
 v_cvt_pk_bf16_f32 v88, v64, v65
 v_cvt_pk_bf16_f32 v89, v66, v67
 v_mfma_f32_32x32x16_bf16 v[48:63], a[144:147], a[32:35], v[48:63]
 v_exp_f32 v72, v72
 v_exp_f32 v73, v73
 ds_read_b128 a[128:131], v8 offset:26848
 v_exp_f32 v74, v74
 v_exp_f32 v75, v75
 v_cvt_pk_bf16_f32 v90, v68, v69
 v_cvt_pk_bf16_f32 v91, v70, v71
 v_mfma_f32_32x32x16_bf16 a[72:87], a[120:123], v[84:87], a[72:87]
 v_exp_f32 v76, v76
 v_exp_f32 v77, v77
 v_exp_f32 v78, v78
 v_exp_f32 v79, v79
 v_cvt_pk_bf16_f32 v92, v72, v73
 v_cvt_pk_bf16_f32 v93, v74, v75
 v_mfma_f32_32x32x16_bf16 a[88:103], a[116:119], v[88:91], a[88:103]
 v_exp_f32 v48, v48
 v_exp_f32 v49, v49
 v_cvt_pk_bf16_f32 v94, v76, v77
 v_cvt_pk_bf16_f32 v95, v78, v79
 v_exp_f32 v50, v50
 v_exp_f32 v51, v51
 v_mfma_f32_32x32x16_bf16 v[64:79], a[108:111], a[4:7], v[32:47]
 v_exp_f32 v52, v52
 v_exp_f32 v53, v53
 ds_read_b128 a[104:107], v5 offset:0
 ds_read_b128 a[140:143], v5 offset:8192
 v_exp_f32 v54, v54
 v_exp_f32 v55, v55
 v_cvt_pk_bf16_f32 v80, v48, v49
 v_cvt_pk_bf16_f32 v81, v50, v51
 v_mfma_f32_32x32x16_bf16 v[64:79], a[144:147], a[64:67], v[64:79]
 v_exp_f32 v56, v56
 v_exp_f32 v57, v57
 s_add_u32 s30, s87, 59392
 buffer_load_dwordx4 a[188:191], v1, s[4:7], s30 offen sc1
 v_exp_f32 v58, v58
 v_exp_f32 v59, v59
 v_cvt_pk_bf16_f32 v82, v52, v53
 v_cvt_pk_bf16_f32 v83, v54, v55
 v_mfma_f32_32x32x16_bf16 a[88:103], a[120:123], v[92:95], a[88:103]
 v_exp_f32 v60, v60
 v_exp_f32 v61, v61
 v_exp_f32 v62, v62
 v_exp_f32 v63, v63
 v_cvt_pk_bf16_f32 v84, v56, v57
 v_cvt_pk_bf16_f32 v85, v58, v59
 s_waitcnt lgkmcnt(2)
 v_mfma_f32_32x32x16_bf16 a[72:87], a[124:127], v[80:83], a[72:87]
 v_exp_f32 v64, v64
 v_exp_f32 v65, v65
 v_cvt_pk_bf16_f32 v86, v60, v61
 v_cvt_pk_bf16_f32 v87, v62, v63
 v_exp_f32 v66, v66
 v_exp_f32 v67, v67
 v_mfma_f32_32x32x16_bf16 v[48:63], a[112:115], a[0:3], v[16:31]
 v_exp_f32 v68, v68
 v_exp_f32 v69, v69
 ds_read_b128 a[132:135], v8 offset:27456
 v_exp_f32 v70, v70
 v_exp_f32 v71, v71
 v_cvt_pk_bf16_f32 v88, v64, v65
 v_cvt_pk_bf16_f32 v89, v66, v67
 v_mfma_f32_32x32x16_bf16 v[48:63], a[144:147], a[36:39], v[48:63]
 v_exp_f32 v72, v72
 v_exp_f32 v73, v73
 ds_read_b128 a[136:139], v8 offset:28064
 v_exp_f32 v74, v74
 v_exp_f32 v75, v75
 v_cvt_pk_bf16_f32 v90, v68, v69
 v_cvt_pk_bf16_f32 v91, v70, v71
 v_mfma_f32_32x32x16_bf16 a[72:87], a[128:131], v[84:87], a[72:87]
 v_exp_f32 v76, v76
 v_exp_f32 v77, v77
 v_exp_f32 v78, v78
 v_exp_f32 v79, v79
 v_cvt_pk_bf16_f32 v92, v72, v73
 v_cvt_pk_bf16_f32 v93, v74, v75
 v_mfma_f32_32x32x16_bf16 a[88:103], a[124:127], v[88:91], a[88:103]
 v_exp_f32 v48, v48
 v_exp_f32 v49, v49
 v_cvt_pk_bf16_f32 v94, v76, v77
 v_cvt_pk_bf16_f32 v95, v78, v79
 v_exp_f32 v50, v50
 v_exp_f32 v51, v51
 v_mfma_f32_32x32x16_bf16 v[64:79], a[112:115], a[4:7], v[32:47]
 v_exp_f32 v52, v52
 v_exp_f32 v53, v53
 ds_read_b128 a[108:111], v5 offset:1024
 v_exp_f32 v54, v54
 v_exp_f32 v55, v55
 v_cvt_pk_bf16_f32 v80, v48, v49
 v_cvt_pk_bf16_f32 v81, v50, v51
 v_mfma_f32_32x32x16_bf16 v[64:79], a[144:147], a[68:71], v[64:79]
 v_exp_f32 v56, v56
 v_exp_f32 v57, v57
 s_add_u32 s30, s87, 77824
 buffer_load_dwordx4 a[192:195], v1, s[4:7], s30 offen sc1
 v_exp_f32 v58, v58
 v_exp_f32 v59, v59
 v_cvt_pk_bf16_f32 v82, v52, v53
 v_cvt_pk_bf16_f32 v83, v54, v55
 v_mfma_f32_32x32x16_bf16 a[88:103], a[128:131], v[92:95], a[88:103]
 v_exp_f32 v60, v60
 v_exp_f32 v61, v61
 v_exp_f32 v62, v62
 v_exp_f32 v63, v63
 v_cvt_pk_bf16_f32 v84, v56, v57
 v_cvt_pk_bf16_f32 v85, v58, v59
 s_waitcnt lgkmcnt(1)
 v_mfma_f32_32x32x16_bf16 a[72:87], a[132:135], v[80:83], a[72:87]
 v_exp_f32 v64, v64
 v_exp_f32 v65, v65
 v_cvt_pk_bf16_f32 v86, v60, v61
 v_cvt_pk_bf16_f32 v87, v62, v63
 v_exp_f32 v66, v66
 v_exp_f32 v67, v67
 v_mfma_f32_32x32x16_bf16 v[48:63], a[104:107], a[0:3], v[16:31]
 v_exp_f32 v68, v68
 v_exp_f32 v69, v69
 ds_read_b128 a[116:119], v9 offset:0
 v_exp_f32 v70, v70
 v_exp_f32 v71, v71
 v_cvt_pk_bf16_f32 v88, v64, v65
 v_cvt_pk_bf16_f32 v89, v66, v67
 v_mfma_f32_32x32x16_bf16 v[48:63], a[140:143], a[8:11], v[48:63]
 v_exp_f32 v72, v72
 v_exp_f32 v73, v73
 ds_read_b128 a[120:123], v9 offset:608
 v_exp_f32 v74, v74
 v_exp_f32 v75, v75
 v_cvt_pk_bf16_f32 v90, v68, v69
 v_cvt_pk_bf16_f32 v91, v70, v71
 v_mfma_f32_32x32x16_bf16 a[72:87], a[136:139], v[84:87], a[72:87]
 v_exp_f32 v76, v76
 v_exp_f32 v77, v77
 v_exp_f32 v78, v78
 v_exp_f32 v79, v79
 v_cvt_pk_bf16_f32 v92, v72, v73
 v_cvt_pk_bf16_f32 v93, v74, v75
 v_mfma_f32_32x32x16_bf16 a[88:103], a[132:135], v[88:91], a[88:103]
 v_exp_f32 v48, v48
 v_exp_f32 v49, v49
 v_cvt_pk_bf16_f32 v94, v76, v77
 v_cvt_pk_bf16_f32 v95, v78, v79
 v_exp_f32 v50, v50
 v_exp_f32 v51, v51
 v_mfma_f32_32x32x16_bf16 v[64:79], a[104:107], a[4:7], v[32:47]
 v_exp_f32 v52, v52
 v_exp_f32 v53, v53
 ds_read_b128 a[112:115], v5 offset:2048
 v_exp_f32 v54, v54
 v_exp_f32 v55, v55
 v_cvt_pk_bf16_f32 v80, v48, v49
 v_cvt_pk_bf16_f32 v81, v50, v51
 v_mfma_f32_32x32x16_bf16 v[64:79], a[140:143], a[40:43], v[64:79]
 v_exp_f32 v56, v56
 v_exp_f32 v57, v57
 s_add_u32 s30, s87, 8192
 buffer_load_dwordx4 a[196:199], v1, s[4:7], s30 offen sc1
 v_exp_f32 v58, v58
 v_exp_f32 v59, v59
 v_cvt_pk_bf16_f32 v82, v52, v53
 v_cvt_pk_bf16_f32 v83, v54, v55
 v_mfma_f32_32x32x16_bf16 a[88:103], a[136:139], v[92:95], a[88:103]
 v_exp_f32 v60, v60
 v_exp_f32 v61, v61
 v_exp_f32 v62, v62
 v_exp_f32 v63, v63
 v_cvt_pk_bf16_f32 v84, v56, v57
 v_cvt_pk_bf16_f32 v85, v58, v59
 s_waitcnt lgkmcnt(1)
 v_mfma_f32_32x32x16_bf16 a[72:87], a[116:119], v[80:83], a[72:87]
 v_exp_f32 v64, v64
 v_exp_f32 v65, v65
 v_cvt_pk_bf16_f32 v86, v60, v61
 v_cvt_pk_bf16_f32 v87, v62, v63
 v_exp_f32 v66, v66
 v_exp_f32 v67, v67
 v_mfma_f32_32x32x16_bf16 v[48:63], a[108:111], a[0:3], v[16:31]
 v_exp_f32 v68, v68
 v_exp_f32 v69, v69
 ds_read_b128 a[124:127], v9 offset:1216
 v_exp_f32 v70, v70
 v_exp_f32 v71, v71
 v_cvt_pk_bf16_f32 v88, v64, v65
 v_cvt_pk_bf16_f32 v89, v66, v67
 v_mfma_f32_32x32x16_bf16 v[48:63], a[140:143], a[12:15], v[48:63]
 v_exp_f32 v72, v72
 v_exp_f32 v73, v73
 ds_read_b128 a[128:131], v9 offset:1824
 v_exp_f32 v74, v74
 v_exp_f32 v75, v75
 v_cvt_pk_bf16_f32 v90, v68, v69
 v_cvt_pk_bf16_f32 v91, v70, v71
 v_mfma_f32_32x32x16_bf16 a[72:87], a[120:123], v[84:87], a[72:87]
 v_exp_f32 v76, v76
 v_exp_f32 v77, v77
 v_exp_f32 v78, v78
 v_exp_f32 v79, v79
 v_cvt_pk_bf16_f32 v92, v72, v73
 v_cvt_pk_bf16_f32 v93, v74, v75
 v_mfma_f32_32x32x16_bf16 a[88:103], a[116:119], v[88:91], a[88:103]
 v_exp_f32 v48, v48
 v_exp_f32 v49, v49
 v_cvt_pk_bf16_f32 v94, v76, v77
 v_cvt_pk_bf16_f32 v95, v78, v79
 v_exp_f32 v50, v50
 v_exp_f32 v51, v51
 v_mfma_f32_32x32x16_bf16 v[64:79], a[108:111], a[4:7], v[32:47]
 v_exp_f32 v52, v52
 v_exp_f32 v53, v53
 ds_read_b128 a[104:107], v5 offset:3072
 v_exp_f32 v54, v54
 v_exp_f32 v55, v55
 v_cvt_pk_bf16_f32 v80, v48, v49
 v_cvt_pk_bf16_f32 v81, v50, v51
 v_mfma_f32_32x32x16_bf16 v[64:79], a[140:143], a[44:47], v[64:79]
 v_exp_f32 v56, v56
 v_exp_f32 v57, v57
 s_add_u32 s30, s87, 26624
 buffer_load_dwordx4 a[200:203], v1, s[4:7], s30 offen sc1
 v_exp_f32 v58, v58
 v_exp_f32 v59, v59
 v_cvt_pk_bf16_f32 v82, v52, v53
 v_cvt_pk_bf16_f32 v83, v54, v55
 v_mfma_f32_32x32x16_bf16 a[88:103], a[120:123], v[92:95], a[88:103]
 v_exp_f32 v60, v60
 v_exp_f32 v61, v61
 v_exp_f32 v62, v62
 v_exp_f32 v63, v63
 v_cvt_pk_bf16_f32 v84, v56, v57
 v_cvt_pk_bf16_f32 v85, v58, v59
 s_waitcnt lgkmcnt(1)
 v_mfma_f32_32x32x16_bf16 a[72:87], a[124:127], v[80:83], a[72:87]
 v_exp_f32 v64, v64
 v_exp_f32 v65, v65
 v_cvt_pk_bf16_f32 v86, v60, v61
 v_cvt_pk_bf16_f32 v87, v62, v63
 v_exp_f32 v66, v66
 v_exp_f32 v67, v67
 v_mfma_f32_32x32x16_bf16 v[48:63], a[112:115], a[0:3], v[16:31]
 v_exp_f32 v68, v68
 v_exp_f32 v69, v69
 ds_read_b128 a[132:135], v9 offset:2432
 v_exp_f32 v70, v70
 v_exp_f32 v71, v71
 v_cvt_pk_bf16_f32 v88, v64, v65
 v_cvt_pk_bf16_f32 v89, v66, v67
 v_mfma_f32_32x32x16_bf16 v[48:63], a[140:143], a[16:19], v[48:63]
 v_exp_f32 v72, v72
 v_exp_f32 v73, v73
 ds_read_b128 a[136:139], v9 offset:3040
 v_exp_f32 v74, v74
 v_exp_f32 v75, v75
 v_cvt_pk_bf16_f32 v90, v68, v69
 v_cvt_pk_bf16_f32 v91, v70, v71
 v_mfma_f32_32x32x16_bf16 a[72:87], a[128:131], v[84:87], a[72:87]
 v_exp_f32 v76, v76
 v_exp_f32 v77, v77
 v_exp_f32 v78, v78
 v_exp_f32 v79, v79
 v_cvt_pk_bf16_f32 v92, v72, v73
 v_cvt_pk_bf16_f32 v93, v74, v75
 v_mfma_f32_32x32x16_bf16 a[88:103], a[124:127], v[88:91], a[88:103]
 v_exp_f32 v48, v48
 v_exp_f32 v49, v49
 v_cvt_pk_bf16_f32 v94, v76, v77
 v_cvt_pk_bf16_f32 v95, v78, v79
 v_exp_f32 v50, v50
 v_exp_f32 v51, v51
 v_mfma_f32_32x32x16_bf16 v[64:79], a[112:115], a[4:7], v[32:47]
 v_exp_f32 v52, v52
 v_exp_f32 v53, v53
 ds_read_b128 a[108:111], v5 offset:4096
 v_exp_f32 v54, v54
 v_exp_f32 v55, v55
 v_cvt_pk_bf16_f32 v80, v48, v49
 v_cvt_pk_bf16_f32 v81, v50, v51
 v_mfma_f32_32x32x16_bf16 v[64:79], a[140:143], a[48:51], v[64:79]
 v_exp_f32 v56, v56
 v_exp_f32 v57, v57
 s_add_u32 s30, s87, 45056
 buffer_load_dwordx4 a[204:207], v1, s[4:7], s30 offen sc1
 v_exp_f32 v58, v58
 v_exp_f32 v59, v59
 v_cvt_pk_bf16_f32 v82, v52, v53
 v_cvt_pk_bf16_f32 v83, v54, v55
 v_mfma_f32_32x32x16_bf16 a[88:103], a[128:131], v[92:95], a[88:103]
 v_exp_f32 v60, v60
 v_exp_f32 v61, v61
 v_exp_f32 v62, v62
 v_exp_f32 v63, v63
 v_cvt_pk_bf16_f32 v84, v56, v57
 v_cvt_pk_bf16_f32 v85, v58, v59
 s_waitcnt lgkmcnt(1)
 v_mfma_f32_32x32x16_bf16 a[72:87], a[132:135], v[80:83], a[72:87]
 v_exp_f32 v64, v64
 v_exp_f32 v65, v65
 v_cvt_pk_bf16_f32 v86, v60, v61
 v_cvt_pk_bf16_f32 v87, v62, v63
 v_exp_f32 v66, v66
 v_exp_f32 v67, v67
 v_mfma_f32_32x32x16_bf16 v[48:63], a[104:107], a[0:3], v[16:31]
 v_exp_f32 v68, v68
 v_exp_f32 v69, v69
 ds_read_b128 a[116:119], v9 offset:3648
 v_exp_f32 v70, v70
 v_exp_f32 v71, v71
 v_cvt_pk_bf16_f32 v88, v64, v65
 v_cvt_pk_bf16_f32 v89, v66, v67
 v_mfma_f32_32x32x16_bf16 v[48:63], a[140:143], a[20:23], v[48:63]
 v_exp_f32 v72, v72
 v_exp_f32 v73, v73
 ds_read_b128 a[120:123], v9 offset:4256
 v_exp_f32 v74, v74
 v_exp_f32 v75, v75
 v_cvt_pk_bf16_f32 v90, v68, v69
 v_cvt_pk_bf16_f32 v91, v70, v71
 v_mfma_f32_32x32x16_bf16 a[72:87], a[136:139], v[84:87], a[72:87]
 v_exp_f32 v76, v76
 v_exp_f32 v77, v77
 v_exp_f32 v78, v78
 v_exp_f32 v79, v79
 v_cvt_pk_bf16_f32 v92, v72, v73
 v_cvt_pk_bf16_f32 v93, v74, v75
 v_mfma_f32_32x32x16_bf16 a[88:103], a[132:135], v[88:91], a[88:103]
 v_exp_f32 v48, v48
 v_exp_f32 v49, v49
 v_cvt_pk_bf16_f32 v94, v76, v77
 v_cvt_pk_bf16_f32 v95, v78, v79
 v_exp_f32 v50, v50
 v_exp_f32 v51, v51
 v_mfma_f32_32x32x16_bf16 v[64:79], a[104:107], a[4:7], v[32:47]
 v_exp_f32 v52, v52
 v_exp_f32 v53, v53
 ds_read_b128 a[112:115], v5 offset:5120
 v_exp_f32 v54, v54
 v_exp_f32 v55, v55
 v_cvt_pk_bf16_f32 v80, v48, v49
 v_cvt_pk_bf16_f32 v81, v50, v51
 v_mfma_f32_32x32x16_bf16 v[64:79], a[140:143], a[52:55], v[64:79]
 v_exp_f32 v56, v56
 v_exp_f32 v57, v57
 s_add_u32 s30, s87, 63488
 buffer_load_dwordx4 a[208:211], v1, s[4:7], s30 offen sc1
 v_exp_f32 v58, v58
 v_exp_f32 v59, v59
 v_cvt_pk_bf16_f32 v82, v52, v53
 v_cvt_pk_bf16_f32 v83, v54, v55
 v_mfma_f32_32x32x16_bf16 a[88:103], a[136:139], v[92:95], a[88:103]
 v_exp_f32 v60, v60
 v_exp_f32 v61, v61
 v_exp_f32 v62, v62
 v_exp_f32 v63, v63
 v_cvt_pk_bf16_f32 v84, v56, v57
 v_cvt_pk_bf16_f32 v85, v58, v59
 s_waitcnt lgkmcnt(1)
 v_mfma_f32_32x32x16_bf16 a[72:87], a[116:119], v[80:83], a[72:87]
 v_exp_f32 v64, v64
 v_exp_f32 v65, v65
 v_cvt_pk_bf16_f32 v86, v60, v61
 v_cvt_pk_bf16_f32 v87, v62, v63
 v_exp_f32 v66, v66
 v_exp_f32 v67, v67
 v_mfma_f32_32x32x16_bf16 v[48:63], a[108:111], a[0:3], v[16:31]
 v_exp_f32 v68, v68
 v_exp_f32 v69, v69
 ds_read_b128 a[124:127], v9 offset:4864
 v_exp_f32 v70, v70
 v_exp_f32 v71, v71
 v_cvt_pk_bf16_f32 v88, v64, v65
 v_cvt_pk_bf16_f32 v89, v66, v67
 v_mfma_f32_32x32x16_bf16 v[48:63], a[140:143], a[24:27], v[48:63]
 v_exp_f32 v72, v72
 v_exp_f32 v73, v73
 ds_read_b128 a[128:131], v9 offset:5472
 v_exp_f32 v74, v74
 v_exp_f32 v75, v75
 v_cvt_pk_bf16_f32 v90, v68, v69
 v_cvt_pk_bf16_f32 v91, v70, v71
 v_mfma_f32_32x32x16_bf16 a[72:87], a[120:123], v[84:87], a[72:87]
 v_exp_f32 v76, v76
 v_exp_f32 v77, v77
 v_exp_f32 v78, v78
 v_exp_f32 v79, v79
 v_cvt_pk_bf16_f32 v92, v72, v73
 v_cvt_pk_bf16_f32 v93, v74, v75
 v_mfma_f32_32x32x16_bf16 a[88:103], a[116:119], v[88:91], a[88:103]
 v_exp_f32 v48, v48
 v_exp_f32 v49, v49
 v_cvt_pk_bf16_f32 v94, v76, v77
 v_cvt_pk_bf16_f32 v95, v78, v79
 v_exp_f32 v50, v50
 v_exp_f32 v51, v51
 v_mfma_f32_32x32x16_bf16 v[64:79], a[108:111], a[4:7], v[32:47]
 v_exp_f32 v52, v52
 v_exp_f32 v53, v53
 ds_read_b128 a[104:107], v5 offset:6144
 v_exp_f32 v54, v54
 v_exp_f32 v55, v55
 v_cvt_pk_bf16_f32 v80, v48, v49
 v_cvt_pk_bf16_f32 v81, v50, v51
 v_mfma_f32_32x32x16_bf16 v[64:79], a[140:143], a[56:59], v[64:79]
 v_exp_f32 v56, v56
 v_exp_f32 v57, v57
 s_add_u32 s30, s87, 81920
 buffer_load_dwordx4 a[212:215], v1, s[4:7], s30 offen sc1
 v_exp_f32 v58, v58
 v_exp_f32 v59, v59
 v_cvt_pk_bf16_f32 v82, v52, v53
 v_cvt_pk_bf16_f32 v83, v54, v55
 v_mfma_f32_32x32x16_bf16 a[88:103], a[120:123], v[92:95], a[88:103]
 v_exp_f32 v60, v60
 v_exp_f32 v61, v61
 v_exp_f32 v62, v62
 v_exp_f32 v63, v63
 v_cvt_pk_bf16_f32 v84, v56, v57
 v_cvt_pk_bf16_f32 v85, v58, v59
 s_waitcnt lgkmcnt(1)
 v_mfma_f32_32x32x16_bf16 a[72:87], a[124:127], v[80:83], a[72:87]
 v_exp_f32 v64, v64
 v_exp_f32 v65, v65
 v_cvt_pk_bf16_f32 v86, v60, v61
 v_cvt_pk_bf16_f32 v87, v62, v63
 v_exp_f32 v66, v66
 v_exp_f32 v67, v67
 v_mfma_f32_32x32x16_bf16 v[48:63], a[112:115], a[0:3], v[16:31]
 v_exp_f32 v68, v68
 v_exp_f32 v69, v69
 ds_read_b128 a[132:135], v9 offset:6080
 v_exp_f32 v70, v70
 v_exp_f32 v71, v71
 v_cvt_pk_bf16_f32 v88, v64, v65
 v_cvt_pk_bf16_f32 v89, v66, v67
 v_mfma_f32_32x32x16_bf16 v[48:63], a[140:143], a[28:31], v[48:63]
 v_exp_f32 v72, v72
 v_exp_f32 v73, v73
 ds_read_b128 a[136:139], v9 offset:6688
 v_exp_f32 v74, v74
 v_exp_f32 v75, v75
 v_cvt_pk_bf16_f32 v90, v68, v69
 v_cvt_pk_bf16_f32 v91, v70, v71
 v_mfma_f32_32x32x16_bf16 a[72:87], a[128:131], v[84:87], a[72:87]
 v_exp_f32 v76, v76
 v_exp_f32 v77, v77
 v_exp_f32 v78, v78
 v_exp_f32 v79, v79
 v_cvt_pk_bf16_f32 v92, v72, v73
 v_cvt_pk_bf16_f32 v93, v74, v75
 v_mfma_f32_32x32x16_bf16 a[88:103], a[124:127], v[88:91], a[88:103]
 v_exp_f32 v48, v48
 v_exp_f32 v49, v49
 v_cvt_pk_bf16_f32 v94, v76, v77
 v_cvt_pk_bf16_f32 v95, v78, v79
 v_exp_f32 v50, v50
 v_exp_f32 v51, v51
 v_mfma_f32_32x32x16_bf16 v[64:79], a[112:115], a[4:7], v[32:47]
 v_exp_f32 v52, v52
 v_exp_f32 v53, v53
 ds_read_b128 a[108:111], v5 offset:7168
 v_exp_f32 v54, v54
 v_exp_f32 v55, v55
 v_cvt_pk_bf16_f32 v80, v48, v49
 v_cvt_pk_bf16_f32 v81, v50, v51
 v_mfma_f32_32x32x16_bf16 v[64:79], a[140:143], a[60:63], v[64:79]
 v_exp_f32 v56, v56
 v_exp_f32 v57, v57
 s_add_u32 s30, s87, 12288
 buffer_load_dwordx4 a[216:219], v1, s[4:7], s30 offen sc1
 v_exp_f32 v58, v58
 v_exp_f32 v59, v59
 v_cvt_pk_bf16_f32 v82, v52, v53
 v_cvt_pk_bf16_f32 v83, v54, v55
 v_mfma_f32_32x32x16_bf16 a[88:103], a[128:131], v[92:95], a[88:103]
 v_exp_f32 v60, v60
 v_exp_f32 v61, v61
 v_exp_f32 v62, v62
 v_exp_f32 v63, v63
 v_cvt_pk_bf16_f32 v84, v56, v57
 v_cvt_pk_bf16_f32 v85, v58, v59
 s_waitcnt lgkmcnt(1)
 v_mfma_f32_32x32x16_bf16 a[72:87], a[132:135], v[80:83], a[72:87]
 v_exp_f32 v64, v64
 v_exp_f32 v65, v65
 v_cvt_pk_bf16_f32 v86, v60, v61
 v_cvt_pk_bf16_f32 v87, v62, v63
 v_exp_f32 v66, v66
 v_exp_f32 v67, v67
 v_mfma_f32_32x32x16_bf16 v[48:63], a[104:107], a[0:3], v[16:31]
 v_exp_f32 v68, v68
 v_exp_f32 v69, v69
 ds_read_b128 a[116:119], v9 offset:7296
 v_exp_f32 v70, v70
 v_exp_f32 v71, v71
 v_cvt_pk_bf16_f32 v88, v64, v65
 v_cvt_pk_bf16_f32 v89, v66, v67
 v_mfma_f32_32x32x16_bf16 v[48:63], a[140:143], a[32:35], v[48:63]
 v_exp_f32 v72, v72
 v_exp_f32 v73, v73
 ds_read_b128 a[120:123], v9 offset:7904
 v_exp_f32 v74, v74
 v_exp_f32 v75, v75
 v_cvt_pk_bf16_f32 v90, v68, v69
 v_cvt_pk_bf16_f32 v91, v70, v71
 v_mfma_f32_32x32x16_bf16 a[72:87], a[136:139], v[84:87], a[72:87]
 v_exp_f32 v76, v76
 v_exp_f32 v77, v77
 v_exp_f32 v78, v78
 v_exp_f32 v79, v79
 v_cvt_pk_bf16_f32 v92, v72, v73
 v_cvt_pk_bf16_f32 v93, v74, v75
 v_mfma_f32_32x32x16_bf16 a[88:103], a[132:135], v[88:91], a[88:103]
 v_exp_f32 v48, v48
 v_exp_f32 v49, v49
 v_cvt_pk_bf16_f32 v94, v76, v77
 v_cvt_pk_bf16_f32 v95, v78, v79
 v_exp_f32 v50, v50
 v_exp_f32 v51, v51
 v_mfma_f32_32x32x16_bf16 v[64:79], a[104:107], a[4:7], v[32:47]
 v_exp_f32 v52, v52
 v_exp_f32 v53, v53
 ds_read_b128 a[112:115], v5 offset:18944
 ds_read_b128 a[144:147], v5 offset:27136
 v_exp_f32 v54, v54
 v_exp_f32 v55, v55
 v_cvt_pk_bf16_f32 v80, v48, v49
 v_cvt_pk_bf16_f32 v81, v50, v51
 v_mfma_f32_32x32x16_bf16 v[64:79], a[140:143], a[64:67], v[64:79]
 v_exp_f32 v56, v56
 v_exp_f32 v57, v57
 s_add_u32 s30, s87, 30720
 buffer_load_dwordx4 a[220:223], v1, s[4:7], s30 offen sc1
 v_exp_f32 v58, v58
 v_exp_f32 v59, v59
 v_cvt_pk_bf16_f32 v82, v52, v53
 v_cvt_pk_bf16_f32 v83, v54, v55
 v_mfma_f32_32x32x16_bf16 a[88:103], a[136:139], v[92:95], a[88:103]
 v_exp_f32 v60, v60
 v_exp_f32 v61, v61
 v_exp_f32 v62, v62
 v_exp_f32 v63, v63
 v_cvt_pk_bf16_f32 v84, v56, v57
 v_cvt_pk_bf16_f32 v85, v58, v59
 s_waitcnt lgkmcnt(2)
 v_mfma_f32_32x32x16_bf16 a[72:87], a[116:119], v[80:83], a[72:87]
 v_exp_f32 v64, v64
 v_exp_f32 v65, v65
 v_cvt_pk_bf16_f32 v86, v60, v61
 v_cvt_pk_bf16_f32 v87, v62, v63
 v_exp_f32 v66, v66
 v_exp_f32 v67, v67
 v_mfma_f32_32x32x16_bf16 v[48:63], a[108:111], a[0:3], v[16:31]
 v_exp_f32 v68, v68
 v_exp_f32 v69, v69
 ds_read_b128 a[124:127], v9 offset:8512
 v_exp_f32 v70, v70
 v_exp_f32 v71, v71
 v_cvt_pk_bf16_f32 v88, v64, v65
 v_cvt_pk_bf16_f32 v89, v66, v67
 v_mfma_f32_32x32x16_bf16 v[48:63], a[140:143], a[36:39], v[48:63]
 v_exp_f32 v72, v72
 v_exp_f32 v73, v73
 ds_read_b128 a[128:131], v9 offset:9120
 v_exp_f32 v74, v74
 v_exp_f32 v75, v75
 v_cvt_pk_bf16_f32 v90, v68, v69
 v_cvt_pk_bf16_f32 v91, v70, v71
 v_mfma_f32_32x32x16_bf16 a[72:87], a[120:123], v[84:87], a[72:87]
 v_exp_f32 v76, v76
 v_exp_f32 v77, v77
 v_exp_f32 v78, v78
 v_exp_f32 v79, v79
 v_cvt_pk_bf16_f32 v92, v72, v73
 v_cvt_pk_bf16_f32 v93, v74, v75
 v_mfma_f32_32x32x16_bf16 a[88:103], a[116:119], v[88:91], a[88:103]
 v_exp_f32 v48, v48
 v_exp_f32 v49, v49
 v_cvt_pk_bf16_f32 v94, v76, v77
 v_cvt_pk_bf16_f32 v95, v78, v79
 v_exp_f32 v50, v50
 v_exp_f32 v51, v51
 v_mfma_f32_32x32x16_bf16 v[64:79], a[108:111], a[4:7], v[32:47]
 v_exp_f32 v52, v52
 v_exp_f32 v53, v53
 ds_read_b128 a[104:107], v5 offset:19968
 v_exp_f32 v54, v54
 v_exp_f32 v55, v55
 v_cvt_pk_bf16_f32 v80, v48, v49
 v_cvt_pk_bf16_f32 v81, v50, v51
 v_mfma_f32_32x32x16_bf16 v[64:79], a[140:143], a[68:71], v[64:79]
 v_exp_f32 v56, v56
 v_exp_f32 v57, v57
 s_add_u32 s30, s87, 49152
 buffer_load_dwordx4 a[224:227], v1, s[4:7], s30 offen sc1
 v_exp_f32 v58, v58
 v_exp_f32 v59, v59
 v_cvt_pk_bf16_f32 v82, v52, v53
 v_cvt_pk_bf16_f32 v83, v54, v55
 v_mfma_f32_32x32x16_bf16 a[88:103], a[120:123], v[92:95], a[88:103]
 v_exp_f32 v60, v60
 v_exp_f32 v61, v61
 v_exp_f32 v62, v62
 v_exp_f32 v63, v63
 v_cvt_pk_bf16_f32 v84, v56, v57
 v_cvt_pk_bf16_f32 v85, v58, v59
 s_waitcnt lgkmcnt(1)
 v_mfma_f32_32x32x16_bf16 a[72:87], a[124:127], v[80:83], a[72:87]
 v_exp_f32 v64, v64
 v_exp_f32 v65, v65
 v_cvt_pk_bf16_f32 v86, v60, v61
 v_cvt_pk_bf16_f32 v87, v62, v63
 v_exp_f32 v66, v66
 v_exp_f32 v67, v67
 v_mfma_f32_32x32x16_bf16 v[48:63], a[112:115], a[0:3], v[16:31]
 v_exp_f32 v68, v68
 v_exp_f32 v69, v69
 ds_read_b128 a[132:135], v9 offset:18944
 v_exp_f32 v70, v70
 v_exp_f32 v71, v71
 v_cvt_pk_bf16_f32 v88, v64, v65
 v_cvt_pk_bf16_f32 v89, v66, v67
 v_mfma_f32_32x32x16_bf16 v[48:63], a[144:147], a[8:11], v[48:63]
 v_exp_f32 v72, v72
 v_exp_f32 v73, v73
 ds_read_b128 a[136:139], v9 offset:19552
 v_exp_f32 v74, v74
 v_exp_f32 v75, v75
 v_cvt_pk_bf16_f32 v90, v68, v69
 v_cvt_pk_bf16_f32 v91, v70, v71
 v_mfma_f32_32x32x16_bf16 a[72:87], a[128:131], v[84:87], a[72:87]
 v_exp_f32 v76, v76
 v_exp_f32 v77, v77
 v_exp_f32 v78, v78
 v_exp_f32 v79, v79
 v_cvt_pk_bf16_f32 v92, v72, v73
 v_cvt_pk_bf16_f32 v93, v74, v75
 v_mfma_f32_32x32x16_bf16 a[88:103], a[124:127], v[88:91], a[88:103]
 v_exp_f32 v48, v48
 v_exp_f32 v49, v49
 v_cvt_pk_bf16_f32 v94, v76, v77
 v_cvt_pk_bf16_f32 v95, v78, v79
 v_exp_f32 v50, v50
 v_exp_f32 v51, v51
 v_mfma_f32_32x32x16_bf16 v[64:79], a[112:115], a[4:7], v[32:47]
 v_exp_f32 v52, v52
 v_exp_f32 v53, v53
 ds_read_b128 a[108:111], v5 offset:20992
 v_exp_f32 v54, v54
 v_exp_f32 v55, v55
 v_cvt_pk_bf16_f32 v80, v48, v49
 v_cvt_pk_bf16_f32 v81, v50, v51
 v_mfma_f32_32x32x16_bf16 v[64:79], a[144:147], a[40:43], v[64:79]
 v_exp_f32 v56, v56
 v_exp_f32 v57, v57
 s_add_u32 s30, s87, 67584
 buffer_load_dwordx4 a[228:231], v1, s[4:7], s30 offen sc1
 v_exp_f32 v58, v58
 v_exp_f32 v59, v59
 v_cvt_pk_bf16_f32 v82, v52, v53
 v_cvt_pk_bf16_f32 v83, v54, v55
 v_mfma_f32_32x32x16_bf16 a[88:103], a[128:131], v[92:95], a[88:103]
 v_exp_f32 v60, v60
 v_exp_f32 v61, v61
 v_exp_f32 v62, v62
 v_exp_f32 v63, v63
 v_cvt_pk_bf16_f32 v84, v56, v57
 v_cvt_pk_bf16_f32 v85, v58, v59
 s_waitcnt lgkmcnt(1)
 v_mfma_f32_32x32x16_bf16 a[72:87], a[132:135], v[80:83], a[72:87]
 v_exp_f32 v64, v64
 v_exp_f32 v65, v65
 v_cvt_pk_bf16_f32 v86, v60, v61
 v_cvt_pk_bf16_f32 v87, v62, v63
 v_exp_f32 v66, v66
 v_exp_f32 v67, v67
 v_mfma_f32_32x32x16_bf16 v[48:63], a[104:107], a[0:3], v[16:31]
 v_exp_f32 v68, v68
 v_exp_f32 v69, v69
 ds_read_b128 a[116:119], v9 offset:20160
 v_exp_f32 v70, v70
 v_exp_f32 v71, v71
 v_cvt_pk_bf16_f32 v88, v64, v65
 v_cvt_pk_bf16_f32 v89, v66, v67
 v_mfma_f32_32x32x16_bf16 v[48:63], a[144:147], a[12:15], v[48:63]
 v_exp_f32 v72, v72
 v_exp_f32 v73, v73
 ds_read_b128 a[120:123], v9 offset:20768
 v_exp_f32 v74, v74
 v_exp_f32 v75, v75
 v_cvt_pk_bf16_f32 v90, v68, v69
 v_cvt_pk_bf16_f32 v91, v70, v71
 v_mfma_f32_32x32x16_bf16 a[72:87], a[136:139], v[84:87], a[72:87]
 v_exp_f32 v76, v76
 v_exp_f32 v77, v77
 v_exp_f32 v78, v78
 v_exp_f32 v79, v79
 v_cvt_pk_bf16_f32 v92, v72, v73
 v_cvt_pk_bf16_f32 v93, v74, v75
 v_mfma_f32_32x32x16_bf16 a[88:103], a[132:135], v[88:91], a[88:103]
 v_exp_f32 v48, v48
 v_exp_f32 v49, v49
 v_cvt_pk_bf16_f32 v94, v76, v77
 v_cvt_pk_bf16_f32 v95, v78, v79
 v_exp_f32 v50, v50
 v_exp_f32 v51, v51
 v_mfma_f32_32x32x16_bf16 v[64:79], a[104:107], a[4:7], v[32:47]
 v_exp_f32 v52, v52
 v_exp_f32 v53, v53
 ds_read_b128 a[112:115], v5 offset:22016
 v_exp_f32 v54, v54
 v_exp_f32 v55, v55
 v_cvt_pk_bf16_f32 v80, v48, v49
 v_cvt_pk_bf16_f32 v81, v50, v51
 v_mfma_f32_32x32x16_bf16 v[64:79], a[144:147], a[44:47], v[64:79]
 v_exp_f32 v56, v56
 v_exp_f32 v57, v57
 s_add_u32 s30, s87, 86016
 buffer_load_dwordx4 a[232:235], v1, s[4:7], s30 offen sc1
 v_exp_f32 v58, v58
 v_exp_f32 v59, v59
 v_cvt_pk_bf16_f32 v82, v52, v53
 v_cvt_pk_bf16_f32 v83, v54, v55
 v_mfma_f32_32x32x16_bf16 a[88:103], a[136:139], v[92:95], a[88:103]
 v_exp_f32 v60, v60
 v_exp_f32 v61, v61
 v_exp_f32 v62, v62
 v_exp_f32 v63, v63
 v_cvt_pk_bf16_f32 v84, v56, v57
 v_cvt_pk_bf16_f32 v85, v58, v59
 s_waitcnt lgkmcnt(1)
 v_mfma_f32_32x32x16_bf16 a[72:87], a[116:119], v[80:83], a[72:87]
 v_exp_f32 v64, v64
 v_exp_f32 v65, v65
 v_cvt_pk_bf16_f32 v86, v60, v61
 v_cvt_pk_bf16_f32 v87, v62, v63
 v_exp_f32 v66, v66
 v_exp_f32 v67, v67
 v_mfma_f32_32x32x16_bf16 v[48:63], a[108:111], a[0:3], v[16:31]
 v_exp_f32 v68, v68
 v_exp_f32 v69, v69
 ds_read_b128 a[124:127], v9 offset:21376
 v_exp_f32 v70, v70
 v_exp_f32 v71, v71
 v_cvt_pk_bf16_f32 v88, v64, v65
 v_cvt_pk_bf16_f32 v89, v66, v67
 v_mfma_f32_32x32x16_bf16 v[48:63], a[144:147], a[16:19], v[48:63]
 v_exp_f32 v72, v72
 v_exp_f32 v73, v73
 ds_read_b128 a[128:131], v9 offset:21984
 v_exp_f32 v74, v74
 v_exp_f32 v75, v75
 v_cvt_pk_bf16_f32 v90, v68, v69
 v_cvt_pk_bf16_f32 v91, v70, v71
 v_mfma_f32_32x32x16_bf16 a[72:87], a[120:123], v[84:87], a[72:87]
 v_exp_f32 v76, v76
 v_exp_f32 v77, v77
 v_exp_f32 v78, v78
 v_exp_f32 v79, v79
 v_cvt_pk_bf16_f32 v92, v72, v73
 v_cvt_pk_bf16_f32 v93, v74, v75
 v_mfma_f32_32x32x16_bf16 a[88:103], a[116:119], v[88:91], a[88:103]
 v_exp_f32 v48, v48
 v_exp_f32 v49, v49
 v_cvt_pk_bf16_f32 v94, v76, v77
 v_cvt_pk_bf16_f32 v95, v78, v79
 v_exp_f32 v50, v50
 v_exp_f32 v51, v51
 v_mfma_f32_32x32x16_bf16 v[64:79], a[108:111], a[4:7], v[32:47]
 v_exp_f32 v52, v52
 v_exp_f32 v53, v53
 ds_read_b128 a[104:107], v5 offset:23040
 v_exp_f32 v54, v54
 v_exp_f32 v55, v55
 v_cvt_pk_bf16_f32 v80, v48, v49
 v_cvt_pk_bf16_f32 v81, v50, v51
 v_mfma_f32_32x32x16_bf16 v[64:79], a[144:147], a[48:51], v[64:79]
 v_exp_f32 v56, v56
 v_exp_f32 v57, v57
 s_add_u32 s30, s87, 16384
 buffer_load_dwordx4 a[236:239], v1, s[4:7], s30 offen sc1
 v_exp_f32 v58, v58
 v_exp_f32 v59, v59
 v_cvt_pk_bf16_f32 v82, v52, v53
 v_cvt_pk_bf16_f32 v83, v54, v55
 v_mfma_f32_32x32x16_bf16 a[88:103], a[120:123], v[92:95], a[88:103]
 v_exp_f32 v60, v60
 v_exp_f32 v61, v61
 v_exp_f32 v62, v62
 v_exp_f32 v63, v63
 v_cvt_pk_bf16_f32 v84, v56, v57
 v_cvt_pk_bf16_f32 v85, v58, v59
 s_waitcnt lgkmcnt(1)
 v_mfma_f32_32x32x16_bf16 a[72:87], a[124:127], v[80:83], a[72:87]
 v_exp_f32 v64, v64
 v_exp_f32 v65, v65
 v_cvt_pk_bf16_f32 v86, v60, v61
 v_cvt_pk_bf16_f32 v87, v62, v63
 v_exp_f32 v66, v66
 v_exp_f32 v67, v67
 v_mfma_f32_32x32x16_bf16 v[48:63], a[112:115], a[0:3], v[16:31]
 v_exp_f32 v68, v68
 v_exp_f32 v69, v69
 ds_read_b128 a[132:135], v9 offset:22592
 v_exp_f32 v70, v70
 v_exp_f32 v71, v71
 v_cvt_pk_bf16_f32 v88, v64, v65
 v_cvt_pk_bf16_f32 v89, v66, v67
 v_mfma_f32_32x32x16_bf16 v[48:63], a[144:147], a[20:23], v[48:63]
 v_exp_f32 v72, v72
 v_exp_f32 v73, v73
 ds_read_b128 a[136:139], v9 offset:23200
 v_exp_f32 v74, v74
 v_exp_f32 v75, v75
 v_cvt_pk_bf16_f32 v90, v68, v69
 v_cvt_pk_bf16_f32 v91, v70, v71
 v_mfma_f32_32x32x16_bf16 a[72:87], a[128:131], v[84:87], a[72:87]
 v_exp_f32 v76, v76
 v_exp_f32 v77, v77
 v_exp_f32 v78, v78
 v_exp_f32 v79, v79
 v_cvt_pk_bf16_f32 v92, v72, v73
 v_cvt_pk_bf16_f32 v93, v74, v75
 v_mfma_f32_32x32x16_bf16 a[88:103], a[124:127], v[88:91], a[88:103]
 v_exp_f32 v48, v48
 v_exp_f32 v49, v49
 v_cvt_pk_bf16_f32 v94, v76, v77
 v_cvt_pk_bf16_f32 v95, v78, v79
 v_exp_f32 v50, v50
 v_exp_f32 v51, v51
 v_mfma_f32_32x32x16_bf16 v[64:79], a[112:115], a[4:7], v[32:47]
 v_exp_f32 v52, v52
 v_exp_f32 v53, v53
 ds_read_b128 a[108:111], v5 offset:24064
 v_exp_f32 v54, v54
 v_exp_f32 v55, v55
 v_cvt_pk_bf16_f32 v80, v48, v49
 v_cvt_pk_bf16_f32 v81, v50, v51
 v_mfma_f32_32x32x16_bf16 v[64:79], a[144:147], a[52:55], v[64:79]
 v_exp_f32 v56, v56
 v_exp_f32 v57, v57
 s_add_u32 s30, s87, 34816
 buffer_load_dwordx4 a[240:243], v1, s[4:7], s30 offen sc1
 v_exp_f32 v58, v58
 v_exp_f32 v59, v59
 v_cvt_pk_bf16_f32 v82, v52, v53
 v_cvt_pk_bf16_f32 v83, v54, v55
 v_mfma_f32_32x32x16_bf16 a[88:103], a[128:131], v[92:95], a[88:103]
 v_exp_f32 v60, v60
 v_exp_f32 v61, v61
 v_exp_f32 v62, v62
 v_exp_f32 v63, v63
 v_cvt_pk_bf16_f32 v84, v56, v57
 v_cvt_pk_bf16_f32 v85, v58, v59
 s_waitcnt lgkmcnt(1)
 v_mfma_f32_32x32x16_bf16 a[72:87], a[132:135], v[80:83], a[72:87]
 v_exp_f32 v64, v64
 v_exp_f32 v65, v65
 v_cvt_pk_bf16_f32 v86, v60, v61
 v_cvt_pk_bf16_f32 v87, v62, v63
 v_exp_f32 v66, v66
 v_exp_f32 v67, v67
 v_mfma_f32_32x32x16_bf16 v[48:63], a[104:107], a[0:3], v[16:31]
 v_exp_f32 v68, v68
 v_exp_f32 v69, v69
 ds_read_b128 a[116:119], v9 offset:23808
 v_exp_f32 v70, v70
 v_exp_f32 v71, v71
 v_cvt_pk_bf16_f32 v88, v64, v65
 v_cvt_pk_bf16_f32 v89, v66, v67
 v_mfma_f32_32x32x16_bf16 v[48:63], a[144:147], a[24:27], v[48:63]
 v_exp_f32 v72, v72
 v_exp_f32 v73, v73
 ds_read_b128 a[120:123], v9 offset:24416
 v_exp_f32 v74, v74
 v_exp_f32 v75, v75
 v_cvt_pk_bf16_f32 v90, v68, v69
 v_cvt_pk_bf16_f32 v91, v70, v71
 v_mfma_f32_32x32x16_bf16 a[72:87], a[136:139], v[84:87], a[72:87]
 v_exp_f32 v76, v76
 v_exp_f32 v77, v77
 v_exp_f32 v78, v78
 v_exp_f32 v79, v79
 v_cvt_pk_bf16_f32 v92, v72, v73
 v_cvt_pk_bf16_f32 v93, v74, v75
 v_mfma_f32_32x32x16_bf16 a[88:103], a[132:135], v[88:91], a[88:103]
 v_exp_f32 v48, v48
 v_exp_f32 v49, v49
 v_cvt_pk_bf16_f32 v94, v76, v77
 v_cvt_pk_bf16_f32 v95, v78, v79
 v_exp_f32 v50, v50
 v_exp_f32 v51, v51
 v_mfma_f32_32x32x16_bf16 v[64:79], a[104:107], a[4:7], v[32:47]
 v_exp_f32 v52, v52
 v_exp_f32 v53, v53
 ds_read_b128 a[112:115], v5 offset:25088
 v_exp_f32 v54, v54
 v_exp_f32 v55, v55
 v_cvt_pk_bf16_f32 v80, v48, v49
 v_cvt_pk_bf16_f32 v81, v50, v51
 v_mfma_f32_32x32x16_bf16 v[64:79], a[144:147], a[56:59], v[64:79]
 v_exp_f32 v56, v56
 v_exp_f32 v57, v57
 s_add_u32 s30, s87, 53248
 buffer_load_dwordx4 a[244:247], v1, s[4:7], s30 offen sc1
 v_exp_f32 v58, v58
 v_exp_f32 v59, v59
 v_cvt_pk_bf16_f32 v82, v52, v53
 v_cvt_pk_bf16_f32 v83, v54, v55
 v_mfma_f32_32x32x16_bf16 a[88:103], a[136:139], v[92:95], a[88:103]
 v_exp_f32 v60, v60
 v_exp_f32 v61, v61
 v_exp_f32 v62, v62
 v_exp_f32 v63, v63
 v_cvt_pk_bf16_f32 v84, v56, v57
 v_cvt_pk_bf16_f32 v85, v58, v59
 s_waitcnt lgkmcnt(1)
 v_mfma_f32_32x32x16_bf16 a[72:87], a[116:119], v[80:83], a[72:87]
 v_exp_f32 v64, v64
 v_exp_f32 v65, v65
 v_cvt_pk_bf16_f32 v86, v60, v61
 v_cvt_pk_bf16_f32 v87, v62, v63
 v_exp_f32 v66, v66
 v_exp_f32 v67, v67
 v_mfma_f32_32x32x16_bf16 v[48:63], a[108:111], a[0:3], v[16:31]
 v_exp_f32 v68, v68
 v_exp_f32 v69, v69
 ds_read_b128 a[124:127], v9 offset:25024
 v_exp_f32 v70, v70
 v_exp_f32 v71, v71
 v_cvt_pk_bf16_f32 v88, v64, v65
 v_cvt_pk_bf16_f32 v89, v66, v67
 v_mfma_f32_32x32x16_bf16 v[48:63], a[144:147], a[28:31], v[48:63]
 v_exp_f32 v72, v72
 v_exp_f32 v73, v73
 ds_read_b128 a[128:131], v9 offset:25632
 v_exp_f32 v74, v74
 v_exp_f32 v75, v75
 v_cvt_pk_bf16_f32 v90, v68, v69
 v_cvt_pk_bf16_f32 v91, v70, v71
 v_mfma_f32_32x32x16_bf16 a[72:87], a[120:123], v[84:87], a[72:87]
 v_exp_f32 v76, v76
 v_exp_f32 v77, v77
 v_exp_f32 v78, v78
 v_exp_f32 v79, v79
 v_cvt_pk_bf16_f32 v92, v72, v73
 v_cvt_pk_bf16_f32 v93, v74, v75
 v_mfma_f32_32x32x16_bf16 a[88:103], a[116:119], v[88:91], a[88:103]
 v_exp_f32 v48, v48
 v_exp_f32 v49, v49
 v_cvt_pk_bf16_f32 v94, v76, v77
 v_cvt_pk_bf16_f32 v95, v78, v79
 v_exp_f32 v50, v50
 v_exp_f32 v51, v51
 v_mfma_f32_32x32x16_bf16 v[64:79], a[108:111], a[4:7], v[32:47]
 v_exp_f32 v52, v52
 v_exp_f32 v53, v53
 ds_read_b128 a[104:107], v5 offset:26112
 v_exp_f32 v54, v54
 v_exp_f32 v55, v55
 v_cvt_pk_bf16_f32 v80, v48, v49
 v_cvt_pk_bf16_f32 v81, v50, v51
 v_mfma_f32_32x32x16_bf16 v[64:79], a[144:147], a[60:63], v[64:79]
 v_exp_f32 v56, v56
 v_exp_f32 v57, v57
 s_add_u32 s30, s87, 71680
 buffer_load_dwordx4 a[248:251], v1, s[4:7], s30 offen sc1
 v_exp_f32 v58, v58
 v_exp_f32 v59, v59
 v_cvt_pk_bf16_f32 v82, v52, v53
 v_cvt_pk_bf16_f32 v83, v54, v55
 v_mfma_f32_32x32x16_bf16 a[88:103], a[120:123], v[92:95], a[88:103]
 v_exp_f32 v60, v60
 v_exp_f32 v61, v61
 v_exp_f32 v62, v62
 v_exp_f32 v63, v63
 v_cvt_pk_bf16_f32 v84, v56, v57
 v_cvt_pk_bf16_f32 v85, v58, v59
 s_waitcnt lgkmcnt(1)
 v_mfma_f32_32x32x16_bf16 a[72:87], a[124:127], v[80:83], a[72:87]
 v_exp_f32 v64, v64
 v_exp_f32 v65, v65
 v_cvt_pk_bf16_f32 v86, v60, v61
 v_cvt_pk_bf16_f32 v87, v62, v63
 v_exp_f32 v66, v66
 v_exp_f32 v67, v67
 v_mfma_f32_32x32x16_bf16 v[48:63], a[112:115], a[0:3], v[16:31]
 v_exp_f32 v68, v68
 v_exp_f32 v69, v69
 ds_read_b128 a[132:135], v9 offset:26240
 v_exp_f32 v70, v70
 v_exp_f32 v71, v71
 v_cvt_pk_bf16_f32 v88, v64, v65
 v_cvt_pk_bf16_f32 v89, v66, v67
 v_mfma_f32_32x32x16_bf16 v[48:63], a[144:147], a[32:35], v[48:63]
 v_exp_f32 v72, v72
 v_exp_f32 v73, v73
 ds_read_b128 a[136:139], v9 offset:26848
 v_exp_f32 v74, v74
 v_exp_f32 v75, v75
 v_cvt_pk_bf16_f32 v90, v68, v69
 v_cvt_pk_bf16_f32 v91, v70, v71
 v_mfma_f32_32x32x16_bf16 a[72:87], a[128:131], v[84:87], a[72:87]
 v_exp_f32 v76, v76
 v_exp_f32 v77, v77
 v_exp_f32 v78, v78
 v_exp_f32 v79, v79
 v_cvt_pk_bf16_f32 v92, v72, v73
 v_cvt_pk_bf16_f32 v93, v74, v75
 v_mfma_f32_32x32x16_bf16 a[88:103], a[124:127], v[88:91], a[88:103]
 v_exp_f32 v48, v48
 v_exp_f32 v49, v49
 v_cvt_pk_bf16_f32 v94, v76, v77
 v_cvt_pk_bf16_f32 v95, v78, v79
 v_exp_f32 v50, v50
 v_exp_f32 v51, v51
 v_mfma_f32_32x32x16_bf16 v[64:79], a[112:115], a[4:7], v[32:47]
 v_exp_f32 v52, v52
 v_exp_f32 v53, v53
 v_exp_f32 v54, v54
 v_exp_f32 v55, v55
 v_cvt_pk_bf16_f32 v80, v48, v49
 v_cvt_pk_bf16_f32 v81, v50, v51
 v_mfma_f32_32x32x16_bf16 v[64:79], a[144:147], a[64:67], v[64:79]
 v_exp_f32 v56, v56
 v_exp_f32 v57, v57
 s_add_u32 s30, s87, 90112
 buffer_load_dwordx4 a[252:255], v1, s[4:7], s30 offen sc1
 v_exp_f32 v58, v58
 v_exp_f32 v59, v59
 v_cvt_pk_bf16_f32 v82, v52, v53
 v_cvt_pk_bf16_f32 v83, v54, v55
 v_mfma_f32_32x32x16_bf16 a[88:103], a[128:131], v[92:95], a[88:103]
 v_exp_f32 v60, v60
 v_exp_f32 v61, v61
 v_exp_f32 v62, v62
 v_exp_f32 v63, v63
 v_cvt_pk_bf16_f32 v84, v56, v57
 v_cvt_pk_bf16_f32 v85, v58, v59
 s_waitcnt lgkmcnt(0)
 v_mfma_f32_32x32x16_bf16 a[72:87], a[132:135], v[80:83], a[72:87]
 v_exp_f32 v64, v64
 v_exp_f32 v65, v65
 v_cvt_pk_bf16_f32 v86, v60, v61
 v_cvt_pk_bf16_f32 v87, v62, v63
 v_exp_f32 v66, v66
 v_exp_f32 v67, v67
 v_mfma_f32_32x32x16_bf16 v[48:63], a[104:107], a[0:3], v[16:31]
 v_exp_f32 v68, v68
 v_exp_f32 v69, v69
 ds_read_b128 a[116:119], v9 offset:27456
 v_exp_f32 v70, v70
 v_exp_f32 v71, v71
 v_cvt_pk_bf16_f32 v88, v64, v65
 v_cvt_pk_bf16_f32 v89, v66, v67
 v_mfma_f32_32x32x16_bf16 v[48:63], a[144:147], a[36:39], v[48:63]
 v_exp_f32 v72, v72
 v_exp_f32 v73, v73
 ds_read_b128 a[120:123], v9 offset:28064
 v_exp_f32 v74, v74
 v_exp_f32 v75, v75
 v_cvt_pk_bf16_f32 v90, v68, v69
 v_cvt_pk_bf16_f32 v91, v70, v71
 v_mfma_f32_32x32x16_bf16 a[72:87], a[136:139], v[84:87], a[72:87]
 v_exp_f32 v76, v76
 v_exp_f32 v77, v77
 v_exp_f32 v78, v78
 v_exp_f32 v79, v79
 v_cvt_pk_bf16_f32 v92, v72, v73
 v_cvt_pk_bf16_f32 v93, v74, v75
 v_mfma_f32_32x32x16_bf16 a[88:103], a[132:135], v[88:91], a[88:103]
 v_exp_f32 v48, v48
 v_exp_f32 v49, v49
 v_cvt_pk_bf16_f32 v94, v76, v77
 v_cvt_pk_bf16_f32 v95, v78, v79
 v_exp_f32 v50, v50
 v_exp_f32 v51, v51
 v_mfma_f32_32x32x16_bf16 v[64:79], a[104:107], a[4:7], v[32:47]
 v_exp_f32 v52, v52
 v_exp_f32 v53, v53
 v_exp_f32 v54, v54
 v_exp_f32 v55, v55
 v_cvt_pk_bf16_f32 v80, v48, v49
 v_cvt_pk_bf16_f32 v81, v50, v51
 v_mfma_f32_32x32x16_bf16 v[64:79], a[144:147], a[68:71], v[64:79]
 v_exp_f32 v56, v56
 v_exp_f32 v57, v57
 v_exp_f32 v58, v58
 v_exp_f32 v59, v59
 v_cvt_pk_bf16_f32 v82, v52, v53
 v_cvt_pk_bf16_f32 v83, v54, v55
 v_mfma_f32_32x32x16_bf16 a[88:103], a[136:139], v[92:95], a[88:103]
 v_exp_f32 v60, v60
 v_exp_f32 v61, v61
 v_exp_f32 v62, v62
 v_exp_f32 v63, v63
 v_cvt_pk_bf16_f32 v84, v56, v57
 v_cvt_pk_bf16_f32 v85, v58, v59
 s_waitcnt lgkmcnt(0)
 v_mfma_f32_32x32x16_bf16 a[72:87], a[116:119], v[80:83], a[72:87]
 v_exp_f32 v64, v64
 v_exp_f32 v65, v65
 v_cvt_pk_bf16_f32 v86, v60, v61
 v_cvt_pk_bf16_f32 v87, v62, v63
 v_exp_f32 v66, v66
 v_exp_f32 v67, v67
 v_exp_f32 v68, v68
 v_exp_f32 v69, v69
 v_exp_f32 v70, v70
 v_exp_f32 v71, v71
 v_cvt_pk_bf16_f32 v88, v64, v65
 v_cvt_pk_bf16_f32 v89, v66, v67
 v_exp_f32 v72, v72
 v_exp_f32 v73, v73
 v_exp_f32 v74, v74
 v_exp_f32 v75, v75
 v_cvt_pk_bf16_f32 v90, v68, v69
 v_cvt_pk_bf16_f32 v91, v70, v71
 v_mfma_f32_32x32x16_bf16 a[72:87], a[120:123], v[84:87], a[72:87]
 v_exp_f32 v76, v76
 v_exp_f32 v77, v77
 v_exp_f32 v78, v78
 v_exp_f32 v79, v79
 v_cvt_pk_bf16_f32 v92, v72, v73
 v_cvt_pk_bf16_f32 v93, v74, v75
 v_cvt_pk_bf16_f32 v94, v76, v77
 v_cvt_pk_bf16_f32 v95, v78, v79
 v_mfma_f32_32x32x16_bf16 a[88:103], a[116:119], v[88:91], a[88:103]
 s_nop 0
 v_mfma_f32_32x32x16_bf16 a[88:103], a[120:123], v[92:95], a[88:103]
 s_nop 0
 v_accvgpr_read_b32 v48, a72
 v_accvgpr_read_b32 v49, a73
 v_accvgpr_read_b32 v50, a74
 v_accvgpr_read_b32 v51, a75
 v_accvgpr_read_b32 v52, a76
 v_accvgpr_read_b32 v53, a77
 v_accvgpr_read_b32 v54, a78
 v_accvgpr_read_b32 v55, a79
 v_accvgpr_read_b32 v56, a80
 v_accvgpr_read_b32 v57, a81
 v_accvgpr_read_b32 v58, a82
 v_accvgpr_read_b32 v64, a88
 v_accvgpr_read_b32 v65, a89
 v_accvgpr_read_b32 v66, a90
 v_accvgpr_read_b32 v67, a91
 v_accvgpr_read_b32 v68, a92
 v_accvgpr_read_b32 v69, a93
 v_accvgpr_read_b32 v70, a94
 v_accvgpr_read_b32 v71, a95
 v_accvgpr_read_b32 v72, a96
 v_accvgpr_read_b32 v73, a97
 v_accvgpr_read_b32 v74, a98
 s_mov_b32 s30, 0x5d800000
 v_max_f32 v96, v58, v74
 v_cmp_gt_f32 vcc, s30, v58
 v_cmp_gt_f32 s[32:33], s30, v74
 s_nop 0
 s_and_b64 vcc, vcc, s[32:33]
 s_cmp_eq_u64 vcc, -1
 s_cbranch_scc1 ATB_OUT
 s_mov_b32 s31, 0
 v_mov_b32 v100, 0xff800000
 v_mov_b32 v101, 0xff800000
 v_mov_b32 v104, v2
ATB_F1:
 ds_read_b128 a[140:143], v104 offset:8192
 ds_read_b128 a[104:107], v104 offset:0
 s_waitcnt lgkmcnt(0)
 v_mfma_f32_32x32x16_bf16 v[48:63], a[104:107], a[0:3], 0
 v_mfma_f32_32x32x16_bf16 v[48:63], a[140:143], a[8:11], v[48:63]
 v_mfma_f32_32x32x16_bf16 v[64:79], a[104:107], a[4:7], 0
 v_mfma_f32_32x32x16_bf16 v[64:79], a[140:143], a[40:43], v[64:79]
 s_nop 9
 v_max3_f32 v100, v100, v48, v49
 v_max3_f32 v100, v100, v50, v51
 v_max3_f32 v100, v100, v52, v53
 v_max3_f32 v100, v100, v54, v55
 v_max3_f32 v100, v100, v56, v57
 v_max3_f32 v100, v100, v58, v59
 v_max3_f32 v100, v100, v60, v61
 v_max3_f32 v100, v100, v62, v63
 v_max3_f32 v101, v101, v64, v65
 v_max3_f32 v101, v101, v66, v67
 v_max3_f32 v101, v101, v68, v69
 v_max3_f32 v101, v101, v70, v71
 v_max3_f32 v101, v101, v72, v73
 v_max3_f32 v101, v101, v74, v75
 v_max3_f32 v101, v101, v76, v77
 v_max3_f32 v101, v101, v78, v79
 ds_read_b128 a[104:107], v104 offset:1024
 s_waitcnt lgkmcnt(0)
 v_mfma_f32_32x32x16_bf16 v[48:63], a[104:107], a[0:3], 0
 v_mfma_f32_32x32x16_bf16 v[48:63], a[140:143], a[12:15], v[48:63]
 v_mfma_f32_32x32x16_bf16 v[64:79], a[104:107], a[4:7], 0
 v_mfma_f32_32x32x16_bf16 v[64:79], a[140:143], a[44:47], v[64:79]
 s_nop 9
 v_max3_f32 v100, v100, v48, v49
 v_max3_f32 v100, v100, v50, v51
 v_max3_f32 v100, v100, v52, v53
 v_max3_f32 v100, v100, v54, v55
 v_max3_f32 v100, v100, v56, v57
 v_max3_f32 v100, v100, v58, v59
 v_max3_f32 v100, v100, v60, v61
 v_max3_f32 v100, v100, v62, v63
 v_max3_f32 v101, v101, v64, v65
 v_max3_f32 v101, v101, v66, v67
 v_max3_f32 v101, v101, v68, v69
 v_max3_f32 v101, v101, v70, v71
 v_max3_f32 v101, v101, v72, v73
 v_max3_f32 v101, v101, v74, v75
 v_max3_f32 v101, v101, v76, v77
 v_max3_f32 v101, v101, v78, v79
 ds_read_b128 a[104:107], v104 offset:2048
 s_waitcnt lgkmcnt(0)
 v_mfma_f32_32x32x16_bf16 v[48:63], a[104:107], a[0:3], 0
 v_mfma_f32_32x32x16_bf16 v[48:63], a[140:143], a[16:19], v[48:63]
 v_mfma_f32_32x32x16_bf16 v[64:79], a[104:107], a[4:7], 0
 v_mfma_f32_32x32x16_bf16 v[64:79], a[140:143], a[48:51], v[64:79]
 s_nop 9
 v_max3_f32 v100, v100, v48, v49
 v_max3_f32 v100, v100, v50, v51
 v_max3_f32 v100, v100, v52, v53
 v_max3_f32 v100, v100, v54, v55
 v_max3_f32 v100, v100, v56, v57
 v_max3_f32 v100, v100, v58, v59
 v_max3_f32 v100, v100, v60, v61
 v_max3_f32 v100, v100, v62, v63
 v_max3_f32 v101, v101, v64, v65
 v_max3_f32 v101, v101, v66, v67
 v_max3_f32 v101, v101, v68, v69
 v_max3_f32 v101, v101, v70, v71
 v_max3_f32 v101, v101, v72, v73
 v_max3_f32 v101, v101, v74, v75
 v_max3_f32 v101, v101, v76, v77
 v_max3_f32 v101, v101, v78, v79
 ds_read_b128 a[104:107], v104 offset:3072
 s_waitcnt lgkmcnt(0)
 v_mfma_f32_32x32x16_bf16 v[48:63], a[104:107], a[0:3], 0
 v_mfma_f32_32x32x16_bf16 v[48:63], a[140:143], a[20:23], v[48:63]
 v_mfma_f32_32x32x16_bf16 v[64:79], a[104:107], a[4:7], 0
 v_mfma_f32_32x32x16_bf16 v[64:79], a[140:143], a[52:55], v[64:79]
 s_nop 9
 v_max3_f32 v100, v100, v48, v49
 v_max3_f32 v100, v100, v50, v51
 v_max3_f32 v100, v100, v52, v53
 v_max3_f32 v100, v100, v54, v55
 v_max3_f32 v100, v100, v56, v57
 v_max3_f32 v100, v100, v58, v59
 v_max3_f32 v100, v100, v60, v61
 v_max3_f32 v100, v100, v62, v63
 v_max3_f32 v101, v101, v64, v65
 v_max3_f32 v101, v101, v66, v67
 v_max3_f32 v101, v101, v68, v69
 v_max3_f32 v101, v101, v70, v71
 v_max3_f32 v101, v101, v72, v73
 v_max3_f32 v101, v101, v74, v75
 v_max3_f32 v101, v101, v76, v77
 v_max3_f32 v101, v101, v78, v79
 ds_read_b128 a[104:107], v104 offset:4096
 s_waitcnt lgkmcnt(0)
 v_mfma_f32_32x32x16_bf16 v[48:63], a[104:107], a[0:3], 0
 v_mfma_f32_32x32x16_bf16 v[48:63], a[140:143], a[24:27], v[48:63]
 v_mfma_f32_32x32x16_bf16 v[64:79], a[104:107], a[4:7], 0
 v_mfma_f32_32x32x16_bf16 v[64:79], a[140:143], a[56:59], v[64:79]
 s_nop 9
 v_max3_f32 v100, v100, v48, v49
 v_max3_f32 v100, v100, v50, v51
 v_max3_f32 v100, v100, v52, v53
 v_max3_f32 v100, v100, v54, v55
 v_max3_f32 v100, v100, v56, v57
 v_max3_f32 v100, v100, v58, v59
 v_max3_f32 v100, v100, v60, v61
 v_max3_f32 v100, v100, v62, v63
 v_max3_f32 v101, v101, v64, v65
 v_max3_f32 v101, v101, v66, v67
 v_max3_f32 v101, v101, v68, v69
 v_max3_f32 v101, v101, v70, v71
 v_max3_f32 v101, v101, v72, v73
 v_max3_f32 v101, v101, v74, v75
 v_max3_f32 v101, v101, v76, v77
 v_max3_f32 v101, v101, v78, v79
 ds_read_b128 a[104:107], v104 offset:5120
 s_waitcnt lgkmcnt(0)
 v_mfma_f32_32x32x16_bf16 v[48:63], a[104:107], a[0:3], 0
 v_mfma_f32_32x32x16_bf16 v[48:63], a[140:143], a[28:31], v[48:63]
 v_mfma_f32_32x32x16_bf16 v[64:79], a[104:107], a[4:7], 0
 v_mfma_f32_32x32x16_bf16 v[64:79], a[140:143], a[60:63], v[64:79]
 s_nop 9
 v_max3_f32 v100, v100, v48, v49
 v_max3_f32 v100, v100, v50, v51
 v_max3_f32 v100, v100, v52, v53
 v_max3_f32 v100, v100, v54, v55
 v_max3_f32 v100, v100, v56, v57
 v_max3_f32 v100, v100, v58, v59
 v_max3_f32 v100, v100, v60, v61
 v_max3_f32 v100, v100, v62, v63
 v_max3_f32 v101, v101, v64, v65
 v_max3_f32 v101, v101, v66, v67
 v_max3_f32 v101, v101, v68, v69
 v_max3_f32 v101, v101, v70, v71
 v_max3_f32 v101, v101, v72, v73
 v_max3_f32 v101, v101, v74, v75
 v_max3_f32 v101, v101, v76, v77
 v_max3_f32 v101, v101, v78, v79
 ds_read_b128 a[104:107], v104 offset:6144
 s_waitcnt lgkmcnt(0)
 v_mfma_f32_32x32x16_bf16 v[48:63], a[104:107], a[0:3], 0
 v_mfma_f32_32x32x16_bf16 v[48:63], a[140:143], a[32:35], v[48:63]
 v_mfma_f32_32x32x16_bf16 v[64:79], a[104:107], a[4:7], 0
 v_mfma_f32_32x32x16_bf16 v[64:79], a[140:143], a[64:67], v[64:79]
 s_nop 9
 v_max3_f32 v100, v100, v48, v49
 v_max3_f32 v100, v100, v50, v51
 v_max3_f32 v100, v100, v52, v53
 v_max3_f32 v100, v100, v54, v55
 v_max3_f32 v100, v100, v56, v57
 v_max3_f32 v100, v100, v58, v59
 v_max3_f32 v100, v100, v60, v61
 v_max3_f32 v100, v100, v62, v63
 v_max3_f32 v101, v101, v64, v65
 v_max3_f32 v101, v101, v66, v67
 v_max3_f32 v101, v101, v68, v69
 v_max3_f32 v101, v101, v70, v71
 v_max3_f32 v101, v101, v72, v73
 v_max3_f32 v101, v101, v74, v75
 v_max3_f32 v101, v101, v76, v77
 v_max3_f32 v101, v101, v78, v79
 ds_read_b128 a[104:107], v104 offset:7168
 s_waitcnt lgkmcnt(0)
 v_mfma_f32_32x32x16_bf16 v[48:63], a[104:107], a[0:3], 0
 v_mfma_f32_32x32x16_bf16 v[48:63], a[140:143], a[36:39], v[48:63]
 v_mfma_f32_32x32x16_bf16 v[64:79], a[104:107], a[4:7], 0
 v_mfma_f32_32x32x16_bf16 v[64:79], a[140:143], a[68:71], v[64:79]
 s_nop 9
 v_max3_f32 v100, v100, v48, v49
 v_max3_f32 v100, v100, v50, v51
 v_max3_f32 v100, v100, v52, v53
 v_max3_f32 v100, v100, v54, v55
 v_max3_f32 v100, v100, v56, v57
 v_max3_f32 v100, v100, v58, v59
 v_max3_f32 v100, v100, v60, v61
 v_max3_f32 v100, v100, v62, v63
 v_max3_f32 v101, v101, v64, v65
 v_max3_f32 v101, v101, v66, v67
 v_max3_f32 v101, v101, v68, v69
 v_max3_f32 v101, v101, v70, v71
 v_max3_f32 v101, v101, v72, v73
 v_max3_f32 v101, v101, v74, v75
 v_max3_f32 v101, v101, v76, v77
 v_max3_f32 v101, v101, v78, v79
 v_add_u32 v104, 18944, v104
 s_add_u32 s31, s31, 1
 s_cmp_lt_u32 s31, 8
 s_cbranch_scc1 ATB_F1
 v_mov_b32 v103, v100
 s_nop 1
 v_permlane32_swap_b32 v100, v103
 v_max_f32 v100, v100, v103
 v_sub_f32 v16, 0, v100
 v_sub_f32 v17, 0, v100
 v_sub_f32 v18, 0, v100
 v_sub_f32 v19, 0, v100
 v_sub_f32 v20, 0, v100
 v_sub_f32 v21, 0, v100
 v_sub_f32 v22, 0, v100
 v_sub_f32 v23, 0, v100
 v_sub_f32 v24, 0, v100
 v_sub_f32 v25, 0, v100
 v_sub_f32 v26, 0, v100
 v_sub_f32 v27, 0, v100
 v_sub_f32 v28, 0, v100
 v_sub_f32 v29, 0, v100
 v_sub_f32 v30, 0, v100
 v_sub_f32 v31, 0, v100
 v_mov_b32 v103, v101
 s_nop 1
 v_permlane32_swap_b32 v101, v103
 v_max_f32 v101, v101, v103
 v_sub_f32 v32, 0, v101
 v_sub_f32 v33, 0, v101
 v_sub_f32 v34, 0, v101
 v_sub_f32 v35, 0, v101
 v_sub_f32 v36, 0, v101
 v_sub_f32 v37, 0, v101
 v_sub_f32 v38, 0, v101
 v_sub_f32 v39, 0, v101
 v_sub_f32 v40, 0, v101
 v_sub_f32 v41, 0, v101
 v_sub_f32 v42, 0, v101
 v_sub_f32 v43, 0, v101
 v_sub_f32 v44, 0, v101
 v_sub_f32 v45, 0, v101
 v_sub_f32 v46, 0, v101
 v_sub_f32 v47, 0, v101
 v_accvgpr_write_b32 a72, 0
 v_accvgpr_write_b32 a73, 0
 v_accvgpr_write_b32 a74, 0
 v_accvgpr_write_b32 a75, 0
 v_accvgpr_write_b32 a76, 0
 v_accvgpr_write_b32 a77, 0
 v_accvgpr_write_b32 a78, 0
 v_accvgpr_write_b32 a79, 0
 v_accvgpr_write_b32 a80, 0
 v_accvgpr_write_b32 a81, 0
 v_accvgpr_write_b32 a82, 0
 v_accvgpr_write_b32 a83, 0
 v_accvgpr_write_b32 a84, 0
 v_accvgpr_write_b32 a85, 0
 v_accvgpr_write_b32 a86, 0
 v_accvgpr_write_b32 a87, 0
 v_accvgpr_write_b32 a88, 0
 v_accvgpr_write_b32 a89, 0
 v_accvgpr_write_b32 a90, 0
 v_accvgpr_write_b32 a91, 0
 v_accvgpr_write_b32 a92, 0
 v_accvgpr_write_b32 a93, 0
 v_accvgpr_write_b32 a94, 0
 v_accvgpr_write_b32 a95, 0
 v_accvgpr_write_b32 a96, 0
 v_accvgpr_write_b32 a97, 0
 v_accvgpr_write_b32 a98, 0
 v_accvgpr_write_b32 a99, 0
 v_accvgpr_write_b32 a100, 0
 v_accvgpr_write_b32 a101, 0
 v_accvgpr_write_b32 a102, 0
 v_accvgpr_write_b32 a103, 0
 s_mov_b32 s31, 0
 v_mov_b32 v104, v2
 v_mov_b32 v105, v6
ATB_F2:
 ds_read_b128 a[140:143], v104 offset:8192
 s_nop 15
 ds_read_b128 a[104:107], v104 offset:0
 ds_read_b128 a[116:119], v105 offset:0
 ds_read_b128 a[120:123], v105 offset:608
 s_waitcnt lgkmcnt(0)
 v_mfma_f32_32x32x16_bf16 v[48:63], a[104:107], a[0:3], v[16:31]
 v_mfma_f32_32x32x16_bf16 v[48:63], a[140:143], a[8:11], v[48:63]
 v_mfma_f32_32x32x16_bf16 v[64:79], a[104:107], a[4:7], v[32:47]
 v_mfma_f32_32x32x16_bf16 v[64:79], a[140:143], a[40:43], v[64:79]
 s_nop 9
 v_exp_f32 v48, v48
 v_exp_f32 v49, v49
 v_exp_f32 v50, v50
 v_exp_f32 v51, v51
 v_exp_f32 v52, v52
 v_exp_f32 v53, v53
 v_exp_f32 v54, v54
 v_exp_f32 v55, v55
 v_exp_f32 v56, v56
 v_exp_f32 v57, v57
 v_exp_f32 v58, v58
 v_exp_f32 v59, v59
 v_exp_f32 v60, v60
 v_exp_f32 v61, v61
 v_exp_f32 v62, v62
 v_exp_f32 v63, v63
 v_cvt_pk_bf16_f32 v80, v48, v49
 v_cvt_pk_bf16_f32 v81, v50, v51
 v_cvt_pk_bf16_f32 v82, v52, v53
 v_cvt_pk_bf16_f32 v83, v54, v55
 v_cvt_pk_bf16_f32 v84, v56, v57
 v_cvt_pk_bf16_f32 v85, v58, v59
 v_cvt_pk_bf16_f32 v86, v60, v61
 v_cvt_pk_bf16_f32 v87, v62, v63
 v_mfma_f32_32x32x16_bf16 a[72:87], a[116:119], v[80:83], a[72:87]
 s_nop 0
 v_mfma_f32_32x32x16_bf16 a[72:87], a[120:123], v[84:87], a[72:87]
 v_exp_f32 v64, v64
 v_exp_f32 v65, v65
 v_exp_f32 v66, v66
 v_exp_f32 v67, v67
 v_exp_f32 v68, v68
 v_exp_f32 v69, v69
 v_exp_f32 v70, v70
 v_exp_f32 v71, v71
 v_exp_f32 v72, v72
 v_exp_f32 v73, v73
 v_exp_f32 v74, v74
 v_exp_f32 v75, v75
 v_exp_f32 v76, v76
 v_exp_f32 v77, v77
 v_exp_f32 v78, v78
 v_exp_f32 v79, v79
 v_cvt_pk_bf16_f32 v88, v64, v65
 v_cvt_pk_bf16_f32 v89, v66, v67
 v_cvt_pk_bf16_f32 v90, v68, v69
 v_cvt_pk_bf16_f32 v91, v70, v71
 v_cvt_pk_bf16_f32 v92, v72, v73
 v_cvt_pk_bf16_f32 v93, v74, v75
 v_cvt_pk_bf16_f32 v94, v76, v77
 v_cvt_pk_bf16_f32 v95, v78, v79
 v_mfma_f32_32x32x16_bf16 a[88:103], a[116:119], v[88:91], a[88:103]
 s_nop 0
 v_mfma_f32_32x32x16_bf16 a[88:103], a[120:123], v[92:95], a[88:103]
 s_nop 15
 ds_read_b128 a[104:107], v104 offset:1024
 ds_read_b128 a[116:119], v105 offset:1216
 ds_read_b128 a[120:123], v105 offset:1824
 s_waitcnt lgkmcnt(0)
 v_mfma_f32_32x32x16_bf16 v[48:63], a[104:107], a[0:3], v[16:31]
 v_mfma_f32_32x32x16_bf16 v[48:63], a[140:143], a[12:15], v[48:63]
 v_mfma_f32_32x32x16_bf16 v[64:79], a[104:107], a[4:7], v[32:47]
 v_mfma_f32_32x32x16_bf16 v[64:79], a[140:143], a[44:47], v[64:79]
 s_nop 9
 v_exp_f32 v48, v48
 v_exp_f32 v49, v49
 v_exp_f32 v50, v50
 v_exp_f32 v51, v51
 v_exp_f32 v52, v52
 v_exp_f32 v53, v53
 v_exp_f32 v54, v54
 v_exp_f32 v55, v55
 v_exp_f32 v56, v56
 v_exp_f32 v57, v57
 v_exp_f32 v58, v58
 v_exp_f32 v59, v59
 v_exp_f32 v60, v60
 v_exp_f32 v61, v61
 v_exp_f32 v62, v62
 v_exp_f32 v63, v63
 v_cvt_pk_bf16_f32 v80, v48, v49
 v_cvt_pk_bf16_f32 v81, v50, v51
 v_cvt_pk_bf16_f32 v82, v52, v53
 v_cvt_pk_bf16_f32 v83, v54, v55
 v_cvt_pk_bf16_f32 v84, v56, v57
 v_cvt_pk_bf16_f32 v85, v58, v59
 v_cvt_pk_bf16_f32 v86, v60, v61
 v_cvt_pk_bf16_f32 v87, v62, v63
 v_mfma_f32_32x32x16_bf16 a[72:87], a[116:119], v[80:83], a[72:87]
 s_nop 0
 v_mfma_f32_32x32x16_bf16 a[72:87], a[120:123], v[84:87], a[72:87]
 v_exp_f32 v64, v64
 v_exp_f32 v65, v65
 v_exp_f32 v66, v66
 v_exp_f32 v67, v67
 v_exp_f32 v68, v68
 v_exp_f32 v69, v69
 v_exp_f32 v70, v70
 v_exp_f32 v71, v71
 v_exp_f32 v72, v72
 v_exp_f32 v73, v73
 v_exp_f32 v74, v74
 v_exp_f32 v75, v75
 v_exp_f32 v76, v76
 v_exp_f32 v77, v77
 v_exp_f32 v78, v78
 v_exp_f32 v79, v79
 v_cvt_pk_bf16_f32 v88, v64, v65
 v_cvt_pk_bf16_f32 v89, v66, v67
 v_cvt_pk_bf16_f32 v90, v68, v69
 v_cvt_pk_bf16_f32 v91, v70, v71
 v_cvt_pk_bf16_f32 v92, v72, v73
 v_cvt_pk_bf16_f32 v93, v74, v75
 v_cvt_pk_bf16_f32 v94, v76, v77
 v_cvt_pk_bf16_f32 v95, v78, v79
 v_mfma_f32_32x32x16_bf16 a[88:103], a[116:119], v[88:91], a[88:103]
 s_nop 0
 v_mfma_f32_32x32x16_bf16 a[88:103], a[120:123], v[92:95], a[88:103]
 s_nop 15
 ds_read_b128 a[104:107], v104 offset:2048
 ds_read_b128 a[116:119], v105 offset:2432
 ds_read_b128 a[120:123], v105 offset:3040
 s_waitcnt lgkmcnt(0)
 v_mfma_f32_32x32x16_bf16 v[48:63], a[104:107], a[0:3], v[16:31]
 v_mfma_f32_32x32x16_bf16 v[48:63], a[140:143], a[16:19], v[48:63]
 v_mfma_f32_32x32x16_bf16 v[64:79], a[104:107], a[4:7], v[32:47]
 v_mfma_f32_32x32x16_bf16 v[64:79], a[140:143], a[48:51], v[64:79]
 s_nop 9
 v_exp_f32 v48, v48
 v_exp_f32 v49, v49
 v_exp_f32 v50, v50
 v_exp_f32 v51, v51
 v_exp_f32 v52, v52
 v_exp_f32 v53, v53
 v_exp_f32 v54, v54
 v_exp_f32 v55, v55
 v_exp_f32 v56, v56
 v_exp_f32 v57, v57
 v_exp_f32 v58, v58
 v_exp_f32 v59, v59
 v_exp_f32 v60, v60
 v_exp_f32 v61, v61
 v_exp_f32 v62, v62
 v_exp_f32 v63, v63
 v_cvt_pk_bf16_f32 v80, v48, v49
 v_cvt_pk_bf16_f32 v81, v50, v51
 v_cvt_pk_bf16_f32 v82, v52, v53
 v_cvt_pk_bf16_f32 v83, v54, v55
 v_cvt_pk_bf16_f32 v84, v56, v57
 v_cvt_pk_bf16_f32 v85, v58, v59
 v_cvt_pk_bf16_f32 v86, v60, v61
 v_cvt_pk_bf16_f32 v87, v62, v63
 v_mfma_f32_32x32x16_bf16 a[72:87], a[116:119], v[80:83], a[72:87]
 s_nop 0
 v_mfma_f32_32x32x16_bf16 a[72:87], a[120:123], v[84:87], a[72:87]
 v_exp_f32 v64, v64
 v_exp_f32 v65, v65
 v_exp_f32 v66, v66
 v_exp_f32 v67, v67
 v_exp_f32 v68, v68
 v_exp_f32 v69, v69
 v_exp_f32 v70, v70
 v_exp_f32 v71, v71
 v_exp_f32 v72, v72
 v_exp_f32 v73, v73
 v_exp_f32 v74, v74
 v_exp_f32 v75, v75
 v_exp_f32 v76, v76
 v_exp_f32 v77, v77
 v_exp_f32 v78, v78
 v_exp_f32 v79, v79
 v_cvt_pk_bf16_f32 v88, v64, v65
 v_cvt_pk_bf16_f32 v89, v66, v67
 v_cvt_pk_bf16_f32 v90, v68, v69
 v_cvt_pk_bf16_f32 v91, v70, v71
 v_cvt_pk_bf16_f32 v92, v72, v73
 v_cvt_pk_bf16_f32 v93, v74, v75
 v_cvt_pk_bf16_f32 v94, v76, v77
 v_cvt_pk_bf16_f32 v95, v78, v79
 v_mfma_f32_32x32x16_bf16 a[88:103], a[116:119], v[88:91], a[88:103]
 s_nop 0
 v_mfma_f32_32x32x16_bf16 a[88:103], a[120:123], v[92:95], a[88:103]
 s_nop 15
 ds_read_b128 a[104:107], v104 offset:3072
 ds_read_b128 a[116:119], v105 offset:3648
 ds_read_b128 a[120:123], v105 offset:4256
 s_waitcnt lgkmcnt(0)
 v_mfma_f32_32x32x16_bf16 v[48:63], a[104:107], a[0:3], v[16:31]
 v_mfma_f32_32x32x16_bf16 v[48:63], a[140:143], a[20:23], v[48:63]
 v_mfma_f32_32x32x16_bf16 v[64:79], a[104:107], a[4:7], v[32:47]
 v_mfma_f32_32x32x16_bf16 v[64:79], a[140:143], a[52:55], v[64:79]
 s_nop 9
 v_exp_f32 v48, v48
 v_exp_f32 v49, v49
 v_exp_f32 v50, v50
 v_exp_f32 v51, v51
 v_exp_f32 v52, v52
 v_exp_f32 v53, v53
 v_exp_f32 v54, v54
 v_exp_f32 v55, v55
 v_exp_f32 v56, v56
 v_exp_f32 v57, v57
 v_exp_f32 v58, v58
 v_exp_f32 v59, v59
 v_exp_f32 v60, v60
 v_exp_f32 v61, v61
 v_exp_f32 v62, v62
 v_exp_f32 v63, v63
 v_cvt_pk_bf16_f32 v80, v48, v49
 v_cvt_pk_bf16_f32 v81, v50, v51
 v_cvt_pk_bf16_f32 v82, v52, v53
 v_cvt_pk_bf16_f32 v83, v54, v55
 v_cvt_pk_bf16_f32 v84, v56, v57
 v_cvt_pk_bf16_f32 v85, v58, v59
 v_cvt_pk_bf16_f32 v86, v60, v61
 v_cvt_pk_bf16_f32 v87, v62, v63
 v_mfma_f32_32x32x16_bf16 a[72:87], a[116:119], v[80:83], a[72:87]
 s_nop 0
 v_mfma_f32_32x32x16_bf16 a[72:87], a[120:123], v[84:87], a[72:87]
 v_exp_f32 v64, v64
 v_exp_f32 v65, v65
 v_exp_f32 v66, v66
 v_exp_f32 v67, v67
 v_exp_f32 v68, v68
 v_exp_f32 v69, v69
 v_exp_f32 v70, v70
 v_exp_f32 v71, v71
 v_exp_f32 v72, v72
 v_exp_f32 v73, v73
 v_exp_f32 v74, v74
 v_exp_f32 v75, v75
 v_exp_f32 v76, v76
 v_exp_f32 v77, v77
 v_exp_f32 v78, v78
 v_exp_f32 v79, v79
 v_cvt_pk_bf16_f32 v88, v64, v65
 v_cvt_pk_bf16_f32 v89, v66, v67
 v_cvt_pk_bf16_f32 v90, v68, v69
 v_cvt_pk_bf16_f32 v91, v70, v71
 v_cvt_pk_bf16_f32 v92, v72, v73
 v_cvt_pk_bf16_f32 v93, v74, v75
 v_cvt_pk_bf16_f32 v94, v76, v77
 v_cvt_pk_bf16_f32 v95, v78, v79
 v_mfma_f32_32x32x16_bf16 a[88:103], a[116:119], v[88:91], a[88:103]
 s_nop 0
 v_mfma_f32_32x32x16_bf16 a[88:103], a[120:123], v[92:95], a[88:103]
 s_nop 15
 ds_read_b128 a[104:107], v104 offset:4096
 ds_read_b128 a[116:119], v105 offset:4864
 ds_read_b128 a[120:123], v105 offset:5472
 s_waitcnt lgkmcnt(0)
 v_mfma_f32_32x32x16_bf16 v[48:63], a[104:107], a[0:3], v[16:31]
 v_mfma_f32_32x32x16_bf16 v[48:63], a[140:143], a[24:27], v[48:63]
 v_mfma_f32_32x32x16_bf16 v[64:79], a[104:107], a[4:7], v[32:47]
 v_mfma_f32_32x32x16_bf16 v[64:79], a[140:143], a[56:59], v[64:79]
 s_nop 9
 v_exp_f32 v48, v48
 v_exp_f32 v49, v49
 v_exp_f32 v50, v50
 v_exp_f32 v51, v51
 v_exp_f32 v52, v52
 v_exp_f32 v53, v53
 v_exp_f32 v54, v54
 v_exp_f32 v55, v55
 v_exp_f32 v56, v56
 v_exp_f32 v57, v57
 v_exp_f32 v58, v58
 v_exp_f32 v59, v59
 v_exp_f32 v60, v60
 v_exp_f32 v61, v61
 v_exp_f32 v62, v62
 v_exp_f32 v63, v63
 v_cvt_pk_bf16_f32 v80, v48, v49
 v_cvt_pk_bf16_f32 v81, v50, v51
 v_cvt_pk_bf16_f32 v82, v52, v53
 v_cvt_pk_bf16_f32 v83, v54, v55
 v_cvt_pk_bf16_f32 v84, v56, v57
 v_cvt_pk_bf16_f32 v85, v58, v59
 v_cvt_pk_bf16_f32 v86, v60, v61
 v_cvt_pk_bf16_f32 v87, v62, v63
 v_mfma_f32_32x32x16_bf16 a[72:87], a[116:119], v[80:83], a[72:87]
 s_nop 0
 v_mfma_f32_32x32x16_bf16 a[72:87], a[120:123], v[84:87], a[72:87]
 v_exp_f32 v64, v64
 v_exp_f32 v65, v65
 v_exp_f32 v66, v66
 v_exp_f32 v67, v67
 v_exp_f32 v68, v68
 v_exp_f32 v69, v69
 v_exp_f32 v70, v70
 v_exp_f32 v71, v71
 v_exp_f32 v72, v72
 v_exp_f32 v73, v73
 v_exp_f32 v74, v74
 v_exp_f32 v75, v75
 v_exp_f32 v76, v76
 v_exp_f32 v77, v77
 v_exp_f32 v78, v78
 v_exp_f32 v79, v79
 v_cvt_pk_bf16_f32 v88, v64, v65
 v_cvt_pk_bf16_f32 v89, v66, v67
 v_cvt_pk_bf16_f32 v90, v68, v69
 v_cvt_pk_bf16_f32 v91, v70, v71
 v_cvt_pk_bf16_f32 v92, v72, v73
 v_cvt_pk_bf16_f32 v93, v74, v75
 v_cvt_pk_bf16_f32 v94, v76, v77
 v_cvt_pk_bf16_f32 v95, v78, v79
 v_mfma_f32_32x32x16_bf16 a[88:103], a[116:119], v[88:91], a[88:103]
 s_nop 0
 v_mfma_f32_32x32x16_bf16 a[88:103], a[120:123], v[92:95], a[88:103]
 s_nop 15
 ds_read_b128 a[104:107], v104 offset:5120
 ds_read_b128 a[116:119], v105 offset:6080
 ds_read_b128 a[120:123], v105 offset:6688
 s_waitcnt lgkmcnt(0)
 v_mfma_f32_32x32x16_bf16 v[48:63], a[104:107], a[0:3], v[16:31]
 v_mfma_f32_32x32x16_bf16 v[48:63], a[140:143], a[28:31], v[48:63]
 v_mfma_f32_32x32x16_bf16 v[64:79], a[104:107], a[4:7], v[32:47]
 v_mfma_f32_32x32x16_bf16 v[64:79], a[140:143], a[60:63], v[64:79]
 s_nop 9
 v_exp_f32 v48, v48
 v_exp_f32 v49, v49
 v_exp_f32 v50, v50
 v_exp_f32 v51, v51
 v_exp_f32 v52, v52
 v_exp_f32 v53, v53
 v_exp_f32 v54, v54
 v_exp_f32 v55, v55
 v_exp_f32 v56, v56
 v_exp_f32 v57, v57
 v_exp_f32 v58, v58
 v_exp_f32 v59, v59
 v_exp_f32 v60, v60
 v_exp_f32 v61, v61
 v_exp_f32 v62, v62
 v_exp_f32 v63, v63
 v_cvt_pk_bf16_f32 v80, v48, v49
 v_cvt_pk_bf16_f32 v81, v50, v51
 v_cvt_pk_bf16_f32 v82, v52, v53
 v_cvt_pk_bf16_f32 v83, v54, v55
 v_cvt_pk_bf16_f32 v84, v56, v57
 v_cvt_pk_bf16_f32 v85, v58, v59
 v_cvt_pk_bf16_f32 v86, v60, v61
 v_cvt_pk_bf16_f32 v87, v62, v63
 v_mfma_f32_32x32x16_bf16 a[72:87], a[116:119], v[80:83], a[72:87]
 s_nop 0
 v_mfma_f32_32x32x16_bf16 a[72:87], a[120:123], v[84:87], a[72:87]
 v_exp_f32 v64, v64
 v_exp_f32 v65, v65
 v_exp_f32 v66, v66
 v_exp_f32 v67, v67
 v_exp_f32 v68, v68
 v_exp_f32 v69, v69
 v_exp_f32 v70, v70
 v_exp_f32 v71, v71
 v_exp_f32 v72, v72
 v_exp_f32 v73, v73
 v_exp_f32 v74, v74
 v_exp_f32 v75, v75
 v_exp_f32 v76, v76
 v_exp_f32 v77, v77
 v_exp_f32 v78, v78
 v_exp_f32 v79, v79
 v_cvt_pk_bf16_f32 v88, v64, v65
 v_cvt_pk_bf16_f32 v89, v66, v67
 v_cvt_pk_bf16_f32 v90, v68, v69
 v_cvt_pk_bf16_f32 v91, v70, v71
 v_cvt_pk_bf16_f32 v92, v72, v73
 v_cvt_pk_bf16_f32 v93, v74, v75
 v_cvt_pk_bf16_f32 v94, v76, v77
 v_cvt_pk_bf16_f32 v95, v78, v79
 v_mfma_f32_32x32x16_bf16 a[88:103], a[116:119], v[88:91], a[88:103]
 s_nop 0
 v_mfma_f32_32x32x16_bf16 a[88:103], a[120:123], v[92:95], a[88:103]
 s_nop 15
 ds_read_b128 a[104:107], v104 offset:6144
 ds_read_b128 a[116:119], v105 offset:7296
 ds_read_b128 a[120:123], v105 offset:7904
 s_waitcnt lgkmcnt(0)
 v_mfma_f32_32x32x16_bf16 v[48:63], a[104:107], a[0:3], v[16:31]
 v_mfma_f32_32x32x16_bf16 v[48:63], a[140:143], a[32:35], v[48:63]
 v_mfma_f32_32x32x16_bf16 v[64:79], a[104:107], a[4:7], v[32:47]
 v_mfma_f32_32x32x16_bf16 v[64:79], a[140:143], a[64:67], v[64:79]
 s_nop 9
 v_exp_f32 v48, v48
 v_exp_f32 v49, v49
 v_exp_f32 v50, v50
 v_exp_f32 v51, v51
 v_exp_f32 v52, v52
 v_exp_f32 v53, v53
 v_exp_f32 v54, v54
 v_exp_f32 v55, v55
 v_exp_f32 v56, v56
 v_exp_f32 v57, v57
 v_exp_f32 v58, v58
 v_exp_f32 v59, v59
 v_exp_f32 v60, v60
 v_exp_f32 v61, v61
 v_exp_f32 v62, v62
 v_exp_f32 v63, v63
 v_cvt_pk_bf16_f32 v80, v48, v49
 v_cvt_pk_bf16_f32 v81, v50, v51
 v_cvt_pk_bf16_f32 v82, v52, v53
 v_cvt_pk_bf16_f32 v83, v54, v55
 v_cvt_pk_bf16_f32 v84, v56, v57
 v_cvt_pk_bf16_f32 v85, v58, v59
 v_cvt_pk_bf16_f32 v86, v60, v61
 v_cvt_pk_bf16_f32 v87, v62, v63
 v_mfma_f32_32x32x16_bf16 a[72:87], a[116:119], v[80:83], a[72:87]
 s_nop 0
 v_mfma_f32_32x32x16_bf16 a[72:87], a[120:123], v[84:87], a[72:87]
 v_exp_f32 v64, v64
 v_exp_f32 v65, v65
 v_exp_f32 v66, v66
 v_exp_f32 v67, v67
 v_exp_f32 v68, v68
 v_exp_f32 v69, v69
 v_exp_f32 v70, v70
 v_exp_f32 v71, v71
 v_exp_f32 v72, v72
 v_exp_f32 v73, v73
 v_exp_f32 v74, v74
 v_exp_f32 v75, v75
 v_exp_f32 v76, v76
 v_exp_f32 v77, v77
 v_exp_f32 v78, v78
 v_exp_f32 v79, v79
 v_cvt_pk_bf16_f32 v88, v64, v65
 v_cvt_pk_bf16_f32 v89, v66, v67
 v_cvt_pk_bf16_f32 v90, v68, v69
 v_cvt_pk_bf16_f32 v91, v70, v71
 v_cvt_pk_bf16_f32 v92, v72, v73
 v_cvt_pk_bf16_f32 v93, v74, v75
 v_cvt_pk_bf16_f32 v94, v76, v77
 v_cvt_pk_bf16_f32 v95, v78, v79
 v_mfma_f32_32x32x16_bf16 a[88:103], a[116:119], v[88:91], a[88:103]
 s_nop 0
 v_mfma_f32_32x32x16_bf16 a[88:103], a[120:123], v[92:95], a[88:103]
 s_nop 15
 ds_read_b128 a[104:107], v104 offset:7168
 ds_read_b128 a[116:119], v105 offset:8512
 ds_read_b128 a[120:123], v105 offset:9120
 s_waitcnt lgkmcnt(0)
 v_mfma_f32_32x32x16_bf16 v[48:63], a[104:107], a[0:3], v[16:31]
 v_mfma_f32_32x32x16_bf16 v[48:63], a[140:143], a[36:39], v[48:63]
 v_mfma_f32_32x32x16_bf16 v[64:79], a[104:107], a[4:7], v[32:47]
 v_mfma_f32_32x32x16_bf16 v[64:79], a[140:143], a[68:71], v[64:79]
 s_nop 9
 v_exp_f32 v48, v48
 v_exp_f32 v49, v49
 v_exp_f32 v50, v50
 v_exp_f32 v51, v51
 v_exp_f32 v52, v52
 v_exp_f32 v53, v53
 v_exp_f32 v54, v54
 v_exp_f32 v55, v55
 v_exp_f32 v56, v56
 v_exp_f32 v57, v57
 v_exp_f32 v58, v58
 v_exp_f32 v59, v59
 v_exp_f32 v60, v60
 v_exp_f32 v61, v61
 v_exp_f32 v62, v62
 v_exp_f32 v63, v63
 v_cvt_pk_bf16_f32 v80, v48, v49
 v_cvt_pk_bf16_f32 v81, v50, v51
 v_cvt_pk_bf16_f32 v82, v52, v53
 v_cvt_pk_bf16_f32 v83, v54, v55
 v_cvt_pk_bf16_f32 v84, v56, v57
 v_cvt_pk_bf16_f32 v85, v58, v59
 v_cvt_pk_bf16_f32 v86, v60, v61
 v_cvt_pk_bf16_f32 v87, v62, v63
 v_mfma_f32_32x32x16_bf16 a[72:87], a[116:119], v[80:83], a[72:87]
 s_nop 0
 v_mfma_f32_32x32x16_bf16 a[72:87], a[120:123], v[84:87], a[72:87]
 v_exp_f32 v64, v64
 v_exp_f32 v65, v65
 v_exp_f32 v66, v66
 v_exp_f32 v67, v67
 v_exp_f32 v68, v68
 v_exp_f32 v69, v69
 v_exp_f32 v70, v70
 v_exp_f32 v71, v71
 v_exp_f32 v72, v72
 v_exp_f32 v73, v73
 v_exp_f32 v74, v74
 v_exp_f32 v75, v75
 v_exp_f32 v76, v76
 v_exp_f32 v77, v77
 v_exp_f32 v78, v78
 v_exp_f32 v79, v79
 v_cvt_pk_bf16_f32 v88, v64, v65
 v_cvt_pk_bf16_f32 v89, v66, v67
 v_cvt_pk_bf16_f32 v90, v68, v69
 v_cvt_pk_bf16_f32 v91, v70, v71
 v_cvt_pk_bf16_f32 v92, v72, v73
 v_cvt_pk_bf16_f32 v93, v74, v75
 v_cvt_pk_bf16_f32 v94, v76, v77
 v_cvt_pk_bf16_f32 v95, v78, v79
 v_mfma_f32_32x32x16_bf16 a[88:103], a[116:119], v[88:91], a[88:103]
 s_nop 0
 v_mfma_f32_32x32x16_bf16 a[88:103], a[120:123], v[92:95], a[88:103]
 v_add_u32 v104, 18944, v104
 v_add_u32 v105, 18944, v105
 s_add_u32 s31, s31, 1
 s_cmp_lt_u32 s31, 8
 s_nop 15
 s_cbranch_scc1 ATB_F2
 v_accvgpr_read_b32 v48, a72
 v_accvgpr_read_b32 v49, a73
 v_accvgpr_read_b32 v50, a74
 v_accvgpr_read_b32 v51, a75
 v_accvgpr_read_b32 v52, a76
 v_accvgpr_read_b32 v53, a77
 v_accvgpr_read_b32 v54, a78
 v_accvgpr_read_b32 v55, a79
 v_accvgpr_read_b32 v56, a80
 v_accvgpr_read_b32 v57, a81
 v_accvgpr_read_b32 v58, a82
 v_accvgpr_read_b32 v64, a88
 v_accvgpr_read_b32 v65, a89
 v_accvgpr_read_b32 v66, a90
 v_accvgpr_read_b32 v67, a91
 v_accvgpr_read_b32 v68, a92
 v_accvgpr_read_b32 v69, a93
 v_accvgpr_read_b32 v70, a94
 v_accvgpr_read_b32 v71, a95
 v_accvgpr_read_b32 v72, a96
 v_accvgpr_read_b32 v73, a97
 v_accvgpr_read_b32 v74, a98
ATB_OUT:
 v_rcp_f32 v100, v58
 v_rcp_f32 v101, v74
 v_bfe_u32 v96, v0, 4, 1
 v_mul_u32_u24 v96, 18432, v96
 v_and_b32 v97, 15, v0
 v_lshlrev_b32 v97, 4, v97
 v_add_u32 v96, v96, v97
 v_bfe_u32 v97, v0, 5, 1
 v_lshlrev_b32 v97, 8, v97
 v_add_u32 v97, v96, v97
 s_mul_i32 s30, s25, 36864
 s_add_u32 s30, s30, 25444352
 s_lshl_b32 s31, s24, 9
 s_add_u32 s31, s31, s30
 s_lshr_b32 s32, s24, 2
 s_lshl_b32 s32, s32, 8
 s_and_b32 s33, s24, 3
 s_lshl_b32 s33, s33, 2
 s_add_u32 s32, s32, s33
 s_add_u32 s32, s32, s30
 s_add_u32 s32, s32, 16384
 s_add_u32 s33, s31, 36864
 v_mul_f32 v48, v48, v100
 v_mul_f32 v49, v49, v100
 v_mul_f32 v50, v50, v100
 v_mul_f32 v51, v51, v100
 v_mul_f32 v52, v52, v100
 v_mul_f32 v53, v53, v100
 v_mul_f32 v54, v54, v100
 v_mul_f32 v55, v55, v100
 v_mul_f32 v56, v56, v100
 v_mul_f32 v57, v57, v100
 v_cvt_pk_bf16_f32 v80, v48, v49
 v_cvt_pk_bf16_f32 v81, v50, v51
 v_cvt_pk_bf16_f32 v82, v52, v53
 v_cvt_pk_bf16_f32 v83, v54, v55
 v_cvt_pk_bf16_f32 v84, v56, v57
 buffer_store_dwordx4 v[80:83], v97, s[4:7], s31 offen sc1
 v_mul_f32 v64, v64, v101
 v_mul_f32 v65, v65, v101
 v_mul_f32 v66, v66, v101
 v_mul_f32 v67, v67, v101
 v_mul_f32 v68, v68, v101
 v_mul_f32 v69, v69, v101
 v_mul_f32 v70, v70, v101
 v_mul_f32 v71, v71, v101
 v_mul_f32 v72, v72, v101
 v_mul_f32 v73, v73, v101
 v_cvt_pk_bf16_f32 v88, v64, v65
 v_cvt_pk_bf16_f32 v89, v66, v67
 v_cvt_pk_bf16_f32 v90, v68, v69
 v_cvt_pk_bf16_f32 v91, v70, v71
 v_cvt_pk_bf16_f32 v92, v72, v73
 buffer_store_dwordx4 v[88:91], v97, s[4:7], s33 offen sc1
 s_nop 0
 v_permlane32_swap_b32 v84, v92
 v_lshrrev_b32 v96, 2, v1
 s_lshl_b32 s32, s24, 13
 s_lshl_b32 s33, s25, 7
 s_add_u32 s32, s32, s33
 s_add_u32 s32, s32, 27803648
 buffer_store_dword v84, v96, s[4:7], s32 offen sc1
 s_lshl_b32 s30, s26, 2
 s_add_u32 s30, s30, s3
 s_lshl_b32 s30, s30, 5
 s_add_u32 s30, s30, s24
 s_lshl_b32 s30, s30, 2
 s_add_u32 s30, s30, s41
 s_add_u32 s30, s30, 16384
 s_lshl_b32 s30, s30, 5
 s_add_u32 s31, s30, 9961472
 v_mov_b32 v98, 0
 v_mov_b32 v99, 1
 s_mov_b32 s86, s31
 s_branch CH_K3
ATB_END:
.globl km_kernel
.p2align 8
.type km_kernel,@function
km_kernel:
 s_load_dwordx16 s[64:79], s[0:1], 0
 s_load_dwordx4 s[80:83], s[0:1], 64
 s_cmp_lt_u32 s2, 256
 s_cbranch_scc1 KM_GO
 s_endpgm
KM_GO:
 s_mov_b32 s40, 0
 s_mov_b32 s41, 0
 s_mov_b32 s42, 0
 s_mov_b32 s43, 9437184
 s_mov_b32 s100, 0
 s_mov_b32 s101, 0
 v_lshrrev_b32 v1, 6, v0
 s_nop 0
 v_readfirstlane_b32 s3, v1
 s_waitcnt vmcnt(0) lgkmcnt(0)
 s_mov_b32 s4, s82
 s_and_b32 s5, s83, 0xffff
 s_mov_b32 s6, 75374592
 s_mov_b32 s7, 0x00020000
 s_mov_b32 s16, s80
 s_and_b32 s17, s81, 0xffff
 s_mov_b32 s18, 256
 s_mov_b32 s19, 0x00020000
 s_mov_b32 s84, s78
 s_mov_b32 s85, s79
 s_cmp_lt_u32 s2, 192
 s_cbranch_scc1 KM_NOWQ
 s_mov_b32 s8, s66
 s_and_b32 s9, s67, 0xffff
 s_mov_b32 s10, 1990656
 s_mov_b32 s11, 0x00020000
 s_sub_u32 s29, s2, 192
 s_lshl_b32 s29, s29, 15
 v_lshlrev_b32 v1, 4, v0
 buffer_load_dwordx4 v[200:203], v1, s[8:11], s29 offen
 s_add_u32 s29, s29, 4096
 buffer_load_dwordx4 v[204:207], v1, s[8:11], s29 offen
 s_add_u32 s29, s29, 4096
 buffer_load_dwordx4 v[208:211], v1, s[8:11], s29 offen
 s_add_u32 s29, s29, 4096
 buffer_load_dwordx4 v[212:215], v1, s[8:11], s29 offen
 s_add_u32 s29, s29, 4096
 buffer_load_dwordx4 v[216:219], v1, s[8:11], s29 offen
 s_add_u32 s29, s29, 4096
 buffer_load_dwordx4 v[220:223], v1, s[8:11], s29 offen
 s_add_u32 s29, s29, 4096
 buffer_load_dwordx4 v[224:227], v1, s[8:11], s29 offen
 s_add_u32 s29, s29, 4096
 buffer_load_dwordx4 v[228:231], v1, s[8:11], s29 offen
 s_add_u32 s29, s29, 4096
KM_NOWQ:
 s_nop 0
 s_mov_b32 s24, s2
 s_cmp_lt_u32 s24, 64
 s_cbranch_scc1 K0_x
 s_sub_u32 s24, s24, 64
 s_cmp_lt_u32 s24, 32
 s_cbranch_scc1 K0_qkm
 s_sub_u32 s24, s24, 32
 s_cmp_lt_u32 s24, 16
 s_cbranch_scc1 K0_qke
 s_sub_u32 s24, s24, 16
 s_cmp_lt_u32 s24, 18
 s_cbranch_scc1 K0_v
 s_sub_u32 s24, s24, 18
 s_cmp_lt_u32 s24, 18
 s_cbranch_scc1 K0_wom
 s_sub_u32 s24, s24, 18
 s_cmp_lt_u32 s24, 2
 s_cbranch_scc1 K0_woe
 s_sub_u32 s24, s24, 2
 s_cmp_lt_u32 s24, 32
 s_cbranch_scc1 K0_ones
 s_sub_u32 s24, s24, 32
 s_cmp_lt_u32 s24, 8
 s_cbranch_scc1 K0_zero
 s_sub_u32 s24, s24, 8
 s_cmp_lt_u32 s24, 1
 s_cbranch_scc1 K0_zeroa
 s_sub_u32 s24, s24, 1
 s_branch K0_END
K0_x:
 s_nop 0
 s_nop 0
 s_mov_b32 s8, s64
 s_and_b32 s9, s65, 0xffff
 s_mov_b32 s10, 2359296
 s_mov_b32 s11, 0x00020000
 v_and_b32 v1, 63, v0
 v_and_b32 v2, 31, v1
 v_mul_u32_u24 v2, 1152, v2
 v_lshrrev_b32 v3, 5, v1
 v_lshlrev_b32 v3, 4, v3
 v_add_u32 v2, v2, v3
 v_lshlrev_b32 v4, 4, v1
 s_mul_i32 s20, s24, 36864
 s_mul_i32 s22, s3, 288
 s_add_u32 s20, s20, s22
 s_mul_i32 s21, s24, 36864
 s_mul_i32 s22, s3, 9216
 s_add_u32 s21, s21, s22
 s_add_u32 s21, s21, 0
 buffer_load_dwordx4 v[16:19], v2, s[8:11], s20 offen offset:0
 buffer_load_dwordx4 v[20:23], v2, s[8:11], s20 offen offset:32
 buffer_load_dwordx4 v[24:27], v2, s[8:11], s20 offen offset:64
 buffer_load_dwordx4 v[28:31], v2, s[8:11], s20 offen offset:96
 buffer_load_dwordx4 v[32:35], v2, s[8:11], s20 offen offset:128
 buffer_load_dwordx4 v[36:39], v2, s[8:11], s20 offen offset:160
 buffer_load_dwordx4 v[40:43], v2, s[8:11], s20 offen offset:192
 buffer_load_dwordx4 v[44:47], v2, s[8:11], s20 offen offset:224
 buffer_load_dwordx4 v[48:51], v2, s[8:11], s20 offen offset:256
 s_waitcnt vmcnt(8)
 s_add_u32 s22, s21, 0
 buffer_store_dwordx4 v[16:19], v4, s[4:7], s22 offen sc1
 v_lshlrev_b32 v56, 16, v16
 v_and_b32 v57, 0xffff0000, v16
 v_lshlrev_b32 v58, 16, v17
 v_and_b32 v59, 0xffff0000, v17
 v_lshlrev_b32 v60, 16, v18
 v_and_b32 v61, 0xffff0000, v18
 v_lshlrev_b32 v62, 16, v19
 v_and_b32 v63, 0xffff0000, v19
 s_waitcnt vmcnt(8)
 s_add_u32 s22, s21, 1024
 buffer_store_dwordx4 v[20:23], v4, s[4:7], s22 offen sc1
 v_lshlrev_b32 v64, 16, v20
 v_and_b32 v65, 0xffff0000, v20
 v_lshlrev_b32 v66, 16, v21
 v_and_b32 v67, 0xffff0000, v21
 v_lshlrev_b32 v68, 16, v22
 v_and_b32 v69, 0xffff0000, v22
 v_lshlrev_b32 v70, 16, v23
 v_and_b32 v71, 0xffff0000, v23
 s_waitcnt vmcnt(8)
 s_add_u32 s22, s21, 2048
 buffer_store_dwordx4 v[24:27], v4, s[4:7], s22 offen sc1
 v_lshlrev_b32 v72, 16, v24
 v_and_b32 v73, 0xffff0000, v24
 v_lshlrev_b32 v74, 16, v25
 v_and_b32 v75, 0xffff0000, v25
 v_lshlrev_b32 v76, 16, v26
 v_and_b32 v77, 0xffff0000, v26
 v_lshlrev_b32 v78, 16, v27
 v_and_b32 v79, 0xffff0000, v27
 s_waitcnt vmcnt(8)
 s_add_u32 s22, s21, 3072
 buffer_store_dwordx4 v[28:31], v4, s[4:7], s22 offen sc1
 v_lshlrev_b32 v80, 16, v28
 v_and_b32 v81, 0xffff0000, v28
 v_lshlrev_b32 v82, 16, v29
 v_and_b32 v83, 0xffff0000, v29
 v_lshlrev_b32 v84, 16, v30
 v_and_b32 v85, 0xffff0000, v30
 v_lshlrev_b32 v86, 16, v31
 v_and_b32 v87, 0xffff0000, v31
 s_waitcnt vmcnt(8)
 s_add_u32 s22, s21, 4096
 buffer_store_dwordx4 v[32:35], v4, s[4:7], s22 offen sc1
 v_lshlrev_b32 v88, 16, v32
 v_and_b32 v89, 0xffff0000, v32
 v_lshlrev_b32 v90, 16, v33
 v_and_b32 v91, 0xffff0000, v33
 v_lshlrev_b32 v92, 16, v34
 v_and_b32 v93, 0xffff0000, v34
 v_lshlrev_b32 v94, 16, v35
 v_and_b32 v95, 0xffff0000, v35
 s_waitcnt vmcnt(8)
 s_add_u32 s22, s21, 5120
 buffer_store_dwordx4 v[36:39], v4, s[4:7], s22 offen sc1
 v_lshlrev_b32 v96, 16, v36
 v_and_b32 v97, 0xffff0000, v36
 v_lshlrev_b32 v98, 16, v37
 v_and_b32 v99, 0xffff0000, v37
 v_lshlrev_b32 v100, 16, v38
 v_and_b32 v101, 0xffff0000, v38
 v_lshlrev_b32 v102, 16, v39
 v_and_b32 v103, 0xffff0000, v39
 s_waitcnt vmcnt(8)
 s_add_u32 s22, s21, 6144
 buffer_store_dwordx4 v[40:43], v4, s[4:7], s22 offen sc1
 v_lshlrev_b32 v104, 16, v40
 v_and_b32 v105, 0xffff0000, v40
 v_lshlrev_b32 v106, 16, v41
 v_and_b32 v107, 0xffff0000, v41
 v_lshlrev_b32 v108, 16, v42
 v_and_b32 v109, 0xffff0000, v42
 v_lshlrev_b32 v110, 16, v43
 v_and_b32 v111, 0xffff0000, v43
 s_waitcnt vmcnt(8)
 s_add_u32 s22, s21, 7168
 buffer_store_dwordx4 v[44:47], v4, s[4:7], s22 offen sc1
 v_lshlrev_b32 v112, 16, v44
 v_and_b32 v113, 0xffff0000, v44
 v_lshlrev_b32 v114, 16, v45
 v_and_b32 v115, 0xffff0000, v45
 v_lshlrev_b32 v116, 16, v46
 v_and_b32 v117, 0xffff0000, v46
 v_lshlrev_b32 v118, 16, v47
 v_and_b32 v119, 0xffff0000, v47
 s_waitcnt vmcnt(8)
 s_add_u32 s22, s21, 8192
 buffer_store_dwordx4 v[48:51], v4, s[4:7], s22 offen sc1
 v_lshlrev_b32 v120, 16, v48
 v_and_b32 v121, 0xffff0000, v48
 v_lshlrev_b32 v122, 16, v49
 v_and_b32 v123, 0xffff0000, v49
 v_lshlrev_b32 v124, 16, v50
 v_and_b32 v125, 0xffff0000, v50
 v_lshlrev_b32 v126, 16, v51
 v_and_b32 v127, 0xffff0000, v51
 v_add_f32 v6, v56, v57
 v_add_f32 v6, v6, v58
 v_add_f32 v6, v6, v59
 v_add_f32 v6, v6, v60
 v_add_f32 v6, v6, v61
 v_add_f32 v6, v6, v62
 v_add_f32 v6, v6, v63
 v_add_f32 v6, v6, v64
 v_add_f32 v6, v6, v65
 v_add_f32 v6, v6, v66
 v_add_f32 v6, v6, v67
 v_add_f32 v6, v6, v68
 v_add_f32 v6, v6, v69
 v_add_f32 v6, v6, v70
 v_add_f32 v6, v6, v71
 v_add_f32 v6, v6, v72
 v_add_f32 v6, v6, v73
 v_add_f32 v6, v6, v74
 v_add_f32 v6, v6, v75
 v_add_f32 v6, v6, v76
 v_add_f32 v6, v6, v77
 v_add_f32 v6, v6, v78
 v_add_f32 v6, v6, v79
 v_add_f32 v6, v6, v80
 v_add_f32 v6, v6, v81
 v_add_f32 v6, v6, v82
 v_add_f32 v6, v6, v83
 v_add_f32 v6, v6, v84
 v_add_f32 v6, v6, v85
 v_add_f32 v6, v6, v86
 v_add_f32 v6, v6, v87
 v_mov_b32 v10, v6
 s_nop 1
 v_permlane32_swap_b32 v6, v10
 v_add_f32 v6, v6, v10
 v_mul_f32 v6, 0x3c800000, v6
 v_mov_b32 v7, 0
 v_sub_f32 v56, v56, v6
 v_fmac_f32 v7, v56, v56
 v_sub_f32 v57, v57, v6
 v_fmac_f32 v7, v57, v57
 v_sub_f32 v58, v58, v6
 v_fmac_f32 v7, v58, v58
 v_sub_f32 v59, v59, v6
 v_fmac_f32 v7, v59, v59
 v_sub_f32 v60, v60, v6
 v_fmac_f32 v7, v60, v60
 v_sub_f32 v61, v61, v6
 v_fmac_f32 v7, v61, v61
 v_sub_f32 v62, v62, v6
 v_fmac_f32 v7, v62, v62
 v_sub_f32 v63, v63, v6
 v_fmac_f32 v7, v63, v63
 v_sub_f32 v64, v64, v6
 v_fmac_f32 v7, v64, v64
 v_sub_f32 v65, v65, v6
 v_fmac_f32 v7, v65, v65
 v_sub_f32 v66, v66, v6
 v_fmac_f32 v7, v66, v66
 v_sub_f32 v67, v67, v6
 v_fmac_f32 v7, v67, v67
 v_sub_f32 v68, v68, v6
 v_fmac_f32 v7, v68, v68
 v_sub_f32 v69, v69, v6
 v_fmac_f32 v7, v69, v69
 v_sub_f32 v70, v70, v6
 v_fmac_f32 v7, v70, v70
 v_sub_f32 v71, v71, v6
 v_fmac_f32 v7, v71, v71
 v_sub_f32 v72, v72, v6
 v_fmac_f32 v7, v72, v72
 v_sub_f32 v73, v73, v6
 v_fmac_f32 v7, v73, v73
 v_sub_f32 v74, v74, v6
 v_fmac_f32 v7, v74, v74
 v_sub_f32 v75, v75, v6
 v_fmac_f32 v7, v75, v75
 v_sub_f32 v76, v76, v6
 v_fmac_f32 v7, v76, v76
 v_sub_f32 v77, v77, v6
 v_fmac_f32 v7, v77, v77
 v_sub_f32 v78, v78, v6
 v_fmac_f32 v7, v78, v78
 v_sub_f32 v79, v79, v6
 v_fmac_f32 v7, v79, v79
 v_sub_f32 v80, v80, v6
 v_fmac_f32 v7, v80, v80
 v_sub_f32 v81, v81, v6
 v_fmac_f32 v7, v81, v81
 v_sub_f32 v82, v82, v6
 v_fmac_f32 v7, v82, v82
 v_sub_f32 v83, v83, v6
 v_fmac_f32 v7, v83, v83
 v_sub_f32 v84, v84, v6
 v_fmac_f32 v7, v84, v84
 v_sub_f32 v85, v85, v6
 v_fmac_f32 v7, v85, v85
 v_sub_f32 v86, v86, v6
 v_fmac_f32 v7, v86, v86
 v_sub_f32 v87, v87, v6
 v_fmac_f32 v7, v87, v87
 v_mov_b32 v10, v7
 s_nop 1
 v_permlane32_swap_b32 v7, v10
 v_add_f32 v7, v7, v10
 v_add_f32 v8, v88, v89
 v_add_f32 v8, v8, v90
 v_add_f32 v8, v8, v91
 v_add_f32 v8, v8, v92
 v_add_f32 v8, v8, v93
 v_add_f32 v8, v8, v94
 v_add_f32 v8, v8, v95
 v_add_f32 v8, v8, v96
 v_add_f32 v8, v8, v97
 v_add_f32 v8, v8, v98
 v_add_f32 v8, v8, v99
 v_add_f32 v8, v8, v100
 v_add_f32 v8, v8, v101
 v_add_f32 v8, v8, v102
 v_add_f32 v8, v8, v103
 v_add_f32 v8, v8, v104
 v_add_f32 v8, v8, v105
 v_add_f32 v8, v8, v106
 v_add_f32 v8, v8, v107
 v_add_f32 v8, v8, v108
 v_add_f32 v8, v8, v109
 v_add_f32 v8, v8, v110
 v_add_f32 v8, v8, v111
 v_add_f32 v8, v8, v112
 v_add_f32 v8, v8, v113
 v_add_f32 v8, v8, v114
 v_add_f32 v8, v8, v115
 v_add_f32 v8, v8, v116
 v_add_f32 v8, v8, v117
 v_add_f32 v8, v8, v118
 v_add_f32 v8, v8, v119
 v_add_f32 v8, v8, v120
 v_add_f32 v8, v8, v121
 v_add_f32 v8, v8, v122
 v_add_f32 v8, v8, v123
 v_add_f32 v8, v8, v124
 v_add_f32 v8, v8, v125
 v_add_f32 v8, v8, v126
 v_add_f32 v8, v8, v127
 v_mov_b32 v10, v8
 s_nop 1
 v_permlane32_swap_b32 v8, v10
 v_add_f32 v8, v8, v10
 v_mul_f32 v8, 0x3c4ccccd, v8
 v_mov_b32 v9, 0
 v_sub_f32 v88, v88, v8
 v_fmac_f32 v9, v88, v88
 v_sub_f32 v89, v89, v8
 v_fmac_f32 v9, v89, v89
 v_sub_f32 v90, v90, v8
 v_fmac_f32 v9, v90, v90
 v_sub_f32 v91, v91, v8
 v_fmac_f32 v9, v91, v91
 v_sub_f32 v92, v92, v8
 v_fmac_f32 v9, v92, v92
 v_sub_f32 v93, v93, v8
 v_fmac_f32 v9, v93, v93
 v_sub_f32 v94, v94, v8
 v_fmac_f32 v9, v94, v94
 v_sub_f32 v95, v95, v8
 v_fmac_f32 v9, v95, v95
 v_sub_f32 v96, v96, v8
 v_fmac_f32 v9, v96, v96
 v_sub_f32 v97, v97, v8
 v_fmac_f32 v9, v97, v97
 v_sub_f32 v98, v98, v8
 v_fmac_f32 v9, v98, v98
 v_sub_f32 v99, v99, v8
 v_fmac_f32 v9, v99, v99
 v_sub_f32 v100, v100, v8
 v_fmac_f32 v9, v100, v100
 v_sub_f32 v101, v101, v8
 v_fmac_f32 v9, v101, v101
 v_sub_f32 v102, v102, v8
 v_fmac_f32 v9, v102, v102
 v_sub_f32 v103, v103, v8
 v_fmac_f32 v9, v103, v103
 v_sub_f32 v104, v104, v8
 v_fmac_f32 v9, v104, v104
 v_sub_f32 v105, v105, v8
 v_fmac_f32 v9, v105, v105
 v_sub_f32 v106, v106, v8
 v_fmac_f32 v9, v106, v106
 v_sub_f32 v107, v107, v8
 v_fmac_f32 v9, v107, v107
 v_sub_f32 v108, v108, v8
 v_fmac_f32 v9, v108, v108
 v_sub_f32 v109, v109, v8
 v_fmac_f32 v9, v109, v109
 v_sub_f32 v110, v110, v8
 v_fmac_f32 v9, v110, v110
 v_sub_f32 v111, v111, v8
 v_fmac_f32 v9, v111, v111
 v_sub_f32 v112, v112, v8
 v_fmac_f32 v9, v112, v112
 v_sub_f32 v113, v113, v8
 v_fmac_f32 v9, v113, v113
 v_sub_f32 v114, v114, v8
 v_fmac_f32 v9, v114, v114
 v_sub_f32 v115, v115, v8
 v_fmac_f32 v9, v115, v115
 v_sub_f32 v116, v116, v8
 v_fmac_f32 v9, v116, v116
 v_sub_f32 v117, v117, v8
 v_fmac_f32 v9, v117, v117
 v_sub_f32 v118, v118, v8
 v_fmac_f32 v9, v118, v118
 v_sub_f32 v119, v119, v8
 v_fmac_f32 v9, v119, v119
 v_sub_f32 v120, v120, v8
 v_fmac_f32 v9, v120, v120
 v_sub_f32 v121, v121, v8
 v_fmac_f32 v9, v121, v121
 v_sub_f32 v122, v122, v8
 v_fmac_f32 v9, v122, v122
 v_sub_f32 v123, v123, v8
 v_fmac_f32 v9, v123, v123
 v_sub_f32 v124, v124, v8
 v_fmac_f32 v9, v124, v124
 v_sub_f32 v125, v125, v8
 v_fmac_f32 v9, v125, v125
 v_sub_f32 v126, v126, v8
 v_fmac_f32 v9, v126, v126
 v_sub_f32 v127, v127, v8
 v_fmac_f32 v9, v127, v127
 v_mov_b32 v10, v9
 s_nop 1
 v_permlane32_swap_b32 v9, v10
 v_add_f32 v9, v9, v10
 v_and_b32 v2, 15, v1
 v_lshlrev_b32 v2, 3, v2
 v_bfe_u32 v3, v1, 4, 1
 v_lshlrev_b32 v3, 10, v3
 v_add_u32 v2, v2, v3
 s_lshl_b32 s22, s24, 11
 s_lshl_b32 s23, s3, 8
 s_add_u32 s22, s22, s23
 s_add_u32 s22, s22, 9437184
 buffer_store_dwordx2 v[6:7], v2, s[4:7], s22 offen sc1
 buffer_store_dwordx2 v[8:9], v2, s[4:7], s22 offen offset:128 sc1
 s_branch K0_END
K0_qkm:
 s_nop 0
 s_nop 0
 s_nop 0
 s_mov_b32 s8, s66
 s_and_b32 s9, s67, 0xffff
 s_mov_b32 s10, 1990656
 s_mov_b32 s11, 0x00020000
 s_lshr_b32 s22, s24, 4
 s_mul_i32 s20, s22, 1152
 s_and_b32 s23, s24, 15
 s_mul_i32 s23, s23, 72
 s_add_u32 s20, s20, s23
 s_mul_i32 s23, s3, 497664
 s_add_u32 s20, s20, s23
 s_mul_i32 s21, s24, 37888
 s_mul_i32 s23, s3, 9216
 s_add_u32 s21, s21, s23
 s_add_u32 s21, s21, 56442880
 v_and_b32 v1, 63, v0
 v_lshrrev_b32 v2, 5, v1
 v_lshlrev_b32 v2, 3, v2
 v_bfe_u32 v3, v1, 2, 2
 v_add_u32 v2, v2, v3
 s_mov_b32 s22, 3456
 v_mul_lo_u32 v2, v2, s22
 v_bfe_u32 v3, v1, 4, 1
 v_mul_u32_u24 v3, 40, v3
 v_add_u32 v2, v2, v3
 v_and_b32 v3, 1, v1
 v_mul_u32_u24 v3, 16, v3
 v_add_u32 v2, v2, v3
 v_bfe_u32 v3, v1, 1, 1
 v_mul_u32_u24 v3, 8, v3
 v_add_u32 v2, v2, v3
 v_add_u32 v3, 13824, v2
 v_bfe_u32 v4, v1, 4, 1
 s_mov_b32 s22, 256
 v_mul_lo_u32 v4, v4, s22
 v_and_b32 v5, 15, v1
 v_lshlrev_b32 v5, 4, v5
 v_add_u32 v4, v4, v5
 v_lshrrev_b32 v5, 5, v1
 v_mul_u32_u24 v5, 512, v5
 v_add_u32 v4, v4, v5
 s_mul_i32 s22, s3, 9216
 v_lshlrev_b32 v5, 3, v1
 v_add_u32 v5, s22, v5
 v_mov_b32 v6, 0
 s_mov_b32 s23, 0x3f803f80
 s_add_u32 s22, s20, 0
 buffer_load_dwordx2 v[16:17], v2, s[8:11], s22 offen
 buffer_load_dwordx2 v[18:19], v3, s[8:11], s22 offen
 s_add_u32 s22, s20, 55296
 buffer_load_dwordx2 v[20:21], v2, s[8:11], s22 offen
 buffer_load_dwordx2 v[22:23], v3, s[8:11], s22 offen
 s_add_u32 s22, s20, 110592
 buffer_load_dwordx2 v[24:25], v2, s[8:11], s22 offen
 buffer_load_dwordx2 v[26:27], v3, s[8:11], s22 offen
 s_add_u32 s22, s20, 165888
 buffer_load_dwordx2 v[28:29], v2, s[8:11], s22 offen
 buffer_load_dwordx2 v[30:31], v3, s[8:11], s22 offen
 s_add_u32 s22, s20, 221184
 buffer_load_dwordx2 v[32:33], v2, s[8:11], s22 offen
 buffer_load_dwordx2 v[34:35], v3, s[8:11], s22 offen
 s_add_u32 s22, s20, 276480
 buffer_load_dwordx2 v[36:37], v2, s[8:11], s22 offen
 buffer_load_dwordx2 v[38:39], v3, s[8:11], s22 offen
 s_add_u32 s22, s20, 331776
 buffer_load_dwordx2 v[40:41], v2, s[8:11], s22 offen
 buffer_load_dwordx2 v[42:43], v3, s[8:11], s22 offen
 s_add_u32 s22, s20, 387072
 buffer_load_dwordx2 v[44:45], v2, s[8:11], s22 offen
 buffer_load_dwordx2 v[46:47], v3, s[8:11], s22 offen
 s_add_u32 s22, s20, 442368
 buffer_load_dwordx2 v[48:49], v2, s[8:11], s22 offen
 buffer_load_dwordx2 v[50:51], v3, s[8:11], s22 offen
 s_waitcnt vmcnt(16)
 ds_write_b64 v5, v[16:17] offset:0
 ds_write_b64 v5, v[18:19] offset:512
 s_waitcnt vmcnt(14)
 ds_write_b64 v5, v[20:21] offset:1024
 ds_write_b64 v5, v[22:23] offset:1536
 s_waitcnt vmcnt(12)
 ds_write_b64 v5, v[24:25] offset:2048
 ds_write_b64 v5, v[26:27] offset:2560
 s_waitcnt vmcnt(10)
 ds_write_b64 v5, v[28:29] offset:3072
 ds_write_b64 v5, v[30:31] offset:3584
 s_waitcnt vmcnt(8)
 ds_write_b64 v5, v[32:33] offset:4096
 ds_write_b64 v5, v[34:35] offset:4608
 s_waitcnt vmcnt(6)
 ds_write_b64 v5, v[36:37] offset:5120
 ds_write_b64 v5, v[38:39] offset:5632
 s_waitcnt vmcnt(4)
 ds_write_b64 v5, v[40:41] offset:6144
 ds_write_b64 v5, v[42:43] offset:6656
 s_waitcnt vmcnt(2)
 ds_write_b64 v5, v[44:45] offset:7168
 ds_write_b64 v5, v[46:47] offset:7680
 s_waitcnt vmcnt(0)
 ds_write_b64 v5, v[48:49] offset:8192
 ds_write_b64 v5, v[50:51] offset:8704
 s_waitcnt lgkmcnt(15)
 ds_read_b64_tr_b16 v[56:57], v5 offset:0
 ds_read_b64_tr_b16 v[58:59], v5 offset:512
 s_waitcnt lgkmcnt(15)
 ds_read_b64_tr_b16 v[60:61], v5 offset:1024
 ds_read_b64_tr_b16 v[62:63], v5 offset:1536
 s_waitcnt lgkmcnt(15)
 ds_read_b64_tr_b16 v[64:65], v5 offset:2048
 ds_read_b64_tr_b16 v[66:67], v5 offset:2560
 s_waitcnt lgkmcnt(15)
 ds_read_b64_tr_b16 v[68:69], v5 offset:3072
 ds_read_b64_tr_b16 v[70:71], v5 offset:3584
 s_waitcnt lgkmcnt(15)
 ds_read_b64_tr_b16 v[72:73], v5 offset:4096
 ds_read_b64_tr_b16 v[74:75], v5 offset:4608
 s_waitcnt lgkmcnt(15)
 ds_read_b64_tr_b16 v[76:77], v5 offset:5120
 ds_read_b64_tr_b16 v[78:79], v5 offset:5632
 s_waitcnt lgkmcnt(15)
 ds_read_b64_tr_b16 v[80:81], v5 offset:6144
 ds_read_b64_tr_b16 v[82:83], v5 offset:6656
 s_waitcnt lgkmcnt(15)
 ds_read_b64_tr_b16 v[84:85], v5 offset:7168
 ds_read_b64_tr_b16 v[86:87], v5 offset:7680
 s_waitcnt lgkmcnt(15)
 ds_read_b64_tr_b16 v[88:89], v5 offset:8192
 ds_read_b64_tr_b16 v[90:91], v5 offset:8704
 s_waitcnt lgkmcnt(15)
 s_add_u32 s22, s21, 0
 buffer_store_dwordx4 v[56:59], v4, s[4:7], s22 offen sc1
 v_dot2_f32_bf16 v6, v56, s23, v6
 v_dot2_f32_bf16 v6, v57, s23, v6
 v_dot2_f32_bf16 v6, v58, s23, v6
 v_dot2_f32_bf16 v6, v59, s23, v6
 s_waitcnt lgkmcnt(14)
 s_add_u32 s22, s21, 1024
 buffer_store_dwordx4 v[60:63], v4, s[4:7], s22 offen sc1
 v_dot2_f32_bf16 v6, v60, s23, v6
 v_dot2_f32_bf16 v6, v61, s23, v6
 v_dot2_f32_bf16 v6, v62, s23, v6
 v_dot2_f32_bf16 v6, v63, s23, v6
 s_waitcnt lgkmcnt(12)
 s_add_u32 s22, s21, 2048
 buffer_store_dwordx4 v[64:67], v4, s[4:7], s22 offen sc1
 v_dot2_f32_bf16 v6, v64, s23, v6
 v_dot2_f32_bf16 v6, v65, s23, v6
 v_dot2_f32_bf16 v6, v66, s23, v6
 v_dot2_f32_bf16 v6, v67, s23, v6
 s_waitcnt lgkmcnt(10)
 s_add_u32 s22, s21, 3072
 buffer_store_dwordx4 v[68:71], v4, s[4:7], s22 offen sc1
 v_dot2_f32_bf16 v6, v68, s23, v6
 v_dot2_f32_bf16 v6, v69, s23, v6
 v_dot2_f32_bf16 v6, v70, s23, v6
 v_dot2_f32_bf16 v6, v71, s23, v6
 s_waitcnt lgkmcnt(8)
 s_add_u32 s22, s21, 4096
 buffer_store_dwordx4 v[72:75], v4, s[4:7], s22 offen sc1
 v_dot2_f32_bf16 v6, v72, s23, v6
 v_dot2_f32_bf16 v6, v73, s23, v6
 v_dot2_f32_bf16 v6, v74, s23, v6
 v_dot2_f32_bf16 v6, v75, s23, v6
 s_waitcnt lgkmcnt(6)
 s_add_u32 s22, s21, 5120
 buffer_store_dwordx4 v[76:79], v4, s[4:7], s22 offen sc1
 v_dot2_f32_bf16 v6, v76, s23, v6
 v_dot2_f32_bf16 v6, v77, s23, v6
 v_dot2_f32_bf16 v6, v78, s23, v6
 v_dot2_f32_bf16 v6, v79, s23, v6
 s_waitcnt lgkmcnt(4)
 s_add_u32 s22, s21, 6144
 buffer_store_dwordx4 v[80:83], v4, s[4:7], s22 offen sc1
 v_dot2_f32_bf16 v6, v80, s23, v6
 v_dot2_f32_bf16 v6, v81, s23, v6
 v_dot2_f32_bf16 v6, v82, s23, v6
 v_dot2_f32_bf16 v6, v83, s23, v6
 s_waitcnt lgkmcnt(2)
 s_add_u32 s22, s21, 7168
 buffer_store_dwordx4 v[84:87], v4, s[4:7], s22 offen sc1
 v_dot2_f32_bf16 v6, v84, s23, v6
 v_dot2_f32_bf16 v6, v85, s23, v6
 v_dot2_f32_bf16 v6, v86, s23, v6
 v_dot2_f32_bf16 v6, v87, s23, v6
 s_waitcnt lgkmcnt(0)
 s_add_u32 s22, s21, 8192
 buffer_store_dwordx4 v[88:91], v4, s[4:7], s22 offen sc1
 v_dot2_f32_bf16 v6, v88, s23, v6
 v_dot2_f32_bf16 v6, v89, s23, v6
 v_dot2_f32_bf16 v6, v90, s23, v6
 v_dot2_f32_bf16 v6, v91, s23, v6
 s_lshl_b32 s22, s3, 8
 v_lshlrev_b32 v7, 2, v1
 v_add_u32 v7, s22, v7
 s_nop 2
 ds_write_b32 v7, v6 offset:40960
 s_waitcnt lgkmcnt(0)
 s_barrier
 s_cmp_lg_u32 s3, 0
 s_cbranch_scc1 K0_END
 v_and_b32 v7, 31, v1
 v_lshlrev_b32 v7, 2, v7
 ds_read_b32 v8, v7 offset:40960
 ds_read_b32 v9, v7 offset:41088
 ds_read_b32 v10, v7 offset:41216
 ds_read_b32 v11, v7 offset:41344
 ds_read_b32 v12, v7 offset:41472
 ds_read_b32 v13, v7 offset:41600
 ds_read_b32 v14, v7 offset:41728
 ds_read_b32 v15, v7 offset:41856
 s_waitcnt lgkmcnt(0)
 v_add_f32 v8, v8, v9
 v_add_f32 v10, v10, v11
 v_add_f32 v12, v12, v13
 v_add_f32 v14, v14, v15
 v_add_f32 v8, v8, v10
 v_add_f32 v12, v12, v14
 v_add_f32 v8, v8, v12
 v_sub_f32 v8, 0, v8
 v_cvt_pk_bf16_f32 v9, v8, v8
 v_lshlrev_b32 v9, 16, v9
 v_sub_f32 v8, v8, v9
 v_cvt_pk_bf16_f32 v10, v8, v8
 v_lshlrev_b32 v10, 16, v10
 v_sub_f32 v11, v8, v10
 v_cvt_pk_bf16_f32 v12, v9, v10
 v_cvt_pk_bf16_f32 v13, v9, v11
 v_cvt_pk_bf16_f32 v14, v10, v9
 v_mov_b32 v15, 0
 v_cmp_gt_u32 vcc, 32, v1
 s_nop 1
 v_cndmask_b32 v12, 0, v12, vcc
 v_cndmask_b32 v13, 0, v13, vcc
 v_cndmask_b32 v14, 0, v14, vcc
 s_add_u32 s22, s21, 36864
 buffer_store_dwordx4 v[12:15], v4, s[4:7], s22 offen sc1
 s_branch K0_END
K0_qke:
 s_mov_b32 s8, s66
 s_and_b32 s9, s67, 0xffff
 s_mov_b32 s10, 1990656
 s_mov_b32 s11, 0x00020000
 s_mul_i32 s20, s24, 144
 s_add_u32 s20, s20, 32
 s_mul_i32 s23, s3, 497664
 s_add_u32 s20, s20, s23
 s_and_b32 s25, s24, 3
 s_lshr_b32 s21, s24, 2
 s_mul_i32 s21, s21, 37888
 s_nop 0
 s_mul_i32 s23, s3, 9216
 s_add_u32 s21, s21, s23
 s_add_u32 s21, s21, 57655296
 v_and_b32 v1, 63, v0
 v_lshrrev_b32 v2, 5, v1
 v_lshlrev_b32 v2, 3, v2
 v_bfe_u32 v3, v1, 2, 2
 v_add_u32 v2, v2, v3
 s_mov_b32 s22, 3456
 v_mul_lo_u32 v2, v2, s22
 v_bfe_u32 v3, v1, 4, 1
 v_mul_u32_u24 v3, 0, v3
 v_add_u32 v2, v2, v3
 v_and_b32 v3, 1, v1
 v_mul_u32_u24 v3, 72, v3
 v_add_u32 v2, v2, v3
 v_bfe_u32 v3, v1, 1, 1
 v_mul_u32_u24 v3, 0, v3
 v_add_u32 v2, v2, v3
 v_add_u32 v3, 13824, v2
 v_bfe_u32 v4, v1, 4, 1
 s_mov_b32 s22, 256
 v_mul_lo_u32 v4, v4, s22
 v_and_b32 v5, 15, v1
 v_lshlrev_b32 v5, 4, v5
 v_add_u32 v4, v4, v5
 v_lshrrev_b32 v5, 5, v1
 v_mul_u32_u24 v5, 512, v5
 v_add_u32 v4, v4, v5
 v_bfe_u32 v5, v1, 3, 2
 v_cmp_eq_u32 vcc, s25, v5
 v_mov_b32 v5, 0x7ffffff0
 s_nop 0
 v_cndmask_b32 v4, v5, v4, vcc
 s_mul_i32 s22, s3, 9216
 v_lshlrev_b32 v5, 3, v1
 v_add_u32 v5, s22, v5
 v_mov_b32 v6, 0
 s_mov_b32 s23, 0x3f803f80
 s_add_u32 s22, s20, 0
 buffer_load_dwordx2 v[16:17], v2, s[8:11], s22 offen
 buffer_load_dwordx2 v[18:19], v3, s[8:11], s22 offen
 s_add_u32 s22, s20, 55296
 buffer_load_dwordx2 v[20:21], v2, s[8:11], s22 offen
 buffer_load_dwordx2 v[22:23], v3, s[8:11], s22 offen
 s_add_u32 s22, s20, 110592
 buffer_load_dwordx2 v[24:25], v2, s[8:11], s22 offen
 buffer_load_dwordx2 v[26:27], v3, s[8:11], s22 offen
 s_add_u32 s22, s20, 165888
 buffer_load_dwordx2 v[28:29], v2, s[8:11], s22 offen
 buffer_load_dwordx2 v[30:31], v3, s[8:11], s22 offen
 s_add_u32 s22, s20, 221184
 buffer_load_dwordx2 v[32:33], v2, s[8:11], s22 offen
 buffer_load_dwordx2 v[34:35], v3, s[8:11], s22 offen
 s_add_u32 s22, s20, 276480
 buffer_load_dwordx2 v[36:37], v2, s[8:11], s22 offen
 buffer_load_dwordx2 v[38:39], v3, s[8:11], s22 offen
 s_add_u32 s22, s20, 331776
 buffer_load_dwordx2 v[40:41], v2, s[8:11], s22 offen
 buffer_load_dwordx2 v[42:43], v3, s[8:11], s22 offen
 s_add_u32 s22, s20, 387072
 buffer_load_dwordx2 v[44:45], v2, s[8:11], s22 offen
 buffer_load_dwordx2 v[46:47], v3, s[8:11], s22 offen
 s_add_u32 s22, s20, 442368
 buffer_load_dwordx2 v[48:49], v2, s[8:11], s22 offen
 buffer_load_dwordx2 v[50:51], v3, s[8:11], s22 offen
 s_waitcnt vmcnt(16)
 ds_write_b64 v5, v[16:17] offset:0
 ds_write_b64 v5, v[18:19] offset:512
 s_waitcnt vmcnt(14)
 ds_write_b64 v5, v[20:21] offset:1024
 ds_write_b64 v5, v[22:23] offset:1536
 s_waitcnt vmcnt(12)
 ds_write_b64 v5, v[24:25] offset:2048
 ds_write_b64 v5, v[26:27] offset:2560
 s_waitcnt vmcnt(10)
 ds_write_b64 v5, v[28:29] offset:3072
 ds_write_b64 v5, v[30:31] offset:3584
 s_waitcnt vmcnt(8)
 ds_write_b64 v5, v[32:33] offset:4096
 ds_write_b64 v5, v[34:35] offset:4608
 s_waitcnt vmcnt(6)
 ds_write_b64 v5, v[36:37] offset:5120
 ds_write_b64 v5, v[38:39] offset:5632
 s_waitcnt vmcnt(4)
 ds_write_b64 v5, v[40:41] offset:6144
 ds_write_b64 v5, v[42:43] offset:6656
 s_waitcnt vmcnt(2)
 ds_write_b64 v5, v[44:45] offset:7168
 ds_write_b64 v5, v[46:47] offset:7680
 s_waitcnt vmcnt(0)
 ds_write_b64 v5, v[48:49] offset:8192
 ds_write_b64 v5, v[50:51] offset:8704
 s_waitcnt lgkmcnt(15)
 ds_read_b64_tr_b16 v[56:57], v5 offset:0
 ds_read_b64_tr_b16 v[58:59], v5 offset:512
 s_waitcnt lgkmcnt(15)
 ds_read_b64_tr_b16 v[60:61], v5 offset:1024
 ds_read_b64_tr_b16 v[62:63], v5 offset:1536
 s_waitcnt lgkmcnt(15)
 ds_read_b64_tr_b16 v[64:65], v5 offset:2048
 ds_read_b64_tr_b16 v[66:67], v5 offset:2560
 s_waitcnt lgkmcnt(15)
 ds_read_b64_tr_b16 v[68:69], v5 offset:3072
 ds_read_b64_tr_b16 v[70:71], v5 offset:3584
 s_waitcnt lgkmcnt(15)
 ds_read_b64_tr_b16 v[72:73], v5 offset:4096
 ds_read_b64_tr_b16 v[74:75], v5 offset:4608
 s_waitcnt lgkmcnt(15)
 ds_read_b64_tr_b16 v[76:77], v5 offset:5120
 ds_read_b64_tr_b16 v[78:79], v5 offset:5632
 s_waitcnt lgkmcnt(15)
 ds_read_b64_tr_b16 v[80:81], v5 offset:6144
 ds_read_b64_tr_b16 v[82:83], v5 offset:6656
 s_waitcnt lgkmcnt(15)
 ds_read_b64_tr_b16 v[84:85], v5 offset:7168
 ds_read_b64_tr_b16 v[86:87], v5 offset:7680
 s_waitcnt lgkmcnt(15)
 ds_read_b64_tr_b16 v[88:89], v5 offset:8192
 ds_read_b64_tr_b16 v[90:91], v5 offset:8704
 s_waitcnt lgkmcnt(15)
 s_add_u32 s22, s21, 0
 buffer_store_dwordx4 v[56:59], v4, s[4:7], s22 offen sc1
 v_dot2_f32_bf16 v6, v56, s23, v6
 v_dot2_f32_bf16 v6, v57, s23, v6
 v_dot2_f32_bf16 v6, v58, s23, v6
 v_dot2_f32_bf16 v6, v59, s23, v6
 s_waitcnt lgkmcnt(14)
 s_add_u32 s22, s21, 1024
 buffer_store_dwordx4 v[60:63], v4, s[4:7], s22 offen sc1
 v_dot2_f32_bf16 v6, v60, s23, v6
 v_dot2_f32_bf16 v6, v61, s23, v6
 v_dot2_f32_bf16 v6, v62, s23, v6
 v_dot2_f32_bf16 v6, v63, s23, v6
 s_waitcnt lgkmcnt(12)
 s_add_u32 s22, s21, 2048
 buffer_store_dwordx4 v[64:67], v4, s[4:7], s22 offen sc1
 v_dot2_f32_bf16 v6, v64, s23, v6
 v_dot2_f32_bf16 v6, v65, s23, v6
 v_dot2_f32_bf16 v6, v66, s23, v6
 v_dot2_f32_bf16 v6, v67, s23, v6
 s_waitcnt lgkmcnt(10)
 s_add_u32 s22, s21, 3072
 buffer_store_dwordx4 v[68:71], v4, s[4:7], s22 offen sc1
 v_dot2_f32_bf16 v6, v68, s23, v6
 v_dot2_f32_bf16 v6, v69, s23, v6
 v_dot2_f32_bf16 v6, v70, s23, v6
 v_dot2_f32_bf16 v6, v71, s23, v6
 s_waitcnt lgkmcnt(8)
 s_add_u32 s22, s21, 4096
 buffer_store_dwordx4 v[72:75], v4, s[4:7], s22 offen sc1
 v_dot2_f32_bf16 v6, v72, s23, v6
 v_dot2_f32_bf16 v6, v73, s23, v6
 v_dot2_f32_bf16 v6, v74, s23, v6
 v_dot2_f32_bf16 v6, v75, s23, v6
 s_waitcnt lgkmcnt(6)
 s_add_u32 s22, s21, 5120
 buffer_store_dwordx4 v[76:79], v4, s[4:7], s22 offen sc1
 v_dot2_f32_bf16 v6, v76, s23, v6
 v_dot2_f32_bf16 v6, v77, s23, v6
 v_dot2_f32_bf16 v6, v78, s23, v6
 v_dot2_f32_bf16 v6, v79, s23, v6
 s_waitcnt lgkmcnt(4)
 s_add_u32 s22, s21, 6144
 buffer_store_dwordx4 v[80:83], v4, s[4:7], s22 offen sc1
 v_dot2_f32_bf16 v6, v80, s23, v6
 v_dot2_f32_bf16 v6, v81, s23, v6
 v_dot2_f32_bf16 v6, v82, s23, v6
 v_dot2_f32_bf16 v6, v83, s23, v6
 s_waitcnt lgkmcnt(2)
 s_add_u32 s22, s21, 7168
 buffer_store_dwordx4 v[84:87], v4, s[4:7], s22 offen sc1
 v_dot2_f32_bf16 v6, v84, s23, v6
 v_dot2_f32_bf16 v6, v85, s23, v6
 v_dot2_f32_bf16 v6, v86, s23, v6
 v_dot2_f32_bf16 v6, v87, s23, v6
 s_waitcnt lgkmcnt(0)
 s_add_u32 s22, s21, 8192
 buffer_store_dwordx4 v[88:91], v4, s[4:7], s22 offen sc1
 v_dot2_f32_bf16 v6, v88, s23, v6
 v_dot2_f32_bf16 v6, v89, s23, v6
 v_dot2_f32_bf16 v6, v90, s23, v6
 v_dot2_f32_bf16 v6, v91, s23, v6
 s_lshl_b32 s22, s3, 8
 v_lshlrev_b32 v7, 2, v1
 v_add_u32 v7, s22, v7
 s_nop 2
 ds_write_b32 v7, v6 offset:40960
 s_waitcnt lgkmcnt(0)
 s_barrier
 s_cmp_lg_u32 s3, 0
 s_cbranch_scc1 K0_END
 v_and_b32 v7, 31, v1
 v_lshlrev_b32 v7, 2, v7
 ds_read_b32 v8, v7 offset:40960
 ds_read_b32 v9, v7 offset:41088
 ds_read_b32 v10, v7 offset:41216
 ds_read_b32 v11, v7 offset:41344
 ds_read_b32 v12, v7 offset:41472
 ds_read_b32 v13, v7 offset:41600
 ds_read_b32 v14, v7 offset:41728
 ds_read_b32 v15, v7 offset:41856
 s_waitcnt lgkmcnt(0)
 v_add_f32 v8, v8, v9
 v_add_f32 v10, v10, v11
 v_add_f32 v12, v12, v13
 v_add_f32 v14, v14, v15
 v_add_f32 v8, v8, v10
 v_add_f32 v12, v12, v14
 v_add_f32 v8, v8, v12
 v_sub_f32 v8, 0, v8
 v_cvt_pk_bf16_f32 v9, v8, v8
 v_lshlrev_b32 v9, 16, v9
 v_sub_f32 v8, v8, v9
 v_cvt_pk_bf16_f32 v10, v8, v8
 v_lshlrev_b32 v10, 16, v10
 v_sub_f32 v11, v8, v10
 v_cvt_pk_bf16_f32 v12, v9, v10
 v_cvt_pk_bf16_f32 v13, v9, v11
 v_cvt_pk_bf16_f32 v14, v10, v9
 v_mov_b32 v15, 0
 v_cmp_gt_u32 vcc, 32, v1
 s_nop 1
 v_cndmask_b32 v12, 0, v12, vcc
 v_cndmask_b32 v13, 0, v13, vcc
 v_cndmask_b32 v14, 0, v14, vcc
 s_add_u32 s22, s21, 36864
 buffer_store_dwordx4 v[12:15], v4, s[4:7], s22 offen sc1
 s_branch K0_END
K0_v:
 s_nop 0
 s_nop 0
 s_nop 0
 s_nop 0
 s_mov_b32 s8, s66
 s_and_b32 s9, s67, 0xffff
 s_mov_b32 s10, 1990656
 s_mov_b32 s11, 0x00020000
 s_lshl_b32 s20, s24, 6
 s_add_u32 s20, s20, 2304
 s_mul_i32 s23, s3, 497664
 s_add_u32 s20, s20, s23
 s_mul_i32 s21, s24, 37888
 s_mul_i32 s23, s3, 9216
 s_add_u32 s21, s21, s23
 s_add_u32 s21, s21, 57806848
 v_and_b32 v1, 63, v0
 v_lshrrev_b32 v2, 5, v1
 v_lshlrev_b32 v2, 3, v2
 v_bfe_u32 v3, v1, 2, 2
 v_add_u32 v2, v2, v3
 s_mov_b32 s22, 3456
 v_mul_lo_u32 v2, v2, s22
 v_bfe_u32 v3, v1, 4, 1
 v_mul_u32_u24 v3, 32, v3
 v_add_u32 v2, v2, v3
 v_and_b32 v3, 1, v1
 v_mul_u32_u24 v3, 8, v3
 v_add_u32 v2, v2, v3
 v_bfe_u32 v3, v1, 1, 1
 v_mul_u32_u24 v3, 16, v3
 v_add_u32 v2, v2, v3
 v_add_u32 v3, 13824, v2
 v_bfe_u32 v4, v1, 4, 1
 s_mov_b32 s22, 256
 v_mul_lo_u32 v4, v4, s22
 v_and_b32 v5, 15, v1
 v_lshlrev_b32 v5, 4, v5
 v_add_u32 v4, v4, v5
 v_lshrrev_b32 v5, 5, v1
 v_mul_u32_u24 v5, 512, v5
 v_add_u32 v4, v4, v5
 s_mul_i32 s22, s3, 9216
 v_lshlrev_b32 v5, 3, v1
 v_add_u32 v5, s22, v5
 v_mov_b32 v6, 0
 s_mov_b32 s23, 0x3f803f80
 s_add_u32 s22, s20, 0
 buffer_load_dwordx2 v[16:17], v2, s[8:11], s22 offen
 buffer_load_dwordx2 v[18:19], v3, s[8:11], s22 offen
 s_add_u32 s22, s20, 55296
 buffer_load_dwordx2 v[20:21], v2, s[8:11], s22 offen
 buffer_load_dwordx2 v[22:23], v3, s[8:11], s22 offen
 s_add_u32 s22, s20, 110592
 buffer_load_dwordx2 v[24:25], v2, s[8:11], s22 offen
 buffer_load_dwordx2 v[26:27], v3, s[8:11], s22 offen
 s_add_u32 s22, s20, 165888
 buffer_load_dwordx2 v[28:29], v2, s[8:11], s22 offen
 buffer_load_dwordx2 v[30:31], v3, s[8:11], s22 offen
 s_add_u32 s22, s20, 221184
 buffer_load_dwordx2 v[32:33], v2, s[8:11], s22 offen
 buffer_load_dwordx2 v[34:35], v3, s[8:11], s22 offen
 s_add_u32 s22, s20, 276480
 buffer_load_dwordx2 v[36:37], v2, s[8:11], s22 offen
 buffer_load_dwordx2 v[38:39], v3, s[8:11], s22 offen
 s_add_u32 s22, s20, 331776
 buffer_load_dwordx2 v[40:41], v2, s[8:11], s22 offen
 buffer_load_dwordx2 v[42:43], v3, s[8:11], s22 offen
 s_add_u32 s22, s20, 387072
 buffer_load_dwordx2 v[44:45], v2, s[8:11], s22 offen
 buffer_load_dwordx2 v[46:47], v3, s[8:11], s22 offen
 s_add_u32 s22, s20, 442368
 buffer_load_dwordx2 v[48:49], v2, s[8:11], s22 offen
 buffer_load_dwordx2 v[50:51], v3, s[8:11], s22 offen
 s_waitcnt vmcnt(16)
 ds_write_b64 v5, v[16:17] offset:0
 ds_write_b64 v5, v[18:19] offset:512
 s_waitcnt vmcnt(14)
 ds_write_b64 v5, v[20:21] offset:1024
 ds_write_b64 v5, v[22:23] offset:1536
 s_waitcnt vmcnt(12)
 ds_write_b64 v5, v[24:25] offset:2048
 ds_write_b64 v5, v[26:27] offset:2560
 s_waitcnt vmcnt(10)
 ds_write_b64 v5, v[28:29] offset:3072
 ds_write_b64 v5, v[30:31] offset:3584
 s_waitcnt vmcnt(8)
 ds_write_b64 v5, v[32:33] offset:4096
 ds_write_b64 v5, v[34:35] offset:4608
 s_waitcnt vmcnt(6)
 ds_write_b64 v5, v[36:37] offset:5120
 ds_write_b64 v5, v[38:39] offset:5632
 s_waitcnt vmcnt(4)
 ds_write_b64 v5, v[40:41] offset:6144
 ds_write_b64 v5, v[42:43] offset:6656
 s_waitcnt vmcnt(2)
 ds_write_b64 v5, v[44:45] offset:7168
 ds_write_b64 v5, v[46:47] offset:7680
 s_waitcnt vmcnt(0)
 ds_write_b64 v5, v[48:49] offset:8192
 ds_write_b64 v5, v[50:51] offset:8704
 s_waitcnt lgkmcnt(15)
 ds_read_b64_tr_b16 v[56:57], v5 offset:0
 ds_read_b64_tr_b16 v[58:59], v5 offset:512
 s_waitcnt lgkmcnt(15)
 ds_read_b64_tr_b16 v[60:61], v5 offset:1024
 ds_read_b64_tr_b16 v[62:63], v5 offset:1536
 s_waitcnt lgkmcnt(15)
 ds_read_b64_tr_b16 v[64:65], v5 offset:2048
 ds_read_b64_tr_b16 v[66:67], v5 offset:2560
 s_waitcnt lgkmcnt(15)
 ds_read_b64_tr_b16 v[68:69], v5 offset:3072
 ds_read_b64_tr_b16 v[70:71], v5 offset:3584
 s_waitcnt lgkmcnt(15)
 ds_read_b64_tr_b16 v[72:73], v5 offset:4096
 ds_read_b64_tr_b16 v[74:75], v5 offset:4608
 s_waitcnt lgkmcnt(15)
 ds_read_b64_tr_b16 v[76:77], v5 offset:5120
 ds_read_b64_tr_b16 v[78:79], v5 offset:5632
 s_waitcnt lgkmcnt(15)
 ds_read_b64_tr_b16 v[80:81], v5 offset:6144
 ds_read_b64_tr_b16 v[82:83], v5 offset:6656
 s_waitcnt lgkmcnt(15)
 ds_read_b64_tr_b16 v[84:85], v5 offset:7168
 ds_read_b64_tr_b16 v[86:87], v5 offset:7680
 s_waitcnt lgkmcnt(15)
 ds_read_b64_tr_b16 v[88:89], v5 offset:8192
 ds_read_b64_tr_b16 v[90:91], v5 offset:8704
 s_waitcnt lgkmcnt(15)
 s_add_u32 s22, s21, 0
 buffer_store_dwordx4 v[56:59], v4, s[4:7], s22 offen sc1
 v_dot2_f32_bf16 v6, v56, s23, v6
 v_dot2_f32_bf16 v6, v57, s23, v6
 v_dot2_f32_bf16 v6, v58, s23, v6
 v_dot2_f32_bf16 v6, v59, s23, v6
 s_waitcnt lgkmcnt(14)
 s_add_u32 s22, s21, 1024
 buffer_store_dwordx4 v[60:63], v4, s[4:7], s22 offen sc1
 v_dot2_f32_bf16 v6, v60, s23, v6
 v_dot2_f32_bf16 v6, v61, s23, v6
 v_dot2_f32_bf16 v6, v62, s23, v6
 v_dot2_f32_bf16 v6, v63, s23, v6
 s_waitcnt lgkmcnt(12)
 s_add_u32 s22, s21, 2048
 buffer_store_dwordx4 v[64:67], v4, s[4:7], s22 offen sc1
 v_dot2_f32_bf16 v6, v64, s23, v6
 v_dot2_f32_bf16 v6, v65, s23, v6
 v_dot2_f32_bf16 v6, v66, s23, v6
 v_dot2_f32_bf16 v6, v67, s23, v6
 s_waitcnt lgkmcnt(10)
 s_add_u32 s22, s21, 3072
 buffer_store_dwordx4 v[68:71], v4, s[4:7], s22 offen sc1
 v_dot2_f32_bf16 v6, v68, s23, v6
 v_dot2_f32_bf16 v6, v69, s23, v6
 v_dot2_f32_bf16 v6, v70, s23, v6
 v_dot2_f32_bf16 v6, v71, s23, v6
 s_waitcnt lgkmcnt(8)
 s_add_u32 s22, s21, 4096
 buffer_store_dwordx4 v[72:75], v4, s[4:7], s22 offen sc1
 v_dot2_f32_bf16 v6, v72, s23, v6
 v_dot2_f32_bf16 v6, v73, s23, v6
 v_dot2_f32_bf16 v6, v74, s23, v6
 v_dot2_f32_bf16 v6, v75, s23, v6
 s_waitcnt lgkmcnt(6)
 s_add_u32 s22, s21, 5120
 buffer_store_dwordx4 v[76:79], v4, s[4:7], s22 offen sc1
 v_dot2_f32_bf16 v6, v76, s23, v6
 v_dot2_f32_bf16 v6, v77, s23, v6
 v_dot2_f32_bf16 v6, v78, s23, v6
 v_dot2_f32_bf16 v6, v79, s23, v6
 s_waitcnt lgkmcnt(4)
 s_add_u32 s22, s21, 6144
 buffer_store_dwordx4 v[80:83], v4, s[4:7], s22 offen sc1
 v_dot2_f32_bf16 v6, v80, s23, v6
 v_dot2_f32_bf16 v6, v81, s23, v6
 v_dot2_f32_bf16 v6, v82, s23, v6
 v_dot2_f32_bf16 v6, v83, s23, v6
 s_waitcnt lgkmcnt(2)
 s_add_u32 s22, s21, 7168
 buffer_store_dwordx4 v[84:87], v4, s[4:7], s22 offen sc1
 v_dot2_f32_bf16 v6, v84, s23, v6
 v_dot2_f32_bf16 v6, v85, s23, v6
 v_dot2_f32_bf16 v6, v86, s23, v6
 v_dot2_f32_bf16 v6, v87, s23, v6
 s_waitcnt lgkmcnt(0)
 s_add_u32 s22, s21, 8192
 buffer_store_dwordx4 v[88:91], v4, s[4:7], s22 offen sc1
 v_dot2_f32_bf16 v6, v88, s23, v6
 v_dot2_f32_bf16 v6, v89, s23, v6
 v_dot2_f32_bf16 v6, v90, s23, v6
 v_dot2_f32_bf16 v6, v91, s23, v6
 s_lshl_b32 s22, s3, 8
 v_lshlrev_b32 v7, 2, v1
 v_add_u32 v7, s22, v7
 s_nop 2
 ds_write_b32 v7, v6 offset:40960
 s_waitcnt lgkmcnt(0)
 s_barrier
 s_cmp_lg_u32 s3, 0
 s_cbranch_scc1 K0_END
 v_and_b32 v7, 31, v1
 v_lshlrev_b32 v7, 2, v7
 ds_read_b32 v8, v7 offset:40960
 ds_read_b32 v9, v7 offset:41088
 ds_read_b32 v10, v7 offset:41216
 ds_read_b32 v11, v7 offset:41344
 ds_read_b32 v12, v7 offset:41472
 ds_read_b32 v13, v7 offset:41600
 ds_read_b32 v14, v7 offset:41728
 ds_read_b32 v15, v7 offset:41856
 s_waitcnt lgkmcnt(0)
 v_add_f32 v8, v8, v9
 v_add_f32 v10, v10, v11
 v_add_f32 v12, v12, v13
 v_add_f32 v14, v14, v15
 v_add_f32 v8, v8, v10
 v_add_f32 v12, v12, v14
 v_add_f32 v8, v8, v12
 v_sub_f32 v8, 0, v8
 v_cvt_pk_bf16_f32 v9, v8, v8
 v_lshlrev_b32 v9, 16, v9
 v_sub_f32 v8, v8, v9
 v_cvt_pk_bf16_f32 v10, v8, v8
 v_lshlrev_b32 v10, 16, v10
 v_sub_f32 v11, v8, v10
 v_cvt_pk_bf16_f32 v12, v9, v10
 v_cvt_pk_bf16_f32 v13, v9, v11
 v_cvt_pk_bf16_f32 v14, v10, v9
 v_mov_b32 v15, 0
 v_cmp_gt_u32 vcc, 32, v1
 s_nop 1
 v_cndmask_b32 v12, 0, v12, vcc
 v_cndmask_b32 v13, 0, v13, vcc
 v_cndmask_b32 v14, 0, v14, vcc
 s_add_u32 s22, s21, 36864
 buffer_store_dwordx4 v[12:15], v4, s[4:7], s22 offen sc1
 s_branch K0_END
K0_wom:
 s_mov_b32 s8, s68
 s_and_b32 s9, s69, 0xffff
 s_mov_b32 s10, 663552
 s_mov_b32 s11, 0x00020000
 s_mul_i32 s20, s3, 165888
 s_lshl_b32 s25, s24, 6
 s_add_u32 s20, s20, s25
 s_lshl_b32 s21, s3, 12
 s_mul_i32 s25, s24, 36864
 s_add_u32 s21, s21, s25
 s_add_u32 s21, s21, 69402624
 v_and_b32 v1, 63, v0
 v_lshrrev_b32 v2, 5, v1
 v_lshlrev_b32 v2, 3, v2
 v_bfe_u32 v3, v1, 2, 2
 v_add_u32 v2, v2, v3
 s_mov_b32 s22, 1152
 v_mul_lo_u32 v2, v2, s22
 v_bfe_u32 v3, v1, 4, 1
 v_mul_u32_u24 v3, 32, v3
 v_add_u32 v2, v2, v3
 v_and_b32 v3, 1, v1
 v_mul_u32_u24 v3, 8, v3
 v_add_u32 v2, v2, v3
 v_bfe_u32 v3, v1, 1, 1
 v_mul_u32_u24 v3, 16, v3
 v_add_u32 v2, v2, v3
 v_add_u32 v3, 4608, v2
 v_bfe_u32 v4, v1, 4, 1
 s_mov_b32 s22, 18432
 v_mul_lo_u32 v4, v4, s22
 v_and_b32 v5, 15, v1
 v_lshlrev_b32 v5, 4, v5
 v_add_u32 v4, v4, v5
 v_lshrrev_b32 v5, 5, v1
 v_mul_u32_u24 v5, 256, v5
 v_add_u32 v4, v4, v5
 s_mul_i32 s22, s3, 9216
 v_lshlrev_b32 v5, 3, v1
 v_add_u32 v5, s22, v5
 v_mov_b32 v6, 0
 s_mov_b32 s23, 0x3f803f80
 s_add_u32 s22, s20, 0
 buffer_load_dwordx2 v[16:17], v2, s[8:11], s22 offen
 buffer_load_dwordx2 v[18:19], v3, s[8:11], s22 offen
 s_add_u32 s22, s20, 20736
 buffer_load_dwordx2 v[20:21], v2, s[8:11], s22 offen
 buffer_load_dwordx2 v[22:23], v3, s[8:11], s22 offen
 s_add_u32 s22, s20, 41472
 buffer_load_dwordx2 v[24:25], v2, s[8:11], s22 offen
 buffer_load_dwordx2 v[26:27], v3, s[8:11], s22 offen
 s_add_u32 s22, s20, 62208
 buffer_load_dwordx2 v[28:29], v2, s[8:11], s22 offen
 buffer_load_dwordx2 v[30:31], v3, s[8:11], s22 offen
 s_add_u32 s22, s20, 82944
 buffer_load_dwordx2 v[32:33], v2, s[8:11], s22 offen
 buffer_load_dwordx2 v[34:35], v3, s[8:11], s22 offen
 s_add_u32 s22, s20, 103680
 buffer_load_dwordx2 v[36:37], v2, s[8:11], s22 offen
 buffer_load_dwordx2 v[38:39], v3, s[8:11], s22 offen
 s_add_u32 s22, s20, 124416
 buffer_load_dwordx2 v[40:41], v2, s[8:11], s22 offen
 buffer_load_dwordx2 v[42:43], v3, s[8:11], s22 offen
 s_add_u32 s22, s20, 145152
 buffer_load_dwordx2 v[44:45], v2, s[8:11], s22 offen
 buffer_load_dwordx2 v[46:47], v3, s[8:11], s22 offen
 s_waitcnt vmcnt(14)
 ds_write_b64 v5, v[16:17] offset:0
 ds_write_b64 v5, v[18:19] offset:512
 s_waitcnt vmcnt(12)
 ds_write_b64 v5, v[20:21] offset:1024
 ds_write_b64 v5, v[22:23] offset:1536
 s_waitcnt vmcnt(10)
 ds_write_b64 v5, v[24:25] offset:2048
 ds_write_b64 v5, v[26:27] offset:2560
 s_waitcnt vmcnt(8)
 ds_write_b64 v5, v[28:29] offset:3072
 ds_write_b64 v5, v[30:31] offset:3584
 s_waitcnt vmcnt(6)
 ds_write_b64 v5, v[32:33] offset:4096
 ds_write_b64 v5, v[34:35] offset:4608
 s_waitcnt vmcnt(4)
 ds_write_b64 v5, v[36:37] offset:5120
 ds_write_b64 v5, v[38:39] offset:5632
 s_waitcnt vmcnt(2)
 ds_write_b64 v5, v[40:41] offset:6144
 ds_write_b64 v5, v[42:43] offset:6656
 s_waitcnt vmcnt(0)
 ds_write_b64 v5, v[44:45] offset:7168
 ds_write_b64 v5, v[46:47] offset:7680
 s_waitcnt lgkmcnt(14)
 ds_read_b64_tr_b16 v[56:57], v5 offset:0
 ds_read_b64_tr_b16 v[58:59], v5 offset:512
 s_waitcnt lgkmcnt(14)
 ds_read_b64_tr_b16 v[60:61], v5 offset:1024
 ds_read_b64_tr_b16 v[62:63], v5 offset:1536
 s_waitcnt lgkmcnt(14)
 ds_read_b64_tr_b16 v[64:65], v5 offset:2048
 ds_read_b64_tr_b16 v[66:67], v5 offset:2560
 s_waitcnt lgkmcnt(14)
 ds_read_b64_tr_b16 v[68:69], v5 offset:3072
 ds_read_b64_tr_b16 v[70:71], v5 offset:3584
 s_waitcnt lgkmcnt(14)
 ds_read_b64_tr_b16 v[72:73], v5 offset:4096
 ds_read_b64_tr_b16 v[74:75], v5 offset:4608
 s_waitcnt lgkmcnt(14)
 ds_read_b64_tr_b16 v[76:77], v5 offset:5120
 ds_read_b64_tr_b16 v[78:79], v5 offset:5632
 s_waitcnt lgkmcnt(14)
 ds_read_b64_tr_b16 v[80:81], v5 offset:6144
 ds_read_b64_tr_b16 v[82:83], v5 offset:6656
 s_waitcnt lgkmcnt(14)
 ds_read_b64_tr_b16 v[84:85], v5 offset:7168
 ds_read_b64_tr_b16 v[86:87], v5 offset:7680
 s_waitcnt lgkmcnt(14)
 s_add_u32 s22, s21, 0
 buffer_store_dwordx4 v[56:59], v4, s[4:7], s22 offen sc1
 s_waitcnt lgkmcnt(12)
 s_add_u32 s22, s21, 512
 buffer_store_dwordx4 v[60:63], v4, s[4:7], s22 offen sc1
 s_waitcnt lgkmcnt(10)
 s_add_u32 s22, s21, 1024
 buffer_store_dwordx4 v[64:67], v4, s[4:7], s22 offen sc1
 s_waitcnt lgkmcnt(8)
 s_add_u32 s22, s21, 1536
 buffer_store_dwordx4 v[68:71], v4, s[4:7], s22 offen sc1
 s_waitcnt lgkmcnt(6)
 s_add_u32 s22, s21, 2048
 buffer_store_dwordx4 v[72:75], v4, s[4:7], s22 offen sc1
 s_waitcnt lgkmcnt(4)
 s_add_u32 s22, s21, 2560
 buffer_store_dwordx4 v[76:79], v4, s[4:7], s22 offen sc1
 s_waitcnt lgkmcnt(2)
 s_add_u32 s22, s21, 3072
 buffer_store_dwordx4 v[80:83], v4, s[4:7], s22 offen sc1
 s_waitcnt lgkmcnt(0)
 s_add_u32 s22, s21, 3584
 buffer_store_dwordx4 v[84:87], v4, s[4:7], s22 offen sc1
 s_branch K0_END
K0_woe:
 s_mov_b32 s8, s68
 s_and_b32 s9, s69, 0xffff
 s_mov_b32 s10, 663552
 s_mov_b32 s11, 0x00020000
 s_mul_i32 s20, s3, 165888
 s_add_u32 s20, s20, 18432
 s_mul_i32 s25, s24, 576
 s_add_u32 s20, s20, s25
 s_lshl_b32 s21, s3, 9
 s_add_u32 s21, s21, 69419008
 s_mul_i32 s25, s24, 331776
 s_add_u32 s21, s21, s25
 v_and_b32 v1, 63, v0
 v_lshrrev_b32 v2, 5, v1
 v_lshlrev_b32 v2, 3, v2
 v_bfe_u32 v3, v1, 2, 2
 v_add_u32 v2, v2, v3
 v_lshrrev_b32 v3, 1, v2
 v_mul_u32_u24 v3, 18, v3
 v_and_b32 v2, 1, v2
 v_add_u32 v2, v2, v3
 s_mov_b32 s22, 1152
 v_mul_lo_u32 v2, v2, s22
 v_bfe_u32 v3, v1, 4, 1
 v_mul_u32_u24 v3, 32, v3
 v_add_u32 v2, v2, v3
 v_and_b32 v3, 1, v1
 v_mul_u32_u24 v3, 8, v3
 v_add_u32 v2, v2, v3
 v_bfe_u32 v3, v1, 1, 1
 v_mul_u32_u24 v3, 16, v3
 v_add_u32 v2, v2, v3
 v_add_u32 v3, 41472, v2
 v_bfe_u32 v4, v1, 4, 1
 s_mov_b32 s22, 18432
 v_mul_lo_u32 v4, v4, s22
 v_and_b32 v5, 15, v1
 v_lshlrev_b32 v5, 4, v5
 v_add_u32 v4, v4, v5
 v_lshrrev_b32 v5, 5, v1
 v_mul_u32_u24 v5, 256, v5
 v_add_u32 v4, v4, v5
 s_mul_i32 s22, s3, 9216
 v_lshlrev_b32 v5, 3, v1
 v_add_u32 v5, s22, v5
 v_mov_b32 v6, 0
 s_mov_b32 s23, 0x3f803f80
 s_add_u32 s22, s20, 0
 buffer_load_dwordx2 v[16:17], v2, s[8:11], s22 offen
 buffer_load_dwordx2 v[18:19], v3, s[8:11], s22 offen
 s_add_u32 s22, s20, 64
 buffer_load_dwordx2 v[20:21], v2, s[8:11], s22 offen
 buffer_load_dwordx2 v[22:23], v3, s[8:11], s22 offen
 s_add_u32 s22, s20, 128
 buffer_load_dwordx2 v[24:25], v2, s[8:11], s22 offen
 buffer_load_dwordx2 v[26:27], v3, s[8:11], s22 offen
 s_add_u32 s22, s20, 192
 buffer_load_dwordx2 v[28:29], v2, s[8:11], s22 offen
 buffer_load_dwordx2 v[30:31], v3, s[8:11], s22 offen
 s_add_u32 s22, s20, 256
 buffer_load_dwordx2 v[32:33], v2, s[8:11], s22 offen
 buffer_load_dwordx2 v[34:35], v3, s[8:11], s22 offen
 s_add_u32 s22, s20, 320
 buffer_load_dwordx2 v[36:37], v2, s[8:11], s22 offen
 buffer_load_dwordx2 v[38:39], v3, s[8:11], s22 offen
 s_add_u32 s22, s20, 384
 buffer_load_dwordx2 v[40:41], v2, s[8:11], s22 offen
 buffer_load_dwordx2 v[42:43], v3, s[8:11], s22 offen
 s_add_u32 s22, s20, 448
 buffer_load_dwordx2 v[44:45], v2, s[8:11], s22 offen
 buffer_load_dwordx2 v[46:47], v3, s[8:11], s22 offen
 s_add_u32 s22, s20, 512
 buffer_load_dwordx2 v[48:49], v2, s[8:11], s22 offen
 buffer_load_dwordx2 v[50:51], v3, s[8:11], s22 offen
 s_waitcnt vmcnt(16)
 ds_write_b64 v5, v[16:17] offset:0
 ds_write_b64 v5, v[18:19] offset:512
 s_waitcnt vmcnt(14)
 ds_write_b64 v5, v[20:21] offset:1024
 ds_write_b64 v5, v[22:23] offset:1536
 s_waitcnt vmcnt(12)
 ds_write_b64 v5, v[24:25] offset:2048
 ds_write_b64 v5, v[26:27] offset:2560
 s_waitcnt vmcnt(10)
 ds_write_b64 v5, v[28:29] offset:3072
 ds_write_b64 v5, v[30:31] offset:3584
 s_waitcnt vmcnt(8)
 ds_write_b64 v5, v[32:33] offset:4096
 ds_write_b64 v5, v[34:35] offset:4608
 s_waitcnt vmcnt(6)
 ds_write_b64 v5, v[36:37] offset:5120
 ds_write_b64 v5, v[38:39] offset:5632
 s_waitcnt vmcnt(4)
 ds_write_b64 v5, v[40:41] offset:6144
 ds_write_b64 v5, v[42:43] offset:6656
 s_waitcnt vmcnt(2)
 ds_write_b64 v5, v[44:45] offset:7168
 ds_write_b64 v5, v[46:47] offset:7680
 s_waitcnt vmcnt(0)
 ds_write_b64 v5, v[48:49] offset:8192
 ds_write_b64 v5, v[50:51] offset:8704
 s_waitcnt lgkmcnt(15)
 ds_read_b64_tr_b16 v[56:57], v5 offset:0
 ds_read_b64_tr_b16 v[58:59], v5 offset:512
 s_waitcnt lgkmcnt(15)
 ds_read_b64_tr_b16 v[60:61], v5 offset:1024
 ds_read_b64_tr_b16 v[62:63], v5 offset:1536
 s_waitcnt lgkmcnt(15)
 ds_read_b64_tr_b16 v[64:65], v5 offset:2048
 ds_read_b64_tr_b16 v[66:67], v5 offset:2560
 s_waitcnt lgkmcnt(15)
 ds_read_b64_tr_b16 v[68:69], v5 offset:3072
 ds_read_b64_tr_b16 v[70:71], v5 offset:3584
 s_waitcnt lgkmcnt(15)
 ds_read_b64_tr_b16 v[72:73], v5 offset:4096
 ds_read_b64_tr_b16 v[74:75], v5 offset:4608
 s_waitcnt lgkmcnt(15)
 ds_read_b64_tr_b16 v[76:77], v5 offset:5120
 ds_read_b64_tr_b16 v[78:79], v5 offset:5632
 s_waitcnt lgkmcnt(15)
 ds_read_b64_tr_b16 v[80:81], v5 offset:6144
 ds_read_b64_tr_b16 v[82:83], v5 offset:6656
 s_waitcnt lgkmcnt(15)
 ds_read_b64_tr_b16 v[84:85], v5 offset:7168
 ds_read_b64_tr_b16 v[86:87], v5 offset:7680
 s_waitcnt lgkmcnt(15)
 ds_read_b64_tr_b16 v[88:89], v5 offset:8192
 ds_read_b64_tr_b16 v[90:91], v5 offset:8704
 s_waitcnt lgkmcnt(15)
 s_add_u32 s22, s21, 0
 buffer_store_dwordx4 v[56:59], v4, s[4:7], s22 offen sc1
 s_waitcnt lgkmcnt(14)
 s_add_u32 s22, s21, 36864
 buffer_store_dwordx4 v[60:63], v4, s[4:7], s22 offen sc1
 s_waitcnt lgkmcnt(12)
 s_add_u32 s22, s21, 73728
 buffer_store_dwordx4 v[64:67], v4, s[4:7], s22 offen sc1
 s_waitcnt lgkmcnt(10)
 s_add_u32 s22, s21, 110592
 buffer_store_dwordx4 v[68:71], v4, s[4:7], s22 offen sc1
 s_waitcnt lgkmcnt(8)
 s_add_u32 s22, s21, 147456
 buffer_store_dwordx4 v[72:75], v4, s[4:7], s22 offen sc1
 s_waitcnt lgkmcnt(6)
 s_add_u32 s22, s21, 184320
 buffer_store_dwordx4 v[76:79], v4, s[4:7], s22 offen sc1
 s_waitcnt lgkmcnt(4)
 s_add_u32 s22, s21, 221184
 buffer_store_dwordx4 v[80:83], v4, s[4:7], s22 offen sc1
 s_waitcnt lgkmcnt(2)
 s_add_u32 s22, s21, 258048
 buffer_store_dwordx4 v[84:87], v4, s[4:7], s22 offen sc1
 s_waitcnt lgkmcnt(0)
 s_add_u32 s22, s21, 294912
 buffer_store_dwordx4 v[88:91], v4, s[4:7], s22 offen sc1
 s_branch K0_END
K0_ones:
 v_lshrrev_b32 v1, 5, v0
 v_mul_u32_u24 v1, 18944, v1
 v_and_b32 v2, 31, v0
 v_mul_u32_u24 v2, 304, v2
 v_add_u32 v1, v1, v2
 s_mul_i32 s22, s24, 151552
 s_add_u32 s22, s22, 13378848
 v_mov_b32 v8, 0x3f803f80
 v_mov_b32 v9, 0x3f803f80
 v_mov_b32 v10, 0x3f803f80
 v_mov_b32 v11, 0x3f803f80
 buffer_store_dwordx4 v[8:11], v1, s[4:7], s22 offen sc1
 s_add_u32 s22, s22, 7217152
 buffer_store_dwordx4 v[8:11], v1, s[4:7], s22 offen sc1
 s_branch K0_END
K0_zero:
 v_lshlrev_b32 v2, 7, v0
 v_mov_b32 v12, 0
 s_lshl_b32 s22, s24, 17
 s_add_u32 s22, s22, 9961472
 buffer_store_dword v12, v2, s[4:7], s22 offen sc1
 s_add_u32 s22, s22, 32768
 buffer_store_dword v12, v2, s[4:7], s22 offen sc1
 s_add_u32 s22, s22, 32768
 buffer_store_dword v12, v2, s[4:7], s22 offen sc1
 s_add_u32 s22, s22, 32768
 s_cmp_eq_u32 s24, 1
 s_cselect_b32 s22, 0x7fff0000, s22
 buffer_store_dword v12, v2, s[4:7], s22 offen sc1
 s_add_u32 s22, s22, 32768
 s_branch K0_END
K0_zeroa:
 v_lshlrev_b32 v2, 7, v0
 v_mov_b32 v12, 0
 s_mov_b32 s22, 10190848
 buffer_store_dword v12, v2, s[4:7], s22 offen sc1
 s_waitcnt vmcnt(0)
 s_lshl_b32 s22, s3, 2
 v_mov_b32 v12, 1
 v_mov_b32 v2, 0
 s_mov_b64 exec, 1
 buffer_store_dword v12, v2, s[16:19], s22 offen sc1
 s_mov_b64 exec, -1
K0_END:
 s_cmp_lt_u32 s2, 152
 s_cbranch_scc1 KM_NOPF
 s_lshr_b32 s29, s2, 3
 s_sub_u32 s29, s29, 19
 s_lshl_b32 s29, s29, 2
 s_add_u32 s29, s29, s3
 v_and_b32 v1, 63, v0
 v_lshlrev_b32 v1, 4, v1
 s_getpc_b64 s[12:13]
PF0:
 s_sub_u32 s12, s12, PF0-ATB_BEGIN
 s_subb_u32 s13, s13, 0
 s_and_b32 s13, s13, 0xffff
 s_mov_b32 s14, CODE_END-ATB_BEGIN
 s_mov_b32 s15, 0x00020000
 s_lshl_b32 s29, s29, 10
 buffer_load_dwordx4 v[248:251], v1, s[12:15], s29 offen
 s_add_u32 s29, s29, 53248
 buffer_load_dwordx4 v[248:251], v1, s[12:15], s29 offen
 s_add_u32 s29, s29, 53248
 buffer_load_dwordx4 v[248:251], v1, s[12:15], s29 offen
KM_NOPF:
 s_cmp_lg_u32 s3, 1
 s_cbranch_scc1 KM_NOTK
 s_getreg_b32 s26, hwreg(HW_REG_XCC_ID)
 s_and_b32 s26, s26, 7
 s_mov_b32 s27, 8
 v_mov_b32 v28, 0
 s_mov_b64 exec, 1
KM_TK:
 v_mov_b32 v29, 1
 s_lshl_b32 s28, s26, 2
 s_add_u32 s28, s28, 128
 buffer_atomic_add v29, v28, s[16:19], s28 offen sc0
 s_waitcnt vmcnt(0)
 v_readfirstlane_b32 s29, v29
 s_nop 0
 s_cmp_lt_u32 s29, 32
 s_cbranch_scc1 KM_TKOK
 s_add_u32 s26, s26, 1
 s_and_b32 s26, s26, 7
 s_sub_u32 s27, s27, 1
 s_cmp_lg_u32 s27, 0
 s_cbranch_scc1 KM_TK
KM_TKOK:
 s_lshl_b32 s29, s29, 3
 s_add_u32 s29, s29, s26
 s_and_b32 s29, s29, 255
 v_mov_b32 v29, s29
 v_mov_b32 v28, 163824
 ds_write_b32 v28, v29
 s_mov_b64 exec, -1
KM_NOTK:
 v_and_b32 v30, 3, v0
 v_lshlrev_b32 v30, 2, v30
 s_mov_b32 s39, 0x20000
 s_mov_b64 exec, 0xf
ZRDY:
 buffer_load_dword v31, v30, s[16:19], 0 offen sc1
 s_waitcnt vmcnt(0)
 v_cmp_ne_u32 vcc, 1, v31
 s_nop 1
 s_and_b64 exec, exec, vcc
 s_cbranch_scc0 ZRDY_X
 s_sleep 4
 s_sub_u32 s39, s39, 1
 s_cmp_lg_u32 s39, 0
 s_cbranch_scc1 ZRDY
ZRDY_X:
 s_mov_b64 exec, -1
 s_waitcnt lgkmcnt(0)
 s_barrier
 v_mov_b32 v28, 163824
 ds_read_b32 v29, v28
 s_cmp_ge_u32 s2, 190
 s_cbranch_scc1 KM_NOSIG
 s_lshl_b32 s24, s2, 2
 s_add_u32 s24, s24, 7168
 s_cmp_lg_u32 s3, 0
 s_cbranch_scc1 SIG0
 s_mov_b64 exec, 1
 v_mov_b32 v30, 0
 v_mov_b32 v31, 1
 s_lshl_b32 s38, s24, 5
 s_add_u32 s38, s38, 9961472
 buffer_store_dword v31, v30, s[4:7], s38 offen sc1
 s_mov_b64 exec, -1
SIG0:
KM_NOSIG:
 s_waitcnt lgkmcnt(0)
 v_readfirstlane_b32 s2, v29
 s_nop 0
 s_and_b32 s2, s2, 255
 s_mov_b32 s8, s84
 s_and_b32 s9, s85, 0xffff
 s_mov_b32 s10, 2359296
 s_mov_b32 s11, 0x00020000
 s_and_b32 s24, s2, 7
 s_lshr_b32 s25, s2, 3
 s_lshr_b32 s86, s24, 1
 s_lshl_b32 s86, s86, 2
 s_and_b32 s27, s25, 3
 s_add_u32 s86, s86, s27
 s_and_b32 s87, s24, 1
 s_lshl_b32 s87, s87, 3
 s_lshr_b32 s34, s25, 2
 s_add_u32 s87, s87, s34
 s_lshl_b32 s78, s3, 10
 s_lshl_b32 s34, s87, 2
 s_mul_i32 s35, s87, 3
 s_add_u32 s35, s35, 9
 s_cmp_ge_u32 s87, 9
 s_cselect_b32 s34, s35, s34
 s_cmp_eq_u32 s87, 15
 s_cselect_b32 s34, 34, s34
 s_mul_i32 s76, s34, 37888
 s_add_u32 s76, s76, 56442880
 s_add_u32 s77, s76, s78
 v_and_b32 v1, 63, v0
 v_lshlrev_b32 v1, 4, v1
 s_lshl_b32 s24, s87, 2
 s_add_u32 s24, s24, 64
 s_mov_b32 s25, 3
 s_mul_i32 s26, s87, 3
 s_add_u32 s26, s26, 85
 s_cmp_ge_u32 s87, 9
 s_cselect_b32 s24, s26, s24
 s_cselect_b32 s25, 2, s25
 s_cmp_eq_u32 s87, 8
 s_cselect_b32 s25, 7, s25
 s_cmp_eq_u32 s87, 15
 s_cselect_b32 s24, 104, s24
 s_cselect_b32 s25, 7, s25
 v_and_b32 v30, 7, v0
 v_min_u32 v30, s25, v30
 v_add_u32 v30, s24, v30
 s_lshl_b32 s26, s86, 2
 s_add_u32 s26, s26, s3
 v_mov_b32 v31, s26
 v_and_b32 v29, 8, v0
 v_cmp_eq_u32 vcc, 8, v29
 s_nop 1
 v_cndmask_b32 v30, v30, v31, vcc
 v_lshlrev_b32 v30, 7, v30
 s_mov_b32 s38, 10190848
 s_mov_b32 s39, 0x20000
 s_mov_b64 exec, 0x1ff
PRDY:
 buffer_load_dword v31, v30, s[4:7], s38 offen sc1
 s_waitcnt vmcnt(0)
 v_cmp_ne_u32 vcc, 1, v31
 s_nop 1
 s_and_b64 exec, exec, vcc
 s_cbranch_scc0 PRDY_X
 s_sleep 4
 s_sub_u32 s39, s39, 1
 s_cmp_lg_u32 s39, 0
 s_cbranch_scc1 PRDY
PRDY_X:
 s_mov_b64 exec, -1
 v_mov_b32 v2, v1
 v_add_u32 v3, 0x10000, v1
 v_add_u32 v4, 0x20000, v1
 s_lshl_b32 s26, s86, 2
 s_add_u32 s26, s26, s3
 s_mov_b32 s27, s87
 s_mul_i32 s23, s26, 36864
 s_add_u32 s23, s23, s42
 s_add_u32 s23, s23, 0
 s_lshl_b32 s29, s26, 11
 s_add_u32 s29, s29, s43
 s_add_u32 s29, s29, 0
 s_lshr_b32 s31, s26, 3
 s_mul_i32 s31, s31, 18944
 s_add_u32 s31, s31, 13369344
 s_add_u32 s31, s31, s100
 s_lshr_b32 s24, s26, 1
 s_lshl_b32 s24, s24, 5
 s_add_u32 s24, s24, s41
 s_add_u32 s24, s24, 2048
 s_and_b32 s32, s27, 7
 s_cmp_eq_u32 s27, 8
 s_cbranch_scc1 K1S_EXT
 s_cmp_eq_u32 s27, 15
 s_cbranch_scc1 K1S_EXT
 s_cmp_ge_u32 s27, 9
 s_cbranch_scc1 K1S_V
 s_add_u32 s38, s77, 0
 s_add_u32 m0, s78, 0
 s_nop 0
 buffer_load_dwordx4 v1, s[4:7], s38 offen sc1 lds
 s_add_u32 s38, s77, 37888
 s_add_u32 m0, s78, 37888
 s_nop 0
 buffer_load_dwordx4 v1, s[4:7], s38 offen sc1 lds
 s_add_u32 s38, s77, 75776
 s_add_u32 m0, s78, 75776
 s_nop 0
 buffer_load_dwordx4 v1, s[4:7], s38 offen sc1 lds
 s_add_u32 s38, s77, 113664
 s_add_u32 m0, s78, 113664
 s_nop 0
 buffer_load_dwordx4 v1, s[4:7], s38 offen sc1 lds
 s_add_u32 s30, s23, 0
 buffer_load_dwordx4 a[0:3], v1, s[4:7], s30 offen offset:0 sc1
 s_add_u32 s30, s23, 0
 buffer_load_dwordx4 a[4:7], v1, s[4:7], s30 offen offset:1024 sc1
 s_add_u32 s30, s23, 0
 buffer_load_dwordx4 a[8:11], v1, s[4:7], s30 offen offset:2048 sc1
 s_add_u32 s30, s23, 0
 buffer_load_dwordx4 a[12:15], v1, s[4:7], s30 offen offset:3072 sc1
 v_and_b32 v12, 15, v0
 v_lshlrev_b32 v12, 3, v12
 v_bfe_u32 v13, v0, 4, 1
 v_lshlrev_b32 v13, 10, v13
 v_add_u32 v12, v12, v13
 buffer_load_dwordx2 v[16:17], v12, s[4:7], s29 offen offset:0 sc1
 buffer_load_dwordx2 v[18:19], v12, s[4:7], s29 offen offset:128 sc1
 buffer_load_dwordx2 v[20:21], v12, s[4:7], s29 offen offset:256 sc1
 buffer_load_dwordx2 v[22:23], v12, s[4:7], s29 offen offset:384 sc1
 buffer_load_dwordx2 v[24:25], v12, s[4:7], s29 offen offset:512 sc1
 buffer_load_dwordx2 v[26:27], v12, s[4:7], s29 offen offset:640 sc1
 buffer_load_dwordx2 v[28:29], v12, s[4:7], s29 offen offset:768 sc1
 buffer_load_dwordx2 v[30:31], v12, s[4:7], s29 offen offset:896 sc1
 s_add_u32 s38, s77, 4096
 s_add_u32 m0, s78, 4096
 s_nop 0
 buffer_load_dwordx4 v1, s[4:7], s38 offen sc1 lds
 s_add_u32 s38, s77, 41984
 s_add_u32 m0, s78, 41984
 s_nop 0
 buffer_load_dwordx4 v1, s[4:7], s38 offen sc1 lds
 s_add_u32 s38, s77, 79872
 s_add_u32 m0, s78, 79872
 s_nop 0
 buffer_load_dwordx4 v1, s[4:7], s38 offen sc1 lds
 s_add_u32 s38, s77, 117760
 s_add_u32 m0, s78, 117760
 s_nop 0
 buffer_load_dwordx4 v1, s[4:7], s38 offen sc1 lds
 s_add_u32 s30, s23, 4096
 buffer_load_dwordx4 a[16:19], v1, s[4:7], s30 offen offset:0 sc1
 s_add_u32 s30, s23, 4096
 buffer_load_dwordx4 a[20:23], v1, s[4:7], s30 offen offset:1024 sc1
 s_add_u32 s30, s23, 4096
 buffer_load_dwordx4 a[24:27], v1, s[4:7], s30 offen offset:2048 sc1
 s_add_u32 s30, s23, 4096
 buffer_load_dwordx4 a[28:31], v1, s[4:7], s30 offen offset:3072 sc1
 s_add_u32 s38, s77, 8192
 s_add_u32 m0, s78, 8192
 s_nop 0
 buffer_load_dwordx4 v1, s[4:7], s38 offen sc1 lds
 s_add_u32 s38, s77, 46080
 s_add_u32 m0, s78, 46080
 s_nop 0
 buffer_load_dwordx4 v1, s[4:7], s38 offen sc1 lds
 s_add_u32 s38, s77, 83968
 s_add_u32 m0, s78, 83968
 s_nop 0
 buffer_load_dwordx4 v1, s[4:7], s38 offen sc1 lds
 s_add_u32 s38, s77, 121856
 s_add_u32 m0, s78, 121856
 s_nop 0
 buffer_load_dwordx4 v1, s[4:7], s38 offen sc1 lds
 s_add_u32 s30, s23, 8192
 buffer_load_dwordx4 a[32:35], v1, s[4:7], s30 offen offset:0 sc1
 s_add_u32 s30, s23, 8192
 buffer_load_dwordx4 a[36:39], v1, s[4:7], s30 offen offset:1024 sc1
 s_add_u32 s30, s23, 8192
 buffer_load_dwordx4 a[40:43], v1, s[4:7], s30 offen offset:2048 sc1
 s_add_u32 s30, s23, 8192
 buffer_load_dwordx4 a[44:47], v1, s[4:7], s30 offen offset:3072 sc1
 s_waitcnt vmcnt(28)
 s_barrier
 ds_read_b128 v[32:35], v2 offset:0
 ds_read_b128 v[36:39], v2 offset:37888
 ds_read_b128 v[40:43], v3 offset:10240
 ds_read_b128 v[44:47], v3 offset:48128
 ds_read_b128 v[48:51], v2 offset:1024
 ds_read_b128 v[52:55], v2 offset:38912
 ds_read_b128 v[56:59], v3 offset:11264
 s_waitcnt vmcnt(27) lgkmcnt(6)
 v_mfma_f32_32x32x16_bf16 v[64:79], v[32:35], a[0:3], 0
 s_add_u32 s38, s77, 12288
 s_add_u32 m0, s78, 12288
 s_nop 0
 buffer_load_dwordx4 v1, s[4:7], s38 offen sc1 lds
 ds_read_b128 v[60:63], v3 offset:49152
 s_waitcnt lgkmcnt(6)
 v_mfma_f32_32x32x16_bf16 v[80:95], v[36:39], a[0:3], 0
 s_add_u32 s38, s77, 50176
 s_add_u32 m0, s78, 50176
 s_nop 0
 buffer_load_dwordx4 v1, s[4:7], s38 offen sc1 lds
 ds_read_b128 v[32:35], v2 offset:2048
 s_waitcnt lgkmcnt(6)
 v_mfma_f32_32x32x16_bf16 v[96:111], v[40:43], a[0:3], 0
 s_add_u32 s38, s77, 88064
 s_add_u32 m0, s78, 88064
 s_nop 0
 buffer_load_dwordx4 v1, s[4:7], s38 offen sc1 lds
 ds_read_b128 v[36:39], v2 offset:39936
 s_waitcnt lgkmcnt(6)
 v_mfma_f32_32x32x16_bf16 v[112:127], v[44:47], a[0:3], 0
 s_add_u32 s38, s77, 125952
 s_add_u32 m0, s78, 125952
 s_nop 0
 buffer_load_dwordx4 v1, s[4:7], s38 offen sc1 lds
 ds_read_b128 v[40:43], v3 offset:12288
 s_waitcnt vmcnt(30) lgkmcnt(6)
 v_mfma_f32_32x32x16_bf16 v[64:79], v[48:51], a[4:7], v[64:79]
 s_add_u32 s30, s23, 12288
 buffer_load_dwordx4 a[48:51], v1, s[4:7], s30 offen offset:0 sc1
 ds_read_b128 v[44:47], v3 offset:50176
 s_waitcnt lgkmcnt(6)
 v_mfma_f32_32x32x16_bf16 v[80:95], v[52:55], a[4:7], v[80:95]
 s_add_u32 s30, s23, 12288
 buffer_load_dwordx4 a[52:55], v1, s[4:7], s30 offen offset:1024 sc1
 ds_read_b128 v[48:51], v2 offset:3072
 s_waitcnt lgkmcnt(6)
 v_mfma_f32_32x32x16_bf16 v[96:111], v[56:59], a[4:7], v[96:111]
 s_add_u32 s30, s23, 12288
 buffer_load_dwordx4 a[56:59], v1, s[4:7], s30 offen offset:2048 sc1
 ds_read_b128 v[52:55], v2 offset:40960
 s_waitcnt lgkmcnt(6)
 v_mfma_f32_32x32x16_bf16 v[112:127], v[60:63], a[4:7], v[112:127]
 s_add_u32 s30, s23, 12288
 buffer_load_dwordx4 a[60:63], v1, s[4:7], s30 offen offset:3072 sc1
 ds_read_b128 v[56:59], v3 offset:13312
 s_waitcnt vmcnt(33) lgkmcnt(6)
 v_mfma_f32_32x32x16_bf16 v[64:79], v[32:35], a[8:11], v[64:79]
 ds_read_b128 v[60:63], v3 offset:51200
 s_waitcnt lgkmcnt(6)
 v_mfma_f32_32x32x16_bf16 v[80:95], v[36:39], a[8:11], v[80:95]
 s_waitcnt vmcnt(20)
 s_barrier
 ds_read_b128 v[32:35], v2 offset:4096
 s_waitcnt lgkmcnt(6)
 v_mfma_f32_32x32x16_bf16 v[96:111], v[40:43], a[8:11], v[96:111]
 ds_read_b128 v[36:39], v2 offset:41984
 s_waitcnt lgkmcnt(6)
 v_mfma_f32_32x32x16_bf16 v[112:127], v[44:47], a[8:11], v[112:127]
 ds_read_b128 v[40:43], v3 offset:14336
 s_waitcnt lgkmcnt(6)
 v_mfma_f32_32x32x16_bf16 v[64:79], v[48:51], a[12:15], v[64:79]
 v_add_f32 v12, v16, v20
 v_add_f32 v13, v18, v22
 ds_read_b128 v[44:47], v3 offset:52224
 s_waitcnt lgkmcnt(6)
 v_mfma_f32_32x32x16_bf16 v[80:95], v[52:55], a[12:15], v[80:95]
 v_add_f32 v12, v12, v24
 v_add_f32 v13, v13, v26
 ds_read_b128 v[48:51], v2 offset:5120
 s_waitcnt lgkmcnt(6)
 v_mfma_f32_32x32x16_bf16 v[96:111], v[56:59], a[12:15], v[96:111]
 v_add_f32 v12, v12, v28
 v_add_f32 v13, v13, v30
 ds_read_b128 v[52:55], v2 offset:43008
 s_waitcnt lgkmcnt(6)
 v_mfma_f32_32x32x16_bf16 v[112:127], v[60:63], a[12:15], v[112:127]
 v_mul_f32 v12, 0x3de38e39, v12
 v_mul_f32 v13, 0x3e0e38e4, v13
 ds_read_b128 v[56:59], v3 offset:15360
 s_waitcnt vmcnt(19) lgkmcnt(6)
 v_mfma_f32_32x32x16_bf16 v[64:79], v[32:35], a[16:19], v[64:79]
 s_add_u32 s38, s77, 16384
 s_add_u32 m0, s78, 16384
 s_nop 0
 buffer_load_dwordx4 v1, s[4:7], s38 offen sc1 lds
 ds_read_b128 v[60:63], v3 offset:53248
 s_waitcnt lgkmcnt(6)
 v_mfma_f32_32x32x16_bf16 v[80:95], v[36:39], a[16:19], v[80:95]
 s_add_u32 s38, s77, 54272
 s_add_u32 m0, s78, 54272
 s_nop 0
 buffer_load_dwordx4 v1, s[4:7], s38 offen sc1 lds
 ds_read_b128 v[32:35], v2 offset:6144
 s_waitcnt lgkmcnt(6)
 v_mfma_f32_32x32x16_bf16 v[96:111], v[40:43], a[16:19], v[96:111]
 s_add_u32 s38, s77, 92160
 s_add_u32 m0, s78, 92160
 s_nop 0
 buffer_load_dwordx4 v1, s[4:7], s38 offen sc1 lds
 ds_read_b128 v[36:39], v2 offset:44032
 s_waitcnt lgkmcnt(6)
 v_mfma_f32_32x32x16_bf16 v[112:127], v[44:47], a[16:19], v[112:127]
 s_add_u32 s38, s77, 130048
 s_add_u32 m0, s78, 130048
 s_nop 0
 buffer_load_dwordx4 v1, s[4:7], s38 offen sc1 lds
 ds_read_b128 v[40:43], v3 offset:16384
 s_waitcnt vmcnt(22) lgkmcnt(6)
 v_mfma_f32_32x32x16_bf16 v[64:79], v[48:51], a[20:23], v[64:79]
 s_add_u32 s30, s23, 16384
 buffer_load_dwordx4 a[64:67], v1, s[4:7], s30 offen offset:0 sc1
 ds_read_b128 v[44:47], v3 offset:54272
 s_waitcnt lgkmcnt(6)
 v_mfma_f32_32x32x16_bf16 v[80:95], v[52:55], a[20:23], v[80:95]
 s_add_u32 s30, s23, 16384
 buffer_load_dwordx4 a[68:71], v1, s[4:7], s30 offen offset:1024 sc1
 ds_read_b128 v[48:51], v2 offset:7168
 s_waitcnt lgkmcnt(6)
 v_mfma_f32_32x32x16_bf16 v[96:111], v[56:59], a[20:23], v[96:111]
 s_add_u32 s30, s23, 16384
 buffer_load_dwordx4 a[72:75], v1, s[4:7], s30 offen offset:2048 sc1
 ds_read_b128 v[52:55], v2 offset:45056
 s_waitcnt lgkmcnt(6)
 v_mfma_f32_32x32x16_bf16 v[112:127], v[60:63], a[20:23], v[112:127]
 s_add_u32 s30, s23, 16384
 buffer_load_dwordx4 a[76:79], v1, s[4:7], s30 offen offset:3072 sc1
 ds_read_b128 v[56:59], v3 offset:17408
 s_waitcnt vmcnt(25) lgkmcnt(6)
 v_mfma_f32_32x32x16_bf16 v[64:79], v[32:35], a[24:27], v[64:79]
 v_add_f32 v5, v12, v13
 v_mov_b32 v12, 0
 ds_read_b128 v[60:63], v3 offset:55296
 s_waitcnt lgkmcnt(6)
 v_mfma_f32_32x32x16_bf16 v[80:95], v[36:39], a[24:27], v[80:95]
 s_waitcnt vmcnt(20)
 s_barrier
 ds_read_b128 v[32:35], v2 offset:8192
 s_waitcnt lgkmcnt(6)
 v_mfma_f32_32x32x16_bf16 v[96:111], v[40:43], a[24:27], v[96:111]
 v_mov_b32 v13, 0
 v_sub_f32 v16, v16, v5
 ds_read_b128 v[36:39], v2 offset:46080
 s_waitcnt lgkmcnt(6)
 v_mfma_f32_32x32x16_bf16 v[112:127], v[44:47], a[24:27], v[112:127]
 v_fmac_f32 v12, v16, v16
 v_sub_f32 v18, v18, v5
 ds_read_b128 v[40:43], v3 offset:18432
 s_waitcnt lgkmcnt(6)
 v_mfma_f32_32x32x16_bf16 v[64:79], v[48:51], a[28:31], v[64:79]
 v_fmac_f32 v13, v18, v18
 v_sub_f32 v20, v20, v5
 ds_read_b128 v[44:47], v3 offset:56320
 s_waitcnt lgkmcnt(6)
 v_mfma_f32_32x32x16_bf16 v[80:95], v[52:55], a[28:31], v[80:95]
 v_fmac_f32 v12, v20, v20
 v_sub_f32 v22, v22, v5
 ds_read_b128 v[48:51], v2 offset:9216
 s_waitcnt lgkmcnt(6)
 v_mfma_f32_32x32x16_bf16 v[96:111], v[56:59], a[28:31], v[96:111]
 v_fmac_f32 v13, v22, v22
 v_sub_f32 v24, v24, v5
 ds_read_b128 v[52:55], v2 offset:47104
 s_waitcnt lgkmcnt(6)
 v_mfma_f32_32x32x16_bf16 v[112:127], v[60:63], a[28:31], v[112:127]
 v_fmac_f32 v12, v24, v24
 v_sub_f32 v26, v26, v5
 ds_read_b128 v[56:59], v3 offset:19456
 s_waitcnt vmcnt(19) lgkmcnt(6)
 v_mfma_f32_32x32x16_bf16 v[64:79], v[32:35], a[32:35], v[64:79]
 s_add_u32 s38, s77, 20480
 s_add_u32 m0, s78, 20480
 s_nop 0
 buffer_load_dwordx4 v1, s[4:7], s38 offen sc1 lds
 ds_read_b128 v[60:63], v3 offset:57344
 s_waitcnt lgkmcnt(6)
 v_mfma_f32_32x32x16_bf16 v[80:95], v[36:39], a[32:35], v[80:95]
 s_add_u32 s38, s77, 58368
 s_add_u32 m0, s78, 58368
 s_nop 0
 buffer_load_dwordx4 v1, s[4:7], s38 offen sc1 lds
 ds_read_b128 v[32:35], v2 offset:10240
 s_waitcnt lgkmcnt(6)
 v_mfma_f32_32x32x16_bf16 v[96:111], v[40:43], a[32:35], v[96:111]
 s_add_u32 s38, s77, 96256
 s_add_u32 m0, s78, 96256
 s_nop 0
 buffer_load_dwordx4 v1, s[4:7], s38 offen sc1 lds
 ds_read_b128 v[36:39], v2 offset:48128
 s_waitcnt lgkmcnt(6)
 v_mfma_f32_32x32x16_bf16 v[112:127], v[44:47], a[32:35], v[112:127]
 s_add_u32 s38, s77, 134144
 s_add_u32 m0, s78, 134144
 s_nop 0
 buffer_load_dwordx4 v1, s[4:7], s38 offen sc1 lds
 ds_read_b128 v[40:43], v3 offset:20480
 s_waitcnt vmcnt(22) lgkmcnt(6)
 v_mfma_f32_32x32x16_bf16 v[64:79], v[48:51], a[36:39], v[64:79]
 s_add_u32 s30, s23, 20480
 buffer_load_dwordx4 a[80:83], v1, s[4:7], s30 offen offset:0 sc1
 ds_read_b128 v[44:47], v3 offset:58368
 s_waitcnt lgkmcnt(6)
 v_mfma_f32_32x32x16_bf16 v[80:95], v[52:55], a[36:39], v[80:95]
 s_add_u32 s30, s23, 20480
 buffer_load_dwordx4 a[84:87], v1, s[4:7], s30 offen offset:1024 sc1
 ds_read_b128 v[48:51], v2 offset:11264
 s_waitcnt lgkmcnt(6)
 v_mfma_f32_32x32x16_bf16 v[96:111], v[56:59], a[36:39], v[96:111]
 s_add_u32 s30, s23, 20480
 buffer_load_dwordx4 a[88:91], v1, s[4:7], s30 offen offset:2048 sc1
 ds_read_b128 v[52:55], v2 offset:49152
 s_waitcnt lgkmcnt(6)
 v_mfma_f32_32x32x16_bf16 v[112:127], v[60:63], a[36:39], v[112:127]
 s_add_u32 s30, s23, 20480
 buffer_load_dwordx4 a[92:95], v1, s[4:7], s30 offen offset:3072 sc1
 ds_read_b128 v[56:59], v3 offset:21504
 s_waitcnt vmcnt(25) lgkmcnt(6)
 v_mfma_f32_32x32x16_bf16 v[64:79], v[32:35], a[40:43], v[64:79]
 v_fmac_f32 v13, v26, v26
 v_sub_f32 v28, v28, v5
 ds_read_b128 v[60:63], v3 offset:59392
 s_waitcnt lgkmcnt(6)
 v_mfma_f32_32x32x16_bf16 v[80:95], v[36:39], a[40:43], v[80:95]
 s_waitcnt vmcnt(20)
 s_barrier
 ds_read_b128 v[32:35], v2 offset:12288
 s_waitcnt lgkmcnt(6)
 v_mfma_f32_32x32x16_bf16 v[96:111], v[40:43], a[40:43], v[96:111]
 v_fmac_f32 v12, v28, v28
 v_sub_f32 v30, v30, v5
 ds_read_b128 v[36:39], v2 offset:50176
 s_waitcnt lgkmcnt(6)
 v_mfma_f32_32x32x16_bf16 v[112:127], v[44:47], a[40:43], v[112:127]
 v_fmac_f32 v13, v30, v30
 v_mul_f32 v12, 0x42800000, v12
 ds_read_b128 v[40:43], v3 offset:22528
 s_waitcnt lgkmcnt(6)
 v_mfma_f32_32x32x16_bf16 v[64:79], v[48:51], a[44:47], v[64:79]
 v_mul_f32 v13, 0x42a00000, v13
 v_add_f32 v12, v12, v13
 ds_read_b128 v[44:47], v3 offset:60416
 s_waitcnt lgkmcnt(6)
 v_mfma_f32_32x32x16_bf16 v[80:95], v[52:55], a[44:47], v[80:95]
 v_add_f32 v12, v12, v17
 v_add_f32 v12, v12, v19
 ds_read_b128 v[48:51], v2 offset:13312
 s_waitcnt lgkmcnt(6)
 v_mfma_f32_32x32x16_bf16 v[96:111], v[56:59], a[44:47], v[96:111]
 v_add_f32 v12, v12, v21
 v_add_f32 v12, v12, v23
 ds_read_b128 v[52:55], v2 offset:51200
 s_waitcnt lgkmcnt(6)
 v_mfma_f32_32x32x16_bf16 v[112:127], v[60:63], a[44:47], v[112:127]
 v_add_f32 v12, v12, v25
 v_add_f32 v12, v12, v27
 ds_read_b128 v[56:59], v3 offset:23552
 s_waitcnt vmcnt(19) lgkmcnt(6)
 v_mfma_f32_32x32x16_bf16 v[64:79], v[32:35], a[48:51], v[64:79]
 s_add_u32 s38, s77, 24576
 s_add_u32 m0, s78, 24576
 s_nop 0
 buffer_load_dwordx4 v1, s[4:7], s38 offen sc1 lds
 ds_read_b128 v[60:63], v3 offset:61440
 s_waitcnt lgkmcnt(6)
 v_mfma_f32_32x32x16_bf16 v[80:95], v[36:39], a[48:51], v[80:95]
 s_add_u32 s38, s77, 62464
 s_add_u32 m0, s78, 62464
 s_nop 0
 buffer_load_dwordx4 v1, s[4:7], s38 offen sc1 lds
 ds_read_b128 v[32:35], v2 offset:14336
 s_waitcnt lgkmcnt(6)
 v_mfma_f32_32x32x16_bf16 v[96:111], v[40:43], a[48:51], v[96:111]
 s_add_u32 s38, s77, 100352
 s_add_u32 m0, s78, 100352
 s_nop 0
 buffer_load_dwordx4 v1, s[4:7], s38 offen sc1 lds
 ds_read_b128 v[36:39], v2 offset:52224
 s_waitcnt lgkmcnt(6)
 v_mfma_f32_32x32x16_bf16 v[112:127], v[44:47], a[48:51], v[112:127]
 s_add_u32 s38, s77, 138240
 s_add_u32 m0, s78, 138240
 s_nop 0
 buffer_load_dwordx4 v1, s[4:7], s38 offen sc1 lds
 ds_read_b128 v[40:43], v3 offset:24576
 s_waitcnt vmcnt(22) lgkmcnt(6)
 v_mfma_f32_32x32x16_bf16 v[64:79], v[48:51], a[52:55], v[64:79]
 s_add_u32 s30, s23, 24576
 buffer_load_dwordx4 a[96:99], v1, s[4:7], s30 offen offset:0 sc1
 ds_read_b128 v[44:47], v3 offset:62464
 s_waitcnt lgkmcnt(6)
 v_mfma_f32_32x32x16_bf16 v[80:95], v[52:55], a[52:55], v[80:95]
 s_add_u32 s30, s23, 24576
 buffer_load_dwordx4 a[100:103], v1, s[4:7], s30 offen offset:1024 sc1
 ds_read_b128 v[48:51], v2 offset:15360
 s_waitcnt lgkmcnt(6)
 v_mfma_f32_32x32x16_bf16 v[96:111], v[56:59], a[52:55], v[96:111]
 s_add_u32 s30, s23, 24576
 buffer_load_dwordx4 a[104:107], v1, s[4:7], s30 offen offset:2048 sc1
 ds_read_b128 v[52:55], v2 offset:53248
 s_waitcnt lgkmcnt(6)
 v_mfma_f32_32x32x16_bf16 v[112:127], v[60:63], a[52:55], v[112:127]
 s_add_u32 s30, s23, 24576
 buffer_load_dwordx4 a[108:111], v1, s[4:7], s30 offen offset:3072 sc1
 ds_read_b128 v[56:59], v3 offset:25600
 s_waitcnt vmcnt(25) lgkmcnt(6)
 v_mfma_f32_32x32x16_bf16 v[64:79], v[32:35], a[56:59], v[64:79]
 v_add_f32 v12, v12, v29
 v_add_f32 v12, v12, v31
 ds_read_b128 v[60:63], v3 offset:63488
 s_waitcnt lgkmcnt(6)
 v_mfma_f32_32x32x16_bf16 v[80:95], v[36:39], a[56:59], v[80:95]
 s_waitcnt vmcnt(20)
 s_barrier
 ds_read_b128 v[32:35], v2 offset:16384
 s_waitcnt lgkmcnt(6)
 v_mfma_f32_32x32x16_bf16 v[96:111], v[40:43], a[56:59], v[96:111]
 v_mov_b32 v13, 0x3727c5ac
 v_mov_b32 v6, 0x3ae38e39
 ds_read_b128 v[36:39], v2 offset:54272
 s_waitcnt lgkmcnt(6)
 v_mfma_f32_32x32x16_bf16 v[112:127], v[44:47], a[56:59], v[112:127]
 v_fma_f32 v6, v12, v6, v13
 v_cmp_gt_u32 vcc, 512, v1
 ds_read_b128 v[40:43], v3 offset:26624
 s_waitcnt lgkmcnt(6)
 v_mfma_f32_32x32x16_bf16 v[64:79], v[48:51], a[60:63], v[64:79]
 v_cvt_pk_bf16_f32 v12, v5, v5
 v_lshlrev_b32 v12, 16, v12
 ds_read_b128 v[44:47], v3 offset:64512
 s_waitcnt lgkmcnt(6)
 v_mfma_f32_32x32x16_bf16 v[80:95], v[52:55], a[60:63], v[80:95]
 v_sub_f32 v14, v5, v12
 v_cvt_pk_bf16_f32 v13, v14, v14
 ds_read_b128 v[48:51], v2 offset:17408
 s_waitcnt lgkmcnt(6)
 v_mfma_f32_32x32x16_bf16 v[96:111], v[56:59], a[60:63], v[96:111]
 v_lshlrev_b32 v13, 16, v13
 v_sub_f32 v14, v14, v13
 ds_read_b128 v[52:55], v2 offset:55296
 s_waitcnt lgkmcnt(6)
 v_mfma_f32_32x32x16_bf16 v[112:127], v[60:63], a[60:63], v[112:127]
 v_cvt_pk_bf16_f32 v8, v12, v12
 v_cvt_pk_bf16_f32 v9, v13, v12
 ds_read_b128 v[56:59], v3 offset:27648
 s_waitcnt vmcnt(19) lgkmcnt(6)
 v_mfma_f32_32x32x16_bf16 v[64:79], v[32:35], a[64:67], v[64:79]
 s_add_u32 s38, s77, 28672
 s_add_u32 m0, s78, 28672
 s_nop 0
 buffer_load_dwordx4 v1, s[4:7], s38 offen sc1 lds
 ds_read_b128 v[60:63], v4 offset:0
 s_waitcnt lgkmcnt(6)
 v_mfma_f32_32x32x16_bf16 v[80:95], v[36:39], a[64:67], v[80:95]
 s_add_u32 s38, s77, 66560
 s_add_u32 m0, s78, 66560
 s_nop 0
 buffer_load_dwordx4 v1, s[4:7], s38 offen sc1 lds
 ds_read_b128 v[32:35], v2 offset:18432
 s_waitcnt lgkmcnt(6)
 v_mfma_f32_32x32x16_bf16 v[96:111], v[40:43], a[64:67], v[96:111]
 s_add_u32 s38, s77, 104448
 s_add_u32 m0, s78, 104448
 s_nop 0
 buffer_load_dwordx4 v1, s[4:7], s38 offen sc1 lds
 ds_read_b128 v[36:39], v2 offset:56320
 s_waitcnt lgkmcnt(6)
 v_mfma_f32_32x32x16_bf16 v[112:127], v[44:47], a[64:67], v[112:127]
 s_add_u32 s38, s77, 142336
 s_add_u32 m0, s78, 142336
 s_nop 0
 buffer_load_dwordx4 v1, s[4:7], s38 offen sc1 lds
 ds_read_b128 v[40:43], v3 offset:28672
 s_waitcnt vmcnt(22) lgkmcnt(6)
 v_mfma_f32_32x32x16_bf16 v[64:79], v[48:51], a[68:71], v[64:79]
 s_add_u32 s30, s23, 28672
 buffer_load_dwordx4 a[112:115], v1, s[4:7], s30 offen offset:0 sc1
 ds_read_b128 v[44:47], v4 offset:1024
 s_waitcnt lgkmcnt(6)
 v_mfma_f32_32x32x16_bf16 v[80:95], v[52:55], a[68:71], v[80:95]
 s_add_u32 s30, s23, 28672
 buffer_load_dwordx4 a[116:119], v1, s[4:7], s30 offen offset:1024 sc1
 ds_read_b128 v[48:51], v2 offset:19456
 s_waitcnt lgkmcnt(6)
 v_mfma_f32_32x32x16_bf16 v[96:111], v[56:59], a[68:71], v[96:111]
 s_add_u32 s30, s23, 28672
 buffer_load_dwordx4 a[120:123], v1, s[4:7], s30 offen offset:2048 sc1
 ds_read_b128 v[52:55], v2 offset:57344
 s_waitcnt lgkmcnt(6)
 v_mfma_f32_32x32x16_bf16 v[112:127], v[60:63], a[68:71], v[112:127]
 s_add_u32 s30, s23, 28672
 buffer_load_dwordx4 a[124:127], v1, s[4:7], s30 offen offset:3072 sc1
 ds_read_b128 v[56:59], v3 offset:29696
 s_waitcnt vmcnt(25) lgkmcnt(6)
 v_mfma_f32_32x32x16_bf16 v[64:79], v[32:35], a[72:75], v[64:79]
 v_cvt_pk_bf16_f32 v10, v13, v14
 v_mov_b32 v11, 0
 ds_read_b128 v[60:63], v4 offset:2048
 s_waitcnt lgkmcnt(6)
 v_mfma_f32_32x32x16_bf16 v[80:95], v[36:39], a[72:75], v[80:95]
 s_waitcnt vmcnt(20)
 s_barrier
 ds_read_b128 v[32:35], v2 offset:20480
 s_waitcnt lgkmcnt(6)
 v_mfma_f32_32x32x16_bf16 v[96:111], v[40:43], a[72:75], v[96:111]
 v_cndmask_b32 v8, 0, v8, vcc
 v_cndmask_b32 v9, 0, v9, vcc
 ds_read_b128 v[36:39], v2 offset:58368
 s_waitcnt lgkmcnt(6)
 v_mfma_f32_32x32x16_bf16 v[112:127], v[44:47], a[72:75], v[112:127]
 v_cndmask_b32 v10, 0, v10, vcc
 ds_read_b128 v[40:43], v3 offset:30720
 s_waitcnt lgkmcnt(6)
 v_mfma_f32_32x32x16_bf16 v[64:79], v[48:51], a[76:79], v[64:79]
 v_rsq_f32 v6, v6
 ds_read_b128 v[44:47], v4 offset:3072
 s_waitcnt lgkmcnt(6)
 v_mfma_f32_32x32x16_bf16 v[80:95], v[52:55], a[76:79], v[80:95]
 ds_read_b128 v[48:51], v2 offset:21504
 s_waitcnt lgkmcnt(6)
 v_mfma_f32_32x32x16_bf16 v[96:111], v[56:59], a[76:79], v[96:111]
 ds_read_b128 v[52:55], v2 offset:59392
 s_waitcnt lgkmcnt(6)
 v_mfma_f32_32x32x16_bf16 v[112:127], v[60:63], a[76:79], v[112:127]
 ds_read_b128 v[56:59], v3 offset:31744
 s_waitcnt vmcnt(19) lgkmcnt(6)
 v_mfma_f32_32x32x16_bf16 v[64:79], v[32:35], a[80:83], v[64:79]
 s_add_u32 s38, s77, 32768
 s_add_u32 m0, s78, 32768
 s_nop 0
 buffer_load_dwordx4 v1, s[4:7], s38 offen sc1 lds
 ds_read_b128 v[60:63], v4 offset:4096
 s_waitcnt lgkmcnt(6)
 v_mfma_f32_32x32x16_bf16 v[80:95], v[36:39], a[80:83], v[80:95]
 s_add_u32 s38, s77, 70656
 s_add_u32 m0, s78, 70656
 s_nop 0
 buffer_load_dwordx4 v1, s[4:7], s38 offen sc1 lds
 ds_read_b128 v[32:35], v2 offset:22528
 s_waitcnt lgkmcnt(6)
 v_mfma_f32_32x32x16_bf16 v[96:111], v[40:43], a[80:83], v[96:111]
 s_add_u32 s38, s77, 108544
 s_add_u32 m0, s78, 108544
 s_nop 0
 buffer_load_dwordx4 v1, s[4:7], s38 offen sc1 lds
 ds_read_b128 v[36:39], v2 offset:60416
 s_waitcnt lgkmcnt(6)
 v_mfma_f32_32x32x16_bf16 v[112:127], v[44:47], a[80:83], v[112:127]
 s_add_u32 s38, s77, 146432
 s_add_u32 m0, s78, 146432
 s_nop 0
 buffer_load_dwordx4 v1, s[4:7], s38 offen sc1 lds
 ds_read_b128 v[40:43], v3 offset:32768
 s_waitcnt vmcnt(22) lgkmcnt(6)
 v_mfma_f32_32x32x16_bf16 v[64:79], v[48:51], a[84:87], v[64:79]
 s_add_u32 s30, s23, 32768
 buffer_load_dwordx4 a[128:131], v1, s[4:7], s30 offen offset:0 sc1
 ds_read_b128 v[44:47], v4 offset:5120
 s_waitcnt lgkmcnt(6)
 v_mfma_f32_32x32x16_bf16 v[80:95], v[52:55], a[84:87], v[80:95]
 s_add_u32 s30, s23, 32768
 buffer_load_dwordx4 a[132:135], v1, s[4:7], s30 offen offset:1024 sc1
 ds_read_b128 v[48:51], v2 offset:23552
 s_waitcnt lgkmcnt(6)
 v_mfma_f32_32x32x16_bf16 v[96:111], v[56:59], a[84:87], v[96:111]
 s_add_u32 s30, s23, 32768
 buffer_load_dwordx4 a[136:139], v1, s[4:7], s30 offen offset:2048 sc1
 ds_read_b128 v[52:55], v2 offset:61440
 s_waitcnt lgkmcnt(6)
 v_mfma_f32_32x32x16_bf16 v[112:127], v[60:63], a[84:87], v[112:127]
 s_add_u32 s30, s23, 32768
 buffer_load_dwordx4 a[140:143], v1, s[4:7], s30 offen offset:3072 sc1
 ds_read_b128 v[56:59], v3 offset:33792
 s_waitcnt vmcnt(25) lgkmcnt(6)
 v_mfma_f32_32x32x16_bf16 v[64:79], v[32:35], a[88:91], v[64:79]
 ds_read_b128 v[60:63], v4 offset:6144
 s_waitcnt lgkmcnt(6)
 v_mfma_f32_32x32x16_bf16 v[80:95], v[36:39], a[88:91], v[80:95]
 s_waitcnt vmcnt(20)
 s_barrier
 ds_read_b128 v[32:35], v2 offset:24576
 s_waitcnt lgkmcnt(6)
 v_mfma_f32_32x32x16_bf16 v[96:111], v[40:43], a[88:91], v[96:111]
 ds_read_b128 v[36:39], v2 offset:62464
 s_waitcnt lgkmcnt(6)
 v_mfma_f32_32x32x16_bf16 v[112:127], v[44:47], a[88:91], v[112:127]
 ds_read_b128 v[40:43], v3 offset:34816
 s_waitcnt lgkmcnt(6)
 v_mfma_f32_32x32x16_bf16 v[64:79], v[48:51], a[92:95], v[64:79]
 ds_read_b128 v[44:47], v4 offset:7168
 s_waitcnt lgkmcnt(6)
 v_mfma_f32_32x32x16_bf16 v[80:95], v[52:55], a[92:95], v[80:95]
 ds_read_b128 v[48:51], v2 offset:25600
 s_waitcnt lgkmcnt(6)
 v_mfma_f32_32x32x16_bf16 v[96:111], v[56:59], a[92:95], v[96:111]
 ds_read_b128 v[52:55], v2 offset:63488
 s_waitcnt lgkmcnt(6)
 v_mfma_f32_32x32x16_bf16 v[112:127], v[60:63], a[92:95], v[112:127]
 ds_read_b128 v[56:59], v3 offset:35840
 s_waitcnt vmcnt(19) lgkmcnt(6)
 v_mfma_f32_32x32x16_bf16 v[64:79], v[32:35], a[96:99], v[64:79]
 s_add_u32 s38, s76, 36864
 s_mov_b32 m0, 36864
 s_nop 0
 buffer_load_dwordx4 v1, s[4:7], s38 offen sc1 lds
 ds_read_b128 v[60:63], v4 offset:8192
 s_waitcnt lgkmcnt(6)
 v_mfma_f32_32x32x16_bf16 v[80:95], v[36:39], a[96:99], v[80:95]
 s_add_u32 s38, s76, 74752
 s_mov_b32 m0, 74752
 s_nop 0
 buffer_load_dwordx4 v1, s[4:7], s38 offen sc1 lds
 ds_read_b128 v[32:35], v2 offset:26624
 s_waitcnt lgkmcnt(6)
 v_mfma_f32_32x32x16_bf16 v[96:111], v[40:43], a[96:99], v[96:111]
 s_add_u32 s38, s76, 112640
 s_mov_b32 m0, 112640
 s_nop 0
 buffer_load_dwordx4 v1, s[4:7], s38 offen sc1 lds
 ds_read_b128 v[36:39], v2 offset:64512
 s_waitcnt lgkmcnt(6)
 v_mfma_f32_32x32x16_bf16 v[112:127], v[44:47], a[96:99], v[112:127]
 s_add_u32 s38, s76, 150528
 s_mov_b32 m0, 150528
 s_nop 0
 buffer_load_dwordx4 v1, s[4:7], s38 offen sc1 lds
 ds_read_b128 v[40:43], v3 offset:36864
 s_waitcnt vmcnt(22) lgkmcnt(6)
 v_mfma_f32_32x32x16_bf16 v[64:79], v[48:51], a[100:103], v[64:79]
 ds_read_b128 v[44:47], v4 offset:9216
 s_waitcnt lgkmcnt(6)
 v_mfma_f32_32x32x16_bf16 v[80:95], v[52:55], a[100:103], v[80:95]
 ds_read_b128 v[48:51], v2 offset:27648
 s_waitcnt lgkmcnt(6)
 v_mfma_f32_32x32x16_bf16 v[96:111], v[56:59], a[100:103], v[96:111]
 ds_read_b128 v[52:55], v3 offset:0
 s_waitcnt lgkmcnt(6)
 v_mfma_f32_32x32x16_bf16 v[112:127], v[60:63], a[100:103], v[112:127]
 ds_read_b128 v[56:59], v3 offset:37888
 s_waitcnt vmcnt(21) lgkmcnt(6)
 v_mfma_f32_32x32x16_bf16 v[64:79], v[32:35], a[104:107], v[64:79]
 ds_read_b128 v[60:63], v4 offset:10240
 s_waitcnt lgkmcnt(6)
 v_mfma_f32_32x32x16_bf16 v[80:95], v[36:39], a[104:107], v[80:95]
 s_waitcnt vmcnt(16)
 s_barrier
 ds_read_b128 v[32:35], v2 offset:28672
 s_waitcnt lgkmcnt(6)
 v_mfma_f32_32x32x16_bf16 v[96:111], v[40:43], a[104:107], v[96:111]
 ds_read_b128 v[36:39], v3 offset:1024
 s_waitcnt lgkmcnt(6)
 v_mfma_f32_32x32x16_bf16 v[112:127], v[44:47], a[104:107], v[112:127]
 ds_read_b128 v[40:43], v3 offset:38912
 s_waitcnt lgkmcnt(6)
 v_mfma_f32_32x32x16_bf16 v[64:79], v[48:51], a[108:111], v[64:79]
 ds_read_b128 v[44:47], v4 offset:11264
 s_waitcnt lgkmcnt(6)
 v_mfma_f32_32x32x16_bf16 v[80:95], v[52:55], a[108:111], v[80:95]
 ds_read_b128 v[48:51], v2 offset:29696
 s_waitcnt lgkmcnt(6)
 v_mfma_f32_32x32x16_bf16 v[96:111], v[56:59], a[108:111], v[96:111]
 ds_read_b128 v[52:55], v3 offset:2048
 s_waitcnt lgkmcnt(6)
 v_mfma_f32_32x32x16_bf16 v[112:127], v[60:63], a[108:111], v[112:127]
 ds_read_b128 v[56:59], v3 offset:39936
 s_waitcnt vmcnt(15) lgkmcnt(6)
 v_mfma_f32_32x32x16_bf16 v[64:79], v[32:35], a[112:115], v[64:79]
 ds_read_b128 v[60:63], v4 offset:12288
 s_waitcnt lgkmcnt(6)
 v_mfma_f32_32x32x16_bf16 v[80:95], v[36:39], a[112:115], v[80:95]
 ds_read_b128 v[32:35], v2 offset:30720
 s_waitcnt lgkmcnt(6)
 v_mfma_f32_32x32x16_bf16 v[96:111], v[40:43], a[112:115], v[96:111]
 ds_read_b128 v[36:39], v3 offset:3072
 s_waitcnt lgkmcnt(6)
 v_mfma_f32_32x32x16_bf16 v[112:127], v[44:47], a[112:115], v[112:127]
 ds_read_b128 v[40:43], v3 offset:40960
 s_waitcnt vmcnt(14) lgkmcnt(6)
 v_mfma_f32_32x32x16_bf16 v[64:79], v[48:51], a[116:119], v[64:79]
 ds_read_b128 v[44:47], v4 offset:13312
 s_waitcnt lgkmcnt(6)
 v_mfma_f32_32x32x16_bf16 v[80:95], v[52:55], a[116:119], v[80:95]
 ds_read_b128 v[48:51], v2 offset:31744
 s_waitcnt lgkmcnt(6)
 v_mfma_f32_32x32x16_bf16 v[96:111], v[56:59], a[116:119], v[96:111]
 ds_read_b128 v[52:55], v3 offset:4096
 s_waitcnt lgkmcnt(6)
 v_mfma_f32_32x32x16_bf16 v[112:127], v[60:63], a[116:119], v[112:127]
 ds_read_b128 v[56:59], v3 offset:41984
 s_waitcnt vmcnt(13) lgkmcnt(6)
 v_mfma_f32_32x32x16_bf16 v[64:79], v[32:35], a[120:123], v[64:79]
 ds_read_b128 v[60:63], v4 offset:14336
 s_waitcnt lgkmcnt(6)
 v_mfma_f32_32x32x16_bf16 v[80:95], v[36:39], a[120:123], v[80:95]
 s_waitcnt vmcnt(8)
 s_barrier
 ds_read_b128 v[32:35], v2 offset:32768
 s_waitcnt lgkmcnt(6)
 v_mfma_f32_32x32x16_bf16 v[96:111], v[40:43], a[120:123], v[96:111]
 ds_read_b128 v[36:39], v3 offset:5120
 s_waitcnt lgkmcnt(6)
 v_mfma_f32_32x32x16_bf16 v[112:127], v[44:47], a[120:123], v[112:127]
 ds_read_b128 v[40:43], v3 offset:43008
 s_waitcnt lgkmcnt(6)
 v_mfma_f32_32x32x16_bf16 v[64:79], v[48:51], a[124:127], v[64:79]
 ds_read_b128 v[44:47], v4 offset:15360
 s_waitcnt lgkmcnt(6)
 v_mfma_f32_32x32x16_bf16 v[80:95], v[52:55], a[124:127], v[80:95]
 ds_read_b128 v[48:51], v2 offset:33792
 s_waitcnt lgkmcnt(6)
 v_mfma_f32_32x32x16_bf16 v[96:111], v[56:59], a[124:127], v[96:111]
 ds_read_b128 v[52:55], v3 offset:6144
 s_waitcnt lgkmcnt(6)
 v_mfma_f32_32x32x16_bf16 v[112:127], v[60:63], a[124:127], v[112:127]
 ds_read_b128 v[56:59], v3 offset:44032
 s_waitcnt vmcnt(7) lgkmcnt(6)
 v_mfma_f32_32x32x16_bf16 v[64:79], v[32:35], a[128:131], v[64:79]
 ds_read_b128 v[60:63], v4 offset:16384
 s_waitcnt lgkmcnt(6)
 v_mfma_f32_32x32x16_bf16 v[80:95], v[36:39], a[128:131], v[80:95]
 ds_read_b128 v[32:35], v2 offset:34816
 s_waitcnt lgkmcnt(6)
 v_mfma_f32_32x32x16_bf16 v[96:111], v[40:43], a[128:131], v[96:111]
 ds_read_b128 v[36:39], v3 offset:7168
 s_waitcnt lgkmcnt(6)
 v_mfma_f32_32x32x16_bf16 v[112:127], v[44:47], a[128:131], v[112:127]
 ds_read_b128 v[40:43], v3 offset:45056
 s_waitcnt vmcnt(6) lgkmcnt(6)
 v_mfma_f32_32x32x16_bf16 v[64:79], v[48:51], a[132:135], v[64:79]
 ds_read_b128 v[44:47], v4 offset:17408
 s_waitcnt lgkmcnt(6)
 v_mfma_f32_32x32x16_bf16 v[80:95], v[52:55], a[132:135], v[80:95]
 ds_read_b128 v[48:51], v2 offset:35840
 s_waitcnt lgkmcnt(6)
 v_mfma_f32_32x32x16_bf16 v[96:111], v[56:59], a[132:135], v[96:111]
 ds_read_b128 v[52:55], v3 offset:8192
 s_waitcnt lgkmcnt(6)
 v_mfma_f32_32x32x16_bf16 v[112:127], v[60:63], a[132:135], v[112:127]
 ds_read_b128 v[56:59], v3 offset:46080
 s_waitcnt vmcnt(5) lgkmcnt(6)
 v_mfma_f32_32x32x16_bf16 v[64:79], v[32:35], a[136:139], v[64:79]
 ds_read_b128 v[60:63], v4 offset:18432
 s_waitcnt lgkmcnt(6)
 v_mfma_f32_32x32x16_bf16 v[80:95], v[36:39], a[136:139], v[80:95]
 s_waitcnt vmcnt(0)
 s_barrier
 ds_read_b128 v[32:35], v2 offset:36864
 s_waitcnt lgkmcnt(6)
 v_mfma_f32_32x32x16_bf16 v[96:111], v[40:43], a[136:139], v[96:111]
 ds_read_b128 v[36:39], v3 offset:9216
 s_waitcnt lgkmcnt(6)
 v_mfma_f32_32x32x16_bf16 v[112:127], v[44:47], a[136:139], v[112:127]
 ds_read_b128 v[40:43], v3 offset:47104
 s_waitcnt lgkmcnt(6)
 v_mfma_f32_32x32x16_bf16 v[64:79], v[48:51], a[140:143], v[64:79]
 ds_read_b128 v[44:47], v4 offset:19456
 s_waitcnt lgkmcnt(6)
 v_mfma_f32_32x32x16_bf16 v[80:95], v[52:55], a[140:143], v[80:95]
 s_waitcnt lgkmcnt(5)
 v_mfma_f32_32x32x16_bf16 v[96:111], v[56:59], a[140:143], v[96:111]
 s_waitcnt lgkmcnt(4)
 v_mfma_f32_32x32x16_bf16 v[112:127], v[60:63], a[140:143], v[112:127]
 s_waitcnt lgkmcnt(3)
 v_mfma_f32_32x32x16_bf16 v[64:79], v[32:35], v[8:11], v[64:79]
 s_waitcnt lgkmcnt(2)
 v_mfma_f32_32x32x16_bf16 v[80:95], v[36:39], v[8:11], v[80:95]
 s_waitcnt lgkmcnt(1)
 v_mfma_f32_32x32x16_bf16 v[96:111], v[40:43], v[8:11], v[96:111]
 s_waitcnt lgkmcnt(0)
 v_mfma_f32_32x32x16_bf16 v[112:127], v[44:47], v[8:11], v[112:127]
 s_and_b32 s32, s27, 3
 s_lshl_b32 s32, s32, 3
 s_lshl_b32 s33, s26, 10
 s_add_u32 s33, s33, 11010048
 s_add_u32 s33, s33, s100
 s_and_b32 s34, s26, 7
 s_lshl_b32 s34, s34, 10
 s_add_u32 s34, s34, s31
 s_cmp_lt_u32 s27, 4
 s_cselect_b32 s33, s33, s34
 s_mov_b32 s35, 151552
 s_cselect_b32 s35, 65536, s35
 s_mov_b32 s36, 0x3eae1a93
 s_cselect_b32 s36, s36, 1.0
 s_mul_i32 s32, s32, s35
 s_add_u32 s33, s33, s32
 v_mul_f32 v7, s36, v6
 v_mul_f32 v64, v64, v7
 v_mul_f32 v65, v65, v7
 v_mul_f32 v66, v66, v7
 v_mul_f32 v67, v67, v7
 v_mul_f32 v68, v68, v7
 v_mul_f32 v69, v69, v7
 v_mul_f32 v70, v70, v7
 v_mul_f32 v71, v71, v7
 v_cvt_pk_bf16_f32 v128, v64, v65
 v_cvt_pk_bf16_f32 v129, v66, v67
 v_cvt_pk_bf16_f32 v130, v68, v69
 v_cvt_pk_bf16_f32 v131, v70, v71
 buffer_store_dwordx4 v[128:131], v1, s[4:7], s33 offen sc1
 s_add_u32 s33, s33, s35
 v_mul_f32 v72, v72, v7
 v_mul_f32 v73, v73, v7
 v_mul_f32 v74, v74, v7
 v_mul_f32 v75, v75, v7
 v_mul_f32 v76, v76, v7
 v_mul_f32 v77, v77, v7
 v_mul_f32 v78, v78, v7
 v_mul_f32 v79, v79, v7
 v_cvt_pk_bf16_f32 v132, v72, v73
 v_cvt_pk_bf16_f32 v133, v74, v75
 v_cvt_pk_bf16_f32 v134, v76, v77
 v_cvt_pk_bf16_f32 v135, v78, v79
 buffer_store_dwordx4 v[132:135], v1, s[4:7], s33 offen sc1
 s_add_u32 s33, s33, s35
 v_mul_f32 v80, v80, v7
 v_mul_f32 v81, v81, v7
 v_mul_f32 v82, v82, v7
 v_mul_f32 v83, v83, v7
 v_mul_f32 v84, v84, v7
 v_mul_f32 v85, v85, v7
 v_mul_f32 v86, v86, v7
 v_mul_f32 v87, v87, v7
 v_cvt_pk_bf16_f32 v136, v80, v81
 v_cvt_pk_bf16_f32 v137, v82, v83
 v_cvt_pk_bf16_f32 v138, v84, v85
 v_cvt_pk_bf16_f32 v139, v86, v87
 buffer_store_dwordx4 v[136:139], v1, s[4:7], s33 offen sc1
 s_add_u32 s33, s33, s35
 v_mul_f32 v88, v88, v7
 v_mul_f32 v89, v89, v7
 v_mul_f32 v90, v90, v7
 v_mul_f32 v91, v91, v7
 v_mul_f32 v92, v92, v7
 v_mul_f32 v93, v93, v7
 v_mul_f32 v94, v94, v7
 v_mul_f32 v95, v95, v7
 v_cvt_pk_bf16_f32 v140, v88, v89
 v_cvt_pk_bf16_f32 v141, v90, v91
 v_cvt_pk_bf16_f32 v142, v92, v93
 v_cvt_pk_bf16_f32 v143, v94, v95
 buffer_store_dwordx4 v[140:143], v1, s[4:7], s33 offen sc1
 s_add_u32 s33, s33, s35
 v_mul_f32 v96, v96, v7
 v_mul_f32 v97, v97, v7
 v_mul_f32 v98, v98, v7
 v_mul_f32 v99, v99, v7
 v_mul_f32 v100, v100, v7
 v_mul_f32 v101, v101, v7
 v_mul_f32 v102, v102, v7
 v_mul_f32 v103, v103, v7
 v_cvt_pk_bf16_f32 v144, v96, v97
 v_cvt_pk_bf16_f32 v145, v98, v99
 v_cvt_pk_bf16_f32 v146, v100, v101
 v_cvt_pk_bf16_f32 v147, v102, v103
 buffer_store_dwordx4 v[144:147], v1, s[4:7], s33 offen sc1
 s_add_u32 s33, s33, s35
 v_mul_f32 v104, v104, v7
 v_mul_f32 v105, v105, v7
 v_mul_f32 v106, v106, v7
 v_mul_f32 v107, v107, v7
 v_mul_f32 v108, v108, v7
 v_mul_f32 v109, v109, v7
 v_mul_f32 v110, v110, v7
 v_mul_f32 v111, v111, v7
 v_cvt_pk_bf16_f32 v148, v104, v105
 v_cvt_pk_bf16_f32 v149, v106, v107
 v_cvt_pk_bf16_f32 v150, v108, v109
 v_cvt_pk_bf16_f32 v151, v110, v111
 buffer_store_dwordx4 v[148:151], v1, s[4:7], s33 offen sc1
 s_add_u32 s33, s33, s35
 v_mul_f32 v112, v112, v7
 v_mul_f32 v113, v113, v7
 v_mul_f32 v114, v114, v7
 v_mul_f32 v115, v115, v7
 v_mul_f32 v116, v116, v7
 v_mul_f32 v117, v117, v7
 v_mul_f32 v118, v118, v7
 v_mul_f32 v119, v119, v7
 v_cvt_pk_bf16_f32 v152, v112, v113
 v_cvt_pk_bf16_f32 v153, v114, v115
 v_cvt_pk_bf16_f32 v154, v116, v117
 v_cvt_pk_bf16_f32 v155, v118, v119
 buffer_store_dwordx4 v[152:155], v1, s[4:7], s33 offen sc1
 s_add_u32 s33, s33, s35
 v_mul_f32 v120, v120, v7
 v_mul_f32 v121, v121, v7
 v_mul_f32 v122, v122, v7
 v_mul_f32 v123, v123, v7
 v_mul_f32 v124, v124, v7
 v_mul_f32 v125, v125, v7
 v_mul_f32 v126, v126, v7
 v_mul_f32 v127, v127, v7
 v_cvt_pk_bf16_f32 v156, v120, v121
 v_cvt_pk_bf16_f32 v157, v122, v123
 v_cvt_pk_bf16_f32 v158, v124, v125
 v_cvt_pk_bf16_f32 v159, v126, v127
 buffer_store_dwordx4 v[156:159], v1, s[4:7], s33 offen sc1
 s_add_u32 s33, s33, s35
 s_branch K1S_JOIN
K1S_EXT:
 s_add_u32 s38, s77, 0
 s_add_u32 m0, s78, 0
 s_nop 0
 buffer_load_dwordx4 v1, s[4:7], s38 offen sc1 lds
 s_add_u32 s38, s77, 37888
 s_add_u32 m0, s78, 37888
 s_nop 0
 buffer_load_dwordx4 v1, s[4:7], s38 offen sc1 lds
 s_add_u32 s30, s23, 0
 buffer_load_dwordx4 a[0:3], v1, s[4:7], s30 offen offset:0 sc1
 s_add_u32 s30, s23, 0
 buffer_load_dwordx4 a[4:7], v1, s[4:7], s30 offen offset:1024 sc1
 s_add_u32 s30, s23, 0
 buffer_load_dwordx4 a[8:11], v1, s[4:7], s30 offen offset:2048 sc1
 s_add_u32 s30, s23, 0
 buffer_load_dwordx4 a[12:15], v1, s[4:7], s30 offen offset:3072 sc1
 v_and_b32 v12, 15, v0
 v_lshlrev_b32 v12, 3, v12
 v_bfe_u32 v13, v0, 4, 1
 v_lshlrev_b32 v13, 10, v13
 v_add_u32 v12, v12, v13
 buffer_load_dwordx2 v[16:17], v12, s[4:7], s29 offen offset:0 sc1
 buffer_load_dwordx2 v[18:19], v12, s[4:7], s29 offen offset:128 sc1
 buffer_load_dwordx2 v[20:21], v12, s[4:7], s29 offen offset:256 sc1
 buffer_load_dwordx2 v[22:23], v12, s[4:7], s29 offen offset:384 sc1
 buffer_load_dwordx2 v[24:25], v12, s[4:7], s29 offen offset:512 sc1
 buffer_load_dwordx2 v[26:27], v12, s[4:7], s29 offen offset:640 sc1
 buffer_load_dwordx2 v[28:29], v12, s[4:7], s29 offen offset:768 sc1
 buffer_load_dwordx2 v[30:31], v12, s[4:7], s29 offen offset:896 sc1
 s_add_u32 s38, s77, 4096
 s_add_u32 m0, s78, 4096
 s_nop 0
 buffer_load_dwordx4 v1, s[4:7], s38 offen sc1 lds
 s_add_u32 s38, s77, 41984
 s_add_u32 m0, s78, 41984
 s_nop 0
 buffer_load_dwordx4 v1, s[4:7], s38 offen sc1 lds
 s_add_u32 s30, s23, 4096
 buffer_load_dwordx4 a[16:19], v1, s[4:7], s30 offen offset:0 sc1
 s_add_u32 s30, s23, 4096
 buffer_load_dwordx4 a[20:23], v1, s[4:7], s30 offen offset:1024 sc1
 s_add_u32 s30, s23, 4096
 buffer_load_dwordx4 a[24:27], v1, s[4:7], s30 offen offset:2048 sc1
 s_add_u32 s30, s23, 4096
 buffer_load_dwordx4 a[28:31], v1, s[4:7], s30 offen offset:3072 sc1
 s_add_u32 s38, s77, 8192
 s_add_u32 m0, s78, 8192
 s_nop 0
 buffer_load_dwordx4 v1, s[4:7], s38 offen sc1 lds
 s_add_u32 s38, s77, 46080
 s_add_u32 m0, s78, 46080
 s_nop 0
 buffer_load_dwordx4 v1, s[4:7], s38 offen sc1 lds
 s_add_u32 s30, s23, 8192
 buffer_load_dwordx4 a[32:35], v1, s[4:7], s30 offen offset:0 sc1
 s_add_u32 s30, s23, 8192
 buffer_load_dwordx4 a[36:39], v1, s[4:7], s30 offen offset:1024 sc1
 s_add_u32 s30, s23, 8192
 buffer_load_dwordx4 a[40:43], v1, s[4:7], s30 offen offset:2048 sc1
 s_add_u32 s30, s23, 8192
 buffer_load_dwordx4 a[44:47], v1, s[4:7], s30 offen offset:3072 sc1
 s_waitcnt vmcnt(24)
 s_barrier
 ds_read_b128 v[32:35], v2 offset:0
 ds_read_b128 v[36:39], v2 offset:37888
 ds_read_b128 v[40:43], v2 offset:1024
 ds_read_b128 v[44:47], v2 offset:38912
 ds_read_b128 v[48:51], v2 offset:2048
 ds_read_b128 v[52:55], v2 offset:39936
 ds_read_b128 v[56:59], v2 offset:3072
 s_waitcnt vmcnt(23) lgkmcnt(6)
 v_mfma_f32_32x32x16_bf16 v[64:79], v[32:35], a[0:3], 0
 s_add_u32 s38, s77, 12288
 s_add_u32 m0, s78, 12288
 s_nop 0
 buffer_load_dwordx4 v1, s[4:7], s38 offen sc1 lds
 ds_read_b128 v[60:63], v2 offset:40960
 s_waitcnt lgkmcnt(6)
 v_mfma_f32_32x32x16_bf16 v[80:95], v[36:39], a[0:3], 0
 s_add_u32 s38, s77, 50176
 s_add_u32 m0, s78, 50176
 s_nop 0
 buffer_load_dwordx4 v1, s[4:7], s38 offen sc1 lds
 s_waitcnt vmcnt(12)
 s_barrier
 ds_read_b128 v[32:35], v2 offset:4096
 s_waitcnt lgkmcnt(6)
 v_mfma_f32_32x32x16_bf16 v[64:79], v[40:43], a[4:7], v[64:79]
 s_add_u32 s30, s23, 12288
 buffer_load_dwordx4 a[48:51], v1, s[4:7], s30 offen offset:0 sc1
 ds_read_b128 v[36:39], v2 offset:41984
 s_waitcnt lgkmcnt(6)
 v_mfma_f32_32x32x16_bf16 v[80:95], v[44:47], a[4:7], v[80:95]
 s_add_u32 s30, s23, 12288
 buffer_load_dwordx4 a[52:55], v1, s[4:7], s30 offen offset:1024 sc1
 ds_read_b128 v[40:43], v2 offset:5120
 s_waitcnt lgkmcnt(6)
 v_mfma_f32_32x32x16_bf16 v[64:79], v[48:51], a[8:11], v[64:79]
 s_add_u32 s30, s23, 12288
 buffer_load_dwordx4 a[56:59], v1, s[4:7], s30 offen offset:2048 sc1
 ds_read_b128 v[44:47], v2 offset:43008
 s_waitcnt lgkmcnt(6)
 v_mfma_f32_32x32x16_bf16 v[80:95], v[52:55], a[8:11], v[80:95]
 s_add_u32 s30, s23, 12288
 buffer_load_dwordx4 a[60:63], v1, s[4:7], s30 offen offset:3072 sc1
 ds_read_b128 v[48:51], v2 offset:6144
 s_waitcnt lgkmcnt(6)
 v_mfma_f32_32x32x16_bf16 v[64:79], v[56:59], a[12:15], v[64:79]
 v_add_f32 v12, v16, v20
 v_add_f32 v13, v18, v22
 ds_read_b128 v[52:55], v2 offset:44032
 s_waitcnt lgkmcnt(6)
 v_mfma_f32_32x32x16_bf16 v[80:95], v[60:63], a[12:15], v[80:95]
 v_add_f32 v12, v12, v24
 v_add_f32 v13, v13, v26
 ds_read_b128 v[56:59], v2 offset:7168
 s_waitcnt vmcnt(15) lgkmcnt(6)
 v_mfma_f32_32x32x16_bf16 v[64:79], v[32:35], a[16:19], v[64:79]
 s_add_u32 s38, s77, 16384
 s_add_u32 m0, s78, 16384
 s_nop 0
 buffer_load_dwordx4 v1, s[4:7], s38 offen sc1 lds
 ds_read_b128 v[60:63], v2 offset:45056
 s_waitcnt lgkmcnt(6)
 v_mfma_f32_32x32x16_bf16 v[80:95], v[36:39], a[16:19], v[80:95]
 s_add_u32 s38, s77, 54272
 s_add_u32 m0, s78, 54272
 s_nop 0
 buffer_load_dwordx4 v1, s[4:7], s38 offen sc1 lds
 s_waitcnt vmcnt(12)
 s_barrier
 ds_read_b128 v[32:35], v2 offset:8192
 s_waitcnt lgkmcnt(6)
 v_mfma_f32_32x32x16_bf16 v[64:79], v[40:43], a[20:23], v[64:79]
 s_add_u32 s30, s23, 16384
 buffer_load_dwordx4 a[64:67], v1, s[4:7], s30 offen offset:0 sc1
 ds_read_b128 v[36:39], v2 offset:46080
 s_waitcnt lgkmcnt(6)
 v_mfma_f32_32x32x16_bf16 v[80:95], v[44:47], a[20:23], v[80:95]
 s_add_u32 s30, s23, 16384
 buffer_load_dwordx4 a[68:71], v1, s[4:7], s30 offen offset:1024 sc1
 ds_read_b128 v[40:43], v2 offset:9216
 s_waitcnt lgkmcnt(6)
 v_mfma_f32_32x32x16_bf16 v[64:79], v[48:51], a[24:27], v[64:79]
 s_add_u32 s30, s23, 16384
 buffer_load_dwordx4 a[72:75], v1, s[4:7], s30 offen offset:2048 sc1
 ds_read_b128 v[44:47], v2 offset:47104
 s_waitcnt lgkmcnt(6)
 v_mfma_f32_32x32x16_bf16 v[80:95], v[52:55], a[24:27], v[80:95]
 s_add_u32 s30, s23, 16384
 buffer_load_dwordx4 a[76:79], v1, s[4:7], s30 offen offset:3072 sc1
 ds_read_b128 v[48:51], v2 offset:10240
 s_waitcnt lgkmcnt(6)
 v_mfma_f32_32x32x16_bf16 v[64:79], v[56:59], a[28:31], v[64:79]
 v_add_f32 v12, v12, v28
 v_add_f32 v13, v13, v30
 ds_read_b128 v[52:55], v2 offset:48128
 s_waitcnt lgkmcnt(6)
 v_mfma_f32_32x32x16_bf16 v[80:95], v[60:63], a[28:31], v[80:95]
 v_mul_f32 v12, 0x3de38e39, v12
 v_mul_f32 v13, 0x3e0e38e4, v13
 ds_read_b128 v[56:59], v2 offset:11264
 s_waitcnt vmcnt(15) lgkmcnt(6)
 v_mfma_f32_32x32x16_bf16 v[64:79], v[32:35], a[32:35], v[64:79]
 s_add_u32 s38, s77, 20480
 s_add_u32 m0, s78, 20480
 s_nop 0
 buffer_load_dwordx4 v1, s[4:7], s38 offen sc1 lds
 ds_read_b128 v[60:63], v2 offset:49152
 s_waitcnt lgkmcnt(6)
 v_mfma_f32_32x32x16_bf16 v[80:95], v[36:39], a[32:35], v[80:95]
 s_add_u32 s38, s77, 58368
 s_add_u32 m0, s78, 58368
 s_nop 0
 buffer_load_dwordx4 v1, s[4:7], s38 offen sc1 lds
 s_waitcnt vmcnt(12)
 s_barrier
 ds_read_b128 v[32:35], v2 offset:12288
 s_waitcnt lgkmcnt(6)
 v_mfma_f32_32x32x16_bf16 v[64:79], v[40:43], a[36:39], v[64:79]
 s_add_u32 s30, s23, 20480
 buffer_load_dwordx4 a[80:83], v1, s[4:7], s30 offen offset:0 sc1
 ds_read_b128 v[36:39], v2 offset:50176
 s_waitcnt lgkmcnt(6)
 v_mfma_f32_32x32x16_bf16 v[80:95], v[44:47], a[36:39], v[80:95]
 s_add_u32 s30, s23, 20480
 buffer_load_dwordx4 a[84:87], v1, s[4:7], s30 offen offset:1024 sc1
 ds_read_b128 v[40:43], v2 offset:13312
 s_waitcnt lgkmcnt(6)
 v_mfma_f32_32x32x16_bf16 v[64:79], v[48:51], a[40:43], v[64:79]
 s_add_u32 s30, s23, 20480
 buffer_load_dwordx4 a[88:91], v1, s[4:7], s30 offen offset:2048 sc1
 ds_read_b128 v[44:47], v2 offset:51200
 s_waitcnt lgkmcnt(6)
 v_mfma_f32_32x32x16_bf16 v[80:95], v[52:55], a[40:43], v[80:95]
 s_add_u32 s30, s23, 20480
 buffer_load_dwordx4 a[92:95], v1, s[4:7], s30 offen offset:3072 sc1
 ds_read_b128 v[48:51], v2 offset:14336
 s_waitcnt lgkmcnt(6)
 v_mfma_f32_32x32x16_bf16 v[64:79], v[56:59], a[44:47], v[64:79]
 v_add_f32 v5, v12, v13
 v_mov_b32 v12, 0
 ds_read_b128 v[52:55], v2 offset:52224
 s_waitcnt lgkmcnt(6)
 v_mfma_f32_32x32x16_bf16 v[80:95], v[60:63], a[44:47], v[80:95]
 v_mov_b32 v13, 0
 v_sub_f32 v16, v16, v5
 ds_read_b128 v[56:59], v2 offset:15360
 s_waitcnt vmcnt(15) lgkmcnt(6)
 v_mfma_f32_32x32x16_bf16 v[64:79], v[32:35], a[48:51], v[64:79]
 s_add_u32 s38, s77, 24576
 s_add_u32 m0, s78, 24576
 s_nop 0
 buffer_load_dwordx4 v1, s[4:7], s38 offen sc1 lds
 ds_read_b128 v[60:63], v2 offset:53248
 s_waitcnt lgkmcnt(6)
 v_mfma_f32_32x32x16_bf16 v[80:95], v[36:39], a[48:51], v[80:95]
 s_add_u32 s38, s77, 62464
 s_add_u32 m0, s78, 62464
 s_nop 0
 buffer_load_dwordx4 v1, s[4:7], s38 offen sc1 lds
 s_waitcnt vmcnt(12)
 s_barrier
 ds_read_b128 v[32:35], v2 offset:16384
 s_waitcnt lgkmcnt(6)
 v_mfma_f32_32x32x16_bf16 v[64:79], v[40:43], a[52:55], v[64:79]
 s_add_u32 s30, s23, 24576
 buffer_load_dwordx4 a[96:99], v1, s[4:7], s30 offen offset:0 sc1
 ds_read_b128 v[36:39], v2 offset:54272
 s_waitcnt lgkmcnt(6)
 v_mfma_f32_32x32x16_bf16 v[80:95], v[44:47], a[52:55], v[80:95]
 s_add_u32 s30, s23, 24576
 buffer_load_dwordx4 a[100:103], v1, s[4:7], s30 offen offset:1024 sc1
 ds_read_b128 v[40:43], v2 offset:17408
 s_waitcnt lgkmcnt(6)
 v_mfma_f32_32x32x16_bf16 v[64:79], v[48:51], a[56:59], v[64:79]
 s_add_u32 s30, s23, 24576
 buffer_load_dwordx4 a[104:107], v1, s[4:7], s30 offen offset:2048 sc1
 ds_read_b128 v[44:47], v2 offset:55296
 s_waitcnt lgkmcnt(6)
 v_mfma_f32_32x32x16_bf16 v[80:95], v[52:55], a[56:59], v[80:95]
 s_add_u32 s30, s23, 24576
 buffer_load_dwordx4 a[108:111], v1, s[4:7], s30 offen offset:3072 sc1
 ds_read_b128 v[48:51], v2 offset:18432
 s_waitcnt lgkmcnt(6)
 v_mfma_f32_32x32x16_bf16 v[64:79], v[56:59], a[60:63], v[64:79]
 v_fmac_f32 v12, v16, v16
 v_sub_f32 v18, v18, v5
 ds_read_b128 v[52:55], v2 offset:56320
 s_waitcnt lgkmcnt(6)
 v_mfma_f32_32x32x16_bf16 v[80:95], v[60:63], a[60:63], v[80:95]
 v_fmac_f32 v13, v18, v18
 v_sub_f32 v20, v20, v5
 ds_read_b128 v[56:59], v2 offset:19456
 s_waitcnt vmcnt(15) lgkmcnt(6)
 v_mfma_f32_32x32x16_bf16 v[64:79], v[32:35], a[64:67], v[64:79]
 s_add_u32 s38, s77, 28672
 s_add_u32 m0, s78, 28672
 s_nop 0
 buffer_load_dwordx4 v1, s[4:7], s38 offen sc1 lds
 ds_read_b128 v[60:63], v2 offset:57344
 s_waitcnt lgkmcnt(6)
 v_mfma_f32_32x32x16_bf16 v[80:95], v[36:39], a[64:67], v[80:95]
 s_add_u32 s38, s77, 66560
 s_add_u32 m0, s78, 66560
 s_nop 0
 buffer_load_dwordx4 v1, s[4:7], s38 offen sc1 lds
 s_waitcnt vmcnt(12)
 s_barrier
 ds_read_b128 v[32:35], v2 offset:20480
 s_waitcnt lgkmcnt(6)
 v_mfma_f32_32x32x16_bf16 v[64:79], v[40:43], a[68:71], v[64:79]
 s_add_u32 s30, s23, 28672
 buffer_load_dwordx4 a[112:115], v1, s[4:7], s30 offen offset:0 sc1
 ds_read_b128 v[36:39], v2 offset:58368
 s_waitcnt lgkmcnt(6)
 v_mfma_f32_32x32x16_bf16 v[80:95], v[44:47], a[68:71], v[80:95]
 s_add_u32 s30, s23, 28672
 buffer_load_dwordx4 a[116:119], v1, s[4:7], s30 offen offset:1024 sc1
 ds_read_b128 v[40:43], v2 offset:21504
 s_waitcnt lgkmcnt(6)
 v_mfma_f32_32x32x16_bf16 v[64:79], v[48:51], a[72:75], v[64:79]
 s_add_u32 s30, s23, 28672
 buffer_load_dwordx4 a[120:123], v1, s[4:7], s30 offen offset:2048 sc1
 ds_read_b128 v[44:47], v2 offset:59392
 s_waitcnt lgkmcnt(6)
 v_mfma_f32_32x32x16_bf16 v[80:95], v[52:55], a[72:75], v[80:95]
 s_add_u32 s30, s23, 28672
 buffer_load_dwordx4 a[124:127], v1, s[4:7], s30 offen offset:3072 sc1
 ds_read_b128 v[48:51], v2 offset:22528
 s_waitcnt lgkmcnt(6)
 v_mfma_f32_32x32x16_bf16 v[64:79], v[56:59], a[76:79], v[64:79]
 v_fmac_f32 v12, v20, v20
 v_sub_f32 v22, v22, v5
 ds_read_b128 v[52:55], v2 offset:60416
 s_waitcnt lgkmcnt(6)
 v_mfma_f32_32x32x16_bf16 v[80:95], v[60:63], a[76:79], v[80:95]
 v_fmac_f32 v13, v22, v22
 v_sub_f32 v24, v24, v5
 ds_read_b128 v[56:59], v2 offset:23552
 s_waitcnt vmcnt(15) lgkmcnt(6)
 v_mfma_f32_32x32x16_bf16 v[64:79], v[32:35], a[80:83], v[64:79]
 s_add_u32 s38, s77, 32768
 s_add_u32 m0, s78, 32768
 s_nop 0
 buffer_load_dwordx4 v1, s[4:7], s38 offen sc1 lds
 ds_read_b128 v[60:63], v2 offset:61440
 s_waitcnt lgkmcnt(6)
 v_mfma_f32_32x32x16_bf16 v[80:95], v[36:39], a[80:83], v[80:95]
 s_add_u32 s38, s77, 70656
 s_add_u32 m0, s78, 70656
 s_nop 0
 buffer_load_dwordx4 v1, s[4:7], s38 offen sc1 lds
 s_waitcnt vmcnt(12)
 s_barrier
 ds_read_b128 v[32:35], v2 offset:24576
 s_waitcnt lgkmcnt(6)
 v_mfma_f32_32x32x16_bf16 v[64:79], v[40:43], a[84:87], v[64:79]
 s_add_u32 s30, s23, 32768
 buffer_load_dwordx4 a[128:131], v1, s[4:7], s30 offen offset:0 sc1
 ds_read_b128 v[36:39], v2 offset:62464
 s_waitcnt lgkmcnt(6)
 v_mfma_f32_32x32x16_bf16 v[80:95], v[44:47], a[84:87], v[80:95]
 s_add_u32 s30, s23, 32768
 buffer_load_dwordx4 a[132:135], v1, s[4:7], s30 offen offset:1024 sc1
 ds_read_b128 v[40:43], v2 offset:25600
 s_waitcnt lgkmcnt(6)
 v_mfma_f32_32x32x16_bf16 v[64:79], v[48:51], a[88:91], v[64:79]
 s_add_u32 s30, s23, 32768
 buffer_load_dwordx4 a[136:139], v1, s[4:7], s30 offen offset:2048 sc1
 ds_read_b128 v[44:47], v2 offset:63488
 s_waitcnt lgkmcnt(6)
 v_mfma_f32_32x32x16_bf16 v[80:95], v[52:55], a[88:91], v[80:95]
 s_add_u32 s30, s23, 32768
 buffer_load_dwordx4 a[140:143], v1, s[4:7], s30 offen offset:3072 sc1
 ds_read_b128 v[48:51], v2 offset:26624
 s_waitcnt lgkmcnt(6)
 v_mfma_f32_32x32x16_bf16 v[64:79], v[56:59], a[92:95], v[64:79]
 v_fmac_f32 v12, v24, v24
 v_sub_f32 v26, v26, v5
 ds_read_b128 v[52:55], v2 offset:64512
 s_waitcnt lgkmcnt(6)
 v_mfma_f32_32x32x16_bf16 v[80:95], v[60:63], a[92:95], v[80:95]
 v_fmac_f32 v13, v26, v26
 v_sub_f32 v28, v28, v5
 ds_read_b128 v[56:59], v2 offset:27648
 s_waitcnt vmcnt(15) lgkmcnt(6)
 v_mfma_f32_32x32x16_bf16 v[64:79], v[32:35], a[96:99], v[64:79]
 s_add_u32 s38, s76, 36864
 s_mov_b32 m0, 36864
 s_nop 0
 buffer_load_dwordx4 v1, s[4:7], s38 offen sc1 lds
 ds_read_b128 v[60:63], v3 offset:0
 s_waitcnt lgkmcnt(6)
 v_mfma_f32_32x32x16_bf16 v[80:95], v[36:39], a[96:99], v[80:95]
 s_add_u32 s38, s76, 74752
 s_mov_b32 m0, 74752
 s_nop 0
 buffer_load_dwordx4 v1, s[4:7], s38 offen sc1 lds
 s_waitcnt vmcnt(12)
 s_barrier
 ds_read_b128 v[32:35], v2 offset:28672
 s_waitcnt lgkmcnt(6)
 v_mfma_f32_32x32x16_bf16 v[64:79], v[40:43], a[100:103], v[64:79]
 v_fmac_f32 v12, v28, v28
 v_sub_f32 v30, v30, v5
 ds_read_b128 v[36:39], v3 offset:1024
 s_waitcnt lgkmcnt(6)
 v_mfma_f32_32x32x16_bf16 v[80:95], v[44:47], a[100:103], v[80:95]
 v_fmac_f32 v13, v30, v30
 v_mul_f32 v12, 0x42800000, v12
 ds_read_b128 v[40:43], v2 offset:29696
 s_waitcnt lgkmcnt(6)
 v_mfma_f32_32x32x16_bf16 v[64:79], v[48:51], a[104:107], v[64:79]
 v_mul_f32 v13, 0x42a00000, v13
 v_add_f32 v12, v12, v13
 ds_read_b128 v[44:47], v3 offset:2048
 s_waitcnt lgkmcnt(6)
 v_mfma_f32_32x32x16_bf16 v[80:95], v[52:55], a[104:107], v[80:95]
 v_add_f32 v12, v12, v17
 v_add_f32 v12, v12, v19
 ds_read_b128 v[48:51], v2 offset:30720
 s_waitcnt lgkmcnt(6)
 v_mfma_f32_32x32x16_bf16 v[64:79], v[56:59], a[108:111], v[64:79]
 v_add_f32 v12, v12, v21
 v_add_f32 v12, v12, v23
 ds_read_b128 v[52:55], v3 offset:3072
 s_waitcnt lgkmcnt(6)
 v_mfma_f32_32x32x16_bf16 v[80:95], v[60:63], a[108:111], v[80:95]
 v_add_f32 v12, v12, v25
 v_add_f32 v12, v12, v27
 ds_read_b128 v[56:59], v2 offset:31744
 s_waitcnt vmcnt(11) lgkmcnt(6)
 v_mfma_f32_32x32x16_bf16 v[64:79], v[32:35], a[112:115], v[64:79]
 v_add_f32 v12, v12, v29
 v_add_f32 v12, v12, v31
 ds_read_b128 v[60:63], v3 offset:4096
 s_waitcnt lgkmcnt(6)
 v_mfma_f32_32x32x16_bf16 v[80:95], v[36:39], a[112:115], v[80:95]
 s_waitcnt vmcnt(6)
 s_barrier
 ds_read_b128 v[32:35], v2 offset:32768
 s_waitcnt lgkmcnt(6)
 v_mfma_f32_32x32x16_bf16 v[64:79], v[40:43], a[116:119], v[64:79]
 v_mov_b32 v13, 0x3727c5ac
 v_mov_b32 v6, 0x3ae38e39
 ds_read_b128 v[36:39], v3 offset:5120
 s_waitcnt lgkmcnt(6)
 v_mfma_f32_32x32x16_bf16 v[80:95], v[44:47], a[116:119], v[80:95]
 v_fma_f32 v6, v12, v6, v13
 v_cmp_gt_u32 vcc, 512, v1
 ds_read_b128 v[40:43], v2 offset:33792
 s_waitcnt lgkmcnt(6)
 v_mfma_f32_32x32x16_bf16 v[64:79], v[48:51], a[120:123], v[64:79]
 v_cvt_pk_bf16_f32 v12, v5, v5
 v_lshlrev_b32 v12, 16, v12
 ds_read_b128 v[44:47], v3 offset:6144
 s_waitcnt lgkmcnt(6)
 v_mfma_f32_32x32x16_bf16 v[80:95], v[52:55], a[120:123], v[80:95]
 v_sub_f32 v14, v5, v12
 v_cvt_pk_bf16_f32 v13, v14, v14
 ds_read_b128 v[48:51], v2 offset:34816
 s_waitcnt lgkmcnt(6)
 v_mfma_f32_32x32x16_bf16 v[64:79], v[56:59], a[124:127], v[64:79]
 v_lshlrev_b32 v13, 16, v13
 v_sub_f32 v14, v14, v13
 ds_read_b128 v[52:55], v3 offset:7168
 s_waitcnt lgkmcnt(6)
 v_mfma_f32_32x32x16_bf16 v[80:95], v[60:63], a[124:127], v[80:95]
 v_cvt_pk_bf16_f32 v8, v12, v12
 v_cvt_pk_bf16_f32 v9, v13, v12
 ds_read_b128 v[56:59], v2 offset:35840
 s_waitcnt vmcnt(5) lgkmcnt(6)
 v_mfma_f32_32x32x16_bf16 v[64:79], v[32:35], a[128:131], v[64:79]
 v_cvt_pk_bf16_f32 v10, v13, v14
 v_mov_b32 v11, 0
 ds_read_b128 v[60:63], v3 offset:8192
 s_waitcnt lgkmcnt(6)
 v_mfma_f32_32x32x16_bf16 v[80:95], v[36:39], a[128:131], v[80:95]
 s_waitcnt vmcnt(0)
 s_barrier
 ds_read_b128 v[32:35], v2 offset:36864
 s_waitcnt lgkmcnt(6)
 v_mfma_f32_32x32x16_bf16 v[64:79], v[40:43], a[132:135], v[64:79]
 v_cndmask_b32 v8, 0, v8, vcc
 v_cndmask_b32 v9, 0, v9, vcc
 ds_read_b128 v[36:39], v3 offset:9216
 s_waitcnt lgkmcnt(6)
 v_mfma_f32_32x32x16_bf16 v[80:95], v[44:47], a[132:135], v[80:95]
 v_cndmask_b32 v10, 0, v10, vcc
 v_rsq_f32 v6, v6
 s_waitcnt lgkmcnt(5)
 v_mfma_f32_32x32x16_bf16 v[64:79], v[48:51], a[136:139], v[64:79]
 s_waitcnt lgkmcnt(4)
 v_mfma_f32_32x32x16_bf16 v[80:95], v[52:55], a[136:139], v[80:95]
 s_waitcnt lgkmcnt(3)
 v_mfma_f32_32x32x16_bf16 v[64:79], v[56:59], a[140:143], v[64:79]
 s_waitcnt lgkmcnt(2)
 v_mfma_f32_32x32x16_bf16 v[80:95], v[60:63], a[140:143], v[80:95]
 s_waitcnt lgkmcnt(1)
 v_mfma_f32_32x32x16_bf16 v[64:79], v[32:35], v[8:11], v[64:79]
 s_waitcnt lgkmcnt(0)
 v_mfma_f32_32x32x16_bf16 v[80:95], v[36:39], v[8:11], v[80:95]
 v_and_b32 v12, 31, v0
 v_bfe_u32 v13, v0, 5, 1
 v_lshlrev_b32 v13, 10, v13
 s_cmp_eq_u32 s27, 8
 s_cselect_b32 s32, 2, 4
 s_cselect_b32 s33, 7, 2
 s_mov_b32 s36, 0x3eae1a93
 s_cselect_b32 s36, s36, 1.0
 s_mov_b32 s35, 151552
 s_cselect_b32 s35, 8192, s35
 s_lshl_b32 s34, s86, 9
 s_add_u32 s34, s34, 13107200
 s_add_u32 s34, s34, s100
 s_and_b32 s37, s86, 1
 s_lshl_b32 s37, s37, 9
 s_add_u32 s37, s37, s31
 s_add_u32 s37, s37, 8192
 s_cmp_eq_u32 s27, 8
 s_cselect_b32 s34, s34, s37
 s_lshl_b32 s33, s3, s33
 v_lshlrev_b32 v16, s32, v12
 v_add3_u32 v16, v16, v13, s33
 v_lshlrev_b32 v18, 4, v0
 v_lshrrev_b32 v13, 5, v0
 v_mul_lo_u32 v19, v13, s35
 v_lshlrev_b32 v21, 4, v12
 v_add_u32 v19, v19, v21
 s_lshl_b32 s35, s35, 3
 v_add_u32 v17, 75776, v16
 v_add_u32 v22, 75776, v18
 v_mul_f32 v6, s36, v6
 v_mul_f32 v64, v64, v6
 v_mul_f32 v65, v65, v6
 v_mul_f32 v66, v66, v6
 v_mul_f32 v67, v67, v6
 v_mul_f32 v68, v68, v6
 v_mul_f32 v69, v69, v6
 v_mul_f32 v70, v70, v6
 v_mul_f32 v71, v71, v6
 v_mul_f32 v72, v72, v6
 v_mul_f32 v73, v73, v6
 v_mul_f32 v74, v74, v6
 v_mul_f32 v75, v75, v6
 v_mul_f32 v76, v76, v6
 v_mul_f32 v77, v77, v6
 v_mul_f32 v78, v78, v6
 v_mul_f32 v79, v79, v6
 v_cvt_pk_bf16_f32 v128, v64, v65
 v_cvt_pk_bf16_f32 v129, v66, v67
 v_cvt_pk_bf16_f32 v130, v68, v69
 v_cvt_pk_bf16_f32 v131, v70, v71
 v_cvt_pk_bf16_f32 v132, v72, v73
 v_cvt_pk_bf16_f32 v133, v74, v75
 v_cvt_pk_bf16_f32 v134, v76, v77
 v_cvt_pk_bf16_f32 v135, v78, v79
 ds_write_b32 v17, v128 offset:0
 ds_write_b32 v17, v129 offset:512
 ds_write_b32 v17, v130 offset:2048
 ds_write_b32 v17, v131 offset:2560
 ds_write_b32 v17, v132 offset:4096
 ds_write_b32 v17, v133 offset:4608
 ds_write_b32 v17, v134 offset:6144
 ds_write_b32 v17, v135 offset:6656
 v_mul_f32 v80, v80, v6
 v_mul_f32 v81, v81, v6
 v_mul_f32 v82, v82, v6
 v_mul_f32 v83, v83, v6
 v_mul_f32 v84, v84, v6
 v_mul_f32 v85, v85, v6
 v_mul_f32 v86, v86, v6
 v_mul_f32 v87, v87, v6
 v_mul_f32 v88, v88, v6
 v_mul_f32 v89, v89, v6
 v_mul_f32 v90, v90, v6
 v_mul_f32 v91, v91, v6
 v_mul_f32 v92, v92, v6
 v_mul_f32 v93, v93, v6
 v_mul_f32 v94, v94, v6
 v_mul_f32 v95, v95, v6
 v_cvt_pk_bf16_f32 v136, v80, v81
 v_cvt_pk_bf16_f32 v137, v82, v83
 v_cvt_pk_bf16_f32 v138, v84, v85
 v_cvt_pk_bf16_f32 v139, v86, v87
 v_cvt_pk_bf16_f32 v140, v88, v89
 v_cvt_pk_bf16_f32 v141, v90, v91
 v_cvt_pk_bf16_f32 v142, v92, v93
 v_cvt_pk_bf16_f32 v143, v94, v95
 ds_write_b32 v17, v136 offset:8192
 ds_write_b32 v17, v137 offset:8704
 ds_write_b32 v17, v138 offset:10240
 ds_write_b32 v17, v139 offset:10752
 ds_write_b32 v17, v140 offset:12288
 ds_write_b32 v17, v141 offset:12800
 ds_write_b32 v17, v142 offset:14336
 ds_write_b32 v17, v143 offset:14848
 s_waitcnt lgkmcnt(0)
 s_barrier
 ds_read_b128 v[64:67], v22 offset:0
 ds_read_b128 v[68:71], v22 offset:4096
 ds_read_b128 v[72:75], v22 offset:8192
 ds_read_b128 v[76:79], v22 offset:12288
 s_waitcnt lgkmcnt(3)
 buffer_store_dwordx4 v[64:67], v19, s[4:7], s34 offen sc1
 s_add_u32 s34, s34, s35
 s_waitcnt lgkmcnt(2)
 buffer_store_dwordx4 v[68:71], v19, s[4:7], s34 offen sc1
 s_add_u32 s34, s34, s35
 s_waitcnt lgkmcnt(1)
 buffer_store_dwordx4 v[72:75], v19, s[4:7], s34 offen sc1
 s_add_u32 s34, s34, s35
 s_waitcnt lgkmcnt(0)
 buffer_store_dwordx4 v[76:79], v19, s[4:7], s34 offen sc1
 s_add_u32 s34, s34, s35
 s_branch K1S_JOIN
K1S_V:
 s_add_u32 s38, s77, 0
 s_add_u32 m0, s78, 0
 s_nop 0
 buffer_load_dwordx4 v1, s[4:7], s38 offen sc1 lds
 s_add_u32 s38, s77, 37888
 s_add_u32 m0, s78, 37888
 s_nop 0
 buffer_load_dwordx4 v1, s[4:7], s38 offen sc1 lds
 s_add_u32 s38, s77, 75776
 s_add_u32 m0, s78, 75776
 s_nop 0
 buffer_load_dwordx4 v1, s[4:7], s38 offen sc1 lds
 s_add_u32 s30, s23, 0
 buffer_load_dwordx4 a[0:3], v1, s[4:7], s30 offen offset:0 sc1
 s_add_u32 s30, s23, 0
 buffer_load_dwordx4 a[4:7], v1, s[4:7], s30 offen offset:1024 sc1
 s_add_u32 s30, s23, 0
 buffer_load_dwordx4 a[8:11], v1, s[4:7], s30 offen offset:2048 sc1
 s_add_u32 s30, s23, 0
 buffer_load_dwordx4 a[12:15], v1, s[4:7], s30 offen offset:3072 sc1
 v_and_b32 v12, 15, v0
 v_lshlrev_b32 v12, 3, v12
 v_bfe_u32 v13, v0, 4, 1
 v_lshlrev_b32 v13, 10, v13
 v_add_u32 v12, v12, v13
 buffer_load_dwordx2 v[16:17], v12, s[4:7], s29 offen offset:0 sc1
 buffer_load_dwordx2 v[18:19], v12, s[4:7], s29 offen offset:128 sc1
 buffer_load_dwordx2 v[20:21], v12, s[4:7], s29 offen offset:256 sc1
 buffer_load_dwordx2 v[22:23], v12, s[4:7], s29 offen offset:384 sc1
 buffer_load_dwordx2 v[24:25], v12, s[4:7], s29 offen offset:512 sc1
 buffer_load_dwordx2 v[26:27], v12, s[4:7], s29 offen offset:640 sc1
 buffer_load_dwordx2 v[28:29], v12, s[4:7], s29 offen offset:768 sc1
 buffer_load_dwordx2 v[30:31], v12, s[4:7], s29 offen offset:896 sc1
 s_add_u32 s38, s77, 4096
 s_add_u32 m0, s78, 4096
 s_nop 0
 buffer_load_dwordx4 v1, s[4:7], s38 offen sc1 lds
 s_add_u32 s38, s77, 41984
 s_add_u32 m0, s78, 41984
 s_nop 0
 buffer_load_dwordx4 v1, s[4:7], s38 offen sc1 lds
 s_add_u32 s38, s77, 79872
 s_add_u32 m0, s78, 79872
 s_nop 0
 buffer_load_dwordx4 v1, s[4:7], s38 offen sc1 lds
 s_add_u32 s30, s23, 4096
 buffer_load_dwordx4 a[16:19], v1, s[4:7], s30 offen offset:0 sc1
 s_add_u32 s30, s23, 4096
 buffer_load_dwordx4 a[20:23], v1, s[4:7], s30 offen offset:1024 sc1
 s_add_u32 s30, s23, 4096
 buffer_load_dwordx4 a[24:27], v1, s[4:7], s30 offen offset:2048 sc1
 s_add_u32 s30, s23, 4096
 buffer_load_dwordx4 a[28:31], v1, s[4:7], s30 offen offset:3072 sc1
 s_add_u32 s38, s77, 8192
 s_add_u32 m0, s78, 8192
 s_nop 0
 buffer_load_dwordx4 v1, s[4:7], s38 offen sc1 lds
 s_add_u32 s38, s77, 46080
 s_add_u32 m0, s78, 46080
 s_nop 0
 buffer_load_dwordx4 v1, s[4:7], s38 offen sc1 lds
 s_add_u32 s38, s77, 83968
 s_add_u32 m0, s78, 83968
 s_nop 0
 buffer_load_dwordx4 v1, s[4:7], s38 offen sc1 lds
 s_add_u32 s30, s23, 8192
 buffer_load_dwordx4 a[32:35], v1, s[4:7], s30 offen offset:0 sc1
 s_add_u32 s30, s23, 8192
 buffer_load_dwordx4 a[36:39], v1, s[4:7], s30 offen offset:1024 sc1
 s_add_u32 s30, s23, 8192
 buffer_load_dwordx4 a[40:43], v1, s[4:7], s30 offen offset:2048 sc1
 s_add_u32 s30, s23, 8192
 buffer_load_dwordx4 a[44:47], v1, s[4:7], s30 offen offset:3072 sc1
 s_waitcnt vmcnt(26)
 s_barrier
 ds_read_b128 v[32:35], v2 offset:0
 ds_read_b128 v[36:39], v2 offset:37888
 ds_read_b128 v[40:43], v3 offset:10240
 ds_read_b128 v[44:47], v2 offset:1024
 ds_read_b128 v[48:51], v2 offset:38912
 ds_read_b128 v[52:55], v3 offset:11264
 ds_read_b128 v[56:59], v2 offset:2048
 s_waitcnt vmcnt(25) lgkmcnt(6)
 v_mfma_f32_32x32x16_bf16 v[64:79], a[0:3], v[32:35], 0
 s_add_u32 s38, s77, 12288
 s_add_u32 m0, s78, 12288
 s_nop 0
 buffer_load_dwordx4 v1, s[4:7], s38 offen sc1 lds
 ds_read_b128 v[60:63], v2 offset:39936
 s_waitcnt lgkmcnt(6)
 v_mfma_f32_32x32x16_bf16 v[80:95], a[0:3], v[36:39], 0
 s_add_u32 s38, s77, 50176
 s_add_u32 m0, s78, 50176
 s_nop 0
 buffer_load_dwordx4 v1, s[4:7], s38 offen sc1 lds
 ds_read_b128 v[32:35], v3 offset:12288
 s_waitcnt lgkmcnt(6)
 v_mfma_f32_32x32x16_bf16 v[96:111], a[0:3], v[40:43], 0
 s_add_u32 s38, s77, 88064
 s_add_u32 m0, s78, 88064
 s_nop 0
 buffer_load_dwordx4 v1, s[4:7], s38 offen sc1 lds
 ds_read_b128 v[36:39], v2 offset:3072
 s_waitcnt vmcnt(27) lgkmcnt(6)
 v_mfma_f32_32x32x16_bf16 v[64:79], a[4:7], v[44:47], v[64:79]
 s_add_u32 s30, s23, 12288
 buffer_load_dwordx4 a[48:51], v1, s[4:7], s30 offen offset:0 sc1
 ds_read_b128 v[40:43], v2 offset:40960
 s_waitcnt lgkmcnt(6)
 v_mfma_f32_32x32x16_bf16 v[80:95], a[4:7], v[48:51], v[80:95]
 s_add_u32 s30, s23, 12288
 buffer_load_dwordx4 a[52:55], v1, s[4:7], s30 offen offset:1024 sc1
 ds_read_b128 v[44:47], v3 offset:13312
 s_waitcnt lgkmcnt(6)
 v_mfma_f32_32x32x16_bf16 v[96:111], a[4:7], v[52:55], v[96:111]
 s_add_u32 s30, s23, 12288
 buffer_load_dwordx4 a[56:59], v1, s[4:7], s30 offen offset:2048 sc1
 s_waitcnt vmcnt(17)
 s_barrier
 ds_read_b128 v[48:51], v2 offset:4096
 s_waitcnt lgkmcnt(6)
 v_mfma_f32_32x32x16_bf16 v[64:79], a[8:11], v[56:59], v[64:79]
 s_add_u32 s30, s23, 12288
 buffer_load_dwordx4 a[60:63], v1, s[4:7], s30 offen offset:3072 sc1
 ds_read_b128 v[52:55], v2 offset:41984
 s_waitcnt lgkmcnt(6)
 v_mfma_f32_32x32x16_bf16 v[80:95], a[8:11], v[60:63], v[80:95]
 ds_read_b128 v[56:59], v3 offset:14336
 s_waitcnt lgkmcnt(6)
 v_mfma_f32_32x32x16_bf16 v[96:111], a[8:11], v[32:35], v[96:111]
 ds_read_b128 v[60:63], v2 offset:5120
 s_waitcnt lgkmcnt(6)
 v_mfma_f32_32x32x16_bf16 v[64:79], a[12:15], v[36:39], v[64:79]
 v_add_f32 v12, v16, v20
 v_add_f32 v13, v18, v22
 ds_read_b128 v[32:35], v2 offset:43008
 s_waitcnt lgkmcnt(6)
 v_mfma_f32_32x32x16_bf16 v[80:95], a[12:15], v[40:43], v[80:95]
 v_add_f32 v12, v12, v24
 v_add_f32 v13, v13, v26
 ds_read_b128 v[36:39], v3 offset:15360
 s_waitcnt lgkmcnt(6)
 v_mfma_f32_32x32x16_bf16 v[96:111], a[12:15], v[44:47], v[96:111]
 v_add_f32 v12, v12, v28
 v_add_f32 v13, v13, v30
 ds_read_b128 v[40:43], v2 offset:6144
 s_waitcnt vmcnt(17) lgkmcnt(6)
 v_mfma_f32_32x32x16_bf16 v[64:79], a[16:19], v[48:51], v[64:79]
 s_add_u32 s38, s77, 16384
 s_add_u32 m0, s78, 16384
 s_nop 0
 buffer_load_dwordx4 v1, s[4:7], s38 offen sc1 lds
 ds_read_b128 v[44:47], v2 offset:44032
 s_waitcnt lgkmcnt(6)
 v_mfma_f32_32x32x16_bf16 v[80:95], a[16:19], v[52:55], v[80:95]
 s_add_u32 s38, s77, 54272
 s_add_u32 m0, s78, 54272
 s_nop 0
 buffer_load_dwordx4 v1, s[4:7], s38 offen sc1 lds
 ds_read_b128 v[48:51], v3 offset:16384
 s_waitcnt lgkmcnt(6)
 v_mfma_f32_32x32x16_bf16 v[96:111], a[16:19], v[56:59], v[96:111]
 s_add_u32 s38, s77, 92160
 s_add_u32 m0, s78, 92160
 s_nop 0
 buffer_load_dwordx4 v1, s[4:7], s38 offen sc1 lds
 ds_read_b128 v[52:55], v2 offset:7168
 s_waitcnt vmcnt(19) lgkmcnt(6)
 v_mfma_f32_32x32x16_bf16 v[64:79], a[20:23], v[60:63], v[64:79]
 s_add_u32 s30, s23, 16384
 buffer_load_dwordx4 a[64:67], v1, s[4:7], s30 offen offset:0 sc1
 ds_read_b128 v[56:59], v2 offset:45056
 s_waitcnt lgkmcnt(6)
 v_mfma_f32_32x32x16_bf16 v[80:95], a[20:23], v[32:35], v[80:95]
 s_add_u32 s30, s23, 16384
 buffer_load_dwordx4 a[68:71], v1, s[4:7], s30 offen offset:1024 sc1
 ds_read_b128 v[60:63], v3 offset:17408
 s_waitcnt lgkmcnt(6)
 v_mfma_f32_32x32x16_bf16 v[96:111], a[20:23], v[36:39], v[96:111]
 s_add_u32 s30, s23, 16384
 buffer_load_dwordx4 a[72:75], v1, s[4:7], s30 offen offset:2048 sc1
 s_waitcnt vmcnt(17)
 s_barrier
 ds_read_b128 v[32:35], v2 offset:8192
 s_waitcnt lgkmcnt(6)
 v_mfma_f32_32x32x16_bf16 v[64:79], a[24:27], v[40:43], v[64:79]
 s_add_u32 s30, s23, 16384
 buffer_load_dwordx4 a[76:79], v1, s[4:7], s30 offen offset:3072 sc1
 ds_read_b128 v[36:39], v2 offset:46080
 s_waitcnt lgkmcnt(6)
 v_mfma_f32_32x32x16_bf16 v[80:95], a[24:27], v[44:47], v[80:95]
 v_mul_f32 v12, 0x3de38e39, v12
 v_mul_f32 v13, 0x3e0e38e4, v13
 ds_read_b128 v[40:43], v3 offset:18432
 s_waitcnt lgkmcnt(6)
 v_mfma_f32_32x32x16_bf16 v[96:111], a[24:27], v[48:51], v[96:111]
 v_add_f32 v5, v12, v13
 v_mov_b32 v12, 0
 ds_read_b128 v[44:47], v2 offset:9216
 s_waitcnt lgkmcnt(6)
 v_mfma_f32_32x32x16_bf16 v[64:79], a[28:31], v[52:55], v[64:79]
 v_mov_b32 v13, 0
 v_sub_f32 v16, v16, v5
 ds_read_b128 v[48:51], v2 offset:47104
 s_waitcnt lgkmcnt(6)
 v_mfma_f32_32x32x16_bf16 v[80:95], a[28:31], v[56:59], v[80:95]
 v_fmac_f32 v12, v16, v16
 v_sub_f32 v18, v18, v5
 ds_read_b128 v[52:55], v3 offset:19456
 s_waitcnt lgkmcnt(6)
 v_mfma_f32_32x32x16_bf16 v[96:111], a[28:31], v[60:63], v[96:111]
 v_fmac_f32 v13, v18, v18
 v_sub_f32 v20, v20, v5
 ds_read_b128 v[56:59], v2 offset:10240
 s_waitcnt vmcnt(17) lgkmcnt(6)
 v_mfma_f32_32x32x16_bf16 v[64:79], a[32:35], v[32:35], v[64:79]
 s_add_u32 s38, s77, 20480
 s_add_u32 m0, s78, 20480
 s_nop 0
 buffer_load_dwordx4 v1, s[4:7], s38 offen sc1 lds
 ds_read_b128 v[60:63], v2 offset:48128
 s_waitcnt lgkmcnt(6)
 v_mfma_f32_32x32x16_bf16 v[80:95], a[32:35], v[36:39], v[80:95]
 s_add_u32 s38, s77, 58368
 s_add_u32 m0, s78, 58368
 s_nop 0
 buffer_load_dwordx4 v1, s[4:7], s38 offen sc1 lds
 ds_read_b128 v[32:35], v3 offset:20480
 s_waitcnt lgkmcnt(6)
 v_mfma_f32_32x32x16_bf16 v[96:111], a[32:35], v[40:43], v[96:111]
 s_add_u32 s38, s77, 96256
 s_add_u32 m0, s78, 96256
 s_nop 0
 buffer_load_dwordx4 v1, s[4:7], s38 offen sc1 lds
 ds_read_b128 v[36:39], v2 offset:11264
 s_waitcnt vmcnt(19) lgkmcnt(6)
 v_mfma_f32_32x32x16_bf16 v[64:79], a[36:39], v[44:47], v[64:79]
 s_add_u32 s30, s23, 20480
 buffer_load_dwordx4 a[80:83], v1, s[4:7], s30 offen offset:0 sc1
 ds_read_b128 v[40:43], v2 offset:49152
 s_waitcnt lgkmcnt(6)
 v_mfma_f32_32x32x16_bf16 v[80:95], a[36:39], v[48:51], v[80:95]
 s_add_u32 s30, s23, 20480
 buffer_load_dwordx4 a[84:87], v1, s[4:7], s30 offen offset:1024 sc1
 ds_read_b128 v[44:47], v3 offset:21504
 s_waitcnt lgkmcnt(6)
 v_mfma_f32_32x32x16_bf16 v[96:111], a[36:39], v[52:55], v[96:111]
 s_add_u32 s30, s23, 20480
 buffer_load_dwordx4 a[88:91], v1, s[4:7], s30 offen offset:2048 sc1
 s_waitcnt vmcnt(17)
 s_barrier
 ds_read_b128 v[48:51], v2 offset:12288
 s_waitcnt lgkmcnt(6)
 v_mfma_f32_32x32x16_bf16 v[64:79], a[40:43], v[56:59], v[64:79]
 s_add_u32 s30, s23, 20480
 buffer_load_dwordx4 a[92:95], v1, s[4:7], s30 offen offset:3072 sc1
 ds_read_b128 v[52:55], v2 offset:50176
 s_waitcnt lgkmcnt(6)
 v_mfma_f32_32x32x16_bf16 v[80:95], a[40:43], v[60:63], v[80:95]
 v_fmac_f32 v12, v20, v20
 v_sub_f32 v22, v22, v5
 ds_read_b128 v[56:59], v3 offset:22528
 s_waitcnt lgkmcnt(6)
 v_mfma_f32_32x32x16_bf16 v[96:111], a[40:43], v[32:35], v[96:111]
 v_fmac_f32 v13, v22, v22
 v_sub_f32 v24, v24, v5
 ds_read_b128 v[60:63], v2 offset:13312
 s_waitcnt lgkmcnt(6)
 v_mfma_f32_32x32x16_bf16 v[64:79], a[44:47], v[36:39], v[64:79]
 v_fmac_f32 v12, v24, v24
 v_sub_f32 v26, v26, v5
 ds_read_b128 v[32:35], v2 offset:51200
 s_waitcnt lgkmcnt(6)
 v_mfma_f32_32x32x16_bf16 v[80:95], a[44:47], v[40:43], v[80:95]
 v_fmac_f32 v13, v26, v26
 v_sub_f32 v28, v28, v5
 ds_read_b128 v[36:39], v3 offset:23552
 s_waitcnt lgkmcnt(6)
 v_mfma_f32_32x32x16_bf16 v[96:111], a[44:47], v[44:47], v[96:111]
 v_fmac_f32 v12, v28, v28
 v_sub_f32 v30, v30, v5
 ds_read_b128 v[40:43], v2 offset:14336
 s_waitcnt vmcnt(17) lgkmcnt(6)
 v_mfma_f32_32x32x16_bf16 v[64:79], a[48:51], v[48:51], v[64:79]
 s_add_u32 s38, s77, 24576
 s_add_u32 m0, s78, 24576
 s_nop 0
 buffer_load_dwordx4 v1, s[4:7], s38 offen sc1 lds
 ds_read_b128 v[44:47], v2 offset:52224
 s_waitcnt lgkmcnt(6)
 v_mfma_f32_32x32x16_bf16 v[80:95], a[48:51], v[52:55], v[80:95]
 s_add_u32 s38, s77, 62464
 s_add_u32 m0, s78, 62464
 s_nop 0
 buffer_load_dwordx4 v1, s[4:7], s38 offen sc1 lds
 ds_read_b128 v[48:51], v3 offset:24576
 s_waitcnt lgkmcnt(6)
 v_mfma_f32_32x32x16_bf16 v[96:111], a[48:51], v[56:59], v[96:111]
 s_add_u32 s38, s77, 100352
 s_add_u32 m0, s78, 100352
 s_nop 0
 buffer_load_dwordx4 v1, s[4:7], s38 offen sc1 lds
 ds_read_b128 v[52:55], v2 offset:15360
 s_waitcnt vmcnt(19) lgkmcnt(6)
 v_mfma_f32_32x32x16_bf16 v[64:79], a[52:55], v[60:63], v[64:79]
 s_add_u32 s30, s23, 24576
 buffer_load_dwordx4 a[96:99], v1, s[4:7], s30 offen offset:0 sc1
 ds_read_b128 v[56:59], v2 offset:53248
 s_waitcnt lgkmcnt(6)
 v_mfma_f32_32x32x16_bf16 v[80:95], a[52:55], v[32:35], v[80:95]
 s_add_u32 s30, s23, 24576
 buffer_load_dwordx4 a[100:103], v1, s[4:7], s30 offen offset:1024 sc1
 ds_read_b128 v[60:63], v3 offset:25600
 s_waitcnt lgkmcnt(6)
 v_mfma_f32_32x32x16_bf16 v[96:111], a[52:55], v[36:39], v[96:111]
 s_add_u32 s30, s23, 24576
 buffer_load_dwordx4 a[104:107], v1, s[4:7], s30 offen offset:2048 sc1
 s_waitcnt vmcnt(17)
 s_barrier
 ds_read_b128 v[32:35], v2 offset:16384
 s_waitcnt lgkmcnt(6)
 v_mfma_f32_32x32x16_bf16 v[64:79], a[56:59], v[40:43], v[64:79]
 s_add_u32 s30, s23, 24576
 buffer_load_dwordx4 a[108:111], v1, s[4:7], s30 offen offset:3072 sc1
 ds_read_b128 v[36:39], v2 offset:54272
 s_waitcnt lgkmcnt(6)
 v_mfma_f32_32x32x16_bf16 v[80:95], a[56:59], v[44:47], v[80:95]
 v_fmac_f32 v13, v30, v30
 v_mul_f32 v12, 0x42800000, v12
 ds_read_b128 v[40:43], v3 offset:26624
 s_waitcnt lgkmcnt(6)
 v_mfma_f32_32x32x16_bf16 v[96:111], a[56:59], v[48:51], v[96:111]
 v_mul_f32 v13, 0x42a00000, v13
 v_add_f32 v12, v12, v13
 ds_read_b128 v[44:47], v2 offset:17408
 s_waitcnt lgkmcnt(6)
 v_mfma_f32_32x32x16_bf16 v[64:79], a[60:63], v[52:55], v[64:79]
 v_add_f32 v12, v12, v17
 v_add_f32 v12, v12, v19
 ds_read_b128 v[48:51], v2 offset:55296
 s_waitcnt lgkmcnt(6)
 v_mfma_f32_32x32x16_bf16 v[80:95], a[60:63], v[56:59], v[80:95]
 v_add_f32 v12, v12, v21
 v_add_f32 v12, v12, v23
 ds_read_b128 v[52:55], v3 offset:27648
 s_waitcnt lgkmcnt(6)
 v_mfma_f32_32x32x16_bf16 v[96:111], a[60:63], v[60:63], v[96:111]
 v_add_f32 v12, v12, v25
 v_add_f32 v12, v12, v27
 ds_read_b128 v[56:59], v2 offset:18432
 s_waitcnt vmcnt(17) lgkmcnt(6)
 v_mfma_f32_32x32x16_bf16 v[64:79], a[64:67], v[32:35], v[64:79]
 s_add_u32 s38, s77, 28672
 s_add_u32 m0, s78, 28672
 s_nop 0
 buffer_load_dwordx4 v1, s[4:7], s38 offen sc1 lds
 ds_read_b128 v[60:63], v2 offset:56320
 s_waitcnt lgkmcnt(6)
 v_mfma_f32_32x32x16_bf16 v[80:95], a[64:67], v[36:39], v[80:95]
 s_add_u32 s38, s77, 66560
 s_add_u32 m0, s78, 66560
 s_nop 0
 buffer_load_dwordx4 v1, s[4:7], s38 offen sc1 lds
 ds_read_b128 v[32:35], v3 offset:28672
 s_waitcnt lgkmcnt(6)
 v_mfma_f32_32x32x16_bf16 v[96:111], a[64:67], v[40:43], v[96:111]
 s_add_u32 s38, s77, 104448
 s_add_u32 m0, s78, 104448
 s_nop 0
 buffer_load_dwordx4 v1, s[4:7], s38 offen sc1 lds
 ds_read_b128 v[36:39], v2 offset:19456
 s_waitcnt vmcnt(19) lgkmcnt(6)
 v_mfma_f32_32x32x16_bf16 v[64:79], a[68:71], v[44:47], v[64:79]
 s_add_u32 s30, s23, 28672
 buffer_load_dwordx4 a[112:115], v1, s[4:7], s30 offen offset:0 sc1
 ds_read_b128 v[40:43], v2 offset:57344
 s_waitcnt lgkmcnt(6)
 v_mfma_f32_32x32x16_bf16 v[80:95], a[68:71], v[48:51], v[80:95]
 s_add_u32 s30, s23, 28672
 buffer_load_dwordx4 a[116:119], v1, s[4:7], s30 offen offset:1024 sc1
 ds_read_b128 v[44:47], v3 offset:29696
 s_waitcnt lgkmcnt(6)
 v_mfma_f32_32x32x16_bf16 v[96:111], a[68:71], v[52:55], v[96:111]
 s_add_u32 s30, s23, 28672
 buffer_load_dwordx4 a[120:123], v1, s[4:7], s30 offen offset:2048 sc1
 s_waitcnt vmcnt(17)
 s_barrier
 ds_read_b128 v[48:51], v2 offset:20480
 s_waitcnt lgkmcnt(6)
 v_mfma_f32_32x32x16_bf16 v[64:79], a[72:75], v[56:59], v[64:79]
 s_add_u32 s30, s23, 28672
 buffer_load_dwordx4 a[124:127], v1, s[4:7], s30 offen offset:3072 sc1
 ds_read_b128 v[52:55], v2 offset:58368
 s_waitcnt lgkmcnt(6)
 v_mfma_f32_32x32x16_bf16 v[80:95], a[72:75], v[60:63], v[80:95]
 v_add_f32 v12, v12, v29
 v_add_f32 v12, v12, v31
 ds_read_b128 v[56:59], v3 offset:30720
 s_waitcnt lgkmcnt(6)
 v_mfma_f32_32x32x16_bf16 v[96:111], a[72:75], v[32:35], v[96:111]
 v_mov_b32 v13, 0x3727c5ac
 v_mov_b32 v6, 0x3ae38e39
 ds_read_b128 v[60:63], v2 offset:21504
 s_waitcnt lgkmcnt(6)
 v_mfma_f32_32x32x16_bf16 v[64:79], a[76:79], v[36:39], v[64:79]
 v_fma_f32 v6, v12, v6, v13
 v_cmp_gt_u32 vcc, 512, v1
 ds_read_b128 v[32:35], v2 offset:59392
 s_waitcnt lgkmcnt(6)
 v_mfma_f32_32x32x16_bf16 v[80:95], a[76:79], v[40:43], v[80:95]
 v_cvt_pk_bf16_f32 v12, v5, v5
 v_lshlrev_b32 v12, 16, v12
 ds_read_b128 v[36:39], v3 offset:31744
 s_waitcnt lgkmcnt(6)
 v_mfma_f32_32x32x16_bf16 v[96:111], a[76:79], v[44:47], v[96:111]
 v_sub_f32 v14, v5, v12
 v_cvt_pk_bf16_f32 v13, v14, v14
 ds_read_b128 v[40:43], v2 offset:22528
 s_waitcnt vmcnt(17) lgkmcnt(6)
 v_mfma_f32_32x32x16_bf16 v[64:79], a[80:83], v[48:51], v[64:79]
 s_add_u32 s38, s77, 32768
 s_add_u32 m0, s78, 32768
 s_nop 0
 buffer_load_dwordx4 v1, s[4:7], s38 offen sc1 lds
 ds_read_b128 v[44:47], v2 offset:60416
 s_waitcnt lgkmcnt(6)
 v_mfma_f32_32x32x16_bf16 v[80:95], a[80:83], v[52:55], v[80:95]
 s_add_u32 s38, s77, 70656
 s_add_u32 m0, s78, 70656
 s_nop 0
 buffer_load_dwordx4 v1, s[4:7], s38 offen sc1 lds
 ds_read_b128 v[48:51], v3 offset:32768
 s_waitcnt lgkmcnt(6)
 v_mfma_f32_32x32x16_bf16 v[96:111], a[80:83], v[56:59], v[96:111]
 s_add_u32 s38, s77, 108544
 s_add_u32 m0, s78, 108544
 s_nop 0
 buffer_load_dwordx4 v1, s[4:7], s38 offen sc1 lds
 ds_read_b128 v[52:55], v2 offset:23552
 s_waitcnt vmcnt(19) lgkmcnt(6)
 v_mfma_f32_32x32x16_bf16 v[64:79], a[84:87], v[60:63], v[64:79]
 s_add_u32 s30, s23, 32768
 buffer_load_dwordx4 a[128:131], v1, s[4:7], s30 offen offset:0 sc1
 ds_read_b128 v[56:59], v2 offset:61440
 s_waitcnt lgkmcnt(6)
 v_mfma_f32_32x32x16_bf16 v[80:95], a[84:87], v[32:35], v[80:95]
 s_add_u32 s30, s23, 32768
 buffer_load_dwordx4 a[132:135], v1, s[4:7], s30 offen offset:1024 sc1
 ds_read_b128 v[60:63], v3 offset:33792
 s_waitcnt lgkmcnt(6)
 v_mfma_f32_32x32x16_bf16 v[96:111], a[84:87], v[36:39], v[96:111]
 s_add_u32 s30, s23, 32768
 buffer_load_dwordx4 a[136:139], v1, s[4:7], s30 offen offset:2048 sc1
 s_waitcnt vmcnt(17)
 s_barrier
 ds_read_b128 v[32:35], v2 offset:24576
 s_waitcnt lgkmcnt(6)
 v_mfma_f32_32x32x16_bf16 v[64:79], a[88:91], v[40:43], v[64:79]
 s_add_u32 s30, s23, 32768
 buffer_load_dwordx4 a[140:143], v1, s[4:7], s30 offen offset:3072 sc1
 ds_read_b128 v[36:39], v2 offset:62464
 s_waitcnt lgkmcnt(6)
 v_mfma_f32_32x32x16_bf16 v[80:95], a[88:91], v[44:47], v[80:95]
 v_lshlrev_b32 v13, 16, v13
 v_sub_f32 v14, v14, v13
 ds_read_b128 v[40:43], v3 offset:34816
 s_waitcnt lgkmcnt(6)
 v_mfma_f32_32x32x16_bf16 v[96:111], a[88:91], v[48:51], v[96:111]
 v_cvt_pk_bf16_f32 v8, v12, v12
 v_cvt_pk_bf16_f32 v9, v13, v12
 ds_read_b128 v[44:47], v2 offset:25600
 s_waitcnt lgkmcnt(6)
 v_mfma_f32_32x32x16_bf16 v[64:79], a[92:95], v[52:55], v[64:79]
 v_cvt_pk_bf16_f32 v10, v13, v14
 v_mov_b32 v11, 0
 ds_read_b128 v[48:51], v2 offset:63488
 s_waitcnt lgkmcnt(6)
 v_mfma_f32_32x32x16_bf16 v[80:95], a[92:95], v[56:59], v[80:95]
 v_cndmask_b32 v8, 0, v8, vcc
 v_cndmask_b32 v9, 0, v9, vcc
 ds_read_b128 v[52:55], v3 offset:35840
 s_waitcnt lgkmcnt(6)
 v_mfma_f32_32x32x16_bf16 v[96:111], a[92:95], v[60:63], v[96:111]
 v_cndmask_b32 v10, 0, v10, vcc
 ds_read_b128 v[56:59], v2 offset:26624
 s_waitcnt vmcnt(17) lgkmcnt(6)
 v_mfma_f32_32x32x16_bf16 v[64:79], a[96:99], v[32:35], v[64:79]
 s_add_u32 s38, s76, 36864
 s_mov_b32 m0, 36864
 s_nop 0
 buffer_load_dwordx4 v1, s[4:7], s38 offen sc1 lds
 ds_read_b128 v[60:63], v2 offset:64512
 s_waitcnt lgkmcnt(6)
 v_mfma_f32_32x32x16_bf16 v[80:95], a[96:99], v[36:39], v[80:95]
 s_add_u32 s38, s76, 74752
 s_mov_b32 m0, 74752
 s_nop 0
 buffer_load_dwordx4 v1, s[4:7], s38 offen sc1 lds
 ds_read_b128 v[32:35], v3 offset:36864
 s_waitcnt lgkmcnt(6)
 v_mfma_f32_32x32x16_bf16 v[96:111], a[96:99], v[40:43], v[96:111]
 s_add_u32 s38, s76, 112640
 s_mov_b32 m0, 112640
 s_nop 0
 buffer_load_dwordx4 v1, s[4:7], s38 offen sc1 lds
 ds_read_b128 v[36:39], v2 offset:27648
 s_waitcnt vmcnt(19) lgkmcnt(6)
 v_mfma_f32_32x32x16_bf16 v[64:79], a[100:103], v[44:47], v[64:79]
 v_rsq_f32 v6, v6
 ds_read_b128 v[40:43], v3 offset:0
 s_waitcnt lgkmcnt(6)
 v_mfma_f32_32x32x16_bf16 v[80:95], a[100:103], v[48:51], v[80:95]
 ds_read_b128 v[44:47], v3 offset:37888
 s_waitcnt lgkmcnt(6)
 v_mfma_f32_32x32x16_bf16 v[96:111], a[100:103], v[52:55], v[96:111]
 s_waitcnt vmcnt(14)
 s_barrier
 ds_read_b128 v[48:51], v2 offset:28672
 s_waitcnt lgkmcnt(6)
 v_mfma_f32_32x32x16_bf16 v[64:79], a[104:107], v[56:59], v[64:79]
 ds_read_b128 v[52:55], v3 offset:1024
 s_waitcnt lgkmcnt(6)
 v_mfma_f32_32x32x16_bf16 v[80:95], a[104:107], v[60:63], v[80:95]
 ds_read_b128 v[56:59], v3 offset:38912
 s_waitcnt lgkmcnt(6)
 v_mfma_f32_32x32x16_bf16 v[96:111], a[104:107], v[32:35], v[96:111]
 ds_read_b128 v[60:63], v2 offset:29696
 s_waitcnt lgkmcnt(6)
 v_mfma_f32_32x32x16_bf16 v[64:79], a[108:111], v[36:39], v[64:79]
 ds_read_b128 v[32:35], v3 offset:2048
 s_waitcnt lgkmcnt(6)
 v_mfma_f32_32x32x16_bf16 v[80:95], a[108:111], v[40:43], v[80:95]
 ds_read_b128 v[36:39], v3 offset:39936
 s_waitcnt lgkmcnt(6)
 v_mfma_f32_32x32x16_bf16 v[96:111], a[108:111], v[44:47], v[96:111]
 ds_read_b128 v[40:43], v2 offset:30720
 s_waitcnt vmcnt(13) lgkmcnt(6)
 v_mfma_f32_32x32x16_bf16 v[64:79], a[112:115], v[48:51], v[64:79]
 ds_read_b128 v[44:47], v3 offset:3072
 s_waitcnt lgkmcnt(6)
 v_mfma_f32_32x32x16_bf16 v[80:95], a[112:115], v[52:55], v[80:95]
 ds_read_b128 v[48:51], v3 offset:40960
 s_waitcnt lgkmcnt(6)
 v_mfma_f32_32x32x16_bf16 v[96:111], a[112:115], v[56:59], v[96:111]
 ds_read_b128 v[52:55], v2 offset:31744
 s_waitcnt vmcnt(12) lgkmcnt(6)
 v_mfma_f32_32x32x16_bf16 v[64:79], a[116:119], v[60:63], v[64:79]
 ds_read_b128 v[56:59], v3 offset:4096
 s_waitcnt lgkmcnt(6)
 v_mfma_f32_32x32x16_bf16 v[80:95], a[116:119], v[32:35], v[80:95]
 ds_read_b128 v[60:63], v3 offset:41984
 s_waitcnt lgkmcnt(6)
 v_mfma_f32_32x32x16_bf16 v[96:111], a[116:119], v[36:39], v[96:111]
 s_waitcnt vmcnt(7)
 s_barrier
 ds_read_b128 v[32:35], v2 offset:32768
 s_waitcnt lgkmcnt(6)
 v_mfma_f32_32x32x16_bf16 v[64:79], a[120:123], v[40:43], v[64:79]
 ds_read_b128 v[36:39], v3 offset:5120
 s_waitcnt lgkmcnt(6)
 v_mfma_f32_32x32x16_bf16 v[80:95], a[120:123], v[44:47], v[80:95]
 ds_read_b128 v[40:43], v3 offset:43008
 s_waitcnt lgkmcnt(6)
 v_mfma_f32_32x32x16_bf16 v[96:111], a[120:123], v[48:51], v[96:111]
 ds_read_b128 v[44:47], v2 offset:33792
 s_waitcnt lgkmcnt(6)
 v_mfma_f32_32x32x16_bf16 v[64:79], a[124:127], v[52:55], v[64:79]
 ds_read_b128 v[48:51], v3 offset:6144
 s_waitcnt lgkmcnt(6)
 v_mfma_f32_32x32x16_bf16 v[80:95], a[124:127], v[56:59], v[80:95]
 ds_read_b128 v[52:55], v3 offset:44032
 s_waitcnt lgkmcnt(6)
 v_mfma_f32_32x32x16_bf16 v[96:111], a[124:127], v[60:63], v[96:111]
 ds_read_b128 v[56:59], v2 offset:34816
 s_waitcnt vmcnt(6) lgkmcnt(6)
 v_mfma_f32_32x32x16_bf16 v[64:79], a[128:131], v[32:35], v[64:79]
 ds_read_b128 v[60:63], v3 offset:7168
 s_waitcnt lgkmcnt(6)
 v_mfma_f32_32x32x16_bf16 v[80:95], a[128:131], v[36:39], v[80:95]
 ds_read_b128 v[32:35], v3 offset:45056
 s_waitcnt lgkmcnt(6)
 v_mfma_f32_32x32x16_bf16 v[96:111], a[128:131], v[40:43], v[96:111]
 ds_read_b128 v[36:39], v2 offset:35840
 s_waitcnt vmcnt(5) lgkmcnt(6)
 v_mfma_f32_32x32x16_bf16 v[64:79], a[132:135], v[44:47], v[64:79]
 ds_read_b128 v[40:43], v3 offset:8192
 s_waitcnt lgkmcnt(6)
 v_mfma_f32_32x32x16_bf16 v[80:95], a[132:135], v[48:51], v[80:95]
 ds_read_b128 v[44:47], v3 offset:46080
 s_waitcnt lgkmcnt(6)
 v_mfma_f32_32x32x16_bf16 v[96:111], a[132:135], v[52:55], v[96:111]
 s_waitcnt vmcnt(0)
 s_barrier
 ds_read_b128 v[48:51], v2 offset:36864
 s_waitcnt lgkmcnt(6)
 v_mfma_f32_32x32x16_bf16 v[64:79], a[136:139], v[56:59], v[64:79]
 ds_read_b128 v[52:55], v3 offset:9216
 s_waitcnt lgkmcnt(6)
 v_mfma_f32_32x32x16_bf16 v[80:95], a[136:139], v[60:63], v[80:95]
 ds_read_b128 v[56:59], v3 offset:47104
 s_waitcnt lgkmcnt(6)
 v_mfma_f32_32x32x16_bf16 v[96:111], a[136:139], v[32:35], v[96:111]
 s_waitcnt lgkmcnt(5)
 v_mfma_f32_32x32x16_bf16 v[64:79], a[140:143], v[36:39], v[64:79]
 s_waitcnt lgkmcnt(4)
 v_mfma_f32_32x32x16_bf16 v[80:95], a[140:143], v[40:43], v[80:95]
 s_waitcnt lgkmcnt(3)
 v_mfma_f32_32x32x16_bf16 v[96:111], a[140:143], v[44:47], v[96:111]
 s_waitcnt lgkmcnt(2)
 v_mfma_f32_32x32x16_bf16 v[64:79], v[8:11], v[48:51], v[64:79]
 s_waitcnt lgkmcnt(1)
 v_mfma_f32_32x32x16_bf16 v[80:95], v[8:11], v[52:55], v[80:95]
 s_waitcnt lgkmcnt(0)
 v_mfma_f32_32x32x16_bf16 v[96:111], v[8:11], v[56:59], v[96:111]
 v_and_b32 v12, 31, v0
 v_lshlrev_b32 v13, 2, v12
 s_lshl_b32 s32, s3, 7
 s_add_u32 s32, s32, 151552
 v_add_u32 v13, s32, v13
 ds_write_b32 v13, v6
 v_bfe_u32 v14, v0, 5, 1
 v_lshlrev_b32 v13, 4, v14
 v_add_u32 v13, s32, v13
 s_waitcnt lgkmcnt(0)
 ds_read_b128 v[16:19], v13 offset:0
 ds_read_b128 v[20:23], v13 offset:32
 ds_read_b128 v[24:27], v13 offset:64
 ds_read_b128 v[28:31], v13 offset:96
 s_sub_u32 s32, s27, 9
 s_mul_i32 s32, s32, 96
 v_add_u32 v12, s32, v12
 v_mul_u32_u24 v14, 304, v14
 s_and_b32 s33, s26, 7
 s_mul_i32 s33, s33, 1216
 s_add_u32 s33, s33, s31
 s_add_u32 s33, s33, 9216
 s_mov_b32 s34, 151552
 s_waitcnt lgkmcnt(0)
 v_mul_u32_u24 v13, 3641, v12
 v_lshrrev_b32 v13, 16, v13
 v_mul_u32_u24 v15, 18, v13
 v_sub_u32 v15, v12, v15
 v_mul_lo_u32 v13, v13, s34
 v_lshlrev_b32 v15, 4, v15
 v_add3_u32 v7, v13, v15, v14
 v_add_u32 v12, 32, v12
 v_mul_f32 v64, v64, v16
 v_mul_f32 v65, v65, v17
 v_mul_f32 v66, v66, v18
 v_mul_f32 v67, v67, v19
 v_mul_f32 v68, v68, v20
 v_mul_f32 v69, v69, v21
 v_mul_f32 v70, v70, v22
 v_mul_f32 v71, v71, v23
 v_mul_f32 v72, v72, v24
 v_mul_f32 v73, v73, v25
 v_mul_f32 v74, v74, v26
 v_mul_f32 v75, v75, v27
 v_mul_f32 v76, v76, v28
 v_mul_f32 v77, v77, v29
 v_mul_f32 v78, v78, v30
 v_mul_f32 v79, v79, v31
 v_cvt_pk_bf16_f32 v128, v64, v65
 v_cvt_pk_bf16_f32 v129, v66, v67
 v_cvt_pk_bf16_f32 v130, v68, v69
 v_cvt_pk_bf16_f32 v131, v70, v71
 v_cvt_pk_bf16_f32 v132, v72, v73
 v_cvt_pk_bf16_f32 v133, v74, v75
 v_cvt_pk_bf16_f32 v134, v76, v77
 v_cvt_pk_bf16_f32 v135, v78, v79
 buffer_store_dwordx4 v[128:131], v7, s[4:7], s33 offen offset:0 sc1
 buffer_store_dwordx4 v[132:135], v7, s[4:7], s33 offen offset:608 sc1
 v_mul_u32_u24 v13, 3641, v12
 v_lshrrev_b32 v13, 16, v13
 v_mul_u32_u24 v15, 18, v13
 v_sub_u32 v15, v12, v15
 v_mul_lo_u32 v13, v13, s34
 v_lshlrev_b32 v15, 4, v15
 v_add3_u32 v8, v13, v15, v14
 v_add_u32 v12, 32, v12
 v_mul_f32 v80, v80, v16
 v_mul_f32 v81, v81, v17
 v_mul_f32 v82, v82, v18
 v_mul_f32 v83, v83, v19
 v_mul_f32 v84, v84, v20
 v_mul_f32 v85, v85, v21
 v_mul_f32 v86, v86, v22
 v_mul_f32 v87, v87, v23
 v_mul_f32 v88, v88, v24
 v_mul_f32 v89, v89, v25
 v_mul_f32 v90, v90, v26
 v_mul_f32 v91, v91, v27
 v_mul_f32 v92, v92, v28
 v_mul_f32 v93, v93, v29
 v_mul_f32 v94, v94, v30
 v_mul_f32 v95, v95, v31
 v_cvt_pk_bf16_f32 v136, v80, v81
 v_cvt_pk_bf16_f32 v137, v82, v83
 v_cvt_pk_bf16_f32 v138, v84, v85
 v_cvt_pk_bf16_f32 v139, v86, v87
 v_cvt_pk_bf16_f32 v140, v88, v89
 v_cvt_pk_bf16_f32 v141, v90, v91
 v_cvt_pk_bf16_f32 v142, v92, v93
 v_cvt_pk_bf16_f32 v143, v94, v95
 buffer_store_dwordx4 v[136:139], v8, s[4:7], s33 offen offset:0 sc1
 buffer_store_dwordx4 v[140:143], v8, s[4:7], s33 offen offset:608 sc1
 v_mul_u32_u24 v13, 3641, v12
 v_lshrrev_b32 v13, 16, v13
 v_mul_u32_u24 v15, 18, v13
 v_sub_u32 v15, v12, v15
 v_mul_lo_u32 v13, v13, s34
 v_lshlrev_b32 v15, 4, v15
 v_add3_u32 v9, v13, v15, v14
 v_add_u32 v12, 32, v12
 v_mul_f32 v96, v96, v16
 v_mul_f32 v97, v97, v17
 v_mul_f32 v98, v98, v18
 v_mul_f32 v99, v99, v19
 v_mul_f32 v100, v100, v20
 v_mul_f32 v101, v101, v21
 v_mul_f32 v102, v102, v22
 v_mul_f32 v103, v103, v23
 v_mul_f32 v104, v104, v24
 v_mul_f32 v105, v105, v25
 v_mul_f32 v106, v106, v26
 v_mul_f32 v107, v107, v27
 v_mul_f32 v108, v108, v28
 v_mul_f32 v109, v109, v29
 v_mul_f32 v110, v110, v30
 v_mul_f32 v111, v111, v31
 v_cvt_pk_bf16_f32 v144, v96, v97
 v_cvt_pk_bf16_f32 v145, v98, v99
 v_cvt_pk_bf16_f32 v146, v100, v101
 v_cvt_pk_bf16_f32 v147, v102, v103
 v_cvt_pk_bf16_f32 v148, v104, v105
 v_cvt_pk_bf16_f32 v149, v106, v107
 v_cvt_pk_bf16_f32 v150, v108, v109
 v_cvt_pk_bf16_f32 v151, v110, v111
 buffer_store_dwordx4 v[144:147], v9, s[4:7], s33 offen offset:0 sc1
 buffer_store_dwordx4 v[148:151], v9, s[4:7], s33 offen offset:608 sc1
 s_branch K1S_JOIN
K1S_JOIN:
 v_and_b32 v30, 7, v0
 v_lshlrev_b32 v30, 7, v30
 s_mov_b32 s38, 10214144
 s_mov_b32 s39, 0x20000
 s_mov_b64 exec, 0xff
ZBRDY:
 buffer_load_dword v31, v30, s[4:7], s38 offen sc1
 s_waitcnt vmcnt(0)
 v_cmp_ne_u32 vcc, 1, v31
 s_nop 1
 s_and_b64 exec, exec, vcc
 s_cbranch_scc0 ZBRDY_X
 s_sleep 4
 s_sub_u32 s39, s39, 1
 s_cmp_lg_u32 s39, 0
 s_cbranch_scc1 ZBRDY
ZBRDY_X:
 s_mov_b64 exec, -1
 s_waitcnt vmcnt(0) lgkmcnt(0)
 s_lshl_b32 s24, s87, 4
 s_add_u32 s24, s24, s86
 s_lshl_b32 s24, s24, 2
 s_add_u32 s24, s24, s41
 s_add_u32 s24, s24, 4096
 s_barrier
 s_cmp_lg_u32 s3, 0
 s_cbranch_scc1 SIG1
 s_mov_b64 exec, 1
 v_mov_b32 v30, 0
 v_mov_b32 v31, 1
 s_lshl_b32 s38, s24, 5
 s_add_u32 s38, s38, 9961472
 buffer_store_dword v31, v30, s[4:7], s38 offen sc1
 s_mov_b64 exec, -1
SIG1:
 s_and_b32 s24, s2, 7
 s_lshr_b32 s25, s2, 3
 s_lshr_b32 s80, s24, 1
 s_lshl_b32 s80, s80, 3
 s_and_b32 s27, s25, 7
 s_add_u32 s80, s80, s27
 s_and_b32 s81, s24, 1
 s_lshl_b32 s81, s81, 2
 s_lshr_b32 s28, s25, 3
 s_add_u32 s81, s81, s28
 s_lshr_b32 s82, s81, 1
 s_mul_i32 s82, s82, 9
 s_and_b32 s83, s81, 1
 s_lshl_b32 s34, s83, 2
 s_add_u32 s82, s82, s34
 s_and_b32 s84, s2, 3
 s_lshl_b32 s84, s84, 3
 s_bfe_u32 s25, s2, 0x30003
 s_add_u32 s84, s84, s25
 s_bfe_u32 s85, s2, 0x10002
 s_lshl_b32 s85, s85, 2
 s_lshr_b32 s25, s2, 6
 s_add_u32 s85, s85, s25
 s_lshl_b32 s78, s3, 10
 s_mul_i32 s76, s84, 340992
 s_add_u32 s76, s76, 58490880
 s_add_u32 s77, s76, s78
 s_mul_i32 s87, s82, 18432
 s_add_u32 s87, s87, 69402624
 s_add_u32 s87, s87, s78
 s_and_b32 s24, s2, 7
 s_lshl_b32 s24, s24, 2
 s_bfe_u32 s25, s2, 0x20003
 s_add_u32 s24, s24, s25
 s_lshr_b32 s26, s2, 5
 s_lshl_b32 s25, s26, 3
 s_lshl_b32 s27, s3, 1
 s_add_u32 s25, s25, s27
 s_lshl_b32 s29, s24, 6
 s_add_u32 s29, s29, s25
 s_lshl_b32 s27, s29, 10
 s_add_u32 s27, s27, 11010048
 s_add_u32 s27, s27, s100
 s_lshl_b32 s28, s29, 7
 s_add_u32 s28, s28, 13107200
 s_add_u32 s28, s28, s100
 s_lshl_b32 s21, s3, 10
 s_mul_i32 s20, s24, 151552
 s_add_u32 s20, s20, 13369344
 s_add_u32 s20, s20, s100
 s_add_u32 s20, s20, s21
 v_and_b32 v96, 31, v0
 v_lshlrev_b32 v97, 2, v96
 s_lshr_b32 s30, s24, 3
 s_add_u32 s31, s30, 4
 s_mul_i32 s32, s24, 18
 s_add_u32 s33, s32, 17
 s_mul_i32 s32, s32, 683
 s_lshr_b32 s32, s32, 16
 s_add_u32 s32, s32, 9
 s_mul_i32 s33, s33, 683
 s_lshr_b32 s33, s33, 16
 s_add_u32 s33, s33, 9
 v_bfe_u32 v98, v0, 4, 2
 v_mov_b32 v99, s31
 v_cmp_eq_u32 vcc, 1, v98
 s_nop 1
 v_cndmask_b32 v99, v99, 15, vcc
 v_mov_b32 v100, s32
 v_cmp_eq_u32 vcc, 2, v98
 s_nop 1
 v_cndmask_b32 v99, v99, v100, vcc
 v_mov_b32 v100, s33
 v_cmp_eq_u32 vcc, 3, v98
 s_nop 1
 v_cndmask_b32 v99, v99, v100, vcc
 v_lshlrev_b32 v99, 4, v99
 v_and_b32 v100, 15, v0
 v_add_u32 v99, v99, v100
 v_lshlrev_b32 v99, 7, v99
 s_lshl_b32 s30, s30, 4
 s_lshl_b32 s31, s26, 1
 s_add_u32 s30, s30, s31
 v_and_b32 v100, 1, v0
 s_add_u32 s31, s31, 128
 v_mov_b32 v101, s30
 v_mov_b32 v102, s31
 v_and_b32 v103, 2, v0
 v_cmp_eq_u32 vcc, 2, v103
 s_nop 1
 v_cndmask_b32 v101, v101, v102, vcc
 v_add_u32 v100, v101, v100
 v_lshlrev_b32 v100, 7, v100
 s_add_u32 s38, s41, 4096
 s_lshl_b32 s38, s38, 5
 s_add_u32 s38, s38, 9961472
 s_lshr_b32 s30, s82, 1
 s_add_u32 s30, s30, 130
 v_and_b32 v104, 3, v0
 v_min_u32 v104, 2, v104
 v_add_u32 v104, s30, v104
 v_and_b32 v105, 1, v0
 v_add_u32 v105, 148, v105
 v_and_b32 v106, 4, v0
 v_cmp_eq_u32 vcc, 4, v106
 s_nop 1
 v_cndmask_b32 v104, v104, v105, vcc
 s_lshr_b32 s30, s24, 0
 s_add_u32 s30, s30, 150
 v_mov_b32 v105, s30
 v_and_b32 v106, 8, v0
 v_cmp_eq_u32 vcc, 8, v106
 s_nop 1
 v_cndmask_b32 v104, v104, v105, vcc
 v_lshlrev_b32 v108, 7, v104
 v_add_u32 v108, 10190848, v108
 v_bfe_u32 v101, v0, 2, 1
 v_lshlrev_b32 v101, 3, v101
 v_bfe_u32 v102, v0, 3, 1
 v_lshlrev_b32 v102, 2, v102
 v_and_b32 v103, 3, v0
 v_add3_u32 v101, v101, v102, v103
 v_min_u32 v102, 18, v96
 v_cmp_gt_u32 vcc, 16, v96
 s_nop 1
 v_cndmask_b32 v101, v102, v101, vcc
 v_lshlrev_b32 v101, 4, v101
 v_bfe_u32 v102, v0, 5, 1
 v_mul_u32_u24 v102, 304, v102
 v_add_u32 v101, v101, v102
 v_cmp_lt_u32 vcc, 18, v96
 v_cmp_ne_u32 s[32:33], 22, v96
 s_nop 0
 s_and_b64 vcc, vcc, s[32:33]
 v_mov_b32 v102, 0x100000
 v_cndmask_b32 v101, v101, v102, vcc
 v_add_u32 v2, 0, v1
 v_add_u32 v6, 9216, v101
 v_add_u32 v3, 37888, v1
 v_add_u32 v7, 47104, v101
 v_add_u32 v4, 75776, v1
 v_add_u32 v8, 84992, v101
 v_add_u32 v5, 113664, v1
 v_add_u32 v9, 122880, v101
 v_accvgpr_write_b32 a8, 0
 v_accvgpr_write_b32 a9, 0
 v_accvgpr_write_b32 a10, 0
 v_accvgpr_write_b32 a11, 0
 v_accvgpr_write_b32 a12, 0
 v_accvgpr_write_b32 a13, 0
 v_accvgpr_write_b32 a14, 0
 v_accvgpr_write_b32 a15, 0
 v_accvgpr_write_b32 a16, 0
 v_accvgpr_write_b32 a17, 0
 v_accvgpr_write_b32 a18, 0
 v_accvgpr_write_b32 a19, 0
 v_accvgpr_write_b32 a20, 0
 v_accvgpr_write_b32 a21, 0
 v_accvgpr_write_b32 a22, 0
 v_accvgpr_write_b32 a23, 0
 v_accvgpr_write_b32 a24, 0
 v_accvgpr_write_b32 a25, 0
 v_accvgpr_write_b32 a26, 0
 v_accvgpr_write_b32 a27, 0
 v_accvgpr_write_b32 a28, 0
 v_accvgpr_write_b32 a29, 0
 v_accvgpr_write_b32 a30, 0
 v_accvgpr_write_b32 a31, 0
 v_accvgpr_write_b32 a32, 0
 v_accvgpr_write_b32 a33, 0
 v_accvgpr_write_b32 a34, 0
 v_accvgpr_write_b32 a35, 0
 v_accvgpr_write_b32 a36, 0
 v_accvgpr_write_b32 a37, 0
 v_accvgpr_write_b32 a38, 0
 v_accvgpr_write_b32 a39, 0
 v_accvgpr_write_b32 a40, 0
 v_accvgpr_write_b32 a41, 0
 v_accvgpr_write_b32 a42, 0
 v_accvgpr_write_b32 a43, 0
 v_accvgpr_write_b32 a44, 0
 v_accvgpr_write_b32 a45, 0
 v_accvgpr_write_b32 a46, 0
 v_accvgpr_write_b32 a47, 0
 v_accvgpr_write_b32 a48, 0
 v_accvgpr_write_b32 a49, 0
 v_accvgpr_write_b32 a50, 0
 v_accvgpr_write_b32 a51, 0
 v_accvgpr_write_b32 a52, 0
 v_accvgpr_write_b32 a53, 0
 v_accvgpr_write_b32 a54, 0
 v_accvgpr_write_b32 a55, 0
 v_accvgpr_write_b32 a56, 0
 v_accvgpr_write_b32 a57, 0
 v_accvgpr_write_b32 a58, 0
 v_accvgpr_write_b32 a59, 0
 v_accvgpr_write_b32 a60, 0
 v_accvgpr_write_b32 a61, 0
 v_accvgpr_write_b32 a62, 0
 v_accvgpr_write_b32 a63, 0
 v_accvgpr_write_b32 a64, 0
 v_accvgpr_write_b32 a65, 0
 v_accvgpr_write_b32 a66, 0
 v_accvgpr_write_b32 a67, 0
 v_accvgpr_write_b32 a68, 0
 v_accvgpr_write_b32 a69, 0
 v_accvgpr_write_b32 a70, 0
 v_accvgpr_write_b32 a71, 0
 v_mov_b32 v208, -1
 v_mov_b32 v209, -1
 v_mov_b32 v210, -1
 v_mov_b32 v211, -1
 s_mul_i32 s86, s26, 1179648
 s_mul_i32 s30, s24, 36864
 s_add_u32 s86, s86, s30
 s_add_u32 s86, s86, s21
 s_add_u32 s86, s86, 46940160
 s_load_dwordx4 s[72:75], s[0:1], 32
 s_load_dwordx2 s[70:71], s[0:1], 48
 s_mov_b32 s19, 0x3f803f80
 s_mov_b32 s14, 5308416
 s_mov_b32 s15, 0x00020000
 v_and_b32 v104, 63, v0
 v_lshrrev_b32 v112, 3, v104
 v_and_b32 v114, 15, v104
 v_lshlrev_b32 v114, 4, v114
 s_lshl_b32 s30, s3, 11
 s_add_u32 s30, s30, 151552
 v_add_u32 v115, s30, v1
 v_lshrrev_b32 v117, 5, v104
 v_lshlrev_b32 v117, 3, v117
 v_bfe_u32 v105, v104, 2, 2
 v_add_u32 v117, v117, v105
 v_lshlrev_b32 v117, 7, v117
 v_add_u32 v117, s30, v117
 v_bfe_u32 v105, v104, 4, 1
 v_lshlrev_b32 v105, 5, v105
 v_add_u32 v117, v117, v105
 s_lshl_b32 s30, s3, 8
 s_add_u32 s30, s30, 159744
 v_lshlrev_b32 v119, 2, v104
 v_add_u32 v119, s30, v119
 s_lshl_b32 s18, s2, 1
 s_add_u32 s18, s18, s3
 s_lshl_b32 s18, s18, 7
 s_add_u32 s18, s18, 10125312
 s_waitcnt lgkmcnt(0)
 s_cmp_ge_u32 s2, 144
 s_cbranch_scc1 ATA_SW2
 s_cmp_ge_u32 s2, 72
 s_cselect_b32 s12, s74, s72
 s_cselect_b32 s13, s75, s73
 s_cselect_b32 s30, 72, 0
 s_cselect_b32 s36, 256, 0
 s_and_b32 s13, s13, 0xffff
 s_sub_u32 s29, s2, s30
 s_lshl_b32 s34, s29, 7
 s_mul_i32 s30, s3, 1327104
 s_add_u32 s34, s34, s30
 s_mov_b32 s35, 147456
 s_mul_i32 s30, s29, 151552
 s_add_u32 s36, s36, s30
 s_add_u32 s16, s36, 58527744
 s_mul_i32 s30, s3, 9216
 s_add_u32 s36, s36, s30
 s_add_u32 s36, s36, 58490880
 s_mov_b32 s37, 1024
 s_mov_b32 s17, 75776
 s_mov_b32 s30, 9216
 s_mov_b32 s32, 16
 s_mov_b32 s33, 8
 s_mov_b32 s22, 37888
 s_mov_b32 s23, 512
 s_branch ATA_SCOM
ATA_SW2:
 s_mov_b32 s12, s70
 s_and_b32 s13, s71, 0xffff
 s_sub_u32 s29, s2, 144
 s_mul_i32 s30, s29, 7282
 s_lshr_b32 s30, s30, 16
 s_mul_i32 s32, s30, 9
 s_sub_u32 s32, s29, s32
 s_mul_i32 s30, s30, 36
 s_mul_i32 s33, s3, 9
 s_add_u32 s30, s30, s33
 s_mul_i32 s34, s30, 18432
 s_lshl_b32 s33, s32, 7
 s_add_u32 s34, s34, s33
 s_mov_b32 s35, 18432
 s_lshl_b32 s36, s30, 9
 s_mul_i32 s33, s32, 589824
 s_add_u32 s36, s36, s33
 s_add_u32 s36, s36, 70066176
 s_mov_b32 s16, 0x7fff0000
 s_cmp_ge_u32 s2, 216
 s_cselect_b32 s14, 0, s14
 s_cselect_b32 s36, s16, s36
 s_mov_b32 s37, 512
 s_mov_b32 s17, 294912
 s_mov_b32 s30, 1152
 s_mov_b32 s32, 8
 s_mov_b32 s33, 16
 s_mov_b32 s22, 147456
 s_mov_b32 s23, 256
ATA_SCOM:
 v_mul_lo_u32 v112, v112, s30
 v_and_b32 v105, 7, v104
 v_lshlrev_b32 v105, 4, v105
 v_add_u32 v112, v112, v105
 s_lshl_b32 s30, s30, 3
 v_add_u32 v113, s30, v112
 v_bfe_u32 v105, v104, 4, 1
 v_mul_lo_u32 v105, v105, s22
 v_add_u32 v114, v114, v105
 v_lshrrev_b32 v105, 5, v104
 v_mul_lo_u32 v105, v105, s23
 v_add_u32 v114, v114, v105
 v_and_b32 v105, 1, v104
 v_mul_lo_u32 v105, v105, s32
 v_add_u32 v117, v117, v105
 v_bfe_u32 v105, v104, 1, 1
 v_mul_lo_u32 v105, v105, s33
 v_add_u32 v117, v117, v105
 s_cmp_lg_u32 s3, 0
 s_cbranch_scc1 ATA_PD
 s_mov_b32 s39, 0x20000
ATA_PL:
 buffer_load_dword v102, v99, s[4:7], s38 offen sc1
 buffer_load_dword v103, v100, s[4:7], s38 offen sc1
 buffer_load_dword v109, v108, s[4:7], 0 offen sc1
 s_waitcnt vmcnt(0)
 v_and_b32 v102, v102, v109
 v_and_b32 v102, v102, v103
 v_cmp_ne_u32 vcc, 1, v102
 s_nop 1
 s_and_b64 exec, exec, vcc
 s_cbranch_scc0 ATA_PX
 s_sleep 2
 s_sub_u32 s39, s39, 1
 s_cmp_lg_u32 s39, 0
 s_cbranch_scc1 ATA_PL
ATA_PX:
 s_mov_b64 exec, -1
ATA_PD:
 s_barrier
 s_add_u32 s30, s20, 0
 s_add_u32 m0, s21, 0
 s_nop 0
 buffer_load_dwordx4 v1, s[4:7], s30 offen sc1 lds
 s_add_u32 s30, s20, 4096
 s_add_u32 m0, s21, 4096
 s_nop 0
 buffer_load_dwordx4 v1, s[4:7], s30 offen sc1 lds
 s_add_u32 s30, s20, 8192
 s_add_u32 m0, s21, 8192
 s_nop 0
 buffer_load_dwordx4 v1, s[4:7], s30 offen sc1 lds
 buffer_load_dwordx4 a[0:3], v1, s[4:7], s27 offen offset:0 sc1
 buffer_load_dword v98, v97, s[4:7], s28 offen offset:0 sc1
 buffer_load_dwordx4 a[4:7], v1, s[4:7], s27 offen offset:1024 sc1
 buffer_load_dword v99, v97, s[4:7], s28 offen offset:128 sc1
 s_add_u32 s30, s20, 12288
 s_add_u32 m0, s21, 12288
 s_nop 0
 buffer_load_dwordx4 v1, s[4:7], s30 offen sc1 lds
 s_add_u32 s30, s20, 16384
 s_add_u32 m0, s21, 16384
 s_nop 0
 buffer_load_dwordx4 v1, s[4:7], s30 offen sc1 lds
 s_add_u32 s30, s20, 20480
 s_add_u32 m0, s21, 20480
 s_nop 0
 buffer_load_dwordx4 v1, s[4:7], s30 offen sc1 lds
 s_add_u32 s30, s20, 24576
 s_add_u32 m0, s21, 24576
 s_nop 0
 buffer_load_dwordx4 v1, s[4:7], s30 offen sc1 lds
 s_add_u32 s30, s20, 28672
 s_add_u32 m0, s21, 28672
 s_nop 0
 buffer_load_dwordx4 v1, s[4:7], s30 offen sc1 lds
 s_add_u32 s30, s20, 32768
 s_add_u32 m0, s21, 32768
 s_nop 0
 buffer_load_dwordx4 v1, s[4:7], s30 offen sc1 lds
 s_add_u32 s30, s20, 36864
 s_add_u32 m0, s21, 36864
 s_nop 0
 buffer_load_dwordx4 v1, s[4:7], s30 offen sc1 lds
 s_add_u32 s30, s20, 40960
 s_add_u32 m0, s21, 40960
 s_nop 0
 buffer_load_dwordx4 v1, s[4:7], s30 offen sc1 lds
 s_add_u32 s30, s20, 45056
 s_add_u32 m0, s21, 45056
 s_nop 0
 buffer_load_dwordx4 v1, s[4:7], s30 offen sc1 lds
 s_add_u32 s30, s20, 49152
 s_add_u32 m0, s21, 49152
 s_nop 0
 buffer_load_dwordx4 v1, s[4:7], s30 offen sc1 lds
 s_add_u32 s30, s20, 53248
 s_add_u32 m0, s21, 53248
 s_nop 0
 buffer_load_dwordx4 v1, s[4:7], s30 offen sc1 lds
 s_add_u32 s30, s20, 57344
 s_add_u32 m0, s21, 57344
 s_nop 0
 buffer_load_dwordx4 v1, s[4:7], s30 offen sc1 lds
 s_add_u32 s30, s20, 61440
 s_add_u32 m0, s21, 61440
 s_nop 0
 buffer_load_dwordx4 v1, s[4:7], s30 offen sc1 lds
 s_waitcnt vmcnt(13)
 v_cmp_gt_u32 vcc, 512, v1
 s_nop 1
 v_cndmask_b32 v100, 0, v98, vcc
 v_cndmask_b32 v101, v98, 0, vcc
 v_accvgpr_write_b32 a8, v100
 v_accvgpr_write_b32 a24, v101
 v_accvgpr_write_b32 a13, v100
 v_accvgpr_write_b32 a29, v101
 v_accvgpr_write_b32 a18, v100
 v_accvgpr_write_b32 a34, v101
 v_accvgpr_write_b32 a23, v100
 v_accvgpr_write_b32 a39, v101
 v_cndmask_b32 v100, 0, v99, vcc
 v_cndmask_b32 v101, v99, 0, vcc
 v_accvgpr_write_b32 a40, v100
 v_accvgpr_write_b32 a56, v101
 v_accvgpr_write_b32 a45, v100
 v_accvgpr_write_b32 a61, v101
 v_accvgpr_write_b32 a50, v100
 v_accvgpr_write_b32 a66, v101
 v_accvgpr_write_b32 a55, v100
 v_accvgpr_write_b32 a71, v101
 s_waitcnt vmcnt(11)
 s_barrier
 ds_read_b128 a[104:107], v2 offset:0
 ds_read_b128 a[140:143], v2 offset:8192
 ds_read_b128 a[108:111], v2 offset:1024
 ds_read_b128 a[116:119], v6 offset:0
 ds_read_b128 a[120:123], v6 offset:608
 s_waitcnt lgkmcnt(3)
 v_mfma_f32_32x32x16_bf16 v[48:63], a[104:107], a[0:3], 0
 v_mfma_f32_32x32x16_bf16 v[64:79], a[104:107], a[4:7], 0
 v_mfma_f32_32x32x16_bf16 v[48:63], a[140:143], a[8:11], v[48:63]
 v_mfma_f32_32x32x16_bf16 v[64:79], a[140:143], a[40:43], v[64:79]
 s_nop 10
 v_max3_f32 v100, v48, v49, v50
 v_max_f32 v100, v100, v51
 v_max3_f32 v100, v100, v52, v53
 v_max3_f32 v100, v100, v54, v55
 v_max3_f32 v100, v100, v56, v57
 v_max3_f32 v100, v100, v58, v59
 v_max3_f32 v100, v100, v60, v61
 v_max3_f32 v100, v100, v62, v63
 v_mov_b32 v103, v100
 s_nop 1
 v_permlane32_swap_b32 v100, v103
 v_max_f32 v100, v100, v103
 v_sub_f32 v16, 0, v100
 v_sub_f32 v17, 0, v100
 v_sub_f32 v18, 0, v100
 v_sub_f32 v19, 0, v100
 v_sub_f32 v20, 0, v100
 v_sub_f32 v21, 0, v100
 v_sub_f32 v22, 0, v100
 v_sub_f32 v23, 0, v100
 v_sub_f32 v24, 0, v100
 v_sub_f32 v25, 0, v100
 v_sub_f32 v26, 0, v100
 v_sub_f32 v27, 0, v100
 v_sub_f32 v28, 0, v100
 v_sub_f32 v29, 0, v100
 v_sub_f32 v30, 0, v100
 v_sub_f32 v31, 0, v100
 s_nop 1
 v_mfma_f32_32x32x16_bf16 v[48:63], a[104:107], a[0:3], v[16:31]
 v_mfma_f32_32x32x16_bf16 v[48:63], a[140:143], a[8:11], v[48:63]
 v_max3_f32 v101, v64, v65, v66
 v_max_f32 v101, v101, v67
 v_max3_f32 v101, v101, v68, v69
 v_max3_f32 v101, v101, v70, v71
 v_max3_f32 v101, v101, v72, v73
 v_max3_f32 v101, v101, v74, v75
 v_max3_f32 v101, v101, v76, v77
 v_max3_f32 v101, v101, v78, v79
 v_mov_b32 v103, v101
 s_nop 1
 v_permlane32_swap_b32 v101, v103
 v_max_f32 v101, v101, v103
 v_sub_f32 v32, 0, v101
 v_sub_f32 v33, 0, v101
 v_sub_f32 v34, 0, v101
 v_sub_f32 v35, 0, v101
 v_sub_f32 v36, 0, v101
 v_sub_f32 v37, 0, v101
 v_sub_f32 v38, 0, v101
 v_sub_f32 v39, 0, v101
 v_sub_f32 v40, 0, v101
 v_sub_f32 v41, 0, v101
 v_sub_f32 v42, 0, v101
 v_sub_f32 v43, 0, v101
 v_sub_f32 v44, 0, v101
 v_sub_f32 v45, 0, v101
 v_sub_f32 v46, 0, v101
 v_sub_f32 v47, 0, v101
 v_mov_b32 v116, 0
 v_mov_b32 v118, 0
 v_exp_f32 v48, v48
 v_exp_f32 v49, v49
 v_exp_f32 v50, v50
 v_exp_f32 v51, v51
 v_mfma_f32_32x32x16_bf16 v[64:79], a[104:107], a[4:7], v[32:47]
 v_exp_f32 v52, v52
 v_exp_f32 v53, v53
 ds_read_b128 a[112:115], v2 offset:2048
 v_exp_f32 v54, v54
 v_exp_f32 v55, v55
 v_cvt_pk_bf16_f32 v80, v48, v49
 v_cvt_pk_bf16_f32 v81, v50, v51
 v_mfma_f32_32x32x16_bf16 v[64:79], a[140:143], a[40:43], v[64:79]
 v_exp_f32 v56, v56
 v_exp_f32 v57, v57
 s_add_u32 s30, s20, 65536
 s_add_u32 m0, s21, 65536
 s_nop 0
 buffer_load_dwordx4 v1, s[4:7], s30 offen sc1 lds
 s_add_u32 s30, s20, 69632
 s_add_u32 m0, s21, 69632
 s_nop 0
 buffer_load_dwordx4 v1, s[4:7], s30 offen sc1 lds
 s_add_u32 s30, s20, 73728
 s_add_u32 m0, s21, 73728
 s_nop 0
 buffer_load_dwordx4 v1, s[4:7], s30 offen sc1 lds
 v_exp_f32 v58, v58
 v_exp_f32 v59, v59
 v_cvt_pk_bf16_f32 v82, v52, v53
 v_cvt_pk_bf16_f32 v83, v54, v55
 v_exp_f32 v60, v60
 v_exp_f32 v61, v61
 v_exp_f32 v62, v62
 v_exp_f32 v63, v63
 v_cvt_pk_bf16_f32 v84, v56, v57
 v_cvt_pk_bf16_f32 v85, v58, v59
 s_waitcnt lgkmcnt(1)
 v_mfma_f32_32x32x16_bf16 a[72:87], a[116:119], v[80:83], 0
 v_exp_f32 v64, v64
 v_exp_f32 v65, v65
 v_cvt_pk_bf16_f32 v86, v60, v61
 v_cvt_pk_bf16_f32 v87, v62, v63
 v_exp_f32 v66, v66
 v_exp_f32 v67, v67
 v_mfma_f32_32x32x16_bf16 v[48:63], a[108:111], a[0:3], v[16:31]
 v_exp_f32 v68, v68
 v_exp_f32 v69, v69
 ds_read_b128 a[124:127], v6 offset:1216
 v_exp_f32 v70, v70
 v_exp_f32 v71, v71
 v_cvt_pk_bf16_f32 v88, v64, v65
 v_cvt_pk_bf16_f32 v89, v66, v67
 v_mfma_f32_32x32x16_bf16 v[48:63], a[140:143], a[12:15], v[48:63]
 v_exp_f32 v72, v72
 v_exp_f32 v73, v73
 ds_read_b128 a[128:131], v6 offset:1824
 v_exp_f32 v74, v74
 v_exp_f32 v75, v75
 v_cvt_pk_bf16_f32 v90, v68, v69
 v_cvt_pk_bf16_f32 v91, v70, v71
 v_mfma_f32_32x32x16_bf16 a[72:87], a[120:123], v[84:87], a[72:87]
 v_exp_f32 v76, v76
 v_exp_f32 v77, v77
 v_exp_f32 v78, v78
 v_exp_f32 v79, v79
 v_cvt_pk_bf16_f32 v92, v72, v73
 v_cvt_pk_bf16_f32 v93, v74, v75
 v_mfma_f32_32x32x16_bf16 a[88:103], a[116:119], v[88:91], 0
 v_exp_f32 v48, v48
 v_exp_f32 v49, v49
 v_cvt_pk_bf16_f32 v94, v76, v77
 v_cvt_pk_bf16_f32 v95, v78, v79
 v_exp_f32 v50, v50
 v_exp_f32 v51, v51
 v_mfma_f32_32x32x16_bf16 v[64:79], a[108:111], a[4:7], v[32:47]
 v_exp_f32 v52, v52
 v_exp_f32 v53, v53
 ds_read_b128 a[104:107], v2 offset:3072
 v_exp_f32 v54, v54
 v_exp_f32 v55, v55
 v_cvt_pk_bf16_f32 v80, v48, v49
 v_cvt_pk_bf16_f32 v81, v50, v51
 v_mfma_f32_32x32x16_bf16 v[64:79], a[140:143], a[44:47], v[64:79]
 v_exp_f32 v56, v56
 v_exp_f32 v57, v57
 s_add_u32 s30, s20, 77824
 s_add_u32 m0, s21, 77824
 s_nop 0
 buffer_load_dwordx4 v1, s[4:7], s30 offen sc1 lds
 s_add_u32 s30, s20, 81920
 s_add_u32 m0, s21, 81920
 s_nop 0
 buffer_load_dwordx4 v1, s[4:7], s30 offen sc1 lds
 s_add_u32 s30, s20, 86016
 s_add_u32 m0, s21, 86016
 s_nop 0
 buffer_load_dwordx4 v1, s[4:7], s30 offen sc1 lds
 v_exp_f32 v58, v58
 v_exp_f32 v59, v59
 v_cvt_pk_bf16_f32 v82, v52, v53
 v_cvt_pk_bf16_f32 v83, v54, v55
 v_mfma_f32_32x32x16_bf16 a[88:103], a[120:123], v[92:95], a[88:103]
 v_exp_f32 v60, v60
 v_exp_f32 v61, v61
 v_exp_f32 v62, v62
 v_exp_f32 v63, v63
 v_cvt_pk_bf16_f32 v84, v56, v57
 v_cvt_pk_bf16_f32 v85, v58, v59
 s_waitcnt lgkmcnt(1)
 v_mfma_f32_32x32x16_bf16 a[72:87], a[124:127], v[80:83], a[72:87]
 v_exp_f32 v64, v64
 v_exp_f32 v65, v65
 v_cvt_pk_bf16_f32 v86, v60, v61
 v_cvt_pk_bf16_f32 v87, v62, v63
 v_exp_f32 v66, v66
 v_exp_f32 v67, v67
 v_mfma_f32_32x32x16_bf16 v[48:63], a[112:115], a[0:3], v[16:31]
 v_exp_f32 v68, v68
 v_exp_f32 v69, v69
 ds_read_b128 a[132:135], v6 offset:2432
 v_exp_f32 v70, v70
 v_exp_f32 v71, v71
 v_cvt_pk_bf16_f32 v88, v64, v65
 v_cvt_pk_bf16_f32 v89, v66, v67
 v_mfma_f32_32x32x16_bf16 v[48:63], a[140:143], a[16:19], v[48:63]
 v_exp_f32 v72, v72
 v_exp_f32 v73, v73
 ds_read_b128 a[136:139], v6 offset:3040
 v_exp_f32 v74, v74
 v_exp_f32 v75, v75
 v_cvt_pk_bf16_f32 v90, v68, v69
 v_cvt_pk_bf16_f32 v91, v70, v71
 v_mfma_f32_32x32x16_bf16 a[72:87], a[128:131], v[84:87], a[72:87]
 v_exp_f32 v76, v76
 v_exp_f32 v77, v77
 v_exp_f32 v78, v78
 v_exp_f32 v79, v79
 v_cvt_pk_bf16_f32 v92, v72, v73
 v_cvt_pk_bf16_f32 v93, v74, v75
 v_mfma_f32_32x32x16_bf16 a[88:103], a[124:127], v[88:91], a[88:103]
 v_exp_f32 v48, v48
 v_exp_f32 v49, v49
 v_cvt_pk_bf16_f32 v94, v76, v77
 v_cvt_pk_bf16_f32 v95, v78, v79
 v_exp_f32 v50, v50
 v_exp_f32 v51, v51
 v_mfma_f32_32x32x16_bf16 v[64:79], a[112:115], a[4:7], v[32:47]
 v_exp_f32 v52, v52
 v_exp_f32 v53, v53
 ds_read_b128 a[108:111], v2 offset:4096
 v_exp_f32 v54, v54
 v_exp_f32 v55, v55
 v_cvt_pk_bf16_f32 v80, v48, v49
 v_cvt_pk_bf16_f32 v81, v50, v51
 v_mfma_f32_32x32x16_bf16 v[64:79], a[140:143], a[48:51], v[64:79]
 v_exp_f32 v56, v56
 v_exp_f32 v57, v57
 s_add_u32 s30, s20, 90112
 s_add_u32 m0, s21, 90112
 s_nop 0
 buffer_load_dwordx4 v1, s[4:7], s30 offen sc1 lds
 s_add_u32 s30, s20, 94208
 s_add_u32 m0, s21, 94208
 s_nop 0
 buffer_load_dwordx4 v1, s[4:7], s30 offen sc1 lds
 s_add_u32 s30, s20, 98304
 s_add_u32 m0, s21, 98304
 s_nop 0
 buffer_load_dwordx4 v1, s[4:7], s30 offen sc1 lds
 v_exp_f32 v58, v58
 v_exp_f32 v59, v59
 v_cvt_pk_bf16_f32 v82, v52, v53
 v_cvt_pk_bf16_f32 v83, v54, v55
 v_mfma_f32_32x32x16_bf16 a[88:103], a[128:131], v[92:95], a[88:103]
 v_exp_f32 v60, v60
 v_exp_f32 v61, v61
 v_exp_f32 v62, v62
 v_exp_f32 v63, v63
 v_cvt_pk_bf16_f32 v84, v56, v57
 v_cvt_pk_bf16_f32 v85, v58, v59
 s_waitcnt lgkmcnt(1)
 v_mfma_f32_32x32x16_bf16 a[72:87], a[132:135], v[80:83], a[72:87]
 v_exp_f32 v64, v64
 v_exp_f32 v65, v65
 v_cvt_pk_bf16_f32 v86, v60, v61
 v_cvt_pk_bf16_f32 v87, v62, v63
 v_exp_f32 v66, v66
 v_exp_f32 v67, v67
 v_mfma_f32_32x32x16_bf16 v[48:63], a[104:107], a[0:3], v[16:31]
 v_exp_f32 v68, v68
 v_exp_f32 v69, v69
 ds_read_b128 a[116:119], v6 offset:3648
 v_exp_f32 v70, v70
 v_exp_f32 v71, v71
 v_cvt_pk_bf16_f32 v88, v64, v65
 v_cvt_pk_bf16_f32 v89, v66, v67
 v_mfma_f32_32x32x16_bf16 v[48:63], a[140:143], a[20:23], v[48:63]
 v_exp_f32 v72, v72
 v_exp_f32 v73, v73
 ds_read_b128 a[120:123], v6 offset:4256
 v_exp_f32 v74, v74
 v_exp_f32 v75, v75
 v_cvt_pk_bf16_f32 v90, v68, v69
 v_cvt_pk_bf16_f32 v91, v70, v71
 v_mfma_f32_32x32x16_bf16 a[72:87], a[136:139], v[84:87], a[72:87]
 v_exp_f32 v76, v76
 v_exp_f32 v77, v77
 v_exp_f32 v78, v78
 v_exp_f32 v79, v79
 v_cvt_pk_bf16_f32 v92, v72, v73
 v_cvt_pk_bf16_f32 v93, v74, v75
 v_mfma_f32_32x32x16_bf16 a[88:103], a[132:135], v[88:91], a[88:103]
 v_exp_f32 v48, v48
 v_exp_f32 v49, v49
 v_cvt_pk_bf16_f32 v94, v76, v77
 v_cvt_pk_bf16_f32 v95, v78, v79
 v_exp_f32 v50, v50
 v_exp_f32 v51, v51
 v_mfma_f32_32x32x16_bf16 v[64:79], a[104:107], a[4:7], v[32:47]
 v_exp_f32 v52, v52
 v_exp_f32 v53, v53
 ds_read_b128 a[112:115], v2 offset:5120
 v_exp_f32 v54, v54
 v_exp_f32 v55, v55
 v_cvt_pk_bf16_f32 v80, v48, v49
 v_cvt_pk_bf16_f32 v81, v50, v51
 v_mfma_f32_32x32x16_bf16 v[64:79], a[140:143], a[52:55], v[64:79]
 v_exp_f32 v56, v56
 v_exp_f32 v57, v57
 s_add_u32 s30, s20, 102400
 s_add_u32 m0, s21, 102400
 s_nop 0
 buffer_load_dwordx4 v1, s[4:7], s30 offen sc1 lds
 s_add_u32 s30, s20, 106496
 s_add_u32 m0, s21, 106496
 s_nop 0
 buffer_load_dwordx4 v1, s[4:7], s30 offen sc1 lds
 s_add_u32 s30, s20, 110592
 s_add_u32 m0, s21, 110592
 s_nop 0
 buffer_load_dwordx4 v1, s[4:7], s30 offen sc1 lds
 v_exp_f32 v58, v58
 v_exp_f32 v59, v59
 v_cvt_pk_bf16_f32 v82, v52, v53
 v_cvt_pk_bf16_f32 v83, v54, v55
 v_mfma_f32_32x32x16_bf16 a[88:103], a[136:139], v[92:95], a[88:103]
 v_exp_f32 v60, v60
 v_exp_f32 v61, v61
 v_exp_f32 v62, v62
 v_exp_f32 v63, v63
 v_cvt_pk_bf16_f32 v84, v56, v57
 v_cvt_pk_bf16_f32 v85, v58, v59
 s_waitcnt lgkmcnt(1)
 v_mfma_f32_32x32x16_bf16 a[72:87], a[116:119], v[80:83], a[72:87]
 v_exp_f32 v64, v64
 v_exp_f32 v65, v65
 v_cvt_pk_bf16_f32 v86, v60, v61
 v_cvt_pk_bf16_f32 v87, v62, v63
 v_exp_f32 v66, v66
 v_exp_f32 v67, v67
 v_mfma_f32_32x32x16_bf16 v[48:63], a[108:111], a[0:3], v[16:31]
 v_exp_f32 v68, v68
 v_exp_f32 v69, v69
 ds_read_b128 a[124:127], v6 offset:4864
 v_exp_f32 v70, v70
 v_exp_f32 v71, v71
 v_cvt_pk_bf16_f32 v88, v64, v65
 v_cvt_pk_bf16_f32 v89, v66, v67
 v_mfma_f32_32x32x16_bf16 v[48:63], a[140:143], a[24:27], v[48:63]
 v_exp_f32 v72, v72
 v_exp_f32 v73, v73
 ds_read_b128 a[128:131], v6 offset:5472
 buffer_load_dwordx4 v[120:123], v112, s[12:15], s34 offen
 buffer_load_dwordx4 v[124:127], v113, s[12:15], s34 offen
 s_add_u32 s34, s34, s35
 v_exp_f32 v74, v74
 v_exp_f32 v75, v75
 v_cvt_pk_bf16_f32 v90, v68, v69
 v_cvt_pk_bf16_f32 v91, v70, v71
 v_mfma_f32_32x32x16_bf16 a[72:87], a[120:123], v[84:87], a[72:87]
 v_exp_f32 v76, v76
 v_exp_f32 v77, v77
 v_exp_f32 v78, v78
 v_exp_f32 v79, v79
 v_cvt_pk_bf16_f32 v92, v72, v73
 v_cvt_pk_bf16_f32 v93, v74, v75
 v_mfma_f32_32x32x16_bf16 a[88:103], a[116:119], v[88:91], a[88:103]
 v_exp_f32 v48, v48
 v_exp_f32 v49, v49
 v_cvt_pk_bf16_f32 v94, v76, v77
 v_cvt_pk_bf16_f32 v95, v78, v79
 v_exp_f32 v50, v50
 v_exp_f32 v51, v51
 v_mfma_f32_32x32x16_bf16 v[64:79], a[108:111], a[4:7], v[32:47]
 v_exp_f32 v52, v52
 v_exp_f32 v53, v53
 ds_read_b128 a[104:107], v2 offset:6144
 v_exp_f32 v54, v54
 v_exp_f32 v55, v55
 v_cvt_pk_bf16_f32 v80, v48, v49
 v_cvt_pk_bf16_f32 v81, v50, v51
 v_mfma_f32_32x32x16_bf16 v[64:79], a[140:143], a[56:59], v[64:79]
 v_exp_f32 v56, v56
 v_exp_f32 v57, v57
 s_add_u32 s30, s20, 114688
 s_add_u32 m0, s21, 114688
 s_nop 0
 buffer_load_dwordx4 v1, s[4:7], s30 offen sc1 lds
 s_add_u32 s30, s20, 118784
 s_add_u32 m0, s21, 118784
 s_nop 0
 buffer_load_dwordx4 v1, s[4:7], s30 offen sc1 lds
 s_add_u32 s30, s20, 122880
 s_add_u32 m0, s21, 122880
 s_nop 0
 buffer_load_dwordx4 v1, s[4:7], s30 offen sc1 lds
 v_exp_f32 v58, v58
 v_exp_f32 v59, v59
 v_cvt_pk_bf16_f32 v82, v52, v53
 v_cvt_pk_bf16_f32 v83, v54, v55
 v_mfma_f32_32x32x16_bf16 a[88:103], a[120:123], v[92:95], a[88:103]
 v_exp_f32 v60, v60
 v_exp_f32 v61, v61
 v_exp_f32 v62, v62
 v_exp_f32 v63, v63
 v_cvt_pk_bf16_f32 v84, v56, v57
 v_cvt_pk_bf16_f32 v85, v58, v59
 s_waitcnt lgkmcnt(1)
 v_mfma_f32_32x32x16_bf16 a[72:87], a[124:127], v[80:83], a[72:87]
 v_exp_f32 v64, v64
 v_exp_f32 v65, v65
 v_cvt_pk_bf16_f32 v86, v60, v61
 v_cvt_pk_bf16_f32 v87, v62, v63
 v_exp_f32 v66, v66
 v_exp_f32 v67, v67
 v_mfma_f32_32x32x16_bf16 v[48:63], a[112:115], a[0:3], v[16:31]
 v_exp_f32 v68, v68
 v_exp_f32 v69, v69
 ds_read_b128 a[132:135], v6 offset:6080
 v_exp_f32 v70, v70
 v_exp_f32 v71, v71
 v_cvt_pk_bf16_f32 v88, v64, v65
 v_cvt_pk_bf16_f32 v89, v66, v67
 v_mfma_f32_32x32x16_bf16 v[48:63], a[140:143], a[28:31], v[48:63]
 v_exp_f32 v72, v72
 v_exp_f32 v73, v73
 ds_read_b128 a[136:139], v6 offset:6688
 v_exp_f32 v74, v74
 v_exp_f32 v75, v75
 v_cvt_pk_bf16_f32 v90, v68, v69
 v_cvt_pk_bf16_f32 v91, v70, v71
 v_mfma_f32_32x32x16_bf16 a[72:87], a[128:131], v[84:87], a[72:87]
 v_exp_f32 v76, v76
 v_exp_f32 v77, v77
 v_exp_f32 v78, v78
 v_exp_f32 v79, v79
 v_cvt_pk_bf16_f32 v92, v72, v73
 v_cvt_pk_bf16_f32 v93, v74, v75
 v_mfma_f32_32x32x16_bf16 a[88:103], a[124:127], v[88:91], a[88:103]
 v_exp_f32 v48, v48
 v_exp_f32 v49, v49
 v_cvt_pk_bf16_f32 v94, v76, v77
 v_cvt_pk_bf16_f32 v95, v78, v79
 v_exp_f32 v50, v50
 v_exp_f32 v51, v51
 v_mfma_f32_32x32x16_bf16 v[64:79], a[112:115], a[4:7], v[32:47]
 v_exp_f32 v52, v52
 v_exp_f32 v53, v53
 ds_read_b128 a[108:111], v2 offset:7168
 v_exp_f32 v54, v54
 v_exp_f32 v55, v55
 v_cvt_pk_bf16_f32 v80, v48, v49
 v_cvt_pk_bf16_f32 v81, v50, v51
 v_mfma_f32_32x32x16_bf16 v[64:79], a[140:143], a[60:63], v[64:79]
 v_exp_f32 v56, v56
 v_exp_f32 v57, v57
 s_add_u32 s30, s20, 126976
 s_add_u32 m0, s21, 126976
 s_nop 0
 buffer_load_dwordx4 v1, s[4:7], s30 offen sc1 lds
 s_add_u32 s30, s20, 131072
 s_add_u32 m0, s21, 131072
 s_nop 0
 buffer_load_dwordx4 v1, s[4:7], s30 offen sc1 lds
 s_add_u32 s30, s20, 135168
 s_add_u32 m0, s21, 135168
 s_nop 0
 buffer_load_dwordx4 v1, s[4:7], s30 offen sc1 lds
 v_exp_f32 v58, v58
 v_exp_f32 v59, v59
 v_cvt_pk_bf16_f32 v82, v52, v53
 v_cvt_pk_bf16_f32 v83, v54, v55
 v_mfma_f32_32x32x16_bf16 a[88:103], a[128:131], v[92:95], a[88:103]
 v_exp_f32 v60, v60
 v_exp_f32 v61, v61
 v_exp_f32 v62, v62
 v_exp_f32 v63, v63
 v_cvt_pk_bf16_f32 v84, v56, v57
 v_cvt_pk_bf16_f32 v85, v58, v59
 s_waitcnt lgkmcnt(1)
 v_mfma_f32_32x32x16_bf16 a[72:87], a[132:135], v[80:83], a[72:87]
 v_exp_f32 v64, v64
 v_exp_f32 v65, v65
 v_cvt_pk_bf16_f32 v86, v60, v61
 v_cvt_pk_bf16_f32 v87, v62, v63
 v_exp_f32 v66, v66
 v_exp_f32 v67, v67
 v_mfma_f32_32x32x16_bf16 v[48:63], a[104:107], a[0:3], v[16:31]
 v_exp_f32 v68, v68
 v_exp_f32 v69, v69
 ds_read_b128 a[116:119], v6 offset:7296
 v_exp_f32 v70, v70
 v_exp_f32 v71, v71
 v_cvt_pk_bf16_f32 v88, v64, v65
 v_cvt_pk_bf16_f32 v89, v66, v67
 v_mfma_f32_32x32x16_bf16 v[48:63], a[140:143], a[32:35], v[48:63]
 v_exp_f32 v72, v72
 v_exp_f32 v73, v73
 ds_read_b128 a[120:123], v6 offset:7904
 v_exp_f32 v74, v74
 v_exp_f32 v75, v75
 v_cvt_pk_bf16_f32 v90, v68, v69
 v_cvt_pk_bf16_f32 v91, v70, v71
 v_mfma_f32_32x32x16_bf16 a[72:87], a[136:139], v[84:87], a[72:87]
 v_exp_f32 v76, v76
 v_exp_f32 v77, v77
 v_exp_f32 v78, v78
 v_exp_f32 v79, v79
 v_cvt_pk_bf16_f32 v92, v72, v73
 v_cvt_pk_bf16_f32 v93, v74, v75
 v_mfma_f32_32x32x16_bf16 a[88:103], a[132:135], v[88:91], a[88:103]
 v_exp_f32 v48, v48
 v_exp_f32 v49, v49
 v_cvt_pk_bf16_f32 v94, v76, v77
 v_cvt_pk_bf16_f32 v95, v78, v79
 v_exp_f32 v50, v50
 v_exp_f32 v51, v51
 v_mfma_f32_32x32x16_bf16 v[64:79], a[104:107], a[4:7], v[32:47]
 v_exp_f32 v52, v52
 v_exp_f32 v53, v53
 s_waitcnt vmcnt(26)
 s_barrier
 ds_read_b128 a[112:115], v2 offset:18944
 ds_read_b128 a[144:147], v2 offset:27136
 v_exp_f32 v54, v54
 v_exp_f32 v55, v55
 v_cvt_pk_bf16_f32 v80, v48, v49
 v_cvt_pk_bf16_f32 v81, v50, v51
 v_mfma_f32_32x32x16_bf16 v[64:79], a[140:143], a[64:67], v[64:79]
 v_exp_f32 v56, v56
 v_exp_f32 v57, v57
 s_add_u32 s30, s20, 139264
 s_add_u32 m0, s21, 139264
 s_nop 0
 buffer_load_dwordx4 v1, s[4:7], s30 offen sc1 lds
 s_add_u32 s30, s20, 143360
 s_add_u32 m0, s21, 143360
 s_nop 0
 buffer_load_dwordx4 v1, s[4:7], s30 offen sc1 lds
 s_add_u32 s30, s20, 147456
 s_add_u32 m0, s21, 147456
 s_nop 0
 buffer_load_dwordx4 v1, s[4:7], s30 offen sc1 lds
 v_exp_f32 v58, v58
 v_exp_f32 v59, v59
 v_cvt_pk_bf16_f32 v82, v52, v53
 v_cvt_pk_bf16_f32 v83, v54, v55
 v_mfma_f32_32x32x16_bf16 a[88:103], a[136:139], v[92:95], a[88:103]
 v_exp_f32 v60, v60
 v_exp_f32 v61, v61
 v_exp_f32 v62, v62
 v_exp_f32 v63, v63
 v_cvt_pk_bf16_f32 v84, v56, v57
 v_cvt_pk_bf16_f32 v85, v58, v59
 s_waitcnt lgkmcnt(2)
 v_mfma_f32_32x32x16_bf16 a[72:87], a[116:119], v[80:83], a[72:87]
 v_exp_f32 v64, v64
 v_exp_f32 v65, v65
 v_cvt_pk_bf16_f32 v86, v60, v61
 v_cvt_pk_bf16_f32 v87, v62, v63
 v_exp_f32 v66, v66
 v_exp_f32 v67, v67
 v_mfma_f32_32x32x16_bf16 v[48:63], a[108:111], a[0:3], v[16:31]
 v_exp_f32 v68, v68
 v_exp_f32 v69, v69
 ds_read_b128 a[124:127], v6 offset:8512
 v_exp_f32 v70, v70
 v_exp_f32 v71, v71
 v_cvt_pk_bf16_f32 v88, v64, v65
 v_cvt_pk_bf16_f32 v89, v66, v67
 v_mfma_f32_32x32x16_bf16 v[48:63], a[140:143], a[36:39], v[48:63]
 v_exp_f32 v72, v72
 v_exp_f32 v73, v73
 ds_read_b128 a[128:131], v6 offset:9120
 v_exp_f32 v74, v74
 v_exp_f32 v75, v75
 v_cvt_pk_bf16_f32 v90, v68, v69
 v_cvt_pk_bf16_f32 v91, v70, v71
 v_mfma_f32_32x32x16_bf16 a[72:87], a[120:123], v[84:87], a[72:87]
 v_exp_f32 v76, v76
 v_exp_f32 v77, v77
 v_exp_f32 v78, v78
 v_exp_f32 v79, v79
 v_cvt_pk_bf16_f32 v92, v72, v73
 v_cvt_pk_bf16_f32 v93, v74, v75
 v_mfma_f32_32x32x16_bf16 a[88:103], a[116:119], v[88:91], a[88:103]
 v_exp_f32 v48, v48
 v_exp_f32 v49, v49
 v_cvt_pk_bf16_f32 v94, v76, v77
 v_cvt_pk_bf16_f32 v95, v78, v79
 v_exp_f32 v50, v50
 v_exp_f32 v51, v51
 v_mfma_f32_32x32x16_bf16 v[64:79], a[108:111], a[4:7], v[32:47]
 v_exp_f32 v52, v52
 v_exp_f32 v53, v53
 ds_read_b128 a[104:107], v2 offset:19968
 v_exp_f32 v54, v54
 v_exp_f32 v55, v55
 v_cvt_pk_bf16_f32 v80, v48, v49
 v_cvt_pk_bf16_f32 v81, v50, v51
 v_mfma_f32_32x32x16_bf16 v[64:79], a[140:143], a[68:71], v[64:79]
 v_exp_f32 v56, v56
 v_exp_f32 v57, v57
 v_exp_f32 v58, v58
 v_exp_f32 v59, v59
 v_cvt_pk_bf16_f32 v82, v52, v53
 v_cvt_pk_bf16_f32 v83, v54, v55
 v_mfma_f32_32x32x16_bf16 a[88:103], a[120:123], v[92:95], a[88:103]
 v_exp_f32 v60, v60
 v_exp_f32 v61, v61
 v_exp_f32 v62, v62
 v_exp_f32 v63, v63
 v_cvt_pk_bf16_f32 v84, v56, v57
 v_cvt_pk_bf16_f32 v85, v58, v59
 s_waitcnt lgkmcnt(1)
 v_mfma_f32_32x32x16_bf16 a[72:87], a[124:127], v[80:83], a[72:87]
 v_exp_f32 v64, v64
 v_exp_f32 v65, v65
 v_cvt_pk_bf16_f32 v86, v60, v61
 v_cvt_pk_bf16_f32 v87, v62, v63
 v_exp_f32 v66, v66
 v_exp_f32 v67, v67
 v_mfma_f32_32x32x16_bf16 v[48:63], a[112:115], a[0:3], v[16:31]
 v_exp_f32 v68, v68
 v_exp_f32 v69, v69
 ds_read_b128 a[132:135], v6 offset:18944
 v_exp_f32 v70, v70
 v_exp_f32 v71, v71
 v_cvt_pk_bf16_f32 v88, v64, v65
 v_cvt_pk_bf16_f32 v89, v66, v67
 v_mfma_f32_32x32x16_bf16 v[48:63], a[144:147], a[8:11], v[48:63]
 v_exp_f32 v72, v72
 v_exp_f32 v73, v73
 ds_read_b128 a[136:139], v6 offset:19552
 v_exp_f32 v74, v74
 v_exp_f32 v75, v75
 v_cvt_pk_bf16_f32 v90, v68, v69
 v_cvt_pk_bf16_f32 v91, v70, v71
 v_mfma_f32_32x32x16_bf16 a[72:87], a[128:131], v[84:87], a[72:87]
 v_exp_f32 v76, v76
 v_exp_f32 v77, v77
 v_exp_f32 v78, v78
 v_exp_f32 v79, v79
 v_cvt_pk_bf16_f32 v92, v72, v73
 v_cvt_pk_bf16_f32 v93, v74, v75
 v_mfma_f32_32x32x16_bf16 a[88:103], a[124:127], v[88:91], a[88:103]
 v_exp_f32 v48, v48
 v_exp_f32 v49, v49
 v_cvt_pk_bf16_f32 v94, v76, v77
 v_cvt_pk_bf16_f32 v95, v78, v79
 v_exp_f32 v50, v50
 v_exp_f32 v51, v51
 v_mfma_f32_32x32x16_bf16 v[64:79], a[112:115], a[4:7], v[32:47]
 v_exp_f32 v52, v52
 v_exp_f32 v53, v53
 ds_read_b128 a[108:111], v2 offset:20992
 v_exp_f32 v54, v54
 v_exp_f32 v55, v55
 v_cvt_pk_bf16_f32 v80, v48, v49
 v_cvt_pk_bf16_f32 v81, v50, v51
 v_mfma_f32_32x32x16_bf16 v[64:79], a[144:147], a[40:43], v[64:79]
 v_exp_f32 v56, v56
 v_exp_f32 v57, v57
 v_exp_f32 v58, v58
 v_exp_f32 v59, v59
 v_cvt_pk_bf16_f32 v82, v52, v53
 v_cvt_pk_bf16_f32 v83, v54, v55
 v_mfma_f32_32x32x16_bf16 a[88:103], a[128:131], v[92:95], a[88:103]
 v_exp_f32 v60, v60
 v_exp_f32 v61, v61
 v_exp_f32 v62, v62
 v_exp_f32 v63, v63
 v_cvt_pk_bf16_f32 v84, v56, v57
 v_cvt_pk_bf16_f32 v85, v58, v59
 s_waitcnt lgkmcnt(1)
 v_mfma_f32_32x32x16_bf16 a[72:87], a[132:135], v[80:83], a[72:87]
 v_exp_f32 v64, v64
 v_exp_f32 v65, v65
 v_cvt_pk_bf16_f32 v86, v60, v61
 v_cvt_pk_bf16_f32 v87, v62, v63
 v_exp_f32 v66, v66
 v_exp_f32 v67, v67
 v_mfma_f32_32x32x16_bf16 v[48:63], a[104:107], a[0:3], v[16:31]
 v_exp_f32 v68, v68
 v_exp_f32 v69, v69
 ds_read_b128 a[116:119], v6 offset:20160
 v_exp_f32 v70, v70
 v_exp_f32 v71, v71
 v_cvt_pk_bf16_f32 v88, v64, v65
 v_cvt_pk_bf16_f32 v89, v66, v67
 v_mfma_f32_32x32x16_bf16 v[48:63], a[144:147], a[12:15], v[48:63]
 v_exp_f32 v72, v72
 v_exp_f32 v73, v73
 ds_read_b128 a[120:123], v6 offset:20768
 buffer_load_dwordx4 v[128:131], v112, s[12:15], s34 offen
 buffer_load_dwordx4 v[132:135], v113, s[12:15], s34 offen
 s_add_u32 s34, s34, s35
 v_exp_f32 v74, v74
 v_exp_f32 v75, v75
 v_cvt_pk_bf16_f32 v90, v68, v69
 v_cvt_pk_bf16_f32 v91, v70, v71
 v_mfma_f32_32x32x16_bf16 a[72:87], a[136:139], v[84:87], a[72:87]
 v_exp_f32 v76, v76
 v_exp_f32 v77, v77
 v_exp_f32 v78, v78
 v_exp_f32 v79, v79
 v_cvt_pk_bf16_f32 v92, v72, v73
 v_cvt_pk_bf16_f32 v93, v74, v75
 v_mfma_f32_32x32x16_bf16 a[88:103], a[132:135], v[88:91], a[88:103]
 v_exp_f32 v48, v48
 v_exp_f32 v49, v49
 v_cvt_pk_bf16_f32 v94, v76, v77
 v_cvt_pk_bf16_f32 v95, v78, v79
 v_exp_f32 v50, v50
 v_exp_f32 v51, v51
 v_mfma_f32_32x32x16_bf16 v[64:79], a[104:107], a[4:7], v[32:47]
 v_exp_f32 v52, v52
 v_exp_f32 v53, v53
 ds_read_b128 a[112:115], v2 offset:22016
 v_exp_f32 v54, v54
 v_exp_f32 v55, v55
 v_cvt_pk_bf16_f32 v80, v48, v49
 v_cvt_pk_bf16_f32 v81, v50, v51
 v_mfma_f32_32x32x16_bf16 v[64:79], a[144:147], a[44:47], v[64:79]
 v_exp_f32 v56, v56
 v_exp_f32 v57, v57
 v_exp_f32 v58, v58
 v_exp_f32 v59, v59
 v_cvt_pk_bf16_f32 v82, v52, v53
 v_cvt_pk_bf16_f32 v83, v54, v55
 v_mfma_f32_32x32x16_bf16 a[88:103], a[136:139], v[92:95], a[88:103]
 v_exp_f32 v60, v60
 v_exp_f32 v61, v61
 v_exp_f32 v62, v62
 v_exp_f32 v63, v63
 v_cvt_pk_bf16_f32 v84, v56, v57
 v_cvt_pk_bf16_f32 v85, v58, v59
 s_waitcnt lgkmcnt(1)
 v_mfma_f32_32x32x16_bf16 a[72:87], a[116:119], v[80:83], a[72:87]
 v_exp_f32 v64, v64
 v_exp_f32 v65, v65
 v_cvt_pk_bf16_f32 v86, v60, v61
 v_cvt_pk_bf16_f32 v87, v62, v63
 v_exp_f32 v66, v66
 v_exp_f32 v67, v67
 v_mfma_f32_32x32x16_bf16 v[48:63], a[108:111], a[0:3], v[16:31]
 v_exp_f32 v68, v68
 v_exp_f32 v69, v69
 ds_read_b128 a[124:127], v6 offset:21376
 v_exp_f32 v70, v70
 v_exp_f32 v71, v71
 v_cvt_pk_bf16_f32 v88, v64, v65
 v_cvt_pk_bf16_f32 v89, v66, v67
 v_mfma_f32_32x32x16_bf16 v[48:63], a[144:147], a[16:19], v[48:63]
 v_exp_f32 v72, v72
 v_exp_f32 v73, v73
 ds_read_b128 a[128:131], v6 offset:21984
 v_exp_f32 v74, v74
 v_exp_f32 v75, v75
 v_cvt_pk_bf16_f32 v90, v68, v69
 v_cvt_pk_bf16_f32 v91, v70, v71
 v_mfma_f32_32x32x16_bf16 a[72:87], a[120:123], v[84:87], a[72:87]
 v_exp_f32 v76, v76
 v_exp_f32 v77, v77
 v_exp_f32 v78, v78
 v_exp_f32 v79, v79
 v_cvt_pk_bf16_f32 v92, v72, v73
 v_cvt_pk_bf16_f32 v93, v74, v75
 v_mfma_f32_32x32x16_bf16 a[88:103], a[116:119], v[88:91], a[88:103]
 v_exp_f32 v48, v48
 v_exp_f32 v49, v49
 v_cvt_pk_bf16_f32 v94, v76, v77
 v_cvt_pk_bf16_f32 v95, v78, v79
 v_exp_f32 v50, v50
 v_exp_f32 v51, v51
 v_mfma_f32_32x32x16_bf16 v[64:79], a[108:111], a[4:7], v[32:47]
 v_exp_f32 v52, v52
 v_exp_f32 v53, v53
 ds_read_b128 a[104:107], v2 offset:23040
 v_exp_f32 v54, v54
 v_exp_f32 v55, v55
 v_cvt_pk_bf16_f32 v80, v48, v49
 v_cvt_pk_bf16_f32 v81, v50, v51
 v_mfma_f32_32x32x16_bf16 v[64:79], a[144:147], a[48:51], v[64:79]
 v_exp_f32 v56, v56
 v_exp_f32 v57, v57
 v_exp_f32 v58, v58
 v_exp_f32 v59, v59
 v_cvt_pk_bf16_f32 v82, v52, v53
 v_cvt_pk_bf16_f32 v83, v54, v55
 v_mfma_f32_32x32x16_bf16 a[88:103], a[120:123], v[92:95], a[88:103]
 v_exp_f32 v60, v60
 v_exp_f32 v61, v61
 v_exp_f32 v62, v62
 v_exp_f32 v63, v63
 v_cvt_pk_bf16_f32 v84, v56, v57
 v_cvt_pk_bf16_f32 v85, v58, v59
 s_waitcnt lgkmcnt(1)
 v_mfma_f32_32x32x16_bf16 a[72:87], a[124:127], v[80:83], a[72:87]
 v_exp_f32 v64, v64
 v_exp_f32 v65, v65
 v_cvt_pk_bf16_f32 v86, v60, v61
 v_cvt_pk_bf16_f32 v87, v62, v63
 v_exp_f32 v66, v66
 v_exp_f32 v67, v67
 v_mfma_f32_32x32x16_bf16 v[48:63], a[112:115], a[0:3], v[16:31]
 v_exp_f32 v68, v68
 v_exp_f32 v69, v69
 ds_read_b128 a[132:135], v6 offset:22592
 v_exp_f32 v70, v70
 v_exp_f32 v71, v71
 v_cvt_pk_bf16_f32 v88, v64, v65
 v_cvt_pk_bf16_f32 v89, v66, v67
 v_mfma_f32_32x32x16_bf16 v[48:63], a[144:147], a[20:23], v[48:63]
 v_exp_f32 v72, v72
 v_exp_f32 v73, v73
 ds_read_b128 a[136:139], v6 offset:23200
 v_exp_f32 v74, v74
 v_exp_f32 v75, v75
 v_cvt_pk_bf16_f32 v90, v68, v69
 v_cvt_pk_bf16_f32 v91, v70, v71
 v_mfma_f32_32x32x16_bf16 a[72:87], a[128:131], v[84:87], a[72:87]
 v_exp_f32 v76, v76
 v_exp_f32 v77, v77
 v_exp_f32 v78, v78
 v_exp_f32 v79, v79
 v_cvt_pk_bf16_f32 v92, v72, v73
 v_cvt_pk_bf16_f32 v93, v74, v75
 v_mfma_f32_32x32x16_bf16 a[88:103], a[124:127], v[88:91], a[88:103]
 v_exp_f32 v48, v48
 v_exp_f32 v49, v49
 v_cvt_pk_bf16_f32 v94, v76, v77
 v_cvt_pk_bf16_f32 v95, v78, v79
 v_exp_f32 v50, v50
 v_exp_f32 v51, v51
 v_mfma_f32_32x32x16_bf16 v[64:79], a[112:115], a[4:7], v[32:47]
 v_exp_f32 v52, v52
 v_exp_f32 v53, v53
 ds_read_b128 a[108:111], v2 offset:24064
 v_exp_f32 v54, v54
 v_exp_f32 v55, v55
 v_cvt_pk_bf16_f32 v80, v48, v49
 v_cvt_pk_bf16_f32 v81, v50, v51
 v_mfma_f32_32x32x16_bf16 v[64:79], a[144:147], a[52:55], v[64:79]
 v_exp_f32 v56, v56
 v_exp_f32 v57, v57
 v_exp_f32 v58, v58
 v_exp_f32 v59, v59
 v_cvt_pk_bf16_f32 v82, v52, v53
 v_cvt_pk_bf16_f32 v83, v54, v55
 v_mfma_f32_32x32x16_bf16 a[88:103], a[128:131], v[92:95], a[88:103]
 v_exp_f32 v60, v60
 v_exp_f32 v61, v61
 v_exp_f32 v62, v62
 v_exp_f32 v63, v63
 v_cvt_pk_bf16_f32 v84, v56, v57
 v_cvt_pk_bf16_f32 v85, v58, v59
 s_waitcnt lgkmcnt(1)
 v_mfma_f32_32x32x16_bf16 a[72:87], a[132:135], v[80:83], a[72:87]
 v_exp_f32 v64, v64
 v_exp_f32 v65, v65
 v_cvt_pk_bf16_f32 v86, v60, v61
 v_cvt_pk_bf16_f32 v87, v62, v63
 v_exp_f32 v66, v66
 v_exp_f32 v67, v67
 v_mfma_f32_32x32x16_bf16 v[48:63], a[104:107], a[0:3], v[16:31]
 v_exp_f32 v68, v68
 v_exp_f32 v69, v69
 ds_read_b128 a[116:119], v6 offset:23808
 v_exp_f32 v70, v70
 v_exp_f32 v71, v71
 v_cvt_pk_bf16_f32 v88, v64, v65
 v_cvt_pk_bf16_f32 v89, v66, v67
 v_mfma_f32_32x32x16_bf16 v[48:63], a[144:147], a[24:27], v[48:63]
 v_exp_f32 v72, v72
 v_exp_f32 v73, v73
 ds_read_b128 a[120:123], v6 offset:24416
 v_exp_f32 v74, v74
 v_exp_f32 v75, v75
 v_cvt_pk_bf16_f32 v90, v68, v69
 v_cvt_pk_bf16_f32 v91, v70, v71
 v_mfma_f32_32x32x16_bf16 a[72:87], a[136:139], v[84:87], a[72:87]
 v_exp_f32 v76, v76
 v_exp_f32 v77, v77
 v_exp_f32 v78, v78
 v_exp_f32 v79, v79
 v_cvt_pk_bf16_f32 v92, v72, v73
 v_cvt_pk_bf16_f32 v93, v74, v75
 v_mfma_f32_32x32x16_bf16 a[88:103], a[132:135], v[88:91], a[88:103]
 v_exp_f32 v48, v48
 v_exp_f32 v49, v49
 v_cvt_pk_bf16_f32 v94, v76, v77
 v_cvt_pk_bf16_f32 v95, v78, v79
 v_exp_f32 v50, v50
 v_exp_f32 v51, v51
 v_mfma_f32_32x32x16_bf16 v[64:79], a[104:107], a[4:7], v[32:47]
 v_exp_f32 v52, v52
 v_exp_f32 v53, v53
 ds_read_b128 a[112:115], v2 offset:25088
 v_exp_f32 v54, v54
 v_exp_f32 v55, v55
 v_cvt_pk_bf16_f32 v80, v48, v49
 v_cvt_pk_bf16_f32 v81, v50, v51
 v_mfma_f32_32x32x16_bf16 v[64:79], a[144:147], a[56:59], v[64:79]
 v_exp_f32 v56, v56
 v_exp_f32 v57, v57
 v_exp_f32 v58, v58
 v_exp_f32 v59, v59
 v_cvt_pk_bf16_f32 v82, v52, v53
 v_cvt_pk_bf16_f32 v83, v54, v55
 v_mfma_f32_32x32x16_bf16 a[88:103], a[136:139], v[92:95], a[88:103]
 v_exp_f32 v60, v60
 v_exp_f32 v61, v61
 v_exp_f32 v62, v62
 v_exp_f32 v63, v63
 v_cvt_pk_bf16_f32 v84, v56, v57
 v_cvt_pk_bf16_f32 v85, v58, v59
 s_waitcnt lgkmcnt(1)
 v_mfma_f32_32x32x16_bf16 a[72:87], a[116:119], v[80:83], a[72:87]
 v_exp_f32 v64, v64
 v_exp_f32 v65, v65
 v_cvt_pk_bf16_f32 v86, v60, v61
 v_cvt_pk_bf16_f32 v87, v62, v63
 v_exp_f32 v66, v66
 v_exp_f32 v67, v67
 v_mfma_f32_32x32x16_bf16 v[48:63], a[108:111], a[0:3], v[16:31]
 v_exp_f32 v68, v68
 v_exp_f32 v69, v69
 ds_read_b128 a[124:127], v6 offset:25024
 v_exp_f32 v70, v70
 v_exp_f32 v71, v71
 v_cvt_pk_bf16_f32 v88, v64, v65
 v_cvt_pk_bf16_f32 v89, v66, v67
 v_mfma_f32_32x32x16_bf16 v[48:63], a[144:147], a[28:31], v[48:63]
 v_exp_f32 v72, v72
 v_exp_f32 v73, v73
 ds_read_b128 a[128:131], v6 offset:25632
 v_exp_f32 v74, v74
 v_exp_f32 v75, v75
 v_cvt_pk_bf16_f32 v90, v68, v69
 v_cvt_pk_bf16_f32 v91, v70, v71
 v_mfma_f32_32x32x16_bf16 a[72:87], a[120:123], v[84:87], a[72:87]
 v_exp_f32 v76, v76
 v_exp_f32 v77, v77
 v_exp_f32 v78, v78
 v_exp_f32 v79, v79
 v_cvt_pk_bf16_f32 v92, v72, v73
 v_cvt_pk_bf16_f32 v93, v74, v75
 v_mfma_f32_32x32x16_bf16 a[88:103], a[116:119], v[88:91], a[88:103]
 v_exp_f32 v48, v48
 v_exp_f32 v49, v49
 v_cvt_pk_bf16_f32 v94, v76, v77
 v_cvt_pk_bf16_f32 v95, v78, v79
 v_exp_f32 v50, v50
 v_exp_f32 v51, v51
 v_mfma_f32_32x32x16_bf16 v[64:79], a[108:111], a[4:7], v[32:47]
 v_exp_f32 v52, v52
 v_exp_f32 v53, v53
 ds_read_b128 a[104:107], v2 offset:26112
 v_exp_f32 v54, v54
 v_exp_f32 v55, v55
 v_cvt_pk_bf16_f32 v80, v48, v49
 v_cvt_pk_bf16_f32 v81, v50, v51
 v_mfma_f32_32x32x16_bf16 v[64:79], a[144:147], a[60:63], v[64:79]
 v_exp_f32 v56, v56
 v_exp_f32 v57, v57
 v_exp_f32 v58, v58
 v_exp_f32 v59, v59
 v_cvt_pk_bf16_f32 v82, v52, v53
 v_cvt_pk_bf16_f32 v83, v54, v55
 v_mfma_f32_32x32x16_bf16 a[88:103], a[120:123], v[92:95], a[88:103]
 v_exp_f32 v60, v60
 v_exp_f32 v61, v61
 v_exp_f32 v62, v62
 v_exp_f32 v63, v63
 v_cvt_pk_bf16_f32 v84, v56, v57
 v_cvt_pk_bf16_f32 v85, v58, v59
 s_waitcnt lgkmcnt(1)
 v_mfma_f32_32x32x16_bf16 a[72:87], a[124:127], v[80:83], a[72:87]
 v_exp_f32 v64, v64
 v_exp_f32 v65, v65
 v_cvt_pk_bf16_f32 v86, v60, v61
 v_cvt_pk_bf16_f32 v87, v62, v63
 v_exp_f32 v66, v66
 v_exp_f32 v67, v67
 v_mfma_f32_32x32x16_bf16 v[48:63], a[112:115], a[0:3], v[16:31]
 v_exp_f32 v68, v68
 v_exp_f32 v69, v69
 ds_read_b128 a[132:135], v6 offset:26240
 v_exp_f32 v70, v70
 v_exp_f32 v71, v71
 v_cvt_pk_bf16_f32 v88, v64, v65
 v_cvt_pk_bf16_f32 v89, v66, v67
 v_mfma_f32_32x32x16_bf16 v[48:63], a[144:147], a[32:35], v[48:63]
 v_exp_f32 v72, v72
 v_exp_f32 v73, v73
 ds_read_b128 a[136:139], v6 offset:26848
 buffer_load_dwordx4 v[136:139], v112, s[12:15], s34 offen
 buffer_load_dwordx4 v[140:143], v113, s[12:15], s34 offen
 s_add_u32 s34, s34, s35
 s_waitcnt vmcnt(13)
 ds_write_b128 v115, v[120:123]
 ds_write_b128 v115, v[124:127] offset:1024
 v_exp_f32 v74, v74
 v_exp_f32 v75, v75
 v_cvt_pk_bf16_f32 v90, v68, v69
 v_cvt_pk_bf16_f32 v91, v70, v71
 v_mfma_f32_32x32x16_bf16 a[72:87], a[128:131], v[84:87], a[72:87]
 v_exp_f32 v76, v76
 v_exp_f32 v77, v77
 v_exp_f32 v78, v78
 v_exp_f32 v79, v79
 v_cvt_pk_bf16_f32 v92, v72, v73
 v_cvt_pk_bf16_f32 v93, v74, v75
 v_mfma_f32_32x32x16_bf16 a[88:103], a[124:127], v[88:91], a[88:103]
 v_exp_f32 v48, v48
 v_exp_f32 v49, v49
 v_cvt_pk_bf16_f32 v94, v76, v77
 v_cvt_pk_bf16_f32 v95, v78, v79
 v_exp_f32 v50, v50
 v_exp_f32 v51, v51
 v_mfma_f32_32x32x16_bf16 v[64:79], a[112:115], a[4:7], v[32:47]
 v_exp_f32 v52, v52
 v_exp_f32 v53, v53
 s_waitcnt vmcnt(4)
 s_barrier
 ds_read_b128 a[108:111], v3 offset:0
 ds_read_b128 a[140:143], v3 offset:8192
 v_exp_f32 v54, v54
 v_exp_f32 v55, v55
 v_cvt_pk_bf16_f32 v80, v48, v49
 v_cvt_pk_bf16_f32 v81, v50, v51
 v_mfma_f32_32x32x16_bf16 v[64:79], a[144:147], a[64:67], v[64:79]
 v_exp_f32 v56, v56
 v_exp_f32 v57, v57
 v_exp_f32 v58, v58
 v_exp_f32 v59, v59
 v_cvt_pk_bf16_f32 v82, v52, v53
 v_cvt_pk_bf16_f32 v83, v54, v55
 v_mfma_f32_32x32x16_bf16 a[88:103], a[128:131], v[92:95], a[88:103]
 v_exp_f32 v60, v60
 v_exp_f32 v61, v61
 v_exp_f32 v62, v62
 v_exp_f32 v63, v63
 v_cvt_pk_bf16_f32 v84, v56, v57
 v_cvt_pk_bf16_f32 v85, v58, v59
 s_waitcnt lgkmcnt(4)
 v_mfma_f32_32x32x16_bf16 a[72:87], a[132:135], v[80:83], a[72:87]
 v_exp_f32 v64, v64
 v_exp_f32 v65, v65
 v_cvt_pk_bf16_f32 v86, v60, v61
 v_cvt_pk_bf16_f32 v87, v62, v63
 v_exp_f32 v66, v66
 v_exp_f32 v67, v67
 v_mfma_f32_32x32x16_bf16 v[48:63], a[104:107], a[0:3], v[16:31]
 v_exp_f32 v68, v68
 v_exp_f32 v69, v69
 ds_read_b128 a[116:119], v6 offset:27456
 v_exp_f32 v70, v70
 v_exp_f32 v71, v71
 v_cvt_pk_bf16_f32 v88, v64, v65
 v_cvt_pk_bf16_f32 v89, v66, v67
 v_mfma_f32_32x32x16_bf16 v[48:63], a[144:147], a[36:39], v[48:63]
 v_exp_f32 v72, v72
 v_exp_f32 v73, v73
 ds_read_b128 a[120:123], v6 offset:28064
 s_waitcnt lgkmcnt(4)
 ds_read_b64_tr_b16 v[192:193], v117 offset:0
 ds_read_b64_tr_b16 v[194:195], v117 offset:512
 ds_read_b64_tr_b16 v[196:197], v117 offset:64
 ds_read_b64_tr_b16 v[198:199], v117 offset:576
 v_exp_f32 v74, v74
 v_exp_f32 v75, v75
 v_cvt_pk_bf16_f32 v90, v68, v69
 v_cvt_pk_bf16_f32 v91, v70, v71
 v_mfma_f32_32x32x16_bf16 a[72:87], a[136:139], v[84:87], a[72:87]
 v_exp_f32 v76, v76
 v_exp_f32 v77, v77
 v_exp_f32 v78, v78
 v_exp_f32 v79, v79
 v_cvt_pk_bf16_f32 v92, v72, v73
 v_cvt_pk_bf16_f32 v93, v74, v75
 v_mfma_f32_32x32x16_bf16 a[88:103], a[132:135], v[88:91], a[88:103]
 v_exp_f32 v48, v48
 v_exp_f32 v49, v49
 v_cvt_pk_bf16_f32 v94, v76, v77
 v_cvt_pk_bf16_f32 v95, v78, v79
 v_exp_f32 v50, v50
 v_exp_f32 v51, v51
 v_mfma_f32_32x32x16_bf16 v[64:79], a[104:107], a[4:7], v[32:47]
 v_exp_f32 v52, v52
 v_exp_f32 v53, v53
 ds_read_b128 a[112:115], v3 offset:1024
 v_exp_f32 v54, v54
 v_exp_f32 v55, v55
 v_cvt_pk_bf16_f32 v80, v48, v49
 v_cvt_pk_bf16_f32 v81, v50, v51
 v_mfma_f32_32x32x16_bf16 v[64:79], a[144:147], a[68:71], v[64:79]
 v_exp_f32 v56, v56
 v_exp_f32 v57, v57
 v_exp_f32 v58, v58
 v_exp_f32 v59, v59
 v_cvt_pk_bf16_f32 v82, v52, v53
 v_cvt_pk_bf16_f32 v83, v54, v55
 v_mfma_f32_32x32x16_bf16 a[88:103], a[136:139], v[92:95], a[88:103]
 v_exp_f32 v60, v60
 v_exp_f32 v61, v61
 v_exp_f32 v62, v62
 v_exp_f32 v63, v63
 v_cvt_pk_bf16_f32 v84, v56, v57
 v_cvt_pk_bf16_f32 v85, v58, v59
 s_waitcnt lgkmcnt(5)
 v_mfma_f32_32x32x16_bf16 a[72:87], a[116:119], v[80:83], a[72:87]
 v_exp_f32 v64, v64
 v_exp_f32 v65, v65
 v_cvt_pk_bf16_f32 v86, v60, v61
 v_cvt_pk_bf16_f32 v87, v62, v63
 v_exp_f32 v66, v66
 v_exp_f32 v67, v67
 v_mfma_f32_32x32x16_bf16 v[48:63], a[108:111], a[0:3], v[16:31]
 v_exp_f32 v68, v68
 v_exp_f32 v69, v69
 ds_read_b128 a[124:127], v7 offset:0
 v_exp_f32 v70, v70
 v_exp_f32 v71, v71
 v_cvt_pk_bf16_f32 v88, v64, v65
 v_cvt_pk_bf16_f32 v89, v66, v67
 v_mfma_f32_32x32x16_bf16 v[48:63], a[140:143], a[8:11], v[48:63]
 v_exp_f32 v72, v72
 v_exp_f32 v73, v73
 ds_read_b128 a[128:131], v7 offset:608
 s_waitcnt lgkmcnt(3)
 buffer_store_dwordx4 v[192:195], v114, s[4:7], s36 offen sc1
 s_add_u32 s30, s36, s17
 buffer_store_dwordx4 v[196:199], v114, s[4:7], s30 offen sc1
 s_add_u32 s36, s36, s37
 v_exp_f32 v74, v74
 v_exp_f32 v75, v75
 v_cvt_pk_bf16_f32 v90, v68, v69
 v_cvt_pk_bf16_f32 v91, v70, v71
 v_mfma_f32_32x32x16_bf16 a[72:87], a[120:123], v[84:87], a[72:87]
 v_exp_f32 v76, v76
 v_exp_f32 v77, v77
 v_exp_f32 v78, v78
 v_exp_f32 v79, v79
 v_cvt_pk_bf16_f32 v92, v72, v73
 v_cvt_pk_bf16_f32 v93, v74, v75
 v_mfma_f32_32x32x16_bf16 a[88:103], a[116:119], v[88:91], a[88:103]
 v_exp_f32 v48, v48
 v_exp_f32 v49, v49
 v_cvt_pk_bf16_f32 v94, v76, v77
 v_cvt_pk_bf16_f32 v95, v78, v79
 v_exp_f32 v50, v50
 v_exp_f32 v51, v51
 v_mfma_f32_32x32x16_bf16 v[64:79], a[108:111], a[4:7], v[32:47]
 v_exp_f32 v52, v52
 v_exp_f32 v53, v53
 ds_read_b128 a[104:107], v3 offset:2048
 v_exp_f32 v54, v54
 v_exp_f32 v55, v55
 v_cvt_pk_bf16_f32 v80, v48, v49
 v_cvt_pk_bf16_f32 v81, v50, v51
 v_mfma_f32_32x32x16_bf16 v[64:79], a[140:143], a[40:43], v[64:79]
 v_exp_f32 v56, v56
 v_exp_f32 v57, v57
 v_exp_f32 v58, v58
 v_exp_f32 v59, v59
 v_cvt_pk_bf16_f32 v82, v52, v53
 v_cvt_pk_bf16_f32 v83, v54, v55
 v_mfma_f32_32x32x16_bf16 a[88:103], a[120:123], v[92:95], a[88:103]
 v_exp_f32 v60, v60
 v_exp_f32 v61, v61
 v_exp_f32 v62, v62
 v_exp_f32 v63, v63
 v_cvt_pk_bf16_f32 v84, v56, v57
 v_cvt_pk_bf16_f32 v85, v58, v59
 s_waitcnt lgkmcnt(1)
 v_mfma_f32_32x32x16_bf16 a[72:87], a[124:127], v[80:83], a[72:87]
 v_exp_f32 v64, v64
 v_exp_f32 v65, v65
 v_cvt_pk_bf16_f32 v86, v60, v61
 v_cvt_pk_bf16_f32 v87, v62, v63
 v_exp_f32 v66, v66
 v_exp_f32 v67, v67
 v_mfma_f32_32x32x16_bf16 v[48:63], a[112:115], a[0:3], v[16:31]
 v_exp_f32 v68, v68
 v_exp_f32 v69, v69
 ds_read_b128 a[132:135], v7 offset:1216
 v_exp_f32 v70, v70
 v_exp_f32 v71, v71
 v_cvt_pk_bf16_f32 v88, v64, v65
 v_cvt_pk_bf16_f32 v89, v66, v67
 v_mfma_f32_32x32x16_bf16 v[48:63], a[140:143], a[12:15], v[48:63]
 v_exp_f32 v72, v72
 v_exp_f32 v73, v73
 ds_read_b128 a[136:139], v7 offset:1824
 v_dot2_f32_bf16 v116, v192, s19, v116
 v_dot2_f32_bf16 v116, v193, s19, v116
 v_dot2_f32_bf16 v116, v194, s19, v116
 v_dot2_f32_bf16 v116, v195, s19, v116
 v_dot2_f32_bf16 v118, v196, s19, v118
 v_dot2_f32_bf16 v118, v197, s19, v118
 v_dot2_f32_bf16 v118, v198, s19, v118
 v_dot2_f32_bf16 v118, v199, s19, v118
 v_exp_f32 v74, v74
 v_exp_f32 v75, v75
 v_cvt_pk_bf16_f32 v90, v68, v69
 v_cvt_pk_bf16_f32 v91, v70, v71
 v_mfma_f32_32x32x16_bf16 a[72:87], a[128:131], v[84:87], a[72:87]
 v_exp_f32 v76, v76
 v_exp_f32 v77, v77
 v_exp_f32 v78, v78
 v_exp_f32 v79, v79
 v_cvt_pk_bf16_f32 v92, v72, v73
 v_cvt_pk_bf16_f32 v93, v74, v75
 v_mfma_f32_32x32x16_bf16 a[88:103], a[124:127], v[88:91], a[88:103]
 v_exp_f32 v48, v48
 v_exp_f32 v49, v49
 v_cvt_pk_bf16_f32 v94, v76, v77
 v_cvt_pk_bf16_f32 v95, v78, v79
 v_exp_f32 v50, v50
 v_exp_f32 v51, v51
 v_mfma_f32_32x32x16_bf16 v[64:79], a[112:115], a[4:7], v[32:47]
 v_exp_f32 v52, v52
 v_exp_f32 v53, v53
 ds_read_b128 a[108:111], v3 offset:3072
 v_exp_f32 v54, v54
 v_exp_f32 v55, v55
 v_cvt_pk_bf16_f32 v80, v48, v49
 v_cvt_pk_bf16_f32 v81, v50, v51
 v_mfma_f32_32x32x16_bf16 v[64:79], a[140:143], a[44:47], v[64:79]
 v_exp_f32 v56, v56
 v_exp_f32 v57, v57
 v_exp_f32 v58, v58
 v_exp_f32 v59, v59
 v_cvt_pk_bf16_f32 v82, v52, v53
 v_cvt_pk_bf16_f32 v83, v54, v55
 v_mfma_f32_32x32x16_bf16 a[88:103], a[128:131], v[92:95], a[88:103]
 v_exp_f32 v60, v60
 v_exp_f32 v61, v61
 v_exp_f32 v62, v62
 v_exp_f32 v63, v63
 v_cvt_pk_bf16_f32 v84, v56, v57
 v_cvt_pk_bf16_f32 v85, v58, v59
 s_waitcnt lgkmcnt(1)
 v_mfma_f32_32x32x16_bf16 a[72:87], a[132:135], v[80:83], a[72:87]
 v_exp_f32 v64, v64
 v_exp_f32 v65, v65
 v_cvt_pk_bf16_f32 v86, v60, v61
 v_cvt_pk_bf16_f32 v87, v62, v63
 v_exp_f32 v66, v66
 v_exp_f32 v67, v67
 v_mfma_f32_32x32x16_bf16 v[48:63], a[104:107], a[0:3], v[16:31]
 v_exp_f32 v68, v68
 v_exp_f32 v69, v69
 ds_read_b128 a[116:119], v7 offset:2432
 v_exp_f32 v70, v70
 v_exp_f32 v71, v71
 v_cvt_pk_bf16_f32 v88, v64, v65
 v_cvt_pk_bf16_f32 v89, v66, v67
 v_mfma_f32_32x32x16_bf16 v[48:63], a[140:143], a[16:19], v[48:63]
 v_exp_f32 v72, v72
 v_exp_f32 v73, v73
 ds_read_b128 a[120:123], v7 offset:3040
 v_exp_f32 v74, v74
 v_exp_f32 v75, v75
 v_cvt_pk_bf16_f32 v90, v68, v69
 v_cvt_pk_bf16_f32 v91, v70, v71
 v_mfma_f32_32x32x16_bf16 a[72:87], a[136:139], v[84:87], a[72:87]
 v_exp_f32 v76, v76
 v_exp_f32 v77, v77
 v_exp_f32 v78, v78
 v_exp_f32 v79, v79
 v_cvt_pk_bf16_f32 v92, v72, v73
 v_cvt_pk_bf16_f32 v93, v74, v75
 v_mfma_f32_32x32x16_bf16 a[88:103], a[132:135], v[88:91], a[88:103]
 v_exp_f32 v48, v48
 v_exp_f32 v49, v49
 v_cvt_pk_bf16_f32 v94, v76, v77
 v_cvt_pk_bf16_f32 v95, v78, v79
 v_exp_f32 v50, v50
 v_exp_f32 v51, v51
 v_mfma_f32_32x32x16_bf16 v[64:79], a[104:107], a[4:7], v[32:47]
 v_exp_f32 v52, v52
 v_exp_f32 v53, v53
 ds_read_b128 a[112:115], v3 offset:4096
 v_exp_f32 v54, v54
 v_exp_f32 v55, v55
 v_cvt_pk_bf16_f32 v80, v48, v49
 v_cvt_pk_bf16_f32 v81, v50, v51
 v_mfma_f32_32x32x16_bf16 v[64:79], a[140:143], a[48:51], v[64:79]
 v_exp_f32 v56, v56
 v_exp_f32 v57, v57
 v_exp_f32 v58, v58
 v_exp_f32 v59, v59
 v_cvt_pk_bf16_f32 v82, v52, v53
 v_cvt_pk_bf16_f32 v83, v54, v55
 v_mfma_f32_32x32x16_bf16 a[88:103], a[136:139], v[92:95], a[88:103]
 v_exp_f32 v60, v60
 v_exp_f32 v61, v61
 v_exp_f32 v62, v62
 v_exp_f32 v63, v63
 v_cvt_pk_bf16_f32 v84, v56, v57
 v_cvt_pk_bf16_f32 v85, v58, v59
 s_waitcnt lgkmcnt(1)
 v_mfma_f32_32x32x16_bf16 a[72:87], a[116:119], v[80:83], a[72:87]
 v_exp_f32 v64, v64
 v_exp_f32 v65, v65
 v_cvt_pk_bf16_f32 v86, v60, v61
 v_cvt_pk_bf16_f32 v87, v62, v63
 v_exp_f32 v66, v66
 v_exp_f32 v67, v67
 v_mfma_f32_32x32x16_bf16 v[48:63], a[108:111], a[0:3], v[16:31]
 v_exp_f32 v68, v68
 v_exp_f32 v69, v69
 ds_read_b128 a[124:127], v7 offset:3648
 v_exp_f32 v70, v70
 v_exp_f32 v71, v71
 v_cvt_pk_bf16_f32 v88, v64, v65
 v_cvt_pk_bf16_f32 v89, v66, v67
 v_mfma_f32_32x32x16_bf16 v[48:63], a[140:143], a[20:23], v[48:63]
 v_exp_f32 v72, v72
 v_exp_f32 v73, v73
 ds_read_b128 a[128:131], v7 offset:4256
 buffer_load_dwordx4 v[144:147], v112, s[12:15], s34 offen
 buffer_load_dwordx4 v[148:151], v113, s[12:15], s34 offen
 s_add_u32 s34, s34, s35
 s_waitcnt vmcnt(6)
 ds_write_b128 v115, v[128:131]
 ds_write_b128 v115, v[132:135] offset:1024
 v_exp_f32 v74, v74
 v_exp_f32 v75, v75
 v_cvt_pk_bf16_f32 v90, v68, v69
 v_cvt_pk_bf16_f32 v91, v70, v71
 v_mfma_f32_32x32x16_bf16 a[72:87], a[120:123], v[84:87], a[72:87]
 v_exp_f32 v76, v76
 v_exp_f32 v77, v77
 v_exp_f32 v78, v78
 v_exp_f32 v79, v79
 v_cvt_pk_bf16_f32 v92, v72, v73
 v_cvt_pk_bf16_f32 v93, v74, v75
 v_mfma_f32_32x32x16_bf16 a[88:103], a[116:119], v[88:91], a[88:103]
 v_exp_f32 v48, v48
 v_exp_f32 v49, v49
 v_cvt_pk_bf16_f32 v94, v76, v77
 v_cvt_pk_bf16_f32 v95, v78, v79
 v_exp_f32 v50, v50
 v_exp_f32 v51, v51
 v_mfma_f32_32x32x16_bf16 v[64:79], a[108:111], a[4:7], v[32:47]
 v_exp_f32 v52, v52
 v_exp_f32 v53, v53
 ds_read_b128 a[104:107], v3 offset:5120
 v_exp_f32 v54, v54
 v_exp_f32 v55, v55
 v_cvt_pk_bf16_f32 v80, v48, v49
 v_cvt_pk_bf16_f32 v81, v50, v51
 v_mfma_f32_32x32x16_bf16 v[64:79], a[140:143], a[52:55], v[64:79]
 v_exp_f32 v56, v56
 v_exp_f32 v57, v57
 v_exp_f32 v58, v58
 v_exp_f32 v59, v59
 v_cvt_pk_bf16_f32 v82, v52, v53
 v_cvt_pk_bf16_f32 v83, v54, v55
 v_mfma_f32_32x32x16_bf16 a[88:103], a[120:123], v[92:95], a[88:103]
 v_exp_f32 v60, v60
 v_exp_f32 v61, v61
 v_exp_f32 v62, v62
 v_exp_f32 v63, v63
 v_cvt_pk_bf16_f32 v84, v56, v57
 v_cvt_pk_bf16_f32 v85, v58, v59
 s_waitcnt lgkmcnt(3)
 v_mfma_f32_32x32x16_bf16 a[72:87], a[124:127], v[80:83], a[72:87]
 v_exp_f32 v64, v64
 v_exp_f32 v65, v65
 v_cvt_pk_bf16_f32 v86, v60, v61
 v_cvt_pk_bf16_f32 v87, v62, v63
 v_exp_f32 v66, v66
 v_exp_f32 v67, v67
 v_mfma_f32_32x32x16_bf16 v[48:63], a[112:115], a[0:3], v[16:31]
 v_exp_f32 v68, v68
 v_exp_f32 v69, v69
 ds_read_b128 a[132:135], v7 offset:4864
 v_exp_f32 v70, v70
 v_exp_f32 v71, v71
 v_cvt_pk_bf16_f32 v88, v64, v65
 v_cvt_pk_bf16_f32 v89, v66, v67
 v_mfma_f32_32x32x16_bf16 v[48:63], a[140:143], a[24:27], v[48:63]
 v_exp_f32 v72, v72
 v_exp_f32 v73, v73
 ds_read_b128 a[136:139], v7 offset:5472
 s_waitcnt lgkmcnt(3)
 ds_read_b64_tr_b16 v[192:193], v117 offset:0
 ds_read_b64_tr_b16 v[194:195], v117 offset:512
 ds_read_b64_tr_b16 v[196:197], v117 offset:64
 ds_read_b64_tr_b16 v[198:199], v117 offset:576
 v_exp_f32 v74, v74
 v_exp_f32 v75, v75
 v_cvt_pk_bf16_f32 v90, v68, v69
 v_cvt_pk_bf16_f32 v91, v70, v71
 v_mfma_f32_32x32x16_bf16 a[72:87], a[128:131], v[84:87], a[72:87]
 v_exp_f32 v76, v76
 v_exp_f32 v77, v77
 v_exp_f32 v78, v78
 v_exp_f32 v79, v79
 v_cvt_pk_bf16_f32 v92, v72, v73
 v_cvt_pk_bf16_f32 v93, v74, v75
 v_mfma_f32_32x32x16_bf16 a[88:103], a[124:127], v[88:91], a[88:103]
 v_exp_f32 v48, v48
 v_exp_f32 v49, v49
 v_cvt_pk_bf16_f32 v94, v76, v77
 v_cvt_pk_bf16_f32 v95, v78, v79
 v_exp_f32 v50, v50
 v_exp_f32 v51, v51
 v_mfma_f32_32x32x16_bf16 v[64:79], a[112:115], a[4:7], v[32:47]
 v_exp_f32 v52, v52
 v_exp_f32 v53, v53
 ds_read_b128 a[108:111], v3 offset:6144
 v_exp_f32 v54, v54
 v_exp_f32 v55, v55
 v_cvt_pk_bf16_f32 v80, v48, v49
 v_cvt_pk_bf16_f32 v81, v50, v51
 v_mfma_f32_32x32x16_bf16 v[64:79], a[140:143], a[56:59], v[64:79]
 v_exp_f32 v56, v56
 v_exp_f32 v57, v57
 buffer_store_dwordx4 v[208:211], v1, s[4:7], s86 offen sc1
 s_add_u32 s86, s86, 4096
 v_exp_f32 v58, v58
 v_exp_f32 v59, v59
 v_cvt_pk_bf16_f32 v82, v52, v53
 v_cvt_pk_bf16_f32 v83, v54, v55
 v_mfma_f32_32x32x16_bf16 a[88:103], a[128:131], v[92:95], a[88:103]
 v_exp_f32 v60, v60
 v_exp_f32 v61, v61
 v_exp_f32 v62, v62
 v_exp_f32 v63, v63
 v_cvt_pk_bf16_f32 v84, v56, v57
 v_cvt_pk_bf16_f32 v85, v58, v59
 s_waitcnt lgkmcnt(5)
 v_mfma_f32_32x32x16_bf16 a[72:87], a[132:135], v[80:83], a[72:87]
 v_exp_f32 v64, v64
 v_exp_f32 v65, v65
 v_cvt_pk_bf16_f32 v86, v60, v61
 v_cvt_pk_bf16_f32 v87, v62, v63
 v_exp_f32 v66, v66
 v_exp_f32 v67, v67
 v_mfma_f32_32x32x16_bf16 v[48:63], a[104:107], a[0:3], v[16:31]
 v_exp_f32 v68, v68
 v_exp_f32 v69, v69
 ds_read_b128 a[116:119], v7 offset:6080
 v_exp_f32 v70, v70
 v_exp_f32 v71, v71
 v_cvt_pk_bf16_f32 v88, v64, v65
 v_cvt_pk_bf16_f32 v89, v66, v67
 v_mfma_f32_32x32x16_bf16 v[48:63], a[140:143], a[28:31], v[48:63]
 v_exp_f32 v72, v72
 v_exp_f32 v73, v73
 ds_read_b128 a[120:123], v7 offset:6688
 s_waitcnt lgkmcnt(3)
 buffer_store_dwordx4 v[192:195], v114, s[4:7], s36 offen sc1
 s_add_u32 s30, s36, s17
 buffer_store_dwordx4 v[196:199], v114, s[4:7], s30 offen sc1
 s_add_u32 s36, s36, s37
 v_exp_f32 v74, v74
 v_exp_f32 v75, v75
 v_cvt_pk_bf16_f32 v90, v68, v69
 v_cvt_pk_bf16_f32 v91, v70, v71
 v_mfma_f32_32x32x16_bf16 a[72:87], a[136:139], v[84:87], a[72:87]
 v_exp_f32 v76, v76
 v_exp_f32 v77, v77
 v_exp_f32 v78, v78
 v_exp_f32 v79, v79
 v_cvt_pk_bf16_f32 v92, v72, v73
 v_cvt_pk_bf16_f32 v93, v74, v75
 v_mfma_f32_32x32x16_bf16 a[88:103], a[132:135], v[88:91], a[88:103]
 v_exp_f32 v48, v48
 v_exp_f32 v49, v49
 v_cvt_pk_bf16_f32 v94, v76, v77
 v_cvt_pk_bf16_f32 v95, v78, v79
 v_exp_f32 v50, v50
 v_exp_f32 v51, v51
 v_mfma_f32_32x32x16_bf16 v[64:79], a[104:107], a[4:7], v[32:47]
 v_exp_f32 v52, v52
 v_exp_f32 v53, v53
 ds_read_b128 a[112:115], v3 offset:7168
 v_exp_f32 v54, v54
 v_exp_f32 v55, v55
 v_cvt_pk_bf16_f32 v80, v48, v49
 v_cvt_pk_bf16_f32 v81, v50, v51
 v_mfma_f32_32x32x16_bf16 v[64:79], a[140:143], a[60:63], v[64:79]
 v_exp_f32 v56, v56
 v_exp_f32 v57, v57
 v_exp_f32 v58, v58
 v_exp_f32 v59, v59
 v_cvt_pk_bf16_f32 v82, v52, v53
 v_cvt_pk_bf16_f32 v83, v54, v55
 v_mfma_f32_32x32x16_bf16 a[88:103], a[136:139], v[92:95], a[88:103]
 v_exp_f32 v60, v60
 v_exp_f32 v61, v61
 v_exp_f32 v62, v62
 v_exp_f32 v63, v63
 v_cvt_pk_bf16_f32 v84, v56, v57
 v_cvt_pk_bf16_f32 v85, v58, v59
 s_waitcnt lgkmcnt(1)
 v_mfma_f32_32x32x16_bf16 a[72:87], a[116:119], v[80:83], a[72:87]
 v_exp_f32 v64, v64
 v_exp_f32 v65, v65
 v_cvt_pk_bf16_f32 v86, v60, v61
 v_cvt_pk_bf16_f32 v87, v62, v63
 v_exp_f32 v66, v66
 v_exp_f32 v67, v67
 v_mfma_f32_32x32x16_bf16 v[48:63], a[108:111], a[0:3], v[16:31]
 v_exp_f32 v68, v68
 v_exp_f32 v69, v69
 ds_read_b128 a[124:127], v7 offset:7296
 v_exp_f32 v70, v70
 v_exp_f32 v71, v71
 v_cvt_pk_bf16_f32 v88, v64, v65
 v_cvt_pk_bf16_f32 v89, v66, v67
 v_mfma_f32_32x32x16_bf16 v[48:63], a[140:143], a[32:35], v[48:63]
 v_exp_f32 v72, v72
 v_exp_f32 v73, v73
 ds_read_b128 a[128:131], v7 offset:7904
 v_dot2_f32_bf16 v116, v192, s19, v116
 v_dot2_f32_bf16 v116, v193, s19, v116
 v_dot2_f32_bf16 v116, v194, s19, v116
 v_dot2_f32_bf16 v116, v195, s19, v116
 v_dot2_f32_bf16 v118, v196, s19, v118
 v_dot2_f32_bf16 v118, v197, s19, v118
 v_dot2_f32_bf16 v118, v198, s19, v118
 v_dot2_f32_bf16 v118, v199, s19, v118
 v_exp_f32 v74, v74
 v_exp_f32 v75, v75
 v_cvt_pk_bf16_f32 v90, v68, v69
 v_cvt_pk_bf16_f32 v91, v70, v71
 v_mfma_f32_32x32x16_bf16 a[72:87], a[120:123], v[84:87], a[72:87]
 v_exp_f32 v76, v76
 v_exp_f32 v77, v77
 v_exp_f32 v78, v78
 v_exp_f32 v79, v79
 v_cvt_pk_bf16_f32 v92, v72, v73
 v_cvt_pk_bf16_f32 v93, v74, v75
 v_mfma_f32_32x32x16_bf16 a[88:103], a[116:119], v[88:91], a[88:103]
 v_exp_f32 v48, v48
 v_exp_f32 v49, v49
 v_cvt_pk_bf16_f32 v94, v76, v77
 v_cvt_pk_bf16_f32 v95, v78, v79
 v_exp_f32 v50, v50
 v_exp_f32 v51, v51
 v_mfma_f32_32x32x16_bf16 v[64:79], a[108:111], a[4:7], v[32:47]
 v_exp_f32 v52, v52
 v_exp_f32 v53, v53
 ds_read_b128 a[104:107], v3 offset:18944
 ds_read_b128 a[144:147], v3 offset:27136
 v_exp_f32 v54, v54
 v_exp_f32 v55, v55
 v_cvt_pk_bf16_f32 v80, v48, v49
 v_cvt_pk_bf16_f32 v81, v50, v51
 v_mfma_f32_32x32x16_bf16 v[64:79], a[140:143], a[64:67], v[64:79]
 v_exp_f32 v56, v56
 v_exp_f32 v57, v57
 buffer_store_dwordx4 v[208:211], v1, s[4:7], s86 offen sc1
 s_add_u32 s86, s86, 4096
 v_exp_f32 v58, v58
 v_exp_f32 v59, v59
 v_cvt_pk_bf16_f32 v82, v52, v53
 v_cvt_pk_bf16_f32 v83, v54, v55
 v_mfma_f32_32x32x16_bf16 a[88:103], a[120:123], v[92:95], a[88:103]
 v_exp_f32 v60, v60
 v_exp_f32 v61, v61
 v_exp_f32 v62, v62
 v_exp_f32 v63, v63
 v_cvt_pk_bf16_f32 v84, v56, v57
 v_cvt_pk_bf16_f32 v85, v58, v59
 s_waitcnt lgkmcnt(2)
 v_mfma_f32_32x32x16_bf16 a[72:87], a[124:127], v[80:83], a[72:87]
 v_exp_f32 v64, v64
 v_exp_f32 v65, v65
 v_cvt_pk_bf16_f32 v86, v60, v61
 v_cvt_pk_bf16_f32 v87, v62, v63
 v_exp_f32 v66, v66
 v_exp_f32 v67, v67
 v_mfma_f32_32x32x16_bf16 v[48:63], a[112:115], a[0:3], v[16:31]
 v_exp_f32 v68, v68
 v_exp_f32 v69, v69
 ds_read_b128 a[132:135], v7 offset:8512
 v_exp_f32 v70, v70
 v_exp_f32 v71, v71
 v_cvt_pk_bf16_f32 v88, v64, v65
 v_cvt_pk_bf16_f32 v89, v66, v67
 v_mfma_f32_32x32x16_bf16 v[48:63], a[140:143], a[36:39], v[48:63]
 v_exp_f32 v72, v72
 v_exp_f32 v73, v73
 ds_read_b128 a[136:139], v7 offset:9120
 v_exp_f32 v74, v74
 v_exp_f32 v75, v75
 v_cvt_pk_bf16_f32 v90, v68, v69
 v_cvt_pk_bf16_f32 v91, v70, v71
 v_mfma_f32_32x32x16_bf16 a[72:87], a[128:131], v[84:87], a[72:87]
 v_exp_f32 v76, v76
 v_exp_f32 v77, v77
 v_exp_f32 v78, v78
 v_exp_f32 v79, v79
 v_cvt_pk_bf16_f32 v92, v72, v73
 v_cvt_pk_bf16_f32 v93, v74, v75
 v_mfma_f32_32x32x16_bf16 a[88:103], a[124:127], v[88:91], a[88:103]
 v_exp_f32 v48, v48
 v_exp_f32 v49, v49
 v_cvt_pk_bf16_f32 v94, v76, v77
 v_cvt_pk_bf16_f32 v95, v78, v79
 v_exp_f32 v50, v50
 v_exp_f32 v51, v51
 v_mfma_f32_32x32x16_bf16 v[64:79], a[112:115], a[4:7], v[32:47]
 v_exp_f32 v52, v52
 v_exp_f32 v53, v53
 ds_read_b128 a[108:111], v3 offset:19968
 v_exp_f32 v54, v54
 v_exp_f32 v55, v55
 v_cvt_pk_bf16_f32 v80, v48, v49
 v_cvt_pk_bf16_f32 v81, v50, v51
 v_mfma_f32_32x32x16_bf16 v[64:79], a[140:143], a[68:71], v[64:79]
 v_exp_f32 v56, v56
 v_exp_f32 v57, v57
 v_exp_f32 v58, v58
 v_exp_f32 v59, v59
 v_cvt_pk_bf16_f32 v82, v52, v53
 v_cvt_pk_bf16_f32 v83, v54, v55
 v_mfma_f32_32x32x16_bf16 a[88:103], a[128:131], v[92:95], a[88:103]
 v_exp_f32 v60, v60
 v_exp_f32 v61, v61
 v_exp_f32 v62, v62
 v_exp_f32 v63, v63
 v_cvt_pk_bf16_f32 v84, v56, v57
 v_cvt_pk_bf16_f32 v85, v58, v59
 s_waitcnt lgkmcnt(1)
 v_mfma_f32_32x32x16_bf16 a[72:87], a[132:135], v[80:83], a[72:87]
 v_exp_f32 v64, v64
 v_exp_f32 v65, v65
 v_cvt_pk_bf16_f32 v86, v60, v61
 v_cvt_pk_bf16_f32 v87, v62, v63
 v_exp_f32 v66, v66
 v_exp_f32 v67, v67
 v_mfma_f32_32x32x16_bf16 v[48:63], a[104:107], a[0:3], v[16:31]
 v_exp_f32 v68, v68
 v_exp_f32 v69, v69
 ds_read_b128 a[116:119], v7 offset:18944
 v_exp_f32 v70, v70
 v_exp_f32 v71, v71
 v_cvt_pk_bf16_f32 v88, v64, v65
 v_cvt_pk_bf16_f32 v89, v66, v67
 v_mfma_f32_32x32x16_bf16 v[48:63], a[144:147], a[8:11], v[48:63]
 v_exp_f32 v72, v72
 v_exp_f32 v73, v73
 ds_read_b128 a[120:123], v7 offset:19552
 buffer_load_dwordx4 v[152:155], v112, s[12:15], s34 offen
 buffer_load_dwordx4 v[156:159], v113, s[12:15], s34 offen
 s_add_u32 s34, s34, s35
 s_waitcnt vmcnt(10)
 ds_write_b128 v115, v[136:139]
 ds_write_b128 v115, v[140:143] offset:1024
 v_exp_f32 v74, v74
 v_exp_f32 v75, v75
 v_cvt_pk_bf16_f32 v90, v68, v69
 v_cvt_pk_bf16_f32 v91, v70, v71
 v_mfma_f32_32x32x16_bf16 a[72:87], a[136:139], v[84:87], a[72:87]
 v_exp_f32 v76, v76
 v_exp_f32 v77, v77
 v_exp_f32 v78, v78
 v_exp_f32 v79, v79
 v_cvt_pk_bf16_f32 v92, v72, v73
 v_cvt_pk_bf16_f32 v93, v74, v75
 v_mfma_f32_32x32x16_bf16 a[88:103], a[132:135], v[88:91], a[88:103]
 v_exp_f32 v48, v48
 v_exp_f32 v49, v49
 v_cvt_pk_bf16_f32 v94, v76, v77
 v_cvt_pk_bf16_f32 v95, v78, v79
 v_exp_f32 v50, v50
 v_exp_f32 v51, v51
 v_mfma_f32_32x32x16_bf16 v[64:79], a[104:107], a[4:7], v[32:47]
 v_exp_f32 v52, v52
 v_exp_f32 v53, v53
 ds_read_b128 a[112:115], v3 offset:20992
 v_exp_f32 v54, v54
 v_exp_f32 v55, v55
 v_cvt_pk_bf16_f32 v80, v48, v49
 v_cvt_pk_bf16_f32 v81, v50, v51
 v_mfma_f32_32x32x16_bf16 v[64:79], a[144:147], a[40:43], v[64:79]
 v_exp_f32 v56, v56
 v_exp_f32 v57, v57
 buffer_store_dwordx4 v[208:211], v1, s[4:7], s86 offen sc1
 s_add_u32 s86, s86, 4096
 v_exp_f32 v58, v58
 v_exp_f32 v59, v59
 v_cvt_pk_bf16_f32 v82, v52, v53
 v_cvt_pk_bf16_f32 v83, v54, v55
 v_mfma_f32_32x32x16_bf16 a[88:103], a[136:139], v[92:95], a[88:103]
 v_exp_f32 v60, v60
 v_exp_f32 v61, v61
 v_exp_f32 v62, v62
 v_exp_f32 v63, v63
 v_cvt_pk_bf16_f32 v84, v56, v57
 v_cvt_pk_bf16_f32 v85, v58, v59
 s_waitcnt lgkmcnt(3)
 v_mfma_f32_32x32x16_bf16 a[72:87], a[116:119], v[80:83], a[72:87]
 v_exp_f32 v64, v64
 v_exp_f32 v65, v65
 v_cvt_pk_bf16_f32 v86, v60, v61
 v_cvt_pk_bf16_f32 v87, v62, v63
 v_exp_f32 v66, v66
 v_exp_f32 v67, v67
 v_mfma_f32_32x32x16_bf16 v[48:63], a[108:111], a[0:3], v[16:31]
 v_exp_f32 v68, v68
 v_exp_f32 v69, v69
 ds_read_b128 a[124:127], v7 offset:20160
 v_exp_f32 v70, v70
 v_exp_f32 v71, v71
 v_cvt_pk_bf16_f32 v88, v64, v65
 v_cvt_pk_bf16_f32 v89, v66, v67
 v_mfma_f32_32x32x16_bf16 v[48:63], a[144:147], a[12:15], v[48:63]
 v_exp_f32 v72, v72
 v_exp_f32 v73, v73
 ds_read_b128 a[128:131], v7 offset:20768
 s_waitcnt lgkmcnt(3)
 ds_read_b64_tr_b16 v[192:193], v117 offset:0
 ds_read_b64_tr_b16 v[194:195], v117 offset:512
 ds_read_b64_tr_b16 v[196:197], v117 offset:64
 ds_read_b64_tr_b16 v[198:199], v117 offset:576
 v_exp_f32 v74, v74
 v_exp_f32 v75, v75
 v_cvt_pk_bf16_f32 v90, v68, v69
 v_cvt_pk_bf16_f32 v91, v70, v71
 v_mfma_f32_32x32x16_bf16 a[72:87], a[120:123], v[84:87], a[72:87]
 v_exp_f32 v76, v76
 v_exp_f32 v77, v77
 v_exp_f32 v78, v78
 v_exp_f32 v79, v79
 v_cvt_pk_bf16_f32 v92, v72, v73
 v_cvt_pk_bf16_f32 v93, v74, v75
 v_mfma_f32_32x32x16_bf16 a[88:103], a[116:119], v[88:91], a[88:103]
 v_exp_f32 v48, v48
 v_exp_f32 v49, v49
 v_cvt_pk_bf16_f32 v94, v76, v77
 v_cvt_pk_bf16_f32 v95, v78, v79
 v_exp_f32 v50, v50
 v_exp_f32 v51, v51
 v_mfma_f32_32x32x16_bf16 v[64:79], a[108:111], a[4:7], v[32:47]
 v_exp_f32 v52, v52
 v_exp_f32 v53, v53
 ds_read_b128 a[104:107], v3 offset:22016
 v_exp_f32 v54, v54
 v_exp_f32 v55, v55
 v_cvt_pk_bf16_f32 v80, v48, v49
 v_cvt_pk_bf16_f32 v81, v50, v51
 v_mfma_f32_32x32x16_bf16 v[64:79], a[144:147], a[44:47], v[64:79]
 v_exp_f32 v56, v56
 v_exp_f32 v57, v57
 v_exp_f32 v58, v58
 v_exp_f32 v59, v59
 v_cvt_pk_bf16_f32 v82, v52, v53
 v_cvt_pk_bf16_f32 v83, v54, v55
 v_mfma_f32_32x32x16_bf16 a[88:103], a[120:123], v[92:95], a[88:103]
 v_exp_f32 v60, v60
 v_exp_f32 v61, v61
 v_exp_f32 v62, v62
 v_exp_f32 v63, v63
 v_cvt_pk_bf16_f32 v84, v56, v57
 v_cvt_pk_bf16_f32 v85, v58, v59
 s_waitcnt lgkmcnt(5)
 v_mfma_f32_32x32x16_bf16 a[72:87], a[124:127], v[80:83], a[72:87]
 v_exp_f32 v64, v64
 v_exp_f32 v65, v65
 v_cvt_pk_bf16_f32 v86, v60, v61
 v_cvt_pk_bf16_f32 v87, v62, v63
 v_exp_f32 v66, v66
 v_exp_f32 v67, v67
 v_mfma_f32_32x32x16_bf16 v[48:63], a[112:115], a[0:3], v[16:31]
 v_exp_f32 v68, v68
 v_exp_f32 v69, v69
 ds_read_b128 a[132:135], v7 offset:21376
 v_exp_f32 v70, v70
 v_exp_f32 v71, v71
 v_cvt_pk_bf16_f32 v88, v64, v65
 v_cvt_pk_bf16_f32 v89, v66, v67
 v_mfma_f32_32x32x16_bf16 v[48:63], a[144:147], a[16:19], v[48:63]
 v_exp_f32 v72, v72
 v_exp_f32 v73, v73
 ds_read_b128 a[136:139], v7 offset:21984
 s_waitcnt lgkmcnt(3)
 buffer_store_dwordx4 v[192:195], v114, s[4:7], s36 offen sc1
 s_add_u32 s30, s36, s17
 buffer_store_dwordx4 v[196:199], v114, s[4:7], s30 offen sc1
 s_add_u32 s36, s36, s37
 v_exp_f32 v74, v74
 v_exp_f32 v75, v75
 v_cvt_pk_bf16_f32 v90, v68, v69
 v_cvt_pk_bf16_f32 v91, v70, v71
 v_mfma_f32_32x32x16_bf16 a[72:87], a[128:131], v[84:87], a[72:87]
 v_exp_f32 v76, v76
 v_exp_f32 v77, v77
 v_exp_f32 v78, v78
 v_exp_f32 v79, v79
 v_cvt_pk_bf16_f32 v92, v72, v73
 v_cvt_pk_bf16_f32 v93, v74, v75
 v_mfma_f32_32x32x16_bf16 a[88:103], a[124:127], v[88:91], a[88:103]
 v_exp_f32 v48, v48
 v_exp_f32 v49, v49
 v_cvt_pk_bf16_f32 v94, v76, v77
 v_cvt_pk_bf16_f32 v95, v78, v79
 v_exp_f32 v50, v50
 v_exp_f32 v51, v51
 v_mfma_f32_32x32x16_bf16 v[64:79], a[112:115], a[4:7], v[32:47]
 v_exp_f32 v52, v52
 v_exp_f32 v53, v53
 ds_read_b128 a[108:111], v3 offset:23040
 v_exp_f32 v54, v54
 v_exp_f32 v55, v55
 v_cvt_pk_bf16_f32 v80, v48, v49
 v_cvt_pk_bf16_f32 v81, v50, v51
 v_mfma_f32_32x32x16_bf16 v[64:79], a[144:147], a[48:51], v[64:79]
 v_exp_f32 v56, v56
 v_exp_f32 v57, v57
 buffer_store_dwordx4 v[208:211], v1, s[4:7], s86 offen sc1
 s_add_u32 s86, s86, 4096
 v_exp_f32 v58, v58
 v_exp_f32 v59, v59
 v_cvt_pk_bf16_f32 v82, v52, v53
 v_cvt_pk_bf16_f32 v83, v54, v55
 v_mfma_f32_32x32x16_bf16 a[88:103], a[128:131], v[92:95], a[88:103]
 v_exp_f32 v60, v60
 v_exp_f32 v61, v61
 v_exp_f32 v62, v62
 v_exp_f32 v63, v63
 v_cvt_pk_bf16_f32 v84, v56, v57
 v_cvt_pk_bf16_f32 v85, v58, v59
 s_waitcnt lgkmcnt(1)
 v_mfma_f32_32x32x16_bf16 a[72:87], a[132:135], v[80:83], a[72:87]
 v_exp_f32 v64, v64
 v_exp_f32 v65, v65
 v_cvt_pk_bf16_f32 v86, v60, v61
 v_cvt_pk_bf16_f32 v87, v62, v63
 v_exp_f32 v66, v66
 v_exp_f32 v67, v67
 v_mfma_f32_32x32x16_bf16 v[48:63], a[104:107], a[0:3], v[16:31]
 v_exp_f32 v68, v68
 v_exp_f32 v69, v69
 ds_read_b128 a[116:119], v7 offset:22592
 v_exp_f32 v70, v70
 v_exp_f32 v71, v71
 v_cvt_pk_bf16_f32 v88, v64, v65
 v_cvt_pk_bf16_f32 v89, v66, v67
 v_mfma_f32_32x32x16_bf16 v[48:63], a[144:147], a[20:23], v[48:63]
 v_exp_f32 v72, v72
 v_exp_f32 v73, v73
 ds_read_b128 a[120:123], v7 offset:23200
 v_dot2_f32_bf16 v116, v192, s19, v116
 v_dot2_f32_bf16 v116, v193, s19, v116
 v_dot2_f32_bf16 v116, v194, s19, v116
 v_dot2_f32_bf16 v116, v195, s19, v116
 v_dot2_f32_bf16 v118, v196, s19, v118
 v_dot2_f32_bf16 v118, v197, s19, v118
 v_dot2_f32_bf16 v118, v198, s19, v118
 v_dot2_f32_bf16 v118, v199, s19, v118
 v_exp_f32 v74, v74
 v_exp_f32 v75, v75
 v_cvt_pk_bf16_f32 v90, v68, v69
 v_cvt_pk_bf16_f32 v91, v70, v71
 v_mfma_f32_32x32x16_bf16 a[72:87], a[136:139], v[84:87], a[72:87]
 v_exp_f32 v76, v76
 v_exp_f32 v77, v77
 v_exp_f32 v78, v78
 v_exp_f32 v79, v79
 v_cvt_pk_bf16_f32 v92, v72, v73
 v_cvt_pk_bf16_f32 v93, v74, v75
 v_mfma_f32_32x32x16_bf16 a[88:103], a[132:135], v[88:91], a[88:103]
 v_exp_f32 v48, v48
 v_exp_f32 v49, v49
 v_cvt_pk_bf16_f32 v94, v76, v77
 v_cvt_pk_bf16_f32 v95, v78, v79
 v_exp_f32 v50, v50
 v_exp_f32 v51, v51
 v_mfma_f32_32x32x16_bf16 v[64:79], a[104:107], a[4:7], v[32:47]
 v_exp_f32 v52, v52
 v_exp_f32 v53, v53
 ds_read_b128 a[112:115], v3 offset:24064
 v_exp_f32 v54, v54
 v_exp_f32 v55, v55
 v_cvt_pk_bf16_f32 v80, v48, v49
 v_cvt_pk_bf16_f32 v81, v50, v51
 v_mfma_f32_32x32x16_bf16 v[64:79], a[144:147], a[52:55], v[64:79]
 v_exp_f32 v56, v56
 v_exp_f32 v57, v57
 v_exp_f32 v58, v58
 v_exp_f32 v59, v59
 v_cvt_pk_bf16_f32 v82, v52, v53
 v_cvt_pk_bf16_f32 v83, v54, v55
 v_mfma_f32_32x32x16_bf16 a[88:103], a[136:139], v[92:95], a[88:103]
 v_exp_f32 v60, v60
 v_exp_f32 v61, v61
 v_exp_f32 v62, v62
 v_exp_f32 v63, v63
 v_cvt_pk_bf16_f32 v84, v56, v57
 v_cvt_pk_bf16_f32 v85, v58, v59
 s_waitcnt lgkmcnt(1)
 v_mfma_f32_32x32x16_bf16 a[72:87], a[116:119], v[80:83], a[72:87]
 v_exp_f32 v64, v64
 v_exp_f32 v65, v65
 v_cvt_pk_bf16_f32 v86, v60, v61
 v_cvt_pk_bf16_f32 v87, v62, v63
 v_exp_f32 v66, v66
 v_exp_f32 v67, v67
 v_mfma_f32_32x32x16_bf16 v[48:63], a[108:111], a[0:3], v[16:31]
 v_exp_f32 v68, v68
 v_exp_f32 v69, v69
 ds_read_b128 a[124:127], v7 offset:23808
 v_exp_f32 v70, v70
 v_exp_f32 v71, v71
 v_cvt_pk_bf16_f32 v88, v64, v65
 v_cvt_pk_bf16_f32 v89, v66, v67
 v_mfma_f32_32x32x16_bf16 v[48:63], a[144:147], a[24:27], v[48:63]
 v_exp_f32 v72, v72
 v_exp_f32 v73, v73
 ds_read_b128 a[128:131], v7 offset:24416
 v_exp_f32 v74, v74
 v_exp_f32 v75, v75
 v_cvt_pk_bf16_f32 v90, v68, v69
 v_cvt_pk_bf16_f32 v91, v70, v71
 v_mfma_f32_32x32x16_bf16 a[72:87], a[120:123], v[84:87], a[72:87]
 v_exp_f32 v76, v76
 v_exp_f32 v77, v77
 v_exp_f32 v78, v78
 v_exp_f32 v79, v79
 v_cvt_pk_bf16_f32 v92, v72, v73
 v_cvt_pk_bf16_f32 v93, v74, v75
 v_mfma_f32_32x32x16_bf16 a[88:103], a[116:119], v[88:91], a[88:103]
 v_exp_f32 v48, v48
 v_exp_f32 v49, v49
 v_cvt_pk_bf16_f32 v94, v76, v77
 v_cvt_pk_bf16_f32 v95, v78, v79
 v_exp_f32 v50, v50
 v_exp_f32 v51, v51
 v_mfma_f32_32x32x16_bf16 v[64:79], a[108:111], a[4:7], v[32:47]
 v_exp_f32 v52, v52
 v_exp_f32 v53, v53
 ds_read_b128 a[104:107], v3 offset:25088
 v_exp_f32 v54, v54
 v_exp_f32 v55, v55
 v_cvt_pk_bf16_f32 v80, v48, v49
 v_cvt_pk_bf16_f32 v81, v50, v51
 v_mfma_f32_32x32x16_bf16 v[64:79], a[144:147], a[56:59], v[64:79]
 v_exp_f32 v56, v56
 v_exp_f32 v57, v57
 buffer_store_dwordx4 v[208:211], v1, s[4:7], s86 offen sc1
 s_add_u32 s86, s86, 4096
 v_exp_f32 v58, v58
 v_exp_f32 v59, v59
 v_cvt_pk_bf16_f32 v82, v52, v53
 v_cvt_pk_bf16_f32 v83, v54, v55
 v_mfma_f32_32x32x16_bf16 a[88:103], a[120:123], v[92:95], a[88:103]
 v_exp_f32 v60, v60
 v_exp_f32 v61, v61
 v_exp_f32 v62, v62
 v_exp_f32 v63, v63
 v_cvt_pk_bf16_f32 v84, v56, v57
 v_cvt_pk_bf16_f32 v85, v58, v59
 s_waitcnt lgkmcnt(1)
 v_mfma_f32_32x32x16_bf16 a[72:87], a[124:127], v[80:83], a[72:87]
 v_exp_f32 v64, v64
 v_exp_f32 v65, v65
 v_cvt_pk_bf16_f32 v86, v60, v61
 v_cvt_pk_bf16_f32 v87, v62, v63
 v_exp_f32 v66, v66
 v_exp_f32 v67, v67
 v_mfma_f32_32x32x16_bf16 v[48:63], a[112:115], a[0:3], v[16:31]
 v_exp_f32 v68, v68
 v_exp_f32 v69, v69
 ds_read_b128 a[132:135], v7 offset:25024
 v_exp_f32 v70, v70
 v_exp_f32 v71, v71
 v_cvt_pk_bf16_f32 v88, v64, v65
 v_cvt_pk_bf16_f32 v89, v66, v67
 v_mfma_f32_32x32x16_bf16 v[48:63], a[144:147], a[28:31], v[48:63]
 v_exp_f32 v72, v72
 v_exp_f32 v73, v73
 ds_read_b128 a[136:139], v7 offset:25632
 buffer_load_dwordx4 v[160:163], v112, s[12:15], s34 offen
 buffer_load_dwordx4 v[164:167], v113, s[12:15], s34 offen
 s_add_u32 s34, s34, s35
 s_waitcnt vmcnt(13)
 ds_write_b128 v115, v[144:147]
 ds_write_b128 v115, v[148:151] offset:1024
 v_exp_f32 v74, v74
 v_exp_f32 v75, v75
 v_cvt_pk_bf16_f32 v90, v68, v69
 v_cvt_pk_bf16_f32 v91, v70, v71
 v_mfma_f32_32x32x16_bf16 a[72:87], a[128:131], v[84:87], a[72:87]
 v_exp_f32 v76, v76
 v_exp_f32 v77, v77
 v_exp_f32 v78, v78
 v_exp_f32 v79, v79
 v_cvt_pk_bf16_f32 v92, v72, v73
 v_cvt_pk_bf16_f32 v93, v74, v75
 v_mfma_f32_32x32x16_bf16 a[88:103], a[124:127], v[88:91], a[88:103]
 v_exp_f32 v48, v48
 v_exp_f32 v49, v49
 v_cvt_pk_bf16_f32 v94, v76, v77
 v_cvt_pk_bf16_f32 v95, v78, v79
 v_exp_f32 v50, v50
 v_exp_f32 v51, v51
 v_mfma_f32_32x32x16_bf16 v[64:79], a[112:115], a[4:7], v[32:47]
 v_exp_f32 v52, v52
 v_exp_f32 v53, v53
 ds_read_b128 a[108:111], v3 offset:26112
 v_exp_f32 v54, v54
 v_exp_f32 v55, v55
 v_cvt_pk_bf16_f32 v80, v48, v49
 v_cvt_pk_bf16_f32 v81, v50, v51
 v_mfma_f32_32x32x16_bf16 v[64:79], a[144:147], a[60:63], v[64:79]
 v_exp_f32 v56, v56
 v_exp_f32 v57, v57
 v_exp_f32 v58, v58
 v_exp_f32 v59, v59
 v_cvt_pk_bf16_f32 v82, v52, v53
 v_cvt_pk_bf16_f32 v83, v54, v55
 v_mfma_f32_32x32x16_bf16 a[88:103], a[128:131], v[92:95], a[88:103]
 v_exp_f32 v60, v60
 v_exp_f32 v61, v61
 v_exp_f32 v62, v62
 v_exp_f32 v63, v63
 v_cvt_pk_bf16_f32 v84, v56, v57
 v_cvt_pk_bf16_f32 v85, v58, v59
 s_waitcnt lgkmcnt(3)
 v_mfma_f32_32x32x16_bf16 a[72:87], a[132:135], v[80:83], a[72:87]
 v_exp_f32 v64, v64
 v_exp_f32 v65, v65
 v_cvt_pk_bf16_f32 v86, v60, v61
 v_cvt_pk_bf16_f32 v87, v62, v63
 v_exp_f32 v66, v66
 v_exp_f32 v67, v67
 v_mfma_f32_32x32x16_bf16 v[48:63], a[104:107], a[0:3], v[16:31]
 v_exp_f32 v68, v68
 v_exp_f32 v69, v69
 ds_read_b128 a[116:119], v7 offset:26240
 v_exp_f32 v70, v70
 v_exp_f32 v71, v71
 v_cvt_pk_bf16_f32 v88, v64, v65
 v_cvt_pk_bf16_f32 v89, v66, v67
 v_mfma_f32_32x32x16_bf16 v[48:63], a[144:147], a[32:35], v[48:63]
 v_exp_f32 v72, v72
 v_exp_f32 v73, v73
 ds_read_b128 a[120:123], v7 offset:26848
 s_waitcnt lgkmcnt(3)
 ds_read_b64_tr_b16 v[192:193], v117 offset:0
 ds_read_b64_tr_b16 v[194:195], v117 offset:512
 ds_read_b64_tr_b16 v[196:197], v117 offset:64
 ds_read_b64_tr_b16 v[198:199], v117 offset:576
 v_exp_f32 v74, v74
 v_exp_f32 v75, v75
 v_cvt_pk_bf16_f32 v90, v68, v69
 v_cvt_pk_bf16_f32 v91, v70, v71
 v_mfma_f32_32x32x16_bf16 a[72:87], a[136:139], v[84:87], a[72:87]
 v_exp_f32 v76, v76
 v_exp_f32 v77, v77
 v_exp_f32 v78, v78
 v_exp_f32 v79, v79
 v_cvt_pk_bf16_f32 v92, v72, v73
 v_cvt_pk_bf16_f32 v93, v74, v75
 v_mfma_f32_32x32x16_bf16 a[88:103], a[132:135], v[88:91], a[88:103]
 v_exp_f32 v48, v48
 v_exp_f32 v49, v49
 v_cvt_pk_bf16_f32 v94, v76, v77
 v_cvt_pk_bf16_f32 v95, v78, v79
 v_exp_f32 v50, v50
 v_exp_f32 v51, v51
 v_mfma_f32_32x32x16_bf16 v[64:79], a[104:107], a[4:7], v[32:47]
 v_exp_f32 v52, v52
 v_exp_f32 v53, v53
 ds_read_b128 a[112:115], v4 offset:0
 ds_read_b128 a[140:143], v4 offset:8192
 v_exp_f32 v54, v54
 v_exp_f32 v55, v55
 v_cvt_pk_bf16_f32 v80, v48, v49
 v_cvt_pk_bf16_f32 v81, v50, v51
 v_mfma_f32_32x32x16_bf16 v[64:79], a[144:147], a[64:67], v[64:79]
 v_exp_f32 v56, v56
 v_exp_f32 v57, v57
 buffer_store_dwordx4 v[208:211], v1, s[4:7], s86 offen sc1
 s_add_u32 s86, s86, 4096
 v_exp_f32 v58, v58
 v_exp_f32 v59, v59
 v_cvt_pk_bf16_f32 v82, v52, v53
 v_cvt_pk_bf16_f32 v83, v54, v55
 v_mfma_f32_32x32x16_bf16 a[88:103], a[136:139], v[92:95], a[88:103]
 v_exp_f32 v60, v60
 v_exp_f32 v61, v61
 v_exp_f32 v62, v62
 v_exp_f32 v63, v63
 v_cvt_pk_bf16_f32 v84, v56, v57
 v_cvt_pk_bf16_f32 v85, v58, v59
 s_waitcnt lgkmcnt(6)
 v_mfma_f32_32x32x16_bf16 a[72:87], a[116:119], v[80:83], a[72:87]
 v_exp_f32 v64, v64
 v_exp_f32 v65, v65
 v_cvt_pk_bf16_f32 v86, v60, v61
 v_cvt_pk_bf16_f32 v87, v62, v63
 v_exp_f32 v66, v66
 v_exp_f32 v67, v67
 v_mfma_f32_32x32x16_bf16 v[48:63], a[108:111], a[0:3], v[16:31]
 v_exp_f32 v68, v68
 v_exp_f32 v69, v69
 ds_read_b128 a[124:127], v7 offset:27456
 v_exp_f32 v70, v70
 v_exp_f32 v71, v71
 v_cvt_pk_bf16_f32 v88, v64, v65
 v_cvt_pk_bf16_f32 v89, v66, v67
 v_mfma_f32_32x32x16_bf16 v[48:63], a[144:147], a[36:39], v[48:63]
 v_exp_f32 v72, v72
 v_exp_f32 v73, v73
 ds_read_b128 a[128:131], v7 offset:28064
 s_waitcnt lgkmcnt(4)
 buffer_store_dwordx4 v[192:195], v114, s[4:7], s36 offen sc1
 s_add_u32 s30, s36, s17
 buffer_store_dwordx4 v[196:199], v114, s[4:7], s30 offen sc1
 s_add_u32 s36, s36, s37
 v_exp_f32 v74, v74
 v_exp_f32 v75, v75
 v_cvt_pk_bf16_f32 v90, v68, v69
 v_cvt_pk_bf16_f32 v91, v70, v71
 v_mfma_f32_32x32x16_bf16 a[72:87], a[120:123], v[84:87], a[72:87]
 v_exp_f32 v76, v76
 v_exp_f32 v77, v77
 v_exp_f32 v78, v78
 v_exp_f32 v79, v79
 v_cvt_pk_bf16_f32 v92, v72, v73
 v_cvt_pk_bf16_f32 v93, v74, v75
 v_mfma_f32_32x32x16_bf16 a[88:103], a[116:119], v[88:91], a[88:103]
 v_exp_f32 v48, v48
 v_exp_f32 v49, v49
 v_cvt_pk_bf16_f32 v94, v76, v77
 v_cvt_pk_bf16_f32 v95, v78, v79
 v_exp_f32 v50, v50
 v_exp_f32 v51, v51
 v_mfma_f32_32x32x16_bf16 v[64:79], a[108:111], a[4:7], v[32:47]
 v_exp_f32 v52, v52
 v_exp_f32 v53, v53
 ds_read_b128 a[104:107], v4 offset:1024
 v_exp_f32 v54, v54
 v_exp_f32 v55, v55
 v_cvt_pk_bf16_f32 v80, v48, v49
 v_cvt_pk_bf16_f32 v81, v50, v51
 v_mfma_f32_32x32x16_bf16 v[64:79], a[144:147], a[68:71], v[64:79]
 v_exp_f32 v56, v56
 v_exp_f32 v57, v57
 v_exp_f32 v58, v58
 v_exp_f32 v59, v59
 v_cvt_pk_bf16_f32 v82, v52, v53
 v_cvt_pk_bf16_f32 v83, v54, v55
 v_mfma_f32_32x32x16_bf16 a[88:103], a[120:123], v[92:95], a[88:103]
 v_exp_f32 v60, v60
 v_exp_f32 v61, v61
 v_exp_f32 v62, v62
 v_exp_f32 v63, v63
 v_cvt_pk_bf16_f32 v84, v56, v57
 v_cvt_pk_bf16_f32 v85, v58, v59
 s_waitcnt lgkmcnt(1)
 v_mfma_f32_32x32x16_bf16 a[72:87], a[124:127], v[80:83], a[72:87]
 v_exp_f32 v64, v64
 v_exp_f32 v65, v65
 v_cvt_pk_bf16_f32 v86, v60, v61
 v_cvt_pk_bf16_f32 v87, v62, v63
 v_exp_f32 v66, v66
 v_exp_f32 v67, v67
 v_mfma_f32_32x32x16_bf16 v[48:63], a[112:115], a[0:3], v[16:31]
 v_exp_f32 v68, v68
 v_exp_f32 v69, v69
 ds_read_b128 a[132:135], v8 offset:0
 v_exp_f32 v70, v70
 v_exp_f32 v71, v71
 v_cvt_pk_bf16_f32 v88, v64, v65
 v_cvt_pk_bf16_f32 v89, v66, v67
 v_mfma_f32_32x32x16_bf16 v[48:63], a[140:143], a[8:11], v[48:63]
 v_exp_f32 v72, v72
 v_exp_f32 v73, v73
 ds_read_b128 a[136:139], v8 offset:608
 v_dot2_f32_bf16 v116, v192, s19, v116
 v_dot2_f32_bf16 v116, v193, s19, v116
 v_dot2_f32_bf16 v116, v194, s19, v116
 v_dot2_f32_bf16 v116, v195, s19, v116
 v_dot2_f32_bf16 v118, v196, s19, v118
 v_dot2_f32_bf16 v118, v197, s19, v118
 v_dot2_f32_bf16 v118, v198, s19, v118
 v_dot2_f32_bf16 v118, v199, s19, v118
 v_exp_f32 v74, v74
 v_exp_f32 v75, v75
 v_cvt_pk_bf16_f32 v90, v68, v69
 v_cvt_pk_bf16_f32 v91, v70, v71
 v_mfma_f32_32x32x16_bf16 a[72:87], a[128:131], v[84:87], a[72:87]
 v_exp_f32 v76, v76
 v_exp_f32 v77, v77
 v_exp_f32 v78, v78
 v_exp_f32 v79, v79
 v_cvt_pk_bf16_f32 v92, v72, v73
 v_cvt_pk_bf16_f32 v93, v74, v75
 v_mfma_f32_32x32x16_bf16 a[88:103], a[124:127], v[88:91], a[88:103]
 v_exp_f32 v48, v48
 v_exp_f32 v49, v49
 v_cvt_pk_bf16_f32 v94, v76, v77
 v_cvt_pk_bf16_f32 v95, v78, v79
 v_exp_f32 v50, v50
 v_exp_f32 v51, v51
 v_mfma_f32_32x32x16_bf16 v[64:79], a[112:115], a[4:7], v[32:47]
 v_exp_f32 v52, v52
 v_exp_f32 v53, v53
 ds_read_b128 a[108:111], v4 offset:2048
 v_exp_f32 v54, v54
 v_exp_f32 v55, v55
 v_cvt_pk_bf16_f32 v80, v48, v49
 v_cvt_pk_bf16_f32 v81, v50, v51
 v_mfma_f32_32x32x16_bf16 v[64:79], a[140:143], a[40:43], v[64:79]
 v_exp_f32 v56, v56
 v_exp_f32 v57, v57
 buffer_store_dwordx4 v[208:211], v1, s[4:7], s86 offen sc1
 s_add_u32 s86, s86, 4096
 v_exp_f32 v58, v58
 v_exp_f32 v59, v59
 v_cvt_pk_bf16_f32 v82, v52, v53
 v_cvt_pk_bf16_f32 v83, v54, v55
 v_mfma_f32_32x32x16_bf16 a[88:103], a[128:131], v[92:95], a[88:103]
 v_exp_f32 v60, v60
 v_exp_f32 v61, v61
 v_exp_f32 v62, v62
 v_exp_f32 v63, v63
 v_cvt_pk_bf16_f32 v84, v56, v57
 v_cvt_pk_bf16_f32 v85, v58, v59
 s_waitcnt lgkmcnt(1)
 v_mfma_f32_32x32x16_bf16 a[72:87], a[132:135], v[80:83], a[72:87]
 v_exp_f32 v64, v64
 v_exp_f32 v65, v65
 v_cvt_pk_bf16_f32 v86, v60, v61
 v_cvt_pk_bf16_f32 v87, v62, v63
 v_exp_f32 v66, v66
 v_exp_f32 v67, v67
 v_mfma_f32_32x32x16_bf16 v[48:63], a[104:107], a[0:3], v[16:31]
 v_exp_f32 v68, v68
 v_exp_f32 v69, v69
 ds_read_b128 a[116:119], v8 offset:1216
 v_exp_f32 v70, v70
 v_exp_f32 v71, v71
 v_cvt_pk_bf16_f32 v88, v64, v65
 v_cvt_pk_bf16_f32 v89, v66, v67
 v_mfma_f32_32x32x16_bf16 v[48:63], a[140:143], a[12:15], v[48:63]
 v_exp_f32 v72, v72
 v_exp_f32 v73, v73
 ds_read_b128 a[120:123], v8 offset:1824
 v_exp_f32 v74, v74
 v_exp_f32 v75, v75
 v_cvt_pk_bf16_f32 v90, v68, v69
 v_cvt_pk_bf16_f32 v91, v70, v71
 v_mfma_f32_32x32x16_bf16 a[72:87], a[136:139], v[84:87], a[72:87]
 v_exp_f32 v76, v76
 v_exp_f32 v77, v77
 v_exp_f32 v78, v78
 v_exp_f32 v79, v79
 v_cvt_pk_bf16_f32 v92, v72, v73
 v_cvt_pk_bf16_f32 v93, v74, v75
 v_mfma_f32_32x32x16_bf16 a[88:103], a[132:135], v[88:91], a[88:103]
 v_exp_f32 v48, v48
 v_exp_f32 v49, v49
 v_cvt_pk_bf16_f32 v94, v76, v77
 v_cvt_pk_bf16_f32 v95, v78, v79
 v_exp_f32 v50, v50
 v_exp_f32 v51, v51
 v_mfma_f32_32x32x16_bf16 v[64:79], a[104:107], a[4:7], v[32:47]
 v_exp_f32 v52, v52
 v_exp_f32 v53, v53
 ds_read_b128 a[112:115], v4 offset:3072
 v_exp_f32 v54, v54
 v_exp_f32 v55, v55
 v_cvt_pk_bf16_f32 v80, v48, v49
 v_cvt_pk_bf16_f32 v81, v50, v51
 v_mfma_f32_32x32x16_bf16 v[64:79], a[140:143], a[44:47], v[64:79]
 v_exp_f32 v56, v56
 v_exp_f32 v57, v57
 v_exp_f32 v58, v58
 v_exp_f32 v59, v59
 v_cvt_pk_bf16_f32 v82, v52, v53
 v_cvt_pk_bf16_f32 v83, v54, v55
 v_mfma_f32_32x32x16_bf16 a[88:103], a[136:139], v[92:95], a[88:103]
 v_exp_f32 v60, v60
 v_exp_f32 v61, v61
 v_exp_f32 v62, v62
 v_exp_f32 v63, v63
 v_cvt_pk_bf16_f32 v84, v56, v57
 v_cvt_pk_bf16_f32 v85, v58, v59
 s_waitcnt lgkmcnt(1)
 v_mfma_f32_32x32x16_bf16 a[72:87], a[116:119], v[80:83], a[72:87]
 v_exp_f32 v64, v64
 v_exp_f32 v65, v65
 v_cvt_pk_bf16_f32 v86, v60, v61
 v_cvt_pk_bf16_f32 v87, v62, v63
 v_exp_f32 v66, v66
 v_exp_f32 v67, v67
 v_mfma_f32_32x32x16_bf16 v[48:63], a[108:111], a[0:3], v[16:31]
 v_exp_f32 v68, v68
 v_exp_f32 v69, v69
 ds_read_b128 a[124:127], v8 offset:2432
 v_exp_f32 v70, v70
 v_exp_f32 v71, v71
 v_cvt_pk_bf16_f32 v88, v64, v65
 v_cvt_pk_bf16_f32 v89, v66, v67
 v_mfma_f32_32x32x16_bf16 v[48:63], a[140:143], a[16:19], v[48:63]
 v_exp_f32 v72, v72
 v_exp_f32 v73, v73
 ds_read_b128 a[128:131], v8 offset:3040
 buffer_load_dwordx4 v[168:171], v112, s[12:15], s34 offen
 buffer_load_dwordx4 v[172:175], v113, s[12:15], s34 offen
 s_add_u32 s34, s34, s35
 s_waitcnt vmcnt(13)
 ds_write_b128 v115, v[152:155]
 ds_write_b128 v115, v[156:159] offset:1024
 v_exp_f32 v74, v74
 v_exp_f32 v75, v75
 v_cvt_pk_bf16_f32 v90, v68, v69
 v_cvt_pk_bf16_f32 v91, v70, v71
 v_mfma_f32_32x32x16_bf16 a[72:87], a[120:123], v[84:87], a[72:87]
 v_exp_f32 v76, v76
 v_exp_f32 v77, v77
 v_exp_f32 v78, v78
 v_exp_f32 v79, v79
 v_cvt_pk_bf16_f32 v92, v72, v73
 v_cvt_pk_bf16_f32 v93, v74, v75
 v_mfma_f32_32x32x16_bf16 a[88:103], a[116:119], v[88:91], a[88:103]
 v_exp_f32 v48, v48
 v_exp_f32 v49, v49
 v_cvt_pk_bf16_f32 v94, v76, v77
 v_cvt_pk_bf16_f32 v95, v78, v79
 v_exp_f32 v50, v50
 v_exp_f32 v51, v51
 v_mfma_f32_32x32x16_bf16 v[64:79], a[108:111], a[4:7], v[32:47]
 v_exp_f32 v52, v52
 v_exp_f32 v53, v53
 ds_read_b128 a[104:107], v4 offset:4096
 v_exp_f32 v54, v54
 v_exp_f32 v55, v55
 v_cvt_pk_bf16_f32 v80, v48, v49
 v_cvt_pk_bf16_f32 v81, v50, v51
 v_mfma_f32_32x32x16_bf16 v[64:79], a[140:143], a[48:51], v[64:79]
 v_exp_f32 v56, v56
 v_exp_f32 v57, v57
 buffer_store_dwordx4 v[208:211], v1, s[4:7], s86 offen sc1
 s_add_u32 s86, s86, 4096
 v_exp_f32 v58, v58
 v_exp_f32 v59, v59
 v_cvt_pk_bf16_f32 v82, v52, v53
 v_cvt_pk_bf16_f32 v83, v54, v55
 v_mfma_f32_32x32x16_bf16 a[88:103], a[120:123], v[92:95], a[88:103]
 v_exp_f32 v60, v60
 v_exp_f32 v61, v61
 v_exp_f32 v62, v62
 v_exp_f32 v63, v63
 v_cvt_pk_bf16_f32 v84, v56, v57
 v_cvt_pk_bf16_f32 v85, v58, v59
 s_waitcnt lgkmcnt(3)
 v_mfma_f32_32x32x16_bf16 a[72:87], a[124:127], v[80:83], a[72:87]
 v_exp_f32 v64, v64
 v_exp_f32 v65, v65
 v_cvt_pk_bf16_f32 v86, v60, v61
 v_cvt_pk_bf16_f32 v87, v62, v63
 v_exp_f32 v66, v66
 v_exp_f32 v67, v67
 v_mfma_f32_32x32x16_bf16 v[48:63], a[112:115], a[0:3], v[16:31]
 v_exp_f32 v68, v68
 v_exp_f32 v69, v69
 ds_read_b128 a[132:135], v8 offset:3648
 v_exp_f32 v70, v70
 v_exp_f32 v71, v71
 v_cvt_pk_bf16_f32 v88, v64, v65
 v_cvt_pk_bf16_f32 v89, v66, v67
 v_mfma_f32_32x32x16_bf16 v[48:63], a[140:143], a[20:23], v[48:63]
 v_exp_f32 v72, v72
 v_exp_f32 v73, v73
 ds_read_b128 a[136:139], v8 offset:4256
 s_waitcnt lgkmcnt(3)
 ds_read_b64_tr_b16 v[192:193], v117 offset:0
 ds_read_b64_tr_b16 v[194:195], v117 offset:512
 ds_read_b64_tr_b16 v[196:197], v117 offset:64
 ds_read_b64_tr_b16 v[198:199], v117 offset:576
 v_exp_f32 v74, v74
 v_exp_f32 v75, v75
 v_cvt_pk_bf16_f32 v90, v68, v69
 v_cvt_pk_bf16_f32 v91, v70, v71
 v_mfma_f32_32x32x16_bf16 a[72:87], a[128:131], v[84:87], a[72:87]
 v_exp_f32 v76, v76
 v_exp_f32 v77, v77
 v_exp_f32 v78, v78
 v_exp_f32 v79, v79
 v_cvt_pk_bf16_f32 v92, v72, v73
 v_cvt_pk_bf16_f32 v93, v74, v75
 v_mfma_f32_32x32x16_bf16 a[88:103], a[124:127], v[88:91], a[88:103]
 v_exp_f32 v48, v48
 v_exp_f32 v49, v49
 v_cvt_pk_bf16_f32 v94, v76, v77
 v_cvt_pk_bf16_f32 v95, v78, v79
 v_exp_f32 v50, v50
 v_exp_f32 v51, v51
 v_mfma_f32_32x32x16_bf16 v[64:79], a[112:115], a[4:7], v[32:47]
 v_exp_f32 v52, v52
 v_exp_f32 v53, v53
 ds_read_b128 a[108:111], v4 offset:5120
 v_exp_f32 v54, v54
 v_exp_f32 v55, v55
 v_cvt_pk_bf16_f32 v80, v48, v49
 v_cvt_pk_bf16_f32 v81, v50, v51
 v_mfma_f32_32x32x16_bf16 v[64:79], a[140:143], a[52:55], v[64:79]
 v_exp_f32 v56, v56
 v_exp_f32 v57, v57
 v_exp_f32 v58, v58
 v_exp_f32 v59, v59
 v_cvt_pk_bf16_f32 v82, v52, v53
 v_cvt_pk_bf16_f32 v83, v54, v55
 v_mfma_f32_32x32x16_bf16 a[88:103], a[128:131], v[92:95], a[88:103]
 v_exp_f32 v60, v60
 v_exp_f32 v61, v61
 v_exp_f32 v62, v62
 v_exp_f32 v63, v63
 v_cvt_pk_bf16_f32 v84, v56, v57
 v_cvt_pk_bf16_f32 v85, v58, v59
 s_waitcnt lgkmcnt(5)
 v_mfma_f32_32x32x16_bf16 a[72:87], a[132:135], v[80:83], a[72:87]
 v_exp_f32 v64, v64
 v_exp_f32 v65, v65
 v_cvt_pk_bf16_f32 v86, v60, v61
 v_cvt_pk_bf16_f32 v87, v62, v63
 v_exp_f32 v66, v66
 v_exp_f32 v67, v67
 v_mfma_f32_32x32x16_bf16 v[48:63], a[104:107], a[0:3], v[16:31]
 v_exp_f32 v68, v68
 v_exp_f32 v69, v69
 ds_read_b128 a[116:119], v8 offset:4864
 v_exp_f32 v70, v70
 v_exp_f32 v71, v71
 v_cvt_pk_bf16_f32 v88, v64, v65
 v_cvt_pk_bf16_f32 v89, v66, v67
 v_mfma_f32_32x32x16_bf16 v[48:63], a[140:143], a[24:27], v[48:63]
 v_exp_f32 v72, v72
 v_exp_f32 v73, v73
 ds_read_b128 a[120:123], v8 offset:5472
 s_waitcnt lgkmcnt(3)
 buffer_store_dwordx4 v[192:195], v114, s[4:7], s36 offen sc1
 s_add_u32 s30, s36, s17
 buffer_store_dwordx4 v[196:199], v114, s[4:7], s30 offen sc1
 s_add_u32 s36, s36, s37
 v_exp_f32 v74, v74
 v_exp_f32 v75, v75
 v_cvt_pk_bf16_f32 v90, v68, v69
 v_cvt_pk_bf16_f32 v91, v70, v71
 v_mfma_f32_32x32x16_bf16 a[72:87], a[136:139], v[84:87], a[72:87]
 v_exp_f32 v76, v76
 v_exp_f32 v77, v77
 v_exp_f32 v78, v78
 v_exp_f32 v79, v79
 v_cvt_pk_bf16_f32 v92, v72, v73
 v_cvt_pk_bf16_f32 v93, v74, v75
 v_mfma_f32_32x32x16_bf16 a[88:103], a[132:135], v[88:91], a[88:103]
 v_exp_f32 v48, v48
 v_exp_f32 v49, v49
 v_cvt_pk_bf16_f32 v94, v76, v77
 v_cvt_pk_bf16_f32 v95, v78, v79
 v_exp_f32 v50, v50
 v_exp_f32 v51, v51
 v_mfma_f32_32x32x16_bf16 v[64:79], a[104:107], a[4:7], v[32:47]
 v_exp_f32 v52, v52
 v_exp_f32 v53, v53
 ds_read_b128 a[112:115], v4 offset:6144
 v_exp_f32 v54, v54
 v_exp_f32 v55, v55
 v_cvt_pk_bf16_f32 v80, v48, v49
 v_cvt_pk_bf16_f32 v81, v50, v51
 v_mfma_f32_32x32x16_bf16 v[64:79], a[140:143], a[56:59], v[64:79]
 v_exp_f32 v56, v56
 v_exp_f32 v57, v57
 buffer_store_dwordx4 v[208:211], v1, s[4:7], s86 offen sc1
 s_add_u32 s86, s86, 4096
 v_exp_f32 v58, v58
 v_exp_f32 v59, v59
 v_cvt_pk_bf16_f32 v82, v52, v53
 v_cvt_pk_bf16_f32 v83, v54, v55
 v_mfma_f32_32x32x16_bf16 a[88:103], a[136:139], v[92:95], a[88:103]
 v_exp_f32 v60, v60
 v_exp_f32 v61, v61
 v_exp_f32 v62, v62
 v_exp_f32 v63, v63
 v_cvt_pk_bf16_f32 v84, v56, v57
 v_cvt_pk_bf16_f32 v85, v58, v59
 s_waitcnt lgkmcnt(1)
 v_mfma_f32_32x32x16_bf16 a[72:87], a[116:119], v[80:83], a[72:87]
 v_exp_f32 v64, v64
 v_exp_f32 v65, v65
 v_cvt_pk_bf16_f32 v86, v60, v61
 v_cvt_pk_bf16_f32 v87, v62, v63
 v_exp_f32 v66, v66
 v_exp_f32 v67, v67
 v_mfma_f32_32x32x16_bf16 v[48:63], a[108:111], a[0:3], v[16:31]
 v_exp_f32 v68, v68
 v_exp_f32 v69, v69
 ds_read_b128 a[124:127], v8 offset:6080
 v_exp_f32 v70, v70
 v_exp_f32 v71, v71
 v_cvt_pk_bf16_f32 v88, v64, v65
 v_cvt_pk_bf16_f32 v89, v66, v67
 v_mfma_f32_32x32x16_bf16 v[48:63], a[140:143], a[28:31], v[48:63]
 v_exp_f32 v72, v72
 v_exp_f32 v73, v73
 ds_read_b128 a[128:131], v8 offset:6688
 v_dot2_f32_bf16 v116, v192, s19, v116
 v_dot2_f32_bf16 v116, v193, s19, v116
 v_dot2_f32_bf16 v116, v194, s19, v116
 v_dot2_f32_bf16 v116, v195, s19, v116
 v_dot2_f32_bf16 v118, v196, s19, v118
 v_dot2_f32_bf16 v118, v197, s19, v118
 v_dot2_f32_bf16 v118, v198, s19, v118
 v_dot2_f32_bf16 v118, v199, s19, v118
 v_exp_f32 v74, v74
 v_exp_f32 v75, v75
 v_cvt_pk_bf16_f32 v90, v68, v69
 v_cvt_pk_bf16_f32 v91, v70, v71
 v_mfma_f32_32x32x16_bf16 a[72:87], a[120:123], v[84:87], a[72:87]
 v_exp_f32 v76, v76
 v_exp_f32 v77, v77
 v_exp_f32 v78, v78
 v_exp_f32 v79, v79
 v_cvt_pk_bf16_f32 v92, v72, v73
 v_cvt_pk_bf16_f32 v93, v74, v75
 v_mfma_f32_32x32x16_bf16 a[88:103], a[116:119], v[88:91], a[88:103]
 v_exp_f32 v48, v48
 v_exp_f32 v49, v49
 v_cvt_pk_bf16_f32 v94, v76, v77
 v_cvt_pk_bf16_f32 v95, v78, v79
 v_exp_f32 v50, v50
 v_exp_f32 v51, v51
 v_mfma_f32_32x32x16_bf16 v[64:79], a[108:111], a[4:7], v[32:47]
 v_exp_f32 v52, v52
 v_exp_f32 v53, v53
 ds_read_b128 a[104:107], v4 offset:7168
 v_exp_f32 v54, v54
 v_exp_f32 v55, v55
 v_cvt_pk_bf16_f32 v80, v48, v49
 v_cvt_pk_bf16_f32 v81, v50, v51
 v_mfma_f32_32x32x16_bf16 v[64:79], a[140:143], a[60:63], v[64:79]
 v_exp_f32 v56, v56
 v_exp_f32 v57, v57
 v_exp_f32 v58, v58
 v_exp_f32 v59, v59
 v_cvt_pk_bf16_f32 v82, v52, v53
 v_cvt_pk_bf16_f32 v83, v54, v55
 v_mfma_f32_32x32x16_bf16 a[88:103], a[120:123], v[92:95], a[88:103]
 v_exp_f32 v60, v60
 v_exp_f32 v61, v61
 v_exp_f32 v62, v62
 v_exp_f32 v63, v63
 v_cvt_pk_bf16_f32 v84, v56, v57
 v_cvt_pk_bf16_f32 v85, v58, v59
 s_waitcnt lgkmcnt(1)
 v_mfma_f32_32x32x16_bf16 a[72:87], a[124:127], v[80:83], a[72:87]
 v_exp_f32 v64, v64
 v_exp_f32 v65, v65
 v_cvt_pk_bf16_f32 v86, v60, v61
 v_cvt_pk_bf16_f32 v87, v62, v63
 v_exp_f32 v66, v66
 v_exp_f32 v67, v67
 v_mfma_f32_32x32x16_bf16 v[48:63], a[112:115], a[0:3], v[16:31]
 v_exp_f32 v68, v68
 v_exp_f32 v69, v69
 ds_read_b128 a[132:135], v8 offset:7296
 v_exp_f32 v70, v70
 v_exp_f32 v71, v71
 v_cvt_pk_bf16_f32 v88, v64, v65
 v_cvt_pk_bf16_f32 v89, v66, v67
 v_mfma_f32_32x32x16_bf16 v[48:63], a[140:143], a[32:35], v[48:63]
 v_exp_f32 v72, v72
 v_exp_f32 v73, v73
 ds_read_b128 a[136:139], v8 offset:7904
 v_exp_f32 v74, v74
 v_exp_f32 v75, v75
 v_cvt_pk_bf16_f32 v90, v68, v69
 v_cvt_pk_bf16_f32 v91, v70, v71
 v_mfma_f32_32x32x16_bf16 a[72:87], a[128:131], v[84:87], a[72:87]
 v_exp_f32 v76, v76
 v_exp_f32 v77, v77
 v_exp_f32 v78, v78
 v_exp_f32 v79, v79
 v_cvt_pk_bf16_f32 v92, v72, v73
 v_cvt_pk_bf16_f32 v93, v74, v75
 v_mfma_f32_32x32x16_bf16 a[88:103], a[124:127], v[88:91], a[88:103]
 v_exp_f32 v48, v48
 v_exp_f32 v49, v49
 v_cvt_pk_bf16_f32 v94, v76, v77
 v_cvt_pk_bf16_f32 v95, v78, v79
 v_exp_f32 v50, v50
 v_exp_f32 v51, v51
 v_mfma_f32_32x32x16_bf16 v[64:79], a[112:115], a[4:7], v[32:47]
 v_exp_f32 v52, v52
 v_exp_f32 v53, v53
 ds_read_b128 a[108:111], v4 offset:18944
 ds_read_b128 a[144:147], v4 offset:27136
 v_exp_f32 v54, v54
 v_exp_f32 v55, v55
 v_cvt_pk_bf16_f32 v80, v48, v49
 v_cvt_pk_bf16_f32 v81, v50, v51
 v_mfma_f32_32x32x16_bf16 v[64:79], a[140:143], a[64:67], v[64:79]
 v_exp_f32 v56, v56
 v_exp_f32 v57, v57
 s_add_u32 s30, s87, 0
 buffer_load_dwordx4 a[156:159], v1, s[4:7], s30 offen sc1
 v_exp_f32 v58, v58
 v_exp_f32 v59, v59
 v_cvt_pk_bf16_f32 v82, v52, v53
 v_cvt_pk_bf16_f32 v83, v54, v55
 v_mfma_f32_32x32x16_bf16 a[88:103], a[128:131], v[92:95], a[88:103]
 v_exp_f32 v60, v60
 v_exp_f32 v61, v61
 v_exp_f32 v62, v62
 v_exp_f32 v63, v63
 v_cvt_pk_bf16_f32 v84, v56, v57
 v_cvt_pk_bf16_f32 v85, v58, v59
 s_waitcnt lgkmcnt(2)
 v_mfma_f32_32x32x16_bf16 a[72:87], a[132:135], v[80:83], a[72:87]
 v_exp_f32 v64, v64
 v_exp_f32 v65, v65
 v_cvt_pk_bf16_f32 v86, v60, v61
 v_cvt_pk_bf16_f32 v87, v62, v63
 v_exp_f32 v66, v66
 v_exp_f32 v67, v67
 v_mfma_f32_32x32x16_bf16 v[48:63], a[104:107], a[0:3], v[16:31]
 v_exp_f32 v68, v68
 v_exp_f32 v69, v69
 ds_read_b128 a[116:119], v8 offset:8512
 v_exp_f32 v70, v70
 v_exp_f32 v71, v71
 v_cvt_pk_bf16_f32 v88, v64, v65
 v_cvt_pk_bf16_f32 v89, v66, v67
 v_mfma_f32_32x32x16_bf16 v[48:63], a[140:143], a[36:39], v[48:63]
 v_exp_f32 v72, v72
 v_exp_f32 v73, v73
 ds_read_b128 a[120:123], v8 offset:9120
 buffer_load_dwordx4 v[176:179], v112, s[12:15], s34 offen
 buffer_load_dwordx4 v[180:183], v113, s[12:15], s34 offen
 s_add_u32 s34, s34, s35
 s_waitcnt vmcnt(13)
 ds_write_b128 v115, v[160:163]
 ds_write_b128 v115, v[164:167] offset:1024
 v_exp_f32 v74, v74
 v_exp_f32 v75, v75
 v_cvt_pk_bf16_f32 v90, v68, v69
 v_cvt_pk_bf16_f32 v91, v70, v71
 v_mfma_f32_32x32x16_bf16 a[72:87], a[136:139], v[84:87], a[72:87]
 v_exp_f32 v76, v76
 v_exp_f32 v77, v77
 v_exp_f32 v78, v78
 v_exp_f32 v79, v79
 v_cvt_pk_bf16_f32 v92, v72, v73
 v_cvt_pk_bf16_f32 v93, v74, v75
 v_mfma_f32_32x32x16_bf16 a[88:103], a[132:135], v[88:91], a[88:103]
 v_exp_f32 v48, v48
 v_exp_f32 v49, v49
 v_cvt_pk_bf16_f32 v94, v76, v77
 v_cvt_pk_bf16_f32 v95, v78, v79
 v_exp_f32 v50, v50
 v_exp_f32 v51, v51
 v_mfma_f32_32x32x16_bf16 v[64:79], a[104:107], a[4:7], v[32:47]
 v_exp_f32 v52, v52
 v_exp_f32 v53, v53
 ds_read_b128 a[112:115], v4 offset:19968
 v_exp_f32 v54, v54
 v_exp_f32 v55, v55
 v_cvt_pk_bf16_f32 v80, v48, v49
 v_cvt_pk_bf16_f32 v81, v50, v51
 v_mfma_f32_32x32x16_bf16 v[64:79], a[140:143], a[68:71], v[64:79]
 v_exp_f32 v56, v56
 v_exp_f32 v57, v57
 s_add_u32 s30, s87, 18432
 buffer_load_dwordx4 a[160:163], v1, s[4:7], s30 offen sc1
 v_exp_f32 v58, v58
 v_exp_f32 v59, v59
 v_cvt_pk_bf16_f32 v82, v52, v53
 v_cvt_pk_bf16_f32 v83, v54, v55
 v_mfma_f32_32x32x16_bf16 a[88:103], a[136:139], v[92:95], a[88:103]
 v_exp_f32 v60, v60
 v_exp_f32 v61, v61
 v_exp_f32 v62, v62
 v_exp_f32 v63, v63
 v_cvt_pk_bf16_f32 v84, v56, v57
 v_cvt_pk_bf16_f32 v85, v58, v59
 s_waitcnt lgkmcnt(3)
 v_mfma_f32_32x32x16_bf16 a[72:87], a[116:119], v[80:83], a[72:87]
 v_exp_f32 v64, v64
 v_exp_f32 v65, v65
 v_cvt_pk_bf16_f32 v86, v60, v61
 v_cvt_pk_bf16_f32 v87, v62, v63
 v_exp_f32 v66, v66
 v_exp_f32 v67, v67
 v_mfma_f32_32x32x16_bf16 v[48:63], a[108:111], a[0:3], v[16:31]
 v_exp_f32 v68, v68
 v_exp_f32 v69, v69
 ds_read_b128 a[124:127], v8 offset:18944
 v_exp_f32 v70, v70
 v_exp_f32 v71, v71
 v_cvt_pk_bf16_f32 v88, v64, v65
 v_cvt_pk_bf16_f32 v89, v66, v67
 v_mfma_f32_32x32x16_bf16 v[48:63], a[144:147], a[8:11], v[48:63]
 v_exp_f32 v72, v72
 v_exp_f32 v73, v73
 ds_read_b128 a[128:131], v8 offset:19552
 s_waitcnt lgkmcnt(3)
 ds_read_b64_tr_b16 v[192:193], v117 offset:0
 ds_read_b64_tr_b16 v[194:195], v117 offset:512
 ds_read_b64_tr_b16 v[196:197], v117 offset:64
 ds_read_b64_tr_b16 v[198:199], v117 offset:576
 v_exp_f32 v74, v74
 v_exp_f32 v75, v75
 v_cvt_pk_bf16_f32 v90, v68, v69
 v_cvt_pk_bf16_f32 v91, v70, v71
 v_mfma_f32_32x32x16_bf16 a[72:87], a[120:123], v[84:87], a[72:87]
 v_exp_f32 v76, v76
 v_exp_f32 v77, v77
 v_exp_f32 v78, v78
 v_exp_f32 v79, v79
 v_cvt_pk_bf16_f32 v92, v72, v73
 v_cvt_pk_bf16_f32 v93, v74, v75
 v_mfma_f32_32x32x16_bf16 a[88:103], a[116:119], v[88:91], a[88:103]
 v_exp_f32 v48, v48
 v_exp_f32 v49, v49
 v_cvt_pk_bf16_f32 v94, v76, v77
 v_cvt_pk_bf16_f32 v95, v78, v79
 v_exp_f32 v50, v50
 v_exp_f32 v51, v51
 v_mfma_f32_32x32x16_bf16 v[64:79], a[108:111], a[4:7], v[32:47]
 v_exp_f32 v52, v52
 v_exp_f32 v53, v53
 ds_read_b128 a[104:107], v4 offset:20992
 v_exp_f32 v54, v54
 v_exp_f32 v55, v55
 v_cvt_pk_bf16_f32 v80, v48, v49
 v_cvt_pk_bf16_f32 v81, v50, v51
 v_mfma_f32_32x32x16_bf16 v[64:79], a[144:147], a[40:43], v[64:79]
 v_exp_f32 v56, v56
 v_exp_f32 v57, v57
 s_add_u32 s30, s87, 36864
 buffer_load_dwordx4 a[164:167], v1, s[4:7], s30 offen sc1
 v_exp_f32 v58, v58
 v_exp_f32 v59, v59
 v_cvt_pk_bf16_f32 v82, v52, v53
 v_cvt_pk_bf16_f32 v83, v54, v55
 v_mfma_f32_32x32x16_bf16 a[88:103], a[120:123], v[92:95], a[88:103]
 v_exp_f32 v60, v60
 v_exp_f32 v61, v61
 v_exp_f32 v62, v62
 v_exp_f32 v63, v63
 v_cvt_pk_bf16_f32 v84, v56, v57
 v_cvt_pk_bf16_f32 v85, v58, v59
 s_waitcnt lgkmcnt(5)
 v_mfma_f32_32x32x16_bf16 a[72:87], a[124:127], v[80:83], a[72:87]
 v_exp_f32 v64, v64
 v_exp_f32 v65, v65
 v_cvt_pk_bf16_f32 v86, v60, v61
 v_cvt_pk_bf16_f32 v87, v62, v63
 v_exp_f32 v66, v66
 v_exp_f32 v67, v67
 v_mfma_f32_32x32x16_bf16 v[48:63], a[112:115], a[0:3], v[16:31]
 v_exp_f32 v68, v68
 v_exp_f32 v69, v69
 ds_read_b128 a[132:135], v8 offset:20160
 v_exp_f32 v70, v70
 v_exp_f32 v71, v71
 v_cvt_pk_bf16_f32 v88, v64, v65
 v_cvt_pk_bf16_f32 v89, v66, v67
 v_mfma_f32_32x32x16_bf16 v[48:63], a[144:147], a[12:15], v[48:63]
 v_exp_f32 v72, v72
 v_exp_f32 v73, v73
 ds_read_b128 a[136:139], v8 offset:20768
 s_waitcnt lgkmcnt(3)
 buffer_store_dwordx4 v[192:195], v114, s[4:7], s36 offen sc1
 s_add_u32 s30, s36, s17
 buffer_store_dwordx4 v[196:199], v114, s[4:7], s30 offen sc1
 s_add_u32 s36, s36, s37
 v_exp_f32 v74, v74
 v_exp_f32 v75, v75
 v_cvt_pk_bf16_f32 v90, v68, v69
 v_cvt_pk_bf16_f32 v91, v70, v71
 v_mfma_f32_32x32x16_bf16 a[72:87], a[128:131], v[84:87], a[72:87]
 v_exp_f32 v76, v76
 v_exp_f32 v77, v77
 v_exp_f32 v78, v78
 v_exp_f32 v79, v79
 v_cvt_pk_bf16_f32 v92, v72, v73
 v_cvt_pk_bf16_f32 v93, v74, v75
 v_mfma_f32_32x32x16_bf16 a[88:103], a[124:127], v[88:91], a[88:103]
 v_exp_f32 v48, v48
 v_exp_f32 v49, v49
 v_cvt_pk_bf16_f32 v94, v76, v77
 v_cvt_pk_bf16_f32 v95, v78, v79
 v_exp_f32 v50, v50
 v_exp_f32 v51, v51
 v_mfma_f32_32x32x16_bf16 v[64:79], a[112:115], a[4:7], v[32:47]
 v_exp_f32 v52, v52
 v_exp_f32 v53, v53
 ds_read_b128 a[108:111], v4 offset:22016
 v_exp_f32 v54, v54
 v_exp_f32 v55, v55
 v_cvt_pk_bf16_f32 v80, v48, v49
 v_cvt_pk_bf16_f32 v81, v50, v51
 v_mfma_f32_32x32x16_bf16 v[64:79], a[144:147], a[44:47], v[64:79]
 v_exp_f32 v56, v56
 v_exp_f32 v57, v57
 s_add_u32 s30, s87, 55296
 buffer_load_dwordx4 a[168:171], v1, s[4:7], s30 offen sc1
 v_exp_f32 v58, v58
 v_exp_f32 v59, v59
 v_cvt_pk_bf16_f32 v82, v52, v53
 v_cvt_pk_bf16_f32 v83, v54, v55
 v_mfma_f32_32x32x16_bf16 a[88:103], a[128:131], v[92:95], a[88:103]
 v_exp_f32 v60, v60
 v_exp_f32 v61, v61
 v_exp_f32 v62, v62
 v_exp_f32 v63, v63
 v_cvt_pk_bf16_f32 v84, v56, v57
 v_cvt_pk_bf16_f32 v85, v58, v59
 s_waitcnt lgkmcnt(1)
 v_mfma_f32_32x32x16_bf16 a[72:87], a[132:135], v[80:83], a[72:87]
 v_exp_f32 v64, v64
 v_exp_f32 v65, v65
 v_cvt_pk_bf16_f32 v86, v60, v61
 v_cvt_pk_bf16_f32 v87, v62, v63
 v_exp_f32 v66, v66
 v_exp_f32 v67, v67
 v_mfma_f32_32x32x16_bf16 v[48:63], a[104:107], a[0:3], v[16:31]
 v_exp_f32 v68, v68
 v_exp_f32 v69, v69
 ds_read_b128 a[116:119], v8 offset:21376
 v_exp_f32 v70, v70
 v_exp_f32 v71, v71
 v_cvt_pk_bf16_f32 v88, v64, v65
 v_cvt_pk_bf16_f32 v89, v66, v67
 v_mfma_f32_32x32x16_bf16 v[48:63], a[144:147], a[16:19], v[48:63]
 v_exp_f32 v72, v72
 v_exp_f32 v73, v73
 ds_read_b128 a[120:123], v8 offset:21984
 v_dot2_f32_bf16 v116, v192, s19, v116
 v_dot2_f32_bf16 v116, v193, s19, v116
 v_dot2_f32_bf16 v116, v194, s19, v116
 v_dot2_f32_bf16 v116, v195, s19, v116
 v_dot2_f32_bf16 v118, v196, s19, v118
 v_dot2_f32_bf16 v118, v197, s19, v118
 v_dot2_f32_bf16 v118, v198, s19, v118
 v_dot2_f32_bf16 v118, v199, s19, v118
 v_exp_f32 v74, v74
 v_exp_f32 v75, v75
 v_cvt_pk_bf16_f32 v90, v68, v69
 v_cvt_pk_bf16_f32 v91, v70, v71
 v_mfma_f32_32x32x16_bf16 a[72:87], a[136:139], v[84:87], a[72:87]
 v_exp_f32 v76, v76
 v_exp_f32 v77, v77
 v_exp_f32 v78, v78
 v_exp_f32 v79, v79
 v_cvt_pk_bf16_f32 v92, v72, v73
 v_cvt_pk_bf16_f32 v93, v74, v75
 v_mfma_f32_32x32x16_bf16 a[88:103], a[132:135], v[88:91], a[88:103]
 v_exp_f32 v48, v48
 v_exp_f32 v49, v49
 v_cvt_pk_bf16_f32 v94, v76, v77
 v_cvt_pk_bf16_f32 v95, v78, v79
 v_exp_f32 v50, v50
 v_exp_f32 v51, v51
 v_mfma_f32_32x32x16_bf16 v[64:79], a[104:107], a[4:7], v[32:47]
 v_exp_f32 v52, v52
 v_exp_f32 v53, v53
 ds_read_b128 a[112:115], v4 offset:23040
 v_exp_f32 v54, v54
 v_exp_f32 v55, v55
 v_cvt_pk_bf16_f32 v80, v48, v49
 v_cvt_pk_bf16_f32 v81, v50, v51
 v_mfma_f32_32x32x16_bf16 v[64:79], a[144:147], a[48:51], v[64:79]
 v_exp_f32 v56, v56
 v_exp_f32 v57, v57
 s_add_u32 s30, s87, 73728
 buffer_load_dwordx4 a[172:175], v1, s[4:7], s30 offen sc1
 v_exp_f32 v58, v58
 v_exp_f32 v59, v59
 v_cvt_pk_bf16_f32 v82, v52, v53
 v_cvt_pk_bf16_f32 v83, v54, v55
 v_mfma_f32_32x32x16_bf16 a[88:103], a[136:139], v[92:95], a[88:103]
 v_exp_f32 v60, v60
 v_exp_f32 v61, v61
 v_exp_f32 v62, v62
 v_exp_f32 v63, v63
 v_cvt_pk_bf16_f32 v84, v56, v57
 v_cvt_pk_bf16_f32 v85, v58, v59
 s_waitcnt lgkmcnt(1)
 v_mfma_f32_32x32x16_bf16 a[72:87], a[116:119], v[80:83], a[72:87]
 v_exp_f32 v64, v64
 v_exp_f32 v65, v65
 v_cvt_pk_bf16_f32 v86, v60, v61
 v_cvt_pk_bf16_f32 v87, v62, v63
 v_exp_f32 v66, v66
 v_exp_f32 v67, v67
 v_mfma_f32_32x32x16_bf16 v[48:63], a[108:111], a[0:3], v[16:31]
 v_exp_f32 v68, v68
 v_exp_f32 v69, v69
 ds_read_b128 a[124:127], v8 offset:22592
 v_exp_f32 v70, v70
 v_exp_f32 v71, v71
 v_cvt_pk_bf16_f32 v88, v64, v65
 v_cvt_pk_bf16_f32 v89, v66, v67
 v_mfma_f32_32x32x16_bf16 v[48:63], a[144:147], a[20:23], v[48:63]
 v_exp_f32 v72, v72
 v_exp_f32 v73, v73
 ds_read_b128 a[128:131], v8 offset:23200
 v_exp_f32 v74, v74
 v_exp_f32 v75, v75
 v_cvt_pk_bf16_f32 v90, v68, v69
 v_cvt_pk_bf16_f32 v91, v70, v71
 v_mfma_f32_32x32x16_bf16 a[72:87], a[120:123], v[84:87], a[72:87]
 v_exp_f32 v76, v76
 v_exp_f32 v77, v77
 v_exp_f32 v78, v78
 v_exp_f32 v79, v79
 v_cvt_pk_bf16_f32 v92, v72, v73
 v_cvt_pk_bf16_f32 v93, v74, v75
 v_mfma_f32_32x32x16_bf16 a[88:103], a[116:119], v[88:91], a[88:103]
 v_exp_f32 v48, v48
 v_exp_f32 v49, v49
 v_cvt_pk_bf16_f32 v94, v76, v77
 v_cvt_pk_bf16_f32 v95, v78, v79
 v_exp_f32 v50, v50
 v_exp_f32 v51, v51
 v_mfma_f32_32x32x16_bf16 v[64:79], a[108:111], a[4:7], v[32:47]
 v_exp_f32 v52, v52
 v_exp_f32 v53, v53
 ds_read_b128 a[104:107], v4 offset:24064
 v_exp_f32 v54, v54
 v_exp_f32 v55, v55
 v_cvt_pk_bf16_f32 v80, v48, v49
 v_cvt_pk_bf16_f32 v81, v50, v51
 v_mfma_f32_32x32x16_bf16 v[64:79], a[144:147], a[52:55], v[64:79]
 v_exp_f32 v56, v56
 v_exp_f32 v57, v57
 s_add_u32 s30, s87, 4096
 buffer_load_dwordx4 a[176:179], v1, s[4:7], s30 offen sc1
 v_exp_f32 v58, v58
 v_exp_f32 v59, v59
 v_cvt_pk_bf16_f32 v82, v52, v53
 v_cvt_pk_bf16_f32 v83, v54, v55
 v_mfma_f32_32x32x16_bf16 a[88:103], a[120:123], v[92:95], a[88:103]
 v_exp_f32 v60, v60
 v_exp_f32 v61, v61
 v_exp_f32 v62, v62
 v_exp_f32 v63, v63
 v_cvt_pk_bf16_f32 v84, v56, v57
 v_cvt_pk_bf16_f32 v85, v58, v59
 s_waitcnt lgkmcnt(1)
 v_mfma_f32_32x32x16_bf16 a[72:87], a[124:127], v[80:83], a[72:87]
 v_exp_f32 v64, v64
 v_exp_f32 v65, v65
 v_cvt_pk_bf16_f32 v86, v60, v61
 v_cvt_pk_bf16_f32 v87, v62, v63
 v_exp_f32 v66, v66
 v_exp_f32 v67, v67
 v_mfma_f32_32x32x16_bf16 v[48:63], a[112:115], a[0:3], v[16:31]
 v_exp_f32 v68, v68
 v_exp_f32 v69, v69
 ds_read_b128 a[132:135], v8 offset:23808
 v_exp_f32 v70, v70
 v_exp_f32 v71, v71
 v_cvt_pk_bf16_f32 v88, v64, v65
 v_cvt_pk_bf16_f32 v89, v66, v67
 v_mfma_f32_32x32x16_bf16 v[48:63], a[144:147], a[24:27], v[48:63]
 v_exp_f32 v72, v72
 v_exp_f32 v73, v73
 ds_read_b128 a[136:139], v8 offset:24416
 buffer_load_dwordx4 v[184:187], v112, s[12:15], s34 offen
 buffer_load_dwordx4 v[188:191], v113, s[12:15], s34 offen
 s_add_u32 s34, s34, s35
 s_waitcnt vmcnt(16)
 ds_write_b128 v115, v[168:171]
 ds_write_b128 v115, v[172:175] offset:1024
 v_exp_f32 v74, v74
 v_exp_f32 v75, v75
 v_cvt_pk_bf16_f32 v90, v68, v69
 v_cvt_pk_bf16_f32 v91, v70, v71
 v_mfma_f32_32x32x16_bf16 a[72:87], a[128:131], v[84:87], a[72:87]
 v_exp_f32 v76, v76
 v_exp_f32 v77, v77
 v_exp_f32 v78, v78
 v_exp_f32 v79, v79
 v_cvt_pk_bf16_f32 v92, v72, v73
 v_cvt_pk_bf16_f32 v93, v74, v75
 v_mfma_f32_32x32x16_bf16 a[88:103], a[124:127], v[88:91], a[88:103]
 v_exp_f32 v48, v48
 v_exp_f32 v49, v49
 v_cvt_pk_bf16_f32 v94, v76, v77
 v_cvt_pk_bf16_f32 v95, v78, v79
 v_exp_f32 v50, v50
 v_exp_f32 v51, v51
 v_mfma_f32_32x32x16_bf16 v[64:79], a[112:115], a[4:7], v[32:47]
 v_exp_f32 v52, v52
 v_exp_f32 v53, v53
 ds_read_b128 a[108:111], v4 offset:25088
 v_exp_f32 v54, v54
 v_exp_f32 v55, v55
 v_cvt_pk_bf16_f32 v80, v48, v49
 v_cvt_pk_bf16_f32 v81, v50, v51
 v_mfma_f32_32x32x16_bf16 v[64:79], a[144:147], a[56:59], v[64:79]
 v_exp_f32 v56, v56
 v_exp_f32 v57, v57
 s_add_u32 s30, s87, 22528
 buffer_load_dwordx4 a[180:183], v1, s[4:7], s30 offen sc1
 v_exp_f32 v58, v58
 v_exp_f32 v59, v59
 v_cvt_pk_bf16_f32 v82, v52, v53
 v_cvt_pk_bf16_f32 v83, v54, v55
 v_mfma_f32_32x32x16_bf16 a[88:103], a[128:131], v[92:95], a[88:103]
 v_exp_f32 v60, v60
 v_exp_f32 v61, v61
 v_exp_f32 v62, v62
 v_exp_f32 v63, v63
 v_cvt_pk_bf16_f32 v84, v56, v57
 v_cvt_pk_bf16_f32 v85, v58, v59
 s_waitcnt lgkmcnt(3)
 v_mfma_f32_32x32x16_bf16 a[72:87], a[132:135], v[80:83], a[72:87]
 v_exp_f32 v64, v64
 v_exp_f32 v65, v65
 v_cvt_pk_bf16_f32 v86, v60, v61
 v_cvt_pk_bf16_f32 v87, v62, v63
 v_exp_f32 v66, v66
 v_exp_f32 v67, v67
 v_mfma_f32_32x32x16_bf16 v[48:63], a[104:107], a[0:3], v[16:31]
 v_exp_f32 v68, v68
 v_exp_f32 v69, v69
 ds_read_b128 a[116:119], v8 offset:25024
 v_exp_f32 v70, v70
 v_exp_f32 v71, v71
 v_cvt_pk_bf16_f32 v88, v64, v65
 v_cvt_pk_bf16_f32 v89, v66, v67
 v_mfma_f32_32x32x16_bf16 v[48:63], a[144:147], a[28:31], v[48:63]
 v_exp_f32 v72, v72
 v_exp_f32 v73, v73
 ds_read_b128 a[120:123], v8 offset:25632
 s_waitcnt lgkmcnt(3)
 ds_read_b64_tr_b16 v[192:193], v117 offset:0
 ds_read_b64_tr_b16 v[194:195], v117 offset:512
 ds_read_b64_tr_b16 v[196:197], v117 offset:64
 ds_read_b64_tr_b16 v[198:199], v117 offset:576
 v_exp_f32 v74, v74
 v_exp_f32 v75, v75
 v_cvt_pk_bf16_f32 v90, v68, v69
 v_cvt_pk_bf16_f32 v91, v70, v71
 v_mfma_f32_32x32x16_bf16 a[72:87], a[136:139], v[84:87], a[72:87]
 v_exp_f32 v76, v76
 v_exp_f32 v77, v77
 v_exp_f32 v78, v78
 v_exp_f32 v79, v79
 v_cvt_pk_bf16_f32 v92, v72, v73
 v_cvt_pk_bf16_f32 v93, v74, v75
 v_mfma_f32_32x32x16_bf16 a[88:103], a[132:135], v[88:91], a[88:103]
 v_exp_f32 v48, v48
 v_exp_f32 v49, v49
 v_cvt_pk_bf16_f32 v94, v76, v77
 v_cvt_pk_bf16_f32 v95, v78, v79
 v_exp_f32 v50, v50
 v_exp_f32 v51, v51
 v_mfma_f32_32x32x16_bf16 v[64:79], a[104:107], a[4:7], v[32:47]
 v_exp_f32 v52, v52
 v_exp_f32 v53, v53
 ds_read_b128 a[112:115], v4 offset:26112
 v_exp_f32 v54, v54
 v_exp_f32 v55, v55
 v_cvt_pk_bf16_f32 v80, v48, v49
 v_cvt_pk_bf16_f32 v81, v50, v51
 v_mfma_f32_32x32x16_bf16 v[64:79], a[144:147], a[60:63], v[64:79]
 v_exp_f32 v56, v56
 v_exp_f32 v57, v57
 s_add_u32 s30, s87, 40960
 buffer_load_dwordx4 a[184:187], v1, s[4:7], s30 offen sc1
 v_exp_f32 v58, v58
 v_exp_f32 v59, v59
 v_cvt_pk_bf16_f32 v82, v52, v53
 v_cvt_pk_bf16_f32 v83, v54, v55
 v_mfma_f32_32x32x16_bf16 a[88:103], a[136:139], v[92:95], a[88:103]
 v_exp_f32 v60, v60
 v_exp_f32 v61, v61
 v_exp_f32 v62, v62
 v_exp_f32 v63, v63
 v_cvt_pk_bf16_f32 v84, v56, v57
 v_cvt_pk_bf16_f32 v85, v58, v59
 s_waitcnt lgkmcnt(5)
 v_mfma_f32_32x32x16_bf16 a[72:87], a[116:119], v[80:83], a[72:87]
 v_exp_f32 v64, v64
 v_exp_f32 v65, v65
 v_cvt_pk_bf16_f32 v86, v60, v61
 v_cvt_pk_bf16_f32 v87, v62, v63
 v_exp_f32 v66, v66
 v_exp_f32 v67, v67
 v_mfma_f32_32x32x16_bf16 v[48:63], a[108:111], a[0:3], v[16:31]
 v_exp_f32 v68, v68
 v_exp_f32 v69, v69
 ds_read_b128 a[124:127], v8 offset:26240
 v_exp_f32 v70, v70
 v_exp_f32 v71, v71
 v_cvt_pk_bf16_f32 v88, v64, v65
 v_cvt_pk_bf16_f32 v89, v66, v67
 v_mfma_f32_32x32x16_bf16 v[48:63], a[144:147], a[32:35], v[48:63]
 v_exp_f32 v72, v72
 v_exp_f32 v73, v73
 ds_read_b128 a[128:131], v8 offset:26848
 s_waitcnt lgkmcnt(3)
 buffer_store_dwordx4 v[192:195], v114, s[4:7], s36 offen sc1
 s_add_u32 s30, s36, s17
 buffer_store_dwordx4 v[196:199], v114, s[4:7], s30 offen sc1
 s_add_u32 s36, s36, s37
 v_exp_f32 v74, v74
 v_exp_f32 v75, v75
 v_cvt_pk_bf16_f32 v90, v68, v69
 v_cvt_pk_bf16_f32 v91, v70, v71
 v_mfma_f32_32x32x16_bf16 a[72:87], a[120:123], v[84:87], a[72:87]
 v_exp_f32 v76, v76
 v_exp_f32 v77, v77
 v_exp_f32 v78, v78
 v_exp_f32 v79, v79
 v_cvt_pk_bf16_f32 v92, v72, v73
 v_cvt_pk_bf16_f32 v93, v74, v75
 v_mfma_f32_32x32x16_bf16 a[88:103], a[116:119], v[88:91], a[88:103]
 v_exp_f32 v48, v48
 v_exp_f32 v49, v49
 v_cvt_pk_bf16_f32 v94, v76, v77
 v_cvt_pk_bf16_f32 v95, v78, v79
 v_exp_f32 v50, v50
 v_exp_f32 v51, v51
 v_mfma_f32_32x32x16_bf16 v[64:79], a[108:111], a[4:7], v[32:47]
 v_exp_f32 v52, v52
 v_exp_f32 v53, v53
 ds_read_b128 a[104:107], v5 offset:0
 ds_read_b128 a[140:143], v5 offset:8192
 v_exp_f32 v54, v54
 v_exp_f32 v55, v55
 v_cvt_pk_bf16_f32 v80, v48, v49
 v_cvt_pk_bf16_f32 v81, v50, v51
 v_mfma_f32_32x32x16_bf16 v[64:79], a[144:147], a[64:67], v[64:79]
 v_exp_f32 v56, v56
 v_exp_f32 v57, v57
 s_add_u32 s30, s87, 59392
 buffer_load_dwordx4 a[188:191], v1, s[4:7], s30 offen sc1
 v_exp_f32 v58, v58
 v_exp_f32 v59, v59
 v_cvt_pk_bf16_f32 v82, v52, v53
 v_cvt_pk_bf16_f32 v83, v54, v55
 v_mfma_f32_32x32x16_bf16 a[88:103], a[120:123], v[92:95], a[88:103]
 v_exp_f32 v60, v60
 v_exp_f32 v61, v61
 v_exp_f32 v62, v62
 v_exp_f32 v63, v63
 v_cvt_pk_bf16_f32 v84, v56, v57
 v_cvt_pk_bf16_f32 v85, v58, v59
 s_waitcnt lgkmcnt(2)
 v_mfma_f32_32x32x16_bf16 a[72:87], a[124:127], v[80:83], a[72:87]
 v_exp_f32 v64, v64
 v_exp_f32 v65, v65
 v_cvt_pk_bf16_f32 v86, v60, v61
 v_cvt_pk_bf16_f32 v87, v62, v63
 v_exp_f32 v66, v66
 v_exp_f32 v67, v67
 v_mfma_f32_32x32x16_bf16 v[48:63], a[112:115], a[0:3], v[16:31]
 v_exp_f32 v68, v68
 v_exp_f32 v69, v69
 ds_read_b128 a[132:135], v8 offset:27456
 v_exp_f32 v70, v70
 v_exp_f32 v71, v71
 v_cvt_pk_bf16_f32 v88, v64, v65
 v_cvt_pk_bf16_f32 v89, v66, v67
 v_mfma_f32_32x32x16_bf16 v[48:63], a[144:147], a[36:39], v[48:63]
 v_exp_f32 v72, v72
 v_exp_f32 v73, v73
 ds_read_b128 a[136:139], v8 offset:28064
 v_dot2_f32_bf16 v116, v192, s19, v116
 v_dot2_f32_bf16 v116, v193, s19, v116
 v_dot2_f32_bf16 v116, v194, s19, v116
 v_dot2_f32_bf16 v116, v195, s19, v116
 v_dot2_f32_bf16 v118, v196, s19, v118
 v_dot2_f32_bf16 v118, v197, s19, v118
 v_dot2_f32_bf16 v118, v198, s19, v118
 v_dot2_f32_bf16 v118, v199, s19, v118
 v_exp_f32 v74, v74
 v_exp_f32 v75, v75
 v_cvt_pk_bf16_f32 v90, v68, v69
 v_cvt_pk_bf16_f32 v91, v70, v71
 v_mfma_f32_32x32x16_bf16 a[72:87], a[128:131], v[84:87], a[72:87]
 v_exp_f32 v76, v76
 v_exp_f32 v77, v77
 v_exp_f32 v78, v78
 v_exp_f32 v79, v79
 v_cvt_pk_bf16_f32 v92, v72, v73
 v_cvt_pk_bf16_f32 v93, v74, v75
 v_mfma_f32_32x32x16_bf16 a[88:103], a[124:127], v[88:91], a[88:103]
 v_exp_f32 v48, v48
 v_exp_f32 v49, v49
 v_cvt_pk_bf16_f32 v94, v76, v77
 v_cvt_pk_bf16_f32 v95, v78, v79
 v_exp_f32 v50, v50
 v_exp_f32 v51, v51
 v_mfma_f32_32x32x16_bf16 v[64:79], a[112:115], a[4:7], v[32:47]
 v_exp_f32 v52, v52
 v_exp_f32 v53, v53
 ds_read_b128 a[108:111], v5 offset:1024
 v_exp_f32 v54, v54
 v_exp_f32 v55, v55
 v_cvt_pk_bf16_f32 v80, v48, v49
 v_cvt_pk_bf16_f32 v81, v50, v51
 v_mfma_f32_32x32x16_bf16 v[64:79], a[144:147], a[68:71], v[64:79]
 v_exp_f32 v56, v56
 v_exp_f32 v57, v57
 s_add_u32 s30, s87, 77824
 buffer_load_dwordx4 a[192:195], v1, s[4:7], s30 offen sc1
 v_exp_f32 v58, v58
 v_exp_f32 v59, v59
 v_cvt_pk_bf16_f32 v82, v52, v53
 v_cvt_pk_bf16_f32 v83, v54, v55
 v_mfma_f32_32x32x16_bf16 a[88:103], a[128:131], v[92:95], a[88:103]
 v_exp_f32 v60, v60
 v_exp_f32 v61, v61
 v_exp_f32 v62, v62
 v_exp_f32 v63, v63
 v_cvt_pk_bf16_f32 v84, v56, v57
 v_cvt_pk_bf16_f32 v85, v58, v59
 s_waitcnt lgkmcnt(1)
 v_mfma_f32_32x32x16_bf16 a[72:87], a[132:135], v[80:83], a[72:87]
 v_exp_f32 v64, v64
 v_exp_f32 v65, v65
 v_cvt_pk_bf16_f32 v86, v60, v61
 v_cvt_pk_bf16_f32 v87, v62, v63
 v_exp_f32 v66, v66
 v_exp_f32 v67, v67
 v_mfma_f32_32x32x16_bf16 v[48:63], a[104:107], a[0:3], v[16:31]
 v_exp_f32 v68, v68
 v_exp_f32 v69, v69
 ds_read_b128 a[116:119], v9 offset:0
 v_exp_f32 v70, v70
 v_exp_f32 v71, v71
 v_cvt_pk_bf16_f32 v88, v64, v65
 v_cvt_pk_bf16_f32 v89, v66, v67
 v_mfma_f32_32x32x16_bf16 v[48:63], a[140:143], a[8:11], v[48:63]
 v_exp_f32 v72, v72
 v_exp_f32 v73, v73
 ds_read_b128 a[120:123], v9 offset:608
 v_exp_f32 v74, v74
 v_exp_f32 v75, v75
 v_cvt_pk_bf16_f32 v90, v68, v69
 v_cvt_pk_bf16_f32 v91, v70, v71
 v_mfma_f32_32x32x16_bf16 a[72:87], a[136:139], v[84:87], a[72:87]
 v_exp_f32 v76, v76
 v_exp_f32 v77, v77
 v_exp_f32 v78, v78
 v_exp_f32 v79, v79
 v_cvt_pk_bf16_f32 v92, v72, v73
 v_cvt_pk_bf16_f32 v93, v74, v75
 v_mfma_f32_32x32x16_bf16 a[88:103], a[132:135], v[88:91], a[88:103]
 v_exp_f32 v48, v48
 v_exp_f32 v49, v49
 v_cvt_pk_bf16_f32 v94, v76, v77
 v_cvt_pk_bf16_f32 v95, v78, v79
 v_exp_f32 v50, v50
 v_exp_f32 v51, v51
 v_mfma_f32_32x32x16_bf16 v[64:79], a[104:107], a[4:7], v[32:47]
 v_exp_f32 v52, v52
 v_exp_f32 v53, v53
 ds_read_b128 a[112:115], v5 offset:2048
 v_exp_f32 v54, v54
 v_exp_f32 v55, v55
 v_cvt_pk_bf16_f32 v80, v48, v49
 v_cvt_pk_bf16_f32 v81, v50, v51
 v_mfma_f32_32x32x16_bf16 v[64:79], a[140:143], a[40:43], v[64:79]
 v_exp_f32 v56, v56
 v_exp_f32 v57, v57
 s_add_u32 s30, s87, 8192
 buffer_load_dwordx4 a[196:199], v1, s[4:7], s30 offen sc1
 v_exp_f32 v58, v58
 v_exp_f32 v59, v59
 v_cvt_pk_bf16_f32 v82, v52, v53
 v_cvt_pk_bf16_f32 v83, v54, v55
 v_mfma_f32_32x32x16_bf16 a[88:103], a[136:139], v[92:95], a[88:103]
 v_exp_f32 v60, v60
 v_exp_f32 v61, v61
 v_exp_f32 v62, v62
 v_exp_f32 v63, v63
 v_cvt_pk_bf16_f32 v84, v56, v57
 v_cvt_pk_bf16_f32 v85, v58, v59
 s_waitcnt lgkmcnt(1)
 v_mfma_f32_32x32x16_bf16 a[72:87], a[116:119], v[80:83], a[72:87]
 v_exp_f32 v64, v64
 v_exp_f32 v65, v65
 v_cvt_pk_bf16_f32 v86, v60, v61
 v_cvt_pk_bf16_f32 v87, v62, v63
 v_exp_f32 v66, v66
 v_exp_f32 v67, v67
 v_mfma_f32_32x32x16_bf16 v[48:63], a[108:111], a[0:3], v[16:31]
 v_exp_f32 v68, v68
 v_exp_f32 v69, v69
 ds_read_b128 a[124:127], v9 offset:1216
 v_exp_f32 v70, v70
 v_exp_f32 v71, v71
 v_cvt_pk_bf16_f32 v88, v64, v65
 v_cvt_pk_bf16_f32 v89, v66, v67
 v_mfma_f32_32x32x16_bf16 v[48:63], a[140:143], a[12:15], v[48:63]
 v_exp_f32 v72, v72
 v_exp_f32 v73, v73
 ds_read_b128 a[128:131], v9 offset:1824
 s_waitcnt vmcnt(16)
 ds_write_b128 v115, v[176:179]
 ds_write_b128 v115, v[180:183] offset:1024
 v_exp_f32 v74, v74
 v_exp_f32 v75, v75
 v_cvt_pk_bf16_f32 v90, v68, v69
 v_cvt_pk_bf16_f32 v91, v70, v71
 v_mfma_f32_32x32x16_bf16 a[72:87], a[120:123], v[84:87], a[72:87]
 v_exp_f32 v76, v76
 v_exp_f32 v77, v77
 v_exp_f32 v78, v78
 v_exp_f32 v79, v79
 v_cvt_pk_bf16_f32 v92, v72, v73
 v_cvt_pk_bf16_f32 v93, v74, v75
 v_mfma_f32_32x32x16_bf16 a[88:103], a[116:119], v[88:91], a[88:103]
 v_exp_f32 v48, v48
 v_exp_f32 v49, v49
 v_cvt_pk_bf16_f32 v94, v76, v77
 v_cvt_pk_bf16_f32 v95, v78, v79
 v_exp_f32 v50, v50
 v_exp_f32 v51, v51
 v_mfma_f32_32x32x16_bf16 v[64:79], a[108:111], a[4:7], v[32:47]
 v_exp_f32 v52, v52
 v_exp_f32 v53, v53
 ds_read_b128 a[104:107], v5 offset:3072
 v_exp_f32 v54, v54
 v_exp_f32 v55, v55
 v_cvt_pk_bf16_f32 v80, v48, v49
 v_cvt_pk_bf16_f32 v81, v50, v51
 v_mfma_f32_32x32x16_bf16 v[64:79], a[140:143], a[44:47], v[64:79]
 v_exp_f32 v56, v56
 v_exp_f32 v57, v57
 s_add_u32 s30, s87, 26624
 buffer_load_dwordx4 a[200:203], v1, s[4:7], s30 offen sc1
 v_exp_f32 v58, v58
 v_exp_f32 v59, v59
 v_cvt_pk_bf16_f32 v82, v52, v53
 v_cvt_pk_bf16_f32 v83, v54, v55
 v_mfma_f32_32x32x16_bf16 a[88:103], a[120:123], v[92:95], a[88:103]
 v_exp_f32 v60, v60
 v_exp_f32 v61, v61
 v_exp_f32 v62, v62
 v_exp_f32 v63, v63
 v_cvt_pk_bf16_f32 v84, v56, v57
 v_cvt_pk_bf16_f32 v85, v58, v59
 s_waitcnt lgkmcnt(3)
 v_mfma_f32_32x32x16_bf16 a[72:87], a[124:127], v[80:83], a[72:87]
 v_exp_f32 v64, v64
 v_exp_f32 v65, v65
 v_cvt_pk_bf16_f32 v86, v60, v61
 v_cvt_pk_bf16_f32 v87, v62, v63
 v_exp_f32 v66, v66
 v_exp_f32 v67, v67
 v_mfma_f32_32x32x16_bf16 v[48:63], a[112:115], a[0:3], v[16:31]
 v_exp_f32 v68, v68
 v_exp_f32 v69, v69
 ds_read_b128 a[132:135], v9 offset:2432
 v_exp_f32 v70, v70
 v_exp_f32 v71, v71
 v_cvt_pk_bf16_f32 v88, v64, v65
 v_cvt_pk_bf16_f32 v89, v66, v67
 v_mfma_f32_32x32x16_bf16 v[48:63], a[140:143], a[16:19], v[48:63]
 v_exp_f32 v72, v72
 v_exp_f32 v73, v73
 ds_read_b128 a[136:139], v9 offset:3040
 s_waitcnt lgkmcnt(3)
 ds_read_b64_tr_b16 v[192:193], v117 offset:0
 ds_read_b64_tr_b16 v[194:195], v117 offset:512
 ds_read_b64_tr_b16 v[196:197], v117 offset:64
 ds_read_b64_tr_b16 v[198:199], v117 offset:576
 v_exp_f32 v74, v74
 v_exp_f32 v75, v75
 v_cvt_pk_bf16_f32 v90, v68, v69
 v_cvt_pk_bf16_f32 v91, v70, v71
 v_mfma_f32_32x32x16_bf16 a[72:87], a[128:131], v[84:87], a[72:87]
 v_exp_f32 v76, v76
 v_exp_f32 v77, v77
 v_exp_f32 v78, v78
 v_exp_f32 v79, v79
 v_cvt_pk_bf16_f32 v92, v72, v73
 v_cvt_pk_bf16_f32 v93, v74, v75
 v_mfma_f32_32x32x16_bf16 a[88:103], a[124:127], v[88:91], a[88:103]
 v_exp_f32 v48, v48
 v_exp_f32 v49, v49
 v_cvt_pk_bf16_f32 v94, v76, v77
 v_cvt_pk_bf16_f32 v95, v78, v79
 v_exp_f32 v50, v50
 v_exp_f32 v51, v51
 v_mfma_f32_32x32x16_bf16 v[64:79], a[112:115], a[4:7], v[32:47]
 v_exp_f32 v52, v52
 v_exp_f32 v53, v53
 ds_read_b128 a[108:111], v5 offset:4096
 v_exp_f32 v54, v54
 v_exp_f32 v55, v55
 v_cvt_pk_bf16_f32 v80, v48, v49
 v_cvt_pk_bf16_f32 v81, v50, v51
 v_mfma_f32_32x32x16_bf16 v[64:79], a[140:143], a[48:51], v[64:79]
 v_exp_f32 v56, v56
 v_exp_f32 v57, v57
 s_add_u32 s30, s87, 45056
 buffer_load_dwordx4 a[204:207], v1, s[4:7], s30 offen sc1
 v_exp_f32 v58, v58
 v_exp_f32 v59, v59
 v_cvt_pk_bf16_f32 v82, v52, v53
 v_cvt_pk_bf16_f32 v83, v54, v55
 v_mfma_f32_32x32x16_bf16 a[88:103], a[128:131], v[92:95], a[88:103]
 v_exp_f32 v60, v60
 v_exp_f32 v61, v61
 v_exp_f32 v62, v62
 v_exp_f32 v63, v63
 v_cvt_pk_bf16_f32 v84, v56, v57
 v_cvt_pk_bf16_f32 v85, v58, v59
 s_waitcnt lgkmcnt(5)
 v_mfma_f32_32x32x16_bf16 a[72:87], a[132:135], v[80:83], a[72:87]
 v_exp_f32 v64, v64
 v_exp_f32 v65, v65
 v_cvt_pk_bf16_f32 v86, v60, v61
 v_cvt_pk_bf16_f32 v87, v62, v63
 v_exp_f32 v66, v66
 v_exp_f32 v67, v67
 v_mfma_f32_32x32x16_bf16 v[48:63], a[104:107], a[0:3], v[16:31]
 v_exp_f32 v68, v68
 v_exp_f32 v69, v69
 ds_read_b128 a[116:119], v9 offset:3648
 v_exp_f32 v70, v70
 v_exp_f32 v71, v71
 v_cvt_pk_bf16_f32 v88, v64, v65
 v_cvt_pk_bf16_f32 v89, v66, v67
 v_mfma_f32_32x32x16_bf16 v[48:63], a[140:143], a[20:23], v[48:63]
 v_exp_f32 v72, v72
 v_exp_f32 v73, v73
 ds_read_b128 a[120:123], v9 offset:4256
 s_waitcnt lgkmcnt(3)
 buffer_store_dwordx4 v[192:195], v114, s[4:7], s36 offen sc1
 s_add_u32 s30, s36, s17
 buffer_store_dwordx4 v[196:199], v114, s[4:7], s30 offen sc1
 s_add_u32 s36, s36, s37
 v_exp_f32 v74, v74
 v_exp_f32 v75, v75
 v_cvt_pk_bf16_f32 v90, v68, v69
 v_cvt_pk_bf16_f32 v91, v70, v71
 v_mfma_f32_32x32x16_bf16 a[72:87], a[136:139], v[84:87], a[72:87]
 v_exp_f32 v76, v76
 v_exp_f32 v77, v77
 v_exp_f32 v78, v78
 v_exp_f32 v79, v79
 v_cvt_pk_bf16_f32 v92, v72, v73
 v_cvt_pk_bf16_f32 v93, v74, v75
 v_mfma_f32_32x32x16_bf16 a[88:103], a[132:135], v[88:91], a[88:103]
 v_exp_f32 v48, v48
 v_exp_f32 v49, v49
 v_cvt_pk_bf16_f32 v94, v76, v77
 v_cvt_pk_bf16_f32 v95, v78, v79
 v_exp_f32 v50, v50
 v_exp_f32 v51, v51
 v_mfma_f32_32x32x16_bf16 v[64:79], a[104:107], a[4:7], v[32:47]
 v_exp_f32 v52, v52
 v_exp_f32 v53, v53
 ds_read_b128 a[112:115], v5 offset:5120
 v_exp_f32 v54, v54
 v_exp_f32 v55, v55
 v_cvt_pk_bf16_f32 v80, v48, v49
 v_cvt_pk_bf16_f32 v81, v50, v51
 v_mfma_f32_32x32x16_bf16 v[64:79], a[140:143], a[52:55], v[64:79]
 v_exp_f32 v56, v56
 v_exp_f32 v57, v57
 s_add_u32 s30, s87, 63488
 buffer_load_dwordx4 a[208:211], v1, s[4:7], s30 offen sc1
 v_exp_f32 v58, v58
 v_exp_f32 v59, v59
 v_cvt_pk_bf16_f32 v82, v52, v53
 v_cvt_pk_bf16_f32 v83, v54, v55
 v_mfma_f32_32x32x16_bf16 a[88:103], a[136:139], v[92:95], a[88:103]
 v_exp_f32 v60, v60
 v_exp_f32 v61, v61
 v_exp_f32 v62, v62
 v_exp_f32 v63, v63
 v_cvt_pk_bf16_f32 v84, v56, v57
 v_cvt_pk_bf16_f32 v85, v58, v59
 s_waitcnt lgkmcnt(1)
 v_mfma_f32_32x32x16_bf16 a[72:87], a[116:119], v[80:83], a[72:87]
 v_exp_f32 v64, v64
 v_exp_f32 v65, v65
 v_cvt_pk_bf16_f32 v86, v60, v61
 v_cvt_pk_bf16_f32 v87, v62, v63
 v_exp_f32 v66, v66
 v_exp_f32 v67, v67
 v_mfma_f32_32x32x16_bf16 v[48:63], a[108:111], a[0:3], v[16:31]
 v_exp_f32 v68, v68
 v_exp_f32 v69, v69
 ds_read_b128 a[124:127], v9 offset:4864
 v_exp_f32 v70, v70
 v_exp_f32 v71, v71
 v_cvt_pk_bf16_f32 v88, v64, v65
 v_cvt_pk_bf16_f32 v89, v66, v67
 v_mfma_f32_32x32x16_bf16 v[48:63], a[140:143], a[24:27], v[48:63]
 v_exp_f32 v72, v72
 v_exp_f32 v73, v73
 ds_read_b128 a[128:131], v9 offset:5472
 v_dot2_f32_bf16 v116, v192, s19, v116
 v_dot2_f32_bf16 v116, v193, s19, v116
 v_dot2_f32_bf16 v116, v194, s19, v116
 v_dot2_f32_bf16 v116, v195, s19, v116
 v_dot2_f32_bf16 v118, v196, s19, v118
 v_dot2_f32_bf16 v118, v197, s19, v118
 v_dot2_f32_bf16 v118, v198, s19, v118
 v_dot2_f32_bf16 v118, v199, s19, v118
 v_exp_f32 v74, v74
 v_exp_f32 v75, v75
 v_cvt_pk_bf16_f32 v90, v68, v69
 v_cvt_pk_bf16_f32 v91, v70, v71
 v_mfma_f32_32x32x16_bf16 a[72:87], a[120:123], v[84:87], a[72:87]
 v_exp_f32 v76, v76
 v_exp_f32 v77, v77
 v_exp_f32 v78, v78
 v_exp_f32 v79, v79
 v_cvt_pk_bf16_f32 v92, v72, v73
 v_cvt_pk_bf16_f32 v93, v74, v75
 v_mfma_f32_32x32x16_bf16 a[88:103], a[116:119], v[88:91], a[88:103]
 v_exp_f32 v48, v48
 v_exp_f32 v49, v49
 v_cvt_pk_bf16_f32 v94, v76, v77
 v_cvt_pk_bf16_f32 v95, v78, v79
 v_exp_f32 v50, v50
 v_exp_f32 v51, v51
 v_mfma_f32_32x32x16_bf16 v[64:79], a[108:111], a[4:7], v[32:47]
 v_exp_f32 v52, v52
 v_exp_f32 v53, v53
 ds_read_b128 a[104:107], v5 offset:6144
 v_exp_f32 v54, v54
 v_exp_f32 v55, v55
 v_cvt_pk_bf16_f32 v80, v48, v49
 v_cvt_pk_bf16_f32 v81, v50, v51
 v_mfma_f32_32x32x16_bf16 v[64:79], a[140:143], a[56:59], v[64:79]
 v_exp_f32 v56, v56
 v_exp_f32 v57, v57
 s_add_u32 s30, s87, 81920
 buffer_load_dwordx4 a[212:215], v1, s[4:7], s30 offen sc1
 v_exp_f32 v58, v58
 v_exp_f32 v59, v59
 v_cvt_pk_bf16_f32 v82, v52, v53
 v_cvt_pk_bf16_f32 v83, v54, v55
 v_mfma_f32_32x32x16_bf16 a[88:103], a[120:123], v[92:95], a[88:103]
 v_exp_f32 v60, v60
 v_exp_f32 v61, v61
 v_exp_f32 v62, v62
 v_exp_f32 v63, v63
 v_cvt_pk_bf16_f32 v84, v56, v57
 v_cvt_pk_bf16_f32 v85, v58, v59
 s_waitcnt lgkmcnt(1)
 v_mfma_f32_32x32x16_bf16 a[72:87], a[124:127], v[80:83], a[72:87]
 v_exp_f32 v64, v64
 v_exp_f32 v65, v65
 v_cvt_pk_bf16_f32 v86, v60, v61
 v_cvt_pk_bf16_f32 v87, v62, v63
 v_exp_f32 v66, v66
 v_exp_f32 v67, v67
 v_mfma_f32_32x32x16_bf16 v[48:63], a[112:115], a[0:3], v[16:31]
 v_exp_f32 v68, v68
 v_exp_f32 v69, v69
 ds_read_b128 a[132:135], v9 offset:6080
 v_exp_f32 v70, v70
 v_exp_f32 v71, v71
 v_cvt_pk_bf16_f32 v88, v64, v65
 v_cvt_pk_bf16_f32 v89, v66, v67
 v_mfma_f32_32x32x16_bf16 v[48:63], a[140:143], a[28:31], v[48:63]
 v_exp_f32 v72, v72
 v_exp_f32 v73, v73
 ds_read_b128 a[136:139], v9 offset:6688
 v_exp_f32 v74, v74
 v_exp_f32 v75, v75
 v_cvt_pk_bf16_f32 v90, v68, v69
 v_cvt_pk_bf16_f32 v91, v70, v71
 v_mfma_f32_32x32x16_bf16 a[72:87], a[128:131], v[84:87], a[72:87]
 v_exp_f32 v76, v76
 v_exp_f32 v77, v77
 v_exp_f32 v78, v78
 v_exp_f32 v79, v79
 v_cvt_pk_bf16_f32 v92, v72, v73
 v_cvt_pk_bf16_f32 v93, v74, v75
 v_mfma_f32_32x32x16_bf16 a[88:103], a[124:127], v[88:91], a[88:103]
 v_exp_f32 v48, v48
 v_exp_f32 v49, v49
 v_cvt_pk_bf16_f32 v94, v76, v77
 v_cvt_pk_bf16_f32 v95, v78, v79
 v_exp_f32 v50, v50
 v_exp_f32 v51, v51
 v_mfma_f32_32x32x16_bf16 v[64:79], a[112:115], a[4:7], v[32:47]
 v_exp_f32 v52, v52
 v_exp_f32 v53, v53
 ds_read_b128 a[108:111], v5 offset:7168
 v_exp_f32 v54, v54
 v_exp_f32 v55, v55
 v_cvt_pk_bf16_f32 v80, v48, v49
 v_cvt_pk_bf16_f32 v81, v50, v51
 v_mfma_f32_32x32x16_bf16 v[64:79], a[140:143], a[60:63], v[64:79]
 v_exp_f32 v56, v56
 v_exp_f32 v57, v57
 s_add_u32 s30, s87, 12288
 buffer_load_dwordx4 a[216:219], v1, s[4:7], s30 offen sc1
 v_exp_f32 v58, v58
 v_exp_f32 v59, v59
 v_cvt_pk_bf16_f32 v82, v52, v53
 v_cvt_pk_bf16_f32 v83, v54, v55
 v_mfma_f32_32x32x16_bf16 a[88:103], a[128:131], v[92:95], a[88:103]
 v_exp_f32 v60, v60
 v_exp_f32 v61, v61
 v_exp_f32 v62, v62
 v_exp_f32 v63, v63
 v_cvt_pk_bf16_f32 v84, v56, v57
 v_cvt_pk_bf16_f32 v85, v58, v59
 s_waitcnt lgkmcnt(1)
 v_mfma_f32_32x32x16_bf16 a[72:87], a[132:135], v[80:83], a[72:87]
 v_exp_f32 v64, v64
 v_exp_f32 v65, v65
 v_cvt_pk_bf16_f32 v86, v60, v61
 v_cvt_pk_bf16_f32 v87, v62, v63
 v_exp_f32 v66, v66
 v_exp_f32 v67, v67
 v_mfma_f32_32x32x16_bf16 v[48:63], a[104:107], a[0:3], v[16:31]
 v_exp_f32 v68, v68
 v_exp_f32 v69, v69
 ds_read_b128 a[116:119], v9 offset:7296
 v_exp_f32 v70, v70
 v_exp_f32 v71, v71
 v_cvt_pk_bf16_f32 v88, v64, v65
 v_cvt_pk_bf16_f32 v89, v66, v67
 v_mfma_f32_32x32x16_bf16 v[48:63], a[140:143], a[32:35], v[48:63]
 v_exp_f32 v72, v72
 v_exp_f32 v73, v73
 ds_read_b128 a[120:123], v9 offset:7904
 s_waitcnt vmcnt(14)
 ds_write_b128 v115, v[184:187]
 ds_write_b128 v115, v[188:191] offset:1024
 v_exp_f32 v74, v74
 v_exp_f32 v75, v75
 v_cvt_pk_bf16_f32 v90, v68, v69
 v_cvt_pk_bf16_f32 v91, v70, v71
 v_mfma_f32_32x32x16_bf16 a[72:87], a[136:139], v[84:87], a[72:87]
 v_exp_f32 v76, v76
 v_exp_f32 v77, v77
 v_exp_f32 v78, v78
 v_exp_f32 v79, v79
 v_cvt_pk_bf16_f32 v92, v72, v73
 v_cvt_pk_bf16_f32 v93, v74, v75
 v_mfma_f32_32x32x16_bf16 a[88:103], a[132:135], v[88:91], a[88:103]
 v_exp_f32 v48, v48
 v_exp_f32 v49, v49
 v_cvt_pk_bf16_f32 v94, v76, v77
 v_cvt_pk_bf16_f32 v95, v78, v79
 v_exp_f32 v50, v50
 v_exp_f32 v51, v51
 v_mfma_f32_32x32x16_bf16 v[64:79], a[104:107], a[4:7], v[32:47]
 v_exp_f32 v52, v52
 v_exp_f32 v53, v53
 ds_read_b128 a[112:115], v5 offset:18944
 ds_read_b128 a[144:147], v5 offset:27136
 v_exp_f32 v54, v54
 v_exp_f32 v55, v55
 v_cvt_pk_bf16_f32 v80, v48, v49
 v_cvt_pk_bf16_f32 v81, v50, v51
 v_mfma_f32_32x32x16_bf16 v[64:79], a[140:143], a[64:67], v[64:79]
 v_exp_f32 v56, v56
 v_exp_f32 v57, v57
 s_add_u32 s30, s87, 30720
 buffer_load_dwordx4 a[220:223], v1, s[4:7], s30 offen sc1
 v_exp_f32 v58, v58
 v_exp_f32 v59, v59
 v_cvt_pk_bf16_f32 v82, v52, v53
 v_cvt_pk_bf16_f32 v83, v54, v55
 v_mfma_f32_32x32x16_bf16 a[88:103], a[136:139], v[92:95], a[88:103]
 v_exp_f32 v60, v60
 v_exp_f32 v61, v61
 v_exp_f32 v62, v62
 v_exp_f32 v63, v63
 v_cvt_pk_bf16_f32 v84, v56, v57
 v_cvt_pk_bf16_f32 v85, v58, v59
 s_waitcnt lgkmcnt(4)
 v_mfma_f32_32x32x16_bf16 a[72:87], a[116:119], v[80:83], a[72:87]
 v_exp_f32 v64, v64
 v_exp_f32 v65, v65
 v_cvt_pk_bf16_f32 v86, v60, v61
 v_cvt_pk_bf16_f32 v87, v62, v63
 v_exp_f32 v66, v66
 v_exp_f32 v67, v67
 v_mfma_f32_32x32x16_bf16 v[48:63], a[108:111], a[0:3], v[16:31]
 v_exp_f32 v68, v68
 v_exp_f32 v69, v69
 ds_read_b128 a[124:127], v9 offset:8512
 v_exp_f32 v70, v70
 v_exp_f32 v71, v71
 v_cvt_pk_bf16_f32 v88, v64, v65
 v_cvt_pk_bf16_f32 v89, v66, v67
 v_mfma_f32_32x32x16_bf16 v[48:63], a[140:143], a[36:39], v[48:63]
 v_exp_f32 v72, v72
 v_exp_f32 v73, v73
 ds_read_b128 a[128:131], v9 offset:9120
 s_waitcnt lgkmcnt(4)
 ds_read_b64_tr_b16 v[192:193], v117 offset:0
 ds_read_b64_tr_b16 v[194:195], v117 offset:512
 ds_read_b64_tr_b16 v[196:197], v117 offset:64
 ds_read_b64_tr_b16 v[198:199], v117 offset:576
 v_exp_f32 v74, v74
 v_exp_f32 v75, v75
 v_cvt_pk_bf16_f32 v90, v68, v69
 v_cvt_pk_bf16_f32 v91, v70, v71
 v_mfma_f32_32x32x16_bf16 a[72:87], a[120:123], v[84:87], a[72:87]
 v_exp_f32 v76, v76
 v_exp_f32 v77, v77
 v_exp_f32 v78, v78
 v_exp_f32 v79, v79
 v_cvt_pk_bf16_f32 v92, v72, v73
 v_cvt_pk_bf16_f32 v93, v74, v75
 v_mfma_f32_32x32x16_bf16 a[88:103], a[116:119], v[88:91], a[88:103]
 v_exp_f32 v48, v48
 v_exp_f32 v49, v49
 v_cvt_pk_bf16_f32 v94, v76, v77
 v_cvt_pk_bf16_f32 v95, v78, v79
 v_exp_f32 v50, v50
 v_exp_f32 v51, v51
 v_mfma_f32_32x32x16_bf16 v[64:79], a[108:111], a[4:7], v[32:47]
 v_exp_f32 v52, v52
 v_exp_f32 v53, v53
 ds_read_b128 a[104:107], v5 offset:19968
 v_exp_f32 v54, v54
 v_exp_f32 v55, v55
 v_cvt_pk_bf16_f32 v80, v48, v49
 v_cvt_pk_bf16_f32 v81, v50, v51
 v_mfma_f32_32x32x16_bf16 v[64:79], a[140:143], a[68:71], v[64:79]
 v_exp_f32 v56, v56
 v_exp_f32 v57, v57
 s_add_u32 s30, s87, 49152
 buffer_load_dwordx4 a[224:227], v1, s[4:7], s30 offen sc1
 v_exp_f32 v58, v58
 v_exp_f32 v59, v59
 v_cvt_pk_bf16_f32 v82, v52, v53
 v_cvt_pk_bf16_f32 v83, v54, v55
 v_mfma_f32_32x32x16_bf16 a[88:103], a[120:123], v[92:95], a[88:103]
 v_exp_f32 v60, v60
 v_exp_f32 v61, v61
 v_exp_f32 v62, v62
 v_exp_f32 v63, v63
 v_cvt_pk_bf16_f32 v84, v56, v57
 v_cvt_pk_bf16_f32 v85, v58, v59
 s_waitcnt lgkmcnt(5)
 v_mfma_f32_32x32x16_bf16 a[72:87], a[124:127], v[80:83], a[72:87]
 v_exp_f32 v64, v64
 v_exp_f32 v65, v65
 v_cvt_pk_bf16_f32 v86, v60, v61
 v_cvt_pk_bf16_f32 v87, v62, v63
 v_exp_f32 v66, v66
 v_exp_f32 v67, v67
 v_mfma_f32_32x32x16_bf16 v[48:63], a[112:115], a[0:3], v[16:31]
 v_exp_f32 v68, v68
 v_exp_f32 v69, v69
 ds_read_b128 a[132:135], v9 offset:18944
 v_exp_f32 v70, v70
 v_exp_f32 v71, v71
 v_cvt_pk_bf16_f32 v88, v64, v65
 v_cvt_pk_bf16_f32 v89, v66, v67
 v_mfma_f32_32x32x16_bf16 v[48:63], a[144:147], a[8:11], v[48:63]
 v_exp_f32 v72, v72
 v_exp_f32 v73, v73
 ds_read_b128 a[136:139], v9 offset:19552
 s_waitcnt lgkmcnt(3)
 buffer_store_dwordx4 v[192:195], v114, s[4:7], s36 offen sc1
 s_add_u32 s30, s36, s17
 buffer_store_dwordx4 v[196:199], v114, s[4:7], s30 offen sc1
 s_add_u32 s36, s36, s37
 v_exp_f32 v74, v74
 v_exp_f32 v75, v75
 v_cvt_pk_bf16_f32 v90, v68, v69
 v_cvt_pk_bf16_f32 v91, v70, v71
 v_mfma_f32_32x32x16_bf16 a[72:87], a[128:131], v[84:87], a[72:87]
 v_exp_f32 v76, v76
 v_exp_f32 v77, v77
 v_exp_f32 v78, v78
 v_exp_f32 v79, v79
 v_cvt_pk_bf16_f32 v92, v72, v73
 v_cvt_pk_bf16_f32 v93, v74, v75
 v_mfma_f32_32x32x16_bf16 a[88:103], a[124:127], v[88:91], a[88:103]
 v_exp_f32 v48, v48
 v_exp_f32 v49, v49
 v_cvt_pk_bf16_f32 v94, v76, v77
 v_cvt_pk_bf16_f32 v95, v78, v79
 v_exp_f32 v50, v50
 v_exp_f32 v51, v51
 v_mfma_f32_32x32x16_bf16 v[64:79], a[112:115], a[4:7], v[32:47]
 v_exp_f32 v52, v52
 v_exp_f32 v53, v53
 ds_read_b128 a[108:111], v5 offset:20992
 v_exp_f32 v54, v54
 v_exp_f32 v55, v55
 v_cvt_pk_bf16_f32 v80, v48, v49
 v_cvt_pk_bf16_f32 v81, v50, v51
 v_mfma_f32_32x32x16_bf16 v[64:79], a[144:147], a[40:43], v[64:79]
 v_exp_f32 v56, v56
 v_exp_f32 v57, v57
 s_add_u32 s30, s87, 67584
 buffer_load_dwordx4 a[228:231], v1, s[4:7], s30 offen sc1
 v_exp_f32 v58, v58
 v_exp_f32 v59, v59
 v_cvt_pk_bf16_f32 v82, v52, v53
 v_cvt_pk_bf16_f32 v83, v54, v55
 v_mfma_f32_32x32x16_bf16 a[88:103], a[128:131], v[92:95], a[88:103]
 v_exp_f32 v60, v60
 v_exp_f32 v61, v61
 v_exp_f32 v62, v62
 v_exp_f32 v63, v63
 v_cvt_pk_bf16_f32 v84, v56, v57
 v_cvt_pk_bf16_f32 v85, v58, v59
 s_waitcnt lgkmcnt(1)
 v_mfma_f32_32x32x16_bf16 a[72:87], a[132:135], v[80:83], a[72:87]
 v_exp_f32 v64, v64
 v_exp_f32 v65, v65
 v_cvt_pk_bf16_f32 v86, v60, v61
 v_cvt_pk_bf16_f32 v87, v62, v63
 v_exp_f32 v66, v66
 v_exp_f32 v67, v67
 v_mfma_f32_32x32x16_bf16 v[48:63], a[104:107], a[0:3], v[16:31]
 v_exp_f32 v68, v68
 v_exp_f32 v69, v69
 ds_read_b128 a[116:119], v9 offset:20160
 v_exp_f32 v70, v70
 v_exp_f32 v71, v71
 v_cvt_pk_bf16_f32 v88, v64, v65
 v_cvt_pk_bf16_f32 v89, v66, v67
 v_mfma_f32_32x32x16_bf16 v[48:63], a[144:147], a[12:15], v[48:63]
 v_exp_f32 v72, v72
 v_exp_f32 v73, v73
 ds_read_b128 a[120:123], v9 offset:20768
 v_dot2_f32_bf16 v116, v192, s19, v116
 v_dot2_f32_bf16 v116, v193, s19, v116
 v_dot2_f32_bf16 v116, v194, s19, v116
 v_dot2_f32_bf16 v116, v195, s19, v116
 v_dot2_f32_bf16 v118, v196, s19, v118
 v_dot2_f32_bf16 v118, v197, s19, v118
 v_dot2_f32_bf16 v118, v198, s19, v118
 v_dot2_f32_bf16 v118, v199, s19, v118
 v_exp_f32 v74, v74
 v_exp_f32 v75, v75
 v_cvt_pk_bf16_f32 v90, v68, v69
 v_cvt_pk_bf16_f32 v91, v70, v71
 v_mfma_f32_32x32x16_bf16 a[72:87], a[136:139], v[84:87], a[72:87]
 v_exp_f32 v76, v76
 v_exp_f32 v77, v77
 v_exp_f32 v78, v78
 v_exp_f32 v79, v79
 v_cvt_pk_bf16_f32 v92, v72, v73
 v_cvt_pk_bf16_f32 v93, v74, v75
 v_mfma_f32_32x32x16_bf16 a[88:103], a[132:135], v[88:91], a[88:103]
 v_exp_f32 v48, v48
 v_exp_f32 v49, v49
 v_cvt_pk_bf16_f32 v94, v76, v77
 v_cvt_pk_bf16_f32 v95, v78, v79
 v_exp_f32 v50, v50
 v_exp_f32 v51, v51
 v_mfma_f32_32x32x16_bf16 v[64:79], a[104:107], a[4:7], v[32:47]
 v_exp_f32 v52, v52
 v_exp_f32 v53, v53
 ds_read_b128 a[112:115], v5 offset:22016
 v_exp_f32 v54, v54
 v_exp_f32 v55, v55
 v_cvt_pk_bf16_f32 v80, v48, v49
 v_cvt_pk_bf16_f32 v81, v50, v51
 v_mfma_f32_32x32x16_bf16 v[64:79], a[144:147], a[44:47], v[64:79]
 v_exp_f32 v56, v56
 v_exp_f32 v57, v57
 s_add_u32 s30, s87, 86016
 buffer_load_dwordx4 a[232:235], v1, s[4:7], s30 offen sc1
 v_exp_f32 v58, v58
 v_exp_f32 v59, v59
 v_cvt_pk_bf16_f32 v82, v52, v53
 v_cvt_pk_bf16_f32 v83, v54, v55
 v_mfma_f32_32x32x16_bf16 a[88:103], a[136:139], v[92:95], a[88:103]
 v_exp_f32 v60, v60
 v_exp_f32 v61, v61
 v_exp_f32 v62, v62
 v_exp_f32 v63, v63
 v_cvt_pk_bf16_f32 v84, v56, v57
 v_cvt_pk_bf16_f32 v85, v58, v59
 s_waitcnt lgkmcnt(1)
 v_mfma_f32_32x32x16_bf16 a[72:87], a[116:119], v[80:83], a[72:87]
 v_exp_f32 v64, v64
 v_exp_f32 v65, v65
 v_cvt_pk_bf16_f32 v86, v60, v61
 v_cvt_pk_bf16_f32 v87, v62, v63
 v_exp_f32 v66, v66
 v_exp_f32 v67, v67
 v_mfma_f32_32x32x16_bf16 v[48:63], a[108:111], a[0:3], v[16:31]
 v_exp_f32 v68, v68
 v_exp_f32 v69, v69
 ds_read_b128 a[124:127], v9 offset:21376
 v_exp_f32 v70, v70
 v_exp_f32 v71, v71
 v_cvt_pk_bf16_f32 v88, v64, v65
 v_cvt_pk_bf16_f32 v89, v66, v67
 v_mfma_f32_32x32x16_bf16 v[48:63], a[144:147], a[16:19], v[48:63]
 v_exp_f32 v72, v72
 v_exp_f32 v73, v73
 ds_read_b128 a[128:131], v9 offset:21984
 v_exp_f32 v74, v74
 v_exp_f32 v75, v75
 v_cvt_pk_bf16_f32 v90, v68, v69
 v_cvt_pk_bf16_f32 v91, v70, v71
 v_mfma_f32_32x32x16_bf16 a[72:87], a[120:123], v[84:87], a[72:87]
 v_exp_f32 v76, v76
 v_exp_f32 v77, v77
 v_exp_f32 v78, v78
 v_exp_f32 v79, v79
 v_cvt_pk_bf16_f32 v92, v72, v73
 v_cvt_pk_bf16_f32 v93, v74, v75
 v_mfma_f32_32x32x16_bf16 a[88:103], a[116:119], v[88:91], a[88:103]
 v_exp_f32 v48, v48
 v_exp_f32 v49, v49
 v_cvt_pk_bf16_f32 v94, v76, v77
 v_cvt_pk_bf16_f32 v95, v78, v79
 v_exp_f32 v50, v50
 v_exp_f32 v51, v51
 v_mfma_f32_32x32x16_bf16 v[64:79], a[108:111], a[4:7], v[32:47]
 v_exp_f32 v52, v52
 v_exp_f32 v53, v53
 ds_read_b128 a[104:107], v5 offset:23040
 v_exp_f32 v54, v54
 v_exp_f32 v55, v55
 v_cvt_pk_bf16_f32 v80, v48, v49
 v_cvt_pk_bf16_f32 v81, v50, v51
 v_mfma_f32_32x32x16_bf16 v[64:79], a[144:147], a[48:51], v[64:79]
 v_exp_f32 v56, v56
 v_exp_f32 v57, v57
 s_add_u32 s30, s87, 16384
 buffer_load_dwordx4 a[236:239], v1, s[4:7], s30 offen sc1
 v_exp_f32 v58, v58
 v_exp_f32 v59, v59
 v_cvt_pk_bf16_f32 v82, v52, v53
 v_cvt_pk_bf16_f32 v83, v54, v55
 v_mfma_f32_32x32x16_bf16 a[88:103], a[120:123], v[92:95], a[88:103]
 v_exp_f32 v60, v60
 v_exp_f32 v61, v61
 v_exp_f32 v62, v62
 v_exp_f32 v63, v63
 v_cvt_pk_bf16_f32 v84, v56, v57
 v_cvt_pk_bf16_f32 v85, v58, v59
 s_waitcnt lgkmcnt(1)
 v_mfma_f32_32x32x16_bf16 a[72:87], a[124:127], v[80:83], a[72:87]
 v_exp_f32 v64, v64
 v_exp_f32 v65, v65
 v_cvt_pk_bf16_f32 v86, v60, v61
 v_cvt_pk_bf16_f32 v87, v62, v63
 v_exp_f32 v66, v66
 v_exp_f32 v67, v67
 v_mfma_f32_32x32x16_bf16 v[48:63], a[112:115], a[0:3], v[16:31]
 v_exp_f32 v68, v68
 v_exp_f32 v69, v69
 ds_read_b128 a[132:135], v9 offset:22592
 v_exp_f32 v70, v70
 v_exp_f32 v71, v71
 v_cvt_pk_bf16_f32 v88, v64, v65
 v_cvt_pk_bf16_f32 v89, v66, v67
 v_mfma_f32_32x32x16_bf16 v[48:63], a[144:147], a[20:23], v[48:63]
 v_exp_f32 v72, v72
 v_exp_f32 v73, v73
 ds_read_b128 a[136:139], v9 offset:23200
 ds_write_b32 v119, v116
 ds_write_b32 v119, v118 offset:1024
 s_waitcnt vmcnt(3) lgkmcnt(0)
 s_barrier
 v_and_b32 v120, 31, v0
 v_lshlrev_b32 v120, 2, v120
 s_and_b32 s30, s3, 1
 s_lshl_b32 s30, s30, 10
 s_add_u32 s30, s30, 159744
 v_add_u32 v120, s30, v120
 ds_read_b32 v128, v120 offset:0
 ds_read_b32 v129, v120 offset:128
 ds_read_b32 v130, v120 offset:256
 ds_read_b32 v131, v120 offset:384
 ds_read_b32 v132, v120 offset:512
 ds_read_b32 v133, v120 offset:640
 ds_read_b32 v134, v120 offset:768
 ds_read_b32 v135, v120 offset:896
 v_exp_f32 v74, v74
 v_exp_f32 v75, v75
 v_cvt_pk_bf16_f32 v90, v68, v69
 v_cvt_pk_bf16_f32 v91, v70, v71
 v_mfma_f32_32x32x16_bf16 a[72:87], a[128:131], v[84:87], a[72:87]
 v_exp_f32 v76, v76
 v_exp_f32 v77, v77
 v_exp_f32 v78, v78
 v_exp_f32 v79, v79
 v_cvt_pk_bf16_f32 v92, v72, v73
 v_cvt_pk_bf16_f32 v93, v74, v75
 v_mfma_f32_32x32x16_bf16 a[88:103], a[124:127], v[88:91], a[88:103]
 v_exp_f32 v48, v48
 v_exp_f32 v49, v49
 v_cvt_pk_bf16_f32 v94, v76, v77
 v_cvt_pk_bf16_f32 v95, v78, v79
 v_exp_f32 v50, v50
 v_exp_f32 v51, v51
 v_mfma_f32_32x32x16_bf16 v[64:79], a[112:115], a[4:7], v[32:47]
 v_exp_f32 v52, v52
 v_exp_f32 v53, v53
 ds_read_b128 a[108:111], v5 offset:24064
 v_exp_f32 v54, v54
 v_exp_f32 v55, v55
 v_cvt_pk_bf16_f32 v80, v48, v49
 v_cvt_pk_bf16_f32 v81, v50, v51
 v_mfma_f32_32x32x16_bf16 v[64:79], a[144:147], a[52:55], v[64:79]
 v_exp_f32 v56, v56
 v_exp_f32 v57, v57
 s_add_u32 s30, s87, 34816
 buffer_load_dwordx4 a[240:243], v1, s[4:7], s30 offen sc1
 v_exp_f32 v58, v58
 v_exp_f32 v59, v59
 v_cvt_pk_bf16_f32 v82, v52, v53
 v_cvt_pk_bf16_f32 v83, v54, v55
 v_mfma_f32_32x32x16_bf16 a[88:103], a[128:131], v[92:95], a[88:103]
 v_exp_f32 v60, v60
 v_exp_f32 v61, v61
 v_exp_f32 v62, v62
 v_exp_f32 v63, v63
 v_cvt_pk_bf16_f32 v84, v56, v57
 v_cvt_pk_bf16_f32 v85, v58, v59
 v_mfma_f32_32x32x16_bf16 a[72:87], a[132:135], v[80:83], a[72:87]
 v_exp_f32 v64, v64
 v_exp_f32 v65, v65
 v_cvt_pk_bf16_f32 v86, v60, v61
 v_cvt_pk_bf16_f32 v87, v62, v63
 v_exp_f32 v66, v66
 v_exp_f32 v67, v67
 v_mfma_f32_32x32x16_bf16 v[48:63], a[104:107], a[0:3], v[16:31]
 v_exp_f32 v68, v68
 v_exp_f32 v69, v69
 ds_read_b128 a[116:119], v9 offset:23808
 v_exp_f32 v70, v70
 v_exp_f32 v71, v71
 v_cvt_pk_bf16_f32 v88, v64, v65
 v_cvt_pk_bf16_f32 v89, v66, v67
 v_mfma_f32_32x32x16_bf16 v[48:63], a[144:147], a[24:27], v[48:63]
 v_exp_f32 v72, v72
 v_exp_f32 v73, v73
 ds_read_b128 a[120:123], v9 offset:24416
 s_waitcnt lgkmcnt(3)
 v_add_f32 v128, v128, v129
 v_add_f32 v130, v130, v131
 v_add_f32 v132, v132, v133
 v_add_f32 v134, v134, v135
 v_add_f32 v128, v128, v130
 v_add_f32 v132, v132, v134
 v_add_f32 v128, v128, v132
 v_sub_f32 v128, 0, v128
 v_cvt_pk_bf16_f32 v129, v128, v128
 v_lshlrev_b32 v129, 16, v129
 v_sub_f32 v128, v128, v129
 v_cvt_pk_bf16_f32 v130, v128, v128
 v_lshlrev_b32 v130, 16, v130
 v_sub_f32 v131, v128, v130
 v_cvt_pk_bf16_f32 v132, v129, v130
 v_cvt_pk_bf16_f32 v133, v129, v131
 v_cvt_pk_bf16_f32 v134, v130, v129
 v_mov_b32 v135, 0
 v_cmp_gt_u32 vcc, 512, v1
 s_nop 1
 v_cndmask_b32 v132, 0, v132, vcc
 v_cndmask_b32 v133, 0, v133, vcc
 v_cndmask_b32 v134, 0, v134, vcc
 s_and_b32 s30, s3, 1
 s_mul_i32 s30, s30, s17
 s_add_u32 s30, s30, s16
 buffer_store_dwordx4 v[132:135], v114, s[4:7], s30 offen sc1
 v_exp_f32 v74, v74
 v_exp_f32 v75, v75
 v_cvt_pk_bf16_f32 v90, v68, v69
 v_cvt_pk_bf16_f32 v91, v70, v71
 v_mfma_f32_32x32x16_bf16 a[72:87], a[136:139], v[84:87], a[72:87]
 v_exp_f32 v76, v76
 v_exp_f32 v77, v77
 v_exp_f32 v78, v78
 v_exp_f32 v79, v79
 v_cvt_pk_bf16_f32 v92, v72, v73
 v_cvt_pk_bf16_f32 v93, v74, v75
 v_mfma_f32_32x32x16_bf16 a[88:103], a[132:135], v[88:91], a[88:103]
 v_exp_f32 v48, v48
 v_exp_f32 v49, v49
 v_cvt_pk_bf16_f32 v94, v76, v77
 v_cvt_pk_bf16_f32 v95, v78, v79
 v_exp_f32 v50, v50
 v_exp_f32 v51, v51
 v_mfma_f32_32x32x16_bf16 v[64:79], a[104:107], a[4:7], v[32:47]
 v_exp_f32 v52, v52
 v_exp_f32 v53, v53
 ds_read_b128 a[112:115], v5 offset:25088
 v_exp_f32 v54, v54
 v_exp_f32 v55, v55
 v_cvt_pk_bf16_f32 v80, v48, v49
 v_cvt_pk_bf16_f32 v81, v50, v51
 v_mfma_f32_32x32x16_bf16 v[64:79], a[144:147], a[56:59], v[64:79]
 v_exp_f32 v56, v56
 v_exp_f32 v57, v57
 s_add_u32 s30, s87, 53248
 buffer_load_dwordx4 a[244:247], v1, s[4:7], s30 offen sc1
 v_exp_f32 v58, v58
 v_exp_f32 v59, v59
 v_cvt_pk_bf16_f32 v82, v52, v53
 v_cvt_pk_bf16_f32 v83, v54, v55
 v_mfma_f32_32x32x16_bf16 a[88:103], a[136:139], v[92:95], a[88:103]
 v_exp_f32 v60, v60
 v_exp_f32 v61, v61
 v_exp_f32 v62, v62
 v_exp_f32 v63, v63
 v_cvt_pk_bf16_f32 v84, v56, v57
 v_cvt_pk_bf16_f32 v85, v58, v59
 s_waitcnt lgkmcnt(1)
 v_mfma_f32_32x32x16_bf16 a[72:87], a[116:119], v[80:83], a[72:87]
 v_exp_f32 v64, v64
 v_exp_f32 v65, v65
 v_cvt_pk_bf16_f32 v86, v60, v61
 v_cvt_pk_bf16_f32 v87, v62, v63
 v_exp_f32 v66, v66
 v_exp_f32 v67, v67
 v_mfma_f32_32x32x16_bf16 v[48:63], a[108:111], a[0:3], v[16:31]
 v_exp_f32 v68, v68
 v_exp_f32 v69, v69
 ds_read_b128 a[124:127], v9 offset:25024
 v_exp_f32 v70, v70
 v_exp_f32 v71, v71
 v_cvt_pk_bf16_f32 v88, v64, v65
 v_cvt_pk_bf16_f32 v89, v66, v67
 v_mfma_f32_32x32x16_bf16 v[48:63], a[144:147], a[28:31], v[48:63]
 v_exp_f32 v72, v72
 v_exp_f32 v73, v73
 ds_read_b128 a[128:131], v9 offset:25632
 v_exp_f32 v74, v74
 v_exp_f32 v75, v75
 v_cvt_pk_bf16_f32 v90, v68, v69
 v_cvt_pk_bf16_f32 v91, v70, v71
 v_mfma_f32_32x32x16_bf16 a[72:87], a[120:123], v[84:87], a[72:87]
 v_exp_f32 v76, v76
 v_exp_f32 v77, v77
 v_exp_f32 v78, v78
 v_exp_f32 v79, v79
 v_cvt_pk_bf16_f32 v92, v72, v73
 v_cvt_pk_bf16_f32 v93, v74, v75
 v_mfma_f32_32x32x16_bf16 a[88:103], a[116:119], v[88:91], a[88:103]
 v_exp_f32 v48, v48
 v_exp_f32 v49, v49
 v_cvt_pk_bf16_f32 v94, v76, v77
 v_cvt_pk_bf16_f32 v95, v78, v79
 v_exp_f32 v50, v50
 v_exp_f32 v51, v51
 v_mfma_f32_32x32x16_bf16 v[64:79], a[108:111], a[4:7], v[32:47]
 v_exp_f32 v52, v52
 v_exp_f32 v53, v53
 ds_read_b128 a[104:107], v5 offset:26112
 v_exp_f32 v54, v54
 v_exp_f32 v55, v55
 v_cvt_pk_bf16_f32 v80, v48, v49
 v_cvt_pk_bf16_f32 v81, v50, v51
 v_mfma_f32_32x32x16_bf16 v[64:79], a[144:147], a[60:63], v[64:79]
 v_exp_f32 v56, v56
 v_exp_f32 v57, v57
 s_add_u32 s30, s87, 71680
 buffer_load_dwordx4 a[248:251], v1, s[4:7], s30 offen sc1
 v_exp_f32 v58, v58
 v_exp_f32 v59, v59
 v_cvt_pk_bf16_f32 v82, v52, v53
 v_cvt_pk_bf16_f32 v83, v54, v55
 v_mfma_f32_32x32x16_bf16 a[88:103], a[120:123], v[92:95], a[88:103]
 v_exp_f32 v60, v60
 v_exp_f32 v61, v61
 v_exp_f32 v62, v62
 v_exp_f32 v63, v63
 v_cvt_pk_bf16_f32 v84, v56, v57
 v_cvt_pk_bf16_f32 v85, v58, v59
 s_waitcnt lgkmcnt(1)
 v_mfma_f32_32x32x16_bf16 a[72:87], a[124:127], v[80:83], a[72:87]
 v_exp_f32 v64, v64
 v_exp_f32 v65, v65
 v_cvt_pk_bf16_f32 v86, v60, v61
 v_cvt_pk_bf16_f32 v87, v62, v63
 v_exp_f32 v66, v66
 v_exp_f32 v67, v67
 v_mfma_f32_32x32x16_bf16 v[48:63], a[112:115], a[0:3], v[16:31]
 v_exp_f32 v68, v68
 v_exp_f32 v69, v69
 ds_read_b128 a[132:135], v9 offset:26240
 v_exp_f32 v70, v70
 v_exp_f32 v71, v71
 v_cvt_pk_bf16_f32 v88, v64, v65
 v_cvt_pk_bf16_f32 v89, v66, v67
 v_mfma_f32_32x32x16_bf16 v[48:63], a[144:147], a[32:35], v[48:63]
 v_exp_f32 v72, v72
 v_exp_f32 v73, v73
 ds_read_b128 a[136:139], v9 offset:26848
 v_exp_f32 v74, v74
 v_exp_f32 v75, v75
 v_cvt_pk_bf16_f32 v90, v68, v69
 v_cvt_pk_bf16_f32 v91, v70, v71
 v_mfma_f32_32x32x16_bf16 a[72:87], a[128:131], v[84:87], a[72:87]
 v_exp_f32 v76, v76
 v_exp_f32 v77, v77
 v_exp_f32 v78, v78
 v_exp_f32 v79, v79
 v_cvt_pk_bf16_f32 v92, v72, v73
 v_cvt_pk_bf16_f32 v93, v74, v75
 v_mfma_f32_32x32x16_bf16 a[88:103], a[124:127], v[88:91], a[88:103]
 v_exp_f32 v48, v48
 v_exp_f32 v49, v49
 v_cvt_pk_bf16_f32 v94, v76, v77
 v_cvt_pk_bf16_f32 v95, v78, v79
 v_exp_f32 v50, v50
 v_exp_f32 v51, v51
 v_mfma_f32_32x32x16_bf16 v[64:79], a[112:115], a[4:7], v[32:47]
 v_exp_f32 v52, v52
 v_exp_f32 v53, v53
 v_exp_f32 v54, v54
 v_exp_f32 v55, v55
 v_cvt_pk_bf16_f32 v80, v48, v49
 v_cvt_pk_bf16_f32 v81, v50, v51
 v_mfma_f32_32x32x16_bf16 v[64:79], a[144:147], a[64:67], v[64:79]
 v_exp_f32 v56, v56
 v_exp_f32 v57, v57
 s_add_u32 s30, s87, 90112
 buffer_load_dwordx4 a[252:255], v1, s[4:7], s30 offen sc1
 v_exp_f32 v58, v58
 v_exp_f32 v59, v59
 v_cvt_pk_bf16_f32 v82, v52, v53
 v_cvt_pk_bf16_f32 v83, v54, v55
 v_mfma_f32_32x32x16_bf16 a[88:103], a[128:131], v[92:95], a[88:103]
 v_exp_f32 v60, v60
 v_exp_f32 v61, v61
 v_exp_f32 v62, v62
 v_exp_f32 v63, v63
 v_cvt_pk_bf16_f32 v84, v56, v57
 v_cvt_pk_bf16_f32 v85, v58, v59
 s_waitcnt lgkmcnt(0)
 v_mfma_f32_32x32x16_bf16 a[72:87], a[132:135], v[80:83], a[72:87]
 v_exp_f32 v64, v64
 v_exp_f32 v65, v65
 v_cvt_pk_bf16_f32 v86, v60, v61
 v_cvt_pk_bf16_f32 v87, v62, v63
 v_exp_f32 v66, v66
 v_exp_f32 v67, v67
 v_mfma_f32_32x32x16_bf16 v[48:63], a[104:107], a[0:3], v[16:31]
 v_exp_f32 v68, v68
 v_exp_f32 v69, v69
 ds_read_b128 a[116:119], v9 offset:27456
 v_exp_f32 v70, v70
 v_exp_f32 v71, v71
 v_cvt_pk_bf16_f32 v88, v64, v65
 v_cvt_pk_bf16_f32 v89, v66, v67
 v_mfma_f32_32x32x16_bf16 v[48:63], a[144:147], a[36:39], v[48:63]
 v_exp_f32 v72, v72
 v_exp_f32 v73, v73
 ds_read_b128 a[120:123], v9 offset:28064
 v_exp_f32 v74, v74
 v_exp_f32 v75, v75
 v_cvt_pk_bf16_f32 v90, v68, v69
 v_cvt_pk_bf16_f32 v91, v70, v71
 v_mfma_f32_32x32x16_bf16 a[72:87], a[136:139], v[84:87], a[72:87]
 v_exp_f32 v76, v76
 v_exp_f32 v77, v77
 v_exp_f32 v78, v78
 v_exp_f32 v79, v79
 v_cvt_pk_bf16_f32 v92, v72, v73
 v_cvt_pk_bf16_f32 v93, v74, v75
 v_mfma_f32_32x32x16_bf16 a[88:103], a[132:135], v[88:91], a[88:103]
 v_exp_f32 v48, v48
 v_exp_f32 v49, v49
 v_cvt_pk_bf16_f32 v94, v76, v77
 v_cvt_pk_bf16_f32 v95, v78, v79
 v_exp_f32 v50, v50
 v_exp_f32 v51, v51
 v_mfma_f32_32x32x16_bf16 v[64:79], a[104:107], a[4:7], v[32:47]
 v_exp_f32 v52, v52
 v_exp_f32 v53, v53
 v_exp_f32 v54, v54
 v_exp_f32 v55, v55
 v_cvt_pk_bf16_f32 v80, v48, v49
 v_cvt_pk_bf16_f32 v81, v50, v51
 v_mfma_f32_32x32x16_bf16 v[64:79], a[144:147], a[68:71], v[64:79]
 v_exp_f32 v56, v56
 v_exp_f32 v57, v57
 v_exp_f32 v58, v58
 v_exp_f32 v59, v59
 v_cvt_pk_bf16_f32 v82, v52, v53
 v_cvt_pk_bf16_f32 v83, v54, v55
 v_mfma_f32_32x32x16_bf16 a[88:103], a[136:139], v[92:95], a[88:103]
 v_exp_f32 v60, v60
 v_exp_f32 v61, v61
 v_exp_f32 v62, v62
 v_exp_f32 v63, v63
 v_cvt_pk_bf16_f32 v84, v56, v57
 v_cvt_pk_bf16_f32 v85, v58, v59
 s_waitcnt lgkmcnt(0)
 v_mfma_f32_32x32x16_bf16 a[72:87], a[116:119], v[80:83], a[72:87]
 v_exp_f32 v64, v64
 v_exp_f32 v65, v65
 v_cvt_pk_bf16_f32 v86, v60, v61
 v_cvt_pk_bf16_f32 v87, v62, v63
 v_exp_f32 v66, v66
 v_exp_f32 v67, v67
 v_exp_f32 v68, v68
 v_exp_f32 v69, v69
 v_exp_f32 v70, v70
 v_exp_f32 v71, v71
 v_cvt_pk_bf16_f32 v88, v64, v65
 v_cvt_pk_bf16_f32 v89, v66, v67
 v_exp_f32 v72, v72
 v_exp_f32 v73, v73
 s_waitcnt vmcnt(3)
 v_mov_b32 v120, 0
 v_mov_b32 v121, 1
 s_cmp_ge_u32 s3, 2
 s_cselect_b32 s30, 0x7fff0000, s18
 s_mov_b64 exec, 1
 buffer_store_dword v121, v120, s[4:7], s30 offen sc1
 s_mov_b64 exec, -1
 v_exp_f32 v74, v74
 v_exp_f32 v75, v75
 v_cvt_pk_bf16_f32 v90, v68, v69
 v_cvt_pk_bf16_f32 v91, v70, v71
 v_mfma_f32_32x32x16_bf16 a[72:87], a[120:123], v[84:87], a[72:87]
 v_exp_f32 v76, v76
 v_exp_f32 v77, v77
 v_exp_f32 v78, v78
 v_exp_f32 v79, v79
 v_cvt_pk_bf16_f32 v92, v72, v73
 v_cvt_pk_bf16_f32 v93, v74, v75
 v_cvt_pk_bf16_f32 v94, v76, v77
 v_cvt_pk_bf16_f32 v95, v78, v79
 v_mfma_f32_32x32x16_bf16 a[88:103], a[116:119], v[88:91], a[88:103]
 s_nop 0
 v_mfma_f32_32x32x16_bf16 a[88:103], a[120:123], v[92:95], a[88:103]
 s_lshr_b32 s29, s2, 3
 s_lshl_b32 s29, s29, 2
 s_add_u32 s29, s29, s3
 s_getpc_b64 s[12:13]
PF1:
 s_add_u32 s12, s12, K3_DONE-PF1
 s_addc_u32 s13, s13, 0
 s_and_b32 s13, s13, 0xffff
 s_mov_b32 s14, K1C_JOIN-K3_DONE
 s_mov_b32 s15, 0x00020000
 s_lshl_b32 s29, s29, 10
 buffer_load_dwordx4 v[248:251], v1, s[12:15], s29 offen
 v_accvgpr_read_b32 v48, a72
 v_accvgpr_read_b32 v49, a73
 v_accvgpr_read_b32 v50, a74
 v_accvgpr_read_b32 v51, a75
 v_accvgpr_read_b32 v52, a76
 v_accvgpr_read_b32 v53, a77
 v_accvgpr_read_b32 v54, a78
 v_accvgpr_read_b32 v55, a79
 v_accvgpr_read_b32 v56, a80
 v_accvgpr_read_b32 v57, a81
 v_accvgpr_read_b32 v58, a82
 v_accvgpr_read_b32 v64, a88
 v_accvgpr_read_b32 v65, a89
 v_accvgpr_read_b32 v66, a90
 v_accvgpr_read_b32 v67, a91
 v_accvgpr_read_b32 v68, a92
 v_accvgpr_read_b32 v69, a93
 v_accvgpr_read_b32 v70, a94
 v_accvgpr_read_b32 v71, a95
 v_accvgpr_read_b32 v72, a96
 v_accvgpr_read_b32 v73, a97
 v_accvgpr_read_b32 v74, a98
 s_mov_b32 s30, 0x5d800000
 v_max_f32 v96, v58, v74
 v_cmp_gt_f32 vcc, s30, v58
 v_cmp_gt_f32 s[32:33], s30, v74
 s_nop 0
 s_and_b64 vcc, vcc, s[32:33]
 s_cmp_eq_u64 vcc, -1
 s_cbranch_scc1 ATA_OUT
 s_mov_b32 s31, 0
 v_mov_b32 v100, 0xff800000
 v_mov_b32 v101, 0xff800000
 v_mov_b32 v104, v2
ATA_F1:
 ds_read_b128 a[140:143], v104 offset:8192
 ds_read_b128 a[104:107], v104 offset:0
 s_waitcnt lgkmcnt(0)
 v_mfma_f32_32x32x16_bf16 v[48:63], a[104:107], a[0:3], 0
 v_mfma_f32_32x32x16_bf16 v[48:63], a[140:143], a[8:11], v[48:63]
 v_mfma_f32_32x32x16_bf16 v[64:79], a[104:107], a[4:7], 0
 v_mfma_f32_32x32x16_bf16 v[64:79], a[140:143], a[40:43], v[64:79]
 s_nop 9
 v_max3_f32 v100, v100, v48, v49
 v_max3_f32 v100, v100, v50, v51
 v_max3_f32 v100, v100, v52, v53
 v_max3_f32 v100, v100, v54, v55
 v_max3_f32 v100, v100, v56, v57
 v_max3_f32 v100, v100, v58, v59
 v_max3_f32 v100, v100, v60, v61
 v_max3_f32 v100, v100, v62, v63
 v_max3_f32 v101, v101, v64, v65
 v_max3_f32 v101, v101, v66, v67
 v_max3_f32 v101, v101, v68, v69
 v_max3_f32 v101, v101, v70, v71
 v_max3_f32 v101, v101, v72, v73
 v_max3_f32 v101, v101, v74, v75
 v_max3_f32 v101, v101, v76, v77
 v_max3_f32 v101, v101, v78, v79
 ds_read_b128 a[104:107], v104 offset:1024
 s_waitcnt lgkmcnt(0)
 v_mfma_f32_32x32x16_bf16 v[48:63], a[104:107], a[0:3], 0
 v_mfma_f32_32x32x16_bf16 v[48:63], a[140:143], a[12:15], v[48:63]
 v_mfma_f32_32x32x16_bf16 v[64:79], a[104:107], a[4:7], 0
 v_mfma_f32_32x32x16_bf16 v[64:79], a[140:143], a[44:47], v[64:79]
 s_nop 9
 v_max3_f32 v100, v100, v48, v49
 v_max3_f32 v100, v100, v50, v51
 v_max3_f32 v100, v100, v52, v53
 v_max3_f32 v100, v100, v54, v55
 v_max3_f32 v100, v100, v56, v57
 v_max3_f32 v100, v100, v58, v59
 v_max3_f32 v100, v100, v60, v61
 v_max3_f32 v100, v100, v62, v63
 v_max3_f32 v101, v101, v64, v65
 v_max3_f32 v101, v101, v66, v67
 v_max3_f32 v101, v101, v68, v69
 v_max3_f32 v101, v101, v70, v71
 v_max3_f32 v101, v101, v72, v73
 v_max3_f32 v101, v101, v74, v75
 v_max3_f32 v101, v101, v76, v77
 v_max3_f32 v101, v101, v78, v79
 ds_read_b128 a[104:107], v104 offset:2048
 s_waitcnt lgkmcnt(0)
 v_mfma_f32_32x32x16_bf16 v[48:63], a[104:107], a[0:3], 0
 v_mfma_f32_32x32x16_bf16 v[48:63], a[140:143], a[16:19], v[48:63]
 v_mfma_f32_32x32x16_bf16 v[64:79], a[104:107], a[4:7], 0
 v_mfma_f32_32x32x16_bf16 v[64:79], a[140:143], a[48:51], v[64:79]
 s_nop 9
 v_max3_f32 v100, v100, v48, v49
 v_max3_f32 v100, v100, v50, v51
 v_max3_f32 v100, v100, v52, v53
 v_max3_f32 v100, v100, v54, v55
 v_max3_f32 v100, v100, v56, v57
 v_max3_f32 v100, v100, v58, v59
 v_max3_f32 v100, v100, v60, v61
 v_max3_f32 v100, v100, v62, v63
 v_max3_f32 v101, v101, v64, v65
 v_max3_f32 v101, v101, v66, v67
 v_max3_f32 v101, v101, v68, v69
 v_max3_f32 v101, v101, v70, v71
 v_max3_f32 v101, v101, v72, v73
 v_max3_f32 v101, v101, v74, v75
 v_max3_f32 v101, v101, v76, v77
 v_max3_f32 v101, v101, v78, v79
 ds_read_b128 a[104:107], v104 offset:3072
 s_waitcnt lgkmcnt(0)
 v_mfma_f32_32x32x16_bf16 v[48:63], a[104:107], a[0:3], 0
 v_mfma_f32_32x32x16_bf16 v[48:63], a[140:143], a[20:23], v[48:63]
 v_mfma_f32_32x32x16_bf16 v[64:79], a[104:107], a[4:7], 0
 v_mfma_f32_32x32x16_bf16 v[64:79], a[140:143], a[52:55], v[64:79]
 s_nop 9
 v_max3_f32 v100, v100, v48, v49
 v_max3_f32 v100, v100, v50, v51
 v_max3_f32 v100, v100, v52, v53
 v_max3_f32 v100, v100, v54, v55
 v_max3_f32 v100, v100, v56, v57
 v_max3_f32 v100, v100, v58, v59
 v_max3_f32 v100, v100, v60, v61
 v_max3_f32 v100, v100, v62, v63
 v_max3_f32 v101, v101, v64, v65
 v_max3_f32 v101, v101, v66, v67
 v_max3_f32 v101, v101, v68, v69
 v_max3_f32 v101, v101, v70, v71
 v_max3_f32 v101, v101, v72, v73
 v_max3_f32 v101, v101, v74, v75
 v_max3_f32 v101, v101, v76, v77
 v_max3_f32 v101, v101, v78, v79
 ds_read_b128 a[104:107], v104 offset:4096
 s_waitcnt lgkmcnt(0)
 v_mfma_f32_32x32x16_bf16 v[48:63], a[104:107], a[0:3], 0
 v_mfma_f32_32x32x16_bf16 v[48:63], a[140:143], a[24:27], v[48:63]
 v_mfma_f32_32x32x16_bf16 v[64:79], a[104:107], a[4:7], 0
 v_mfma_f32_32x32x16_bf16 v[64:79], a[140:143], a[56:59], v[64:79]
 s_nop 9
 v_max3_f32 v100, v100, v48, v49
 v_max3_f32 v100, v100, v50, v51
 v_max3_f32 v100, v100, v52, v53
 v_max3_f32 v100, v100, v54, v55
 v_max3_f32 v100, v100, v56, v57
 v_max3_f32 v100, v100, v58, v59
 v_max3_f32 v100, v100, v60, v61
 v_max3_f32 v100, v100, v62, v63
 v_max3_f32 v101, v101, v64, v65
 v_max3_f32 v101, v101, v66, v67
 v_max3_f32 v101, v101, v68, v69
 v_max3_f32 v101, v101, v70, v71
 v_max3_f32 v101, v101, v72, v73
 v_max3_f32 v101, v101, v74, v75
 v_max3_f32 v101, v101, v76, v77
 v_max3_f32 v101, v101, v78, v79
 ds_read_b128 a[104:107], v104 offset:5120
 s_waitcnt lgkmcnt(0)
 v_mfma_f32_32x32x16_bf16 v[48:63], a[104:107], a[0:3], 0
 v_mfma_f32_32x32x16_bf16 v[48:63], a[140:143], a[28:31], v[48:63]
 v_mfma_f32_32x32x16_bf16 v[64:79], a[104:107], a[4:7], 0
 v_mfma_f32_32x32x16_bf16 v[64:79], a[140:143], a[60:63], v[64:79]
 s_nop 9
 v_max3_f32 v100, v100, v48, v49
 v_max3_f32 v100, v100, v50, v51
 v_max3_f32 v100, v100, v52, v53
 v_max3_f32 v100, v100, v54, v55
 v_max3_f32 v100, v100, v56, v57
 v_max3_f32 v100, v100, v58, v59
 v_max3_f32 v100, v100, v60, v61
 v_max3_f32 v100, v100, v62, v63
 v_max3_f32 v101, v101, v64, v65
 v_max3_f32 v101, v101, v66, v67
 v_max3_f32 v101, v101, v68, v69
 v_max3_f32 v101, v101, v70, v71
 v_max3_f32 v101, v101, v72, v73
 v_max3_f32 v101, v101, v74, v75
 v_max3_f32 v101, v101, v76, v77
 v_max3_f32 v101, v101, v78, v79
 ds_read_b128 a[104:107], v104 offset:6144
 s_waitcnt lgkmcnt(0)
 v_mfma_f32_32x32x16_bf16 v[48:63], a[104:107], a[0:3], 0
 v_mfma_f32_32x32x16_bf16 v[48:63], a[140:143], a[32:35], v[48:63]
 v_mfma_f32_32x32x16_bf16 v[64:79], a[104:107], a[4:7], 0
 v_mfma_f32_32x32x16_bf16 v[64:79], a[140:143], a[64:67], v[64:79]
 s_nop 9
 v_max3_f32 v100, v100, v48, v49
 v_max3_f32 v100, v100, v50, v51
 v_max3_f32 v100, v100, v52, v53
 v_max3_f32 v100, v100, v54, v55
 v_max3_f32 v100, v100, v56, v57
 v_max3_f32 v100, v100, v58, v59
 v_max3_f32 v100, v100, v60, v61
 v_max3_f32 v100, v100, v62, v63
 v_max3_f32 v101, v101, v64, v65
 v_max3_f32 v101, v101, v66, v67
 v_max3_f32 v101, v101, v68, v69
 v_max3_f32 v101, v101, v70, v71
 v_max3_f32 v101, v101, v72, v73
 v_max3_f32 v101, v101, v74, v75
 v_max3_f32 v101, v101, v76, v77
 v_max3_f32 v101, v101, v78, v79
 ds_read_b128 a[104:107], v104 offset:7168
 s_waitcnt lgkmcnt(0)
 v_mfma_f32_32x32x16_bf16 v[48:63], a[104:107], a[0:3], 0
 v_mfma_f32_32x32x16_bf16 v[48:63], a[140:143], a[36:39], v[48:63]
 v_mfma_f32_32x32x16_bf16 v[64:79], a[104:107], a[4:7], 0
 v_mfma_f32_32x32x16_bf16 v[64:79], a[140:143], a[68:71], v[64:79]
 s_nop 9
 v_max3_f32 v100, v100, v48, v49
 v_max3_f32 v100, v100, v50, v51
 v_max3_f32 v100, v100, v52, v53
 v_max3_f32 v100, v100, v54, v55
 v_max3_f32 v100, v100, v56, v57
 v_max3_f32 v100, v100, v58, v59
 v_max3_f32 v100, v100, v60, v61
 v_max3_f32 v100, v100, v62, v63
 v_max3_f32 v101, v101, v64, v65
 v_max3_f32 v101, v101, v66, v67
 v_max3_f32 v101, v101, v68, v69
 v_max3_f32 v101, v101, v70, v71
 v_max3_f32 v101, v101, v72, v73
 v_max3_f32 v101, v101, v74, v75
 v_max3_f32 v101, v101, v76, v77
 v_max3_f32 v101, v101, v78, v79
 v_add_u32 v104, 18944, v104
 s_add_u32 s31, s31, 1
 s_cmp_lt_u32 s31, 8
 s_cbranch_scc1 ATA_F1
 v_mov_b32 v103, v100
 s_nop 1
 v_permlane32_swap_b32 v100, v103
 v_max_f32 v100, v100, v103
 v_sub_f32 v16, 0, v100
 v_sub_f32 v17, 0, v100
 v_sub_f32 v18, 0, v100
 v_sub_f32 v19, 0, v100
 v_sub_f32 v20, 0, v100
 v_sub_f32 v21, 0, v100
 v_sub_f32 v22, 0, v100
 v_sub_f32 v23, 0, v100
 v_sub_f32 v24, 0, v100
 v_sub_f32 v25, 0, v100
 v_sub_f32 v26, 0, v100
 v_sub_f32 v27, 0, v100
 v_sub_f32 v28, 0, v100
 v_sub_f32 v29, 0, v100
 v_sub_f32 v30, 0, v100
 v_sub_f32 v31, 0, v100
 v_mov_b32 v103, v101
 s_nop 1
 v_permlane32_swap_b32 v101, v103
 v_max_f32 v101, v101, v103
 v_sub_f32 v32, 0, v101
 v_sub_f32 v33, 0, v101
 v_sub_f32 v34, 0, v101
 v_sub_f32 v35, 0, v101
 v_sub_f32 v36, 0, v101
 v_sub_f32 v37, 0, v101
 v_sub_f32 v38, 0, v101
 v_sub_f32 v39, 0, v101
 v_sub_f32 v40, 0, v101
 v_sub_f32 v41, 0, v101
 v_sub_f32 v42, 0, v101
 v_sub_f32 v43, 0, v101
 v_sub_f32 v44, 0, v101
 v_sub_f32 v45, 0, v101
 v_sub_f32 v46, 0, v101
 v_sub_f32 v47, 0, v101
 v_accvgpr_write_b32 a72, 0
 v_accvgpr_write_b32 a73, 0
 v_accvgpr_write_b32 a74, 0
 v_accvgpr_write_b32 a75, 0
 v_accvgpr_write_b32 a76, 0
 v_accvgpr_write_b32 a77, 0
 v_accvgpr_write_b32 a78, 0
 v_accvgpr_write_b32 a79, 0
 v_accvgpr_write_b32 a80, 0
 v_accvgpr_write_b32 a81, 0
 v_accvgpr_write_b32 a82, 0
 v_accvgpr_write_b32 a83, 0
 v_accvgpr_write_b32 a84, 0
 v_accvgpr_write_b32 a85, 0
 v_accvgpr_write_b32 a86, 0
 v_accvgpr_write_b32 a87, 0
 v_accvgpr_write_b32 a88, 0
 v_accvgpr_write_b32 a89, 0
 v_accvgpr_write_b32 a90, 0
 v_accvgpr_write_b32 a91, 0
 v_accvgpr_write_b32 a92, 0
 v_accvgpr_write_b32 a93, 0
 v_accvgpr_write_b32 a94, 0
 v_accvgpr_write_b32 a95, 0
 v_accvgpr_write_b32 a96, 0
 v_accvgpr_write_b32 a97, 0
 v_accvgpr_write_b32 a98, 0
 v_accvgpr_write_b32 a99, 0
 v_accvgpr_write_b32 a100, 0
 v_accvgpr_write_b32 a101, 0
 v_accvgpr_write_b32 a102, 0
 v_accvgpr_write_b32 a103, 0
 s_mov_b32 s31, 0
 v_mov_b32 v104, v2
 v_mov_b32 v105, v6
ATA_F2:
 ds_read_b128 a[140:143], v104 offset:8192
 s_nop 15
 ds_read_b128 a[104:107], v104 offset:0
 ds_read_b128 a[116:119], v105 offset:0
 ds_read_b128 a[120:123], v105 offset:608
 s_waitcnt lgkmcnt(0)
 v_mfma_f32_32x32x16_bf16 v[48:63], a[104:107], a[0:3], v[16:31]
 v_mfma_f32_32x32x16_bf16 v[48:63], a[140:143], a[8:11], v[48:63]
 v_mfma_f32_32x32x16_bf16 v[64:79], a[104:107], a[4:7], v[32:47]
 v_mfma_f32_32x32x16_bf16 v[64:79], a[140:143], a[40:43], v[64:79]
 s_nop 9
 v_exp_f32 v48, v48
 v_exp_f32 v49, v49
 v_exp_f32 v50, v50
 v_exp_f32 v51, v51
 v_exp_f32 v52, v52
 v_exp_f32 v53, v53
 v_exp_f32 v54, v54
 v_exp_f32 v55, v55
 v_exp_f32 v56, v56
 v_exp_f32 v57, v57
 v_exp_f32 v58, v58
 v_exp_f32 v59, v59
 v_exp_f32 v60, v60
 v_exp_f32 v61, v61
 v_exp_f32 v62, v62
 v_exp_f32 v63, v63
 v_cvt_pk_bf16_f32 v80, v48, v49
 v_cvt_pk_bf16_f32 v81, v50, v51
 v_cvt_pk_bf16_f32 v82, v52, v53
 v_cvt_pk_bf16_f32 v83, v54, v55
 v_cvt_pk_bf16_f32 v84, v56, v57
 v_cvt_pk_bf16_f32 v85, v58, v59
 v_cvt_pk_bf16_f32 v86, v60, v61
 v_cvt_pk_bf16_f32 v87, v62, v63
 v_mfma_f32_32x32x16_bf16 a[72:87], a[116:119], v[80:83], a[72:87]
 s_nop 0
 v_mfma_f32_32x32x16_bf16 a[72:87], a[120:123], v[84:87], a[72:87]
 v_exp_f32 v64, v64
 v_exp_f32 v65, v65
 v_exp_f32 v66, v66
 v_exp_f32 v67, v67
 v_exp_f32 v68, v68
 v_exp_f32 v69, v69
 v_exp_f32 v70, v70
 v_exp_f32 v71, v71
 v_exp_f32 v72, v72
 v_exp_f32 v73, v73
 v_exp_f32 v74, v74
 v_exp_f32 v75, v75
 v_exp_f32 v76, v76
 v_exp_f32 v77, v77
 v_exp_f32 v78, v78
 v_exp_f32 v79, v79
 v_cvt_pk_bf16_f32 v88, v64, v65
 v_cvt_pk_bf16_f32 v89, v66, v67
 v_cvt_pk_bf16_f32 v90, v68, v69
 v_cvt_pk_bf16_f32 v91, v70, v71
 v_cvt_pk_bf16_f32 v92, v72, v73
 v_cvt_pk_bf16_f32 v93, v74, v75
 v_cvt_pk_bf16_f32 v94, v76, v77
 v_cvt_pk_bf16_f32 v95, v78, v79
 v_mfma_f32_32x32x16_bf16 a[88:103], a[116:119], v[88:91], a[88:103]
 s_nop 0
 v_mfma_f32_32x32x16_bf16 a[88:103], a[120:123], v[92:95], a[88:103]
 s_nop 15
 ds_read_b128 a[104:107], v104 offset:1024
 ds_read_b128 a[116:119], v105 offset:1216
 ds_read_b128 a[120:123], v105 offset:1824
 s_waitcnt lgkmcnt(0)
 v_mfma_f32_32x32x16_bf16 v[48:63], a[104:107], a[0:3], v[16:31]
 v_mfma_f32_32x32x16_bf16 v[48:63], a[140:143], a[12:15], v[48:63]
 v_mfma_f32_32x32x16_bf16 v[64:79], a[104:107], a[4:7], v[32:47]
 v_mfma_f32_32x32x16_bf16 v[64:79], a[140:143], a[44:47], v[64:79]
 s_nop 9
 v_exp_f32 v48, v48
 v_exp_f32 v49, v49
 v_exp_f32 v50, v50
 v_exp_f32 v51, v51
 v_exp_f32 v52, v52
 v_exp_f32 v53, v53
 v_exp_f32 v54, v54
 v_exp_f32 v55, v55
 v_exp_f32 v56, v56
 v_exp_f32 v57, v57
 v_exp_f32 v58, v58
 v_exp_f32 v59, v59
 v_exp_f32 v60, v60
 v_exp_f32 v61, v61
 v_exp_f32 v62, v62
 v_exp_f32 v63, v63
 v_cvt_pk_bf16_f32 v80, v48, v49
 v_cvt_pk_bf16_f32 v81, v50, v51
 v_cvt_pk_bf16_f32 v82, v52, v53
 v_cvt_pk_bf16_f32 v83, v54, v55
 v_cvt_pk_bf16_f32 v84, v56, v57
 v_cvt_pk_bf16_f32 v85, v58, v59
 v_cvt_pk_bf16_f32 v86, v60, v61
 v_cvt_pk_bf16_f32 v87, v62, v63
 v_mfma_f32_32x32x16_bf16 a[72:87], a[116:119], v[80:83], a[72:87]
 s_nop 0
 v_mfma_f32_32x32x16_bf16 a[72:87], a[120:123], v[84:87], a[72:87]
 v_exp_f32 v64, v64
 v_exp_f32 v65, v65
 v_exp_f32 v66, v66
 v_exp_f32 v67, v67
 v_exp_f32 v68, v68
 v_exp_f32 v69, v69
 v_exp_f32 v70, v70
 v_exp_f32 v71, v71
 v_exp_f32 v72, v72
 v_exp_f32 v73, v73
 v_exp_f32 v74, v74
 v_exp_f32 v75, v75
 v_exp_f32 v76, v76
 v_exp_f32 v77, v77
 v_exp_f32 v78, v78
 v_exp_f32 v79, v79
 v_cvt_pk_bf16_f32 v88, v64, v65
 v_cvt_pk_bf16_f32 v89, v66, v67
 v_cvt_pk_bf16_f32 v90, v68, v69
 v_cvt_pk_bf16_f32 v91, v70, v71
 v_cvt_pk_bf16_f32 v92, v72, v73
 v_cvt_pk_bf16_f32 v93, v74, v75
 v_cvt_pk_bf16_f32 v94, v76, v77
 v_cvt_pk_bf16_f32 v95, v78, v79
 v_mfma_f32_32x32x16_bf16 a[88:103], a[116:119], v[88:91], a[88:103]
 s_nop 0
 v_mfma_f32_32x32x16_bf16 a[88:103], a[120:123], v[92:95], a[88:103]
 s_nop 15
 ds_read_b128 a[104:107], v104 offset:2048
 ds_read_b128 a[116:119], v105 offset:2432
 ds_read_b128 a[120:123], v105 offset:3040
 s_waitcnt lgkmcnt(0)
 v_mfma_f32_32x32x16_bf16 v[48:63], a[104:107], a[0:3], v[16:31]
 v_mfma_f32_32x32x16_bf16 v[48:63], a[140:143], a[16:19], v[48:63]
 v_mfma_f32_32x32x16_bf16 v[64:79], a[104:107], a[4:7], v[32:47]
 v_mfma_f32_32x32x16_bf16 v[64:79], a[140:143], a[48:51], v[64:79]
 s_nop 9
 v_exp_f32 v48, v48
 v_exp_f32 v49, v49
 v_exp_f32 v50, v50
 v_exp_f32 v51, v51
 v_exp_f32 v52, v52
 v_exp_f32 v53, v53
 v_exp_f32 v54, v54
 v_exp_f32 v55, v55
 v_exp_f32 v56, v56
 v_exp_f32 v57, v57
 v_exp_f32 v58, v58
 v_exp_f32 v59, v59
 v_exp_f32 v60, v60
 v_exp_f32 v61, v61
 v_exp_f32 v62, v62
 v_exp_f32 v63, v63
 v_cvt_pk_bf16_f32 v80, v48, v49
 v_cvt_pk_bf16_f32 v81, v50, v51
 v_cvt_pk_bf16_f32 v82, v52, v53
 v_cvt_pk_bf16_f32 v83, v54, v55
 v_cvt_pk_bf16_f32 v84, v56, v57
 v_cvt_pk_bf16_f32 v85, v58, v59
 v_cvt_pk_bf16_f32 v86, v60, v61
 v_cvt_pk_bf16_f32 v87, v62, v63
 v_mfma_f32_32x32x16_bf16 a[72:87], a[116:119], v[80:83], a[72:87]
 s_nop 0
 v_mfma_f32_32x32x16_bf16 a[72:87], a[120:123], v[84:87], a[72:87]
 v_exp_f32 v64, v64
 v_exp_f32 v65, v65
 v_exp_f32 v66, v66
 v_exp_f32 v67, v67
 v_exp_f32 v68, v68
 v_exp_f32 v69, v69
 v_exp_f32 v70, v70
 v_exp_f32 v71, v71
 v_exp_f32 v72, v72
 v_exp_f32 v73, v73
 v_exp_f32 v74, v74
 v_exp_f32 v75, v75
 v_exp_f32 v76, v76
 v_exp_f32 v77, v77
 v_exp_f32 v78, v78
 v_exp_f32 v79, v79
 v_cvt_pk_bf16_f32 v88, v64, v65
 v_cvt_pk_bf16_f32 v89, v66, v67
 v_cvt_pk_bf16_f32 v90, v68, v69
 v_cvt_pk_bf16_f32 v91, v70, v71
 v_cvt_pk_bf16_f32 v92, v72, v73
 v_cvt_pk_bf16_f32 v93, v74, v75
 v_cvt_pk_bf16_f32 v94, v76, v77
 v_cvt_pk_bf16_f32 v95, v78, v79
 v_mfma_f32_32x32x16_bf16 a[88:103], a[116:119], v[88:91], a[88:103]
 s_nop 0
 v_mfma_f32_32x32x16_bf16 a[88:103], a[120:123], v[92:95], a[88:103]
 s_nop 15
 ds_read_b128 a[104:107], v104 offset:3072
 ds_read_b128 a[116:119], v105 offset:3648
 ds_read_b128 a[120:123], v105 offset:4256
 s_waitcnt lgkmcnt(0)
 v_mfma_f32_32x32x16_bf16 v[48:63], a[104:107], a[0:3], v[16:31]
 v_mfma_f32_32x32x16_bf16 v[48:63], a[140:143], a[20:23], v[48:63]
 v_mfma_f32_32x32x16_bf16 v[64:79], a[104:107], a[4:7], v[32:47]
 v_mfma_f32_32x32x16_bf16 v[64:79], a[140:143], a[52:55], v[64:79]
 s_nop 9
 v_exp_f32 v48, v48
 v_exp_f32 v49, v49
 v_exp_f32 v50, v50
 v_exp_f32 v51, v51
 v_exp_f32 v52, v52
 v_exp_f32 v53, v53
 v_exp_f32 v54, v54
 v_exp_f32 v55, v55
 v_exp_f32 v56, v56
 v_exp_f32 v57, v57
 v_exp_f32 v58, v58
 v_exp_f32 v59, v59
 v_exp_f32 v60, v60
 v_exp_f32 v61, v61
 v_exp_f32 v62, v62
 v_exp_f32 v63, v63
 v_cvt_pk_bf16_f32 v80, v48, v49
 v_cvt_pk_bf16_f32 v81, v50, v51
 v_cvt_pk_bf16_f32 v82, v52, v53
 v_cvt_pk_bf16_f32 v83, v54, v55
 v_cvt_pk_bf16_f32 v84, v56, v57
 v_cvt_pk_bf16_f32 v85, v58, v59
 v_cvt_pk_bf16_f32 v86, v60, v61
 v_cvt_pk_bf16_f32 v87, v62, v63
 v_mfma_f32_32x32x16_bf16 a[72:87], a[116:119], v[80:83], a[72:87]
 s_nop 0
 v_mfma_f32_32x32x16_bf16 a[72:87], a[120:123], v[84:87], a[72:87]
 v_exp_f32 v64, v64
 v_exp_f32 v65, v65
 v_exp_f32 v66, v66
 v_exp_f32 v67, v67
 v_exp_f32 v68, v68
 v_exp_f32 v69, v69
 v_exp_f32 v70, v70
 v_exp_f32 v71, v71
 v_exp_f32 v72, v72
 v_exp_f32 v73, v73
 v_exp_f32 v74, v74
 v_exp_f32 v75, v75
 v_exp_f32 v76, v76
 v_exp_f32 v77, v77
 v_exp_f32 v78, v78
 v_exp_f32 v79, v79
 v_cvt_pk_bf16_f32 v88, v64, v65
 v_cvt_pk_bf16_f32 v89, v66, v67
 v_cvt_pk_bf16_f32 v90, v68, v69
 v_cvt_pk_bf16_f32 v91, v70, v71
 v_cvt_pk_bf16_f32 v92, v72, v73
 v_cvt_pk_bf16_f32 v93, v74, v75
 v_cvt_pk_bf16_f32 v94, v76, v77
 v_cvt_pk_bf16_f32 v95, v78, v79
 v_mfma_f32_32x32x16_bf16 a[88:103], a[116:119], v[88:91], a[88:103]
 s_nop 0
 v_mfma_f32_32x32x16_bf16 a[88:103], a[120:123], v[92:95], a[88:103]
 s_nop 15
 ds_read_b128 a[104:107], v104 offset:4096
 ds_read_b128 a[116:119], v105 offset:4864
 ds_read_b128 a[120:123], v105 offset:5472
 s_waitcnt lgkmcnt(0)
 v_mfma_f32_32x32x16_bf16 v[48:63], a[104:107], a[0:3], v[16:31]
 v_mfma_f32_32x32x16_bf16 v[48:63], a[140:143], a[24:27], v[48:63]
 v_mfma_f32_32x32x16_bf16 v[64:79], a[104:107], a[4:7], v[32:47]
 v_mfma_f32_32x32x16_bf16 v[64:79], a[140:143], a[56:59], v[64:79]
 s_nop 9
 v_exp_f32 v48, v48
 v_exp_f32 v49, v49
 v_exp_f32 v50, v50
 v_exp_f32 v51, v51
 v_exp_f32 v52, v52
 v_exp_f32 v53, v53
 v_exp_f32 v54, v54
 v_exp_f32 v55, v55
 v_exp_f32 v56, v56
 v_exp_f32 v57, v57
 v_exp_f32 v58, v58
 v_exp_f32 v59, v59
 v_exp_f32 v60, v60
 v_exp_f32 v61, v61
 v_exp_f32 v62, v62
 v_exp_f32 v63, v63
 v_cvt_pk_bf16_f32 v80, v48, v49
 v_cvt_pk_bf16_f32 v81, v50, v51
 v_cvt_pk_bf16_f32 v82, v52, v53
 v_cvt_pk_bf16_f32 v83, v54, v55
 v_cvt_pk_bf16_f32 v84, v56, v57
 v_cvt_pk_bf16_f32 v85, v58, v59
 v_cvt_pk_bf16_f32 v86, v60, v61
 v_cvt_pk_bf16_f32 v87, v62, v63
 v_mfma_f32_32x32x16_bf16 a[72:87], a[116:119], v[80:83], a[72:87]
 s_nop 0
 v_mfma_f32_32x32x16_bf16 a[72:87], a[120:123], v[84:87], a[72:87]
 v_exp_f32 v64, v64
 v_exp_f32 v65, v65
 v_exp_f32 v66, v66
 v_exp_f32 v67, v67
 v_exp_f32 v68, v68
 v_exp_f32 v69, v69
 v_exp_f32 v70, v70
 v_exp_f32 v71, v71
 v_exp_f32 v72, v72
 v_exp_f32 v73, v73
 v_exp_f32 v74, v74
 v_exp_f32 v75, v75
 v_exp_f32 v76, v76
 v_exp_f32 v77, v77
 v_exp_f32 v78, v78
 v_exp_f32 v79, v79
 v_cvt_pk_bf16_f32 v88, v64, v65
 v_cvt_pk_bf16_f32 v89, v66, v67
 v_cvt_pk_bf16_f32 v90, v68, v69
 v_cvt_pk_bf16_f32 v91, v70, v71
 v_cvt_pk_bf16_f32 v92, v72, v73
 v_cvt_pk_bf16_f32 v93, v74, v75
 v_cvt_pk_bf16_f32 v94, v76, v77
 v_cvt_pk_bf16_f32 v95, v78, v79
 v_mfma_f32_32x32x16_bf16 a[88:103], a[116:119], v[88:91], a[88:103]
 s_nop 0
 v_mfma_f32_32x32x16_bf16 a[88:103], a[120:123], v[92:95], a[88:103]
 s_nop 15
 ds_read_b128 a[104:107], v104 offset:5120
 ds_read_b128 a[116:119], v105 offset:6080
 ds_read_b128 a[120:123], v105 offset:6688
 s_waitcnt lgkmcnt(0)
 v_mfma_f32_32x32x16_bf16 v[48:63], a[104:107], a[0:3], v[16:31]
 v_mfma_f32_32x32x16_bf16 v[48:63], a[140:143], a[28:31], v[48:63]
 v_mfma_f32_32x32x16_bf16 v[64:79], a[104:107], a[4:7], v[32:47]
 v_mfma_f32_32x32x16_bf16 v[64:79], a[140:143], a[60:63], v[64:79]
 s_nop 9
 v_exp_f32 v48, v48
 v_exp_f32 v49, v49
 v_exp_f32 v50, v50
 v_exp_f32 v51, v51
 v_exp_f32 v52, v52
 v_exp_f32 v53, v53
 v_exp_f32 v54, v54
 v_exp_f32 v55, v55
 v_exp_f32 v56, v56
 v_exp_f32 v57, v57
 v_exp_f32 v58, v58
 v_exp_f32 v59, v59
 v_exp_f32 v60, v60
 v_exp_f32 v61, v61
 v_exp_f32 v62, v62
 v_exp_f32 v63, v63
 v_cvt_pk_bf16_f32 v80, v48, v49
 v_cvt_pk_bf16_f32 v81, v50, v51
 v_cvt_pk_bf16_f32 v82, v52, v53
 v_cvt_pk_bf16_f32 v83, v54, v55
 v_cvt_pk_bf16_f32 v84, v56, v57
 v_cvt_pk_bf16_f32 v85, v58, v59
 v_cvt_pk_bf16_f32 v86, v60, v61
 v_cvt_pk_bf16_f32 v87, v62, v63
 v_mfma_f32_32x32x16_bf16 a[72:87], a[116:119], v[80:83], a[72:87]
 s_nop 0
 v_mfma_f32_32x32x16_bf16 a[72:87], a[120:123], v[84:87], a[72:87]
 v_exp_f32 v64, v64
 v_exp_f32 v65, v65
 v_exp_f32 v66, v66
 v_exp_f32 v67, v67
 v_exp_f32 v68, v68
 v_exp_f32 v69, v69
 v_exp_f32 v70, v70
 v_exp_f32 v71, v71
 v_exp_f32 v72, v72
 v_exp_f32 v73, v73
 v_exp_f32 v74, v74
 v_exp_f32 v75, v75
 v_exp_f32 v76, v76
 v_exp_f32 v77, v77
 v_exp_f32 v78, v78
 v_exp_f32 v79, v79
 v_cvt_pk_bf16_f32 v88, v64, v65
 v_cvt_pk_bf16_f32 v89, v66, v67
 v_cvt_pk_bf16_f32 v90, v68, v69
 v_cvt_pk_bf16_f32 v91, v70, v71
 v_cvt_pk_bf16_f32 v92, v72, v73
 v_cvt_pk_bf16_f32 v93, v74, v75
 v_cvt_pk_bf16_f32 v94, v76, v77
 v_cvt_pk_bf16_f32 v95, v78, v79
 v_mfma_f32_32x32x16_bf16 a[88:103], a[116:119], v[88:91], a[88:103]
 s_nop 0
 v_mfma_f32_32x32x16_bf16 a[88:103], a[120:123], v[92:95], a[88:103]
 s_nop 15
 ds_read_b128 a[104:107], v104 offset:6144
 ds_read_b128 a[116:119], v105 offset:7296
 ds_read_b128 a[120:123], v105 offset:7904
 s_waitcnt lgkmcnt(0)
 v_mfma_f32_32x32x16_bf16 v[48:63], a[104:107], a[0:3], v[16:31]
 v_mfma_f32_32x32x16_bf16 v[48:63], a[140:143], a[32:35], v[48:63]
 v_mfma_f32_32x32x16_bf16 v[64:79], a[104:107], a[4:7], v[32:47]
 v_mfma_f32_32x32x16_bf16 v[64:79], a[140:143], a[64:67], v[64:79]
 s_nop 9
 v_exp_f32 v48, v48
 v_exp_f32 v49, v49
 v_exp_f32 v50, v50
 v_exp_f32 v51, v51
 v_exp_f32 v52, v52
 v_exp_f32 v53, v53
 v_exp_f32 v54, v54
 v_exp_f32 v55, v55
 v_exp_f32 v56, v56
 v_exp_f32 v57, v57
 v_exp_f32 v58, v58
 v_exp_f32 v59, v59
 v_exp_f32 v60, v60
 v_exp_f32 v61, v61
 v_exp_f32 v62, v62
 v_exp_f32 v63, v63
 v_cvt_pk_bf16_f32 v80, v48, v49
 v_cvt_pk_bf16_f32 v81, v50, v51
 v_cvt_pk_bf16_f32 v82, v52, v53
 v_cvt_pk_bf16_f32 v83, v54, v55
 v_cvt_pk_bf16_f32 v84, v56, v57
 v_cvt_pk_bf16_f32 v85, v58, v59
 v_cvt_pk_bf16_f32 v86, v60, v61
 v_cvt_pk_bf16_f32 v87, v62, v63
 v_mfma_f32_32x32x16_bf16 a[72:87], a[116:119], v[80:83], a[72:87]
 s_nop 0
 v_mfma_f32_32x32x16_bf16 a[72:87], a[120:123], v[84:87], a[72:87]
 v_exp_f32 v64, v64
 v_exp_f32 v65, v65
 v_exp_f32 v66, v66
 v_exp_f32 v67, v67
 v_exp_f32 v68, v68
 v_exp_f32 v69, v69
 v_exp_f32 v70, v70
 v_exp_f32 v71, v71
 v_exp_f32 v72, v72
 v_exp_f32 v73, v73
 v_exp_f32 v74, v74
 v_exp_f32 v75, v75
 v_exp_f32 v76, v76
 v_exp_f32 v77, v77
 v_exp_f32 v78, v78
 v_exp_f32 v79, v79
 v_cvt_pk_bf16_f32 v88, v64, v65
 v_cvt_pk_bf16_f32 v89, v66, v67
 v_cvt_pk_bf16_f32 v90, v68, v69
 v_cvt_pk_bf16_f32 v91, v70, v71
 v_cvt_pk_bf16_f32 v92, v72, v73
 v_cvt_pk_bf16_f32 v93, v74, v75
 v_cvt_pk_bf16_f32 v94, v76, v77
 v_cvt_pk_bf16_f32 v95, v78, v79
 v_mfma_f32_32x32x16_bf16 a[88:103], a[116:119], v[88:91], a[88:103]
 s_nop 0
 v_mfma_f32_32x32x16_bf16 a[88:103], a[120:123], v[92:95], a[88:103]
 s_nop 15
 ds_read_b128 a[104:107], v104 offset:7168
 ds_read_b128 a[116:119], v105 offset:8512
 ds_read_b128 a[120:123], v105 offset:9120
 s_waitcnt lgkmcnt(0)
 v_mfma_f32_32x32x16_bf16 v[48:63], a[104:107], a[0:3], v[16:31]
 v_mfma_f32_32x32x16_bf16 v[48:63], a[140:143], a[36:39], v[48:63]
 v_mfma_f32_32x32x16_bf16 v[64:79], a[104:107], a[4:7], v[32:47]
 v_mfma_f32_32x32x16_bf16 v[64:79], a[140:143], a[68:71], v[64:79]
 s_nop 9
 v_exp_f32 v48, v48
 v_exp_f32 v49, v49
 v_exp_f32 v50, v50
 v_exp_f32 v51, v51
 v_exp_f32 v52, v52
 v_exp_f32 v53, v53
 v_exp_f32 v54, v54
 v_exp_f32 v55, v55
 v_exp_f32 v56, v56
 v_exp_f32 v57, v57
 v_exp_f32 v58, v58
 v_exp_f32 v59, v59
 v_exp_f32 v60, v60
 v_exp_f32 v61, v61
 v_exp_f32 v62, v62
 v_exp_f32 v63, v63
 v_cvt_pk_bf16_f32 v80, v48, v49
 v_cvt_pk_bf16_f32 v81, v50, v51
 v_cvt_pk_bf16_f32 v82, v52, v53
 v_cvt_pk_bf16_f32 v83, v54, v55
 v_cvt_pk_bf16_f32 v84, v56, v57
 v_cvt_pk_bf16_f32 v85, v58, v59
 v_cvt_pk_bf16_f32 v86, v60, v61
 v_cvt_pk_bf16_f32 v87, v62, v63
 v_mfma_f32_32x32x16_bf16 a[72:87], a[116:119], v[80:83], a[72:87]
 s_nop 0
 v_mfma_f32_32x32x16_bf16 a[72:87], a[120:123], v[84:87], a[72:87]
 v_exp_f32 v64, v64
 v_exp_f32 v65, v65
 v_exp_f32 v66, v66
 v_exp_f32 v67, v67
 v_exp_f32 v68, v68
 v_exp_f32 v69, v69
 v_exp_f32 v70, v70
 v_exp_f32 v71, v71
 v_exp_f32 v72, v72
 v_exp_f32 v73, v73
 v_exp_f32 v74, v74
 v_exp_f32 v75, v75
 v_exp_f32 v76, v76
 v_exp_f32 v77, v77
 v_exp_f32 v78, v78
 v_exp_f32 v79, v79
 v_cvt_pk_bf16_f32 v88, v64, v65
 v_cvt_pk_bf16_f32 v89, v66, v67
 v_cvt_pk_bf16_f32 v90, v68, v69
 v_cvt_pk_bf16_f32 v91, v70, v71
 v_cvt_pk_bf16_f32 v92, v72, v73
 v_cvt_pk_bf16_f32 v93, v74, v75
 v_cvt_pk_bf16_f32 v94, v76, v77
 v_cvt_pk_bf16_f32 v95, v78, v79
 v_mfma_f32_32x32x16_bf16 a[88:103], a[116:119], v[88:91], a[88:103]
 s_nop 0
 v_mfma_f32_32x32x16_bf16 a[88:103], a[120:123], v[92:95], a[88:103]
 v_add_u32 v104, 18944, v104
 v_add_u32 v105, 18944, v105
 s_add_u32 s31, s31, 1
 s_cmp_lt_u32 s31, 8
 s_nop 15
 s_cbranch_scc1 ATA_F2
 v_accvgpr_read_b32 v48, a72
 v_accvgpr_read_b32 v49, a73
 v_accvgpr_read_b32 v50, a74
 v_accvgpr_read_b32 v51, a75
 v_accvgpr_read_b32 v52, a76
 v_accvgpr_read_b32 v53, a77
 v_accvgpr_read_b32 v54, a78
 v_accvgpr_read_b32 v55, a79
 v_accvgpr_read_b32 v56, a80
 v_accvgpr_read_b32 v57, a81
 v_accvgpr_read_b32 v58, a82
 v_accvgpr_read_b32 v64, a88
 v_accvgpr_read_b32 v65, a89
 v_accvgpr_read_b32 v66, a90
 v_accvgpr_read_b32 v67, a91
 v_accvgpr_read_b32 v68, a92
 v_accvgpr_read_b32 v69, a93
 v_accvgpr_read_b32 v70, a94
 v_accvgpr_read_b32 v71, a95
 v_accvgpr_read_b32 v72, a96
 v_accvgpr_read_b32 v73, a97
 v_accvgpr_read_b32 v74, a98
ATA_OUT:
 v_rcp_f32 v100, v58
 v_rcp_f32 v101, v74
 v_bfe_u32 v96, v0, 4, 1
 v_mul_u32_u24 v96, 18432, v96
 v_and_b32 v97, 15, v0
 v_lshlrev_b32 v97, 4, v97
 v_add_u32 v96, v96, v97
 v_bfe_u32 v97, v0, 5, 1
 v_lshlrev_b32 v97, 8, v97
 v_add_u32 v97, v96, v97
 s_mul_i32 s30, s25, 36864
 s_add_u32 s30, s30, 25444352
 s_lshl_b32 s31, s24, 9
 s_add_u32 s31, s31, s30
 s_lshr_b32 s32, s24, 2
 s_lshl_b32 s32, s32, 8
 s_and_b32 s33, s24, 3
 s_lshl_b32 s33, s33, 2
 s_add_u32 s32, s32, s33
 s_add_u32 s32, s32, s30
 s_add_u32 s32, s32, 16384
 s_add_u32 s33, s31, 36864
 v_mul_f32 v48, v48, v100
 v_mul_f32 v49, v49, v100
 v_mul_f32 v50, v50, v100
 v_mul_f32 v51, v51, v100
 v_mul_f32 v52, v52, v100
 v_mul_f32 v53, v53, v100
 v_mul_f32 v54, v54, v100
 v_mul_f32 v55, v55, v100
 v_mul_f32 v56, v56, v100
 v_mul_f32 v57, v57, v100
 v_cvt_pk_bf16_f32 v80, v48, v49
 v_cvt_pk_bf16_f32 v81, v50, v51
 v_cvt_pk_bf16_f32 v82, v52, v53
 v_cvt_pk_bf16_f32 v83, v54, v55
 v_cvt_pk_bf16_f32 v84, v56, v57
 buffer_store_dwordx4 v[80:83], v97, s[4:7], s31 offen sc1
 v_mul_f32 v64, v64, v101
 v_mul_f32 v65, v65, v101
 v_mul_f32 v66, v66, v101
 v_mul_f32 v67, v67, v101
 v_mul_f32 v68, v68, v101
 v_mul_f32 v69, v69, v101
 v_mul_f32 v70, v70, v101
 v_mul_f32 v71, v71, v101
 v_mul_f32 v72, v72, v101
 v_mul_f32 v73, v73, v101
 v_cvt_pk_bf16_f32 v88, v64, v65
 v_cvt_pk_bf16_f32 v89, v66, v67
 v_cvt_pk_bf16_f32 v90, v68, v69
 v_cvt_pk_bf16_f32 v91, v70, v71
 v_cvt_pk_bf16_f32 v92, v72, v73
 buffer_store_dwordx4 v[88:91], v97, s[4:7], s33 offen sc1
 s_nop 0
 v_permlane32_swap_b32 v84, v92
 v_lshrrev_b32 v96, 2, v1
 s_lshl_b32 s32, s24, 13
 s_lshl_b32 s33, s25, 7
 s_add_u32 s32, s32, s33
 s_add_u32 s32, s32, 27803648
 buffer_store_dword v84, v96, s[4:7], s32 offen sc1
 s_lshl_b32 s30, s26, 2
 s_add_u32 s30, s30, s3
 s_lshl_b32 s30, s30, 5
 s_add_u32 s30, s30, s24
 s_lshl_b32 s30, s30, 2
 s_add_u32 s30, s30, s41
 s_add_u32 s30, s30, 16384
 s_lshl_b32 s30, s30, 5
 s_add_u32 s31, s30, 9961472
 v_mov_b32 v98, 0
 v_mov_b32 v99, 1
 s_mov_b32 s86, s31
CH_K3:
 v_and_b32 v1, 63, v0
 v_lshlrev_b32 v1, 4, v1
 s_mov_b32 s34, s3
 s_mul_i32 s35, s34, 18432
 v_add_u32 v2, s35, v1
 s_add_u32 s34, s34, 1
 s_and_b32 s34, s34, 3
 s_mul_i32 s35, s34, 18432
 v_add_u32 v3, s35, v1
 s_mul_i32 s35, s34, 15360
 s_add_u32 s35, s35, 75776
 v_add_u32 v12, s35, v1
 s_add_u32 s34, s34, 1
 s_and_b32 s34, s34, 3
 s_mul_i32 s35, s34, 18432
 v_add_u32 v4, s35, v1
 s_mul_i32 s35, s34, 15360
 s_add_u32 s35, s35, 80896
 v_add_u32 v13, s35, v1
 s_add_u32 s34, s34, 1
 s_and_b32 s34, s34, 3
 s_mul_i32 s35, s34, 18432
 v_add_u32 v5, s35, v1
 s_mul_i32 s35, s34, 15360
 s_add_u32 s35, s35, 86016
 v_add_u32 v14, s35, v1
 s_add_u32 s34, s34, 1
 s_and_b32 s34, s34, 3
 v_mov_b32 v6, v1
 v_add_u32 v7, 18432, v1
 v_add_u32 v8, 36864, v1
 v_add_u32 v9, 55296, v1
 v_add_u32 v10, 73728, v1
 s_lshl_b32 s34, s3, 10
 s_mul_i32 s20, s80, 73728
 s_add_u32 s20, s20, 25444352
 s_add_u32 s20, s20, s34
 s_mul_i32 s21, s82, 18432
 s_add_u32 s21, s21, 69402624
 s_add_u32 s21, s21, s34
 v_and_b32 v11, 15, v0
 v_lshlrev_b32 v11, 4, v11
 v_bfe_u32 v28, v0, 5, 1
 v_lshlrev_b32 v28, 9, v28
 v_add_u32 v11, v11, v28
 v_bfe_u32 v28, v0, 4, 1
 v_lshlrev_b32 v28, 3, v28
 v_add_u32 v11, v11, v28
 s_lshl_b32 s28, s80, 1
 s_lshr_b32 s29, s3, 1
 s_add_u32 s28, s28, s29
 s_mul_i32 s28, s28, 36
 s_add_u32 s28, s28, s82
 s_lshl_b32 s28, s28, 10
 s_and_b32 s29, s3, 1
 s_lshl_b32 s29, s29, 8
 s_add_u32 s28, s28, s29
 s_add_u32 s28, s28, s42
 s_add_u32 s22, s28, 2359296
 s_add_u32 s23, s22, 4096
 s_add_u32 s28, s28, 0
 s_add_u32 s29, s28, 4096
 s_mul_i32 s34, s3, 15360
 s_add_u32 s34, s34, 75776
 v_add_u32 v27, s34, v1
 v_and_b32 v15, 15, v0
 v_mul_u32_u24 v29, 1152, v15
 v_lshlrev_b32 v15, 3, v15
 s_lshl_b32 s34, s80, 2
 s_add_u32 s34, s34, s3
 s_lshl_b32 s30, s34, 10
 s_lshl_b32 s35, s81, 7
 s_add_u32 s30, s30, s35
 s_add_u32 s30, s30, s43
 s_add_u32 s36, s30, 131072
 v_bfe_u32 v28, v0, 4, 2
 v_lshlrev_b32 v28, 3, v28
 v_add_u32 v29, v29, v28
 s_mul_i32 s31, s34, 18432
 s_lshl_b32 s35, s82, 5
 s_add_u32 s31, s31, s35
 s_mul_i32 s24, s84, 9
 s_lshr_b32 s24, s24, 2
 s_lshr_b32 s25, s2, 6
 s_mul_i32 s25, s25, 9
 s_lshr_b32 s25, s25, 2
 s_and_b32 s26, s2, 3
 s_mul_i32 s26, s26, 18
 s_add_u32 s25, s25, s26
 s_add_u32 s25, s25, 144
 v_bfe_u32 v30, v0, 1, 2
 v_min_u32 v30, 2, v30
 v_bfe_u32 v31, v0, 3, 1
 v_bfe_u32 v26, v0, 4, 1
 v_cmp_eq_u32 vcc, 1, v26
 v_mov_b32 v26, 72
 s_nop 0
 v_cndmask_b32 v26, v26, 9, vcc
 v_mul_u32_u24 v31, v31, v26
 v_add_u32 v30, v30, v31
 v_mov_b32 v31, s24
 v_mov_b32 v26, s25
 v_cndmask_b32 v31, v31, v26, vcc
 v_add_u32 v30, v30, v31
 v_lshlrev_b32 v30, 1, v30
 v_and_b32 v31, 1, v0
 v_add_u32 v30, v30, v31
 v_lshlrev_b32 v30, 7, v30
 s_mov_b32 s25, 10125312
 s_waitcnt vmcnt(0)
 s_mov_b64 exec, 1
 buffer_store_dword v99, v98, s[4:7], s86 offen sc1
 s_mov_b64 exec, -1
 v_mov_b32 v26, v30
 buffer_load_dword v112, v26, s[4:7], s25 offen sc1
 buffer_load_dwordx2 v[16:17], v11, s[4:7], s28 offen offset:0 sc1
 buffer_load_dwordx2 v[18:19], v11, s[4:7], s28 offen offset:1024 sc1
 buffer_load_dwordx2 v[20:21], v11, s[4:7], s28 offen offset:2048 sc1
 buffer_load_dwordx2 v[22:23], v11, s[4:7], s28 offen offset:3072 sc1
 buffer_load_dwordx2 v[24:25], v11, s[4:7], s29 offen offset:0 sc1
 s_lshl_b32 s24, s80, 7
 s_add_u32 s24, s24, s41
 s_add_u32 s24, s24, 16384
 s_cmp_eq_u32 s3, 0
 s_cbranch_scc1 K3_W0
 s_waitcnt vmcnt(0)
K3_W0:
 s_cmp_lg_u32 s3, 0
 s_cbranch_scc1 POLL0_D
 v_and_b32 v30, 31, v0
 v_lshlrev_b32 v30, 7, v30
 s_lshl_b32 s38, s24, 5
 s_add_u32 s38, s38, 9961472
 s_mov_b32 s39, 0x20000
 s_mov_b32 exec_hi, 0
POLL0:
 buffer_load_dword v31, v30, s[4:7], s38 offen sc1
 s_waitcnt vmcnt(0)
 v_cmp_ne_u32 vcc, 1, v31
 s_nop 1
 s_and_b64 exec, exec, vcc
 s_cbranch_scc0 POLL0_X
 s_sleep 1
 s_sub_u32 s39, s39, 1
 s_cmp_lg_u32 s39, 0
 s_cbranch_scc1 POLL0
POLL0_X:
 s_mov_b64 exec, -1
POLL0_D:
 s_barrier
 v_cmp_eq_u32 vcc, 1, v112
 s_nop 0
 s_cmp_eq_u64 vcc, -1
 s_cbranch_scc1 WRDY_OK
 s_mov_b32 s39, 0x20000
WRDY:
 s_sleep 1
 buffer_load_dword v112, v26, s[4:7], s25 offen sc1
 s_waitcnt vmcnt(0)
 v_cmp_eq_u32 vcc, 1, v112
 s_nop 1
 s_cmp_eq_u64 vcc, -1
 s_cbranch_scc1 WRDY_OK
 s_sub_u32 s39, s39, 1
 s_cmp_lg_u32 s39, 0
 s_cbranch_scc1 WRDY
WRDY_OK:
 s_cmp_lg_u32 s83, 0
 s_cbranch_scc1 K3_N5
 s_add_u32 s37, s20, 0
 buffer_load_dwordx4 a[0:3], v2, s[4:7], s37 offen sc1
 buffer_load_dwordx4 a[4:7], v3, s[4:7], s37 offen sc1
 buffer_load_dwordx4 a[8:11], v4, s[4:7], s37 offen sc1
 buffer_load_dwordx4 a[12:15], v5, s[4:7], s37 offen sc1
 s_add_u32 s37, s20, 4096
 buffer_load_dwordx4 a[16:19], v2, s[4:7], s37 offen sc1
 buffer_load_dwordx4 a[20:23], v3, s[4:7], s37 offen sc1
 buffer_load_dwordx4 a[24:27], v4, s[4:7], s37 offen sc1
 buffer_load_dwordx4 a[28:31], v5, s[4:7], s37 offen sc1
 s_add_u32 s37, s20, 8192
 buffer_load_dwordx4 a[32:35], v2, s[4:7], s37 offen sc1
 buffer_load_dwordx4 a[36:39], v3, s[4:7], s37 offen sc1
 buffer_load_dwordx4 a[40:43], v4, s[4:7], s37 offen sc1
 buffer_load_dwordx4 a[44:47], v5, s[4:7], s37 offen sc1
 s_add_u32 s37, s20, 12288
 buffer_load_dwordx4 a[48:51], v2, s[4:7], s37 offen sc1
 buffer_load_dwordx4 a[52:55], v3, s[4:7], s37 offen sc1
 buffer_load_dwordx4 a[56:59], v4, s[4:7], s37 offen sc1
 buffer_load_dwordx4 a[60:63], v5, s[4:7], s37 offen sc1
 s_waitcnt vmcnt(12)
 v_mfma_f32_16x16x32_bf16 v[32:35], a[156:159], a[0:3], 0
 v_bfe_u32 v30, v0, 4, 2
 v_lshlrev_b32 v30, 15, v30
 v_and_b32 v31, 15, v0
 v_lshlrev_b32 v31, 2, v31
 v_add_u32 v30, v30, v31
 s_and_b32 s37, s3, 1
 s_lshl_b32 s37, s37, 17
 s_lshl_b32 s34, s80, 8
 s_add_u32 s37, s37, s34
 s_add_u32 s37, s37, 27803648
 s_add_u32 s34, s3, 0
 s_and_b32 s34, s34, 3
 s_lshl_b32 s34, s34, 6
 s_add_u32 s34, s34, s37
 buffer_load_dword a64, v30, s[4:7], s34 offen sc1
 v_mfma_f32_16x16x32_bf16 v[36:39], a[160:163], a[0:3], 0
 s_add_u32 s34, s34, 8192
 buffer_load_dword a65, v30, s[4:7], s34 offen sc1
 v_mfma_f32_16x16x32_bf16 v[40:43], a[164:167], a[0:3], 0
 s_add_u32 s34, s34, 8192
 buffer_load_dword a66, v30, s[4:7], s34 offen sc1
 v_mfma_f32_16x16x32_bf16 v[44:47], a[168:171], a[0:3], 0
 s_add_u32 s34, s34, 8192
 buffer_load_dword a67, v30, s[4:7], s34 offen sc1
 v_mfma_f32_16x16x32_bf16 v[48:51], a[156:159], a[4:7], 0
 s_add_u32 s34, s3, 1
 s_and_b32 s34, s34, 3
 s_lshl_b32 s34, s34, 6
 s_add_u32 s34, s34, s37
 buffer_load_dword a68, v30, s[4:7], s34 offen sc1
 v_mfma_f32_16x16x32_bf16 v[52:55], a[160:163], a[4:7], 0
 s_add_u32 s34, s34, 8192
 buffer_load_dword a69, v30, s[4:7], s34 offen sc1
 v_mfma_f32_16x16x32_bf16 v[56:59], a[164:167], a[4:7], 0
 s_add_u32 s34, s34, 8192
 buffer_load_dword a70, v30, s[4:7], s34 offen sc1
 v_mfma_f32_16x16x32_bf16 v[60:63], a[168:171], a[4:7], 0
 s_add_u32 s34, s34, 8192
 buffer_load_dword a71, v30, s[4:7], s34 offen sc1
 v_mfma_f32_16x16x32_bf16 v[64:67], a[156:159], a[8:11], 0
 s_add_u32 s34, s3, 2
 s_and_b32 s34, s34, 3
 s_lshl_b32 s34, s34, 6
 s_add_u32 s34, s34, s37
 buffer_load_dword a72, v30, s[4:7], s34 offen sc1
 v_mfma_f32_16x16x32_bf16 v[68:71], a[160:163], a[8:11], 0
 s_add_u32 s34, s34, 8192
 buffer_load_dword a73, v30, s[4:7], s34 offen sc1
 v_mfma_f32_16x16x32_bf16 v[72:75], a[164:167], a[8:11], 0
 s_add_u32 s34, s34, 8192
 buffer_load_dword a74, v30, s[4:7], s34 offen sc1
 v_mfma_f32_16x16x32_bf16 v[76:79], a[168:171], a[8:11], 0
 s_add_u32 s34, s34, 8192
 buffer_load_dword a75, v30, s[4:7], s34 offen sc1
 v_mfma_f32_16x16x32_bf16 v[80:83], a[156:159], a[12:15], 0
 s_add_u32 s34, s3, 3
 s_and_b32 s34, s34, 3
 s_lshl_b32 s34, s34, 6
 s_add_u32 s34, s34, s37
 buffer_load_dword a76, v30, s[4:7], s34 offen sc1
 v_mfma_f32_16x16x32_bf16 v[84:87], a[160:163], a[12:15], 0
 s_add_u32 s34, s34, 8192
 buffer_load_dword a77, v30, s[4:7], s34 offen sc1
 v_mfma_f32_16x16x32_bf16 v[88:91], a[164:167], a[12:15], 0
 s_add_u32 s34, s34, 8192
 buffer_load_dword a78, v30, s[4:7], s34 offen sc1
 v_mfma_f32_16x16x32_bf16 v[92:95], a[168:171], a[12:15], 0
 s_add_u32 s34, s34, 8192
 buffer_load_dword a79, v30, s[4:7], s34 offen sc1
 s_waitcnt vmcnt(24)
 v_mfma_f32_16x16x32_bf16 v[32:35], a[176:179], a[16:19], v[32:35]
 v_mfma_f32_16x16x32_bf16 v[36:39], a[180:183], a[16:19], v[36:39]
 v_mfma_f32_16x16x32_bf16 v[40:43], a[184:187], a[16:19], v[40:43]
 v_mfma_f32_16x16x32_bf16 v[44:47], a[188:191], a[16:19], v[44:47]
 v_mfma_f32_16x16x32_bf16 v[48:51], a[176:179], a[20:23], v[48:51]
 v_mfma_f32_16x16x32_bf16 v[52:55], a[180:183], a[20:23], v[52:55]
 s_add_u32 s38, s77, 0
 s_add_u32 m0, s78, 0
 s_nop 0
 buffer_load_dwordx4 v1, s[4:7], s38 offen sc1 lds
 v_mfma_f32_16x16x32_bf16 v[56:59], a[184:187], a[20:23], v[56:59]
 v_mfma_f32_16x16x32_bf16 v[60:63], a[188:191], a[20:23], v[60:63]
 v_mfma_f32_16x16x32_bf16 v[64:67], a[176:179], a[24:27], v[64:67]
 v_mfma_f32_16x16x32_bf16 v[68:71], a[180:183], a[24:27], v[68:71]
 v_mfma_f32_16x16x32_bf16 v[72:75], a[184:187], a[24:27], v[72:75]
 s_add_u32 s38, s77, 4096
 s_add_u32 m0, s78, 4096
 s_nop 0
 buffer_load_dwordx4 v1, s[4:7], s38 offen sc1 lds
 v_mfma_f32_16x16x32_bf16 v[76:79], a[188:191], a[24:27], v[76:79]
 v_mfma_f32_16x16x32_bf16 v[80:83], a[176:179], a[28:31], v[80:83]
 v_mfma_f32_16x16x32_bf16 v[84:87], a[180:183], a[28:31], v[84:87]
 v_mfma_f32_16x16x32_bf16 v[88:91], a[184:187], a[28:31], v[88:91]
 v_mfma_f32_16x16x32_bf16 v[92:95], a[188:191], a[28:31], v[92:95]
 s_add_u32 s38, s77, 8192
 s_add_u32 m0, s78, 8192
 s_nop 0
 buffer_load_dwordx4 v1, s[4:7], s38 offen sc1 lds
 s_waitcnt vmcnt(23)
 v_mfma_f32_16x16x32_bf16 v[32:35], a[196:199], a[32:35], v[32:35]
 v_mfma_f32_16x16x32_bf16 v[36:39], a[200:203], a[32:35], v[36:39]
 v_mfma_f32_16x16x32_bf16 v[40:43], a[204:207], a[32:35], v[40:43]
 v_mfma_f32_16x16x32_bf16 v[44:47], a[208:211], a[32:35], v[44:47]
 v_mfma_f32_16x16x32_bf16 v[48:51], a[196:199], a[36:39], v[48:51]
 s_add_u32 s38, s77, 12288
 s_add_u32 m0, s78, 12288
 s_nop 0
 buffer_load_dwordx4 v1, s[4:7], s38 offen sc1 lds
 v_mfma_f32_16x16x32_bf16 v[52:55], a[200:203], a[36:39], v[52:55]
 v_mfma_f32_16x16x32_bf16 v[56:59], a[204:207], a[36:39], v[56:59]
 v_mfma_f32_16x16x32_bf16 v[60:63], a[208:211], a[36:39], v[60:63]
 v_mfma_f32_16x16x32_bf16 v[64:67], a[196:199], a[40:43], v[64:67]
 v_mfma_f32_16x16x32_bf16 v[68:71], a[200:203], a[40:43], v[68:71]
 s_add_u32 s38, s77, 16384
 s_add_u32 m0, s78, 16384
 s_nop 0
 buffer_load_dwordx4 v1, s[4:7], s38 offen sc1 lds
 v_mfma_f32_16x16x32_bf16 v[72:75], a[204:207], a[40:43], v[72:75]
 v_mfma_f32_16x16x32_bf16 v[76:79], a[208:211], a[40:43], v[76:79]
 v_mfma_f32_16x16x32_bf16 v[80:83], a[196:199], a[44:47], v[80:83]
 v_mfma_f32_16x16x32_bf16 v[84:87], a[200:203], a[44:47], v[84:87]
 v_mfma_f32_16x16x32_bf16 v[88:91], a[204:207], a[44:47], v[88:91]
 s_add_u32 s38, s77, 20480
 s_add_u32 m0, s78, 20480
 s_nop 0
 buffer_load_dwordx4 v1, s[4:7], s38 offen sc1 lds
 v_mfma_f32_16x16x32_bf16 v[92:95], a[208:211], a[44:47], v[92:95]
 s_waitcnt vmcnt(22)
 v_mfma_f32_16x16x32_bf16 v[32:35], a[216:219], a[48:51], v[32:35]
 v_mfma_f32_16x16x32_bf16 v[36:39], a[220:223], a[48:51], v[36:39]
 v_mfma_f32_16x16x32_bf16 v[40:43], a[224:227], a[48:51], v[40:43]
 v_mfma_f32_16x16x32_bf16 v[44:47], a[228:231], a[48:51], v[44:47]
 s_add_u32 s38, s77, 24576
 s_add_u32 m0, s78, 24576
 s_nop 0
 buffer_load_dwordx4 v1, s[4:7], s38 offen sc1 lds
 v_mfma_f32_16x16x32_bf16 v[48:51], a[216:219], a[52:55], v[48:51]
 v_mfma_f32_16x16x32_bf16 v[52:55], a[220:223], a[52:55], v[52:55]
 v_mfma_f32_16x16x32_bf16 v[56:59], a[224:227], a[52:55], v[56:59]
 v_mfma_f32_16x16x32_bf16 v[60:63], a[228:231], a[52:55], v[60:63]
 v_mfma_f32_16x16x32_bf16 v[64:67], a[216:219], a[56:59], v[64:67]
 s_add_u32 s38, s77, 28672
 s_add_u32 m0, s78, 28672
 s_nop 0
 buffer_load_dwordx4 v1, s[4:7], s38 offen sc1 lds
 v_mfma_f32_16x16x32_bf16 v[68:71], a[220:223], a[56:59], v[68:71]
 v_mfma_f32_16x16x32_bf16 v[72:75], a[224:227], a[56:59], v[72:75]
 v_mfma_f32_16x16x32_bf16 v[76:79], a[228:231], a[56:59], v[76:79]
 v_mfma_f32_16x16x32_bf16 v[80:83], a[216:219], a[60:63], v[80:83]
 v_mfma_f32_16x16x32_bf16 v[84:87], a[220:223], a[60:63], v[84:87]
 s_add_u32 s38, s77, 32768
 s_add_u32 m0, s78, 32768
 s_nop 0
 buffer_load_dwordx4 v1, s[4:7], s38 offen sc1 lds
 v_mfma_f32_16x16x32_bf16 v[88:91], a[224:227], a[60:63], v[88:91]
 v_mfma_f32_16x16x32_bf16 v[92:95], a[228:231], a[60:63], v[92:95]
 s_waitcnt vmcnt(9)
 s_cmp_ge_u32 s3, 2
 s_cbranch_scc1 K3A_SKIP
 v_mfma_f32_16x16x32_bf16 v[32:35], a[236:239], a[64:67], v[32:35]
 v_mfma_f32_16x16x32_bf16 v[36:39], a[240:243], a[64:67], v[36:39]
 v_mfma_f32_16x16x32_bf16 v[40:43], a[244:247], a[64:67], v[40:43]
 v_mfma_f32_16x16x32_bf16 v[44:47], a[248:251], a[64:67], v[44:47]
 v_mfma_f32_16x16x32_bf16 v[48:51], a[236:239], a[68:71], v[48:51]
 v_mfma_f32_16x16x32_bf16 v[52:55], a[240:243], a[68:71], v[52:55]
 v_mfma_f32_16x16x32_bf16 v[56:59], a[244:247], a[68:71], v[56:59]
 v_mfma_f32_16x16x32_bf16 v[60:63], a[248:251], a[68:71], v[60:63]
 v_mfma_f32_16x16x32_bf16 v[64:67], a[236:239], a[72:75], v[64:67]
 v_mfma_f32_16x16x32_bf16 v[68:71], a[240:243], a[72:75], v[68:71]
 v_mfma_f32_16x16x32_bf16 v[72:75], a[244:247], a[72:75], v[72:75]
 v_mfma_f32_16x16x32_bf16 v[76:79], a[248:251], a[72:75], v[76:79]
 v_mfma_f32_16x16x32_bf16 v[80:83], a[236:239], a[76:79], v[80:83]
 v_mfma_f32_16x16x32_bf16 v[84:87], a[240:243], a[76:79], v[84:87]
 v_mfma_f32_16x16x32_bf16 v[88:91], a[244:247], a[76:79], v[88:91]
 v_mfma_f32_16x16x32_bf16 v[92:95], a[248:251], a[76:79], v[92:95]
K3A_SKIP:
 s_add_u32 s38, s76, 36864
 s_mov_b32 m0, 36864
 s_nop 0
 buffer_load_dwordx4 v1, s[4:7], s38 offen sc1 lds
 s_nop 7
 ds_write_b128 v12, v[48:51] offset:0
 ds_write_b128 v12, v[52:55] offset:1024
 s_add_u32 s38, s77, 37888
 s_add_u32 m0, s78, 37888
 s_nop 0
 buffer_load_dwordx4 v1, s[4:7], s38 offen sc1 lds
 ds_write_b128 v12, v[56:59] offset:2048
 ds_write_b128 v12, v[60:63] offset:3072
 s_add_u32 s38, s77, 41984
 s_add_u32 m0, s78, 41984
 s_nop 0
 buffer_load_dwordx4 v1, s[4:7], s38 offen sc1 lds
 ds_write_b128 v13, v[64:67] offset:0
 ds_write_b128 v13, v[68:71] offset:1024
 s_add_u32 s38, s77, 46080
 s_add_u32 m0, s78, 46080
 s_nop 0
 buffer_load_dwordx4 v1, s[4:7], s38 offen sc1 lds
 ds_write_b128 v13, v[72:75] offset:2048
 ds_write_b128 v13, v[76:79] offset:3072
 s_add_u32 s38, s77, 50176
 s_add_u32 m0, s78, 50176
 s_nop 0
 buffer_load_dwordx4 v1, s[4:7], s38 offen sc1 lds
 ds_write_b128 v14, v[80:83] offset:0
 ds_write_b128 v14, v[84:87] offset:1024
 s_add_u32 s38, s77, 54272
 s_add_u32 m0, s78, 54272
 s_nop 0
 buffer_load_dwordx4 v1, s[4:7], s38 offen sc1 lds
 ds_write_b128 v14, v[88:91] offset:2048
 ds_write_b128 v14, v[92:95] offset:3072
 s_add_u32 s38, s77, 58368
 s_add_u32 m0, s78, 58368
 s_nop 0
 buffer_load_dwordx4 v1, s[4:7], s38 offen sc1 lds
 v_lshlrev_b32 v96, 16, v16
 v_and_b32 v97, 0xffff0000, v16
 v_lshlrev_b32 v98, 16, v17
 v_and_b32 v99, 0xffff0000, v17
 v_lshlrev_b32 v100, 16, v18
 v_and_b32 v101, 0xffff0000, v18
 v_lshlrev_b32 v102, 16, v19
 v_and_b32 v103, 0xffff0000, v19
 v_lshlrev_b32 v104, 16, v20
 v_and_b32 v105, 0xffff0000, v20
 v_lshlrev_b32 v106, 16, v21
 v_and_b32 v107, 0xffff0000, v21
 v_lshlrev_b32 v108, 16, v22
 v_and_b32 v109, 0xffff0000, v22
 v_lshlrev_b32 v110, 16, v23
 v_and_b32 v111, 0xffff0000, v23
 v_add_f32 v96, v96, v32
 v_add_f32 v97, v97, v33
 v_add_f32 v98, v98, v34
 v_add_f32 v99, v99, v35
 v_add_f32 v100, v100, v36
 v_add_f32 v101, v101, v37
 v_add_f32 v102, v102, v38
 v_add_f32 v103, v103, v39
 v_add_f32 v104, v104, v40
 v_add_f32 v105, v105, v41
 v_add_f32 v106, v106, v42
 v_add_f32 v107, v107, v43
 v_add_f32 v108, v108, v44
 v_add_f32 v109, v109, v45
 v_add_f32 v110, v110, v46
 v_add_f32 v111, v111, v47
 s_waitcnt lgkmcnt(0)
 s_barrier
 ds_read_b128 v[48:51], v27 offset:0
 ds_read_b128 v[52:55], v27 offset:1024
 ds_read_b128 v[56:59], v27 offset:2048
 ds_read_b128 v[60:63], v27 offset:3072
 ds_read_b128 v[64:67], v27 offset:5120
 ds_read_b128 v[68:71], v27 offset:6144
 ds_read_b128 v[72:75], v27 offset:7168
 ds_read_b128 v[76:79], v27 offset:8192
 ds_read_b128 v[80:83], v27 offset:10240
 ds_read_b128 v[84:87], v27 offset:11264
 ds_read_b128 v[88:91], v27 offset:12288
 ds_read_b128 v[92:95], v27 offset:13312
 s_waitcnt lgkmcnt(8)
 v_add_f32 v96, v96, v48
 v_add_f32 v97, v97, v49
 v_add_f32 v98, v98, v50
 v_add_f32 v99, v99, v51
 v_add_f32 v100, v100, v52
 v_add_f32 v101, v101, v53
 v_add_f32 v102, v102, v54
 v_add_f32 v103, v103, v55
 v_add_f32 v104, v104, v56
 v_add_f32 v105, v105, v57
 v_add_f32 v106, v106, v58
 v_add_f32 v107, v107, v59
 v_add_f32 v108, v108, v60
 v_add_f32 v109, v109, v61
 v_add_f32 v110, v110, v62
 v_add_f32 v111, v111, v63
 s_waitcnt lgkmcnt(4)
 v_add_f32 v96, v96, v64
 v_add_f32 v97, v97, v65
 v_add_f32 v98, v98, v66
 v_add_f32 v99, v99, v67
 v_add_f32 v100, v100, v68
 v_add_f32 v101, v101, v69
 v_add_f32 v102, v102, v70
 v_add_f32 v103, v103, v71
 v_add_f32 v104, v104, v72
 v_add_f32 v105, v105, v73
 v_add_f32 v106, v106, v74
 v_add_f32 v107, v107, v75
 v_add_f32 v108, v108, v76
 v_add_f32 v109, v109, v77
 v_add_f32 v110, v110, v78
 v_add_f32 v111, v111, v79
 s_waitcnt lgkmcnt(0)
 v_add_f32 v96, v96, v80
 v_add_f32 v97, v97, v81
 v_add_f32 v98, v98, v82
 v_add_f32 v99, v99, v83
 v_add_f32 v100, v100, v84
 v_add_f32 v101, v101, v85
 v_add_f32 v102, v102, v86
 v_add_f32 v103, v103, v87
 v_add_f32 v104, v104, v88
 v_add_f32 v105, v105, v89
 v_add_f32 v106, v106, v90
 v_add_f32 v107, v107, v91
 v_add_f32 v108, v108, v92
 v_add_f32 v109, v109, v93
 v_add_f32 v110, v110, v94
 v_add_f32 v111, v111, v95
 v_cvt_pk_bf16_f32 v16, v96, v97
 v_cvt_pk_bf16_f32 v17, v98, v99
 v_cvt_pk_bf16_f32 v18, v100, v101
 v_cvt_pk_bf16_f32 v19, v102, v103
 v_cvt_pk_bf16_f32 v20, v104, v105
 v_cvt_pk_bf16_f32 v21, v106, v107
 v_cvt_pk_bf16_f32 v22, v108, v109
 v_cvt_pk_bf16_f32 v23, v110, v111
 v_bfe_u32 v28, v0, 4, 1
 v_lshlrev_b32 v28, 10, v28
 v_bfe_u32 v30, v0, 5, 1
 v_lshlrev_b32 v30, 9, v30
 v_and_b32 v31, 15, v0
 v_lshlrev_b32 v31, 4, v31
 v_add3_u32 v30, v28, v30, v31
 v_permlane16_swap_b32 v16, v18
 v_permlane16_swap_b32 v17, v19
 v_permlane16_swap_b32 v20, v22
 v_permlane16_swap_b32 v21, v23
 buffer_store_dwordx4 v[16:19], v30, s[4:7], s22 offen offset:0 sc1
 buffer_store_dwordx4 v[20:23], v30, s[4:7], s22 offen offset:2048 sc1
 v_lshlrev_b32 v96, 16, v16
 v_and_b32 v97, 0xffff0000, v16
 v_lshlrev_b32 v98, 16, v17
 v_and_b32 v99, 0xffff0000, v17
 v_lshlrev_b32 v100, 16, v18
 v_and_b32 v101, 0xffff0000, v18
 v_lshlrev_b32 v102, 16, v19
 v_and_b32 v103, 0xffff0000, v19
 v_lshlrev_b32 v104, 16, v20
 v_and_b32 v105, 0xffff0000, v20
 v_lshlrev_b32 v106, 16, v21
 v_and_b32 v107, 0xffff0000, v21
 v_lshlrev_b32 v108, 16, v22
 v_and_b32 v109, 0xffff0000, v22
 v_lshlrev_b32 v110, 16, v23
 v_and_b32 v111, 0xffff0000, v23
 v_add_f32 v26, v96, v97
 v_add_f32 v27, v98, v99
 v_add_f32 v26, v26, v100
 v_add_f32 v27, v27, v101
 v_add_f32 v26, v26, v102
 v_add_f32 v27, v27, v103
 v_add_f32 v26, v26, v104
 v_add_f32 v27, v27, v105
 v_add_f32 v26, v26, v106
 v_add_f32 v27, v27, v107
 v_add_f32 v26, v26, v108
 v_add_f32 v27, v27, v109
 v_add_f32 v26, v26, v110
 v_add_f32 v27, v27, v111
 v_add_f32 v26, v26, v27
 v_mov_b32 v28, v26
 s_nop 1
 v_permlane16_swap_b32 v26, v28
 v_add_f32 v26, v26, v28
 v_mov_b32 v28, v26
 s_nop 1
 v_permlane32_swap_b32 v26, v28
 v_add_f32 v26, v26, v28
 v_mul_f32 v26, 0x3c800000, v26
 v_mov_b32 v27, 0
 v_sub_f32 v96, v96, v26
 v_fmac_f32 v27, v96, v96
 v_sub_f32 v97, v97, v26
 v_fmac_f32 v27, v97, v97
 v_sub_f32 v98, v98, v26
 v_fmac_f32 v27, v98, v98
 v_sub_f32 v99, v99, v26
 v_fmac_f32 v27, v99, v99
 v_sub_f32 v100, v100, v26
 v_fmac_f32 v27, v100, v100
 v_sub_f32 v101, v101, v26
 v_fmac_f32 v27, v101, v101
 v_sub_f32 v102, v102, v26
 v_fmac_f32 v27, v102, v102
 v_sub_f32 v103, v103, v26
 v_fmac_f32 v27, v103, v103
 v_sub_f32 v104, v104, v26
 v_fmac_f32 v27, v104, v104
 v_sub_f32 v105, v105, v26
 v_fmac_f32 v27, v105, v105
 v_sub_f32 v106, v106, v26
 v_fmac_f32 v27, v106, v106
 v_sub_f32 v107, v107, v26
 v_fmac_f32 v27, v107, v107
 v_sub_f32 v108, v108, v26
 v_fmac_f32 v27, v108, v108
 v_sub_f32 v109, v109, v26
 v_fmac_f32 v27, v109, v109
 v_sub_f32 v110, v110, v26
 v_fmac_f32 v27, v110, v110
 v_sub_f32 v111, v111, v26
 v_fmac_f32 v27, v111, v111
 v_mov_b32 v28, v27
 s_nop 1
 v_permlane16_swap_b32 v27, v28
 v_add_f32 v27, v27, v28
 v_mov_b32 v28, v27
 s_nop 1
 v_permlane32_swap_b32 v27, v28
 v_add_f32 v27, v27, v28
 buffer_store_dwordx2 v[26:27], v15, s[4:7], s36 offen sc1
 s_branch K3_DONE
K3_N5:
 s_add_u32 s37, s20, 0
 buffer_load_dwordx4 a[0:3], v2, s[4:7], s37 offen sc1
 buffer_load_dwordx4 a[4:7], v3, s[4:7], s37 offen sc1
 buffer_load_dwordx4 a[8:11], v4, s[4:7], s37 offen sc1
 buffer_load_dwordx4 a[12:15], v5, s[4:7], s37 offen sc1
 s_add_u32 s37, s20, 4096
 buffer_load_dwordx4 a[16:19], v2, s[4:7], s37 offen sc1
 buffer_load_dwordx4 a[20:23], v3, s[4:7], s37 offen sc1
 buffer_load_dwordx4 a[24:27], v4, s[4:7], s37 offen sc1
 buffer_load_dwordx4 a[28:31], v5, s[4:7], s37 offen sc1
 s_add_u32 s37, s20, 8192
 buffer_load_dwordx4 a[32:35], v2, s[4:7], s37 offen sc1
 buffer_load_dwordx4 a[36:39], v3, s[4:7], s37 offen sc1
 buffer_load_dwordx4 a[40:43], v4, s[4:7], s37 offen sc1
 buffer_load_dwordx4 a[44:47], v5, s[4:7], s37 offen sc1
 s_add_u32 s37, s20, 12288
 buffer_load_dwordx4 a[48:51], v2, s[4:7], s37 offen sc1
 buffer_load_dwordx4 a[52:55], v3, s[4:7], s37 offen sc1
 buffer_load_dwordx4 a[56:59], v4, s[4:7], s37 offen sc1
 buffer_load_dwordx4 a[60:63], v5, s[4:7], s37 offen sc1
 s_waitcnt vmcnt(12)
 v_mfma_f32_16x16x32_bf16 v[32:35], a[156:159], a[0:3], 0
 v_bfe_u32 v30, v0, 4, 2
 v_lshlrev_b32 v30, 15, v30
 v_and_b32 v31, 15, v0
 v_lshlrev_b32 v31, 2, v31
 v_add_u32 v30, v30, v31
 s_and_b32 s37, s3, 1
 s_lshl_b32 s37, s37, 17
 s_lshl_b32 s34, s80, 8
 s_add_u32 s37, s37, s34
 s_add_u32 s37, s37, 27803648
 s_add_u32 s34, s3, 0
 s_and_b32 s34, s34, 3
 s_lshl_b32 s34, s34, 6
 s_add_u32 s34, s34, s37
 buffer_load_dword a64, v30, s[4:7], s34 offen sc1
 v_mfma_f32_16x16x32_bf16 v[36:39], a[160:163], a[0:3], 0
 s_add_u32 s34, s34, 8192
 buffer_load_dword a65, v30, s[4:7], s34 offen sc1
 v_mfma_f32_16x16x32_bf16 v[40:43], a[164:167], a[0:3], 0
 s_add_u32 s34, s34, 8192
 buffer_load_dword a66, v30, s[4:7], s34 offen sc1
 v_mfma_f32_16x16x32_bf16 v[44:47], a[168:171], a[0:3], 0
 s_add_u32 s34, s34, 8192
 buffer_load_dword a67, v30, s[4:7], s34 offen sc1
 v_mfma_f32_16x16x32_bf16 v[48:51], a[172:175], a[0:3], 0
 s_add_u32 s34, s3, 1
 s_and_b32 s34, s34, 3
 s_lshl_b32 s34, s34, 6
 s_add_u32 s34, s34, s37
 buffer_load_dword a68, v30, s[4:7], s34 offen sc1
 v_mfma_f32_16x16x32_bf16 v[52:55], a[156:159], a[4:7], 0
 s_add_u32 s34, s34, 8192
 buffer_load_dword a69, v30, s[4:7], s34 offen sc1
 v_mfma_f32_16x16x32_bf16 v[56:59], a[160:163], a[4:7], 0
 s_add_u32 s34, s34, 8192
 buffer_load_dword a70, v30, s[4:7], s34 offen sc1
 v_mfma_f32_16x16x32_bf16 v[60:63], a[164:167], a[4:7], 0
 s_add_u32 s34, s34, 8192
 buffer_load_dword a71, v30, s[4:7], s34 offen sc1
 v_mfma_f32_16x16x32_bf16 v[64:67], a[168:171], a[4:7], 0
 s_add_u32 s34, s3, 2
 s_and_b32 s34, s34, 3
 s_lshl_b32 s34, s34, 6
 s_add_u32 s34, s34, s37
 buffer_load_dword a72, v30, s[4:7], s34 offen sc1
 v_mfma_f32_16x16x32_bf16 v[68:71], a[172:175], a[4:7], 0
 s_add_u32 s34, s34, 8192
 buffer_load_dword a73, v30, s[4:7], s34 offen sc1
 v_mfma_f32_16x16x32_bf16 v[72:75], a[156:159], a[8:11], 0
 s_add_u32 s34, s34, 8192
 buffer_load_dword a74, v30, s[4:7], s34 offen sc1
 v_mfma_f32_16x16x32_bf16 v[76:79], a[160:163], a[8:11], 0
 s_add_u32 s34, s34, 8192
 buffer_load_dword a75, v30, s[4:7], s34 offen sc1
 v_mfma_f32_16x16x32_bf16 v[80:83], a[164:167], a[8:11], 0
 s_add_u32 s34, s3, 3
 s_and_b32 s34, s34, 3
 s_lshl_b32 s34, s34, 6
 s_add_u32 s34, s34, s37
 buffer_load_dword a76, v30, s[4:7], s34 offen sc1
 v_mfma_f32_16x16x32_bf16 v[84:87], a[168:171], a[8:11], 0
 s_add_u32 s34, s34, 8192
 buffer_load_dword a77, v30, s[4:7], s34 offen sc1
 v_mfma_f32_16x16x32_bf16 v[88:91], a[172:175], a[8:11], 0
 s_add_u32 s34, s34, 8192
 buffer_load_dword a78, v30, s[4:7], s34 offen sc1
 v_mfma_f32_16x16x32_bf16 v[92:95], a[156:159], a[12:15], 0
 s_add_u32 s34, s34, 8192
 buffer_load_dword a79, v30, s[4:7], s34 offen sc1
 v_mfma_f32_16x16x32_bf16 v[96:99], a[160:163], a[12:15], 0
 v_mfma_f32_16x16x32_bf16 v[100:103], a[164:167], a[12:15], 0
 v_mfma_f32_16x16x32_bf16 v[104:107], a[168:171], a[12:15], 0
 v_mfma_f32_16x16x32_bf16 v[108:111], a[172:175], a[12:15], 0
 s_waitcnt vmcnt(24)
 v_mfma_f32_16x16x32_bf16 v[32:35], a[176:179], a[16:19], v[32:35]
 v_mfma_f32_16x16x32_bf16 v[36:39], a[180:183], a[16:19], v[36:39]
 s_add_u32 s38, s77, 0
 s_add_u32 m0, s78, 0
 s_nop 0
 buffer_load_dwordx4 v1, s[4:7], s38 offen sc1 lds
 v_mfma_f32_16x16x32_bf16 v[40:43], a[184:187], a[16:19], v[40:43]
 v_mfma_f32_16x16x32_bf16 v[44:47], a[188:191], a[16:19], v[44:47]
 v_mfma_f32_16x16x32_bf16 v[48:51], a[192:195], a[16:19], v[48:51]
 v_mfma_f32_16x16x32_bf16 v[52:55], a[176:179], a[20:23], v[52:55]
 v_mfma_f32_16x16x32_bf16 v[56:59], a[180:183], a[20:23], v[56:59]
 s_add_u32 s38, s77, 4096
 s_add_u32 m0, s78, 4096
 s_nop 0
 buffer_load_dwordx4 v1, s[4:7], s38 offen sc1 lds
 v_mfma_f32_16x16x32_bf16 v[60:63], a[184:187], a[20:23], v[60:63]
 v_mfma_f32_16x16x32_bf16 v[64:67], a[188:191], a[20:23], v[64:67]
 v_mfma_f32_16x16x32_bf16 v[68:71], a[192:195], a[20:23], v[68:71]
 v_mfma_f32_16x16x32_bf16 v[72:75], a[176:179], a[24:27], v[72:75]
 v_mfma_f32_16x16x32_bf16 v[76:79], a[180:183], a[24:27], v[76:79]
 s_add_u32 s38, s77, 8192
 s_add_u32 m0, s78, 8192
 s_nop 0
 buffer_load_dwordx4 v1, s[4:7], s38 offen sc1 lds
 v_mfma_f32_16x16x32_bf16 v[80:83], a[184:187], a[24:27], v[80:83]
 v_mfma_f32_16x16x32_bf16 v[84:87], a[188:191], a[24:27], v[84:87]
 v_mfma_f32_16x16x32_bf16 v[88:91], a[192:195], a[24:27], v[88:91]
 v_mfma_f32_16x16x32_bf16 v[92:95], a[176:179], a[28:31], v[92:95]
 v_mfma_f32_16x16x32_bf16 v[96:99], a[180:183], a[28:31], v[96:99]
 s_add_u32 s38, s77, 12288
 s_add_u32 m0, s78, 12288
 s_nop 0
 buffer_load_dwordx4 v1, s[4:7], s38 offen sc1 lds
 v_mfma_f32_16x16x32_bf16 v[100:103], a[184:187], a[28:31], v[100:103]
 v_mfma_f32_16x16x32_bf16 v[104:107], a[188:191], a[28:31], v[104:107]
 v_mfma_f32_16x16x32_bf16 v[108:111], a[192:195], a[28:31], v[108:111]
 s_waitcnt vmcnt(24)
 v_mfma_f32_16x16x32_bf16 v[32:35], a[196:199], a[32:35], v[32:35]
 v_mfma_f32_16x16x32_bf16 v[36:39], a[200:203], a[32:35], v[36:39]
 s_add_u32 s38, s77, 16384
 s_add_u32 m0, s78, 16384
 s_nop 0
 buffer_load_dwordx4 v1, s[4:7], s38 offen sc1 lds
 v_mfma_f32_16x16x32_bf16 v[40:43], a[204:207], a[32:35], v[40:43]
 v_mfma_f32_16x16x32_bf16 v[44:47], a[208:211], a[32:35], v[44:47]
 v_mfma_f32_16x16x32_bf16 v[48:51], a[212:215], a[32:35], v[48:51]
 v_mfma_f32_16x16x32_bf16 v[52:55], a[196:199], a[36:39], v[52:55]
 v_mfma_f32_16x16x32_bf16 v[56:59], a[200:203], a[36:39], v[56:59]
 s_add_u32 s38, s77, 20480
 s_add_u32 m0, s78, 20480
 s_nop 0
 buffer_load_dwordx4 v1, s[4:7], s38 offen sc1 lds
 v_mfma_f32_16x16x32_bf16 v[60:63], a[204:207], a[36:39], v[60:63]
 v_mfma_f32_16x16x32_bf16 v[64:67], a[208:211], a[36:39], v[64:67]
 v_mfma_f32_16x16x32_bf16 v[68:71], a[212:215], a[36:39], v[68:71]
 v_mfma_f32_16x16x32_bf16 v[72:75], a[196:199], a[40:43], v[72:75]
 v_mfma_f32_16x16x32_bf16 v[76:79], a[200:203], a[40:43], v[76:79]
 s_add_u32 s38, s77, 24576
 s_add_u32 m0, s78, 24576
 s_nop 0
 buffer_load_dwordx4 v1, s[4:7], s38 offen sc1 lds
 v_mfma_f32_16x16x32_bf16 v[80:83], a[204:207], a[40:43], v[80:83]
 v_mfma_f32_16x16x32_bf16 v[84:87], a[208:211], a[40:43], v[84:87]
 v_mfma_f32_16x16x32_bf16 v[88:91], a[212:215], a[40:43], v[88:91]
 v_mfma_f32_16x16x32_bf16 v[92:95], a[196:199], a[44:47], v[92:95]
 v_mfma_f32_16x16x32_bf16 v[96:99], a[200:203], a[44:47], v[96:99]
 s_add_u32 s38, s77, 28672
 s_add_u32 m0, s78, 28672
 s_nop 0
 buffer_load_dwordx4 v1, s[4:7], s38 offen sc1 lds
 v_mfma_f32_16x16x32_bf16 v[100:103], a[204:207], a[44:47], v[100:103]
 v_mfma_f32_16x16x32_bf16 v[104:107], a[208:211], a[44:47], v[104:107]
 v_mfma_f32_16x16x32_bf16 v[108:111], a[212:215], a[44:47], v[108:111]
 s_waitcnt vmcnt(24)
 v_mfma_f32_16x16x32_bf16 v[32:35], a[216:219], a[48:51], v[32:35]
 v_mfma_f32_16x16x32_bf16 v[36:39], a[220:223], a[48:51], v[36:39]
 s_add_u32 s38, s77, 32768
 s_add_u32 m0, s78, 32768
 s_nop 0
 buffer_load_dwordx4 v1, s[4:7], s38 offen sc1 lds
 v_mfma_f32_16x16x32_bf16 v[40:43], a[224:227], a[48:51], v[40:43]
 v_mfma_f32_16x16x32_bf16 v[44:47], a[228:231], a[48:51], v[44:47]
 v_mfma_f32_16x16x32_bf16 v[48:51], a[232:235], a[48:51], v[48:51]
 v_mfma_f32_16x16x32_bf16 v[52:55], a[216:219], a[52:55], v[52:55]
 v_mfma_f32_16x16x32_bf16 v[56:59], a[220:223], a[52:55], v[56:59]
 s_add_u32 s38, s76, 36864
 s_mov_b32 m0, 36864
 s_nop 0
 buffer_load_dwordx4 v1, s[4:7], s38 offen sc1 lds
 v_mfma_f32_16x16x32_bf16 v[60:63], a[224:227], a[52:55], v[60:63]
 v_mfma_f32_16x16x32_bf16 v[64:67], a[228:231], a[52:55], v[64:67]
 v_mfma_f32_16x16x32_bf16 v[68:71], a[232:235], a[52:55], v[68:71]
 v_mfma_f32_16x16x32_bf16 v[72:75], a[216:219], a[56:59], v[72:75]
 v_mfma_f32_16x16x32_bf16 v[76:79], a[220:223], a[56:59], v[76:79]
 s_add_u32 s38, s77, 37888
 s_add_u32 m0, s78, 37888
 s_nop 0
 buffer_load_dwordx4 v1, s[4:7], s38 offen sc1 lds
 v_mfma_f32_16x16x32_bf16 v[80:83], a[224:227], a[56:59], v[80:83]
 v_mfma_f32_16x16x32_bf16 v[84:87], a[228:231], a[56:59], v[84:87]
 v_mfma_f32_16x16x32_bf16 v[88:91], a[232:235], a[56:59], v[88:91]
 v_mfma_f32_16x16x32_bf16 v[92:95], a[216:219], a[60:63], v[92:95]
 v_mfma_f32_16x16x32_bf16 v[96:99], a[220:223], a[60:63], v[96:99]
 s_add_u32 s38, s77, 41984
 s_add_u32 m0, s78, 41984
 s_nop 0
 buffer_load_dwordx4 v1, s[4:7], s38 offen sc1 lds
 v_mfma_f32_16x16x32_bf16 v[100:103], a[224:227], a[60:63], v[100:103]
 v_mfma_f32_16x16x32_bf16 v[104:107], a[228:231], a[60:63], v[104:107]
 v_mfma_f32_16x16x32_bf16 v[108:111], a[232:235], a[60:63], v[108:111]
 s_waitcnt vmcnt(12)
 s_cmp_ge_u32 s3, 2
 s_cbranch_scc1 K3B_SKIP
 v_mfma_f32_16x16x32_bf16 v[32:35], a[236:239], a[64:67], v[32:35]
 v_mfma_f32_16x16x32_bf16 v[36:39], a[240:243], a[64:67], v[36:39]
 v_mfma_f32_16x16x32_bf16 v[40:43], a[244:247], a[64:67], v[40:43]
 v_mfma_f32_16x16x32_bf16 v[44:47], a[248:251], a[64:67], v[44:47]
 v_mfma_f32_16x16x32_bf16 v[48:51], a[252:255], a[64:67], v[48:51]
 v_mfma_f32_16x16x32_bf16 v[52:55], a[236:239], a[68:71], v[52:55]
 v_mfma_f32_16x16x32_bf16 v[56:59], a[240:243], a[68:71], v[56:59]
 v_mfma_f32_16x16x32_bf16 v[60:63], a[244:247], a[68:71], v[60:63]
 v_mfma_f32_16x16x32_bf16 v[64:67], a[248:251], a[68:71], v[64:67]
 v_mfma_f32_16x16x32_bf16 v[68:71], a[252:255], a[68:71], v[68:71]
 v_mfma_f32_16x16x32_bf16 v[72:75], a[236:239], a[72:75], v[72:75]
 v_mfma_f32_16x16x32_bf16 v[76:79], a[240:243], a[72:75], v[76:79]
 v_mfma_f32_16x16x32_bf16 v[80:83], a[244:247], a[72:75], v[80:83]
 v_mfma_f32_16x16x32_bf16 v[84:87], a[248:251], a[72:75], v[84:87]
 v_mfma_f32_16x16x32_bf16 v[88:91], a[252:255], a[72:75], v[88:91]
 v_mfma_f32_16x16x32_bf16 v[92:95], a[236:239], a[76:79], v[92:95]
 v_mfma_f32_16x16x32_bf16 v[96:99], a[240:243], a[76:79], v[96:99]
 v_mfma_f32_16x16x32_bf16 v[100:103], a[244:247], a[76:79], v[100:103]
 v_mfma_f32_16x16x32_bf16 v[104:107], a[248:251], a[76:79], v[104:107]
 v_mfma_f32_16x16x32_bf16 v[108:111], a[252:255], a[76:79], v[108:111]
K3B_SKIP:
 s_add_u32 s38, s77, 46080
 s_add_u32 m0, s78, 46080
 s_nop 0
 buffer_load_dwordx4 v1, s[4:7], s38 offen sc1 lds
 s_nop 7
 ds_write_b128 v12, v[52:55] offset:0
 ds_write_b128 v12, v[56:59] offset:1024
 s_add_u32 s38, s77, 50176
 s_add_u32 m0, s78, 50176
 s_nop 0
 buffer_load_dwordx4 v1, s[4:7], s38 offen sc1 lds
 ds_write_b128 v12, v[60:63] offset:2048
 ds_write_b128 v12, v[64:67] offset:3072
 s_add_u32 s38, s77, 54272
 s_add_u32 m0, s78, 54272
 s_nop 0
 buffer_load_dwordx4 v1, s[4:7], s38 offen sc1 lds
 ds_write_b128 v12, v[68:71] offset:4096
 ds_write_b128 v13, v[72:75] offset:0
 s_add_u32 s38, s77, 58368
 s_add_u32 m0, s78, 58368
 s_nop 0
 buffer_load_dwordx4 v1, s[4:7], s38 offen sc1 lds
 ds_write_b128 v13, v[76:79] offset:1024
 ds_write_b128 v13, v[80:83] offset:2048
 ds_write_b128 v13, v[84:87] offset:3072
 ds_write_b128 v13, v[88:91] offset:4096
 ds_write_b128 v14, v[92:95] offset:0
 ds_write_b128 v14, v[96:99] offset:1024
 ds_write_b128 v14, v[100:103] offset:2048
 ds_write_b128 v14, v[104:107] offset:3072
 ds_write_b128 v14, v[108:111] offset:4096
 v_lshlrev_b32 v112, 16, v16
 v_and_b32 v113, 0xffff0000, v16
 v_lshlrev_b32 v114, 16, v17
 v_and_b32 v115, 0xffff0000, v17
 v_lshlrev_b32 v116, 16, v18
 v_and_b32 v117, 0xffff0000, v18
 v_lshlrev_b32 v118, 16, v19
 v_and_b32 v119, 0xffff0000, v19
 v_lshlrev_b32 v120, 16, v20
 v_and_b32 v121, 0xffff0000, v20
 v_lshlrev_b32 v122, 16, v21
 v_and_b32 v123, 0xffff0000, v21
 v_lshlrev_b32 v124, 16, v22
 v_and_b32 v125, 0xffff0000, v22
 v_lshlrev_b32 v126, 16, v23
 v_and_b32 v127, 0xffff0000, v23
 v_lshlrev_b32 v128, 16, v24
 v_and_b32 v129, 0xffff0000, v24
 v_lshlrev_b32 v130, 16, v25
 v_and_b32 v131, 0xffff0000, v25
 v_add_f32 v112, v112, v32
 v_add_f32 v113, v113, v33
 v_add_f32 v114, v114, v34
 v_add_f32 v115, v115, v35
 v_add_f32 v116, v116, v36
 v_add_f32 v117, v117, v37
 v_add_f32 v118, v118, v38
 v_add_f32 v119, v119, v39
 v_add_f32 v120, v120, v40
 v_add_f32 v121, v121, v41
 v_add_f32 v122, v122, v42
 v_add_f32 v123, v123, v43
 v_add_f32 v124, v124, v44
 v_add_f32 v125, v125, v45
 v_add_f32 v126, v126, v46
 v_add_f32 v127, v127, v47
 v_add_f32 v128, v128, v48
 v_add_f32 v129, v129, v49
 v_add_f32 v130, v130, v50
 v_add_f32 v131, v131, v51
 s_waitcnt lgkmcnt(0)
 s_barrier
 ds_read_b128 v[52:55], v27 offset:0
 ds_read_b128 v[56:59], v27 offset:1024
 ds_read_b128 v[60:63], v27 offset:2048
 ds_read_b128 v[64:67], v27 offset:3072
 ds_read_b128 v[68:71], v27 offset:4096
 ds_read_b128 v[72:75], v27 offset:5120
 ds_read_b128 v[76:79], v27 offset:6144
 ds_read_b128 v[80:83], v27 offset:7168
 ds_read_b128 v[84:87], v27 offset:8192
 ds_read_b128 v[88:91], v27 offset:9216
 ds_read_b128 v[92:95], v27 offset:10240
 ds_read_b128 v[96:99], v27 offset:11264
 ds_read_b128 v[100:103], v27 offset:12288
 ds_read_b128 v[104:107], v27 offset:13312
 ds_read_b128 v[108:111], v27 offset:14336
 s_waitcnt lgkmcnt(10)
 v_add_f32 v112, v112, v52
 v_add_f32 v113, v113, v53
 v_add_f32 v114, v114, v54
 v_add_f32 v115, v115, v55
 v_add_f32 v116, v116, v56
 v_add_f32 v117, v117, v57
 v_add_f32 v118, v118, v58
 v_add_f32 v119, v119, v59
 v_add_f32 v120, v120, v60
 v_add_f32 v121, v121, v61
 v_add_f32 v122, v122, v62
 v_add_f32 v123, v123, v63
 v_add_f32 v124, v124, v64
 v_add_f32 v125, v125, v65
 v_add_f32 v126, v126, v66
 v_add_f32 v127, v127, v67
 v_add_f32 v128, v128, v68
 v_add_f32 v129, v129, v69
 v_add_f32 v130, v130, v70
 v_add_f32 v131, v131, v71
 s_waitcnt lgkmcnt(5)
 v_add_f32 v112, v112, v72
 v_add_f32 v113, v113, v73
 v_add_f32 v114, v114, v74
 v_add_f32 v115, v115, v75
 v_add_f32 v116, v116, v76
 v_add_f32 v117, v117, v77
 v_add_f32 v118, v118, v78
 v_add_f32 v119, v119, v79
 v_add_f32 v120, v120, v80
 v_add_f32 v121, v121, v81
 v_add_f32 v122, v122, v82
 v_add_f32 v123, v123, v83
 v_add_f32 v124, v124, v84
 v_add_f32 v125, v125, v85
 v_add_f32 v126, v126, v86
 v_add_f32 v127, v127, v87
 v_add_f32 v128, v128, v88
 v_add_f32 v129, v129, v89
 v_add_f32 v130, v130, v90
 v_add_f32 v131, v131, v91
 s_waitcnt lgkmcnt(0)
 v_add_f32 v112, v112, v92
 v_add_f32 v113, v113, v93
 v_add_f32 v114, v114, v94
 v_add_f32 v115, v115, v95
 v_add_f32 v116, v116, v96
 v_add_f32 v117, v117, v97
 v_add_f32 v118, v118, v98
 v_add_f32 v119, v119, v99
 v_add_f32 v120, v120, v100
 v_add_f32 v121, v121, v101
 v_add_f32 v122, v122, v102
 v_add_f32 v123, v123, v103
 v_add_f32 v124, v124, v104
 v_add_f32 v125, v125, v105
 v_add_f32 v126, v126, v106
 v_add_f32 v127, v127, v107
 v_add_f32 v128, v128, v108
 v_add_f32 v129, v129, v109
 v_add_f32 v130, v130, v110
 v_add_f32 v131, v131, v111
 v_cvt_pk_bf16_f32 v16, v112, v113
 v_cvt_pk_bf16_f32 v17, v114, v115
 v_cvt_pk_bf16_f32 v18, v116, v117
 v_cvt_pk_bf16_f32 v19, v118, v119
 v_cvt_pk_bf16_f32 v20, v120, v121
 v_cvt_pk_bf16_f32 v21, v122, v123
 v_cvt_pk_bf16_f32 v22, v124, v125
 v_cvt_pk_bf16_f32 v23, v126, v127
 v_cvt_pk_bf16_f32 v24, v128, v129
 v_cvt_pk_bf16_f32 v25, v130, v131
 v_bfe_u32 v28, v0, 4, 1
 v_lshlrev_b32 v28, 10, v28
 v_bfe_u32 v30, v0, 5, 1
 v_lshlrev_b32 v30, 9, v30
 v_and_b32 v31, 15, v0
 v_lshlrev_b32 v31, 4, v31
 v_add3_u32 v30, v28, v30, v31
 v_permlane16_swap_b32 v16, v18
 v_permlane16_swap_b32 v17, v19
 v_permlane16_swap_b32 v20, v22
 v_permlane16_swap_b32 v21, v23
 buffer_store_dwordx4 v[16:19], v30, s[4:7], s22 offen offset:0 sc1
 buffer_store_dwordx4 v[20:23], v30, s[4:7], s22 offen offset:2048 sc1
 buffer_store_dwordx2 v[24:25], v11, s[4:7], s23 offen sc1
 v_lshlrev_b32 v112, 16, v16
 v_and_b32 v113, 0xffff0000, v16
 v_lshlrev_b32 v114, 16, v17
 v_and_b32 v115, 0xffff0000, v17
 v_lshlrev_b32 v116, 16, v18
 v_and_b32 v117, 0xffff0000, v18
 v_lshlrev_b32 v118, 16, v19
 v_and_b32 v119, 0xffff0000, v19
 v_lshlrev_b32 v120, 16, v20
 v_and_b32 v121, 0xffff0000, v20
 v_lshlrev_b32 v122, 16, v21
 v_and_b32 v123, 0xffff0000, v21
 v_lshlrev_b32 v124, 16, v22
 v_and_b32 v125, 0xffff0000, v22
 v_lshlrev_b32 v126, 16, v23
 v_and_b32 v127, 0xffff0000, v23
 v_lshlrev_b32 v128, 16, v24
 v_and_b32 v129, 0xffff0000, v24
 v_lshlrev_b32 v130, 16, v25
 v_and_b32 v131, 0xffff0000, v25
 v_add_f32 v26, v112, v113
 v_add_f32 v27, v114, v115
 v_add_f32 v26, v26, v116
 v_add_f32 v27, v27, v117
 v_add_f32 v26, v26, v118
 v_add_f32 v27, v27, v119
 v_add_f32 v26, v26, v120
 v_add_f32 v27, v27, v121
 v_add_f32 v26, v26, v122
 v_add_f32 v27, v27, v123
 v_add_f32 v26, v26, v124
 v_add_f32 v27, v27, v125
 v_add_f32 v26, v26, v126
 v_add_f32 v27, v27, v127
 v_add_f32 v26, v26, v128
 v_add_f32 v27, v27, v129
 v_add_f32 v26, v26, v130
 v_add_f32 v27, v27, v131
 v_add_f32 v26, v26, v27
 v_mov_b32 v28, v26
 s_nop 1
 v_permlane16_swap_b32 v26, v28
 v_add_f32 v26, v26, v28
 v_mov_b32 v28, v26
 s_nop 1
 v_permlane32_swap_b32 v26, v28
 v_add_f32 v26, v26, v28
 v_mul_f32 v26, 0x3c4ccccd, v26
 v_mov_b32 v27, 0
 v_sub_f32 v112, v112, v26
 v_fmac_f32 v27, v112, v112
 v_sub_f32 v113, v113, v26
 v_fmac_f32 v27, v113, v113
 v_sub_f32 v114, v114, v26
 v_fmac_f32 v27, v114, v114
 v_sub_f32 v115, v115, v26
 v_fmac_f32 v27, v115, v115
 v_sub_f32 v116, v116, v26
 v_fmac_f32 v27, v116, v116
 v_sub_f32 v117, v117, v26
 v_fmac_f32 v27, v117, v117
 v_sub_f32 v118, v118, v26
 v_fmac_f32 v27, v118, v118
 v_sub_f32 v119, v119, v26
 v_fmac_f32 v27, v119, v119
 v_sub_f32 v120, v120, v26
 v_fmac_f32 v27, v120, v120
 v_sub_f32 v121, v121, v26
 v_fmac_f32 v27, v121, v121
 v_sub_f32 v122, v122, v26
 v_fmac_f32 v27, v122, v122
 v_sub_f32 v123, v123, v26
 v_fmac_f32 v27, v123, v123
 v_sub_f32 v124, v124, v26
 v_fmac_f32 v27, v124, v124
 v_sub_f32 v125, v125, v26
 v_fmac_f32 v27, v125, v125
 v_sub_f32 v126, v126, v26
 v_fmac_f32 v27, v126, v126
 v_sub_f32 v127, v127, v26
 v_fmac_f32 v27, v127, v127
 v_sub_f32 v128, v128, v26
 v_fmac_f32 v27, v128, v128
 v_sub_f32 v129, v129, v26
 v_fmac_f32 v27, v129, v129
 v_sub_f32 v130, v130, v26
 v_fmac_f32 v27, v130, v130
 v_sub_f32 v131, v131, v26
 v_fmac_f32 v27, v131, v131
 v_mov_b32 v28, v27
 s_nop 1
 v_permlane16_swap_b32 v27, v28
 v_add_f32 v27, v27, v28
 v_mov_b32 v28, v27
 s_nop 1
 v_permlane32_swap_b32 v27, v28
 v_add_f32 v27, v27, v28
 buffer_store_dwordx2 v[26:27], v15, s[4:7], s36 offen sc1
K3_DONE:
 s_lshl_b32 s24, s80, 3
 s_add_u32 s24, s24, s81
 s_lshl_b32 s24, s24, 2
 s_add_u32 s24, s24, s41
 s_add_u32 s38, s77, 62464
 s_add_u32 m0, s78, 62464
 s_nop 0
 buffer_load_dwordx4 v1, s[4:7], s38 offen sc1 lds
 s_add_u32 s38, s77, 66560
 s_add_u32 m0, s78, 66560
 s_nop 0
 buffer_load_dwordx4 v1, s[4:7], s38 offen sc1 lds
 s_add_u32 s38, s77, 70656
 s_add_u32 m0, s78, 70656
 s_nop 0
 buffer_load_dwordx4 v1, s[4:7], s38 offen sc1 lds
 s_add_u32 s38, s76, 74752
 s_mov_b32 m0, 74752
 s_nop 0
 buffer_load_dwordx4 v1, s[4:7], s38 offen sc1 lds
 s_waitcnt vmcnt(4)
 s_barrier
 s_cmp_lg_u32 s3, 0
 s_cbranch_scc1 SIG2
 s_mov_b64 exec, 1
 v_mov_b32 v30, 0
 v_mov_b32 v31, 1
 s_lshl_b32 s38, s24, 5
 s_add_u32 s38, s38, 9961472
 buffer_store_dword v31, v30, s[4:7], s38 offen sc1
 s_mov_b64 exec, -1
SIG2:
 s_add_u32 s38, s77, 75776
 s_add_u32 m0, s78, 75776
 s_nop 0
 buffer_load_dwordx4 v1, s[4:7], s38 offen sc1 lds
 s_add_u32 s38, s77, 79872
 s_add_u32 m0, s78, 79872
 s_nop 0
 buffer_load_dwordx4 v1, s[4:7], s38 offen sc1 lds
 s_add_u32 s38, s77, 83968
 s_add_u32 m0, s78, 83968
 s_nop 0
 buffer_load_dwordx4 v1, s[4:7], s38 offen sc1 lds
 s_add_u32 s38, s77, 88064
 s_add_u32 m0, s78, 88064
 s_nop 0
 buffer_load_dwordx4 v1, s[4:7], s38 offen sc1 lds
 s_add_u32 s38, s77, 92160
 s_add_u32 m0, s78, 92160
 s_nop 0
 buffer_load_dwordx4 v1, s[4:7], s38 offen sc1 lds
 s_add_u32 s38, s77, 96256
 s_add_u32 m0, s78, 96256
 s_nop 0
 buffer_load_dwordx4 v1, s[4:7], s38 offen sc1 lds
 s_add_u32 s38, s77, 100352
 s_add_u32 m0, s78, 100352
 s_nop 0
 buffer_load_dwordx4 v1, s[4:7], s38 offen sc1 lds
 s_add_u32 s38, s77, 104448
 s_add_u32 m0, s78, 104448
 s_nop 0
 buffer_load_dwordx4 v1, s[4:7], s38 offen sc1 lds
 s_add_u32 s38, s77, 108544
 s_add_u32 m0, s78, 108544
 s_nop 0
 buffer_load_dwordx4 v1, s[4:7], s38 offen sc1 lds
 s_add_u32 s38, s76, 112640
 s_mov_b32 m0, 112640
 s_nop 0
 buffer_load_dwordx4 v1, s[4:7], s38 offen sc1 lds
 s_add_u32 s38, s77, 113664
 s_add_u32 m0, s78, 113664
 s_nop 0
 buffer_load_dwordx4 v1, s[4:7], s38 offen sc1 lds
 s_add_u32 s38, s77, 117760
 s_add_u32 m0, s78, 117760
 s_nop 0
 buffer_load_dwordx4 v1, s[4:7], s38 offen sc1 lds
 s_add_u32 s38, s77, 121856
 s_add_u32 m0, s78, 121856
 s_nop 0
 buffer_load_dwordx4 v1, s[4:7], s38 offen sc1 lds
 s_add_u32 s38, s77, 125952
 s_add_u32 m0, s78, 125952
 s_nop 0
 buffer_load_dwordx4 v1, s[4:7], s38 offen sc1 lds
 s_add_u32 s38, s77, 130048
 s_add_u32 m0, s78, 130048
 s_nop 0
 buffer_load_dwordx4 v1, s[4:7], s38 offen sc1 lds
 s_add_u32 s38, s77, 134144
 s_add_u32 m0, s78, 134144
 s_nop 0
 buffer_load_dwordx4 v1, s[4:7], s38 offen sc1 lds
 s_add_u32 s38, s77, 138240
 s_add_u32 m0, s78, 138240
 s_nop 0
 buffer_load_dwordx4 v1, s[4:7], s38 offen sc1 lds
 s_add_u32 s38, s77, 142336
 s_add_u32 m0, s78, 142336
 s_nop 0
 buffer_load_dwordx4 v1, s[4:7], s38 offen sc1 lds
 s_add_u32 s38, s77, 146432
 s_add_u32 m0, s78, 146432
 s_nop 0
 buffer_load_dwordx4 v1, s[4:7], s38 offen sc1 lds
 s_add_u32 s38, s76, 150528
 s_mov_b32 m0, 150528
 s_nop 0
 buffer_load_dwordx4 v1, s[4:7], s38 offen sc1 lds
 v_mov_b32 v2, v1
 v_add_u32 v3, 0x10000, v1
 v_add_u32 v4, 0x20000, v1
 s_lshl_b32 s26, s85, 3
 s_lshl_b32 s27, s3, 1
 s_add_u32 s26, s26, s27
 s_mul_i32 s23, s26, 36864
 s_add_u32 s23, s23, s42
 s_add_u32 s23, s23, 2359296
 s_lshl_b32 s29, s26, 11
 s_add_u32 s29, s29, s43
 s_add_u32 s29, s29, 131072
 v_bfe_u32 v5, v0, 4, 1
 v_mul_u32_u24 v5, 147456, v5
 v_and_b32 v10, 15, v0
 v_lshlrev_b32 v10, 4, v10
 v_add_u32 v5, v5, v10
 v_bfe_u32 v10, v0, 5, 1
 v_lshlrev_b32 v10, 8, v10
 v_add_u32 v5, v5, v10
 s_mul_i32 s31, s26, 294912
 s_mul_i32 s32, s84, 4608
 s_add_u32 s31, s31, s32
 s_add_u32 s31, s31, 28065792
 s_lshl_b32 s24, s26, 4
 s_add_u32 s24, s24, s41
 s_mul_i32 s79, s82, 147456
 s_add_u32 s79, s79, 70066176
 s_add_u32 s79, s79, s78
 s_and_b32 s82, s2, 3
 s_bfe_u32 s80, s2, 0x10002
 s_lshl_b32 s80, s80, 3
 s_bfe_u32 s81, s2, 0x30003
 s_add_u32 s80, s80, s81
 s_lshr_b32 s81, s2, 6
 s_mul_i32 s79, s81, 1327104
 s_mul_i32 s83, s82, 36864
 s_add_u32 s79, s79, s83
 s_mul_i32 s83, s3, 9216
 s_add_u32 s79, s79, s83
 s_add_u32 s79, s79, 70066176
 s_add_u32 s83, s79, 589824
 s_sub_u32 s19, s79, 737280
 s_bitcmp1_b32 s82, 0
 s_cselect_b32 s19, s79, s19
 s_cselect_b32 s79, s79, s83
 s_mul_i32 s83, s3, 7168
 s_lshl_b32 s14, s3, 11
 s_lshr_b32 s15, s80, 1
 s_lshl_b32 s15, s15, 2
 s_add_u32 s15, s15, s82
 s_lshl_b32 s15, s15, 5
 s_add_u32 s15, s15, s41
 s_add_u32 s15, s15, 3072
 s_lshl_b32 s15, s15, 5
 s_add_u32 s15, s15, 9961472
 s_lshl_b32 s13, s85, 5
 s_add_u32 s13, s13, s84
 s_lshl_b32 s13, s13, 2
 s_add_u32 s13, s13, s41
 s_add_u32 s13, s13, 3072
 s_lshl_b32 s34, s80, 2
 s_add_u32 s34, s34, s3
 s_mul_i32 s20, s34, 294912
 s_mul_i32 s21, s82, 36864
 s_add_u32 s20, s20, s21
 s_add_u32 s20, s20, 28065792
 s_add_u32 s12, s20, 147456
 s_bitcmp1_b32 s82, 1
 s_cselect_b32 s21, s12, s20
 s_cselect_b32 s12, s20, s12
 s_mov_b32 s20, s21
 s_waitcnt vmcnt(0)
 s_barrier
 ds_read_b128 v[56:59], v2 offset:0
 ds_read_b128 v[60:63], v2 offset:37888
 ds_read_b128 v[64:67], v3 offset:10240
 ds_read_b128 v[68:71], v2 offset:1024
 ds_read_b128 v[72:75], v2 offset:38912
 ds_read_b128 v[76:79], v3 offset:11264
 v_and_b32 v30, 7, v0
 v_lshlrev_b32 v30, 7, v30
 s_lshl_b32 s38, s24, 5
 s_add_u32 s38, s38, 9961472
 s_mov_b32 s39, 0x20000
 s_mov_b64 exec, 0xff
POLL1:
 buffer_load_dword v31, v30, s[4:7], s38 offen sc1
 s_waitcnt vmcnt(0)
 v_cmp_ne_u32 vcc, 1, v31
 s_nop 1
 s_and_b64 exec, exec, vcc
 s_cbranch_scc0 POLL1_X
 s_sleep 1
 s_sub_u32 s39, s39, 1
 s_cmp_lg_u32 s39, 0
 s_cbranch_scc1 POLL1
POLL1_X:
 s_mov_b64 exec, -1
POLL1_D:
 s_add_u32 s30, s23, 0
 buffer_load_dwordx4 a[0:3], v1, s[4:7], s30 offen offset:0 sc1
 s_add_u32 s30, s23, 36864
 buffer_load_dwordx4 a[144:147], v1, s[4:7], s30 offen offset:0 sc1
 s_add_u32 s30, s23, 0
 buffer_load_dwordx4 a[4:7], v1, s[4:7], s30 offen offset:1024 sc1
 s_add_u32 s30, s23, 36864
 buffer_load_dwordx4 a[148:151], v1, s[4:7], s30 offen offset:1024 sc1
 s_add_u32 s30, s23, 0
 buffer_load_dwordx4 a[8:11], v1, s[4:7], s30 offen offset:2048 sc1
 s_add_u32 s30, s23, 36864
 buffer_load_dwordx4 a[152:155], v1, s[4:7], s30 offen offset:2048 sc1
 s_add_u32 s30, s23, 0
 buffer_load_dwordx4 a[12:15], v1, s[4:7], s30 offen offset:3072 sc1
 s_add_u32 s30, s23, 36864
 buffer_load_dwordx4 a[156:159], v1, s[4:7], s30 offen offset:3072 sc1
 s_add_u32 s30, s23, 4096
 buffer_load_dwordx4 a[16:19], v1, s[4:7], s30 offen offset:0 sc1
 s_add_u32 s30, s23, 40960
 buffer_load_dwordx4 a[160:163], v1, s[4:7], s30 offen offset:0 sc1
 s_add_u32 s30, s23, 4096
 buffer_load_dwordx4 a[20:23], v1, s[4:7], s30 offen offset:1024 sc1
 s_add_u32 s30, s23, 40960
 buffer_load_dwordx4 a[164:167], v1, s[4:7], s30 offen offset:1024 sc1
 ds_read_b128 v[80:83], v2 offset:2048
 s_waitcnt vmcnt(10) lgkmcnt(6)
 v_mfma_f32_32x32x16_bf16 v[88:103], v[56:59], a[0:3], 0
 s_add_u32 s30, s23, 4096
 buffer_load_dwordx4 a[24:27], v1, s[4:7], s30 offen offset:2048 sc1
 v_mfma_f32_32x32x16_bf16 v[104:119], v[56:59], a[144:147], 0
 ds_read_b128 v[84:87], v2 offset:39936
 s_waitcnt lgkmcnt(6)
 v_mfma_f32_32x32x16_bf16 v[120:135], v[60:63], a[0:3], 0
 s_add_u32 s30, s23, 40960
 buffer_load_dwordx4 a[168:171], v1, s[4:7], s30 offen offset:2048 sc1
 v_mfma_f32_32x32x16_bf16 v[136:151], v[60:63], a[144:147], 0
 ds_read_b128 v[56:59], v3 offset:12288
 s_waitcnt lgkmcnt(6)
 v_mfma_f32_32x32x16_bf16 v[152:167], v[64:67], a[0:3], 0
 v_and_b32 v10, 15, v0
 v_lshlrev_b32 v10, 3, v10
 v_bfe_u32 v11, v0, 4, 1
 v_lshlrev_b32 v11, 10, v11
 v_add_u32 v10, v10, v11
 buffer_load_dwordx2 v[216:217], v10, s[4:7], s29 offen offset:0 sc1
 buffer_load_dwordx2 v[218:219], v10, s[4:7], s29 offen offset:128 sc1
 v_mfma_f32_32x32x16_bf16 v[168:183], v[64:67], a[144:147], 0
 ds_read_b128 v[60:63], v2 offset:3072
 s_waitcnt vmcnt(12) lgkmcnt(6)
 v_mfma_f32_32x32x16_bf16 v[88:103], v[68:71], a[4:7], v[88:103]
 s_add_u32 s30, s23, 4096
 buffer_load_dwordx4 a[28:31], v1, s[4:7], s30 offen offset:3072 sc1
 v_mfma_f32_32x32x16_bf16 v[104:119], v[68:71], a[148:151], v[104:119]
 ds_read_b128 v[64:67], v2 offset:40960
 s_waitcnt lgkmcnt(6)
 v_mfma_f32_32x32x16_bf16 v[120:135], v[72:75], a[4:7], v[120:135]
 s_add_u32 s30, s23, 40960
 buffer_load_dwordx4 a[172:175], v1, s[4:7], s30 offen offset:3072 sc1
 v_mfma_f32_32x32x16_bf16 v[136:151], v[72:75], a[148:151], v[136:151]
 ds_read_b128 v[68:71], v3 offset:13312
 s_waitcnt lgkmcnt(6)
 v_mfma_f32_32x32x16_bf16 v[152:167], v[76:79], a[4:7], v[152:167]
 buffer_load_dwordx2 v[220:221], v10, s[4:7], s29 offen offset:256 sc1
 buffer_load_dwordx2 v[222:223], v10, s[4:7], s29 offen offset:384 sc1
 v_mfma_f32_32x32x16_bf16 v[168:183], v[76:79], a[148:151], v[168:183]
 ds_read_b128 v[72:75], v2 offset:4096
 s_waitcnt vmcnt(14) lgkmcnt(6)
 v_mfma_f32_32x32x16_bf16 v[88:103], v[80:83], a[8:11], v[88:103]
 v_mfma_f32_32x32x16_bf16 v[104:119], v[80:83], a[152:155], v[104:119]
 ds_read_b128 v[76:79], v2 offset:41984
 s_waitcnt lgkmcnt(6)
 v_mfma_f32_32x32x16_bf16 v[120:135], v[84:87], a[8:11], v[120:135]
 s_add_u32 s30, s23, 8192
 buffer_load_dwordx4 a[32:35], v1, s[4:7], s30 offen offset:0 sc1
 v_mfma_f32_32x32x16_bf16 v[136:151], v[84:87], a[152:155], v[136:151]
 ds_read_b128 v[80:83], v3 offset:14336
 s_waitcnt lgkmcnt(6)
 v_mfma_f32_32x32x16_bf16 v[152:167], v[56:59], a[8:11], v[152:167]
 s_add_u32 s30, s23, 45056
 buffer_load_dwordx4 a[176:179], v1, s[4:7], s30 offen offset:0 sc1
 v_mfma_f32_32x32x16_bf16 v[168:183], v[56:59], a[152:155], v[168:183]
 ds_read_b128 v[84:87], v2 offset:5120
 s_waitcnt vmcnt(14) lgkmcnt(6)
 v_mfma_f32_32x32x16_bf16 v[88:103], v[60:63], a[12:15], v[88:103]
 buffer_load_dwordx2 v[224:225], v10, s[4:7], s29 offen offset:512 sc1
 buffer_load_dwordx2 v[226:227], v10, s[4:7], s29 offen offset:640 sc1
 v_mfma_f32_32x32x16_bf16 v[104:119], v[60:63], a[156:159], v[104:119]
 ds_read_b128 v[56:59], v2 offset:43008
 s_waitcnt lgkmcnt(6)
 v_mfma_f32_32x32x16_bf16 v[120:135], v[64:67], a[12:15], v[120:135]
 s_add_u32 s30, s23, 8192
 buffer_load_dwordx4 a[36:39], v1, s[4:7], s30 offen offset:1024 sc1
 v_mfma_f32_32x32x16_bf16 v[136:151], v[64:67], a[156:159], v[136:151]
 ds_read_b128 v[60:63], v3 offset:15360
 s_waitcnt lgkmcnt(6)
 v_mfma_f32_32x32x16_bf16 v[152:167], v[68:71], a[12:15], v[152:167]
 s_add_u32 s30, s23, 45056
 buffer_load_dwordx4 a[180:183], v1, s[4:7], s30 offen offset:1024 sc1
 v_mfma_f32_32x32x16_bf16 v[168:183], v[68:71], a[156:159], v[168:183]
 ds_read_b128 v[64:67], v2 offset:6144
 s_waitcnt vmcnt(16) lgkmcnt(6)
 v_mfma_f32_32x32x16_bf16 v[88:103], v[72:75], a[16:19], v[88:103]
 buffer_load_dwordx2 v[228:229], v10, s[4:7], s29 offen offset:768 sc1
 buffer_load_dwordx2 v[230:231], v10, s[4:7], s29 offen offset:896 sc1
 v_mfma_f32_32x32x16_bf16 v[104:119], v[72:75], a[160:163], v[104:119]
 ds_read_b128 v[68:71], v2 offset:44032
 s_waitcnt lgkmcnt(6)
 v_mfma_f32_32x32x16_bf16 v[120:135], v[76:79], a[16:19], v[120:135]
 s_add_u32 s30, s23, 8192
 buffer_load_dwordx4 a[40:43], v1, s[4:7], s30 offen offset:2048 sc1
 v_mfma_f32_32x32x16_bf16 v[136:151], v[76:79], a[160:163], v[136:151]
 ds_read_b128 v[72:75], v3 offset:16384
 s_waitcnt lgkmcnt(6)
 v_mfma_f32_32x32x16_bf16 v[152:167], v[80:83], a[16:19], v[152:167]
 s_add_u32 s30, s23, 45056
 buffer_load_dwordx4 a[184:187], v1, s[4:7], s30 offen offset:2048 sc1
 v_mfma_f32_32x32x16_bf16 v[168:183], v[80:83], a[160:163], v[168:183]
 ds_read_b128 v[76:79], v2 offset:7168
 s_waitcnt vmcnt(18) lgkmcnt(6)
 v_mfma_f32_32x32x16_bf16 v[88:103], v[84:87], a[20:23], v[88:103]
 buffer_load_dwordx2 v[232:233], v10, s[4:7], s29 offen offset:2048 sc1
 buffer_load_dwordx2 v[234:235], v10, s[4:7], s29 offen offset:2176 sc1
 v_mfma_f32_32x32x16_bf16 v[104:119], v[84:87], a[164:167], v[104:119]
 ds_read_b128 v[80:83], v2 offset:45056
 s_waitcnt lgkmcnt(6)
 v_mfma_f32_32x32x16_bf16 v[120:135], v[56:59], a[20:23], v[120:135]
 s_add_u32 s30, s23, 8192
 buffer_load_dwordx4 a[44:47], v1, s[4:7], s30 offen offset:3072 sc1
 v_mfma_f32_32x32x16_bf16 v[136:151], v[56:59], a[164:167], v[136:151]
 ds_read_b128 v[84:87], v3 offset:17408
 s_waitcnt lgkmcnt(6)
 v_mfma_f32_32x32x16_bf16 v[152:167], v[60:63], a[20:23], v[152:167]
 v_mfma_f32_32x32x16_bf16 v[168:183], v[60:63], a[164:167], v[168:183]
 ds_read_b128 v[56:59], v2 offset:8192
 s_waitcnt vmcnt(19) lgkmcnt(6)
 v_mfma_f32_32x32x16_bf16 v[88:103], v[64:67], a[24:27], v[88:103]
 s_add_u32 s30, s23, 45056
 buffer_load_dwordx4 a[188:191], v1, s[4:7], s30 offen offset:3072 sc1
 v_mfma_f32_32x32x16_bf16 v[104:119], v[64:67], a[168:171], v[104:119]
 ds_read_b128 v[60:63], v2 offset:46080
 s_waitcnt lgkmcnt(6)
 v_mfma_f32_32x32x16_bf16 v[120:135], v[68:71], a[24:27], v[120:135]
 buffer_load_dwordx2 v[236:237], v10, s[4:7], s29 offen offset:2304 sc1
 buffer_load_dwordx2 v[238:239], v10, s[4:7], s29 offen offset:2432 sc1
 v_mfma_f32_32x32x16_bf16 v[136:151], v[68:71], a[168:171], v[136:151]
 ds_read_b128 v[64:67], v3 offset:18432
 s_waitcnt lgkmcnt(6)
 v_mfma_f32_32x32x16_bf16 v[152:167], v[72:75], a[24:27], v[152:167]
 s_add_u32 s30, s23, 12288
 buffer_load_dwordx4 a[48:51], v1, s[4:7], s30 offen offset:0 sc1
 v_mfma_f32_32x32x16_bf16 v[168:183], v[72:75], a[168:171], v[168:183]
 ds_read_b128 v[68:71], v2 offset:9216
 s_waitcnt vmcnt(19) lgkmcnt(6)
 v_mfma_f32_32x32x16_bf16 v[88:103], v[76:79], a[28:31], v[88:103]
 s_add_u32 s30, s23, 49152
 buffer_load_dwordx4 a[192:195], v1, s[4:7], s30 offen offset:0 sc1
 v_mfma_f32_32x32x16_bf16 v[104:119], v[76:79], a[172:175], v[104:119]
 ds_read_b128 v[72:75], v2 offset:47104
 s_waitcnt lgkmcnt(6)
 v_mfma_f32_32x32x16_bf16 v[120:135], v[80:83], a[28:31], v[120:135]
 buffer_load_dwordx2 v[240:241], v10, s[4:7], s29 offen offset:2560 sc1
 buffer_load_dwordx2 v[242:243], v10, s[4:7], s29 offen offset:2688 sc1
 v_mfma_f32_32x32x16_bf16 v[136:151], v[80:83], a[172:175], v[136:151]
 ds_read_b128 v[76:79], v3 offset:19456
 s_waitcnt lgkmcnt(6)
 v_mfma_f32_32x32x16_bf16 v[152:167], v[84:87], a[28:31], v[152:167]
 s_add_u32 s30, s23, 12288
 buffer_load_dwordx4 a[52:55], v1, s[4:7], s30 offen offset:1024 sc1
 v_mfma_f32_32x32x16_bf16 v[168:183], v[84:87], a[172:175], v[168:183]
 ds_read_b128 v[80:83], v2 offset:10240
 s_waitcnt vmcnt(19) lgkmcnt(6)
 v_mfma_f32_32x32x16_bf16 v[88:103], v[56:59], a[32:35], v[88:103]
 s_add_u32 s30, s23, 49152
 buffer_load_dwordx4 a[196:199], v1, s[4:7], s30 offen offset:1024 sc1
 v_mfma_f32_32x32x16_bf16 v[104:119], v[56:59], a[176:179], v[104:119]
 ds_read_b128 v[84:87], v2 offset:48128
 s_waitcnt lgkmcnt(6)
 v_mfma_f32_32x32x16_bf16 v[120:135], v[60:63], a[32:35], v[120:135]
 buffer_load_dwordx2 v[244:245], v10, s[4:7], s29 offen offset:2816 sc1
 buffer_load_dwordx2 v[246:247], v10, s[4:7], s29 offen offset:2944 sc1
 v_mfma_f32_32x32x16_bf16 v[136:151], v[60:63], a[176:179], v[136:151]
 ds_read_b128 v[56:59], v3 offset:20480
 s_waitcnt lgkmcnt(6)
 v_mfma_f32_32x32x16_bf16 v[152:167], v[64:67], a[32:35], v[152:167]
 s_add_u32 s30, s23, 12288
 buffer_load_dwordx4 a[56:59], v1, s[4:7], s30 offen offset:2048 sc1
 v_mfma_f32_32x32x16_bf16 v[168:183], v[64:67], a[176:179], v[168:183]
 ds_read_b128 v[60:63], v2 offset:11264
 s_waitcnt vmcnt(19) lgkmcnt(6)
 v_mfma_f32_32x32x16_bf16 v[88:103], v[68:71], a[36:39], v[88:103]
 s_add_u32 s30, s23, 49152
 buffer_load_dwordx4 a[200:203], v1, s[4:7], s30 offen offset:2048 sc1
 v_mfma_f32_32x32x16_bf16 v[104:119], v[68:71], a[180:183], v[104:119]
 ds_read_b128 v[64:67], v2 offset:49152
 s_waitcnt lgkmcnt(6)
 v_mfma_f32_32x32x16_bf16 v[120:135], v[72:75], a[36:39], v[120:135]
 v_mfma_f32_32x32x16_bf16 v[136:151], v[72:75], a[180:183], v[136:151]
 ds_read_b128 v[68:71], v3 offset:21504
 s_waitcnt lgkmcnt(6)
 v_mfma_f32_32x32x16_bf16 v[152:167], v[76:79], a[36:39], v[152:167]
 s_add_u32 s30, s23, 12288
 buffer_load_dwordx4 a[60:63], v1, s[4:7], s30 offen offset:3072 sc1
 v_mfma_f32_32x32x16_bf16 v[168:183], v[76:79], a[180:183], v[168:183]
 ds_read_b128 v[72:75], v2 offset:12288
 s_waitcnt vmcnt(17) lgkmcnt(6)
 v_mfma_f32_32x32x16_bf16 v[88:103], v[80:83], a[40:43], v[88:103]
 s_add_u32 s30, s23, 49152
 buffer_load_dwordx4 a[204:207], v1, s[4:7], s30 offen offset:3072 sc1
 v_mfma_f32_32x32x16_bf16 v[104:119], v[80:83], a[184:187], v[104:119]
 ds_read_b128 v[76:79], v2 offset:50176
 s_waitcnt lgkmcnt(6)
 v_mfma_f32_32x32x16_bf16 v[120:135], v[84:87], a[40:43], v[120:135]
 s_add_u32 s30, s23, 16384
 buffer_load_dwordx4 a[64:67], v1, s[4:7], s30 offen offset:0 sc1
 v_mfma_f32_32x32x16_bf16 v[136:151], v[84:87], a[184:187], v[136:151]
 ds_read_b128 v[80:83], v3 offset:22528
 s_waitcnt lgkmcnt(6)
 v_mfma_f32_32x32x16_bf16 v[152:167], v[56:59], a[40:43], v[152:167]
 s_add_u32 s30, s23, 53248
 buffer_load_dwordx4 a[208:211], v1, s[4:7], s30 offen offset:0 sc1
 v_mfma_f32_32x32x16_bf16 v[168:183], v[56:59], a[184:187], v[168:183]
 ds_read_b128 v[84:87], v2 offset:13312
 s_waitcnt vmcnt(16) lgkmcnt(6)
 v_mfma_f32_32x32x16_bf16 v[88:103], v[60:63], a[44:47], v[88:103]
 s_add_u32 s30, s23, 16384
 buffer_load_dwordx4 a[68:71], v1, s[4:7], s30 offen offset:1024 sc1
 v_mfma_f32_32x32x16_bf16 v[104:119], v[60:63], a[188:191], v[104:119]
 ds_read_b128 v[56:59], v2 offset:51200
 s_waitcnt lgkmcnt(6)
 v_mfma_f32_32x32x16_bf16 v[120:135], v[64:67], a[44:47], v[120:135]
 s_add_u32 s30, s23, 53248
 buffer_load_dwordx4 a[212:215], v1, s[4:7], s30 offen offset:1024 sc1
 v_mfma_f32_32x32x16_bf16 v[136:151], v[64:67], a[188:191], v[136:151]
 ds_read_b128 v[60:63], v3 offset:23552
 s_waitcnt lgkmcnt(6)
 v_mfma_f32_32x32x16_bf16 v[152:167], v[68:71], a[44:47], v[152:167]
 s_add_u32 s30, s23, 16384
 buffer_load_dwordx4 a[72:75], v1, s[4:7], s30 offen offset:2048 sc1
 v_mfma_f32_32x32x16_bf16 v[168:183], v[68:71], a[188:191], v[168:183]
 ds_read_b128 v[64:67], v2 offset:14336
 s_waitcnt vmcnt(15) lgkmcnt(6)
 v_mfma_f32_32x32x16_bf16 v[88:103], v[72:75], a[48:51], v[88:103]
 s_add_u32 s30, s23, 53248
 buffer_load_dwordx4 a[216:219], v1, s[4:7], s30 offen offset:2048 sc1
 v_mfma_f32_32x32x16_bf16 v[104:119], v[72:75], a[192:195], v[104:119]
 ds_read_b128 v[68:71], v2 offset:52224
 s_waitcnt lgkmcnt(6)
 v_mfma_f32_32x32x16_bf16 v[120:135], v[76:79], a[48:51], v[120:135]
 s_add_u32 s30, s23, 16384
 buffer_load_dwordx4 a[76:79], v1, s[4:7], s30 offen offset:3072 sc1
 v_mfma_f32_32x32x16_bf16 v[136:151], v[76:79], a[192:195], v[136:151]
 ds_read_b128 v[72:75], v3 offset:24576
 s_waitcnt lgkmcnt(6)
 v_mfma_f32_32x32x16_bf16 v[152:167], v[80:83], a[48:51], v[152:167]
 s_add_u32 s30, s23, 53248
 buffer_load_dwordx4 a[220:223], v1, s[4:7], s30 offen offset:3072 sc1
 v_mfma_f32_32x32x16_bf16 v[168:183], v[80:83], a[192:195], v[168:183]
 ds_read_b128 v[76:79], v2 offset:15360
 s_waitcnt vmcnt(14) lgkmcnt(6)
 v_mfma_f32_32x32x16_bf16 v[88:103], v[84:87], a[52:55], v[88:103]
 v_mfma_f32_32x32x16_bf16 v[104:119], v[84:87], a[196:199], v[104:119]
 ds_read_b128 v[80:83], v2 offset:53248
 s_waitcnt lgkmcnt(6)
 v_mfma_f32_32x32x16_bf16 v[120:135], v[56:59], a[52:55], v[120:135]
 s_add_u32 s30, s23, 20480
 buffer_load_dwordx4 a[80:83], v1, s[4:7], s30 offen offset:0 sc1
 v_mfma_f32_32x32x16_bf16 v[136:151], v[56:59], a[196:199], v[136:151]
 ds_read_b128 v[84:87], v3 offset:25600
 s_waitcnt lgkmcnt(6)
 v_mfma_f32_32x32x16_bf16 v[152:167], v[60:63], a[52:55], v[152:167]
 s_add_u32 s30, s23, 57344
 buffer_load_dwordx4 a[224:227], v1, s[4:7], s30 offen offset:0 sc1
 v_mfma_f32_32x32x16_bf16 v[168:183], v[60:63], a[196:199], v[168:183]
 ds_read_b128 v[56:59], v2 offset:16384
 s_waitcnt vmcnt(12) lgkmcnt(6)
 v_mfma_f32_32x32x16_bf16 v[88:103], v[64:67], a[56:59], v[88:103]
 s_add_u32 s30, s23, 20480
 buffer_load_dwordx4 a[84:87], v1, s[4:7], s30 offen offset:1024 sc1
 v_cmp_gt_u32 vcc, 512, v1
 v_add_f32 v10, v216, v220
 v_mfma_f32_32x32x16_bf16 v[104:119], v[64:67], a[200:203], v[104:119]
 v_add_f32 v11, v218, v222
 v_add_f32 v10, v10, v224
 ds_read_b128 v[60:63], v2 offset:54272
 s_waitcnt lgkmcnt(6)
 v_mfma_f32_32x32x16_bf16 v[120:135], v[68:71], a[56:59], v[120:135]
 s_add_u32 s30, s23, 57344
 buffer_load_dwordx4 a[228:231], v1, s[4:7], s30 offen offset:1024 sc1
 v_add_f32 v11, v11, v226
 v_add_f32 v10, v10, v228
 v_mfma_f32_32x32x16_bf16 v[136:151], v[68:71], a[200:203], v[136:151]
 v_add_f32 v11, v11, v230
 v_mul_f32 v10, 0x3de38e39, v10
 ds_read_b128 v[64:67], v3 offset:26624
 s_waitcnt lgkmcnt(6)
 v_mfma_f32_32x32x16_bf16 v[152:167], v[72:75], a[56:59], v[152:167]
 s_add_u32 s30, s23, 20480
 buffer_load_dwordx4 a[88:91], v1, s[4:7], s30 offen offset:2048 sc1
 v_mul_f32 v11, 0x3e0e38e4, v11
 v_add_f32 v12, v10, v11
 v_mfma_f32_32x32x16_bf16 v[168:183], v[72:75], a[200:203], v[168:183]
 v_mov_b32 v10, 0
 v_mov_b32 v11, 0
 ds_read_b128 v[68:71], v2 offset:17408
 s_waitcnt vmcnt(13) lgkmcnt(6)
 v_mfma_f32_32x32x16_bf16 v[88:103], v[76:79], a[60:63], v[88:103]
 s_add_u32 s30, s23, 57344
 buffer_load_dwordx4 a[232:235], v1, s[4:7], s30 offen offset:2048 sc1
 v_sub_f32 v216, v216, v12
 v_fmac_f32 v10, v216, v216
 v_mfma_f32_32x32x16_bf16 v[104:119], v[76:79], a[204:207], v[104:119]
 v_sub_f32 v218, v218, v12
 v_fmac_f32 v11, v218, v218
 ds_read_b128 v[72:75], v2 offset:55296
 s_waitcnt lgkmcnt(6)
 v_mfma_f32_32x32x16_bf16 v[120:135], v[80:83], a[60:63], v[120:135]
 s_add_u32 s30, s23, 20480
 buffer_load_dwordx4 a[92:95], v1, s[4:7], s30 offen offset:3072 sc1
 v_sub_f32 v220, v220, v12
 v_fmac_f32 v10, v220, v220
 v_mfma_f32_32x32x16_bf16 v[136:151], v[80:83], a[204:207], v[136:151]
 v_sub_f32 v222, v222, v12
 v_fmac_f32 v11, v222, v222
 ds_read_b128 v[76:79], v3 offset:27648
 s_waitcnt lgkmcnt(6)
 v_mfma_f32_32x32x16_bf16 v[152:167], v[84:87], a[60:63], v[152:167]
 s_add_u32 s30, s23, 57344
 buffer_load_dwordx4 a[236:239], v1, s[4:7], s30 offen offset:3072 sc1
 v_sub_f32 v224, v224, v12
 v_fmac_f32 v10, v224, v224
 v_mfma_f32_32x32x16_bf16 v[168:183], v[84:87], a[204:207], v[168:183]
 v_sub_f32 v226, v226, v12
 v_fmac_f32 v11, v226, v226
 ds_read_b128 v[80:83], v2 offset:18432
 s_waitcnt vmcnt(14) lgkmcnt(6)
 v_mfma_f32_32x32x16_bf16 v[88:103], v[56:59], a[64:67], v[88:103]
 s_add_u32 s30, s23, 24576
 buffer_load_dwordx4 a[96:99], v1, s[4:7], s30 offen offset:0 sc1
 v_sub_f32 v228, v228, v12
 v_fmac_f32 v10, v228, v228
 v_mfma_f32_32x32x16_bf16 v[104:119], v[56:59], a[208:211], v[104:119]
 v_sub_f32 v230, v230, v12
 v_fmac_f32 v11, v230, v230
 ds_read_b128 v[84:87], v2 offset:56320
 s_waitcnt lgkmcnt(6)
 v_mfma_f32_32x32x16_bf16 v[120:135], v[60:63], a[64:67], v[120:135]
 s_add_u32 s30, s23, 61440
 buffer_load_dwordx4 a[240:243], v1, s[4:7], s30 offen offset:0 sc1
 v_mul_f32 v10, 0x42800000, v10
 v_mul_f32 v11, 0x42a00000, v11
 v_mfma_f32_32x32x16_bf16 v[136:151], v[60:63], a[208:211], v[136:151]
 v_add_f32 v10, v10, v11
 v_add_f32 v10, v10, v217
 ds_read_b128 v[56:59], v3 offset:28672
 s_waitcnt lgkmcnt(6)
 v_mfma_f32_32x32x16_bf16 v[152:167], v[64:67], a[64:67], v[152:167]
 v_add_f32 v10, v10, v219
 v_add_f32 v10, v10, v221
 v_add_f32 v10, v10, v223
 v_add_f32 v10, v10, v225
 v_add_f32 v10, v10, v227
 v_add_f32 v10, v10, v229
 v_mfma_f32_32x32x16_bf16 v[168:183], v[64:67], a[208:211], v[168:183]
 v_add_f32 v10, v10, v231
 v_mov_b32 v11, 0x3727c5ac
 ds_read_b128 v[60:63], v2 offset:19456
 s_waitcnt vmcnt(14) lgkmcnt(6)
 v_mfma_f32_32x32x16_bf16 v[88:103], v[68:71], a[68:71], v[88:103]
 s_add_u32 s30, s23, 24576
 buffer_load_dwordx4 a[100:103], v1, s[4:7], s30 offen offset:1024 sc1
 v_mov_b32 v8, 0x3ae38e39
 v_fma_f32 v8, v10, v8, v11
 v_mfma_f32_32x32x16_bf16 v[104:119], v[68:71], a[212:215], v[104:119]
 v_cvt_pk_bf16_f32 v13, v12, v12
 v_lshlrev_b32 v13, 16, v13
 ds_read_b128 v[64:67], v2 offset:57344
 s_waitcnt lgkmcnt(6)
 v_mfma_f32_32x32x16_bf16 v[120:135], v[72:75], a[68:71], v[120:135]
 s_add_u32 s30, s23, 61440
 buffer_load_dwordx4 a[244:247], v1, s[4:7], s30 offen offset:1024 sc1
 v_sub_f32 v15, v12, v13
 v_cvt_pk_bf16_f32 v14, v15, v15
 v_mfma_f32_32x32x16_bf16 v[136:151], v[72:75], a[212:215], v[136:151]
 v_lshlrev_b32 v14, 16, v14
 v_sub_f32 v15, v15, v14
 ds_read_b128 v[68:71], v3 offset:29696
 s_waitcnt lgkmcnt(6)
 v_mfma_f32_32x32x16_bf16 v[152:167], v[76:79], a[68:71], v[152:167]
 s_add_u32 s30, s23, 24576
 buffer_load_dwordx4 a[104:107], v1, s[4:7], s30 offen offset:2048 sc1
 v_cvt_pk_bf16_f32 v16, v13, v13
 v_cvt_pk_bf16_f32 v17, v14, v13
 v_mfma_f32_32x32x16_bf16 v[168:183], v[76:79], a[212:215], v[168:183]
 v_cvt_pk_bf16_f32 v18, v14, v15
 v_mov_b32 v19, 0
 ds_read_b128 v[72:75], v2 offset:20480
 s_waitcnt vmcnt(15) lgkmcnt(6)
 v_mfma_f32_32x32x16_bf16 v[88:103], v[80:83], a[72:75], v[88:103]
 s_add_u32 s30, s23, 61440
 buffer_load_dwordx4 a[248:251], v1, s[4:7], s30 offen offset:2048 sc1
 v_cndmask_b32 v16, 0, v16, vcc
 v_cndmask_b32 v17, 0, v17, vcc
 v_mfma_f32_32x32x16_bf16 v[104:119], v[80:83], a[216:219], v[104:119]
 v_cndmask_b32 v18, 0, v18, vcc
 ds_read_b128 v[76:79], v2 offset:58368
 s_waitcnt lgkmcnt(6)
 v_mfma_f32_32x32x16_bf16 v[120:135], v[84:87], a[72:75], v[120:135]
 s_add_u32 s30, s23, 24576
 buffer_load_dwordx4 a[108:111], v1, s[4:7], s30 offen offset:3072 sc1
 v_rsq_f32 v6, v8
 v_mfma_f32_32x32x16_bf16 v[136:151], v[84:87], a[216:219], v[136:151]
 v_mul_f32 v6, 0xbfb8aa3b, v6
 v_add_f32 v10, v232, v236
 ds_read_b128 v[80:83], v3 offset:30720
 s_waitcnt lgkmcnt(6)
 v_mfma_f32_32x32x16_bf16 v[152:167], v[56:59], a[72:75], v[152:167]
 s_add_u32 s30, s23, 61440
 buffer_load_dwordx4 a[252:255], v1, s[4:7], s30 offen offset:3072 sc1
 v_add_f32 v11, v234, v238
 v_add_f32 v10, v10, v240
 v_mfma_f32_32x32x16_bf16 v[168:183], v[56:59], a[216:219], v[168:183]
 v_add_f32 v11, v11, v242
 v_add_f32 v10, v10, v244
 ds_read_b128 v[84:87], v2 offset:21504
 s_waitcnt vmcnt(16) lgkmcnt(6)
 v_mfma_f32_32x32x16_bf16 v[88:103], v[60:63], a[76:79], v[88:103]
 s_add_u32 s30, s23, 28672
 buffer_load_dwordx4 a[112:115], v1, s[4:7], s30 offen offset:0 sc1
 v_add_f32 v11, v11, v246
 v_mul_f32 v10, 0x3de38e39, v10
 v_mfma_f32_32x32x16_bf16 v[104:119], v[60:63], a[220:223], v[104:119]
 v_mul_f32 v11, 0x3e0e38e4, v11
 v_add_f32 v12, v10, v11
 ds_read_b128 v[56:59], v2 offset:59392
 s_waitcnt lgkmcnt(6)
 v_mfma_f32_32x32x16_bf16 v[120:135], v[64:67], a[76:79], v[120:135]
 s_add_u32 s30, s23, 65536
 buffer_load_dwordx4 v[24:27], v1, s[4:7], s30 offen offset:0 sc1
 v_mov_b32 v10, 0
 v_mov_b32 v11, 0
 v_mfma_f32_32x32x16_bf16 v[136:151], v[64:67], a[220:223], v[136:151]
 v_sub_f32 v232, v232, v12
 v_fmac_f32 v10, v232, v232
 ds_read_b128 v[60:63], v3 offset:31744
 s_waitcnt lgkmcnt(6)
 v_mfma_f32_32x32x16_bf16 v[152:167], v[68:71], a[76:79], v[152:167]
 s_add_u32 s30, s23, 28672
 buffer_load_dwordx4 a[116:119], v1, s[4:7], s30 offen offset:1024 sc1
 v_sub_f32 v234, v234, v12
 v_fmac_f32 v11, v234, v234
 v_mfma_f32_32x32x16_bf16 v[168:183], v[68:71], a[220:223], v[168:183]
 v_sub_f32 v236, v236, v12
 v_fmac_f32 v10, v236, v236
 ds_read_b128 v[64:67], v2 offset:22528
 s_waitcnt vmcnt(17) lgkmcnt(6)
 v_mfma_f32_32x32x16_bf16 v[88:103], v[72:75], a[80:83], v[88:103]
 s_add_u32 s30, s23, 65536
 buffer_load_dwordx4 v[28:31], v1, s[4:7], s30 offen offset:1024 sc1
 v_sub_f32 v238, v238, v12
 v_fmac_f32 v11, v238, v238
 v_mfma_f32_32x32x16_bf16 v[104:119], v[72:75], a[224:227], v[104:119]
 v_sub_f32 v240, v240, v12
 v_fmac_f32 v10, v240, v240
 ds_read_b128 v[68:71], v2 offset:60416
 s_waitcnt lgkmcnt(6)
 v_mfma_f32_32x32x16_bf16 v[120:135], v[76:79], a[80:83], v[120:135]
 v_sub_f32 v242, v242, v12
 v_fmac_f32 v11, v242, v242
 v_sub_f32 v244, v244, v12
 v_fmac_f32 v10, v244, v244
 v_sub_f32 v246, v246, v12
 v_fmac_f32 v11, v246, v246
 v_mfma_f32_32x32x16_bf16 v[136:151], v[76:79], a[224:227], v[136:151]
 v_mul_f32 v10, 0x42800000, v10
 v_mul_f32 v11, 0x42a00000, v11
 ds_read_b128 v[72:75], v3 offset:32768
 s_waitcnt lgkmcnt(6)
 v_mfma_f32_32x32x16_bf16 v[152:167], v[80:83], a[80:83], v[152:167]
 s_add_u32 s30, s23, 28672
 buffer_load_dwordx4 a[120:123], v1, s[4:7], s30 offen offset:2048 sc1
 v_add_f32 v10, v10, v11
 v_add_f32 v10, v10, v233
 v_mfma_f32_32x32x16_bf16 v[168:183], v[80:83], a[224:227], v[168:183]
 v_add_f32 v10, v10, v235
 v_add_f32 v10, v10, v237
 ds_read_b128 v[76:79], v2 offset:23552
 s_waitcnt vmcnt(17) lgkmcnt(6)
 v_mfma_f32_32x32x16_bf16 v[88:103], v[84:87], a[84:87], v[88:103]
 s_add_u32 s30, s23, 65536
 buffer_load_dwordx4 v[32:35], v1, s[4:7], s30 offen offset:2048 sc1
 v_add_f32 v10, v10, v239
 v_add_f32 v10, v10, v241
 v_mfma_f32_32x32x16_bf16 v[104:119], v[84:87], a[228:231], v[104:119]
 v_add_f32 v10, v10, v243
 v_add_f32 v10, v10, v245
 ds_read_b128 v[80:83], v2 offset:61440
 s_waitcnt lgkmcnt(6)
 v_mfma_f32_32x32x16_bf16 v[120:135], v[56:59], a[84:87], v[120:135]
 s_add_u32 s30, s23, 28672
 buffer_load_dwordx4 a[124:127], v1, s[4:7], s30 offen offset:3072 sc1
 v_add_f32 v10, v10, v247
 v_mov_b32 v11, 0x3727c5ac
 v_mfma_f32_32x32x16_bf16 v[136:151], v[56:59], a[228:231], v[136:151]
 v_mov_b32 v9, 0x3ae38e39
 v_fma_f32 v9, v10, v9, v11
 ds_read_b128 v[84:87], v3 offset:33792
 s_waitcnt lgkmcnt(6)
 v_mfma_f32_32x32x16_bf16 v[152:167], v[60:63], a[84:87], v[152:167]
 s_add_u32 s30, s23, 65536
 buffer_load_dwordx4 v[36:39], v1, s[4:7], s30 offen offset:3072 sc1
 v_cvt_pk_bf16_f32 v13, v12, v12
 v_lshlrev_b32 v13, 16, v13
 v_mfma_f32_32x32x16_bf16 v[168:183], v[60:63], a[228:231], v[168:183]
 v_sub_f32 v15, v12, v13
 v_cvt_pk_bf16_f32 v14, v15, v15
 ds_read_b128 v[56:59], v2 offset:24576
 s_waitcnt vmcnt(18) lgkmcnt(6)
 v_mfma_f32_32x32x16_bf16 v[88:103], v[64:67], a[88:91], v[88:103]
 s_add_u32 s30, s23, 32768
 buffer_load_dwordx4 a[128:131], v1, s[4:7], s30 offen offset:0 sc1
 v_lshlrev_b32 v14, 16, v14
 v_sub_f32 v15, v15, v14
 v_mfma_f32_32x32x16_bf16 v[104:119], v[64:67], a[232:235], v[104:119]
 v_cvt_pk_bf16_f32 v20, v13, v13
 v_cvt_pk_bf16_f32 v21, v14, v13
 ds_read_b128 v[60:63], v2 offset:62464
 s_waitcnt lgkmcnt(6)
 v_mfma_f32_32x32x16_bf16 v[120:135], v[68:71], a[88:91], v[120:135]
 s_add_u32 s30, s23, 69632
 buffer_load_dwordx4 v[40:43], v1, s[4:7], s30 offen offset:0 sc1
 v_cvt_pk_bf16_f32 v22, v14, v15
 v_mov_b32 v23, 0
 v_mfma_f32_32x32x16_bf16 v[136:151], v[68:71], a[232:235], v[136:151]
 v_cndmask_b32 v20, 0, v20, vcc
 v_cndmask_b32 v21, 0, v21, vcc
 ds_read_b128 v[64:67], v3 offset:34816
 s_waitcnt lgkmcnt(6)
 v_mfma_f32_32x32x16_bf16 v[152:167], v[72:75], a[88:91], v[152:167]
 s_add_u32 s30, s23, 32768
 buffer_load_dwordx4 a[132:135], v1, s[4:7], s30 offen offset:1024 sc1
 v_cndmask_b32 v22, 0, v22, vcc
 v_mfma_f32_32x32x16_bf16 v[168:183], v[72:75], a[232:235], v[168:183]
 v_rsq_f32 v7, v9
 ds_read_b128 v[68:71], v2 offset:25600
 s_waitcnt vmcnt(19) lgkmcnt(6)
 v_mfma_f32_32x32x16_bf16 v[88:103], v[76:79], a[92:95], v[88:103]
 s_add_u32 s30, s23, 69632
 buffer_load_dwordx4 v[44:47], v1, s[4:7], s30 offen offset:1024 sc1
 v_mul_f32 v7, 0xbfb8aa3b, v7
 v_mfma_f32_32x32x16_bf16 v[104:119], v[76:79], a[236:239], v[104:119]
 ds_read_b128 v[72:75], v2 offset:63488
 s_waitcnt lgkmcnt(6)
 v_mfma_f32_32x32x16_bf16 v[120:135], v[80:83], a[92:95], v[120:135]
 s_add_u32 s30, s23, 32768
 buffer_load_dwordx4 a[136:139], v1, s[4:7], s30 offen offset:2048 sc1
 v_mfma_f32_32x32x16_bf16 v[136:151], v[80:83], a[236:239], v[136:151]
 ds_read_b128 v[76:79], v3 offset:35840
 s_waitcnt lgkmcnt(6)
 v_mfma_f32_32x32x16_bf16 v[152:167], v[84:87], a[92:95], v[152:167]
 s_add_u32 s30, s23, 69632
 buffer_load_dwordx4 v[48:51], v1, s[4:7], s30 offen offset:2048 sc1
 v_mfma_f32_32x32x16_bf16 v[168:183], v[84:87], a[236:239], v[168:183]
 ds_read_b128 v[80:83], v2 offset:26624
 s_waitcnt vmcnt(20) lgkmcnt(6)
 v_mfma_f32_32x32x16_bf16 v[88:103], v[56:59], a[96:99], v[88:103]
 v_mfma_f32_32x32x16_bf16 v[104:119], v[56:59], a[240:243], v[104:119]
 ds_read_b128 v[84:87], v2 offset:64512
 s_waitcnt lgkmcnt(6)
 v_mfma_f32_32x32x16_bf16 v[120:135], v[60:63], a[96:99], v[120:135]
 s_add_u32 s30, s23, 32768
 buffer_load_dwordx4 a[140:143], v1, s[4:7], s30 offen offset:3072 sc1
 v_mfma_f32_32x32x16_bf16 v[136:151], v[60:63], a[240:243], v[136:151]
 ds_read_b128 v[56:59], v3 offset:36864
 s_waitcnt lgkmcnt(6)
 v_mfma_f32_32x32x16_bf16 v[152:167], v[64:67], a[96:99], v[152:167]
 s_add_u32 s30, s23, 69632
 buffer_load_dwordx4 v[52:55], v1, s[4:7], s30 offen offset:3072 sc1
 v_mfma_f32_32x32x16_bf16 v[168:183], v[64:67], a[240:243], v[168:183]
 ds_read_b128 v[60:63], v2 offset:27648
 s_waitcnt vmcnt(20) lgkmcnt(6)
 v_mfma_f32_32x32x16_bf16 v[88:103], v[68:71], a[100:103], v[88:103]
 v_mfma_f32_32x32x16_bf16 v[104:119], v[68:71], a[244:247], v[104:119]
 ds_read_b128 v[64:67], v3 offset:0
 s_waitcnt lgkmcnt(6)
 v_mfma_f32_32x32x16_bf16 v[120:135], v[72:75], a[100:103], v[120:135]
 v_mfma_f32_32x32x16_bf16 v[136:151], v[72:75], a[244:247], v[136:151]
 ds_read_b128 v[68:71], v3 offset:37888
 s_waitcnt lgkmcnt(6)
 v_mfma_f32_32x32x16_bf16 v[152:167], v[76:79], a[100:103], v[152:167]
 v_mfma_f32_32x32x16_bf16 v[168:183], v[76:79], a[244:247], v[168:183]
 ds_read_b128 v[72:75], v2 offset:28672
 s_waitcnt vmcnt(18) lgkmcnt(6)
 v_mfma_f32_32x32x16_bf16 v[88:103], v[80:83], a[104:107], v[88:103]
 v_mfma_f32_32x32x16_bf16 v[104:119], v[80:83], a[248:251], v[104:119]
 ds_read_b128 v[76:79], v3 offset:1024
 s_waitcnt lgkmcnt(6)
 v_mfma_f32_32x32x16_bf16 v[120:135], v[84:87], a[104:107], v[120:135]
 v_mfma_f32_32x32x16_bf16 v[136:151], v[84:87], a[248:251], v[136:151]
 ds_read_b128 v[80:83], v3 offset:38912
 s_waitcnt lgkmcnt(6)
 v_mfma_f32_32x32x16_bf16 v[152:167], v[56:59], a[104:107], v[152:167]
 v_mfma_f32_32x32x16_bf16 v[168:183], v[56:59], a[248:251], v[168:183]
 ds_read_b128 v[84:87], v2 offset:29696
 s_waitcnt vmcnt(16) lgkmcnt(6)
 v_mfma_f32_32x32x16_bf16 v[88:103], v[60:63], a[108:111], v[88:103]
 v_mfma_f32_32x32x16_bf16 v[104:119], v[60:63], a[252:255], v[104:119]
 ds_read_b128 v[56:59], v3 offset:2048
 s_waitcnt lgkmcnt(6)
 v_mfma_f32_32x32x16_bf16 v[120:135], v[64:67], a[108:111], v[120:135]
 v_mfma_f32_32x32x16_bf16 v[136:151], v[64:67], a[252:255], v[136:151]
 ds_read_b128 v[60:63], v3 offset:39936
 s_waitcnt lgkmcnt(6)
 v_mfma_f32_32x32x16_bf16 v[152:167], v[68:71], a[108:111], v[152:167]
 v_mfma_f32_32x32x16_bf16 v[168:183], v[68:71], a[252:255], v[168:183]
 ds_read_b128 v[64:67], v2 offset:30720
 s_waitcnt vmcnt(14) lgkmcnt(6)
 v_mfma_f32_32x32x16_bf16 v[88:103], v[72:75], a[112:115], v[88:103]
 v_mfma_f32_32x32x16_bf16 v[104:119], v[72:75], v[24:27], v[104:119]
 ds_read_b128 v[68:71], v3 offset:3072
 s_waitcnt lgkmcnt(6)
 v_mfma_f32_32x32x16_bf16 v[120:135], v[76:79], a[112:115], v[120:135]
 v_mfma_f32_32x32x16_bf16 v[136:151], v[76:79], v[24:27], v[136:151]
 ds_read_b128 v[72:75], v3 offset:40960
 s_waitcnt lgkmcnt(6)
 v_mfma_f32_32x32x16_bf16 v[152:167], v[80:83], a[112:115], v[152:167]
 v_mfma_f32_32x32x16_bf16 v[168:183], v[80:83], v[24:27], v[168:183]
 ds_read_b128 v[76:79], v2 offset:31744
 s_waitcnt vmcnt(12) lgkmcnt(6)
 v_mfma_f32_32x32x16_bf16 v[88:103], v[84:87], a[116:119], v[88:103]
 v_mfma_f32_32x32x16_bf16 v[104:119], v[84:87], v[28:31], v[104:119]
 ds_read_b128 v[80:83], v3 offset:4096
 s_waitcnt lgkmcnt(6)
 v_mfma_f32_32x32x16_bf16 v[120:135], v[56:59], a[116:119], v[120:135]
 v_mfma_f32_32x32x16_bf16 v[136:151], v[56:59], v[28:31], v[136:151]
 ds_read_b128 v[84:87], v3 offset:41984
 s_waitcnt lgkmcnt(6)
 v_mfma_f32_32x32x16_bf16 v[152:167], v[60:63], a[116:119], v[152:167]
 v_mfma_f32_32x32x16_bf16 v[168:183], v[60:63], v[28:31], v[168:183]
 ds_read_b128 v[56:59], v2 offset:32768
 s_waitcnt vmcnt(10) lgkmcnt(6)
 v_mfma_f32_32x32x16_bf16 v[88:103], v[64:67], a[120:123], v[88:103]
 v_mfma_f32_32x32x16_bf16 v[104:119], v[64:67], v[32:35], v[104:119]
 ds_read_b128 v[60:63], v3 offset:5120
 s_waitcnt lgkmcnt(6)
 v_mfma_f32_32x32x16_bf16 v[120:135], v[68:71], a[120:123], v[120:135]
 v_mfma_f32_32x32x16_bf16 v[136:151], v[68:71], v[32:35], v[136:151]
 ds_read_b128 v[64:67], v3 offset:43008
 s_waitcnt lgkmcnt(6)
 v_mfma_f32_32x32x16_bf16 v[152:167], v[72:75], a[120:123], v[152:167]
 v_mfma_f32_32x32x16_bf16 v[168:183], v[72:75], v[32:35], v[168:183]
 ds_read_b128 v[68:71], v2 offset:33792
 s_waitcnt vmcnt(8) lgkmcnt(6)
 v_mfma_f32_32x32x16_bf16 v[88:103], v[76:79], a[124:127], v[88:103]
 v_mfma_f32_32x32x16_bf16 v[104:119], v[76:79], v[36:39], v[104:119]
 ds_read_b128 v[72:75], v3 offset:6144
 s_waitcnt lgkmcnt(6)
 v_mfma_f32_32x32x16_bf16 v[120:135], v[80:83], a[124:127], v[120:135]
 v_mfma_f32_32x32x16_bf16 v[136:151], v[80:83], v[36:39], v[136:151]
 ds_read_b128 v[76:79], v3 offset:44032
 s_waitcnt lgkmcnt(6)
 v_mfma_f32_32x32x16_bf16 v[152:167], v[84:87], a[124:127], v[152:167]
 v_mfma_f32_32x32x16_bf16 v[168:183], v[84:87], v[36:39], v[168:183]
 ds_read_b128 v[80:83], v2 offset:34816
 s_waitcnt vmcnt(6) lgkmcnt(6)
 v_mfma_f32_32x32x16_bf16 v[88:103], v[56:59], a[128:131], v[88:103]
 v_mfma_f32_32x32x16_bf16 v[104:119], v[56:59], v[40:43], v[104:119]
 ds_read_b128 v[84:87], v3 offset:7168
 s_waitcnt lgkmcnt(6)
 v_mfma_f32_32x32x16_bf16 v[120:135], v[60:63], a[128:131], v[120:135]
 v_mfma_f32_32x32x16_bf16 v[136:151], v[60:63], v[40:43], v[136:151]
 ds_read_b128 v[56:59], v3 offset:45056
 s_waitcnt lgkmcnt(6)
 v_mfma_f32_32x32x16_bf16 v[152:167], v[64:67], a[128:131], v[152:167]
 v_mfma_f32_32x32x16_bf16 v[168:183], v[64:67], v[40:43], v[168:183]
 ds_read_b128 v[60:63], v2 offset:35840
 s_waitcnt vmcnt(4) lgkmcnt(6)
 v_mfma_f32_32x32x16_bf16 v[88:103], v[68:71], a[132:135], v[88:103]
 v_mfma_f32_32x32x16_bf16 v[104:119], v[68:71], v[44:47], v[104:119]
 ds_read_b128 v[64:67], v3 offset:8192
 s_waitcnt lgkmcnt(6)
 v_mfma_f32_32x32x16_bf16 v[120:135], v[72:75], a[132:135], v[120:135]
 v_mfma_f32_32x32x16_bf16 v[136:151], v[72:75], v[44:47], v[136:151]
 ds_read_b128 v[68:71], v3 offset:46080
 s_waitcnt lgkmcnt(6)
 v_mfma_f32_32x32x16_bf16 v[152:167], v[76:79], a[132:135], v[152:167]
 v_mfma_f32_32x32x16_bf16 v[168:183], v[76:79], v[44:47], v[168:183]
 ds_read_b128 v[72:75], v2 offset:36864
 s_waitcnt vmcnt(2) lgkmcnt(6)
 v_mfma_f32_32x32x16_bf16 v[88:103], v[80:83], a[136:139], v[88:103]
 v_mfma_f32_32x32x16_bf16 v[104:119], v[80:83], v[48:51], v[104:119]
 ds_read_b128 v[76:79], v3 offset:9216
 s_waitcnt lgkmcnt(6)
 v_mfma_f32_32x32x16_bf16 v[120:135], v[84:87], a[136:139], v[120:135]
 v_mfma_f32_32x32x16_bf16 v[136:151], v[84:87], v[48:51], v[136:151]
 ds_read_b128 v[80:83], v3 offset:47104
 s_waitcnt lgkmcnt(6)
 v_mfma_f32_32x32x16_bf16 v[152:167], v[56:59], a[136:139], v[152:167]
 v_mfma_f32_32x32x16_bf16 v[168:183], v[56:59], v[48:51], v[168:183]
 ds_read_b128 v[84:87], v3 offset:48128
 s_waitcnt vmcnt(0) lgkmcnt(6)
 v_mfma_f32_32x32x16_bf16 v[88:103], v[60:63], a[140:143], v[88:103]
 v_mfma_f32_32x32x16_bf16 v[104:119], v[60:63], v[52:55], v[104:119]
 ds_read_b128 v[56:59], v3 offset:49152
 s_waitcnt lgkmcnt(6)
 v_mfma_f32_32x32x16_bf16 v[120:135], v[64:67], a[140:143], v[120:135]
 v_mfma_f32_32x32x16_bf16 v[136:151], v[64:67], v[52:55], v[136:151]
 ds_read_b128 v[60:63], v3 offset:50176
 s_waitcnt lgkmcnt(6)
 v_mfma_f32_32x32x16_bf16 v[152:167], v[68:71], a[140:143], v[152:167]
 v_mfma_f32_32x32x16_bf16 v[168:183], v[68:71], v[52:55], v[168:183]
 ds_read_b128 v[64:67], v3 offset:51200
 s_waitcnt lgkmcnt(6)
 v_mfma_f32_32x32x16_bf16 v[88:103], v[72:75], v[16:19], v[88:103]
 v_mfma_f32_32x32x16_bf16 v[104:119], v[72:75], v[20:23], v[104:119]
 ds_read_b128 v[68:71], v3 offset:52224
 s_waitcnt lgkmcnt(6)
 v_mfma_f32_32x32x16_bf16 v[120:135], v[76:79], v[16:19], v[120:135]
 v_mfma_f32_32x32x16_bf16 v[136:151], v[76:79], v[20:23], v[136:151]
 ds_read_b128 v[72:75], v3 offset:53248
 s_waitcnt lgkmcnt(6)
 v_mfma_f32_32x32x16_bf16 v[152:167], v[80:83], v[16:19], v[152:167]
 v_mfma_f32_32x32x16_bf16 v[168:183], v[80:83], v[20:23], v[168:183]
 ds_read_b128 v[76:79], v3 offset:54272
 s_waitcnt lgkmcnt(6)
 v_mfma_f32_32x32x16_bf16 v[184:199], v[84:87], a[0:3], 0
 v_mfma_f32_32x32x16_bf16 v[200:215], v[84:87], a[144:147], 0
 ds_read_b128 v[80:83], v3 offset:55296
 s_waitcnt lgkmcnt(6)
 v_mfma_f32_32x32x16_bf16 v[184:199], v[56:59], a[4:7], v[184:199]
 v_mfma_f32_32x32x16_bf16 v[200:215], v[56:59], a[148:151], v[200:215]
 v_mul_f32 v216, v88, v6
 v_mul_f32 v217, v89, v6
 ds_read_b128 v[84:87], v3 offset:56320
 s_waitcnt lgkmcnt(6)
 v_mfma_f32_32x32x16_bf16 v[184:199], v[60:63], a[8:11], v[184:199]
 v_mul_f32 v218, v90, v6
 v_mul_f32 v219, v91, v6
 v_mul_f32 v220, v92, v6
 v_mul_f32 v221, v93, v6
 v_mul_f32 v222, v94, v6
 v_mul_f32 v223, v95, v6
 v_mfma_f32_32x32x16_bf16 v[200:215], v[60:63], a[152:155], v[200:215]
 s_barrier
 ds_read_b128 v[56:59], v3 offset:57344
 s_waitcnt lgkmcnt(6)
 v_mfma_f32_32x32x16_bf16 v[184:199], v[64:67], a[12:15], v[184:199]
 s_add_u32 s38, s77, 151552
 s_add_u32 m0, s78, 0
 s_nop 0
 buffer_load_dwordx4 v1, s[4:7], s38 offen sc1 lds
 v_exp_f32 v216, v216
 v_mfma_f32_32x32x16_bf16 v[200:215], v[64:67], a[156:159], v[200:215]
 v_exp_f32 v217, v217
 ds_read_b128 v[60:63], v3 offset:58368
 s_waitcnt lgkmcnt(6)
 v_mfma_f32_32x32x16_bf16 v[184:199], v[68:71], a[16:19], v[184:199]
 v_exp_f32 v218, v218
 v_exp_f32 v219, v219
 v_exp_f32 v220, v220
 v_mfma_f32_32x32x16_bf16 v[200:215], v[68:71], a[160:163], v[200:215]
 v_exp_f32 v221, v221
 ds_read_b128 v[64:67], v3 offset:59392
 s_waitcnt lgkmcnt(6)
 v_mfma_f32_32x32x16_bf16 v[184:199], v[72:75], a[20:23], v[184:199]
 s_add_u32 s38, s77, 155648
 s_add_u32 m0, s78, 4096
 s_nop 0
 buffer_load_dwordx4 v1, s[4:7], s38 offen sc1 lds
 v_exp_f32 v222, v222
 v_mfma_f32_32x32x16_bf16 v[200:215], v[72:75], a[164:167], v[200:215]
 v_exp_f32 v223, v223
 ds_read_b128 v[68:71], v3 offset:60416
 s_waitcnt lgkmcnt(6)
 v_mfma_f32_32x32x16_bf16 v[184:199], v[76:79], a[24:27], v[184:199]
 s_add_u32 s38, s77, 159744
 s_add_u32 m0, s78, 8192
 s_nop 0
 buffer_load_dwordx4 v1, s[4:7], s38 offen sc1 lds
 v_mul_f32 v224, v88, v96
 v_mul_f32 v225, v89, v97
 v_mfma_f32_32x32x16_bf16 v[200:215], v[76:79], a[168:171], v[200:215]
 v_mul_f32 v226, v90, v98
 v_mul_f32 v227, v91, v99
 ds_read_b128 v[72:75], v3 offset:61440
 s_waitcnt lgkmcnt(6)
 v_mfma_f32_32x32x16_bf16 v[184:199], v[80:83], a[28:31], v[184:199]
 v_mul_f32 v228, v92, v100
 v_mul_f32 v229, v93, v101
 v_mul_f32 v230, v94, v102
 v_mul_f32 v231, v95, v103
 v_fma_f32 v216, v216, v8, v8
 v_fma_f32 v217, v217, v8, v8
 v_mfma_f32_32x32x16_bf16 v[200:215], v[80:83], a[172:175], v[200:215]
 v_fma_f32 v218, v218, v8, v8
 v_fma_f32 v219, v219, v8, v8
 ds_read_b128 v[76:79], v3 offset:62464
 s_waitcnt lgkmcnt(6)
 v_mfma_f32_32x32x16_bf16 v[184:199], v[84:87], a[32:35], v[184:199]
 s_add_u32 s38, s77, 163840
 s_add_u32 m0, s78, 12288
 s_nop 0
 buffer_load_dwordx4 v1, s[4:7], s38 offen sc1 lds
 v_fma_f32 v220, v220, v8, v8
 v_fma_f32 v221, v221, v8, v8
 v_mfma_f32_32x32x16_bf16 v[200:215], v[84:87], a[176:179], v[200:215]
 v_fma_f32 v222, v222, v8, v8
 v_fma_f32 v223, v223, v8, v8
 ds_read_b128 v[80:83], v3 offset:63488
 s_waitcnt lgkmcnt(6)
 v_mfma_f32_32x32x16_bf16 v[184:199], v[56:59], a[36:39], v[184:199]
 s_add_u32 s38, s77, 167936
 s_add_u32 m0, s78, 16384
 s_nop 0
 buffer_load_dwordx4 v1, s[4:7], s38 offen sc1 lds
 v_rcp_f32 v216, v216
 v_mfma_f32_32x32x16_bf16 v[200:215], v[56:59], a[180:183], v[200:215]
 v_rcp_f32 v217, v217
 ds_read_b128 v[84:87], v3 offset:64512
 s_waitcnt lgkmcnt(6)
 v_mfma_f32_32x32x16_bf16 v[184:199], v[60:63], a[40:43], v[184:199]
 v_rcp_f32 v218, v218
 v_rcp_f32 v219, v219
 v_rcp_f32 v220, v220
 v_mfma_f32_32x32x16_bf16 v[200:215], v[60:63], a[184:187], v[200:215]
 v_rcp_f32 v221, v221
 ds_read_b128 v[56:59], v4 offset:0
 s_waitcnt lgkmcnt(6)
 v_mfma_f32_32x32x16_bf16 v[184:199], v[64:67], a[44:47], v[184:199]
 s_add_u32 s38, s77, 172032
 s_add_u32 m0, s78, 20480
 s_nop 0
 buffer_load_dwordx4 v1, s[4:7], s38 offen sc1 lds
 v_rcp_f32 v222, v222
 v_mfma_f32_32x32x16_bf16 v[200:215], v[64:67], a[188:191], v[200:215]
 v_rcp_f32 v223, v223
 ds_read_b128 v[60:63], v4 offset:1024
 s_waitcnt lgkmcnt(6)
 v_mfma_f32_32x32x16_bf16 v[184:199], v[68:71], a[48:51], v[184:199]
 s_add_u32 s38, s77, 176128
 s_add_u32 m0, s78, 24576
 s_nop 0
 buffer_load_dwordx4 v1, s[4:7], s38 offen sc1 lds
 v_mul_f32 v224, v224, v216
 v_mul_f32 v225, v225, v217
 v_mfma_f32_32x32x16_bf16 v[200:215], v[68:71], a[192:195], v[200:215]
 v_mul_f32 v226, v226, v218
 v_mul_f32 v227, v227, v219
 ds_read_b128 v[64:67], v4 offset:2048
 s_waitcnt lgkmcnt(6)
 v_mfma_f32_32x32x16_bf16 v[184:199], v[72:75], a[52:55], v[184:199]
 v_mul_f32 v228, v228, v220
 v_mul_f32 v229, v229, v221
 v_mul_f32 v230, v230, v222
 v_mul_f32 v231, v231, v223
 v_cvt_pk_bf16_f32 v232, v224, v225
 v_cvt_pk_bf16_f32 v233, v226, v227
 v_mfma_f32_32x32x16_bf16 v[200:215], v[72:75], a[196:199], v[200:215]
 v_cvt_pk_bf16_f32 v234, v228, v229
 v_cvt_pk_bf16_f32 v235, v230, v231
 ds_read_b128 v[68:71], v4 offset:3072
 s_waitcnt lgkmcnt(6)
 v_mfma_f32_32x32x16_bf16 v[184:199], v[76:79], a[56:59], v[184:199]
 s_add_u32 s38, s77, 180224
 s_add_u32 m0, s78, 28672
 s_nop 0
 buffer_load_dwordx4 v1, s[4:7], s38 offen sc1 lds
 v_mfma_f32_32x32x16_bf16 v[200:215], v[76:79], a[200:203], v[200:215]
 ds_read_b128 v[72:75], v4 offset:4096
 s_waitcnt lgkmcnt(6)
 v_mfma_f32_32x32x16_bf16 v[184:199], v[80:83], a[60:63], v[184:199]
 s_add_u32 s38, s77, 184320
 s_add_u32 m0, s78, 32768
 s_nop 0
 buffer_load_dwordx4 v1, s[4:7], s38 offen sc1 lds
 v_mfma_f32_32x32x16_bf16 v[200:215], v[80:83], a[204:207], v[200:215]
 ds_read_b128 v[76:79], v4 offset:5120
 s_waitcnt lgkmcnt(6)
 v_mfma_f32_32x32x16_bf16 v[184:199], v[84:87], a[64:67], v[184:199]
 s_add_u32 s33, s31, 0
 buffer_store_dwordx4 v[232:235], v5, s[4:7], s33 offen sc1
 v_mul_f32 v236, v104, v7
 v_mfma_f32_32x32x16_bf16 v[200:215], v[84:87], a[208:211], v[200:215]
 v_mul_f32 v237, v105, v7
 v_mul_f32 v238, v106, v7
 ds_read_b128 v[80:83], v4 offset:6144
 s_waitcnt lgkmcnt(6)
 v_mfma_f32_32x32x16_bf16 v[184:199], v[56:59], a[68:71], v[184:199]
 s_add_u32 s38, s76, 188416
 s_mov_b32 m0, 36864
 s_nop 0
 buffer_load_dwordx4 v1, s[4:7], s38 offen sc1 lds
 v_mul_f32 v239, v107, v7
 v_mul_f32 v240, v108, v7
 v_mfma_f32_32x32x16_bf16 v[200:215], v[56:59], a[212:215], v[200:215]
 v_mul_f32 v241, v109, v7
 v_mul_f32 v242, v110, v7
 ds_read_b128 v[84:87], v4 offset:7168
 s_waitcnt lgkmcnt(6)
 v_mfma_f32_32x32x16_bf16 v[184:199], v[60:63], a[72:75], v[184:199]
 s_add_u32 s38, s77, 189440
 s_add_u32 m0, s78, 37888
 s_nop 0
 buffer_load_dwordx4 v1, s[4:7], s38 offen sc1 lds
 v_mul_f32 v243, v111, v7
 v_mfma_f32_32x32x16_bf16 v[200:215], v[60:63], a[216:219], v[200:215]
 v_exp_f32 v236, v236
 ds_read_b128 v[56:59], v4 offset:8192
 s_waitcnt lgkmcnt(6)
 v_mfma_f32_32x32x16_bf16 v[184:199], v[64:67], a[76:79], v[184:199]
 v_exp_f32 v237, v237
 v_exp_f32 v238, v238
 v_exp_f32 v239, v239
 v_mfma_f32_32x32x16_bf16 v[200:215], v[64:67], a[220:223], v[200:215]
 v_exp_f32 v240, v240
 ds_read_b128 v[60:63], v4 offset:9216
 s_waitcnt lgkmcnt(6)
 v_mfma_f32_32x32x16_bf16 v[184:199], v[68:71], a[80:83], v[184:199]
 s_add_u32 s38, s77, 193536
 s_add_u32 m0, s78, 41984
 s_nop 0
 buffer_load_dwordx4 v1, s[4:7], s38 offen sc1 lds
 v_exp_f32 v241, v241
 v_mfma_f32_32x32x16_bf16 v[200:215], v[68:71], a[224:227], v[200:215]
 v_exp_f32 v242, v242
 ds_read_b128 v[64:67], v4 offset:10240
 s_waitcnt lgkmcnt(6)
 v_mfma_f32_32x32x16_bf16 v[184:199], v[72:75], a[84:87], v[184:199]
 s_add_u32 s38, s77, 197632
 s_add_u32 m0, s78, 46080
 s_nop 0
 buffer_load_dwordx4 v1, s[4:7], s38 offen sc1 lds
 v_exp_f32 v243, v243
 v_mfma_f32_32x32x16_bf16 v[200:215], v[72:75], a[228:231], v[200:215]
 v_mul_f32 v244, v104, v112
 v_mul_f32 v245, v105, v113
 ds_read_b128 v[68:71], v4 offset:11264
 s_waitcnt lgkmcnt(6)
 v_mfma_f32_32x32x16_bf16 v[184:199], v[76:79], a[88:91], v[184:199]
 v_mul_f32 v246, v106, v114
 v_mul_f32 v247, v107, v115
 v_mul_f32 v248, v108, v116
 v_mul_f32 v249, v109, v117
 v_mul_f32 v250, v110, v118
 v_mul_f32 v251, v111, v119
 v_mfma_f32_32x32x16_bf16 v[200:215], v[76:79], a[232:235], v[200:215]
 v_fma_f32 v236, v236, v9, v9
 v_fma_f32 v237, v237, v9, v9
 ds_read_b128 v[72:75], v4 offset:12288
 s_waitcnt lgkmcnt(6)
 v_mfma_f32_32x32x16_bf16 v[184:199], v[80:83], a[92:95], v[184:199]
 s_add_u32 s38, s77, 201728
 s_add_u32 m0, s78, 50176
 s_nop 0
 buffer_load_dwordx4 v1, s[4:7], s38 offen sc1 lds
 v_fma_f32 v238, v238, v9, v9
 v_fma_f32 v239, v239, v9, v9
 v_mfma_f32_32x32x16_bf16 v[200:215], v[80:83], a[236:239], v[200:215]
 v_fma_f32 v240, v240, v9, v9
 v_fma_f32 v241, v241, v9, v9
 ds_read_b128 v[76:79], v4 offset:13312
 s_waitcnt lgkmcnt(6)
 v_mfma_f32_32x32x16_bf16 v[184:199], v[84:87], a[96:99], v[184:199]
 s_add_u32 s38, s77, 205824
 s_add_u32 m0, s78, 54272
 s_nop 0
 buffer_load_dwordx4 v1, s[4:7], s38 offen sc1 lds
 v_fma_f32 v242, v242, v9, v9
 v_fma_f32 v243, v243, v9, v9
 v_mfma_f32_32x32x16_bf16 v[200:215], v[84:87], a[240:243], v[200:215]
 v_rcp_f32 v236, v236
 ds_read_b128 v[80:83], v4 offset:14336
 s_waitcnt lgkmcnt(6)
 v_mfma_f32_32x32x16_bf16 v[184:199], v[56:59], a[100:103], v[184:199]
 v_rcp_f32 v237, v237
 v_rcp_f32 v238, v238
 v_rcp_f32 v239, v239
 v_mfma_f32_32x32x16_bf16 v[200:215], v[56:59], a[244:247], v[200:215]
 v_rcp_f32 v240, v240
 ds_read_b128 v[84:87], v4 offset:15360
 s_waitcnt lgkmcnt(6)
 v_mfma_f32_32x32x16_bf16 v[184:199], v[60:63], a[104:107], v[184:199]
 s_add_u32 s38, s77, 209920
 s_add_u32 m0, s78, 58368
 s_nop 0
 buffer_load_dwordx4 v1, s[4:7], s38 offen sc1 lds
 v_rcp_f32 v241, v241
 v_mfma_f32_32x32x16_bf16 v[200:215], v[60:63], a[248:251], v[200:215]
 v_rcp_f32 v242, v242
 ds_read_b128 v[56:59], v4 offset:16384
 s_waitcnt lgkmcnt(6)
 v_mfma_f32_32x32x16_bf16 v[184:199], v[64:67], a[108:111], v[184:199]
 s_add_u32 s38, s77, 214016
 s_add_u32 m0, s78, 62464
 s_nop 0
 buffer_load_dwordx4 v1, s[4:7], s38 offen sc1 lds
 v_rcp_f32 v243, v243
 v_mfma_f32_32x32x16_bf16 v[200:215], v[64:67], a[252:255], v[200:215]
 v_mul_f32 v244, v244, v236
 v_mul_f32 v245, v245, v237
 ds_read_b128 v[60:63], v4 offset:17408
 s_waitcnt lgkmcnt(6)
 v_mfma_f32_32x32x16_bf16 v[184:199], v[68:71], a[112:115], v[184:199]
 v_mul_f32 v246, v246, v238
 v_mul_f32 v247, v247, v239
 v_mul_f32 v248, v248, v240
 v_mul_f32 v249, v249, v241
 v_mul_f32 v250, v250, v242
 v_mul_f32 v251, v251, v243
 v_mfma_f32_32x32x16_bf16 v[200:215], v[68:71], v[24:27], v[200:215]
 v_cvt_pk_bf16_f32 v252, v244, v245
 v_cvt_pk_bf16_f32 v253, v246, v247
 ds_read_b128 v[64:67], v4 offset:18432
 s_waitcnt lgkmcnt(6)
 v_mfma_f32_32x32x16_bf16 v[184:199], v[72:75], a[116:119], v[184:199]
 s_add_u32 s38, s77, 218112
 s_add_u32 m0, s78, 66560
 s_nop 0
 buffer_load_dwordx4 v1, s[4:7], s38 offen sc1 lds
 v_cvt_pk_bf16_f32 v254, v248, v249
 v_cvt_pk_bf16_f32 v255, v250, v251
 v_mfma_f32_32x32x16_bf16 v[200:215], v[72:75], v[28:31], v[200:215]
 ds_read_b128 v[68:71], v4 offset:19456
 s_waitcnt lgkmcnt(6)
 v_mfma_f32_32x32x16_bf16 v[184:199], v[76:79], a[120:123], v[184:199]
 s_add_u32 s38, s77, 222208
 s_add_u32 m0, s78, 70656
 s_nop 0
 buffer_load_dwordx4 v1, s[4:7], s38 offen sc1 lds
 v_mfma_f32_32x32x16_bf16 v[200:215], v[76:79], v[32:35], v[200:215]
 s_waitcnt vmcnt(9)
 s_barrier
 ds_read_b128 v[72:75], v2 offset:0
 s_waitcnt lgkmcnt(6)
 v_mfma_f32_32x32x16_bf16 v[184:199], v[80:83], a[124:127], v[184:199]
 s_add_u32 s33, s31, 294912
 buffer_store_dwordx4 v[252:255], v5, s[4:7], s33 offen sc1
 v_mul_f32 v216, v120, v6
 v_mfma_f32_32x32x16_bf16 v[200:215], v[80:83], v[36:39], v[200:215]
 v_mul_f32 v217, v121, v6
 v_mul_f32 v218, v122, v6
 ds_read_b128 v[76:79], v2 offset:1024
 s_waitcnt lgkmcnt(6)
 v_mfma_f32_32x32x16_bf16 v[184:199], v[84:87], a[128:131], v[184:199]
 s_add_u32 s38, s76, 226304
 s_mov_b32 m0, 74752
 s_nop 0
 buffer_load_dwordx4 v1, s[4:7], s38 offen sc1 lds
 v_mul_f32 v219, v123, v6
 v_mul_f32 v220, v124, v6
 v_mfma_f32_32x32x16_bf16 v[200:215], v[84:87], v[40:43], v[200:215]
 v_mul_f32 v221, v125, v6
 v_mul_f32 v222, v126, v6
 ds_read_b128 v[80:83], v2 offset:2048
 s_waitcnt lgkmcnt(6)
 v_mfma_f32_32x32x16_bf16 v[184:199], v[56:59], a[132:135], v[184:199]
 s_add_u32 s38, s77, 227328
 s_add_u32 m0, s78, 75776
 s_nop 0
 buffer_load_dwordx4 v1, s[4:7], s38 offen sc1 lds
 v_mul_f32 v223, v127, v6
 v_mfma_f32_32x32x16_bf16 v[200:215], v[56:59], v[44:47], v[200:215]
 v_exp_f32 v216, v216
 ds_read_b128 v[84:87], v2 offset:3072
 s_waitcnt lgkmcnt(6)
 v_mfma_f32_32x32x16_bf16 v[184:199], v[60:63], a[136:139], v[184:199]
 v_exp_f32 v217, v217
 v_exp_f32 v218, v218
 v_exp_f32 v219, v219
 v_mfma_f32_32x32x16_bf16 v[200:215], v[60:63], v[48:51], v[200:215]
 v_exp_f32 v220, v220
 ds_read_b128 v[56:59], v2 offset:4096
 s_waitcnt lgkmcnt(6)
 v_mfma_f32_32x32x16_bf16 v[184:199], v[64:67], a[140:143], v[184:199]
 s_add_u32 s38, s77, 231424
 s_add_u32 m0, s78, 79872
 s_nop 0
 buffer_load_dwordx4 v1, s[4:7], s38 offen sc1 lds
 v_exp_f32 v221, v221
 v_mfma_f32_32x32x16_bf16 v[200:215], v[64:67], v[52:55], v[200:215]
 v_exp_f32 v222, v222
 ds_read_b128 v[60:63], v2 offset:5120
 s_waitcnt lgkmcnt(6)
 v_mfma_f32_32x32x16_bf16 v[184:199], v[68:71], v[16:19], v[184:199]
 s_add_u32 s38, s77, 235520
 s_add_u32 m0, s78, 83968
 s_nop 0
 buffer_load_dwordx4 v1, s[4:7], s38 offen sc1 lds
 v_exp_f32 v223, v223
 v_mfma_f32_32x32x16_bf16 v[200:215], v[68:71], v[20:23], v[200:215]
 v_mul_f32 v224, v120, v128
 v_mul_f32 v225, v121, v129
 ds_read_b128 v[64:67], v2 offset:6144
 s_waitcnt lgkmcnt(6)
 v_mfma_f32_32x32x16_bf16 v[88:103], v[72:75], a[0:3], 0
 v_mfma_f32_32x32x16_bf16 v[104:119], v[72:75], a[144:147], 0
 ds_read_b128 v[68:71], v2 offset:7168
 s_waitcnt lgkmcnt(6)
 v_mfma_f32_32x32x16_bf16 v[88:103], v[76:79], a[4:7], v[88:103]
 s_add_u32 s38, s77, 239616
 s_add_u32 m0, s78, 88064
 s_nop 0
 buffer_load_dwordx4 v1, s[4:7], s38 offen sc1 lds
 v_mfma_f32_32x32x16_bf16 v[104:119], v[76:79], a[148:151], v[104:119]
 v_mul_f32 v226, v122, v130
 v_mul_f32 v227, v123, v131
 ds_read_b128 v[72:75], v2 offset:8192
 s_waitcnt lgkmcnt(6)
 v_mfma_f32_32x32x16_bf16 v[88:103], v[80:83], a[8:11], v[88:103]
 s_add_u32 s38, s77, 243712
 s_add_u32 m0, s78, 92160
 s_nop 0
 buffer_load_dwordx4 v1, s[4:7], s38 offen sc1 lds
 v_mul_f32 v228, v124, v132
 v_mul_f32 v229, v125, v133
 v_mfma_f32_32x32x16_bf16 v[104:119], v[80:83], a[152:155], v[104:119]
 v_mul_f32 v230, v126, v134
 v_mul_f32 v231, v127, v135
 ds_read_b128 v[76:79], v2 offset:9216
 s_waitcnt lgkmcnt(6)
 v_mfma_f32_32x32x16_bf16 v[88:103], v[84:87], a[12:15], v[88:103]
 v_fma_f32 v216, v216, v8, v8
 v_fma_f32 v217, v217, v8, v8
 v_fma_f32 v218, v218, v8, v8
 v_fma_f32 v219, v219, v8, v8
 v_fma_f32 v220, v220, v8, v8
 v_fma_f32 v221, v221, v8, v8
 v_mfma_f32_32x32x16_bf16 v[104:119], v[84:87], a[156:159], v[104:119]
 v_fma_f32 v222, v222, v8, v8
 v_fma_f32 v223, v223, v8, v8
 ds_read_b128 v[80:83], v2 offset:10240
 s_waitcnt lgkmcnt(6)
 v_mfma_f32_32x32x16_bf16 v[88:103], v[56:59], a[16:19], v[88:103]
 s_add_u32 s38, s77, 247808
 s_add_u32 m0, s78, 96256
 s_nop 0
 buffer_load_dwordx4 v1, s[4:7], s38 offen sc1 lds
 v_rcp_f32 v216, v216
 v_mfma_f32_32x32x16_bf16 v[104:119], v[56:59], a[160:163], v[104:119]
 v_rcp_f32 v217, v217
 ds_read_b128 v[84:87], v2 offset:11264
 s_waitcnt lgkmcnt(6)
 v_mfma_f32_32x32x16_bf16 v[88:103], v[60:63], a[20:23], v[88:103]
 s_add_u32 s38, s77, 251904
 s_add_u32 m0, s78, 100352
 s_nop 0
 buffer_load_dwordx4 v1, s[4:7], s38 offen sc1 lds
 v_rcp_f32 v218, v218
 v_mfma_f32_32x32x16_bf16 v[104:119], v[60:63], a[164:167], v[104:119]
 v_rcp_f32 v219, v219
 ds_read_b128 v[56:59], v2 offset:12288
 s_waitcnt lgkmcnt(6)
 v_mfma_f32_32x32x16_bf16 v[88:103], v[64:67], a[24:27], v[88:103]
 v_rcp_f32 v220, v220
 v_rcp_f32 v221, v221
 v_rcp_f32 v222, v222
 v_mfma_f32_32x32x16_bf16 v[104:119], v[64:67], a[168:171], v[104:119]
 v_rcp_f32 v223, v223
 ds_read_b128 v[60:63], v2 offset:13312
 s_waitcnt lgkmcnt(6)
 v_mfma_f32_32x32x16_bf16 v[88:103], v[68:71], a[28:31], v[88:103]
 s_add_u32 s38, s77, 256000
 s_add_u32 m0, s78, 104448
 s_nop 0
 buffer_load_dwordx4 v1, s[4:7], s38 offen sc1 lds
 v_mul_f32 v224, v224, v216
 v_mul_f32 v225, v225, v217
 v_mfma_f32_32x32x16_bf16 v[104:119], v[68:71], a[172:175], v[104:119]
 v_mul_f32 v226, v226, v218
 v_mul_f32 v227, v227, v219
 ds_read_b128 v[64:67], v2 offset:14336
 s_waitcnt lgkmcnt(6)
 v_mfma_f32_32x32x16_bf16 v[88:103], v[72:75], a[32:35], v[88:103]
 s_add_u32 s38, s77, 260096
 s_add_u32 m0, s78, 108544
 s_nop 0
 buffer_load_dwordx4 v1, s[4:7], s38 offen sc1 lds
 v_mul_f32 v228, v228, v220
 v_mul_f32 v229, v229, v221
 v_mfma_f32_32x32x16_bf16 v[104:119], v[72:75], a[176:179], v[104:119]
 v_mul_f32 v230, v230, v222
 v_mul_f32 v231, v231, v223
 ds_read_b128 v[68:71], v2 offset:15360
 s_waitcnt lgkmcnt(6)
 v_mfma_f32_32x32x16_bf16 v[88:103], v[76:79], a[36:39], v[88:103]
 v_cvt_pk_bf16_f32 v232, v224, v225
 v_cvt_pk_bf16_f32 v233, v226, v227
 v_cvt_pk_bf16_f32 v234, v228, v229
 v_cvt_pk_bf16_f32 v235, v230, v231
 v_mfma_f32_32x32x16_bf16 v[104:119], v[76:79], a[180:183], v[104:119]
 ds_read_b128 v[72:75], v2 offset:16384
 s_waitcnt lgkmcnt(6)
 v_mfma_f32_32x32x16_bf16 v[88:103], v[80:83], a[40:43], v[88:103]
 s_add_u32 s38, s76, 264192
 s_mov_b32 m0, 112640
 s_nop 0
 buffer_load_dwordx4 v1, s[4:7], s38 offen sc1 lds
 v_mfma_f32_32x32x16_bf16 v[104:119], v[80:83], a[184:187], v[104:119]
 ds_read_b128 v[76:79], v2 offset:17408
 s_waitcnt lgkmcnt(6)
 v_mfma_f32_32x32x16_bf16 v[88:103], v[84:87], a[44:47], v[88:103]
 s_add_u32 s33, s31, 512
 buffer_store_dwordx4 v[232:235], v5, s[4:7], s33 offen sc1
 v_mul_f32 v236, v136, v7
 v_mfma_f32_32x32x16_bf16 v[104:119], v[84:87], a[188:191], v[104:119]
 v_mul_f32 v237, v137, v7
 v_mul_f32 v238, v138, v7
 ds_read_b128 v[80:83], v2 offset:18432
 s_waitcnt lgkmcnt(6)
 v_mfma_f32_32x32x16_bf16 v[88:103], v[56:59], a[48:51], v[88:103]
 v_mul_f32 v239, v139, v7
 v_mul_f32 v240, v140, v7
 v_mul_f32 v241, v141, v7
 v_mul_f32 v242, v142, v7
 v_mul_f32 v243, v143, v7
 v_mfma_f32_32x32x16_bf16 v[104:119], v[56:59], a[192:195], v[104:119]
 v_exp_f32 v236, v236
 ds_read_b128 v[84:87], v2 offset:19456
 s_waitcnt lgkmcnt(6)
 v_mfma_f32_32x32x16_bf16 v[88:103], v[60:63], a[52:55], v[88:103]
 v_exp_f32 v237, v237
 v_exp_f32 v238, v238
 v_exp_f32 v239, v239
 v_mfma_f32_32x32x16_bf16 v[104:119], v[60:63], a[196:199], v[104:119]
 v_exp_f32 v240, v240
 ds_read_b128 v[56:59], v2 offset:20480
 s_waitcnt lgkmcnt(6)
 v_mfma_f32_32x32x16_bf16 v[88:103], v[64:67], a[56:59], v[88:103]
 v_exp_f32 v241, v241
 v_exp_f32 v242, v242
 v_exp_f32 v243, v243
 v_mfma_f32_32x32x16_bf16 v[104:119], v[64:67], a[200:203], v[104:119]
 v_mul_f32 v244, v136, v144
 v_mul_f32 v245, v137, v145
 ds_read_b128 v[60:63], v2 offset:21504
 s_waitcnt lgkmcnt(6)
 v_mfma_f32_32x32x16_bf16 v[88:103], v[68:71], a[60:63], v[88:103]
 v_mul_f32 v246, v138, v146
 v_mul_f32 v247, v139, v147
 v_mul_f32 v248, v140, v148
 v_mul_f32 v249, v141, v149
 v_mul_f32 v250, v142, v150
 v_mul_f32 v251, v143, v151
 v_mfma_f32_32x32x16_bf16 v[104:119], v[68:71], a[204:207], v[104:119]
 v_fma_f32 v236, v236, v9, v9
 v_fma_f32 v237, v237, v9, v9
 ds_read_b128 v[64:67], v2 offset:22528
 s_waitcnt lgkmcnt(6)
 v_mfma_f32_32x32x16_bf16 v[88:103], v[72:75], a[64:67], v[88:103]
 v_fma_f32 v238, v238, v9, v9
 v_fma_f32 v239, v239, v9, v9
 v_fma_f32 v240, v240, v9, v9
 v_fma_f32 v241, v241, v9, v9
 v_fma_f32 v242, v242, v9, v9
 v_fma_f32 v243, v243, v9, v9
 v_mfma_f32_32x32x16_bf16 v[104:119], v[72:75], a[208:211], v[104:119]
 v_rcp_f32 v236, v236
 ds_read_b128 v[68:71], v2 offset:23552
 s_waitcnt lgkmcnt(6)
 v_mfma_f32_32x32x16_bf16 v[88:103], v[76:79], a[68:71], v[88:103]
 v_rcp_f32 v237, v237
 v_rcp_f32 v238, v238
 v_rcp_f32 v239, v239
 v_mfma_f32_32x32x16_bf16 v[104:119], v[76:79], a[212:215], v[104:119]
 v_rcp_f32 v240, v240
 ds_read_b128 v[72:75], v2 offset:24576
 s_waitcnt lgkmcnt(6)
 v_mfma_f32_32x32x16_bf16 v[88:103], v[80:83], a[72:75], v[88:103]
 v_rcp_f32 v241, v241
 v_rcp_f32 v242, v242
 v_rcp_f32 v243, v243
 v_mfma_f32_32x32x16_bf16 v[104:119], v[80:83], a[216:219], v[104:119]
 v_mul_f32 v244, v244, v236
 v_mul_f32 v245, v245, v237
 ds_read_b128 v[76:79], v2 offset:25600
 s_waitcnt lgkmcnt(6)
 v_mfma_f32_32x32x16_bf16 v[88:103], v[84:87], a[76:79], v[88:103]
 v_mul_f32 v246, v246, v238
 v_mul_f32 v247, v247, v239
 v_mul_f32 v248, v248, v240
 v_mul_f32 v249, v249, v241
 v_mul_f32 v250, v250, v242
 v_mul_f32 v251, v251, v243
 v_mfma_f32_32x32x16_bf16 v[104:119], v[84:87], a[220:223], v[104:119]
 v_cvt_pk_bf16_f32 v252, v244, v245
 v_cvt_pk_bf16_f32 v253, v246, v247
 ds_read_b128 v[80:83], v2 offset:26624
 s_waitcnt lgkmcnt(6)
 v_mfma_f32_32x32x16_bf16 v[88:103], v[56:59], a[80:83], v[88:103]
 v_cvt_pk_bf16_f32 v254, v248, v249
 v_cvt_pk_bf16_f32 v255, v250, v251
 v_mfma_f32_32x32x16_bf16 v[104:119], v[56:59], a[224:227], v[104:119]
 ds_read_b128 v[84:87], v2 offset:27648
 s_waitcnt lgkmcnt(6)
 v_mfma_f32_32x32x16_bf16 v[88:103], v[60:63], a[84:87], v[88:103]
 s_add_u32 s33, s31, 295424
 buffer_store_dwordx4 v[252:255], v5, s[4:7], s33 offen sc1
 v_mul_f32 v216, v152, v6
 v_mfma_f32_32x32x16_bf16 v[104:119], v[60:63], a[228:231], v[104:119]
 v_mul_f32 v217, v153, v6
 v_mul_f32 v218, v154, v6
 ds_read_b128 v[56:59], v2 offset:28672
 s_waitcnt lgkmcnt(6)
 v_mfma_f32_32x32x16_bf16 v[88:103], v[64:67], a[88:91], v[88:103]
 v_mul_f32 v219, v155, v6
 v_mul_f32 v220, v156, v6
 v_mul_f32 v221, v157, v6
 v_mul_f32 v222, v158, v6
 v_mul_f32 v223, v159, v6
 v_mfma_f32_32x32x16_bf16 v[104:119], v[64:67], a[232:235], v[104:119]
 v_exp_f32 v216, v216
 ds_read_b128 v[60:63], v2 offset:29696
 s_waitcnt lgkmcnt(6)
 v_mfma_f32_32x32x16_bf16 v[88:103], v[68:71], a[92:95], v[88:103]
 v_exp_f32 v217, v217
 v_exp_f32 v218, v218
 v_exp_f32 v219, v219
 v_mfma_f32_32x32x16_bf16 v[104:119], v[68:71], a[236:239], v[104:119]
 v_exp_f32 v220, v220
 ds_read_b128 v[64:67], v2 offset:30720
 s_waitcnt lgkmcnt(6)
 v_mfma_f32_32x32x16_bf16 v[88:103], v[72:75], a[96:99], v[88:103]
 v_exp_f32 v221, v221
 v_exp_f32 v222, v222
 v_exp_f32 v223, v223
 v_mfma_f32_32x32x16_bf16 v[104:119], v[72:75], a[240:243], v[104:119]
 v_mul_f32 v224, v152, v160
 v_mul_f32 v225, v153, v161
 ds_read_b128 v[68:71], v2 offset:31744
 s_waitcnt lgkmcnt(6)
 v_mfma_f32_32x32x16_bf16 v[88:103], v[76:79], a[100:103], v[88:103]
 v_mul_f32 v226, v154, v162
 v_mul_f32 v227, v155, v163
 v_mul_f32 v228, v156, v164
 v_mul_f32 v229, v157, v165
 v_mul_f32 v230, v158, v166
 v_mul_f32 v231, v159, v167
 v_mfma_f32_32x32x16_bf16 v[104:119], v[76:79], a[244:247], v[104:119]
 v_fma_f32 v216, v216, v8, v8
 v_fma_f32 v217, v217, v8, v8
 ds_read_b128 v[72:75], v2 offset:32768
 s_waitcnt lgkmcnt(6)
 v_mfma_f32_32x32x16_bf16 v[88:103], v[80:83], a[104:107], v[88:103]
 v_fma_f32 v218, v218, v8, v8
 v_fma_f32 v219, v219, v8, v8
 v_fma_f32 v220, v220, v8, v8
 v_fma_f32 v221, v221, v8, v8
 v_fma_f32 v222, v222, v8, v8
 v_fma_f32 v223, v223, v8, v8
 v_mfma_f32_32x32x16_bf16 v[104:119], v[80:83], a[248:251], v[104:119]
 v_rcp_f32 v216, v216
 ds_read_b128 v[76:79], v2 offset:33792
 s_waitcnt lgkmcnt(6)
 v_mfma_f32_32x32x16_bf16 v[88:103], v[84:87], a[108:111], v[88:103]
 v_rcp_f32 v217, v217
 v_rcp_f32 v218, v218
 v_rcp_f32 v219, v219
 v_mfma_f32_32x32x16_bf16 v[104:119], v[84:87], a[252:255], v[104:119]
 v_rcp_f32 v220, v220
 ds_read_b128 v[80:83], v2 offset:34816
 s_waitcnt lgkmcnt(6)
 v_mfma_f32_32x32x16_bf16 v[88:103], v[56:59], a[112:115], v[88:103]
 v_rcp_f32 v221, v221
 v_rcp_f32 v222, v222
 v_rcp_f32 v223, v223
 v_mfma_f32_32x32x16_bf16 v[104:119], v[56:59], v[24:27], v[104:119]
 v_mul_f32 v224, v224, v216
 v_mul_f32 v225, v225, v217
 ds_read_b128 v[84:87], v2 offset:35840
 s_waitcnt lgkmcnt(6)
 v_mfma_f32_32x32x16_bf16 v[88:103], v[60:63], a[116:119], v[88:103]
 v_mul_f32 v226, v226, v218
 v_mul_f32 v227, v227, v219
 v_mul_f32 v228, v228, v220
 v_mul_f32 v229, v229, v221
 v_mul_f32 v230, v230, v222
 v_mul_f32 v231, v231, v223
 v_mfma_f32_32x32x16_bf16 v[104:119], v[60:63], v[28:31], v[104:119]
 v_cvt_pk_bf16_f32 v232, v224, v225
 v_cvt_pk_bf16_f32 v233, v226, v227
 ds_read_b128 v[56:59], v2 offset:36864
 s_waitcnt lgkmcnt(6)
 v_mfma_f32_32x32x16_bf16 v[88:103], v[64:67], a[120:123], v[88:103]
 v_cvt_pk_bf16_f32 v234, v228, v229
 v_cvt_pk_bf16_f32 v235, v230, v231
 v_mfma_f32_32x32x16_bf16 v[104:119], v[64:67], v[32:35], v[104:119]
 s_waitcnt vmcnt(12)
 s_barrier
 ds_read_b128 v[60:63], v2 offset:37888
 s_waitcnt lgkmcnt(6)
 v_mfma_f32_32x32x16_bf16 v[88:103], v[68:71], a[124:127], v[88:103]
 s_add_u32 s38, s77, 265216
 s_add_u32 m0, s78, 113664
 s_nop 0
 buffer_load_dwordx4 v1, s[4:7], s38 offen sc1 lds
 v_mfma_f32_32x32x16_bf16 v[104:119], v[68:71], v[36:39], v[104:119]
 ds_read_b128 v[64:67], v2 offset:38912
 s_waitcnt lgkmcnt(6)
 v_mfma_f32_32x32x16_bf16 v[88:103], v[72:75], a[128:131], v[88:103]
 s_add_u32 s33, s31, 1024
 buffer_store_dwordx4 v[232:235], v5, s[4:7], s33 offen sc1
 v_mul_f32 v236, v168, v7
 v_mfma_f32_32x32x16_bf16 v[104:119], v[72:75], v[40:43], v[104:119]
 v_mul_f32 v237, v169, v7
 v_mul_f32 v238, v170, v7
 ds_read_b128 v[68:71], v2 offset:39936
 s_waitcnt lgkmcnt(6)
 v_mfma_f32_32x32x16_bf16 v[88:103], v[76:79], a[132:135], v[88:103]
 s_add_u32 s38, s77, 269312
 s_add_u32 m0, s78, 117760
 s_nop 0
 buffer_load_dwordx4 v1, s[4:7], s38 offen sc1 lds
 v_mul_f32 v239, v171, v7
 v_mul_f32 v240, v172, v7
 v_mfma_f32_32x32x16_bf16 v[104:119], v[76:79], v[44:47], v[104:119]
 v_mul_f32 v241, v173, v7
 v_mul_f32 v242, v174, v7
 ds_read_b128 v[72:75], v2 offset:40960
 s_waitcnt lgkmcnt(6)
 v_mfma_f32_32x32x16_bf16 v[88:103], v[80:83], a[136:139], v[88:103]
 s_add_u32 s38, s77, 273408
 s_add_u32 m0, s78, 121856
 s_nop 0
 buffer_load_dwordx4 v1, s[4:7], s38 offen sc1 lds
 v_mul_f32 v243, v175, v7
 v_mfma_f32_32x32x16_bf16 v[104:119], v[80:83], v[48:51], v[104:119]
 v_exp_f32 v236, v236
 ds_read_b128 v[76:79], v2 offset:41984
 s_waitcnt lgkmcnt(6)
 v_mfma_f32_32x32x16_bf16 v[88:103], v[84:87], a[140:143], v[88:103]
 v_exp_f32 v237, v237
 v_exp_f32 v238, v238
 v_exp_f32 v239, v239
 v_mfma_f32_32x32x16_bf16 v[104:119], v[84:87], v[52:55], v[104:119]
 v_exp_f32 v240, v240
 ds_read_b128 v[80:83], v2 offset:43008
 s_waitcnt lgkmcnt(6)
 v_mfma_f32_32x32x16_bf16 v[88:103], v[56:59], v[16:19], v[88:103]
 s_add_u32 s38, s77, 277504
 s_add_u32 m0, s78, 125952
 s_nop 0
 buffer_load_dwordx4 v1, s[4:7], s38 offen sc1 lds
 v_exp_f32 v241, v241
 v_mfma_f32_32x32x16_bf16 v[104:119], v[56:59], v[20:23], v[104:119]
 v_exp_f32 v242, v242
 ds_read_b128 v[84:87], v2 offset:44032
 s_waitcnt lgkmcnt(6)
 v_mfma_f32_32x32x16_bf16 v[120:135], v[60:63], a[0:3], 0
 s_add_u32 s38, s77, 281600
 s_add_u32 m0, s78, 130048
 s_nop 0
 buffer_load_dwordx4 v1, s[4:7], s38 offen sc1 lds
 v_mfma_f32_32x32x16_bf16 v[136:151], v[60:63], a[144:147], 0
 ds_read_b128 v[56:59], v2 offset:45056
 s_waitcnt lgkmcnt(6)
 v_mfma_f32_32x32x16_bf16 v[120:135], v[64:67], a[4:7], v[120:135]
 v_mfma_f32_32x32x16_bf16 v[136:151], v[64:67], a[148:151], v[136:151]
 v_exp_f32 v243, v243
 ds_read_b128 v[60:63], v2 offset:46080
 s_waitcnt lgkmcnt(6)
 v_mfma_f32_32x32x16_bf16 v[120:135], v[68:71], a[8:11], v[120:135]
 s_add_u32 s38, s77, 285696
 s_add_u32 m0, s78, 134144
 s_nop 0
 buffer_load_dwordx4 v1, s[4:7], s38 offen sc1 lds
 v_mul_f32 v244, v168, v176
 v_mul_f32 v245, v169, v177
 v_mfma_f32_32x32x16_bf16 v[136:151], v[68:71], a[152:155], v[136:151]
 v_mul_f32 v246, v170, v178
 v_mul_f32 v247, v171, v179
 ds_read_b128 v[64:67], v2 offset:47104
 s_waitcnt lgkmcnt(6)
 v_mfma_f32_32x32x16_bf16 v[120:135], v[72:75], a[12:15], v[120:135]
 s_add_u32 s38, s77, 289792
 s_add_u32 m0, s78, 138240
 s_nop 0
 buffer_load_dwordx4 v1, s[4:7], s38 offen sc1 lds
 v_mul_f32 v248, v172, v180
 v_mul_f32 v249, v173, v181
 v_mfma_f32_32x32x16_bf16 v[136:151], v[72:75], a[156:159], v[136:151]
 v_mul_f32 v250, v174, v182
 v_mul_f32 v251, v175, v183
 ds_read_b128 v[68:71], v2 offset:48128
 s_waitcnt lgkmcnt(6)
 v_mfma_f32_32x32x16_bf16 v[120:135], v[76:79], a[16:19], v[120:135]
 v_fma_f32 v236, v236, v9, v9
 v_fma_f32 v237, v237, v9, v9
 v_fma_f32 v238, v238, v9, v9
 v_fma_f32 v239, v239, v9, v9
 v_fma_f32 v240, v240, v9, v9
 v_fma_f32 v241, v241, v9, v9
 v_mfma_f32_32x32x16_bf16 v[136:151], v[76:79], a[160:163], v[136:151]
 v_fma_f32 v242, v242, v9, v9
 v_fma_f32 v243, v243, v9, v9
 ds_read_b128 v[72:75], v2 offset:49152
 s_waitcnt lgkmcnt(6)
 v_mfma_f32_32x32x16_bf16 v[120:135], v[80:83], a[20:23], v[120:135]
 s_add_u32 s38, s77, 293888
 s_add_u32 m0, s78, 142336
 s_nop 0
 buffer_load_dwordx4 v1, s[4:7], s38 offen sc1 lds
 v_rcp_f32 v236, v236
 v_mfma_f32_32x32x16_bf16 v[136:151], v[80:83], a[164:167], v[136:151]
 v_rcp_f32 v237, v237
 ds_read_b128 v[76:79], v2 offset:50176
 s_waitcnt lgkmcnt(6)
 v_mfma_f32_32x32x16_bf16 v[120:135], v[84:87], a[24:27], v[120:135]
 s_add_u32 s38, s77, 297984
 s_add_u32 m0, s78, 146432
 s_nop 0
 buffer_load_dwordx4 v1, s[4:7], s38 offen sc1 lds
 v_rcp_f32 v238, v238
 v_mfma_f32_32x32x16_bf16 v[136:151], v[84:87], a[168:171], v[136:151]
 v_rcp_f32 v239, v239
 ds_read_b128 v[80:83], v2 offset:51200
 s_waitcnt lgkmcnt(6)
 v_mfma_f32_32x32x16_bf16 v[120:135], v[56:59], a[28:31], v[120:135]
 v_rcp_f32 v240, v240
 v_rcp_f32 v241, v241
 v_rcp_f32 v242, v242
 v_mfma_f32_32x32x16_bf16 v[136:151], v[56:59], a[172:175], v[136:151]
 v_rcp_f32 v243, v243
 ds_read_b128 v[84:87], v2 offset:52224
 s_waitcnt lgkmcnt(6)
 v_mfma_f32_32x32x16_bf16 v[120:135], v[60:63], a[32:35], v[120:135]
 s_add_u32 s38, s76, 302080
 s_mov_b32 m0, 150528
 s_nop 0
 buffer_load_dwordx4 v1, s[4:7], s38 offen sc1 lds
 v_mul_f32 v244, v244, v236
 v_mul_f32 v245, v245, v237
 v_mfma_f32_32x32x16_bf16 v[136:151], v[60:63], a[176:179], v[136:151]
 v_mul_f32 v246, v246, v238
 v_mul_f32 v247, v247, v239
 ds_read_b128 v[56:59], v2 offset:53248
 s_waitcnt lgkmcnt(6)
 v_mfma_f32_32x32x16_bf16 v[120:135], v[64:67], a[36:39], v[120:135]
 v_mul_f32 v248, v248, v240
 v_mul_f32 v249, v249, v241
 v_mul_f32 v250, v250, v242
 v_mul_f32 v251, v251, v243
 v_cvt_pk_bf16_f32 v252, v244, v245
 v_cvt_pk_bf16_f32 v253, v246, v247
 v_mfma_f32_32x32x16_bf16 v[136:151], v[64:67], a[180:183], v[136:151]
 v_cvt_pk_bf16_f32 v254, v248, v249
 v_cvt_pk_bf16_f32 v255, v250, v251
 ds_read_b128 v[60:63], v2 offset:54272
 s_waitcnt lgkmcnt(6)
 v_mfma_f32_32x32x16_bf16 v[120:135], v[68:71], a[40:43], v[120:135]
 s_add_u32 s33, s31, 295936
 buffer_store_dwordx4 v[252:255], v5, s[4:7], s33 offen sc1
 v_mul_f32 v216, v184, v6
 v_mfma_f32_32x32x16_bf16 v[136:151], v[68:71], a[184:187], v[136:151]
 v_mul_f32 v217, v185, v6
 v_mul_f32 v218, v186, v6
 ds_read_b128 v[64:67], v2 offset:55296
 s_waitcnt lgkmcnt(6)
 v_mfma_f32_32x32x16_bf16 v[120:135], v[72:75], a[44:47], v[120:135]
 v_mul_f32 v219, v187, v6
 v_mul_f32 v220, v188, v6
 v_mul_f32 v221, v189, v6
 v_mul_f32 v222, v190, v6
 v_mul_f32 v223, v191, v6
 v_mfma_f32_32x32x16_bf16 v[136:151], v[72:75], a[188:191], v[136:151]
 v_exp_f32 v216, v216
 ds_read_b128 v[68:71], v2 offset:56320
 s_waitcnt lgkmcnt(6)
 v_mfma_f32_32x32x16_bf16 v[120:135], v[76:79], a[48:51], v[120:135]
 v_exp_f32 v217, v217
 v_exp_f32 v218, v218
 v_exp_f32 v219, v219
 v_mfma_f32_32x32x16_bf16 v[136:151], v[76:79], a[192:195], v[136:151]
 v_exp_f32 v220, v220
 ds_read_b128 v[72:75], v2 offset:57344
 s_waitcnt lgkmcnt(6)
 v_mfma_f32_32x32x16_bf16 v[120:135], v[80:83], a[52:55], v[120:135]
 v_exp_f32 v221, v221
 v_exp_f32 v222, v222
 v_exp_f32 v223, v223
 v_mfma_f32_32x32x16_bf16 v[136:151], v[80:83], a[196:199], v[136:151]
 v_mul_f32 v224, v184, v192
 v_mul_f32 v225, v185, v193
 ds_read_b128 v[76:79], v2 offset:58368
 s_waitcnt lgkmcnt(6)
 v_mfma_f32_32x32x16_bf16 v[120:135], v[84:87], a[56:59], v[120:135]
 v_mul_f32 v226, v186, v194
 v_mul_f32 v227, v187, v195
 v_mul_f32 v228, v188, v196
 v_mul_f32 v229, v189, v197
 v_mul_f32 v230, v190, v198
 v_mul_f32 v231, v191, v199
 v_mfma_f32_32x32x16_bf16 v[136:151], v[84:87], a[200:203], v[136:151]
 v_fma_f32 v216, v216, v8, v8
 v_fma_f32 v217, v217, v8, v8
 ds_read_b128 v[80:83], v2 offset:59392
 s_waitcnt lgkmcnt(6)
 v_mfma_f32_32x32x16_bf16 v[120:135], v[56:59], a[60:63], v[120:135]
 v_fma_f32 v218, v218, v8, v8
 v_fma_f32 v219, v219, v8, v8
 v_fma_f32 v220, v220, v8, v8
 v_fma_f32 v221, v221, v8, v8
 v_fma_f32 v222, v222, v8, v8
 v_fma_f32 v223, v223, v8, v8
 v_mfma_f32_32x32x16_bf16 v[136:151], v[56:59], a[204:207], v[136:151]
 v_rcp_f32 v216, v216
 ds_read_b128 v[84:87], v2 offset:60416
 s_waitcnt lgkmcnt(6)
 v_mfma_f32_32x32x16_bf16 v[120:135], v[60:63], a[64:67], v[120:135]
 v_rcp_f32 v217, v217
 v_rcp_f32 v218, v218
 v_rcp_f32 v219, v219
 v_mfma_f32_32x32x16_bf16 v[136:151], v[60:63], a[208:211], v[136:151]
 v_rcp_f32 v220, v220
 ds_read_b128 v[56:59], v2 offset:61440
 s_waitcnt lgkmcnt(6)
 v_mfma_f32_32x32x16_bf16 v[120:135], v[64:67], a[68:71], v[120:135]
 v_rcp_f32 v221, v221
 v_rcp_f32 v222, v222
 v_rcp_f32 v223, v223
 v_mfma_f32_32x32x16_bf16 v[136:151], v[64:67], a[212:215], v[136:151]
 v_mul_f32 v224, v224, v216
 v_mul_f32 v225, v225, v217
 ds_read_b128 v[60:63], v2 offset:62464
 s_waitcnt lgkmcnt(6)
 v_mfma_f32_32x32x16_bf16 v[120:135], v[68:71], a[72:75], v[120:135]
 v_mul_f32 v226, v226, v218
 v_mul_f32 v227, v227, v219
 v_mul_f32 v228, v228, v220
 v_mul_f32 v229, v229, v221
 v_mul_f32 v230, v230, v222
 v_mul_f32 v231, v231, v223
 v_mfma_f32_32x32x16_bf16 v[136:151], v[68:71], a[216:219], v[136:151]
 v_cvt_pk_bf16_f32 v232, v224, v225
 v_cvt_pk_bf16_f32 v233, v226, v227
 ds_read_b128 v[64:67], v2 offset:63488
 s_waitcnt lgkmcnt(6)
 v_mfma_f32_32x32x16_bf16 v[120:135], v[72:75], a[76:79], v[120:135]
 v_cvt_pk_bf16_f32 v234, v228, v229
 v_cvt_pk_bf16_f32 v235, v230, v231
 v_mfma_f32_32x32x16_bf16 v[136:151], v[72:75], a[220:223], v[136:151]
 ds_read_b128 v[68:71], v2 offset:64512
 s_waitcnt lgkmcnt(6)
 v_mfma_f32_32x32x16_bf16 v[120:135], v[76:79], a[80:83], v[120:135]
 s_add_u32 s33, s31, 1536
 buffer_store_dwordx4 v[232:235], v5, s[4:7], s33 offen sc1
 v_mul_f32 v236, v200, v7
 v_mfma_f32_32x32x16_bf16 v[136:151], v[76:79], a[224:227], v[136:151]
 v_mul_f32 v237, v201, v7
 v_mul_f32 v238, v202, v7
 ds_read_b128 v[72:75], v3 offset:0
 s_waitcnt lgkmcnt(6)
 v_mfma_f32_32x32x16_bf16 v[120:135], v[80:83], a[84:87], v[120:135]
 v_mul_f32 v239, v203, v7
 v_mul_f32 v240, v204, v7
 v_mul_f32 v241, v205, v7
 v_mul_f32 v242, v206, v7
 v_mul_f32 v243, v207, v7
 v_mfma_f32_32x32x16_bf16 v[136:151], v[80:83], a[228:231], v[136:151]
 v_exp_f32 v236, v236
 ds_read_b128 v[76:79], v3 offset:1024
 s_waitcnt lgkmcnt(6)
 v_mfma_f32_32x32x16_bf16 v[120:135], v[84:87], a[88:91], v[120:135]
 v_exp_f32 v237, v237
 v_exp_f32 v238, v238
 v_exp_f32 v239, v239
 v_mfma_f32_32x32x16_bf16 v[136:151], v[84:87], a[232:235], v[136:151]
 v_exp_f32 v240, v240
 ds_read_b128 v[80:83], v3 offset:2048
 s_waitcnt lgkmcnt(6)
 v_mfma_f32_32x32x16_bf16 v[120:135], v[56:59], a[92:95], v[120:135]
 v_exp_f32 v241, v241
 v_exp_f32 v242, v242
 v_exp_f32 v243, v243
 v_mfma_f32_32x32x16_bf16 v[136:151], v[56:59], a[236:239], v[136:151]
 v_mul_f32 v244, v200, v208
 v_mul_f32 v245, v201, v209
 ds_read_b128 v[84:87], v3 offset:3072
 s_waitcnt lgkmcnt(6)
 v_mfma_f32_32x32x16_bf16 v[120:135], v[60:63], a[96:99], v[120:135]
 v_mul_f32 v246, v202, v210
 v_mul_f32 v247, v203, v211
 v_mul_f32 v248, v204, v212
 v_mul_f32 v249, v205, v213
 v_mul_f32 v250, v206, v214
 v_mul_f32 v251, v207, v215
 v_mfma_f32_32x32x16_bf16 v[136:151], v[60:63], a[240:243], v[136:151]
 v_fma_f32 v236, v236, v9, v9
 v_fma_f32 v237, v237, v9, v9
 ds_read_b128 v[56:59], v3 offset:4096
 s_waitcnt lgkmcnt(6)
 v_mfma_f32_32x32x16_bf16 v[120:135], v[64:67], a[100:103], v[120:135]
 v_fma_f32 v238, v238, v9, v9
 v_fma_f32 v239, v239, v9, v9
 v_fma_f32 v240, v240, v9, v9
 v_fma_f32 v241, v241, v9, v9
 v_fma_f32 v242, v242, v9, v9
 v_fma_f32 v243, v243, v9, v9
 v_mfma_f32_32x32x16_bf16 v[136:151], v[64:67], a[244:247], v[136:151]
 v_rcp_f32 v236, v236
 ds_read_b128 v[60:63], v3 offset:5120
 s_waitcnt lgkmcnt(6)
 v_mfma_f32_32x32x16_bf16 v[120:135], v[68:71], a[104:107], v[120:135]
 v_rcp_f32 v237, v237
 v_rcp_f32 v238, v238
 v_rcp_f32 v239, v239
 v_mfma_f32_32x32x16_bf16 v[136:151], v[68:71], a[248:251], v[136:151]
 v_rcp_f32 v240, v240
 ds_read_b128 v[64:67], v3 offset:6144
 s_waitcnt lgkmcnt(6)
 v_mfma_f32_32x32x16_bf16 v[120:135], v[72:75], a[108:111], v[120:135]
 v_rcp_f32 v241, v241
 v_rcp_f32 v242, v242
 v_rcp_f32 v243, v243
 v_mfma_f32_32x32x16_bf16 v[136:151], v[72:75], a[252:255], v[136:151]
 v_mul_f32 v244, v244, v236
 v_mul_f32 v245, v245, v237
 ds_read_b128 v[68:71], v3 offset:7168
 s_waitcnt lgkmcnt(6)
 v_mfma_f32_32x32x16_bf16 v[120:135], v[76:79], a[112:115], v[120:135]
 v_mul_f32 v246, v246, v238
 v_mul_f32 v247, v247, v239
 v_mul_f32 v248, v248, v240
 v_mul_f32 v249, v249, v241
 v_mul_f32 v250, v250, v242
 v_mul_f32 v251, v251, v243
 v_mfma_f32_32x32x16_bf16 v[136:151], v[76:79], v[24:27], v[136:151]
 v_cvt_pk_bf16_f32 v252, v244, v245
 v_cvt_pk_bf16_f32 v253, v246, v247
 ds_read_b128 v[72:75], v3 offset:8192
 s_waitcnt lgkmcnt(6)
 v_mfma_f32_32x32x16_bf16 v[120:135], v[80:83], a[116:119], v[120:135]
 v_cvt_pk_bf16_f32 v254, v248, v249
 v_cvt_pk_bf16_f32 v255, v250, v251
 v_mfma_f32_32x32x16_bf16 v[136:151], v[80:83], v[28:31], v[136:151]
 ds_read_b128 v[76:79], v3 offset:9216
 s_waitcnt lgkmcnt(6)
 v_mfma_f32_32x32x16_bf16 v[120:135], v[84:87], a[120:123], v[120:135]
 s_add_u32 s33, s31, 296448
 buffer_store_dwordx4 v[252:255], v5, s[4:7], s33 offen sc1
 v_mul_f32 v216, v88, v6
 v_mfma_f32_32x32x16_bf16 v[136:151], v[84:87], v[32:35], v[136:151]
 s_waitcnt vmcnt(16)
 s_barrier
 ds_read_b128 v[80:83], v3 offset:10240
 s_waitcnt lgkmcnt(6)
 v_mfma_f32_32x32x16_bf16 v[120:135], v[56:59], a[124:127], v[120:135]
 s_add_u32 s38, s77, 303104
 s_add_u32 m0, s78, 0
 s_nop 0
 buffer_load_dwordx4 v1, s[4:7], s38 offen sc1 lds
 v_mul_f32 v217, v89, v6
 v_mul_f32 v218, v90, v6
 v_mfma_f32_32x32x16_bf16 v[136:151], v[56:59], v[36:39], v[136:151]
 v_mul_f32 v219, v91, v6
 v_mul_f32 v220, v92, v6
 ds_read_b128 v[84:87], v3 offset:11264
 s_waitcnt lgkmcnt(6)
 v_mfma_f32_32x32x16_bf16 v[120:135], v[60:63], a[128:131], v[120:135]
 v_mul_f32 v221, v93, v6
 v_mul_f32 v222, v94, v6
 v_mul_f32 v223, v95, v6
 v_exp_f32 v216, v216
 v_mfma_f32_32x32x16_bf16 v[136:151], v[60:63], v[40:43], v[136:151]
 v_exp_f32 v217, v217
 ds_read_b128 v[56:59], v3 offset:12288
 s_waitcnt lgkmcnt(6)
 v_mfma_f32_32x32x16_bf16 v[120:135], v[64:67], a[132:135], v[120:135]
 s_add_u32 s38, s77, 307200
 s_add_u32 m0, s78, 4096
 s_nop 0
 buffer_load_dwordx4 v1, s[4:7], s38 offen sc1 lds
 v_exp_f32 v218, v218
 v_mfma_f32_32x32x16_bf16 v[136:151], v[64:67], v[44:47], v[136:151]
 v_exp_f32 v219, v219
 ds_read_b128 v[60:63], v3 offset:13312
 s_waitcnt lgkmcnt(6)
 v_mfma_f32_32x32x16_bf16 v[120:135], v[68:71], a[136:139], v[120:135]
 s_add_u32 s38, s77, 311296
 s_add_u32 m0, s78, 8192
 s_nop 0
 buffer_load_dwordx4 v1, s[4:7], s38 offen sc1 lds
 v_exp_f32 v220, v220
 v_mfma_f32_32x32x16_bf16 v[136:151], v[68:71], v[48:51], v[136:151]
 v_exp_f32 v221, v221
 ds_read_b128 v[64:67], v3 offset:14336
 s_waitcnt lgkmcnt(6)
 v_mfma_f32_32x32x16_bf16 v[120:135], v[72:75], a[140:143], v[120:135]
 v_exp_f32 v222, v222
 v_exp_f32 v223, v223
 v_mul_f32 v224, v88, v96
 v_mul_f32 v225, v89, v97
 v_mfma_f32_32x32x16_bf16 v[136:151], v[72:75], v[52:55], v[136:151]
 v_mul_f32 v226, v90, v98
 v_mul_f32 v227, v91, v99
 ds_read_b128 v[68:71], v3 offset:15360
 s_waitcnt lgkmcnt(6)
 v_mfma_f32_32x32x16_bf16 v[120:135], v[76:79], v[16:19], v[120:135]
 s_add_u32 s38, s77, 315392
 s_add_u32 m0, s78, 12288
 s_nop 0
 buffer_load_dwordx4 v1, s[4:7], s38 offen sc1 lds
 v_mul_f32 v228, v92, v100
 v_mul_f32 v229, v93, v101
 v_mfma_f32_32x32x16_bf16 v[136:151], v[76:79], v[20:23], v[136:151]
 v_mul_f32 v230, v94, v102
 v_mul_f32 v231, v95, v103
 ds_read_b128 v[72:75], v3 offset:16384
 s_waitcnt lgkmcnt(6)
 v_mfma_f32_32x32x16_bf16 v[152:167], v[80:83], a[0:3], 0
 s_add_u32 s38, s77, 319488
 s_add_u32 m0, s78, 16384
 s_nop 0
 buffer_load_dwordx4 v1, s[4:7], s38 offen sc1 lds
 v_mfma_f32_32x32x16_bf16 v[168:183], v[80:83], a[144:147], 0
 ds_read_b128 v[76:79], v3 offset:17408
 s_waitcnt lgkmcnt(6)
 v_mfma_f32_32x32x16_bf16 v[152:167], v[84:87], a[4:7], v[152:167]
 v_mfma_f32_32x32x16_bf16 v[168:183], v[84:87], a[148:151], v[168:183]
 v_fma_f32 v216, v216, v8, v8
 v_fma_f32 v217, v217, v8, v8
 ds_read_b128 v[80:83], v3 offset:18432
 s_waitcnt lgkmcnt(6)
 v_mfma_f32_32x32x16_bf16 v[152:167], v[56:59], a[8:11], v[152:167]
 s_add_u32 s38, s77, 323584
 s_add_u32 m0, s78, 20480
 s_nop 0
 buffer_load_dwordx4 v1, s[4:7], s38 offen sc1 lds
 v_fma_f32 v218, v218, v8, v8
 v_fma_f32 v219, v219, v8, v8
 v_mfma_f32_32x32x16_bf16 v[168:183], v[56:59], a[152:155], v[168:183]
 v_fma_f32 v220, v220, v8, v8
 v_fma_f32 v221, v221, v8, v8
 ds_read_b128 v[84:87], v3 offset:19456
 s_waitcnt lgkmcnt(6)
 v_mfma_f32_32x32x16_bf16 v[152:167], v[60:63], a[12:15], v[152:167]
 s_add_u32 s38, s77, 327680
 s_add_u32 m0, s78, 24576
 s_nop 0
 buffer_load_dwordx4 v1, s[4:7], s38 offen sc1 lds
 v_fma_f32 v222, v222, v8, v8
 v_fma_f32 v223, v223, v8, v8
 v_mfma_f32_32x32x16_bf16 v[168:183], v[60:63], a[156:159], v[168:183]
 v_rcp_f32 v216, v216
 ds_read_b128 v[56:59], v3 offset:20480
 s_waitcnt lgkmcnt(6)
 v_mfma_f32_32x32x16_bf16 v[152:167], v[64:67], a[16:19], v[152:167]
 v_rcp_f32 v217, v217
 v_rcp_f32 v218, v218
 v_rcp_f32 v219, v219
 v_mfma_f32_32x32x16_bf16 v[168:183], v[64:67], a[160:163], v[168:183]
 v_rcp_f32 v220, v220
 ds_read_b128 v[60:63], v3 offset:21504
 s_waitcnt lgkmcnt(6)
 v_mfma_f32_32x32x16_bf16 v[152:167], v[68:71], a[20:23], v[152:167]
 s_add_u32 s38, s77, 331776
 s_add_u32 m0, s78, 28672
 s_nop 0
 buffer_load_dwordx4 v1, s[4:7], s38 offen sc1 lds
 v_rcp_f32 v221, v221
 v_mfma_f32_32x32x16_bf16 v[168:183], v[68:71], a[164:167], v[168:183]
 v_rcp_f32 v222, v222
 ds_read_b128 v[64:67], v3 offset:22528
 s_waitcnt lgkmcnt(6)
 v_mfma_f32_32x32x16_bf16 v[152:167], v[72:75], a[24:27], v[152:167]
 s_add_u32 s38, s77, 335872
 s_add_u32 m0, s78, 32768
 s_nop 0
 buffer_load_dwordx4 v1, s[4:7], s38 offen sc1 lds
 v_rcp_f32 v223, v223
 v_mfma_f32_32x32x16_bf16 v[168:183], v[72:75], a[168:171], v[168:183]
 v_mul_f32 v224, v224, v216
 v_mul_f32 v225, v225, v217
 ds_read_b128 v[68:71], v3 offset:23552
 s_waitcnt lgkmcnt(6)
 v_mfma_f32_32x32x16_bf16 v[152:167], v[76:79], a[28:31], v[152:167]
 v_mul_f32 v226, v226, v218
 v_mul_f32 v227, v227, v219
 v_mul_f32 v228, v228, v220
 v_mul_f32 v229, v229, v221
 v_mul_f32 v230, v230, v222
 v_mul_f32 v231, v231, v223
 v_mfma_f32_32x32x16_bf16 v[168:183], v[76:79], a[172:175], v[168:183]
 v_cvt_pk_bf16_f32 v232, v224, v225
 v_cvt_pk_bf16_f32 v233, v226, v227
 ds_read_b128 v[72:75], v3 offset:24576
 s_waitcnt lgkmcnt(6)
 v_mfma_f32_32x32x16_bf16 v[152:167], v[80:83], a[32:35], v[152:167]
 s_add_u32 s38, s76, 339968
 s_mov_b32 m0, 36864
 s_nop 0
 buffer_load_dwordx4 v1, s[4:7], s38 offen sc1 lds
 v_cvt_pk_bf16_f32 v234, v228, v229
 v_cvt_pk_bf16_f32 v235, v230, v231
 v_mfma_f32_32x32x16_bf16 v[168:183], v[80:83], a[176:179], v[168:183]
 ds_read_b128 v[76:79], v3 offset:25600
 s_waitcnt lgkmcnt(6)
 v_mfma_f32_32x32x16_bf16 v[152:167], v[84:87], a[36:39], v[152:167]
 s_add_u32 s33, s31, 2048
 buffer_store_dwordx4 v[232:235], v5, s[4:7], s33 offen sc1
 v_mul_f32 v236, v104, v7
 v_mfma_f32_32x32x16_bf16 v[168:183], v[84:87], a[180:183], v[168:183]
 v_mul_f32 v237, v105, v7
 v_mul_f32 v238, v106, v7
 ds_read_b128 v[80:83], v3 offset:26624
 s_waitcnt lgkmcnt(6)
 v_mfma_f32_32x32x16_bf16 v[152:167], v[56:59], a[40:43], v[152:167]
 v_mul_f32 v239, v107, v7
 v_mul_f32 v240, v108, v7
 v_mul_f32 v241, v109, v7
 v_mul_f32 v242, v110, v7
 v_mul_f32 v243, v111, v7
 v_mfma_f32_32x32x16_bf16 v[168:183], v[56:59], a[184:187], v[168:183]
 v_exp_f32 v236, v236
 ds_read_b128 v[84:87], v3 offset:27648
 s_waitcnt lgkmcnt(6)
 v_mfma_f32_32x32x16_bf16 v[152:167], v[60:63], a[44:47], v[152:167]
 v_exp_f32 v237, v237
 v_exp_f32 v238, v238
 v_exp_f32 v239, v239
 v_mfma_f32_32x32x16_bf16 v[168:183], v[60:63], a[188:191], v[168:183]
 v_exp_f32 v240, v240
 ds_read_b128 v[56:59], v3 offset:28672
 s_waitcnt lgkmcnt(6)
 v_mfma_f32_32x32x16_bf16 v[152:167], v[64:67], a[48:51], v[152:167]
 v_exp_f32 v241, v241
 v_exp_f32 v242, v242
 v_exp_f32 v243, v243
 v_mfma_f32_32x32x16_bf16 v[168:183], v[64:67], a[192:195], v[168:183]
 v_mul_f32 v244, v104, v112
 v_mul_f32 v245, v105, v113
 ds_read_b128 v[60:63], v3 offset:29696
 s_waitcnt lgkmcnt(6)
 v_mfma_f32_32x32x16_bf16 v[152:167], v[68:71], a[52:55], v[152:167]
 v_mul_f32 v246, v106, v114
 v_mul_f32 v247, v107, v115
 v_mul_f32 v248, v108, v116
 v_mul_f32 v249, v109, v117
 v_mul_f32 v250, v110, v118
 v_mul_f32 v251, v111, v119
 v_mfma_f32_32x32x16_bf16 v[168:183], v[68:71], a[196:199], v[168:183]
 v_fma_f32 v236, v236, v9, v9
 v_fma_f32 v237, v237, v9, v9
 ds_read_b128 v[64:67], v3 offset:30720
 s_waitcnt lgkmcnt(6)
 v_mfma_f32_32x32x16_bf16 v[152:167], v[72:75], a[56:59], v[152:167]
 v_fma_f32 v238, v238, v9, v9
 v_fma_f32 v239, v239, v9, v9
 v_fma_f32 v240, v240, v9, v9
 v_fma_f32 v241, v241, v9, v9
 v_fma_f32 v242, v242, v9, v9
 v_fma_f32 v243, v243, v9, v9
 v_mfma_f32_32x32x16_bf16 v[168:183], v[72:75], a[200:203], v[168:183]
 v_rcp_f32 v236, v236
 ds_read_b128 v[68:71], v3 offset:31744
 s_waitcnt lgkmcnt(6)
 v_mfma_f32_32x32x16_bf16 v[152:167], v[76:79], a[60:63], v[152:167]
 v_rcp_f32 v237, v237
 v_rcp_f32 v238, v238
 v_rcp_f32 v239, v239
 v_mfma_f32_32x32x16_bf16 v[168:183], v[76:79], a[204:207], v[168:183]
 v_rcp_f32 v240, v240
 ds_read_b128 v[72:75], v3 offset:32768
 s_waitcnt lgkmcnt(6)
 v_mfma_f32_32x32x16_bf16 v[152:167], v[80:83], a[64:67], v[152:167]
 v_rcp_f32 v241, v241
 v_rcp_f32 v242, v242
 v_rcp_f32 v243, v243
 v_mfma_f32_32x32x16_bf16 v[168:183], v[80:83], a[208:211], v[168:183]
 v_mul_f32 v244, v244, v236
 v_mul_f32 v245, v245, v237
 ds_read_b128 v[76:79], v3 offset:33792
 s_waitcnt lgkmcnt(6)
 v_mfma_f32_32x32x16_bf16 v[152:167], v[84:87], a[68:71], v[152:167]
 v_mul_f32 v246, v246, v238
 v_mul_f32 v247, v247, v239
 v_mul_f32 v248, v248, v240
 v_mul_f32 v249, v249, v241
 v_mul_f32 v250, v250, v242
 v_mul_f32 v251, v251, v243
 v_mfma_f32_32x32x16_bf16 v[168:183], v[84:87], a[212:215], v[168:183]
 v_cvt_pk_bf16_f32 v252, v244, v245
 v_cvt_pk_bf16_f32 v253, v246, v247
 ds_read_b128 v[80:83], v3 offset:34816
 s_waitcnt lgkmcnt(6)
 v_mfma_f32_32x32x16_bf16 v[152:167], v[56:59], a[72:75], v[152:167]
 v_cvt_pk_bf16_f32 v254, v248, v249
 v_cvt_pk_bf16_f32 v255, v250, v251
 v_mfma_f32_32x32x16_bf16 v[168:183], v[56:59], a[216:219], v[168:183]
 ds_read_b128 v[84:87], v3 offset:35840
 s_waitcnt lgkmcnt(6)
 v_mfma_f32_32x32x16_bf16 v[152:167], v[60:63], a[76:79], v[152:167]
 s_add_u32 s33, s31, 296960
 buffer_store_dwordx4 v[252:255], v5, s[4:7], s33 offen sc1
 v_mul_f32 v216, v120, v6
 v_mfma_f32_32x32x16_bf16 v[168:183], v[60:63], a[220:223], v[168:183]
 v_mul_f32 v217, v121, v6
 v_mul_f32 v218, v122, v6
 ds_read_b128 v[56:59], v3 offset:36864
 s_waitcnt lgkmcnt(6)
 v_mfma_f32_32x32x16_bf16 v[152:167], v[64:67], a[80:83], v[152:167]
 v_mul_f32 v219, v123, v6
 v_mul_f32 v220, v124, v6
 v_mul_f32 v221, v125, v6
 v_mul_f32 v222, v126, v6
 v_mul_f32 v223, v127, v6
 v_mfma_f32_32x32x16_bf16 v[168:183], v[64:67], a[224:227], v[168:183]
 v_exp_f32 v216, v216
 ds_read_b128 v[60:63], v3 offset:37888
 s_waitcnt lgkmcnt(6)
 v_mfma_f32_32x32x16_bf16 v[152:167], v[68:71], a[84:87], v[152:167]
 v_exp_f32 v217, v217
 v_exp_f32 v218, v218
 v_exp_f32 v219, v219
 v_mfma_f32_32x32x16_bf16 v[168:183], v[68:71], a[228:231], v[168:183]
 v_exp_f32 v220, v220
 ds_read_b128 v[64:67], v3 offset:38912
 s_waitcnt lgkmcnt(6)
 v_mfma_f32_32x32x16_bf16 v[152:167], v[72:75], a[88:91], v[152:167]
 v_exp_f32 v221, v221
 v_exp_f32 v222, v222
 v_exp_f32 v223, v223
 v_mfma_f32_32x32x16_bf16 v[168:183], v[72:75], a[232:235], v[168:183]
 v_mul_f32 v224, v120, v128
 v_mul_f32 v225, v121, v129
 ds_read_b128 v[68:71], v3 offset:39936
 s_waitcnt lgkmcnt(6)
 v_mfma_f32_32x32x16_bf16 v[152:167], v[76:79], a[92:95], v[152:167]
 v_mul_f32 v226, v122, v130
 v_mul_f32 v227, v123, v131
 v_mul_f32 v228, v124, v132
 v_mul_f32 v229, v125, v133
 v_mul_f32 v230, v126, v134
 v_mul_f32 v231, v127, v135
 v_mfma_f32_32x32x16_bf16 v[168:183], v[76:79], a[236:239], v[168:183]
 v_fma_f32 v216, v216, v8, v8
 v_fma_f32 v217, v217, v8, v8
 ds_read_b128 v[72:75], v3 offset:40960
 s_waitcnt lgkmcnt(6)
 v_mfma_f32_32x32x16_bf16 v[152:167], v[80:83], a[96:99], v[152:167]
 v_fma_f32 v218, v218, v8, v8
 v_fma_f32 v219, v219, v8, v8
 v_fma_f32 v220, v220, v8, v8
 v_fma_f32 v221, v221, v8, v8
 v_fma_f32 v222, v222, v8, v8
 v_fma_f32 v223, v223, v8, v8
 v_mfma_f32_32x32x16_bf16 v[168:183], v[80:83], a[240:243], v[168:183]
 v_rcp_f32 v216, v216
 ds_read_b128 v[76:79], v3 offset:41984
 s_waitcnt lgkmcnt(6)
 v_mfma_f32_32x32x16_bf16 v[152:167], v[84:87], a[100:103], v[152:167]
 v_rcp_f32 v217, v217
 v_rcp_f32 v218, v218
 v_rcp_f32 v219, v219
 v_mfma_f32_32x32x16_bf16 v[168:183], v[84:87], a[244:247], v[168:183]
 v_rcp_f32 v220, v220
 ds_read_b128 v[80:83], v3 offset:43008
 s_waitcnt lgkmcnt(6)
 v_mfma_f32_32x32x16_bf16 v[152:167], v[56:59], a[104:107], v[152:167]
 v_rcp_f32 v221, v221
 v_rcp_f32 v222, v222
 v_rcp_f32 v223, v223
 v_mfma_f32_32x32x16_bf16 v[168:183], v[56:59], a[248:251], v[168:183]
 v_mul_f32 v224, v224, v216
 v_mul_f32 v225, v225, v217
 ds_read_b128 v[84:87], v3 offset:44032
 s_waitcnt lgkmcnt(6)
 v_mfma_f32_32x32x16_bf16 v[152:167], v[60:63], a[108:111], v[152:167]
 v_mul_f32 v226, v226, v218
 v_mul_f32 v227, v227, v219
 v_mul_f32 v228, v228, v220
 v_mul_f32 v229, v229, v221
 v_mul_f32 v230, v230, v222
 v_mul_f32 v231, v231, v223
 v_mfma_f32_32x32x16_bf16 v[168:183], v[60:63], a[252:255], v[168:183]
 v_cvt_pk_bf16_f32 v232, v224, v225
 v_cvt_pk_bf16_f32 v233, v226, v227
 ds_read_b128 v[56:59], v3 offset:45056
 s_waitcnt lgkmcnt(6)
 v_mfma_f32_32x32x16_bf16 v[152:167], v[64:67], a[112:115], v[152:167]
 v_cvt_pk_bf16_f32 v234, v228, v229
 v_cvt_pk_bf16_f32 v235, v230, v231
 v_mfma_f32_32x32x16_bf16 v[168:183], v[64:67], v[24:27], v[168:183]
 ds_read_b128 v[60:63], v3 offset:46080
 s_waitcnt lgkmcnt(6)
 v_mfma_f32_32x32x16_bf16 v[152:167], v[68:71], a[116:119], v[152:167]
 s_add_u32 s33, s31, 2560
 buffer_store_dwordx4 v[232:235], v5, s[4:7], s33 offen sc1
 v_mul_f32 v236, v136, v7
 v_mfma_f32_32x32x16_bf16 v[168:183], v[68:71], v[28:31], v[168:183]
 v_mul_f32 v237, v137, v7
 v_mul_f32 v238, v138, v7
 ds_read_b128 v[64:67], v3 offset:47104
 s_waitcnt lgkmcnt(6)
 v_mfma_f32_32x32x16_bf16 v[152:167], v[72:75], a[120:123], v[152:167]
 v_mul_f32 v239, v139, v7
 v_mul_f32 v240, v140, v7
 v_mul_f32 v241, v141, v7
 v_mul_f32 v242, v142, v7
 v_mul_f32 v243, v143, v7
 v_mfma_f32_32x32x16_bf16 v[168:183], v[72:75], v[32:35], v[168:183]
 s_waitcnt vmcnt(16)
 s_barrier
 ds_read_b128 v[68:71], v3 offset:48128
 s_waitcnt lgkmcnt(6)
 v_mfma_f32_32x32x16_bf16 v[152:167], v[76:79], a[124:127], v[152:167]
 v_exp_f32 v236, v236
 v_exp_f32 v237, v237
 v_exp_f32 v238, v238
 v_mfma_f32_32x32x16_bf16 v[168:183], v[76:79], v[36:39], v[168:183]
 v_exp_f32 v239, v239
 ds_read_b128 v[72:75], v3 offset:49152
 s_waitcnt lgkmcnt(6)
 v_mfma_f32_32x32x16_bf16 v[152:167], v[80:83], a[128:131], v[152:167]
 v_exp_f32 v240, v240
 v_exp_f32 v241, v241
 v_exp_f32 v242, v242
 v_mfma_f32_32x32x16_bf16 v[168:183], v[80:83], v[40:43], v[168:183]
 v_exp_f32 v243, v243
 ds_read_b128 v[76:79], v3 offset:50176
 s_waitcnt lgkmcnt(6)
 v_mfma_f32_32x32x16_bf16 v[152:167], v[84:87], a[132:135], v[152:167]
 v_mul_f32 v244, v136, v144
 v_mul_f32 v245, v137, v145
 v_mul_f32 v246, v138, v146
 v_mul_f32 v247, v139, v147
 v_mul_f32 v248, v140, v148
 v_mul_f32 v249, v141, v149
 v_mfma_f32_32x32x16_bf16 v[168:183], v[84:87], v[44:47], v[168:183]
 v_mul_f32 v250, v142, v150
 v_mul_f32 v251, v143, v151
 ds_read_b128 v[80:83], v3 offset:51200
 s_waitcnt lgkmcnt(6)
 v_mfma_f32_32x32x16_bf16 v[152:167], v[56:59], a[136:139], v[152:167]
 v_fma_f32 v236, v236, v9, v9
 v_fma_f32 v237, v237, v9, v9
 v_fma_f32 v238, v238, v9, v9
 v_fma_f32 v239, v239, v9, v9
 v_fma_f32 v240, v240, v9, v9
 v_fma_f32 v241, v241, v9, v9
 v_mfma_f32_32x32x16_bf16 v[168:183], v[56:59], v[48:51], v[168:183]
 v_fma_f32 v242, v242, v9, v9
 v_fma_f32 v243, v243, v9, v9
 ds_read_b128 v[84:87], v3 offset:52224
 s_waitcnt lgkmcnt(6)
 v_mfma_f32_32x32x16_bf16 v[152:167], v[60:63], a[140:143], v[152:167]
 v_rcp_f32 v236, v236
 v_rcp_f32 v237, v237
 v_rcp_f32 v238, v238
 v_mfma_f32_32x32x16_bf16 v[168:183], v[60:63], v[52:55], v[168:183]
 v_rcp_f32 v239, v239
 ds_read_b128 v[56:59], v3 offset:53248
 s_waitcnt lgkmcnt(6)
 v_mfma_f32_32x32x16_bf16 v[152:167], v[64:67], v[16:19], v[152:167]
 v_rcp_f32 v240, v240
 v_rcp_f32 v241, v241
 v_rcp_f32 v242, v242
 v_mfma_f32_32x32x16_bf16 v[168:183], v[64:67], v[20:23], v[168:183]
 v_rcp_f32 v243, v243
 ds_read_b128 v[60:63], v3 offset:54272
 s_waitcnt lgkmcnt(6)
 v_mfma_f32_32x32x16_bf16 v[184:199], v[68:71], a[0:3], 0
 v_mfma_f32_32x32x16_bf16 v[200:215], v[68:71], a[144:147], 0
 ds_read_b128 v[64:67], v3 offset:55296
 s_waitcnt lgkmcnt(6)
 v_mfma_f32_32x32x16_bf16 v[184:199], v[72:75], a[4:7], v[184:199]
 v_mfma_f32_32x32x16_bf16 v[200:215], v[72:75], a[148:151], v[200:215]
 v_mul_f32 v244, v244, v236
 v_mul_f32 v245, v245, v237
 ds_read_b128 v[68:71], v3 offset:56320
 s_waitcnt lgkmcnt(6)
 v_mfma_f32_32x32x16_bf16 v[184:199], v[76:79], a[8:11], v[184:199]
 v_mul_f32 v246, v246, v238
 v_mul_f32 v247, v247, v239
 v_mul_f32 v248, v248, v240
 v_mul_f32 v249, v249, v241
 v_mul_f32 v250, v250, v242
 v_mul_f32 v251, v251, v243
 v_mfma_f32_32x32x16_bf16 v[200:215], v[76:79], a[152:155], v[200:215]
 v_cvt_pk_bf16_f32 v252, v244, v245
 v_cvt_pk_bf16_f32 v253, v246, v247
 ds_read_b128 v[72:75], v3 offset:57344
 s_waitcnt lgkmcnt(6)
 v_mfma_f32_32x32x16_bf16 v[184:199], v[80:83], a[12:15], v[184:199]
 v_cvt_pk_bf16_f32 v254, v248, v249
 v_cvt_pk_bf16_f32 v255, v250, v251
 v_mfma_f32_32x32x16_bf16 v[200:215], v[80:83], a[156:159], v[200:215]
 ds_read_b128 v[76:79], v3 offset:58368
 s_waitcnt lgkmcnt(6)
 v_mfma_f32_32x32x16_bf16 v[184:199], v[84:87], a[16:19], v[184:199]
 s_add_u32 s33, s31, 297472
 buffer_store_dwordx4 v[252:255], v5, s[4:7], s33 offen sc1
 v_mul_f32 v216, v152, v6
 v_mfma_f32_32x32x16_bf16 v[200:215], v[84:87], a[160:163], v[200:215]
 v_mul_f32 v217, v153, v6
 v_mul_f32 v218, v154, v6
 ds_read_b128 v[80:83], v3 offset:59392
 s_waitcnt lgkmcnt(6)
 v_mfma_f32_32x32x16_bf16 v[184:199], v[56:59], a[20:23], v[184:199]
 v_mul_f32 v219, v155, v6
 v_mul_f32 v220, v156, v6
 v_mul_f32 v221, v157, v6
 v_mul_f32 v222, v158, v6
 v_mul_f32 v223, v159, v6
 v_mfma_f32_32x32x16_bf16 v[200:215], v[56:59], a[164:167], v[200:215]
 v_exp_f32 v216, v216
 ds_read_b128 v[84:87], v3 offset:60416
 s_waitcnt lgkmcnt(6)
 v_mfma_f32_32x32x16_bf16 v[184:199], v[60:63], a[24:27], v[184:199]
 v_exp_f32 v217, v217
 v_exp_f32 v218, v218
 v_exp_f32 v219, v219
 v_mfma_f32_32x32x16_bf16 v[200:215], v[60:63], a[168:171], v[200:215]
 v_exp_f32 v220, v220
 ds_read_b128 v[56:59], v3 offset:61440
 s_waitcnt lgkmcnt(6)
 v_mfma_f32_32x32x16_bf16 v[184:199], v[64:67], a[28:31], v[184:199]
 v_exp_f32 v221, v221
 v_exp_f32 v222, v222
 v_exp_f32 v223, v223
 v_mfma_f32_32x32x16_bf16 v[200:215], v[64:67], a[172:175], v[200:215]
 v_mul_f32 v224, v152, v160
 v_mul_f32 v225, v153, v161
 ds_read_b128 v[60:63], v3 offset:62464
 s_waitcnt lgkmcnt(6)
 v_mfma_f32_32x32x16_bf16 v[184:199], v[68:71], a[32:35], v[184:199]
 v_mul_f32 v226, v154, v162
 v_mul_f32 v227, v155, v163
 v_mul_f32 v228, v156, v164
 v_mul_f32 v229, v157, v165
 v_mul_f32 v230, v158, v166
 v_mul_f32 v231, v159, v167
 v_mfma_f32_32x32x16_bf16 v[200:215], v[68:71], a[176:179], v[200:215]
 v_fma_f32 v216, v216, v8, v8
 v_fma_f32 v217, v217, v8, v8
 ds_read_b128 v[64:67], v3 offset:63488
 s_waitcnt lgkmcnt(6)
 v_mfma_f32_32x32x16_bf16 v[184:199], v[72:75], a[36:39], v[184:199]
 v_fma_f32 v218, v218, v8, v8
 v_fma_f32 v219, v219, v8, v8
 v_fma_f32 v220, v220, v8, v8
 v_fma_f32 v221, v221, v8, v8
 v_fma_f32 v222, v222, v8, v8
 v_fma_f32 v223, v223, v8, v8
 v_mfma_f32_32x32x16_bf16 v[200:215], v[72:75], a[180:183], v[200:215]
 v_rcp_f32 v216, v216
 ds_read_b128 v[68:71], v3 offset:64512
 s_waitcnt lgkmcnt(6)
 v_mfma_f32_32x32x16_bf16 v[184:199], v[76:79], a[40:43], v[184:199]
 v_rcp_f32 v217, v217
 v_rcp_f32 v218, v218
 v_rcp_f32 v219, v219
 v_mfma_f32_32x32x16_bf16 v[200:215], v[76:79], a[184:187], v[200:215]
 v_rcp_f32 v220, v220
 ds_read_b128 v[72:75], v4 offset:0
 s_waitcnt lgkmcnt(6)
 v_mfma_f32_32x32x16_bf16 v[184:199], v[80:83], a[44:47], v[184:199]
 v_rcp_f32 v221, v221
 v_rcp_f32 v222, v222
 v_rcp_f32 v223, v223
 v_mfma_f32_32x32x16_bf16 v[200:215], v[80:83], a[188:191], v[200:215]
 v_mul_f32 v224, v224, v216
 v_mul_f32 v225, v225, v217
 ds_read_b128 v[76:79], v4 offset:1024
 s_waitcnt lgkmcnt(6)
 v_mfma_f32_32x32x16_bf16 v[184:199], v[84:87], a[48:51], v[184:199]
 v_mul_f32 v226, v226, v218
 v_mul_f32 v227, v227, v219
 v_mul_f32 v228, v228, v220
 v_mul_f32 v229, v229, v221
 v_mul_f32 v230, v230, v222
 v_mul_f32 v231, v231, v223
 v_mfma_f32_32x32x16_bf16 v[200:215], v[84:87], a[192:195], v[200:215]
 v_cvt_pk_bf16_f32 v232, v224, v225
 v_cvt_pk_bf16_f32 v233, v226, v227
 ds_read_b128 v[80:83], v4 offset:2048
 s_waitcnt lgkmcnt(6)
 v_mfma_f32_32x32x16_bf16 v[184:199], v[56:59], a[52:55], v[184:199]
 v_cvt_pk_bf16_f32 v234, v228, v229
 v_cvt_pk_bf16_f32 v235, v230, v231
 v_mfma_f32_32x32x16_bf16 v[200:215], v[56:59], a[196:199], v[200:215]
 ds_read_b128 v[84:87], v4 offset:3072
 s_waitcnt lgkmcnt(6)
 v_mfma_f32_32x32x16_bf16 v[184:199], v[60:63], a[56:59], v[184:199]
 s_add_u32 s33, s31, 3072
 buffer_store_dwordx4 v[232:235], v5, s[4:7], s33 offen sc1
 v_mul_f32 v236, v168, v7
 v_mfma_f32_32x32x16_bf16 v[200:215], v[60:63], a[200:203], v[200:215]
 v_mul_f32 v237, v169, v7
 v_mul_f32 v238, v170, v7
 ds_read_b128 v[56:59], v4 offset:4096
 s_waitcnt lgkmcnt(6)
 v_mfma_f32_32x32x16_bf16 v[184:199], v[64:67], a[60:63], v[184:199]
 v_mul_f32 v239, v171, v7
 v_mul_f32 v240, v172, v7
 v_mul_f32 v241, v173, v7
 v_mul_f32 v242, v174, v7
 v_mul_f32 v243, v175, v7
 v_mfma_f32_32x32x16_bf16 v[200:215], v[64:67], a[204:207], v[200:215]
 v_exp_f32 v236, v236
 ds_read_b128 v[60:63], v4 offset:5120
 s_waitcnt lgkmcnt(6)
 v_mfma_f32_32x32x16_bf16 v[184:199], v[68:71], a[64:67], v[184:199]
 v_exp_f32 v237, v237
 v_exp_f32 v238, v238
 v_exp_f32 v239, v239
 v_mfma_f32_32x32x16_bf16 v[200:215], v[68:71], a[208:211], v[200:215]
 v_exp_f32 v240, v240
 ds_read_b128 v[64:67], v4 offset:6144
 s_waitcnt lgkmcnt(6)
 v_mfma_f32_32x32x16_bf16 v[184:199], v[72:75], a[68:71], v[184:199]
 v_exp_f32 v241, v241
 v_exp_f32 v242, v242
 v_exp_f32 v243, v243
 v_mfma_f32_32x32x16_bf16 v[200:215], v[72:75], a[212:215], v[200:215]
 v_mul_f32 v244, v168, v176
 v_mul_f32 v245, v169, v177
 ds_read_b128 v[68:71], v4 offset:7168
 s_waitcnt lgkmcnt(6)
 v_mfma_f32_32x32x16_bf16 v[184:199], v[76:79], a[72:75], v[184:199]
 v_mul_f32 v246, v170, v178
 v_mul_f32 v247, v171, v179
 v_mul_f32 v248, v172, v180
 v_mul_f32 v249, v173, v181
 v_mul_f32 v250, v174, v182
 v_mul_f32 v251, v175, v183
 v_mfma_f32_32x32x16_bf16 v[200:215], v[76:79], a[216:219], v[200:215]
 v_fma_f32 v236, v236, v9, v9
 v_fma_f32 v237, v237, v9, v9
 ds_read_b128 v[72:75], v4 offset:8192
 s_waitcnt lgkmcnt(6)
 v_mfma_f32_32x32x16_bf16 v[184:199], v[80:83], a[76:79], v[184:199]
 v_fma_f32 v238, v238, v9, v9
 v_fma_f32 v239, v239, v9, v9
 v_fma_f32 v240, v240, v9, v9
 v_fma_f32 v241, v241, v9, v9
 v_fma_f32 v242, v242, v9, v9
 v_fma_f32 v243, v243, v9, v9
 v_mfma_f32_32x32x16_bf16 v[200:215], v[80:83], a[220:223], v[200:215]
 v_rcp_f32 v236, v236
 ds_read_b128 v[76:79], v4 offset:9216
 s_waitcnt lgkmcnt(6)
 v_mfma_f32_32x32x16_bf16 v[184:199], v[84:87], a[80:83], v[184:199]
 v_rcp_f32 v237, v237
 v_rcp_f32 v238, v238
 v_rcp_f32 v239, v239
 v_mfma_f32_32x32x16_bf16 v[200:215], v[84:87], a[224:227], v[200:215]
 v_rcp_f32 v240, v240
 ds_read_b128 v[80:83], v4 offset:10240
 s_waitcnt lgkmcnt(6)
 v_mfma_f32_32x32x16_bf16 v[184:199], v[56:59], a[84:87], v[184:199]
 v_rcp_f32 v241, v241
 v_rcp_f32 v242, v242
 v_rcp_f32 v243, v243
 v_mfma_f32_32x32x16_bf16 v[200:215], v[56:59], a[228:231], v[200:215]
 v_mul_f32 v244, v244, v236
 v_mul_f32 v245, v245, v237
 ds_read_b128 v[84:87], v4 offset:11264
 s_waitcnt lgkmcnt(6)
 v_mfma_f32_32x32x16_bf16 v[184:199], v[60:63], a[88:91], v[184:199]
 v_mul_f32 v246, v246, v238
 v_mul_f32 v247, v247, v239
 v_mul_f32 v248, v248, v240
 v_mul_f32 v249, v249, v241
 v_mul_f32 v250, v250, v242
 v_mul_f32 v251, v251, v243
 v_mfma_f32_32x32x16_bf16 v[200:215], v[60:63], a[232:235], v[200:215]
 v_cvt_pk_bf16_f32 v252, v244, v245
 v_cvt_pk_bf16_f32 v253, v246, v247
 ds_read_b128 v[56:59], v4 offset:12288
 s_waitcnt lgkmcnt(6)
 v_mfma_f32_32x32x16_bf16 v[184:199], v[64:67], a[92:95], v[184:199]
 v_cvt_pk_bf16_f32 v254, v248, v249
 v_cvt_pk_bf16_f32 v255, v250, v251
 v_mfma_f32_32x32x16_bf16 v[200:215], v[64:67], a[236:239], v[200:215]
 ds_read_b128 v[60:63], v4 offset:13312
 s_waitcnt lgkmcnt(6)
 v_mfma_f32_32x32x16_bf16 v[184:199], v[68:71], a[96:99], v[184:199]
 s_add_u32 s33, s31, 297984
 buffer_store_dwordx4 v[252:255], v5, s[4:7], s33 offen sc1
 v_mfma_f32_32x32x16_bf16 v[200:215], v[68:71], a[240:243], v[200:215]
 ds_read_b128 v[64:67], v4 offset:14336
 s_waitcnt lgkmcnt(6)
 v_mfma_f32_32x32x16_bf16 v[184:199], v[72:75], a[100:103], v[184:199]
 v_mfma_f32_32x32x16_bf16 v[200:215], v[72:75], a[244:247], v[200:215]
 ds_read_b128 v[68:71], v4 offset:15360
 s_waitcnt lgkmcnt(6)
 v_mfma_f32_32x32x16_bf16 v[184:199], v[76:79], a[104:107], v[184:199]
 v_mfma_f32_32x32x16_bf16 v[200:215], v[76:79], a[248:251], v[200:215]
 ds_read_b128 v[72:75], v4 offset:16384
 s_waitcnt lgkmcnt(6)
 v_mfma_f32_32x32x16_bf16 v[184:199], v[80:83], a[108:111], v[184:199]
 v_mfma_f32_32x32x16_bf16 v[200:215], v[80:83], a[252:255], v[200:215]
 ds_read_b128 v[76:79], v4 offset:17408
 s_waitcnt lgkmcnt(6)
 v_mfma_f32_32x32x16_bf16 v[184:199], v[84:87], a[112:115], v[184:199]
 v_mfma_f32_32x32x16_bf16 v[200:215], v[84:87], v[24:27], v[200:215]
 ds_read_b128 v[80:83], v4 offset:18432
 s_waitcnt lgkmcnt(6)
 v_mfma_f32_32x32x16_bf16 v[184:199], v[56:59], a[116:119], v[184:199]
 v_mfma_f32_32x32x16_bf16 v[200:215], v[56:59], v[28:31], v[200:215]
 ds_read_b128 v[84:87], v4 offset:19456
 s_waitcnt lgkmcnt(6)
 v_mfma_f32_32x32x16_bf16 v[184:199], v[60:63], a[120:123], v[184:199]
 v_mfma_f32_32x32x16_bf16 v[200:215], v[60:63], v[32:35], v[200:215]
 s_waitcnt vmcnt(6)
 s_waitcnt vmcnt(2)
 s_barrier
 s_cmp_lg_u32 s3, 0
 s_cbranch_scc1 SIG3
 s_mov_b64 exec, 1
 v_mov_b32 v14, 0
 v_mov_b32 v15, 1
 s_lshl_b32 s38, s13, 5
 s_add_u32 s38, s38, 9961472
 buffer_store_dword v15, v14, s[4:7], s38 offen sc1
 s_mov_b64 exec, -1
SIG3:
 v_and_b32 v14, 7, v0
 v_lshlrev_b32 v14, 7, v14
 ds_read_b128 v[56:59], v2 offset:0
 s_waitcnt lgkmcnt(6)
 v_mfma_f32_32x32x16_bf16 v[184:199], v[64:67], a[124:127], v[184:199]
 v_mfma_f32_32x32x16_bf16 v[200:215], v[64:67], v[36:39], v[200:215]
 ds_read_b128 v[60:63], v2 offset:1024
 s_waitcnt lgkmcnt(6)
 v_mfma_f32_32x32x16_bf16 v[184:199], v[68:71], a[128:131], v[184:199]
 v_mfma_f32_32x32x16_bf16 v[200:215], v[68:71], v[40:43], v[200:215]
 ds_read_b128 v[64:67], v2 offset:2048
 s_waitcnt lgkmcnt(6)
 v_mfma_f32_32x32x16_bf16 v[184:199], v[72:75], a[132:135], v[184:199]
 v_mfma_f32_32x32x16_bf16 v[200:215], v[72:75], v[44:47], v[200:215]
 ds_read_b128 v[68:71], v2 offset:3072
 s_waitcnt lgkmcnt(6)
 v_mfma_f32_32x32x16_bf16 v[184:199], v[76:79], a[136:139], v[184:199]
 v_mfma_f32_32x32x16_bf16 v[200:215], v[76:79], v[48:51], v[200:215]
 ds_read_b128 v[72:75], v2 offset:4096
 s_waitcnt lgkmcnt(6)
 v_mfma_f32_32x32x16_bf16 v[184:199], v[80:83], a[140:143], v[184:199]
 v_mfma_f32_32x32x16_bf16 v[200:215], v[80:83], v[52:55], v[200:215]
 ds_read_b128 v[76:79], v2 offset:5120
 s_waitcnt lgkmcnt(6)
 v_mfma_f32_32x32x16_bf16 v[184:199], v[84:87], v[16:19], v[184:199]
 v_mfma_f32_32x32x16_bf16 v[200:215], v[84:87], v[20:23], v[200:215]
 ds_read_b128 v[80:83], v2 offset:6144
 s_waitcnt lgkmcnt(6)
 v_mfma_f32_32x32x16_bf16 v[88:103], v[56:59], a[0:3], 0
 s_add_u32 s38, s79, 0
 s_add_u32 m0, s83, 37888
 s_nop 0
 buffer_load_dwordx4 v1, s[4:7], s38 offen sc1 lds
 v_mfma_f32_32x32x16_bf16 v[104:119], v[56:59], a[144:147], 0
 ds_read_b128 v[84:87], v2 offset:7168
 s_waitcnt lgkmcnt(6)
 v_mfma_f32_32x32x16_bf16 v[88:103], v[60:63], a[4:7], v[88:103]
 s_add_u32 s38, s79, 147456
 s_add_u32 m0, s83, 38912
 s_nop 0
 buffer_load_dwordx4 v1, s[4:7], s38 offen sc1 lds
 v_mfma_f32_32x32x16_bf16 v[104:119], v[60:63], a[148:151], v[104:119]
 v_mul_f32 v216, v184, v6
 v_mul_f32 v217, v185, v6
 ds_read_b128 v[56:59], v2 offset:8192
 s_waitcnt lgkmcnt(6)
 v_mfma_f32_32x32x16_bf16 v[88:103], v[64:67], a[8:11], v[88:103]
 s_add_u32 s38, s79, 294912
 s_add_u32 m0, s83, 39936
 s_nop 0
 buffer_load_dwordx4 v1, s[4:7], s38 offen sc1 lds
 v_mul_f32 v218, v186, v6
 v_mul_f32 v219, v187, v6
 v_mfma_f32_32x32x16_bf16 v[104:119], v[64:67], a[152:155], v[104:119]
 v_mul_f32 v220, v188, v6
 v_mul_f32 v221, v189, v6
 ds_read_b128 v[60:63], v2 offset:9216
 s_waitcnt lgkmcnt(6)
 v_mfma_f32_32x32x16_bf16 v[88:103], v[68:71], a[12:15], v[88:103]
 s_add_u32 s38, s79, 442368
 s_add_u32 m0, s83, 40960
 s_nop 0
 buffer_load_dwordx4 v1, s[4:7], s38 offen sc1 lds
 v_mul_f32 v222, v190, v6
 v_mul_f32 v223, v191, v6
 v_mfma_f32_32x32x16_bf16 v[104:119], v[68:71], a[156:159], v[104:119]
 v_exp_f32 v216, v216
 ds_read_b128 v[64:67], v2 offset:10240
 s_waitcnt lgkmcnt(6)
 v_mfma_f32_32x32x16_bf16 v[88:103], v[72:75], a[16:19], v[88:103]
 s_add_u32 s38, s79, 589824
 s_add_u32 m0, s83, 41984
 s_nop 0
 buffer_load_dwordx4 v1, s[4:7], s38 offen sc1 lds
 v_exp_f32 v217, v217
 v_mfma_f32_32x32x16_bf16 v[104:119], v[72:75], a[160:163], v[104:119]
 s_barrier
 ds_read_b128 v[68:71], v2 offset:11264
 s_waitcnt lgkmcnt(6)
 v_mfma_f32_32x32x16_bf16 v[88:103], v[76:79], a[20:23], v[88:103]
 s_add_u32 s38, s19, 737280
 s_add_u32 m0, s83, 43008
 s_nop 0
 buffer_load_dwordx4 v1, s[4:7], s38 offen sc1 lds
 v_exp_f32 v218, v218
 v_mfma_f32_32x32x16_bf16 v[104:119], v[76:79], a[164:167], v[104:119]
 v_exp_f32 v219, v219
 ds_read_b128 v[72:75], v2 offset:12288
 s_waitcnt lgkmcnt(6)
 v_mfma_f32_32x32x16_bf16 v[88:103], v[80:83], a[24:27], v[88:103]
 s_add_u32 s38, s19, 884736
 s_add_u32 m0, s83, 44032
 s_nop 0
 buffer_load_dwordx4 v1, s[4:7], s38 offen sc1 lds
 v_exp_f32 v220, v220
 v_mfma_f32_32x32x16_bf16 v[104:119], v[80:83], a[168:171], v[104:119]
 v_exp_f32 v221, v221
 ds_read_b128 v[76:79], v2 offset:13312
 s_waitcnt lgkmcnt(6)
 v_mfma_f32_32x32x16_bf16 v[88:103], v[84:87], a[28:31], v[88:103]
 s_add_u32 s38, s79, 1024
 s_add_u32 m0, s83, 66560
 s_nop 0
 buffer_load_dwordx4 v1, s[4:7], s38 offen sc1 lds
 v_exp_f32 v222, v222
 v_mfma_f32_32x32x16_bf16 v[104:119], v[84:87], a[172:175], v[104:119]
 v_exp_f32 v223, v223
 ds_read_b128 v[80:83], v2 offset:14336
 s_waitcnt lgkmcnt(6)
 v_mfma_f32_32x32x16_bf16 v[88:103], v[56:59], a[32:35], v[88:103]
 s_add_u32 s38, s79, 148480
 s_add_u32 m0, s83, 67584
 s_nop 0
 buffer_load_dwordx4 v1, s[4:7], s38 offen sc1 lds
 v_mul_f32 v224, v184, v192
 v_mul_f32 v225, v185, v193
 v_mfma_f32_32x32x16_bf16 v[104:119], v[56:59], a[176:179], v[104:119]
 v_mul_f32 v226, v186, v194
 v_mul_f32 v227, v187, v195
 ds_read_b128 v[84:87], v2 offset:15360
 s_waitcnt lgkmcnt(6)
 v_mfma_f32_32x32x16_bf16 v[88:103], v[60:63], a[36:39], v[88:103]
 s_add_u32 s38, s79, 295936
 s_add_u32 m0, s83, 68608
 s_nop 0
 buffer_load_dwordx4 v1, s[4:7], s38 offen sc1 lds
 v_mul_f32 v228, v188, v196
 v_mul_f32 v229, v189, v197
 v_mfma_f32_32x32x16_bf16 v[104:119], v[60:63], a[180:183], v[104:119]
 v_mul_f32 v230, v190, v198
 v_mul_f32 v231, v191, v199
 ds_read_b128 v[56:59], v2 offset:16384
 s_waitcnt lgkmcnt(6)
 v_mfma_f32_32x32x16_bf16 v[88:103], v[64:67], a[40:43], v[88:103]
 s_add_u32 s38, s79, 443392
 s_add_u32 m0, s83, 69632
 s_nop 0
 buffer_load_dwordx4 v1, s[4:7], s38 offen sc1 lds
 v_fma_f32 v216, v216, v8, v8
 v_fma_f32 v217, v217, v8, v8
 v_mfma_f32_32x32x16_bf16 v[104:119], v[64:67], a[184:187], v[104:119]
 v_fma_f32 v218, v218, v8, v8
 v_fma_f32 v219, v219, v8, v8
 ds_read_b128 v[60:63], v2 offset:17408
 s_waitcnt lgkmcnt(6)
 v_mfma_f32_32x32x16_bf16 v[88:103], v[68:71], a[44:47], v[88:103]
 s_add_u32 s38, s79, 590848
 s_add_u32 m0, s83, 70656
 s_nop 0
 buffer_load_dwordx4 v1, s[4:7], s38 offen sc1 lds
 v_fma_f32 v220, v220, v8, v8
 v_fma_f32 v221, v221, v8, v8
 v_mfma_f32_32x32x16_bf16 v[104:119], v[68:71], a[188:191], v[104:119]
 v_fma_f32 v222, v222, v8, v8
 v_fma_f32 v223, v223, v8, v8
 ds_read_b128 v[64:67], v2 offset:18432
 s_waitcnt lgkmcnt(6)
 v_mfma_f32_32x32x16_bf16 v[88:103], v[72:75], a[48:51], v[88:103]
 s_add_u32 s38, s19, 738304
 s_add_u32 m0, s83, 71680
 s_nop 0
 buffer_load_dwordx4 v1, s[4:7], s38 offen sc1 lds
 v_rcp_f32 v216, v216
 v_mfma_f32_32x32x16_bf16 v[104:119], v[72:75], a[192:195], v[104:119]
 v_rcp_f32 v217, v217
 ds_read_b128 v[68:71], v2 offset:19456
 s_waitcnt lgkmcnt(6)
 v_mfma_f32_32x32x16_bf16 v[88:103], v[76:79], a[52:55], v[88:103]
 s_add_u32 s38, s19, 885760
 s_add_u32 m0, s83, 72704
 s_nop 0
 buffer_load_dwordx4 v1, s[4:7], s38 offen sc1 lds
 v_rcp_f32 v218, v218
 v_mfma_f32_32x32x16_bf16 v[104:119], v[76:79], a[196:199], v[104:119]
 v_rcp_f32 v219, v219
 ds_read_b128 v[72:75], v2 offset:20480
 s_waitcnt lgkmcnt(6)
 v_mfma_f32_32x32x16_bf16 v[88:103], v[80:83], a[56:59], v[88:103]
 s_add_u32 s38, s79, 2048
 s_add_u32 m0, s83, 95232
 s_nop 0
 buffer_load_dwordx4 v1, s[4:7], s38 offen sc1 lds
 v_rcp_f32 v220, v220
 v_mfma_f32_32x32x16_bf16 v[104:119], v[80:83], a[200:203], v[104:119]
 v_rcp_f32 v221, v221
 ds_read_b128 v[76:79], v2 offset:21504
 s_waitcnt lgkmcnt(6)
 v_mfma_f32_32x32x16_bf16 v[88:103], v[84:87], a[60:63], v[88:103]
 s_add_u32 s38, s79, 149504
 s_add_u32 m0, s83, 96256
 s_nop 0
 buffer_load_dwordx4 v1, s[4:7], s38 offen sc1 lds
 v_rcp_f32 v222, v222
 v_mfma_f32_32x32x16_bf16 v[104:119], v[84:87], a[204:207], v[104:119]
 v_rcp_f32 v223, v223
 ds_read_b128 v[80:83], v2 offset:22528
 s_waitcnt lgkmcnt(6)
 v_mfma_f32_32x32x16_bf16 v[88:103], v[56:59], a[64:67], v[88:103]
 s_add_u32 s38, s79, 296960
 s_add_u32 m0, s83, 97280
 s_nop 0
 buffer_load_dwordx4 v1, s[4:7], s38 offen sc1 lds
 v_mul_f32 v224, v224, v216
 v_mul_f32 v225, v225, v217
 v_mfma_f32_32x32x16_bf16 v[104:119], v[56:59], a[208:211], v[104:119]
 v_mul_f32 v226, v226, v218
 v_mul_f32 v227, v227, v219
 ds_read_b128 v[84:87], v2 offset:23552
 s_waitcnt lgkmcnt(6)
 v_mfma_f32_32x32x16_bf16 v[88:103], v[60:63], a[68:71], v[88:103]
 s_add_u32 s38, s79, 444416
 s_add_u32 m0, s83, 98304
 s_nop 0
 buffer_load_dwordx4 v1, s[4:7], s38 offen sc1 lds
 v_mul_f32 v228, v228, v220
 v_mul_f32 v229, v229, v221
 v_mfma_f32_32x32x16_bf16 v[104:119], v[60:63], a[212:215], v[104:119]
 v_mul_f32 v230, v230, v222
 v_mul_f32 v231, v231, v223
 ds_read_b128 v[56:59], v2 offset:24576
 s_waitcnt lgkmcnt(6)
 v_mfma_f32_32x32x16_bf16 v[88:103], v[64:67], a[72:75], v[88:103]
 s_add_u32 s38, s79, 591872
 s_add_u32 m0, s83, 99328
 s_nop 0
 buffer_load_dwordx4 v1, s[4:7], s38 offen sc1 lds
 v_cvt_pk_bf16_f32 v232, v224, v225
 v_cvt_pk_bf16_f32 v233, v226, v227
 v_mfma_f32_32x32x16_bf16 v[104:119], v[64:67], a[216:219], v[104:119]
 v_cvt_pk_bf16_f32 v234, v228, v229
 v_cvt_pk_bf16_f32 v235, v230, v231
 ds_read_b128 v[60:63], v2 offset:25600
 s_waitcnt lgkmcnt(6)
 v_mfma_f32_32x32x16_bf16 v[88:103], v[68:71], a[76:79], v[88:103]
 s_add_u32 s38, s19, 739328
 s_add_u32 m0, s83, 100352
 s_nop 0
 buffer_load_dwordx4 v1, s[4:7], s38 offen sc1 lds
 v_mfma_f32_32x32x16_bf16 v[104:119], v[68:71], a[220:223], v[104:119]
 ds_read_b128 v[64:67], v2 offset:26624
 s_waitcnt lgkmcnt(6)
 v_mfma_f32_32x32x16_bf16 v[88:103], v[72:75], a[80:83], v[88:103]
 s_add_u32 s38, s19, 886784
 s_add_u32 m0, s83, 101376
 s_nop 0
 buffer_load_dwordx4 v1, s[4:7], s38 offen sc1 lds
 v_mfma_f32_32x32x16_bf16 v[104:119], v[72:75], a[224:227], v[104:119]
 buffer_load_dword v15, v14, s[4:7], s15 offen sc1
 ds_read_b128 v[68:71], v2 offset:27648
 s_waitcnt lgkmcnt(6)
 v_mfma_f32_32x32x16_bf16 v[88:103], v[76:79], a[84:87], v[88:103]
 s_add_u32 s38, s79, 5120
 s_add_u32 m0, s83, 123904
 s_nop 0
 buffer_load_dwordx4 v1, s[4:7], s38 offen sc1 lds
 v_mfma_f32_32x32x16_bf16 v[104:119], v[76:79], a[228:231], v[104:119]
 ds_read_b128 v[72:75], v2 offset:28672
 s_waitcnt lgkmcnt(6)
 v_mfma_f32_32x32x16_bf16 v[88:103], v[80:83], a[88:91], v[88:103]
 s_add_u32 s38, s79, 152576
 s_add_u32 m0, s83, 124928
 s_nop 0
 buffer_load_dwordx4 v1, s[4:7], s38 offen sc1 lds
 v_mfma_f32_32x32x16_bf16 v[104:119], v[80:83], a[232:235], v[104:119]
 ds_read_b128 v[76:79], v2 offset:29696
 s_waitcnt lgkmcnt(6)
 v_mfma_f32_32x32x16_bf16 v[88:103], v[84:87], a[92:95], v[88:103]
 s_add_u32 s38, s79, 300032
 s_add_u32 m0, s83, 125952
 s_nop 0
 buffer_load_dwordx4 v1, s[4:7], s38 offen sc1 lds
 v_mfma_f32_32x32x16_bf16 v[104:119], v[84:87], a[236:239], v[104:119]
 ds_read_b128 v[80:83], v2 offset:30720
 s_waitcnt lgkmcnt(6)
 v_mfma_f32_32x32x16_bf16 v[88:103], v[56:59], a[96:99], v[88:103]
 s_add_u32 s38, s79, 447488
 s_add_u32 m0, s83, 126976
 s_nop 0
 buffer_load_dwordx4 v1, s[4:7], s38 offen sc1 lds
 v_mfma_f32_32x32x16_bf16 v[104:119], v[56:59], a[240:243], v[104:119]
 ds_read_b128 v[84:87], v2 offset:31744
 s_waitcnt lgkmcnt(6)
 v_mfma_f32_32x32x16_bf16 v[88:103], v[60:63], a[100:103], v[88:103]
 s_add_u32 s38, s79, 594944
 s_add_u32 m0, s83, 128000
 s_nop 0
 buffer_load_dwordx4 v1, s[4:7], s38 offen sc1 lds
 v_mfma_f32_32x32x16_bf16 v[104:119], v[60:63], a[244:247], v[104:119]
 ds_read_b128 v[56:59], v2 offset:32768
 s_waitcnt lgkmcnt(6)
 v_mfma_f32_32x32x16_bf16 v[88:103], v[64:67], a[104:107], v[88:103]
 s_add_u32 s38, s19, 742400
 s_add_u32 m0, s83, 129024
 s_nop 0
 buffer_load_dwordx4 v1, s[4:7], s38 offen sc1 lds
 v_mfma_f32_32x32x16_bf16 v[104:119], v[64:67], a[248:251], v[104:119]
 s_waitcnt vmcnt(6)
 v_cmp_eq_u32 vcc, 1, v15
 s_nop 0
 s_cmp_eq_u64 vcc, -1
 s_cbranch_scc1 K5E_OK
 s_mov_b32 s39, 0x20000
K5E:
 s_sleep 1
 buffer_load_dword v15, v14, s[4:7], s15 offen sc1
 s_waitcnt vmcnt(0)
 v_cmp_eq_u32 vcc, 1, v15
 s_nop 1
 s_cmp_eq_u64 vcc, -1
 s_cbranch_scc1 K5E_OK
 s_sub_u32 s39, s39, 1
 s_cmp_lg_u32 s39, 0
 s_cbranch_scc1 K5E
K5E_OK:
 ds_read_b128 v[60:63], v2 offset:33792
 s_waitcnt lgkmcnt(6)
 v_mfma_f32_32x32x16_bf16 v[88:103], v[68:71], a[108:111], v[88:103]
 s_add_u32 s30, s20, 0
 buffer_load_dwordx4 a[0:3], v1, s[4:7], s30 offen offset:0 sc1
 v_mfma_f32_32x32x16_bf16 v[104:119], v[68:71], a[252:255], v[104:119]
 ds_read_b128 v[64:67], v2 offset:34816
 s_waitcnt lgkmcnt(6)
 v_mfma_f32_32x32x16_bf16 v[88:103], v[72:75], a[112:115], v[88:103]
 s_add_u32 s30, s12, 0
 buffer_load_dwordx4 a[4:7], v1, s[4:7], s30 offen offset:0 sc1
 v_mfma_f32_32x32x16_bf16 v[104:119], v[72:75], v[24:27], v[104:119]
 ds_read_b128 v[68:71], v2 offset:35840
 s_waitcnt lgkmcnt(6)
 v_mfma_f32_32x32x16_bf16 v[88:103], v[76:79], a[116:119], v[88:103]
 s_add_u32 s30, s20, 8192
 buffer_load_dwordx4 a[8:11], v1, s[4:7], s30 offen offset:1024 sc1
 v_mfma_f32_32x32x16_bf16 v[104:119], v[76:79], v[28:31], v[104:119]
 ds_read_b128 v[72:75], v2 offset:36864
 s_waitcnt lgkmcnt(6)
 v_mfma_f32_32x32x16_bf16 v[88:103], v[80:83], a[120:123], v[88:103]
 s_add_u32 s30, s12, 8192
 buffer_load_dwordx4 a[12:15], v1, s[4:7], s30 offen offset:1024 sc1
 v_mfma_f32_32x32x16_bf16 v[104:119], v[80:83], v[32:35], v[104:119]
 s_add_u32 s30, s20, 16384
 buffer_load_dwordx4 a[16:19], v1, s[4:7], s30 offen offset:2048 sc1
 s_waitcnt lgkmcnt(5)
 v_mfma_f32_32x32x16_bf16 v[88:103], v[84:87], a[124:127], v[88:103]
 s_add_u32 s33, s31, 3584
 buffer_store_dwordx4 v[232:235], v5, s[4:7], s33 offen sc1
 v_mul_f32 v236, v200, v7
 v_mfma_f32_32x32x16_bf16 v[104:119], v[84:87], v[36:39], v[104:119]
 s_add_u32 s30, s12, 16384
 buffer_load_dwordx4 a[20:23], v1, s[4:7], s30 offen offset:2048 sc1
 v_mul_f32 v237, v201, v7
 s_waitcnt lgkmcnt(4)
 v_mfma_f32_32x32x16_bf16 v[88:103], v[56:59], a[128:131], v[88:103]
 v_mul_f32 v238, v202, v7
 v_mul_f32 v239, v203, v7
 v_mul_f32 v240, v204, v7
 v_mul_f32 v241, v205, v7
 v_mul_f32 v242, v206, v7
 v_mul_f32 v243, v207, v7
 v_mfma_f32_32x32x16_bf16 v[104:119], v[56:59], v[40:43], v[104:119]
 s_add_u32 s30, s20, 24576
 buffer_load_dwordx4 a[24:27], v1, s[4:7], s30 offen offset:3072 sc1
 s_waitcnt lgkmcnt(3)
 v_mfma_f32_32x32x16_bf16 v[88:103], v[60:63], a[132:135], v[88:103]
 v_exp_f32 v236, v236
 v_exp_f32 v237, v237
 v_exp_f32 v238, v238
 v_mfma_f32_32x32x16_bf16 v[104:119], v[60:63], v[44:47], v[104:119]
 s_add_u32 s30, s12, 24576
 buffer_load_dwordx4 a[28:31], v1, s[4:7], s30 offen offset:3072 sc1
 s_waitcnt lgkmcnt(2)
 v_mfma_f32_32x32x16_bf16 v[88:103], v[64:67], a[136:139], v[88:103]
 v_exp_f32 v239, v239
 v_exp_f32 v240, v240
 v_exp_f32 v241, v241
 v_mfma_f32_32x32x16_bf16 v[104:119], v[64:67], v[48:51], v[104:119]
 s_add_u32 s30, s20, 0
 buffer_load_dwordx4 a[32:35], v1, s[4:7], s30 offen offset:1024 sc1
 s_waitcnt lgkmcnt(1)
 v_mfma_f32_32x32x16_bf16 v[88:103], v[68:71], a[140:143], v[88:103]
 v_exp_f32 v242, v242
 v_exp_f32 v243, v243
 v_mul_f32 v244, v200, v208
 v_mul_f32 v245, v201, v209
 v_mfma_f32_32x32x16_bf16 v[104:119], v[68:71], v[52:55], v[104:119]
 s_add_u32 s30, s12, 0
 buffer_load_dwordx4 a[36:39], v1, s[4:7], s30 offen offset:1024 sc1
 v_mul_f32 v246, v202, v210
 s_waitcnt lgkmcnt(0)
 v_mfma_f32_32x32x16_bf16 v[88:103], v[72:75], v[16:19], v[88:103]
 v_mul_f32 v247, v203, v211
 v_mul_f32 v248, v204, v212
 v_mul_f32 v249, v205, v213
 v_mul_f32 v250, v206, v214
 v_mul_f32 v251, v207, v215
 v_fma_f32 v236, v236, v9, v9
 v_mfma_f32_32x32x16_bf16 v[104:119], v[72:75], v[20:23], v[104:119]
 s_add_u32 s30, s20, 8192
 buffer_load_dwordx4 a[40:43], v1, s[4:7], s30 offen offset:2048 sc1
 v_fma_f32 v237, v237, v9, v9
 v_fma_f32 v238, v238, v9, v9
 s_add_u32 s30, s12, 8192
 buffer_load_dwordx4 a[44:47], v1, s[4:7], s30 offen offset:2048 sc1
 s_add_u32 s38, s19, 889856
 s_add_u32 m0, s83, 130048
 s_nop 0
 buffer_load_dwordx4 v1, s[4:7], s38 offen sc1 lds
 v_fma_f32 v239, v239, v9, v9
 v_fma_f32 v240, v240, v9, v9
 v_fma_f32 v241, v241, v9, v9
 v_fma_f32 v242, v242, v9, v9
 v_fma_f32 v243, v243, v9, v9
 v_rcp_f32 v236, v236
 v_rcp_f32 v237, v237
 v_rcp_f32 v238, v238
 v_rcp_f32 v239, v239
 v_rcp_f32 v240, v240
 v_rcp_f32 v241, v241
 v_rcp_f32 v242, v242
 v_rcp_f32 v243, v243
 v_mul_f32 v244, v244, v236
 v_mul_f32 v245, v245, v237
 v_mul_f32 v246, v246, v238
 v_mul_f32 v247, v247, v239
 v_mul_f32 v248, v248, v240
 v_mul_f32 v249, v249, v241
 v_mul_f32 v250, v250, v242
 v_mul_f32 v251, v251, v243
 v_cvt_pk_bf16_f32 v252, v244, v245
 v_cvt_pk_bf16_f32 v253, v246, v247
 v_cvt_pk_bf16_f32 v254, v248, v249
 v_cvt_pk_bf16_f32 v255, v250, v251
 s_add_u32 s33, s31, 298496
 buffer_store_dwordx4 v[252:255], v5, s[4:7], s33 offen sc1
 s_barrier
 v_mul_f32 v216, v88, v6
 s_add_u32 s38, s79, 6144
 s_add_u32 m0, s83, 0
 s_nop 0
 buffer_load_dwordx4 v1, s[4:7], s38 offen sc1 lds
 v_mul_f32 v217, v89, v6
 v_mul_f32 v218, v90, v6
 v_mul_f32 v219, v91, v6
 v_mul_f32 v220, v92, v6
 v_mul_f32 v221, v93, v6
 v_mul_f32 v222, v94, v6
 v_mul_f32 v223, v95, v6
 v_exp_f32 v216, v216
 v_exp_f32 v217, v217
 v_exp_f32 v218, v218
 v_exp_f32 v219, v219
 s_add_u32 s38, s79, 153600
 s_add_u32 m0, s83, 1024
 s_nop 0
 buffer_load_dwordx4 v1, s[4:7], s38 offen sc1 lds
 v_exp_f32 v220, v220
 v_exp_f32 v221, v221
 v_exp_f32 v222, v222
 v_exp_f32 v223, v223
 v_mul_f32 v224, v88, v96
 v_mul_f32 v225, v89, v97
 v_mul_f32 v226, v90, v98
 v_mul_f32 v227, v91, v99
 v_mul_f32 v228, v92, v100
 v_mul_f32 v229, v93, v101
 v_mul_f32 v230, v94, v102
 s_add_u32 s38, s79, 301056
 s_add_u32 m0, s83, 2048
 s_nop 0
 buffer_load_dwordx4 v1, s[4:7], s38 offen sc1 lds
 v_mul_f32 v231, v95, v103
 v_fma_f32 v216, v216, v8, v8
 v_fma_f32 v217, v217, v8, v8
 v_fma_f32 v218, v218, v8, v8
 v_fma_f32 v219, v219, v8, v8
 v_fma_f32 v220, v220, v8, v8
 v_fma_f32 v221, v221, v8, v8
 v_fma_f32 v222, v222, v8, v8
 v_fma_f32 v223, v223, v8, v8
 v_rcp_f32 v216, v216
 v_rcp_f32 v217, v217
 v_rcp_f32 v218, v218
 s_add_u32 s38, s79, 448512
 s_add_u32 m0, s83, 3072
 s_nop 0
 buffer_load_dwordx4 v1, s[4:7], s38 offen sc1 lds
 v_rcp_f32 v219, v219
 v_rcp_f32 v220, v220
 v_rcp_f32 v221, v221
 v_rcp_f32 v222, v222
 v_rcp_f32 v223, v223
 v_mul_f32 v224, v224, v216
 v_mul_f32 v225, v225, v217
 v_mul_f32 v226, v226, v218
 v_mul_f32 v227, v227, v219
 v_mul_f32 v228, v228, v220
 s_add_u32 s38, s79, 595968
 s_add_u32 m0, s83, 4096
 s_nop 0
 buffer_load_dwordx4 v1, s[4:7], s38 offen sc1 lds
 v_mul_f32 v229, v229, v221
 v_mul_f32 v230, v230, v222
 v_mul_f32 v231, v231, v223
 v_cvt_pk_bf16_f32 v232, v224, v225
 v_cvt_pk_bf16_f32 v233, v226, v227
 v_cvt_pk_bf16_f32 v234, v228, v229
 v_cvt_pk_bf16_f32 v235, v230, v231
 s_add_u32 s33, s31, 4096
 buffer_store_dwordx4 v[232:235], v5, s[4:7], s33 offen sc1
 v_mul_f32 v236, v104, v7
 v_mul_f32 v237, v105, v7
 v_mul_f32 v238, v106, v7
 v_mul_f32 v239, v107, v7
 s_add_u32 s38, s19, 743424
 s_add_u32 m0, s83, 5120
 s_nop 0
 buffer_load_dwordx4 v1, s[4:7], s38 offen sc1 lds
 v_mul_f32 v240, v108, v7
 v_mul_f32 v241, v109, v7
 v_mul_f32 v242, v110, v7
 v_mul_f32 v243, v111, v7
 v_exp_f32 v236, v236
 v_exp_f32 v237, v237
 v_exp_f32 v238, v238
 v_exp_f32 v239, v239
 v_exp_f32 v240, v240
 v_exp_f32 v241, v241
 s_add_u32 s38, s19, 890880
 s_add_u32 m0, s83, 6144
 s_nop 0
 buffer_load_dwordx4 v1, s[4:7], s38 offen sc1 lds
 v_exp_f32 v242, v242
 v_exp_f32 v243, v243
 v_mul_f32 v244, v104, v112
 v_mul_f32 v245, v105, v113
 v_mul_f32 v246, v106, v114
 v_mul_f32 v247, v107, v115
 v_mul_f32 v248, v108, v116
 v_mul_f32 v249, v109, v117
 v_mul_f32 v250, v110, v118
 v_mul_f32 v251, v111, v119
 v_fma_f32 v236, v236, v9, v9
 v_fma_f32 v237, v237, v9, v9
 v_fma_f32 v238, v238, v9, v9
 v_fma_f32 v239, v239, v9, v9
 v_fma_f32 v240, v240, v9, v9
 v_fma_f32 v241, v241, v9, v9
 v_fma_f32 v242, v242, v9, v9
 v_fma_f32 v243, v243, v9, v9
 v_rcp_f32 v236, v236
 v_rcp_f32 v237, v237
 v_rcp_f32 v238, v238
 v_rcp_f32 v239, v239
 v_rcp_f32 v240, v240
 v_rcp_f32 v241, v241
 v_rcp_f32 v242, v242
 v_rcp_f32 v243, v243
 v_mul_f32 v244, v244, v236
 v_mul_f32 v245, v245, v237
 v_mul_f32 v246, v246, v238
 v_mul_f32 v247, v247, v239
 v_mul_f32 v248, v248, v240
 v_mul_f32 v249, v249, v241
 v_mul_f32 v250, v250, v242
 v_mul_f32 v251, v251, v243
 v_cvt_pk_bf16_f32 v252, v244, v245
 v_cvt_pk_bf16_f32 v253, v246, v247
 v_cvt_pk_bf16_f32 v254, v248, v249
 v_cvt_pk_bf16_f32 v255, v250, v251
 s_add_u32 s33, s31, 299008
 buffer_store_dwordx4 v[252:255], v5, s[4:7], s33 offen sc1
 s_sub_u32 s26, s13, 2048
 s_bitcmp1_b32 s82, 0
 s_cbranch_scc1 K5_N1
 ds_read_b128 v[104:107], v2 offset:37888
 ds_read_b128 v[108:111], v2 offset:38912
 ds_read_b128 v[112:115], v2 offset:39936
 ds_read_b128 v[116:119], v2 offset:40960
 ds_read_b128 v[120:123], v2 offset:41984
 ds_read_b128 v[124:127], v2 offset:43008
 ds_read_b128 v[128:131], v2 offset:44032
 ds_read_b128 v[132:135], v2 offset:45056
 ds_read_b128 v[136:139], v2 offset:46080
 ds_read_b128 v[140:143], v2 offset:47104
 s_waitcnt vmcnt(22) lgkmcnt(7)
 v_mfma_f32_16x16x32_bf16 v[32:35], v[104:107], a[0:3], 0
 s_add_u32 s30, s20, 16384
 buffer_load_dwordx4 a[48:51], v1, s[4:7], s30 offen offset:3072 sc1
 v_mfma_f32_16x16x32_bf16 v[68:71], v[104:107], a[4:7], 0
 ds_read_b128 v[144:147], v2 offset:48128
 v_mfma_f32_16x16x32_bf16 v[36:39], v[108:111], a[0:3], 0
 v_mfma_f32_16x16x32_bf16 v[72:75], v[108:111], a[4:7], 0
 ds_read_b128 v[148:151], v2 offset:49152
 v_mfma_f32_16x16x32_bf16 v[40:43], v[112:115], a[0:3], 0
 s_add_u32 s30, s12, 16384
 buffer_load_dwordx4 a[52:55], v1, s[4:7], s30 offen offset:3072 sc1
 v_mfma_f32_16x16x32_bf16 v[76:79], v[112:115], a[4:7], 0
 ds_read_b128 v[104:107], v2 offset:50176
 s_waitcnt lgkmcnt(7)
 v_mfma_f32_16x16x32_bf16 v[44:47], v[116:119], a[0:3], 0
 v_mfma_f32_16x16x32_bf16 v[80:83], v[116:119], a[4:7], 0
 ds_read_b128 v[108:111], v2 offset:51200
 v_mfma_f32_16x16x32_bf16 v[48:51], v[120:123], a[0:3], 0
 v_mfma_f32_16x16x32_bf16 v[84:87], v[120:123], a[4:7], 0
 ds_read_b128 v[112:115], v2 offset:52224
 v_mfma_f32_16x16x32_bf16 v[52:55], v[124:127], a[0:3], 0
 v_mfma_f32_16x16x32_bf16 v[88:91], v[124:127], a[4:7], 0
 ds_read_b128 v[116:119], v2 offset:53248
 s_waitcnt lgkmcnt(7)
 v_mfma_f32_16x16x32_bf16 v[56:59], v[128:131], a[0:3], 0
 v_mfma_f32_16x16x32_bf16 v[92:95], v[128:131], a[4:7], 0
 ds_read_b128 v[120:123], v2 offset:54272
 s_waitcnt vmcnt(22)
 v_mfma_f32_16x16x32_bf16 v[32:35], v[132:135], a[8:11], v[32:35]
 s_add_u32 s30, s20, 28672
 buffer_load_dwordx4 a[56:59], v1, s[4:7], s30 offen offset:0 sc1
 v_mfma_f32_16x16x32_bf16 v[68:71], v[132:135], a[12:15], v[68:71]
 ds_read_b128 v[124:127], v2 offset:55296
 v_mfma_f32_16x16x32_bf16 v[36:39], v[136:139], a[8:11], v[36:39]
 s_and_b32 s24, s2, 7
 s_lshr_b32 s25, s2, 3
 s_lshr_b32 s86, s24, 1
 s_lshl_b32 s86, s86, 2
 s_and_b32 s27, s25, 3
 s_add_u32 s86, s86, s27
 s_and_b32 s87, s24, 1
 s_lshl_b32 s87, s87, 3
 v_mfma_f32_16x16x32_bf16 v[72:75], v[136:139], a[12:15], v[72:75]
 ds_read_b128 v[128:131], v2 offset:56320
 s_waitcnt lgkmcnt(7)
 v_mfma_f32_16x16x32_bf16 v[40:43], v[140:143], a[8:11], v[40:43]
 s_add_u32 s30, s12, 28672
 buffer_load_dwordx4 a[60:63], v1, s[4:7], s30 offen offset:0 sc1
 v_mfma_f32_16x16x32_bf16 v[76:79], v[140:143], a[12:15], v[76:79]
 ds_read_b128 v[132:135], v2 offset:57344
 v_mfma_f32_16x16x32_bf16 v[44:47], v[144:147], a[8:11], v[44:47]
 s_lshr_b32 s34, s25, 2
 s_add_u32 s87, s87, s34
 s_lshl_b32 s78, s3, 10
 s_lshl_b32 s34, s87, 2
 s_mul_i32 s35, s87, 3
 s_add_u32 s35, s35, 9
 s_cmp_ge_u32 s87, 9
 s_cselect_b32 s34, s35, s34
 v_mfma_f32_16x16x32_bf16 v[80:83], v[144:147], a[12:15], v[80:83]
 ds_read_b128 v[136:139], v2 offset:58368
 v_mfma_f32_16x16x32_bf16 v[48:51], v[148:151], a[8:11], v[48:51]
 s_cmp_eq_u32 s87, 15
 s_cselect_b32 s34, 34, s34
 s_mul_i32 s76, s34, 37888
 s_add_u32 s76, s76, 56442880
 s_add_u32 s77, s76, s78
 s_lshr_b32 s32, s82, 1
 s_and_b32 s33, s82, 1
 s_lshl_b32 s34, s80, 2
 v_mfma_f32_16x16x32_bf16 v[84:87], v[148:151], a[12:15], v[84:87]
 ds_read_b128 v[140:143], v2 offset:59392
 s_waitcnt lgkmcnt(7)
 v_mfma_f32_16x16x32_bf16 v[52:55], v[104:107], a[8:11], v[52:55]
 s_add_u32 s34, s34, s3
 s_lshl_b32 s27, s80, 2
 s_add_u32 s27, s27, s81
 s_mul_i32 s21, s27, 147456
 s_mul_i32 s35, s3, 3072
 s_add_u32 s21, s21, s35
 s_add_u32 s21, s21, 46940160
 s_mul_i32 s35, s32, 12288
 v_mfma_f32_16x16x32_bf16 v[88:91], v[104:107], a[12:15], v[88:91]
 ds_read_b128 v[144:147], v2 offset:60416
 v_mfma_f32_16x16x32_bf16 v[56:59], v[108:111], a[8:11], v[56:59]
 s_add_u32 s35, s35, s21
 s_xor_b32 s36, s82, 1
 s_mul_i32 s36, s36, 36864
 s_add_u32 s16, s35, s36
 s_xor_b32 s36, s82, 3
 s_mul_i32 s36, s36, 36864
 s_add_u32 s17, s35, s36
 s_xor_b32 s36, s82, 2
 v_mfma_f32_16x16x32_bf16 v[92:95], v[108:111], a[12:15], v[92:95]
 ds_read_b128 v[148:151], v2 offset:61440
 s_waitcnt vmcnt(21)
 v_mfma_f32_16x16x32_bf16 v[32:35], v[112:115], a[16:19], v[32:35]
 s_add_u32 s30, s20, 0
 buffer_load_dwordx4 a[64:67], v1, s[4:7], s30 offen offset:2048 sc1
 v_mfma_f32_16x16x32_bf16 v[68:71], v[112:115], a[20:23], v[68:71]
 ds_read_b128 v[104:107], v2 offset:62464
 s_waitcnt lgkmcnt(7)
 v_mfma_f32_16x16x32_bf16 v[36:39], v[116:119], a[16:19], v[36:39]
 s_mul_i32 s36, s36, 36864
 s_add_u32 s18, s21, s36
 s_add_u32 s18, s18, 24576
 s_mul_i32 s36, s82, 36864
 s_add_u32 s21, s21, s36
 s_mul_i32 s13, s81, 9
 s_lshl_b32 s35, s33, 2
 s_add_u32 s13, s13, s35
 v_mfma_f32_16x16x32_bf16 v[72:75], v[116:119], a[20:23], v[72:75]
 ds_read_b128 v[108:111], v2 offset:63488
 v_mfma_f32_16x16x32_bf16 v[40:43], v[120:123], a[16:19], v[40:43]
 s_add_u32 s30, s12, 0
 buffer_load_dwordx4 a[68:71], v1, s[4:7], s30 offen offset:2048 sc1
 v_mfma_f32_16x16x32_bf16 v[76:79], v[120:123], a[20:23], v[76:79]
 ds_read_b128 v[112:115], v2 offset:64512
 v_mfma_f32_16x16x32_bf16 v[44:47], v[124:127], a[16:19], v[44:47]
 v_and_b32 v11, 15, v0
 v_lshlrev_b32 v11, 4, v11
 v_mfma_f32_16x16x32_bf16 v[80:83], v[124:127], a[20:23], v[80:83]
 ds_read_b128 v[116:119], v3 offset:0
 s_waitcnt lgkmcnt(7)
 v_mfma_f32_16x16x32_bf16 v[48:51], v[128:131], a[16:19], v[48:51]
 v_bfe_u32 v28, v0, 5, 1
 v_lshlrev_b32 v28, 9, v28
 v_mfma_f32_16x16x32_bf16 v[84:87], v[128:131], a[20:23], v[84:87]
 ds_read_b128 v[120:123], v3 offset:1024
 v_mfma_f32_16x16x32_bf16 v[52:55], v[132:135], a[16:19], v[52:55]
 v_add_u32 v11, v11, v28
 v_bfe_u32 v28, v0, 4, 1
 v_mfma_f32_16x16x32_bf16 v[88:91], v[132:135], a[20:23], v[88:91]
 ds_read_b128 v[124:127], v3 offset:2048
 v_mfma_f32_16x16x32_bf16 v[56:59], v[136:139], a[16:19], v[56:59]
 v_lshlrev_b32 v28, 3, v28
 v_add_u32 v11, v11, v28
 v_mfma_f32_16x16x32_bf16 v[92:95], v[136:139], a[20:23], v[92:95]
 ds_read_b128 v[128:131], v3 offset:3072
 s_waitcnt vmcnt(21) lgkmcnt(7)
 v_mfma_f32_16x16x32_bf16 v[32:35], v[140:143], a[24:27], v[32:35]
 s_add_u32 s30, s20, 8192
 buffer_load_dwordx4 a[72:75], v1, s[4:7], s30 offen offset:3072 sc1
 v_mfma_f32_16x16x32_bf16 v[68:71], v[140:143], a[28:31], v[68:71]
 ds_read_b128 v[132:135], v3 offset:4096
 v_mfma_f32_16x16x32_bf16 v[36:39], v[144:147], a[24:27], v[36:39]
 s_mul_i32 s28, s34, 36
 s_add_u32 s28, s28, s13
 s_lshl_b32 s28, s28, 10
 s_lshl_b32 s29, s32, 8
 s_add_u32 s28, s28, s29
 s_add_u32 s28, s28, s42
 s_add_u32 s22, s28, 4718592
 s_add_u32 s23, s22, 4096
 v_mfma_f32_16x16x32_bf16 v[72:75], v[144:147], a[28:31], v[72:75]
 ds_read_b128 v[136:139], v3 offset:5120
 v_mfma_f32_16x16x32_bf16 v[40:43], v[148:151], a[24:27], v[40:43]
 s_add_u32 s30, s12, 8192
 buffer_load_dwordx4 a[76:79], v1, s[4:7], s30 offen offset:3072 sc1
 v_mfma_f32_16x16x32_bf16 v[76:79], v[148:151], a[28:31], v[76:79]
 ds_read_b128 v[140:143], v3 offset:6144
 s_waitcnt lgkmcnt(7)
 v_mfma_f32_16x16x32_bf16 v[44:47], v[104:107], a[24:27], v[44:47]
 s_add_u32 s28, s28, 2359296
 s_add_u32 s29, s28, 4096
 v_and_b32 v15, 15, v0
 v_mfma_f32_16x16x32_bf16 v[80:83], v[104:107], a[28:31], v[80:83]
 ds_read_b128 v[144:147], v3 offset:7168
 v_mfma_f32_16x16x32_bf16 v[48:51], v[108:111], a[24:27], v[48:51]
 v_mul_u32_u24 v29, 1152, v15
 v_lshlrev_b32 v15, 3, v15
 v_mfma_f32_16x16x32_bf16 v[84:87], v[108:111], a[28:31], v[84:87]
 ds_read_b128 v[148:151], v3 offset:8192
 v_mfma_f32_16x16x32_bf16 v[52:55], v[112:115], a[24:27], v[52:55]
 s_lshl_b32 s35, s34, 1
 s_add_u32 s35, s35, s32
 s_lshl_b32 s36, s35, 10
 s_lshl_b32 s37, s81, 1
 s_add_u32 s37, s37, s33
 s_lshl_b32 s37, s37, 7
 s_add_u32 s36, s36, s37
 s_add_u32 s36, s36, s43
 v_mfma_f32_16x16x32_bf16 v[88:91], v[112:115], a[28:31], v[88:91]
 ds_read_b128 v[104:107], v3 offset:9216
 s_waitcnt lgkmcnt(7)
 v_mfma_f32_16x16x32_bf16 v[56:59], v[116:119], a[24:27], v[56:59]
 s_add_u32 s36, s36, 262144
 v_bfe_u32 v28, v0, 4, 2
 v_mfma_f32_16x16x32_bf16 v[92:95], v[116:119], a[28:31], v[92:95]
 ds_read_b128 v[108:111], v3 offset:10240
 s_waitcnt vmcnt(21)
 v_mfma_f32_16x16x32_bf16 v[32:35], v[120:123], a[32:35], v[32:35]
 s_add_u32 s30, s20, 20480
 buffer_load_dwordx4 a[80:83], v1, s[4:7], s30 offen offset:0 sc1
 v_mfma_f32_16x16x32_bf16 v[68:71], v[120:123], a[36:39], v[68:71]
 ds_read_b128 v[112:115], v3 offset:11264
 v_mfma_f32_16x16x32_bf16 v[36:39], v[124:127], a[32:35], v[36:39]
 v_lshlrev_b32 v28, 3, v28
 v_add_u32 v29, v29, v28
 v_mfma_f32_16x16x32_bf16 v[72:75], v[124:127], a[36:39], v[72:75]
 ds_read_b128 v[116:119], v3 offset:12288
 s_waitcnt lgkmcnt(7)
 v_mfma_f32_16x16x32_bf16 v[40:43], v[128:131], a[32:35], v[40:43]
 s_add_u32 s30, s12, 20480
 buffer_load_dwordx4 a[84:87], v1, s[4:7], s30 offen offset:0 sc1
 v_mfma_f32_16x16x32_bf16 v[76:79], v[128:131], a[36:39], v[76:79]
 ds_read_b128 v[120:123], v3 offset:13312
 v_mfma_f32_16x16x32_bf16 v[44:47], v[132:135], a[32:35], v[44:47]
 s_mul_i32 s31, s35, 18432
 s_lshl_b32 s37, s13, 5
 s_add_u32 s31, s31, s37
 s_sub_u32 s25, s15, 65536
 v_mfma_f32_16x16x32_bf16 v[80:83], v[132:135], a[36:39], v[80:83]
 ds_read_b128 v[124:127], v3 offset:14336
 v_mfma_f32_16x16x32_bf16 v[48:51], v[136:139], a[32:35], v[48:51]
 v_mfma_f32_16x16x32_bf16 v[84:87], v[136:139], a[36:39], v[84:87]
 ds_read_b128 v[128:131], v3 offset:15360
 s_waitcnt lgkmcnt(7)
 v_mfma_f32_16x16x32_bf16 v[52:55], v[140:143], a[32:35], v[52:55]
 v_mfma_f32_16x16x32_bf16 v[88:91], v[140:143], a[36:39], v[88:91]
 ds_read_b128 v[132:135], v3 offset:16384
 v_mfma_f32_16x16x32_bf16 v[56:59], v[144:147], a[32:35], v[56:59]
 v_mfma_f32_16x16x32_bf16 v[92:95], v[144:147], a[36:39], v[92:95]
 ds_read_b128 v[136:139], v3 offset:17408
 s_waitcnt vmcnt(21)
 v_mfma_f32_16x16x32_bf16 v[32:35], v[148:151], a[40:43], v[32:35]
 s_add_u32 s30, s20, 28672
 buffer_load_dwordx4 a[88:91], v1, s[4:7], s30 offen offset:1024 sc1
 v_mfma_f32_16x16x32_bf16 v[68:71], v[148:151], a[44:47], v[68:71]
 ds_read_b128 v[140:143], v3 offset:18432
 s_waitcnt lgkmcnt(7)
 v_mfma_f32_16x16x32_bf16 v[36:39], v[104:107], a[40:43], v[36:39]
 v_mfma_f32_16x16x32_bf16 v[72:75], v[104:107], a[44:47], v[72:75]
 ds_read_b128 v[144:147], v3 offset:19456
 v_mfma_f32_16x16x32_bf16 v[40:43], v[108:111], a[40:43], v[40:43]
 s_add_u32 s30, s12, 28672
 buffer_load_dwordx4 a[92:95], v1, s[4:7], s30 offen offset:1024 sc1
 v_mfma_f32_16x16x32_bf16 v[76:79], v[108:111], a[44:47], v[76:79]
 ds_read_b128 v[148:151], v3 offset:20480
 v_mfma_f32_16x16x32_bf16 v[44:47], v[112:115], a[40:43], v[44:47]
 v_mfma_f32_16x16x32_bf16 v[80:83], v[112:115], a[44:47], v[80:83]
 ds_read_b128 v[104:107], v3 offset:21504
 s_waitcnt lgkmcnt(7)
 v_mfma_f32_16x16x32_bf16 v[48:51], v[116:119], a[40:43], v[48:51]
 v_mfma_f32_16x16x32_bf16 v[84:87], v[116:119], a[44:47], v[84:87]
 ds_read_b128 v[108:111], v3 offset:22528
 v_mfma_f32_16x16x32_bf16 v[52:55], v[120:123], a[40:43], v[52:55]
 v_mfma_f32_16x16x32_bf16 v[88:91], v[120:123], a[44:47], v[88:91]
 ds_read_b128 v[112:115], v3 offset:23552
 v_mfma_f32_16x16x32_bf16 v[56:59], v[124:127], a[40:43], v[56:59]
 v_mfma_f32_16x16x32_bf16 v[92:95], v[124:127], a[44:47], v[92:95]
 ds_read_b128 v[116:119], v3 offset:24576
 s_waitcnt vmcnt(10) lgkmcnt(7)
 v_mfma_f32_16x16x32_bf16 v[32:35], v[128:131], a[48:51], v[32:35]
 s_add_u32 s30, s20, 4096
 buffer_load_dwordx4 a[96:99], v1, s[4:7], s30 offen offset:1024 sc1
 v_mfma_f32_16x16x32_bf16 v[68:71], v[128:131], a[52:55], v[68:71]
 ds_read_b128 v[120:123], v3 offset:25600
 v_mfma_f32_16x16x32_bf16 v[36:39], v[132:135], a[48:51], v[36:39]
 v_mfma_f32_16x16x32_bf16 v[72:75], v[132:135], a[52:55], v[72:75]
 ds_read_b128 v[124:127], v3 offset:26624
 v_mfma_f32_16x16x32_bf16 v[40:43], v[136:139], a[48:51], v[40:43]
 s_add_u32 s30, s12, 4096
 buffer_load_dwordx4 a[100:103], v1, s[4:7], s30 offen offset:1024 sc1
 v_mfma_f32_16x16x32_bf16 v[76:79], v[136:139], a[52:55], v[76:79]
 ds_read_b128 v[128:131], v3 offset:27648
 s_waitcnt lgkmcnt(7)
 v_mfma_f32_16x16x32_bf16 v[44:47], v[140:143], a[48:51], v[44:47]
 v_mfma_f32_16x16x32_bf16 v[80:83], v[140:143], a[52:55], v[80:83]
 ds_read_b128 v[132:135], v3 offset:28672
 v_mfma_f32_16x16x32_bf16 v[48:51], v[144:147], a[48:51], v[48:51]
 v_mfma_f32_16x16x32_bf16 v[84:87], v[144:147], a[52:55], v[84:87]
 s_barrier
 s_cmp_lg_u32 s3, 0
 s_cbranch_scc1 SIG4
 s_mov_b64 exec, 1
 v_mov_b32 v30, 0
 v_mov_b32 v31, 1
 s_lshl_b32 s38, s26, 5
 s_add_u32 s38, s38, 9961472
 buffer_store_dword v31, v30, s[4:7], s38 offen sc1
 s_mov_b64 exec, -1
SIG4:
 ds_read_b128 v[136:139], v3 offset:29696
 v_mfma_f32_16x16x32_bf16 v[52:55], v[148:151], a[48:51], v[52:55]
 s_add_u32 s38, s79, 3072
 s_add_u32 m0, s83, 37888
 s_nop 0
 buffer_load_dwordx4 v1, s[4:7], s38 offen sc1 lds
 v_mfma_f32_16x16x32_bf16 v[88:91], v[148:151], a[52:55], v[88:91]
 ds_read_b128 v[140:143], v3 offset:30720
 s_waitcnt lgkmcnt(7)
 v_mfma_f32_16x16x32_bf16 v[56:59], v[104:107], a[48:51], v[56:59]
 v_mfma_f32_16x16x32_bf16 v[92:95], v[104:107], a[52:55], v[92:95]
 ds_read_b128 v[144:147], v3 offset:31744
 s_waitcnt vmcnt(11)
 v_mfma_f32_16x16x32_bf16 v[32:35], v[108:111], a[56:59], v[32:35]
 s_add_u32 s30, s20, 12288
 buffer_load_dwordx4 a[104:107], v1, s[4:7], s30 offen offset:2048 sc1
 v_mfma_f32_16x16x32_bf16 v[68:71], v[108:111], a[60:63], v[68:71]
 ds_read_b128 v[148:151], v3 offset:32768
 v_mfma_f32_16x16x32_bf16 v[36:39], v[112:115], a[56:59], v[36:39]
 s_add_u32 s30, s12, 12288
 buffer_load_dwordx4 a[108:111], v1, s[4:7], s30 offen offset:2048 sc1
 v_mfma_f32_16x16x32_bf16 v[72:75], v[112:115], a[60:63], v[72:75]
 ds_read_b128 v[104:107], v3 offset:33792
 s_waitcnt lgkmcnt(7)
 v_mfma_f32_16x16x32_bf16 v[40:43], v[116:119], a[56:59], v[40:43]
 v_mfma_f32_16x16x32_bf16 v[76:79], v[116:119], a[60:63], v[76:79]
 ds_read_b128 v[108:111], v3 offset:34816
 v_mfma_f32_16x16x32_bf16 v[44:47], v[120:123], a[56:59], v[44:47]
 s_add_u32 s38, s79, 150528
 s_add_u32 m0, s83, 38912
 s_nop 0
 buffer_load_dwordx4 v1, s[4:7], s38 offen sc1 lds
 v_mfma_f32_16x16x32_bf16 v[80:83], v[120:123], a[60:63], v[80:83]
 ds_read_b128 v[112:115], v3 offset:35840
 v_mfma_f32_16x16x32_bf16 v[48:51], v[124:127], a[56:59], v[48:51]
 s_add_u32 s38, s79, 297984
 s_add_u32 m0, s83, 39936
 s_nop 0
 buffer_load_dwordx4 v1, s[4:7], s38 offen sc1 lds
 v_mfma_f32_16x16x32_bf16 v[84:87], v[124:127], a[60:63], v[84:87]
 ds_read_b128 v[116:119], v3 offset:36864
 s_waitcnt lgkmcnt(7)
 v_mfma_f32_16x16x32_bf16 v[52:55], v[128:131], a[56:59], v[52:55]
 v_mfma_f32_16x16x32_bf16 v[88:91], v[128:131], a[60:63], v[88:91]
 ds_read_b128 v[120:123], v3 offset:37888
 v_mfma_f32_16x16x32_bf16 v[56:59], v[132:135], a[56:59], v[56:59]
 s_add_u32 s38, s79, 445440
 s_add_u32 m0, s83, 40960
 s_nop 0
 buffer_load_dwordx4 v1, s[4:7], s38 offen sc1 lds
 v_mfma_f32_16x16x32_bf16 v[92:95], v[132:135], a[60:63], v[92:95]
 ds_read_b128 v[124:127], v3 offset:38912
 s_waitcnt vmcnt(14)
 v_mfma_f32_16x16x32_bf16 v[32:35], v[136:139], a[64:67], v[32:35]
 s_add_u32 s30, s20, 20480
 buffer_load_dwordx4 a[112:115], v1, s[4:7], s30 offen offset:3072 sc1
 v_mfma_f32_16x16x32_bf16 v[68:71], v[136:139], a[68:71], v[68:71]
 ds_read_b128 v[128:131], v3 offset:39936
 s_waitcnt lgkmcnt(7)
 v_mfma_f32_16x16x32_bf16 v[36:39], v[140:143], a[64:67], v[36:39]
 v_mfma_f32_16x16x32_bf16 v[72:75], v[140:143], a[68:71], v[72:75]
 ds_read_b128 v[132:135], v3 offset:40960
 v_mfma_f32_16x16x32_bf16 v[40:43], v[144:147], a[64:67], v[40:43]
 s_add_u32 s30, s12, 20480
 buffer_load_dwordx4 a[116:119], v1, s[4:7], s30 offen offset:3072 sc1
 v_mfma_f32_16x16x32_bf16 v[76:79], v[144:147], a[68:71], v[76:79]
 ds_read_b128 v[136:139], v3 offset:41984
 v_mfma_f32_16x16x32_bf16 v[44:47], v[148:151], a[64:67], v[44:47]
 s_add_u32 s38, s79, 592896
 s_add_u32 m0, s83, 41984
 s_nop 0
 buffer_load_dwordx4 v1, s[4:7], s38 offen sc1 lds
 v_mfma_f32_16x16x32_bf16 v[80:83], v[148:151], a[68:71], v[80:83]
 ds_read_b128 v[140:143], v3 offset:43008
 s_waitcnt lgkmcnt(7)
 v_mfma_f32_16x16x32_bf16 v[48:51], v[104:107], a[64:67], v[48:51]
 v_mfma_f32_16x16x32_bf16 v[84:87], v[104:107], a[68:71], v[84:87]
 ds_read_b128 v[144:147], v3 offset:44032
 v_mfma_f32_16x16x32_bf16 v[52:55], v[108:111], a[64:67], v[52:55]
 s_add_u32 s38, s19, 740352
 s_add_u32 m0, s83, 43008
 s_nop 0
 buffer_load_dwordx4 v1, s[4:7], s38 offen sc1 lds
 v_mfma_f32_16x16x32_bf16 v[88:91], v[108:111], a[68:71], v[88:91]
 ds_read_b128 v[148:151], v3 offset:45056
 v_mfma_f32_16x16x32_bf16 v[56:59], v[112:115], a[64:67], v[56:59]
 s_add_u32 s38, s19, 887808
 s_add_u32 m0, s83, 44032
 s_nop 0
 buffer_load_dwordx4 v1, s[4:7], s38 offen sc1 lds
 v_mfma_f32_16x16x32_bf16 v[92:95], v[112:115], a[68:71], v[92:95]
 ds_read_b128 v[104:107], v3 offset:46080
 s_waitcnt vmcnt(17) lgkmcnt(7)
 v_mfma_f32_16x16x32_bf16 v[32:35], v[116:119], a[72:75], v[32:35]
 s_add_u32 s30, s20, 32768
 buffer_load_dwordx4 a[120:123], v1, s[4:7], s30 offen offset:0 sc1
 v_mfma_f32_16x16x32_bf16 v[68:71], v[116:119], a[76:79], v[68:71]
 ds_read_b128 v[108:111], v3 offset:47104
 v_mfma_f32_16x16x32_bf16 v[36:39], v[120:123], a[72:75], v[36:39]
 v_mfma_f32_16x16x32_bf16 v[72:75], v[120:123], a[76:79], v[72:75]
 ds_read_b128 v[112:115], v3 offset:48128
 v_mfma_f32_16x16x32_bf16 v[40:43], v[124:127], a[72:75], v[40:43]
 s_add_u32 s30, s12, 32768
 buffer_load_dwordx4 a[124:127], v1, s[4:7], s30 offen offset:0 sc1
 v_mfma_f32_16x16x32_bf16 v[76:79], v[124:127], a[76:79], v[76:79]
 ds_read_b128 v[116:119], v3 offset:49152
 s_waitcnt lgkmcnt(7)
 v_mfma_f32_16x16x32_bf16 v[44:47], v[128:131], a[72:75], v[44:47]
 v_mfma_f32_16x16x32_bf16 v[80:83], v[128:131], a[76:79], v[80:83]
 ds_read_b128 v[120:123], v3 offset:50176
 v_mfma_f32_16x16x32_bf16 v[48:51], v[132:135], a[72:75], v[48:51]
 v_mfma_f32_16x16x32_bf16 v[84:87], v[132:135], a[76:79], v[84:87]
 ds_read_b128 v[124:127], v3 offset:51200
 v_mfma_f32_16x16x32_bf16 v[52:55], v[136:139], a[72:75], v[52:55]
 v_mfma_f32_16x16x32_bf16 v[88:91], v[136:139], a[76:79], v[88:91]
 ds_read_b128 v[128:131], v3 offset:52224
 s_waitcnt lgkmcnt(7)
 v_mfma_f32_16x16x32_bf16 v[56:59], v[140:143], a[72:75], v[56:59]
 v_mfma_f32_16x16x32_bf16 v[92:95], v[140:143], a[76:79], v[92:95]
 ds_read_b128 v[132:135], v3 offset:53248
 s_waitcnt vmcnt(17)
 v_mfma_f32_16x16x32_bf16 v[32:35], v[144:147], a[80:83], v[32:35]
 s_add_u32 s30, s20, 4096
 buffer_load_dwordx4 a[128:131], v1, s[4:7], s30 offen offset:2048 sc1
 v_mfma_f32_16x16x32_bf16 v[68:71], v[144:147], a[84:87], v[68:71]
 ds_read_b128 v[136:139], v3 offset:54272
 v_mfma_f32_16x16x32_bf16 v[36:39], v[148:151], a[80:83], v[36:39]
 v_mfma_f32_16x16x32_bf16 v[72:75], v[148:151], a[84:87], v[72:75]
 ds_read_b128 v[140:143], v3 offset:55296
 s_waitcnt lgkmcnt(7)
 v_mfma_f32_16x16x32_bf16 v[40:43], v[104:107], a[80:83], v[40:43]
 s_add_u32 s30, s12, 4096
 buffer_load_dwordx4 a[132:135], v1, s[4:7], s30 offen offset:2048 sc1
 v_mfma_f32_16x16x32_bf16 v[76:79], v[104:107], a[84:87], v[76:79]
 ds_read_b128 v[144:147], v3 offset:56320
 v_mfma_f32_16x16x32_bf16 v[44:47], v[108:111], a[80:83], v[44:47]
 v_mfma_f32_16x16x32_bf16 v[80:83], v[108:111], a[84:87], v[80:83]
 ds_read_b128 v[148:151], v3 offset:57344
 v_mfma_f32_16x16x32_bf16 v[48:51], v[112:115], a[80:83], v[48:51]
 v_mfma_f32_16x16x32_bf16 v[84:87], v[112:115], a[84:87], v[84:87]
 s_barrier
 ds_read_b128 v[104:107], v3 offset:58368
 s_waitcnt lgkmcnt(7)
 v_mfma_f32_16x16x32_bf16 v[52:55], v[116:119], a[80:83], v[52:55]
 s_add_u32 s38, s79, 7168
 s_add_u32 m0, s83, 66560
 s_nop 0
 buffer_load_dwordx4 v1, s[4:7], s38 offen sc1 lds
 v_mfma_f32_16x16x32_bf16 v[88:91], v[116:119], a[84:87], v[88:91]
 ds_read_b128 v[108:111], v3 offset:59392
 v_mfma_f32_16x16x32_bf16 v[56:59], v[120:123], a[80:83], v[56:59]
 v_mfma_f32_16x16x32_bf16 v[92:95], v[120:123], a[84:87], v[92:95]
 ds_read_b128 v[112:115], v3 offset:60416
 s_waitcnt vmcnt(18)
 v_mfma_f32_16x16x32_bf16 v[32:35], v[124:127], a[88:91], v[32:35]
 s_add_u32 s30, s20, 12288
 buffer_load_dwordx4 a[136:139], v1, s[4:7], s30 offen offset:3072 sc1
 v_mfma_f32_16x16x32_bf16 v[68:71], v[124:127], a[92:95], v[68:71]
 ds_read_b128 v[116:119], v3 offset:61440
 s_waitcnt lgkmcnt(7)
 v_mfma_f32_16x16x32_bf16 v[36:39], v[128:131], a[88:91], v[36:39]
 s_add_u32 s30, s12, 12288
 buffer_load_dwordx4 a[140:143], v1, s[4:7], s30 offen offset:3072 sc1
 v_mfma_f32_16x16x32_bf16 v[72:75], v[128:131], a[92:95], v[72:75]
 ds_read_b128 v[120:123], v3 offset:62464
 v_mfma_f32_16x16x32_bf16 v[40:43], v[132:135], a[88:91], v[40:43]
 v_mfma_f32_16x16x32_bf16 v[76:79], v[132:135], a[92:95], v[76:79]
 ds_read_b128 v[124:127], v3 offset:63488
 v_mfma_f32_16x16x32_bf16 v[44:47], v[136:139], a[88:91], v[44:47]
 s_add_u32 s38, s79, 154624
 s_add_u32 m0, s83, 67584
 s_nop 0
 buffer_load_dwordx4 v1, s[4:7], s38 offen sc1 lds
 v_mfma_f32_16x16x32_bf16 v[80:83], v[136:139], a[92:95], v[80:83]
 ds_read_b128 v[128:131], v3 offset:64512
 s_waitcnt lgkmcnt(7)
 v_mfma_f32_16x16x32_bf16 v[48:51], v[140:143], a[88:91], v[48:51]
 s_add_u32 s38, s79, 302080
 s_add_u32 m0, s83, 68608
 s_nop 0
 buffer_load_dwordx4 v1, s[4:7], s38 offen sc1 lds
 v_mfma_f32_16x16x32_bf16 v[84:87], v[140:143], a[92:95], v[84:87]
 ds_read_b128 v[132:135], v4 offset:0
 v_mfma_f32_16x16x32_bf16 v[52:55], v[144:147], a[88:91], v[52:55]
 v_mfma_f32_16x16x32_bf16 v[88:91], v[144:147], a[92:95], v[88:91]
 ds_read_b128 v[136:139], v4 offset:1024
 v_mfma_f32_16x16x32_bf16 v[56:59], v[148:151], a[88:91], v[56:59]
 s_add_u32 s38, s79, 449536
 s_add_u32 m0, s83, 69632
 s_nop 0
 buffer_load_dwordx4 v1, s[4:7], s38 offen sc1 lds
 v_mfma_f32_16x16x32_bf16 v[92:95], v[148:151], a[92:95], v[92:95]
 ds_read_b128 v[140:143], v4 offset:2048
 s_waitcnt vmcnt(21) lgkmcnt(7)
 v_mfma_f32_16x16x32_bf16 v[32:35], v[104:107], a[96:99], v[32:35]
 s_add_u32 s30, s20, 24576
 buffer_load_dwordx4 a[144:147], v1, s[4:7], s30 offen offset:0 sc1
 v_mfma_f32_16x16x32_bf16 v[68:71], v[104:107], a[100:103], v[68:71]
 ds_read_b128 v[144:147], v4 offset:3072
 v_mfma_f32_16x16x32_bf16 v[36:39], v[108:111], a[96:99], v[36:39]
 v_mfma_f32_16x16x32_bf16 v[72:75], v[108:111], a[100:103], v[72:75]
 ds_read_b128 v[148:151], v4 offset:4096
 v_mfma_f32_16x16x32_bf16 v[40:43], v[112:115], a[96:99], v[40:43]
 s_add_u32 s30, s12, 24576
 buffer_load_dwordx4 a[148:151], v1, s[4:7], s30 offen offset:0 sc1
 v_mfma_f32_16x16x32_bf16 v[76:79], v[112:115], a[100:103], v[76:79]
 ds_read_b128 v[104:107], v4 offset:5120
 s_waitcnt lgkmcnt(7)
 v_mfma_f32_16x16x32_bf16 v[44:47], v[116:119], a[96:99], v[44:47]
 s_add_u32 s38, s79, 596992
 s_add_u32 m0, s83, 70656
 s_nop 0
 buffer_load_dwordx4 v1, s[4:7], s38 offen sc1 lds
 v_mfma_f32_16x16x32_bf16 v[80:83], v[116:119], a[100:103], v[80:83]
 ds_read_b128 v[108:111], v4 offset:6144
 v_mfma_f32_16x16x32_bf16 v[48:51], v[120:123], a[96:99], v[48:51]
 v_mfma_f32_16x16x32_bf16 v[84:87], v[120:123], a[100:103], v[84:87]
 ds_read_b128 v[112:115], v4 offset:7168
 v_mfma_f32_16x16x32_bf16 v[52:55], v[124:127], a[96:99], v[52:55]
 s_add_u32 s38, s19, 744448
 s_add_u32 m0, s83, 71680
 s_nop 0
 buffer_load_dwordx4 v1, s[4:7], s38 offen sc1 lds
 v_mfma_f32_16x16x32_bf16 v[88:91], v[124:127], a[100:103], v[88:91]
 ds_read_b128 v[116:119], v4 offset:8192
 s_waitcnt lgkmcnt(7)
 v_mfma_f32_16x16x32_bf16 v[56:59], v[128:131], a[96:99], v[56:59]
 s_add_u32 s38, s19, 891904
 s_add_u32 m0, s83, 72704
 s_nop 0
 buffer_load_dwordx4 v1, s[4:7], s38 offen sc1 lds
 v_mfma_f32_16x16x32_bf16 v[92:95], v[128:131], a[100:103], v[92:95]
 buffer_load_dword v13, v14, s[4:7], s25 offen sc1
 ds_read_b128 v[120:123], v4 offset:9216
 s_waitcnt vmcnt(24)
 v_mfma_f32_16x16x32_bf16 v[32:35], v[132:135], a[104:107], v[32:35]
 s_add_u32 s30, s20, 32768
 buffer_load_dwordx4 a[152:155], v1, s[4:7], s30 offen offset:1024 sc1
 v_mfma_f32_16x16x32_bf16 v[68:71], v[132:135], a[108:111], v[68:71]
 ds_read_b128 v[124:127], v4 offset:10240
 v_mfma_f32_16x16x32_bf16 v[36:39], v[136:139], a[104:107], v[36:39]
 v_mfma_f32_16x16x32_bf16 v[72:75], v[136:139], a[108:111], v[72:75]
 ds_read_b128 v[128:131], v4 offset:11264
 s_waitcnt lgkmcnt(7)
 v_mfma_f32_16x16x32_bf16 v[40:43], v[140:143], a[104:107], v[40:43]
 s_add_u32 s30, s12, 32768
 buffer_load_dwordx4 a[156:159], v1, s[4:7], s30 offen offset:1024 sc1
 v_mfma_f32_16x16x32_bf16 v[76:79], v[140:143], a[108:111], v[76:79]
 ds_read_b128 v[132:135], v4 offset:12288
 v_mfma_f32_16x16x32_bf16 v[44:47], v[144:147], a[104:107], v[44:47]
 v_mfma_f32_16x16x32_bf16 v[80:83], v[144:147], a[108:111], v[80:83]
 ds_read_b128 v[136:139], v4 offset:13312
 v_mfma_f32_16x16x32_bf16 v[48:51], v[148:151], a[104:107], v[48:51]
 v_mfma_f32_16x16x32_bf16 v[84:87], v[148:151], a[108:111], v[84:87]
 ds_read_b128 v[140:143], v4 offset:14336
 s_waitcnt lgkmcnt(7)
 v_mfma_f32_16x16x32_bf16 v[52:55], v[104:107], a[104:107], v[52:55]
 v_mfma_f32_16x16x32_bf16 v[88:91], v[104:107], a[108:111], v[88:91]
 ds_read_b128 v[144:147], v4 offset:15360
 v_mfma_f32_16x16x32_bf16 v[56:59], v[108:111], a[104:107], v[56:59]
 v_mfma_f32_16x16x32_bf16 v[92:95], v[108:111], a[108:111], v[92:95]
 ds_read_b128 v[148:151], v4 offset:16384
 s_waitcnt vmcnt(21)
 v_mfma_f32_16x16x32_bf16 v[32:35], v[112:115], a[112:115], v[32:35]
 v_mfma_f32_16x16x32_bf16 v[68:71], v[112:115], a[116:119], v[68:71]
 ds_read_b128 v[104:107], v4 offset:17408
 s_waitcnt lgkmcnt(7)
 v_mfma_f32_16x16x32_bf16 v[36:39], v[116:119], a[112:115], v[36:39]
 v_mfma_f32_16x16x32_bf16 v[72:75], v[116:119], a[116:119], v[72:75]
 ds_read_b128 v[108:111], v4 offset:18432
 v_mfma_f32_16x16x32_bf16 v[40:43], v[120:123], a[112:115], v[40:43]
 v_mfma_f32_16x16x32_bf16 v[76:79], v[120:123], a[116:119], v[76:79]
 ds_read_b128 v[112:115], v4 offset:19456
 v_mfma_f32_16x16x32_bf16 v[44:47], v[124:127], a[112:115], v[44:47]
 v_mfma_f32_16x16x32_bf16 v[80:83], v[124:127], a[116:119], v[80:83]
 ds_read_b128 v[116:119], v4 offset:20480
 s_waitcnt lgkmcnt(7)
 v_mfma_f32_16x16x32_bf16 v[48:51], v[128:131], a[112:115], v[48:51]
 v_mfma_f32_16x16x32_bf16 v[84:87], v[128:131], a[116:119], v[84:87]
 s_barrier
 ds_read_b128 v[120:123], v2 offset:0
 v_mfma_f32_16x16x32_bf16 v[52:55], v[132:135], a[112:115], v[52:55]
 s_add_u32 s38, s79, 4096
 s_add_u32 m0, s83, 95232
 s_nop 0
 buffer_load_dwordx4 v1, s[4:7], s38 offen sc1 lds
 v_mfma_f32_16x16x32_bf16 v[88:91], v[132:135], a[116:119], v[88:91]
 ds_read_b128 v[124:127], v2 offset:1024
 v_mfma_f32_16x16x32_bf16 v[56:59], v[136:139], a[112:115], v[56:59]
 v_mfma_f32_16x16x32_bf16 v[92:95], v[136:139], a[116:119], v[92:95]
 ds_read_b128 v[128:131], v2 offset:2048
 s_waitcnt vmcnt(17) lgkmcnt(7)
 v_mfma_f32_16x16x32_bf16 v[32:35], v[140:143], a[120:123], v[32:35]
 s_add_u32 s38, s79, 151552
 s_add_u32 m0, s83, 96256
 s_nop 0
 buffer_load_dwordx4 v1, s[4:7], s38 offen sc1 lds
 v_mfma_f32_16x16x32_bf16 v[68:71], v[140:143], a[124:127], v[68:71]
 ds_read_b128 v[132:135], v2 offset:3072
 v_mfma_f32_16x16x32_bf16 v[36:39], v[144:147], a[120:123], v[36:39]
 s_add_u32 s38, s79, 299008
 s_add_u32 m0, s83, 97280
 s_nop 0
 buffer_load_dwordx4 v1, s[4:7], s38 offen sc1 lds
 v_mfma_f32_16x16x32_bf16 v[72:75], v[144:147], a[124:127], v[72:75]
 ds_read_b128 v[136:139], v2 offset:4096
 v_mfma_f32_16x16x32_bf16 v[40:43], v[148:151], a[120:123], v[40:43]
 v_mfma_f32_16x16x32_bf16 v[76:79], v[148:151], a[124:127], v[76:79]
 ds_read_b128 v[140:143], v2 offset:5120
 s_waitcnt lgkmcnt(7)
 v_mfma_f32_16x16x32_bf16 v[44:47], v[104:107], a[120:123], v[44:47]
 s_add_u32 s38, s79, 446464
 s_add_u32 m0, s83, 98304
 s_nop 0
 buffer_load_dwordx4 v1, s[4:7], s38 offen sc1 lds
 v_mfma_f32_16x16x32_bf16 v[80:83], v[104:107], a[124:127], v[80:83]
 ds_read_b128 v[144:147], v2 offset:6144
 v_mfma_f32_16x16x32_bf16 v[48:51], v[108:111], a[120:123], v[48:51]
 s_add_u32 s38, s79, 593920
 s_add_u32 m0, s83, 99328
 s_nop 0
 buffer_load_dwordx4 v1, s[4:7], s38 offen sc1 lds
 v_mfma_f32_16x16x32_bf16 v[84:87], v[108:111], a[124:127], v[84:87]
 ds_read_b128 v[148:151], v2 offset:7168
 v_mfma_f32_16x16x32_bf16 v[52:55], v[112:115], a[120:123], v[52:55]
 v_mfma_f32_16x16x32_bf16 v[88:91], v[112:115], a[124:127], v[88:91]
 ds_read_b128 v[104:107], v2 offset:8192
 s_waitcnt lgkmcnt(7)
 v_mfma_f32_16x16x32_bf16 v[56:59], v[116:119], a[120:123], v[56:59]
 s_add_u32 s38, s19, 741376
 s_add_u32 m0, s83, 100352
 s_nop 0
 buffer_load_dwordx4 v1, s[4:7], s38 offen sc1 lds
 v_mfma_f32_16x16x32_bf16 v[92:95], v[116:119], a[124:127], v[92:95]
 s_waitcnt vmcnt(8)
 v_cmp_eq_u32 vcc, 1, v13
 s_nop 0
 s_cmp_eq_u64 vcc, -1
 s_cbranch_scc1 K5L0_OK
 s_mov_b32 s39, 0x20000
K5L0:
 s_sleep 1
 buffer_load_dword v13, v14, s[4:7], s25 offen sc1
 s_waitcnt vmcnt(0)
 v_cmp_eq_u32 vcc, 1, v13
 s_nop 1
 s_cmp_eq_u64 vcc, -1
 s_cbranch_scc1 K5L0_OK
 s_sub_u32 s39, s39, 1
 s_cmp_lg_u32 s39, 0
 s_cbranch_scc1 K5L0
K5L0_OK:
 ds_read_b128 v[108:111], v2 offset:9216
 v_mfma_f32_16x16x32_bf16 v[32:35], v[120:123], a[128:131], v[32:35]
 s_add_u32 s30, s20, 0
 buffer_load_dwordx4 a[160:163], v1, s[4:7], s30 offen offset:3072 sc1
 v_mfma_f32_16x16x32_bf16 v[68:71], v[120:123], a[132:135], v[68:71]
 ds_read_b128 v[112:115], v2 offset:10240
 v_mfma_f32_16x16x32_bf16 v[36:39], v[124:127], a[128:131], v[36:39]
 v_mfma_f32_16x16x32_bf16 v[72:75], v[124:127], a[132:135], v[72:75]
 ds_read_b128 v[116:119], v2 offset:11264
 s_waitcnt lgkmcnt(7)
 v_mfma_f32_16x16x32_bf16 v[40:43], v[128:131], a[128:131], v[40:43]
 s_add_u32 s30, s12, 0
 buffer_load_dwordx4 a[164:167], v1, s[4:7], s30 offen offset:3072 sc1
 v_mfma_f32_16x16x32_bf16 v[76:79], v[128:131], a[132:135], v[76:79]
 ds_read_b128 v[120:123], v2 offset:12288
 v_mfma_f32_16x16x32_bf16 v[44:47], v[132:135], a[128:131], v[44:47]
 s_add_u32 s30, s20, 12288
 buffer_load_dwordx4 a[168:171], v1, s[4:7], s30 offen offset:0 sc1
 v_mfma_f32_16x16x32_bf16 v[80:83], v[132:135], a[132:135], v[80:83]
 ds_read_b128 v[124:127], v2 offset:13312
 v_mfma_f32_16x16x32_bf16 v[48:51], v[136:139], a[128:131], v[48:51]
 v_mfma_f32_16x16x32_bf16 v[84:87], v[136:139], a[132:135], v[84:87]
 ds_read_b128 v[128:131], v2 offset:14336
 s_waitcnt lgkmcnt(7)
 v_mfma_f32_16x16x32_bf16 v[52:55], v[140:143], a[128:131], v[52:55]
 s_add_u32 s30, s12, 12288
 buffer_load_dwordx4 a[172:175], v1, s[4:7], s30 offen offset:0 sc1
 v_mfma_f32_16x16x32_bf16 v[88:91], v[140:143], a[132:135], v[88:91]
 ds_read_b128 v[132:135], v2 offset:15360
 v_mfma_f32_16x16x32_bf16 v[56:59], v[144:147], a[128:131], v[56:59]
 s_add_u32 s38, s19, 888832
 s_add_u32 m0, s83, 101376
 s_nop 0
 buffer_load_dwordx4 v1, s[4:7], s38 offen sc1 lds
 v_mfma_f32_16x16x32_bf16 v[92:95], v[144:147], a[132:135], v[92:95]
 ds_read_b128 v[136:139], v2 offset:16384
 v_mfma_f32_16x16x32_bf16 v[32:35], v[148:151], a[136:139], v[32:35]
 v_mfma_f32_16x16x32_bf16 v[68:71], v[148:151], a[140:143], v[68:71]
 ds_read_b128 v[140:143], v2 offset:17408
 s_waitcnt lgkmcnt(7)
 v_mfma_f32_16x16x32_bf16 v[36:39], v[104:107], a[136:139], v[36:39]
 s_add_u32 s30, s20, 28672
 buffer_load_dwordx4 a[184:187], v1, s[4:7], s30 offen offset:2048 sc1
 v_mfma_f32_16x16x32_bf16 v[72:75], v[104:107], a[140:143], v[72:75]
 ds_read_b128 v[144:147], v2 offset:18432
 v_mfma_f32_16x16x32_bf16 v[40:43], v[108:111], a[136:139], v[40:43]
 s_add_u32 s30, s12, 28672
 buffer_load_dwordx4 a[188:191], v1, s[4:7], s30 offen offset:2048 sc1
 v_mfma_f32_16x16x32_bf16 v[76:79], v[108:111], a[140:143], v[76:79]
 ds_read_b128 v[148:151], v2 offset:19456
 v_mfma_f32_16x16x32_bf16 v[44:47], v[112:115], a[136:139], v[44:47]
 v_mfma_f32_16x16x32_bf16 v[80:83], v[112:115], a[140:143], v[80:83]
 ds_read_b128 v[104:107], v2 offset:20480
 s_waitcnt lgkmcnt(7)
 v_mfma_f32_16x16x32_bf16 v[48:51], v[116:119], a[136:139], v[48:51]
 s_add_u32 s30, s20, 20480
 buffer_load_dwordx4 a[176:179], v1, s[4:7], s30 offen offset:1024 sc1
 v_mfma_f32_16x16x32_bf16 v[84:87], v[116:119], a[140:143], v[84:87]
 ds_read_b128 v[108:111], v2 offset:21504
 v_mfma_f32_16x16x32_bf16 v[52:55], v[120:123], a[136:139], v[52:55]
 s_add_u32 s30, s12, 20480
 buffer_load_dwordx4 a[180:183], v1, s[4:7], s30 offen offset:1024 sc1
 v_mfma_f32_16x16x32_bf16 v[88:91], v[120:123], a[140:143], v[88:91]
 ds_read_b128 v[112:115], v2 offset:22528
 v_mfma_f32_16x16x32_bf16 v[56:59], v[124:127], a[136:139], v[56:59]
 v_mfma_f32_16x16x32_bf16 v[92:95], v[124:127], a[140:143], v[92:95]
 ds_read_b128 v[116:119], v2 offset:23552
 s_waitcnt lgkmcnt(7)
 v_mfma_f32_16x16x32_bf16 v[32:35], v[128:131], a[144:147], v[32:35]
 s_add_u32 s30, s20, 4096
 buffer_load_dwordx4 a[192:195], v1, s[4:7], s30 offen offset:3072 sc1
 v_mfma_f32_16x16x32_bf16 v[68:71], v[128:131], a[148:151], v[68:71]
 ds_read_b128 v[120:123], v2 offset:24576
 v_mfma_f32_16x16x32_bf16 v[36:39], v[132:135], a[144:147], v[36:39]
 v_mfma_f32_16x16x32_bf16 v[72:75], v[132:135], a[148:151], v[72:75]
 ds_read_b128 v[124:127], v2 offset:25600
 v_mfma_f32_16x16x32_bf16 v[40:43], v[136:139], a[144:147], v[40:43]
 s_add_u32 s30, s12, 4096
 buffer_load_dwordx4 a[196:199], v1, s[4:7], s30 offen offset:3072 sc1
 v_mfma_f32_16x16x32_bf16 v[76:79], v[136:139], a[148:151], v[76:79]
 ds_read_b128 v[128:131], v2 offset:26624
 s_waitcnt lgkmcnt(7)
 v_mfma_f32_16x16x32_bf16 v[44:47], v[140:143], a[144:147], v[44:47]
 v_mfma_f32_16x16x32_bf16 v[80:83], v[140:143], a[148:151], v[80:83]
 ds_read_b128 v[132:135], v2 offset:27648
 v_mfma_f32_16x16x32_bf16 v[48:51], v[144:147], a[144:147], v[48:51]
 v_mfma_f32_16x16x32_bf16 v[84:87], v[144:147], a[148:151], v[84:87]
 s_barrier
 ds_read_b128 v[136:139], v2 offset:37888
 v_mfma_f32_16x16x32_bf16 v[52:55], v[148:151], a[144:147], v[52:55]
 s_add_u32 s38, s79, 8192
 s_add_u32 m0, s83, 123904
 s_nop 0
 buffer_load_dwordx4 v1, s[4:7], s38 offen sc1 lds
 v_mfma_f32_16x16x32_bf16 v[88:91], v[148:151], a[148:151], v[88:91]
 ds_read_b128 v[140:143], v2 offset:38912
 s_waitcnt lgkmcnt(7)
 v_mfma_f32_16x16x32_bf16 v[56:59], v[104:107], a[144:147], v[56:59]
 v_mfma_f32_16x16x32_bf16 v[92:95], v[104:107], a[148:151], v[92:95]
 ds_read_b128 v[144:147], v2 offset:39936
 s_waitcnt vmcnt(18)
 v_mfma_f32_16x16x32_bf16 v[32:35], v[108:111], a[152:155], v[32:35]
 s_add_u32 s30, s20, 16384
 buffer_load_dwordx4 a[200:203], v1, s[4:7], s30 offen offset:0 sc1
 v_mfma_f32_16x16x32_bf16 v[68:71], v[108:111], a[156:159], v[68:71]
 ds_read_b128 v[148:151], v2 offset:40960
 v_mfma_f32_16x16x32_bf16 v[36:39], v[112:115], a[152:155], v[36:39]
 s_add_u32 s30, s12, 16384
 buffer_load_dwordx4 a[204:207], v1, s[4:7], s30 offen offset:0 sc1
 v_mfma_f32_16x16x32_bf16 v[72:75], v[112:115], a[156:159], v[72:75]
 ds_read_b128 v[104:107], v2 offset:41984
 s_waitcnt lgkmcnt(7)
 v_mfma_f32_16x16x32_bf16 v[40:43], v[116:119], a[152:155], v[40:43]
 v_mfma_f32_16x16x32_bf16 v[76:79], v[116:119], a[156:159], v[76:79]
 ds_read_b128 v[108:111], v2 offset:43008
 v_mfma_f32_16x16x32_bf16 v[44:47], v[120:123], a[152:155], v[44:47]
 s_add_u32 s38, s79, 155648
 s_add_u32 m0, s83, 124928
 s_nop 0
 buffer_load_dwordx4 v1, s[4:7], s38 offen sc1 lds
 v_mfma_f32_16x16x32_bf16 v[80:83], v[120:123], a[156:159], v[80:83]
 ds_read_b128 v[112:115], v2 offset:44032
 v_mfma_f32_16x16x32_bf16 v[48:51], v[124:127], a[152:155], v[48:51]
 s_add_u32 s38, s79, 303104
 s_add_u32 m0, s83, 125952
 s_nop 0
 buffer_load_dwordx4 v1, s[4:7], s38 offen sc1 lds
 v_mfma_f32_16x16x32_bf16 v[84:87], v[124:127], a[156:159], v[84:87]
 ds_read_b128 v[116:119], v2 offset:45056
 s_waitcnt lgkmcnt(7)
 v_mfma_f32_16x16x32_bf16 v[52:55], v[128:131], a[152:155], v[52:55]
 v_mfma_f32_16x16x32_bf16 v[88:91], v[128:131], a[156:159], v[88:91]
 ds_read_b128 v[120:123], v2 offset:46080
 v_mfma_f32_16x16x32_bf16 v[56:59], v[132:135], a[152:155], v[56:59]
 s_add_u32 s38, s79, 450560
 s_add_u32 m0, s83, 126976
 s_nop 0
 buffer_load_dwordx4 v1, s[4:7], s38 offen sc1 lds
 v_mfma_f32_16x16x32_bf16 v[92:95], v[132:135], a[156:159], v[92:95]
 ds_read_b128 v[124:127], v2 offset:47104
 s_waitcnt vmcnt(15)
 v_mfma_f32_16x16x32_bf16 v[32:35], v[136:139], a[160:163], v[32:35]
 s_add_u32 s30, s20, 24576
 buffer_load_dwordx4 a[208:211], v1, s[4:7], s30 offen offset:1024 sc1
 v_mfma_f32_16x16x32_bf16 v[68:71], v[136:139], a[164:167], v[68:71]
 ds_read_b128 v[128:131], v2 offset:48128
 s_waitcnt lgkmcnt(7)
 v_mfma_f32_16x16x32_bf16 v[36:39], v[140:143], a[160:163], v[36:39]
 v_mfma_f32_16x16x32_bf16 v[72:75], v[140:143], a[164:167], v[72:75]
 ds_read_b128 v[132:135], v2 offset:49152
 v_mfma_f32_16x16x32_bf16 v[40:43], v[144:147], a[160:163], v[40:43]
 s_add_u32 s30, s12, 24576
 buffer_load_dwordx4 a[212:215], v1, s[4:7], s30 offen offset:1024 sc1
 v_mfma_f32_16x16x32_bf16 v[76:79], v[144:147], a[164:167], v[76:79]
 ds_read_b128 v[136:139], v2 offset:50176
 v_mfma_f32_16x16x32_bf16 v[44:47], v[148:151], a[160:163], v[44:47]
 s_add_u32 s38, s79, 598016
 s_add_u32 m0, s83, 128000
 s_nop 0
 buffer_load_dwordx4 v1, s[4:7], s38 offen sc1 lds
 v_mfma_f32_16x16x32_bf16 v[80:83], v[148:151], a[164:167], v[80:83]
 ds_read_b128 v[140:143], v2 offset:51200
 s_waitcnt lgkmcnt(7)
 v_mfma_f32_16x16x32_bf16 v[48:51], v[104:107], a[160:163], v[48:51]
 v_mfma_f32_16x16x32_bf16 v[84:87], v[104:107], a[164:167], v[84:87]
 ds_read_b128 v[144:147], v2 offset:52224
 v_mfma_f32_16x16x32_bf16 v[52:55], v[108:111], a[160:163], v[52:55]
 s_add_u32 s38, s19, 745472
 s_add_u32 m0, s83, 129024
 s_nop 0
 buffer_load_dwordx4 v1, s[4:7], s38 offen sc1 lds
 v_mfma_f32_16x16x32_bf16 v[88:91], v[108:111], a[164:167], v[88:91]
 ds_read_b128 v[148:151], v2 offset:53248
 v_mfma_f32_16x16x32_bf16 v[56:59], v[112:115], a[160:163], v[56:59]
 s_add_u32 s38, s19, 892928
 s_add_u32 m0, s83, 130048
 s_nop 0
 buffer_load_dwordx4 v1, s[4:7], s38 offen sc1 lds
 v_mfma_f32_16x16x32_bf16 v[92:95], v[112:115], a[164:167], v[92:95]
 ds_read_b128 v[104:107], v2 offset:54272
 s_waitcnt vmcnt(18) lgkmcnt(7)
 v_mfma_f32_16x16x32_bf16 v[32:35], v[116:119], a[168:171], v[32:35]
 s_add_u32 s30, s20, 32768
 buffer_load_dwordx4 a[216:219], v1, s[4:7], s30 offen offset:2048 sc1
 v_mfma_f32_16x16x32_bf16 v[68:71], v[116:119], a[172:175], v[68:71]
 ds_read_b128 v[108:111], v2 offset:55296
 v_mfma_f32_16x16x32_bf16 v[36:39], v[120:123], a[168:171], v[36:39]
 v_mfma_f32_16x16x32_bf16 v[72:75], v[120:123], a[172:175], v[72:75]
 ds_read_b128 v[112:115], v2 offset:56320
 v_mfma_f32_16x16x32_bf16 v[40:43], v[124:127], a[168:171], v[40:43]
 s_add_u32 s30, s12, 32768
 buffer_load_dwordx4 a[220:223], v1, s[4:7], s30 offen offset:2048 sc1
 v_mfma_f32_16x16x32_bf16 v[76:79], v[124:127], a[172:175], v[76:79]
 ds_read_b128 v[116:119], v2 offset:57344
 s_waitcnt lgkmcnt(7)
 v_mfma_f32_16x16x32_bf16 v[44:47], v[128:131], a[168:171], v[44:47]
 v_mfma_f32_16x16x32_bf16 v[80:83], v[128:131], a[172:175], v[80:83]
 ds_read_b128 v[120:123], v2 offset:58368
 v_mfma_f32_16x16x32_bf16 v[48:51], v[132:135], a[168:171], v[48:51]
 v_mfma_f32_16x16x32_bf16 v[84:87], v[132:135], a[172:175], v[84:87]
 ds_read_b128 v[124:127], v2 offset:59392
 v_mfma_f32_16x16x32_bf16 v[52:55], v[136:139], a[168:171], v[52:55]
 v_mfma_f32_16x16x32_bf16 v[88:91], v[136:139], a[172:175], v[88:91]
 ds_read_b128 v[128:131], v2 offset:60416
 s_waitcnt lgkmcnt(7)
 v_mfma_f32_16x16x32_bf16 v[56:59], v[140:143], a[168:171], v[56:59]
 v_mfma_f32_16x16x32_bf16 v[92:95], v[140:143], a[172:175], v[92:95]
 ds_read_b128 v[132:135], v2 offset:61440
 s_waitcnt vmcnt(15)
 v_mfma_f32_16x16x32_bf16 v[32:35], v[144:147], a[176:179], v[32:35]
 s_add_u32 s30, s20, 4096
 buffer_load_dwordx4 a[224:227], v1, s[4:7], s30 offen offset:0 sc1
 v_mfma_f32_16x16x32_bf16 v[68:71], v[144:147], a[180:183], v[68:71]
 ds_read_b128 v[136:139], v2 offset:62464
 v_mfma_f32_16x16x32_bf16 v[36:39], v[148:151], a[176:179], v[36:39]
 v_mfma_f32_16x16x32_bf16 v[72:75], v[148:151], a[180:183], v[72:75]
 ds_read_b128 v[140:143], v2 offset:63488
 s_waitcnt lgkmcnt(7)
 v_mfma_f32_16x16x32_bf16 v[40:43], v[104:107], a[176:179], v[40:43]
 s_add_u32 s30, s12, 4096
 buffer_load_dwordx4 a[228:231], v1, s[4:7], s30 offen offset:0 sc1
 v_mfma_f32_16x16x32_bf16 v[76:79], v[104:107], a[180:183], v[76:79]
 ds_read_b128 v[144:147], v2 offset:64512
 v_mfma_f32_16x16x32_bf16 v[44:47], v[108:111], a[176:179], v[44:47]
 v_mfma_f32_16x16x32_bf16 v[80:83], v[108:111], a[180:183], v[80:83]
 ds_read_b128 v[148:151], v3 offset:0
 v_mfma_f32_16x16x32_bf16 v[48:51], v[112:115], a[176:179], v[48:51]
 v_mfma_f32_16x16x32_bf16 v[84:87], v[112:115], a[180:183], v[84:87]
 s_barrier
 ds_read_b128 v[104:107], v3 offset:1024
 s_waitcnt lgkmcnt(7)
 v_mfma_f32_16x16x32_bf16 v[52:55], v[116:119], a[176:179], v[52:55]
 s_add_u32 s38, s19, 1032192
 s_add_u32 m0, s14, 0
 s_nop 0
 buffer_load_dwordx4 v1, s[4:7], s38 offen sc1 lds
 v_mfma_f32_16x16x32_bf16 v[88:91], v[116:119], a[180:183], v[88:91]
 ds_read_b128 v[108:111], v3 offset:2048
 v_mfma_f32_16x16x32_bf16 v[56:59], v[120:123], a[176:179], v[56:59]
 v_mfma_f32_16x16x32_bf16 v[92:95], v[120:123], a[180:183], v[92:95]
 ds_read_b128 v[112:115], v3 offset:3072
 v_mfma_f32_16x16x32_bf16 v[32:35], v[124:127], a[184:187], v[32:35]
 s_add_u32 s30, s20, 12288
 buffer_load_dwordx4 a[232:235], v1, s[4:7], s30 offen offset:1024 sc1
 v_mfma_f32_16x16x32_bf16 v[68:71], v[124:127], a[188:191], v[68:71]
 ds_read_b128 v[116:119], v3 offset:4096
 s_waitcnt lgkmcnt(7)
 v_mfma_f32_16x16x32_bf16 v[36:39], v[128:131], a[184:187], v[36:39]
 s_add_u32 s30, s12, 12288
 buffer_load_dwordx4 a[236:239], v1, s[4:7], s30 offen offset:1024 sc1
 v_mfma_f32_16x16x32_bf16 v[72:75], v[128:131], a[188:191], v[72:75]
 ds_read_b128 v[120:123], v3 offset:5120
 v_mfma_f32_16x16x32_bf16 v[40:43], v[132:135], a[184:187], v[40:43]
 v_mfma_f32_16x16x32_bf16 v[76:79], v[132:135], a[188:191], v[76:79]
 ds_read_b128 v[124:127], v3 offset:6144
 v_mfma_f32_16x16x32_bf16 v[44:47], v[136:139], a[184:187], v[44:47]
 s_add_u32 s38, s19, 1179648
 s_add_u32 m0, s14, 1024
 s_nop 0
 buffer_load_dwordx4 v1, s[4:7], s38 offen sc1 lds
 v_mfma_f32_16x16x32_bf16 v[80:83], v[136:139], a[188:191], v[80:83]
 ds_read_b128 v[128:131], v3 offset:7168
 s_waitcnt lgkmcnt(7)
 v_mfma_f32_16x16x32_bf16 v[48:51], v[140:143], a[184:187], v[48:51]
 s_add_u32 s38, s19, 1033216
 s_add_u32 m0, s14, 8192
 s_nop 0
 buffer_load_dwordx4 v1, s[4:7], s38 offen sc1 lds
 v_mfma_f32_16x16x32_bf16 v[84:87], v[140:143], a[188:191], v[84:87]
 ds_read_b128 v[132:135], v3 offset:8192
 v_mfma_f32_16x16x32_bf16 v[52:55], v[144:147], a[184:187], v[52:55]
 v_mfma_f32_16x16x32_bf16 v[88:91], v[144:147], a[188:191], v[88:91]
 ds_read_b128 v[136:139], v3 offset:9216
 v_mfma_f32_16x16x32_bf16 v[56:59], v[148:151], a[184:187], v[56:59]
 s_add_u32 s38, s19, 1180672
 s_add_u32 m0, s14, 9216
 s_nop 0
 buffer_load_dwordx4 v1, s[4:7], s38 offen sc1 lds
 v_mfma_f32_16x16x32_bf16 v[92:95], v[148:151], a[188:191], v[92:95]
 ds_read_b128 v[140:143], v3 offset:10240
 s_waitcnt vmcnt(21) lgkmcnt(7)
 v_mfma_f32_16x16x32_bf16 v[32:35], v[104:107], a[192:195], v[32:35]
 s_add_u32 s30, s20, 20480
 buffer_load_dwordx4 a[240:243], v1, s[4:7], s30 offen offset:2048 sc1
 v_mfma_f32_16x16x32_bf16 v[68:71], v[104:107], a[196:199], v[68:71]
 ds_read_b128 v[144:147], v3 offset:11264
 v_mfma_f32_16x16x32_bf16 v[36:39], v[108:111], a[192:195], v[36:39]
 v_mfma_f32_16x16x32_bf16 v[72:75], v[108:111], a[196:199], v[72:75]
 ds_read_b128 v[148:151], v3 offset:12288
 v_mfma_f32_16x16x32_bf16 v[40:43], v[112:115], a[192:195], v[40:43]
 s_add_u32 s30, s12, 20480
 buffer_load_dwordx4 a[244:247], v1, s[4:7], s30 offen offset:2048 sc1
 v_mfma_f32_16x16x32_bf16 v[76:79], v[112:115], a[196:199], v[76:79]
 ds_read_b128 v[104:107], v3 offset:13312
 s_waitcnt lgkmcnt(7)
 v_mfma_f32_16x16x32_bf16 v[44:47], v[116:119], a[192:195], v[44:47]
 s_add_u32 s38, s19, 1034240
 s_add_u32 m0, s14, 16384
 s_nop 0
 buffer_load_dwordx4 v1, s[4:7], s38 offen sc1 lds
 v_mfma_f32_16x16x32_bf16 v[80:83], v[116:119], a[196:199], v[80:83]
 ds_read_b128 v[108:111], v3 offset:14336
 v_mfma_f32_16x16x32_bf16 v[48:51], v[120:123], a[192:195], v[48:51]
 v_mfma_f32_16x16x32_bf16 v[84:87], v[120:123], a[196:199], v[84:87]
 ds_read_b128 v[112:115], v3 offset:15360
 v_mfma_f32_16x16x32_bf16 v[52:55], v[124:127], a[192:195], v[52:55]
 s_add_u32 s38, s19, 1181696
 s_add_u32 m0, s14, 17408
 s_nop 0
 buffer_load_dwordx4 v1, s[4:7], s38 offen sc1 lds
 v_mfma_f32_16x16x32_bf16 v[88:91], v[124:127], a[196:199], v[88:91]
 ds_read_b128 v[116:119], v3 offset:16384
 s_waitcnt lgkmcnt(7)
 v_mfma_f32_16x16x32_bf16 v[56:59], v[128:131], a[192:195], v[56:59]
 v_mfma_f32_16x16x32_bf16 v[92:95], v[128:131], a[196:199], v[92:95]
 ds_read_b128 v[120:123], v3 offset:17408
 s_waitcnt vmcnt(22)
 v_mfma_f32_16x16x32_bf16 v[32:35], v[132:135], a[200:203], v[32:35]
 s_add_u32 s30, s20, 28672
 buffer_load_dwordx4 a[248:251], v1, s[4:7], s30 offen offset:3072 sc1
 v_mfma_f32_16x16x32_bf16 v[68:71], v[132:135], a[204:207], v[68:71]
 ds_read_b128 v[124:127], v3 offset:18432
 v_mfma_f32_16x16x32_bf16 v[36:39], v[136:139], a[200:203], v[36:39]
 v_mfma_f32_16x16x32_bf16 v[72:75], v[136:139], a[204:207], v[72:75]
 ds_read_b128 v[128:131], v3 offset:19456
 s_waitcnt lgkmcnt(7)
 v_mfma_f32_16x16x32_bf16 v[40:43], v[140:143], a[200:203], v[40:43]
 s_add_u32 s30, s12, 28672
 buffer_load_dwordx4 a[252:255], v1, s[4:7], s30 offen offset:3072 sc1
 v_mfma_f32_16x16x32_bf16 v[76:79], v[140:143], a[204:207], v[76:79]
 ds_read_b128 v[132:135], v3 offset:20480
 v_mfma_f32_16x16x32_bf16 v[44:47], v[144:147], a[200:203], v[44:47]
 v_mfma_f32_16x16x32_bf16 v[80:83], v[144:147], a[204:207], v[80:83]
 ds_read_b128 v[136:139], v3 offset:21504
 v_mfma_f32_16x16x32_bf16 v[48:51], v[148:151], a[200:203], v[48:51]
 v_mfma_f32_16x16x32_bf16 v[84:87], v[148:151], a[204:207], v[84:87]
 ds_read_b128 v[140:143], v3 offset:22528
 s_waitcnt lgkmcnt(7)
 v_mfma_f32_16x16x32_bf16 v[52:55], v[104:107], a[200:203], v[52:55]
 v_mfma_f32_16x16x32_bf16 v[88:91], v[104:107], a[204:207], v[88:91]
 ds_read_b128 v[144:147], v3 offset:23552
 v_mfma_f32_16x16x32_bf16 v[56:59], v[108:111], a[200:203], v[56:59]
 v_mfma_f32_16x16x32_bf16 v[92:95], v[108:111], a[204:207], v[92:95]
 ds_read_b128 v[148:151], v3 offset:24576
 s_waitcnt vmcnt(19)
 v_mfma_f32_16x16x32_bf16 v[32:35], v[112:115], a[208:211], v[32:35]
 s_add_u32 s30, s20, 8192
 buffer_load_dwordx4 v[168:171], v1, s[4:7], s30 offen offset:0 sc1
 v_mfma_f32_16x16x32_bf16 v[68:71], v[112:115], a[212:215], v[68:71]
 ds_read_b128 v[104:107], v3 offset:25600
 s_waitcnt lgkmcnt(7)
 v_mfma_f32_16x16x32_bf16 v[36:39], v[116:119], a[208:211], v[36:39]
 v_mfma_f32_16x16x32_bf16 v[72:75], v[116:119], a[212:215], v[72:75]
 ds_read_b128 v[108:111], v3 offset:26624
 v_mfma_f32_16x16x32_bf16 v[40:43], v[120:123], a[208:211], v[40:43]
 s_add_u32 s30, s12, 8192
 buffer_load_dwordx4 v[172:175], v1, s[4:7], s30 offen offset:0 sc1
 v_mfma_f32_16x16x32_bf16 v[76:79], v[120:123], a[212:215], v[76:79]
 ds_read_b128 v[112:115], v3 offset:27648
 v_mfma_f32_16x16x32_bf16 v[44:47], v[124:127], a[208:211], v[44:47]
 v_mfma_f32_16x16x32_bf16 v[80:83], v[124:127], a[212:215], v[80:83]
 ds_read_b128 v[116:119], v3 offset:28672
 s_waitcnt lgkmcnt(7)
 v_mfma_f32_16x16x32_bf16 v[48:51], v[128:131], a[208:211], v[48:51]
 v_mfma_f32_16x16x32_bf16 v[84:87], v[128:131], a[212:215], v[84:87]
 s_barrier
 ds_read_b128 v[120:123], v3 offset:29696
 v_mfma_f32_16x16x32_bf16 v[52:55], v[132:135], a[208:211], v[52:55]
 s_add_u32 s38, s19, 1037312
 s_add_u32 m0, s14, 37888
 s_nop 0
 buffer_load_dwordx4 v1, s[4:7], s38 offen sc1 lds
 v_mfma_f32_16x16x32_bf16 v[88:91], v[132:135], a[212:215], v[88:91]
 ds_read_b128 v[124:127], v3 offset:30720
 v_mfma_f32_16x16x32_bf16 v[56:59], v[136:139], a[208:211], v[56:59]
 v_mfma_f32_16x16x32_bf16 v[92:95], v[136:139], a[212:215], v[92:95]
 ds_read_b128 v[128:131], v3 offset:31744
 s_waitcnt vmcnt(17) lgkmcnt(7)
 v_mfma_f32_16x16x32_bf16 v[32:35], v[140:143], a[216:219], v[32:35]
 s_add_u32 s30, s20, 16384
 buffer_load_dwordx4 v[176:179], v1, s[4:7], s30 offen offset:1024 sc1
 v_mfma_f32_16x16x32_bf16 v[68:71], v[140:143], a[220:223], v[68:71]
 ds_read_b128 v[132:135], v3 offset:32768
 v_mfma_f32_16x16x32_bf16 v[36:39], v[144:147], a[216:219], v[36:39]
 s_add_u32 s30, s12, 16384
 buffer_load_dwordx4 v[180:183], v1, s[4:7], s30 offen offset:1024 sc1
 v_mfma_f32_16x16x32_bf16 v[72:75], v[144:147], a[220:223], v[72:75]
 ds_read_b128 v[136:139], v3 offset:33792
 v_mfma_f32_16x16x32_bf16 v[40:43], v[148:151], a[216:219], v[40:43]
 v_mfma_f32_16x16x32_bf16 v[76:79], v[148:151], a[220:223], v[76:79]
 ds_read_b128 v[140:143], v3 offset:34816
 s_waitcnt lgkmcnt(7)
 v_mfma_f32_16x16x32_bf16 v[44:47], v[104:107], a[216:219], v[44:47]
 s_add_u32 s38, s19, 1184768
 s_add_u32 m0, s14, 38912
 s_nop 0
 buffer_load_dwordx4 v1, s[4:7], s38 offen sc1 lds
 v_mfma_f32_16x16x32_bf16 v[80:83], v[104:107], a[220:223], v[80:83]
 ds_read_b128 v[144:147], v3 offset:35840
 v_mfma_f32_16x16x32_bf16 v[48:51], v[108:111], a[216:219], v[48:51]
 s_add_u32 s38, s19, 1038336
 s_add_u32 m0, s14, 46080
 s_nop 0
 buffer_load_dwordx4 v1, s[4:7], s38 offen sc1 lds
 v_mfma_f32_16x16x32_bf16 v[84:87], v[108:111], a[220:223], v[84:87]
 ds_read_b128 v[148:151], v3 offset:36864
 v_mfma_f32_16x16x32_bf16 v[52:55], v[112:115], a[216:219], v[52:55]
 v_mfma_f32_16x16x32_bf16 v[88:91], v[112:115], a[220:223], v[88:91]
 ds_read_b128 v[104:107], v3 offset:37888
 s_waitcnt lgkmcnt(7)
 v_mfma_f32_16x16x32_bf16 v[56:59], v[116:119], a[216:219], v[56:59]
 s_add_u32 s38, s19, 1185792
 s_add_u32 m0, s14, 47104
 s_nop 0
 buffer_load_dwordx4 v1, s[4:7], s38 offen sc1 lds
 v_mfma_f32_16x16x32_bf16 v[92:95], v[116:119], a[220:223], v[92:95]
 ds_read_b128 v[108:111], v3 offset:38912
 s_waitcnt vmcnt(20)
 v_mfma_f32_16x16x32_bf16 v[32:35], v[120:123], a[224:227], v[32:35]
 s_add_u32 s30, s20, 24576
 buffer_load_dwordx4 v[184:187], v1, s[4:7], s30 offen offset:2048 sc1
 v_mfma_f32_16x16x32_bf16 v[68:71], v[120:123], a[228:231], v[68:71]
 ds_read_b128 v[112:115], v3 offset:39936
 v_mfma_f32_16x16x32_bf16 v[36:39], v[124:127], a[224:227], v[36:39]
 v_mfma_f32_16x16x32_bf16 v[72:75], v[124:127], a[228:231], v[72:75]
 ds_read_b128 v[116:119], v3 offset:40960
 s_waitcnt lgkmcnt(7)
 v_mfma_f32_16x16x32_bf16 v[40:43], v[128:131], a[224:227], v[40:43]
 s_add_u32 s30, s12, 24576
 buffer_load_dwordx4 v[188:191], v1, s[4:7], s30 offen offset:2048 sc1
 v_mfma_f32_16x16x32_bf16 v[76:79], v[128:131], a[228:231], v[76:79]
 ds_read_b128 v[120:123], v3 offset:41984
 v_mfma_f32_16x16x32_bf16 v[44:47], v[132:135], a[224:227], v[44:47]
 s_add_u32 s38, s19, 1035264
 s_add_u32 m0, s14, 54272
 s_nop 0
 buffer_load_dwordx4 v1, s[4:7], s38 offen sc1 lds
 v_mfma_f32_16x16x32_bf16 v[80:83], v[132:135], a[228:231], v[80:83]
 ds_read_b128 v[124:127], v3 offset:43008
 v_mfma_f32_16x16x32_bf16 v[48:51], v[136:139], a[224:227], v[48:51]
 v_mfma_f32_16x16x32_bf16 v[84:87], v[136:139], a[228:231], v[84:87]
 ds_read_b128 v[128:131], v3 offset:44032
 s_waitcnt lgkmcnt(7)
 v_mfma_f32_16x16x32_bf16 v[52:55], v[140:143], a[224:227], v[52:55]
 s_add_u32 s38, s19, 1182720
 s_add_u32 m0, s14, 55296
 s_nop 0
 buffer_load_dwordx4 v1, s[4:7], s38 offen sc1 lds
 v_mfma_f32_16x16x32_bf16 v[88:91], v[140:143], a[228:231], v[88:91]
 ds_read_b128 v[132:135], v3 offset:45056
 v_mfma_f32_16x16x32_bf16 v[56:59], v[144:147], a[224:227], v[56:59]
 v_mfma_f32_16x16x32_bf16 v[92:95], v[144:147], a[228:231], v[92:95]
 ds_read_b128 v[136:139], v3 offset:46080
 s_waitcnt vmcnt(21)
 v_mfma_f32_16x16x32_bf16 v[32:35], v[148:151], a[232:235], v[32:35]
 s_add_u32 s30, s20, 32768
 buffer_load_dwordx4 v[192:195], v1, s[4:7], s30 offen offset:3072 sc1
 v_mfma_f32_16x16x32_bf16 v[68:71], v[148:151], a[236:239], v[68:71]
 ds_read_b128 v[140:143], v3 offset:47104
 s_waitcnt lgkmcnt(7)
 v_mfma_f32_16x16x32_bf16 v[36:39], v[104:107], a[232:235], v[36:39]
 v_mfma_f32_16x16x32_bf16 v[72:75], v[104:107], a[236:239], v[72:75]
 ds_read_b128 v[144:147], v3 offset:48128
 v_mfma_f32_16x16x32_bf16 v[40:43], v[108:111], a[232:235], v[40:43]
 s_add_u32 s30, s12, 32768
 buffer_load_dwordx4 v[196:199], v1, s[4:7], s30 offen offset:3072 sc1
 v_mfma_f32_16x16x32_bf16 v[76:79], v[108:111], a[236:239], v[76:79]
 ds_read_b128 v[148:151], v3 offset:49152
 v_mfma_f32_16x16x32_bf16 v[44:47], v[112:115], a[232:235], v[44:47]
 v_mfma_f32_16x16x32_bf16 v[80:83], v[112:115], a[236:239], v[80:83]
 ds_read_b128 v[104:107], v3 offset:50176
 s_waitcnt lgkmcnt(7)
 v_mfma_f32_16x16x32_bf16 v[48:51], v[116:119], a[232:235], v[48:51]
 v_mfma_f32_16x16x32_bf16 v[84:87], v[116:119], a[236:239], v[84:87]
 ds_read_b128 v[108:111], v3 offset:51200
 v_mfma_f32_16x16x32_bf16 v[52:55], v[120:123], a[232:235], v[52:55]
 v_mfma_f32_16x16x32_bf16 v[88:91], v[120:123], a[236:239], v[88:91]
 ds_read_b128 v[112:115], v3 offset:52224
 v_mfma_f32_16x16x32_bf16 v[56:59], v[124:127], a[232:235], v[56:59]
 v_mfma_f32_16x16x32_bf16 v[92:95], v[124:127], a[236:239], v[92:95]
 ds_read_b128 v[116:119], v3 offset:53248
 s_waitcnt vmcnt(18) lgkmcnt(7)
 v_mfma_f32_16x16x32_bf16 v[32:35], v[128:131], a[240:243], v[32:35]
 buffer_load_dwordx2 v[16:17], v11, s[4:7], s28 offen offset:0 sc1
 v_mfma_f32_16x16x32_bf16 v[68:71], v[128:131], a[244:247], v[68:71]
 ds_read_b128 v[120:123], v3 offset:54272
 v_mfma_f32_16x16x32_bf16 v[36:39], v[132:135], a[240:243], v[36:39]
 v_mfma_f32_16x16x32_bf16 v[72:75], v[132:135], a[244:247], v[72:75]
 ds_read_b128 v[124:127], v3 offset:55296
 v_mfma_f32_16x16x32_bf16 v[40:43], v[136:139], a[240:243], v[40:43]
 buffer_load_dwordx2 v[18:19], v11, s[4:7], s28 offen offset:1024 sc1
 v_mfma_f32_16x16x32_bf16 v[76:79], v[136:139], a[244:247], v[76:79]
 ds_read_b128 v[128:131], v3 offset:56320
 s_waitcnt lgkmcnt(7)
 v_mfma_f32_16x16x32_bf16 v[44:47], v[140:143], a[240:243], v[44:47]
 buffer_load_dwordx2 v[20:21], v11, s[4:7], s28 offen offset:2048 sc1
 v_mfma_f32_16x16x32_bf16 v[80:83], v[140:143], a[244:247], v[80:83]
 ds_read_b128 v[132:135], v3 offset:57344
 v_mfma_f32_16x16x32_bf16 v[48:51], v[144:147], a[240:243], v[48:51]
 v_mfma_f32_16x16x32_bf16 v[84:87], v[144:147], a[244:247], v[84:87]
 s_barrier
 ds_read_b128 v[136:139], v3 offset:58368
 v_mfma_f32_16x16x32_bf16 v[52:55], v[148:151], a[240:243], v[52:55]
 buffer_load_dwordx2 v[22:23], v11, s[4:7], s28 offen offset:3072 sc1
 v_mfma_f32_16x16x32_bf16 v[88:91], v[148:151], a[244:247], v[88:91]
 ds_read_b128 v[140:143], v3 offset:59392
 s_waitcnt lgkmcnt(7)
 v_mfma_f32_16x16x32_bf16 v[56:59], v[104:107], a[240:243], v[56:59]
 s_add_u32 s38, s19, 1039360
 s_add_u32 m0, s14, 66560
 s_nop 0
 buffer_load_dwordx4 v1, s[4:7], s38 offen sc1 lds
 v_mfma_f32_16x16x32_bf16 v[92:95], v[104:107], a[244:247], v[92:95]
 ds_read_b128 v[144:147], v3 offset:60416
 s_waitcnt vmcnt(19)
 v_mfma_f32_16x16x32_bf16 v[32:35], v[108:111], a[248:251], v[32:35]
 v_mfma_f32_16x16x32_bf16 v[68:71], v[108:111], a[252:255], v[68:71]
 ds_read_b128 v[148:151], v3 offset:61440
 v_mfma_f32_16x16x32_bf16 v[36:39], v[112:115], a[248:251], v[36:39]
 s_add_u32 s38, s19, 1186816
 s_add_u32 m0, s14, 67584
 s_nop 0
 buffer_load_dwordx4 v1, s[4:7], s38 offen sc1 lds
 v_mfma_f32_16x16x32_bf16 v[72:75], v[112:115], a[252:255], v[72:75]
 ds_read_b128 v[104:107], v3 offset:62464
 s_waitcnt lgkmcnt(7)
 v_mfma_f32_16x16x32_bf16 v[40:43], v[116:119], a[248:251], v[40:43]
 s_add_u32 s38, s19, 1036288
 s_add_u32 m0, s14, 74752
 s_nop 0
 buffer_load_dwordx4 v1, s[4:7], s38 offen sc1 lds
 v_mfma_f32_16x16x32_bf16 v[76:79], v[116:119], a[252:255], v[76:79]
 ds_read_b128 v[108:111], v3 offset:63488
 v_mfma_f32_16x16x32_bf16 v[44:47], v[120:123], a[248:251], v[44:47]
 v_mfma_f32_16x16x32_bf16 v[80:83], v[120:123], a[252:255], v[80:83]
 ds_read_b128 v[112:115], v3 offset:64512
 v_mfma_f32_16x16x32_bf16 v[48:51], v[124:127], a[248:251], v[48:51]
 s_add_u32 s38, s19, 1183744
 s_add_u32 m0, s14, 75776
 s_nop 0
 buffer_load_dwordx4 v1, s[4:7], s38 offen sc1 lds
 v_mfma_f32_16x16x32_bf16 v[84:87], v[124:127], a[252:255], v[84:87]
 ds_read_b128 v[116:119], v4 offset:0
 s_waitcnt lgkmcnt(7)
 v_mfma_f32_16x16x32_bf16 v[52:55], v[128:131], a[248:251], v[52:55]
 s_add_u32 s38, s19, 1040384
 s_add_u32 m0, s14, 82944
 s_nop 0
 buffer_load_dwordx4 v1, s[4:7], s38 offen sc1 lds
 v_mfma_f32_16x16x32_bf16 v[88:91], v[128:131], a[252:255], v[88:91]
 ds_read_b128 v[120:123], v4 offset:1024
 v_mfma_f32_16x16x32_bf16 v[56:59], v[132:135], a[248:251], v[56:59]
 v_mfma_f32_16x16x32_bf16 v[92:95], v[132:135], a[252:255], v[92:95]
 ds_read_b128 v[124:127], v4 offset:2048
 s_waitcnt vmcnt(21)
 v_mfma_f32_16x16x32_bf16 v[32:35], v[136:139], v[168:171], v[32:35]
 s_add_u32 s38, s19, 1187840
 s_add_u32 m0, s14, 83968
 s_nop 0
 buffer_load_dwordx4 v1, s[4:7], s38 offen sc1 lds
 v_mfma_f32_16x16x32_bf16 v[68:71], v[136:139], v[172:175], v[68:71]
 ds_read_b128 v[128:131], v4 offset:3072
 s_waitcnt lgkmcnt(7)
 v_mfma_f32_16x16x32_bf16 v[36:39], v[140:143], v[168:171], v[36:39]
 v_mfma_f32_16x16x32_bf16 v[72:75], v[140:143], v[172:175], v[72:75]
 ds_read_b128 v[132:135], v4 offset:4096
 v_mfma_f32_16x16x32_bf16 v[40:43], v[144:147], v[168:171], v[40:43]
 v_mfma_f32_16x16x32_bf16 v[76:79], v[144:147], v[172:175], v[76:79]
 ds_read_b128 v[136:139], v4 offset:5120
 v_mfma_f32_16x16x32_bf16 v[44:47], v[148:151], v[168:171], v[44:47]
 v_mfma_f32_16x16x32_bf16 v[80:83], v[148:151], v[172:175], v[80:83]
 ds_read_b128 v[140:143], v4 offset:6144
 s_waitcnt lgkmcnt(7)
 v_mfma_f32_16x16x32_bf16 v[48:51], v[104:107], v[168:171], v[48:51]
 v_mfma_f32_16x16x32_bf16 v[84:87], v[104:107], v[172:175], v[84:87]
 ds_read_b128 v[144:147], v4 offset:7168
 v_mfma_f32_16x16x32_bf16 v[52:55], v[108:111], v[168:171], v[52:55]
 v_mfma_f32_16x16x32_bf16 v[88:91], v[108:111], v[172:175], v[88:91]
 ds_read_b128 v[148:151], v4 offset:8192
 v_mfma_f32_16x16x32_bf16 v[56:59], v[112:115], v[168:171], v[56:59]
 v_mfma_f32_16x16x32_bf16 v[92:95], v[112:115], v[172:175], v[92:95]
 ds_read_b128 v[104:107], v4 offset:9216
 s_waitcnt vmcnt(19) lgkmcnt(7)
 v_mfma_f32_16x16x32_bf16 v[32:35], v[116:119], v[176:179], v[32:35]
 v_mfma_f32_16x16x32_bf16 v[68:71], v[116:119], v[180:183], v[68:71]
 ds_read_b128 v[108:111], v4 offset:10240
 v_mfma_f32_16x16x32_bf16 v[36:39], v[120:123], v[176:179], v[36:39]
 v_mfma_f32_16x16x32_bf16 v[72:75], v[120:123], v[180:183], v[72:75]
 ds_read_b128 v[112:115], v4 offset:11264
 v_mfma_f32_16x16x32_bf16 v[40:43], v[124:127], v[176:179], v[40:43]
 v_mfma_f32_16x16x32_bf16 v[76:79], v[124:127], v[180:183], v[76:79]
 ds_read_b128 v[116:119], v4 offset:12288
 s_waitcnt lgkmcnt(7)
 v_mfma_f32_16x16x32_bf16 v[44:47], v[128:131], v[176:179], v[44:47]
 v_mfma_f32_16x16x32_bf16 v[80:83], v[128:131], v[180:183], v[80:83]
 ds_read_b128 v[120:123], v4 offset:13312
 v_mfma_f32_16x16x32_bf16 v[48:51], v[132:135], v[176:179], v[48:51]
 v_mfma_f32_16x16x32_bf16 v[84:87], v[132:135], v[180:183], v[84:87]
 ds_read_b128 v[124:127], v4 offset:14336
 v_mfma_f32_16x16x32_bf16 v[52:55], v[136:139], v[176:179], v[52:55]
 v_mfma_f32_16x16x32_bf16 v[88:91], v[136:139], v[180:183], v[88:91]
 ds_read_b128 v[128:131], v4 offset:15360
 s_waitcnt lgkmcnt(7)
 v_mfma_f32_16x16x32_bf16 v[56:59], v[140:143], v[176:179], v[56:59]
 v_mfma_f32_16x16x32_bf16 v[92:95], v[140:143], v[180:183], v[92:95]
 ds_read_b128 v[132:135], v4 offset:16384
 s_waitcnt vmcnt(14)
 v_mfma_f32_16x16x32_bf16 v[32:35], v[144:147], v[184:187], v[32:35]
 v_mfma_f32_16x16x32_bf16 v[68:71], v[144:147], v[188:191], v[68:71]
 ds_read_b128 v[136:139], v4 offset:17408
 v_mfma_f32_16x16x32_bf16 v[36:39], v[148:151], v[184:187], v[36:39]
 v_mfma_f32_16x16x32_bf16 v[72:75], v[148:151], v[188:191], v[72:75]
 ds_read_b128 v[140:143], v4 offset:18432
 s_waitcnt lgkmcnt(7)
 v_mfma_f32_16x16x32_bf16 v[40:43], v[104:107], v[184:187], v[40:43]
 v_mfma_f32_16x16x32_bf16 v[76:79], v[104:107], v[188:191], v[76:79]
 ds_read_b128 v[144:147], v4 offset:19456
 v_mfma_f32_16x16x32_bf16 v[44:47], v[108:111], v[184:187], v[44:47]
 v_mfma_f32_16x16x32_bf16 v[80:83], v[108:111], v[188:191], v[80:83]
 ds_read_b128 v[148:151], v4 offset:20480
 v_mfma_f32_16x16x32_bf16 v[48:51], v[112:115], v[184:187], v[48:51]
 v_mfma_f32_16x16x32_bf16 v[84:87], v[112:115], v[188:191], v[84:87]
 s_barrier
 ds_read_b128 v[104:107], v2 offset:0
 s_waitcnt lgkmcnt(7)
 v_mfma_f32_16x16x32_bf16 v[52:55], v[116:119], v[184:187], v[52:55]
 v_mfma_f32_16x16x32_bf16 v[88:91], v[116:119], v[188:191], v[88:91]
 ds_read_b128 v[108:111], v2 offset:1024
 v_mfma_f32_16x16x32_bf16 v[56:59], v[120:123], v[184:187], v[56:59]
 v_mfma_f32_16x16x32_bf16 v[92:95], v[120:123], v[188:191], v[92:95]
 ds_read_b128 v[112:115], v2 offset:2048
 s_waitcnt vmcnt(10)
 v_mfma_f32_16x16x32_bf16 v[32:35], v[124:127], v[192:195], v[32:35]
 v_mfma_f32_16x16x32_bf16 v[68:71], v[124:127], v[196:199], v[68:71]
 ds_read_b128 v[116:119], v2 offset:3072
 s_waitcnt lgkmcnt(7)
 v_mfma_f32_16x16x32_bf16 v[36:39], v[128:131], v[192:195], v[36:39]
 v_mfma_f32_16x16x32_bf16 v[72:75], v[128:131], v[196:199], v[72:75]
 ds_read_b128 v[120:123], v2 offset:4096
 v_mfma_f32_16x16x32_bf16 v[40:43], v[132:135], v[192:195], v[40:43]
 v_mfma_f32_16x16x32_bf16 v[76:79], v[132:135], v[196:199], v[76:79]
 ds_read_b128 v[124:127], v2 offset:5120
 v_mfma_f32_16x16x32_bf16 v[44:47], v[136:139], v[192:195], v[44:47]
 v_mfma_f32_16x16x32_bf16 v[80:83], v[136:139], v[196:199], v[80:83]
 ds_read_b128 v[128:131], v2 offset:6144
 s_waitcnt lgkmcnt(7)
 v_mfma_f32_16x16x32_bf16 v[48:51], v[140:143], v[192:195], v[48:51]
 v_mfma_f32_16x16x32_bf16 v[84:87], v[140:143], v[196:199], v[84:87]
 ds_read_b128 v[132:135], v2 offset:7168
 v_mfma_f32_16x16x32_bf16 v[52:55], v[144:147], v[192:195], v[52:55]
 v_mfma_f32_16x16x32_bf16 v[88:91], v[144:147], v[196:199], v[88:91]
 ds_read_b128 v[136:139], v2 offset:8192
 v_mfma_f32_16x16x32_bf16 v[56:59], v[148:151], v[192:195], v[56:59]
 v_mfma_f32_16x16x32_bf16 v[92:95], v[148:151], v[196:199], v[92:95]
 ds_read_b128 v[140:143], v2 offset:9216
 s_waitcnt lgkmcnt(7)
 v_mfma_f32_16x16x32_bf16 v[60:63], v[104:107], a[0:3], 0
 v_mfma_f32_16x16x32_bf16 v[96:99], v[104:107], a[4:7], 0
 ds_read_b128 v[144:147], v2 offset:10240
 v_mfma_f32_16x16x32_bf16 v[64:67], v[108:111], a[0:3], 0
 v_mfma_f32_16x16x32_bf16 v[100:103], v[108:111], a[4:7], 0
 ds_read_b128 v[148:151], v2 offset:11264
 v_mfma_f32_16x16x32_bf16 v[60:63], v[112:115], a[8:11], v[60:63]
 v_mfma_f32_16x16x32_bf16 v[96:99], v[112:115], a[12:15], v[96:99]
 ds_read_b128 v[104:107], v2 offset:12288
 s_waitcnt lgkmcnt(7)
 v_mfma_f32_16x16x32_bf16 v[64:67], v[116:119], a[8:11], v[64:67]
 v_mfma_f32_16x16x32_bf16 v[100:103], v[116:119], a[12:15], v[100:103]
 ds_read_b128 v[108:111], v2 offset:13312
 v_mfma_f32_16x16x32_bf16 v[60:63], v[120:123], a[16:19], v[60:63]
 v_cvt_pk_bf16_f32 v32, v32, v33
 v_cvt_pk_bf16_f32 v33, v34, v35
 v_mfma_f32_16x16x32_bf16 v[96:99], v[120:123], a[20:23], v[96:99]
 ds_read_b128 v[112:115], v2 offset:14336
 v_mfma_f32_16x16x32_bf16 v[64:67], v[124:127], a[16:19], v[64:67]
 v_cvt_pk_bf16_f32 v34, v36, v37
 v_cvt_pk_bf16_f32 v35, v38, v39
 v_mfma_f32_16x16x32_bf16 v[100:103], v[124:127], a[20:23], v[100:103]
 ds_read_b128 v[116:119], v2 offset:15360
 s_waitcnt lgkmcnt(7)
 v_mfma_f32_16x16x32_bf16 v[60:63], v[128:131], a[24:27], v[60:63]
 buffer_store_dwordx4 v[32:35], v1, s[4:7], s16 offen offset:0 sc1
 v_mfma_f32_16x16x32_bf16 v[96:99], v[128:131], a[28:31], v[96:99]
 ds_read_b128 v[120:123], v2 offset:16384
 v_mfma_f32_16x16x32_bf16 v[64:67], v[132:135], a[24:27], v[64:67]
 v_cvt_pk_bf16_f32 v40, v40, v41
 v_cvt_pk_bf16_f32 v41, v42, v43
 v_mfma_f32_16x16x32_bf16 v[100:103], v[132:135], a[28:31], v[100:103]
 ds_read_b128 v[124:127], v2 offset:17408
 v_mfma_f32_16x16x32_bf16 v[60:63], v[136:139], a[32:35], v[60:63]
 buffer_store_dwordx2 v[40:41], v1, s[4:7], s16 offen offset:1024 sc1
 v_mfma_f32_16x16x32_bf16 v[96:99], v[136:139], a[36:39], v[96:99]
 ds_read_b128 v[128:131], v2 offset:18432
 s_waitcnt lgkmcnt(7)
 v_mfma_f32_16x16x32_bf16 v[64:67], v[140:143], a[32:35], v[64:67]
 v_cvt_pk_bf16_f32 v44, v44, v45
 v_cvt_pk_bf16_f32 v45, v46, v47
 v_mfma_f32_16x16x32_bf16 v[100:103], v[140:143], a[36:39], v[100:103]
 ds_read_b128 v[132:135], v2 offset:19456
 v_mfma_f32_16x16x32_bf16 v[60:63], v[144:147], a[40:43], v[60:63]
 v_cvt_pk_bf16_f32 v46, v48, v49
 v_cvt_pk_bf16_f32 v47, v50, v51
 v_mfma_f32_16x16x32_bf16 v[96:99], v[144:147], a[44:47], v[96:99]
 ds_read_b128 v[136:139], v2 offset:20480
 v_mfma_f32_16x16x32_bf16 v[64:67], v[148:151], a[40:43], v[64:67]
 buffer_store_dwordx4 v[44:47], v1, s[4:7], s16 offen offset:2048 sc1
 v_mfma_f32_16x16x32_bf16 v[100:103], v[148:151], a[44:47], v[100:103]
 ds_read_b128 v[140:143], v2 offset:21504
 s_waitcnt lgkmcnt(7)
 v_mfma_f32_16x16x32_bf16 v[60:63], v[104:107], a[48:51], v[60:63]
 v_cvt_pk_bf16_f32 v68, v68, v69
 v_cvt_pk_bf16_f32 v69, v70, v71
 v_mfma_f32_16x16x32_bf16 v[96:99], v[104:107], a[52:55], v[96:99]
 ds_read_b128 v[144:147], v2 offset:22528
 v_mfma_f32_16x16x32_bf16 v[64:67], v[108:111], a[48:51], v[64:67]
 v_cvt_pk_bf16_f32 v70, v72, v73
 v_cvt_pk_bf16_f32 v71, v74, v75
 v_mfma_f32_16x16x32_bf16 v[100:103], v[108:111], a[52:55], v[100:103]
 ds_read_b128 v[148:151], v2 offset:23552
 v_mfma_f32_16x16x32_bf16 v[60:63], v[112:115], a[56:59], v[60:63]
 buffer_store_dwordx4 v[68:71], v1, s[4:7], s17 offen offset:0 sc1
 v_mfma_f32_16x16x32_bf16 v[96:99], v[112:115], a[60:63], v[96:99]
 s_barrier
 ds_read_b128 v[104:107], v2 offset:37888
 s_waitcnt lgkmcnt(7)
 v_mfma_f32_16x16x32_bf16 v[64:67], v[116:119], a[56:59], v[64:67]
 s_cmp_lg_u32 s40, 0
 s_cbranch_scc1 QSK1
 s_add_u32 s38, s77, 113664
 s_add_u32 m0, s78, 113664
 s_nop 0
 buffer_load_dwordx4 v1, s[4:7], s38 offen sc1 lds
 s_add_u32 s38, s77, 117760
 s_add_u32 m0, s78, 117760
 s_nop 0
 buffer_load_dwordx4 v1, s[4:7], s38 offen sc1 lds
 s_add_u32 s38, s77, 121856
 s_add_u32 m0, s78, 121856
 s_nop 0
 buffer_load_dwordx4 v1, s[4:7], s38 offen sc1 lds
QSK1:
 v_mfma_f32_16x16x32_bf16 v[100:103], v[116:119], a[60:63], v[100:103]
 ds_read_b128 v[108:111], v2 offset:38912
 v_mfma_f32_16x16x32_bf16 v[60:63], v[120:123], a[64:67], v[60:63]
 v_cvt_pk_bf16_f32 v76, v76, v77
 v_cvt_pk_bf16_f32 v77, v78, v79
 v_mfma_f32_16x16x32_bf16 v[96:99], v[120:123], a[68:71], v[96:99]
 ds_read_b128 v[112:115], v2 offset:39936
 v_mfma_f32_16x16x32_bf16 v[64:67], v[124:127], a[64:67], v[64:67]
 buffer_store_dwordx2 v[76:77], v1, s[4:7], s17 offen offset:1024 sc1
 v_mfma_f32_16x16x32_bf16 v[100:103], v[124:127], a[68:71], v[100:103]
 ds_read_b128 v[116:119], v2 offset:40960
 s_waitcnt lgkmcnt(7)
 v_mfma_f32_16x16x32_bf16 v[60:63], v[128:131], a[72:75], v[60:63]
 v_cvt_pk_bf16_f32 v80, v80, v81
 v_cvt_pk_bf16_f32 v81, v82, v83
 v_mfma_f32_16x16x32_bf16 v[96:99], v[128:131], a[76:79], v[96:99]
 ds_read_b128 v[120:123], v2 offset:41984
 v_mfma_f32_16x16x32_bf16 v[64:67], v[132:135], a[72:75], v[64:67]
 s_cmp_lg_u32 s40, 0
 s_cbranch_scc1 QSK2
 s_add_u32 s38, s77, 125952
 s_add_u32 m0, s78, 125952
 s_nop 0
 buffer_load_dwordx4 v1, s[4:7], s38 offen sc1 lds
 s_add_u32 s38, s77, 130048
 s_add_u32 m0, s78, 130048
 s_nop 0
 buffer_load_dwordx4 v1, s[4:7], s38 offen sc1 lds
 s_add_u32 s38, s77, 134144
 s_add_u32 m0, s78, 134144
 s_nop 0
 buffer_load_dwordx4 v1, s[4:7], s38 offen sc1 lds
QSK2:
 v_mfma_f32_16x16x32_bf16 v[100:103], v[132:135], a[76:79], v[100:103]
 ds_read_b128 v[124:127], v2 offset:43008
 v_mfma_f32_16x16x32_bf16 v[60:63], v[136:139], a[80:83], v[60:63]
 v_cvt_pk_bf16_f32 v82, v84, v85
 v_cvt_pk_bf16_f32 v83, v86, v87
 v_mfma_f32_16x16x32_bf16 v[96:99], v[136:139], a[84:87], v[96:99]
 ds_read_b128 v[128:131], v2 offset:44032
 s_waitcnt lgkmcnt(7)
 v_mfma_f32_16x16x32_bf16 v[64:67], v[140:143], a[80:83], v[64:67]
 buffer_store_dwordx4 v[80:83], v1, s[4:7], s17 offen offset:2048 sc1
 v_mfma_f32_16x16x32_bf16 v[100:103], v[140:143], a[84:87], v[100:103]
 ds_read_b128 v[132:135], v2 offset:45056
 v_mfma_f32_16x16x32_bf16 v[60:63], v[144:147], a[88:91], v[60:63]
 v_cvt_pk_bf16_f32 v88, v88, v89
 v_cvt_pk_bf16_f32 v89, v90, v91
 v_mfma_f32_16x16x32_bf16 v[96:99], v[144:147], a[92:95], v[96:99]
 ds_read_b128 v[136:139], v2 offset:46080
 v_mfma_f32_16x16x32_bf16 v[64:67], v[148:151], a[88:91], v[64:67]
 s_cmp_lg_u32 s40, 0
 s_cbranch_scc1 QSK3
 s_add_u32 s38, s77, 138240
 s_add_u32 m0, s78, 138240
 s_nop 0
 buffer_load_dwordx4 v1, s[4:7], s38 offen sc1 lds
 s_add_u32 s38, s77, 142336
 s_add_u32 m0, s78, 142336
 s_nop 0
 buffer_load_dwordx4 v1, s[4:7], s38 offen sc1 lds
 s_add_u32 s38, s77, 146432
 s_add_u32 m0, s78, 146432
 s_nop 0
 buffer_load_dwordx4 v1, s[4:7], s38 offen sc1 lds
QSK3:
 v_mfma_f32_16x16x32_bf16 v[100:103], v[148:151], a[92:95], v[100:103]
 ds_read_b128 v[140:143], v2 offset:47104
 s_waitcnt lgkmcnt(7)
 v_mfma_f32_16x16x32_bf16 v[60:63], v[104:107], a[96:99], v[60:63]
 v_cvt_pk_bf16_f32 v90, v92, v93
 v_cvt_pk_bf16_f32 v91, v94, v95
 v_mfma_f32_16x16x32_bf16 v[96:99], v[104:107], a[100:103], v[96:99]
 ds_read_b128 v[144:147], v2 offset:48128
 v_mfma_f32_16x16x32_bf16 v[64:67], v[108:111], a[96:99], v[64:67]
 buffer_store_dwordx4 v[88:91], v1, s[4:7], s18 offen offset:0 sc1
 v_mfma_f32_16x16x32_bf16 v[100:103], v[108:111], a[100:103], v[100:103]
 ds_read_b128 v[148:151], v2 offset:49152
 v_mfma_f32_16x16x32_bf16 v[60:63], v[112:115], a[104:107], v[60:63]
 v_mfma_f32_16x16x32_bf16 v[96:99], v[112:115], a[108:111], v[96:99]
 ds_read_b128 v[104:107], v2 offset:50176
 s_waitcnt lgkmcnt(7)
 v_mfma_f32_16x16x32_bf16 v[64:67], v[116:119], a[104:107], v[64:67]
 s_cmp_lg_u32 s40, 0
 s_cbranch_scc1 QSK4
 s_add_u32 s38, s76, 150528
 s_mov_b32 m0, 150528
 s_nop 0
 buffer_load_dwordx4 v1, s[4:7], s38 offen sc1 lds
QSK4:
 v_mfma_f32_16x16x32_bf16 v[100:103], v[116:119], a[108:111], v[100:103]
 ds_read_b128 v[108:111], v2 offset:51200
 v_mfma_f32_16x16x32_bf16 v[60:63], v[120:123], a[112:115], v[60:63]
 v_mfma_f32_16x16x32_bf16 v[96:99], v[120:123], a[116:119], v[96:99]
 ds_read_b128 v[112:115], v2 offset:52224
 v_mfma_f32_16x16x32_bf16 v[64:67], v[124:127], a[112:115], v[64:67]
 v_mfma_f32_16x16x32_bf16 v[100:103], v[124:127], a[116:119], v[100:103]
 ds_read_b128 v[116:119], v2 offset:53248
 s_waitcnt lgkmcnt(7)
 v_mfma_f32_16x16x32_bf16 v[60:63], v[128:131], a[120:123], v[60:63]
 v_mfma_f32_16x16x32_bf16 v[96:99], v[128:131], a[124:127], v[96:99]
 ds_read_b128 v[120:123], v2 offset:54272
 v_mfma_f32_16x16x32_bf16 v[64:67], v[132:135], a[120:123], v[64:67]
 v_mfma_f32_16x16x32_bf16 v[100:103], v[132:135], a[124:127], v[100:103]
 ds_read_b128 v[124:127], v2 offset:55296
 v_mfma_f32_16x16x32_bf16 v[60:63], v[136:139], a[128:131], v[60:63]
 v_mfma_f32_16x16x32_bf16 v[96:99], v[136:139], a[132:135], v[96:99]
 ds_read_b128 v[128:131], v2 offset:56320
 s_waitcnt lgkmcnt(7)
 v_mfma_f32_16x16x32_bf16 v[64:67], v[140:143], a[128:131], v[64:67]
 v_mfma_f32_16x16x32_bf16 v[100:103], v[140:143], a[132:135], v[100:103]
 ds_read_b128 v[132:135], v2 offset:57344
 v_mfma_f32_16x16x32_bf16 v[60:63], v[144:147], a[136:139], v[60:63]
 v_mfma_f32_16x16x32_bf16 v[96:99], v[144:147], a[140:143], v[96:99]
 ds_read_b128 v[136:139], v2 offset:58368
 v_mfma_f32_16x16x32_bf16 v[64:67], v[148:151], a[136:139], v[64:67]
 v_mfma_f32_16x16x32_bf16 v[100:103], v[148:151], a[140:143], v[100:103]
 ds_read_b128 v[140:143], v2 offset:59392
 s_waitcnt lgkmcnt(7)
 v_mfma_f32_16x16x32_bf16 v[60:63], v[104:107], a[144:147], v[60:63]
 v_mfma_f32_16x16x32_bf16 v[96:99], v[104:107], a[148:151], v[96:99]
 ds_read_b128 v[144:147], v2 offset:60416
 v_mfma_f32_16x16x32_bf16 v[64:67], v[108:111], a[144:147], v[64:67]
 v_mfma_f32_16x16x32_bf16 v[100:103], v[108:111], a[148:151], v[100:103]
 ds_read_b128 v[148:151], v2 offset:61440
 v_mfma_f32_16x16x32_bf16 v[60:63], v[112:115], a[152:155], v[60:63]
 v_mfma_f32_16x16x32_bf16 v[96:99], v[112:115], a[156:159], v[96:99]
 s_waitcnt vmcnt(7)
 s_barrier
 ds_read_b128 v[104:107], v3 offset:1024
 s_waitcnt lgkmcnt(7)
 v_mfma_f32_16x16x32_bf16 v[64:67], v[116:119], a[152:155], v[64:67]
 s_cmp_lg_u32 s40, 0
 s_cbranch_scc1 QSK5
 s_add_u32 s38, s77, 0
 s_add_u32 m0, s78, 0
 s_nop 0
 buffer_load_dwordx4 v1, s[4:7], s38 offen sc1 lds
 s_add_u32 s38, s77, 4096
 s_add_u32 m0, s78, 4096
 s_nop 0
 buffer_load_dwordx4 v1, s[4:7], s38 offen sc1 lds
 s_add_u32 s38, s77, 8192
 s_add_u32 m0, s78, 8192
 s_nop 0
 buffer_load_dwordx4 v1, s[4:7], s38 offen sc1 lds
QSK5:
 v_mfma_f32_16x16x32_bf16 v[100:103], v[116:119], a[156:159], v[100:103]
 ds_read_b128 v[108:111], v3 offset:2048
 v_mfma_f32_16x16x32_bf16 v[60:63], v[120:123], a[160:163], v[60:63]
 v_mfma_f32_16x16x32_bf16 v[96:99], v[120:123], a[164:167], v[96:99]
 ds_read_b128 v[112:115], v3 offset:3072
 v_mfma_f32_16x16x32_bf16 v[64:67], v[124:127], a[160:163], v[64:67]
 v_mfma_f32_16x16x32_bf16 v[100:103], v[124:127], a[164:167], v[100:103]
 ds_read_b128 v[116:119], v3 offset:4096
 s_waitcnt lgkmcnt(7)
 v_mfma_f32_16x16x32_bf16 v[60:63], v[128:131], a[168:171], v[60:63]
 v_mfma_f32_16x16x32_bf16 v[96:99], v[128:131], a[172:175], v[96:99]
 ds_read_b128 v[120:123], v3 offset:5120
 v_mfma_f32_16x16x32_bf16 v[64:67], v[132:135], a[168:171], v[64:67]
 s_cmp_lg_u32 s40, 0
 s_cbranch_scc1 QSK6
 s_add_u32 s38, s77, 12288
 s_add_u32 m0, s78, 12288
 s_nop 0
 buffer_load_dwordx4 v1, s[4:7], s38 offen sc1 lds
 s_add_u32 s38, s77, 16384
 s_add_u32 m0, s78, 16384
 s_nop 0
 buffer_load_dwordx4 v1, s[4:7], s38 offen sc1 lds
 s_add_u32 s38, s77, 20480
 s_add_u32 m0, s78, 20480
 s_nop 0
 buffer_load_dwordx4 v1, s[4:7], s38 offen sc1 lds
QSK6:
 v_mfma_f32_16x16x32_bf16 v[100:103], v[132:135], a[172:175], v[100:103]
 ds_read_b128 v[124:127], v3 offset:6144
 v_mfma_f32_16x16x32_bf16 v[60:63], v[136:139], a[176:179], v[60:63]
 v_mfma_f32_16x16x32_bf16 v[96:99], v[136:139], a[180:183], v[96:99]
 ds_read_b128 v[128:131], v3 offset:7168
 s_waitcnt lgkmcnt(7)
 v_mfma_f32_16x16x32_bf16 v[64:67], v[140:143], a[176:179], v[64:67]
 v_mfma_f32_16x16x32_bf16 v[100:103], v[140:143], a[180:183], v[100:103]
 ds_read_b128 v[132:135], v3 offset:8192
 v_mfma_f32_16x16x32_bf16 v[60:63], v[144:147], a[184:187], v[60:63]
 v_mfma_f32_16x16x32_bf16 v[96:99], v[144:147], a[188:191], v[96:99]
 ds_read_b128 v[136:139], v3 offset:9216
 v_mfma_f32_16x16x32_bf16 v[64:67], v[148:151], a[184:187], v[64:67]
 s_cmp_lg_u32 s40, 0
 s_cbranch_scc1 QSK7
 s_add_u32 s38, s77, 24576
 s_add_u32 m0, s78, 24576
 s_nop 0
 buffer_load_dwordx4 v1, s[4:7], s38 offen sc1 lds
 s_add_u32 s38, s77, 28672
 s_add_u32 m0, s78, 28672
 s_nop 0
 buffer_load_dwordx4 v1, s[4:7], s38 offen sc1 lds
 s_add_u32 s38, s77, 32768
 s_add_u32 m0, s78, 32768
 s_nop 0
 buffer_load_dwordx4 v1, s[4:7], s38 offen sc1 lds
QSK7:
 v_mfma_f32_16x16x32_bf16 v[100:103], v[148:151], a[188:191], v[100:103]
 ds_read_b128 v[140:143], v3 offset:10240
 s_waitcnt lgkmcnt(7)
 v_mfma_f32_16x16x32_bf16 v[60:63], v[104:107], a[192:195], v[60:63]
 v_mfma_f32_16x16x32_bf16 v[96:99], v[104:107], a[196:199], v[96:99]
 ds_read_b128 v[144:147], v3 offset:11264
 v_mfma_f32_16x16x32_bf16 v[64:67], v[108:111], a[192:195], v[64:67]
 v_mfma_f32_16x16x32_bf16 v[100:103], v[108:111], a[196:199], v[100:103]
 ds_read_b128 v[148:151], v3 offset:12288
 v_mfma_f32_16x16x32_bf16 v[60:63], v[112:115], a[200:203], v[60:63]
 v_mfma_f32_16x16x32_bf16 v[96:99], v[112:115], a[204:207], v[96:99]
 ds_read_b128 v[104:107], v3 offset:13312
 s_waitcnt lgkmcnt(7)
 v_mfma_f32_16x16x32_bf16 v[64:67], v[116:119], a[200:203], v[64:67]
 s_cmp_lg_u32 s40, 0
 s_cbranch_scc1 QSK8
 s_add_u32 s38, s76, 36864
 s_mov_b32 m0, 36864
 s_nop 0
 buffer_load_dwordx4 v1, s[4:7], s38 offen sc1 lds
QSK8:
 v_mfma_f32_16x16x32_bf16 v[100:103], v[116:119], a[204:207], v[100:103]
 ds_read_b128 v[108:111], v3 offset:14336
 v_mfma_f32_16x16x32_bf16 v[60:63], v[120:123], a[208:211], v[60:63]
 v_mfma_f32_16x16x32_bf16 v[96:99], v[120:123], a[212:215], v[96:99]
 ds_read_b128 v[112:115], v3 offset:15360
 v_mfma_f32_16x16x32_bf16 v[64:67], v[124:127], a[208:211], v[64:67]
 v_mfma_f32_16x16x32_bf16 v[100:103], v[124:127], a[212:215], v[100:103]
 ds_read_b128 v[116:119], v3 offset:16384
 s_waitcnt lgkmcnt(7)
 v_mfma_f32_16x16x32_bf16 v[60:63], v[128:131], a[216:219], v[60:63]
 v_mfma_f32_16x16x32_bf16 v[96:99], v[128:131], a[220:223], v[96:99]
 ds_read_b128 v[120:123], v3 offset:17408
 v_mfma_f32_16x16x32_bf16 v[64:67], v[132:135], a[216:219], v[64:67]
 v_mfma_f32_16x16x32_bf16 v[100:103], v[132:135], a[220:223], v[100:103]
 ds_read_b128 v[124:127], v3 offset:18432
 v_mfma_f32_16x16x32_bf16 v[60:63], v[136:139], a[224:227], v[60:63]
 v_mfma_f32_16x16x32_bf16 v[96:99], v[136:139], a[228:231], v[96:99]
 ds_read_b128 v[128:131], v3 offset:19456
 s_waitcnt lgkmcnt(7)
 v_mfma_f32_16x16x32_bf16 v[64:67], v[140:143], a[224:227], v[64:67]
 v_mfma_f32_16x16x32_bf16 v[100:103], v[140:143], a[228:231], v[100:103]
 ds_read_b128 v[132:135], v3 offset:20480
 v_mfma_f32_16x16x32_bf16 v[60:63], v[144:147], a[232:235], v[60:63]
 v_mfma_f32_16x16x32_bf16 v[96:99], v[144:147], a[236:239], v[96:99]
 ds_read_b128 v[136:139], v3 offset:21504
 v_mfma_f32_16x16x32_bf16 v[64:67], v[148:151], a[232:235], v[64:67]
 v_mfma_f32_16x16x32_bf16 v[100:103], v[148:151], a[236:239], v[100:103]
 ds_read_b128 v[140:143], v3 offset:22528
 s_waitcnt lgkmcnt(7)
 v_mfma_f32_16x16x32_bf16 v[60:63], v[104:107], a[240:243], v[60:63]
 v_mfma_f32_16x16x32_bf16 v[96:99], v[104:107], a[244:247], v[96:99]
 ds_read_b128 v[144:147], v3 offset:23552
 v_mfma_f32_16x16x32_bf16 v[64:67], v[108:111], a[240:243], v[64:67]
 v_mfma_f32_16x16x32_bf16 v[100:103], v[108:111], a[244:247], v[100:103]
 ds_read_b128 v[148:151], v3 offset:24576
 v_mfma_f32_16x16x32_bf16 v[60:63], v[112:115], a[248:251], v[60:63]
 v_mfma_f32_16x16x32_bf16 v[96:99], v[112:115], a[252:255], v[96:99]
 s_waitcnt lgkmcnt(6)
 v_mfma_f32_16x16x32_bf16 v[64:67], v[116:119], a[248:251], v[64:67]
 v_mfma_f32_16x16x32_bf16 v[100:103], v[116:119], a[252:255], v[100:103]
 v_mfma_f32_16x16x32_bf16 v[60:63], v[120:123], v[168:171], v[60:63]
 v_mfma_f32_16x16x32_bf16 v[96:99], v[120:123], v[172:175], v[96:99]
 v_mfma_f32_16x16x32_bf16 v[64:67], v[124:127], v[168:171], v[64:67]
 v_mfma_f32_16x16x32_bf16 v[100:103], v[124:127], v[172:175], v[100:103]
 s_waitcnt lgkmcnt(3)
 v_mfma_f32_16x16x32_bf16 v[60:63], v[128:131], v[176:179], v[60:63]
 v_mfma_f32_16x16x32_bf16 v[96:99], v[128:131], v[180:183], v[96:99]
 v_mfma_f32_16x16x32_bf16 v[64:67], v[132:135], v[176:179], v[64:67]
 v_mfma_f32_16x16x32_bf16 v[100:103], v[132:135], v[180:183], v[100:103]
 v_mfma_f32_16x16x32_bf16 v[60:63], v[136:139], v[184:187], v[60:63]
 v_mfma_f32_16x16x32_bf16 v[96:99], v[136:139], v[188:191], v[96:99]
 s_waitcnt lgkmcnt(0)
 v_mfma_f32_16x16x32_bf16 v[64:67], v[140:143], v[184:187], v[64:67]
 v_mfma_f32_16x16x32_bf16 v[100:103], v[140:143], v[188:191], v[100:103]
 v_mfma_f32_16x16x32_bf16 v[60:63], v[144:147], v[192:195], v[60:63]
 v_mfma_f32_16x16x32_bf16 v[96:99], v[144:147], v[196:199], v[96:99]
 v_mfma_f32_16x16x32_bf16 v[64:67], v[148:151], v[192:195], v[64:67]
 v_mfma_f32_16x16x32_bf16 v[100:103], v[148:151], v[196:199], v[100:103]
 s_nop 5
 v_cvt_pk_bf16_f32 v96, v96, v97
 v_cvt_pk_bf16_f32 v97, v98, v99
 v_cvt_pk_bf16_f32 v98, v100, v101
 v_cvt_pk_bf16_f32 v99, v102, v103
 buffer_store_dwordx4 v[96:99], v1, s[4:7], s18 offen offset:1024 sc1
 s_add_u32 s37, s21, 0
 buffer_load_dwordx4 v[200:203], v1, s[4:7], s37 offen offset:0 sc1
 buffer_load_dwordx4 v[204:207], v1, s[4:7], s37 offen offset:1024 sc1
 s_add_u32 s37, s21, 12288
 buffer_load_dwordx4 v[212:215], v1, s[4:7], s37 offen offset:0 sc1
 buffer_load_dwordx4 v[216:219], v1, s[4:7], s37 offen offset:1024 sc1
 s_add_u32 s37, s21, 24576
 buffer_load_dwordx4 v[224:227], v1, s[4:7], s37 offen offset:0 sc1
 buffer_load_dwordx4 v[228:231], v1, s[4:7], s37 offen offset:1024 sc1
 s_barrier
 v_lshlrev_b32 v104, 16, v16
 v_and_b32 v105, 0xffff0000, v16
 v_lshlrev_b32 v106, 16, v17
 v_and_b32 v107, 0xffff0000, v17
 v_lshlrev_b32 v108, 16, v18
 v_and_b32 v109, 0xffff0000, v18
 v_lshlrev_b32 v110, 16, v19
 v_and_b32 v111, 0xffff0000, v19
 v_lshlrev_b32 v112, 16, v20
 v_and_b32 v113, 0xffff0000, v20
 v_lshlrev_b32 v114, 16, v21
 v_and_b32 v115, 0xffff0000, v21
 v_lshlrev_b32 v116, 16, v22
 v_and_b32 v117, 0xffff0000, v22
 v_lshlrev_b32 v118, 16, v23
 v_and_b32 v119, 0xffff0000, v23
 v_add_f32 v104, v104, v52
 v_add_f32 v105, v105, v53
 v_add_f32 v106, v106, v54
 v_add_f32 v107, v107, v55
 v_add_f32 v108, v108, v56
 v_add_f32 v109, v109, v57
 v_add_f32 v110, v110, v58
 v_add_f32 v111, v111, v59
 v_add_f32 v112, v112, v60
 v_add_f32 v113, v113, v61
 v_add_f32 v114, v114, v62
 v_add_f32 v115, v115, v63
 v_add_f32 v116, v116, v64
 v_add_f32 v117, v117, v65
 v_add_f32 v118, v118, v66
 v_add_f32 v119, v119, v67
 s_mov_b32 s39, 0x20000
 s_waitcnt vmcnt(2)
K5SA0:
 v_max3_u32 v30, v200, v201, v202
 v_max3_u32 v30, v30, v203, v204
 v_max3_u32 v30, v30, v205, v206
 v_max3_u32 v30, v30, v207, v212
 v_max3_u32 v30, v30, v213, v214
 v_max3_u32 v30, v30, v215, v216
 v_max3_u32 v30, v30, v217, v218
 v_max_u32 v30, v30, v219
 v_cmp_eq_u32 vcc, -1, v30
 s_nop 0
 s_cmp_eq_u64 vcc, 0
 s_cbranch_scc1 K5SA0_OK
 s_sleep 1
 s_add_u32 s37, s21, 0
 buffer_load_dwordx4 v[200:203], v1, s[4:7], s37 offen offset:0 sc1
 buffer_load_dwordx4 v[204:207], v1, s[4:7], s37 offen offset:1024 sc1
 s_add_u32 s37, s21, 12288
 buffer_load_dwordx4 v[212:215], v1, s[4:7], s37 offen offset:0 sc1
 buffer_load_dwordx4 v[216:219], v1, s[4:7], s37 offen offset:1024 sc1
 s_waitcnt vmcnt(0)
 s_sub_u32 s39, s39, 1
 s_cmp_lg_u32 s39, 0
 s_cbranch_scc1 K5SA0
K5SA0_OK:
 v_lshlrev_b32 v30, 16, v200
 v_and_b32 v31, 0xffff0000, v200
 v_add_f32 v104, v104, v30
 v_add_f32 v105, v105, v31
 v_lshlrev_b32 v30, 16, v201
 v_and_b32 v31, 0xffff0000, v201
 v_add_f32 v106, v106, v30
 v_add_f32 v107, v107, v31
 v_lshlrev_b32 v30, 16, v202
 v_and_b32 v31, 0xffff0000, v202
 v_add_f32 v108, v108, v30
 v_add_f32 v109, v109, v31
 v_lshlrev_b32 v30, 16, v203
 v_and_b32 v31, 0xffff0000, v203
 v_add_f32 v110, v110, v30
 v_add_f32 v111, v111, v31
 v_lshlrev_b32 v30, 16, v204
 v_and_b32 v31, 0xffff0000, v204
 v_add_f32 v112, v112, v30
 v_add_f32 v113, v113, v31
 v_lshlrev_b32 v30, 16, v205
 v_and_b32 v31, 0xffff0000, v205
 v_add_f32 v114, v114, v30
 v_add_f32 v115, v115, v31
 v_lshlrev_b32 v30, 16, v206
 v_and_b32 v31, 0xffff0000, v206
 v_add_f32 v116, v116, v30
 v_add_f32 v117, v117, v31
 v_lshlrev_b32 v30, 16, v207
 v_and_b32 v31, 0xffff0000, v207
 v_add_f32 v118, v118, v30
 v_add_f32 v119, v119, v31
 v_lshlrev_b32 v30, 16, v212
 v_and_b32 v31, 0xffff0000, v212
 v_add_f32 v104, v104, v30
 v_add_f32 v105, v105, v31
 v_lshlrev_b32 v30, 16, v213
 v_and_b32 v31, 0xffff0000, v213
 v_add_f32 v106, v106, v30
 v_add_f32 v107, v107, v31
 v_lshlrev_b32 v30, 16, v214
 v_and_b32 v31, 0xffff0000, v214
 v_add_f32 v108, v108, v30
 v_add_f32 v109, v109, v31
 v_lshlrev_b32 v30, 16, v215
 v_and_b32 v31, 0xffff0000, v215
 v_add_f32 v110, v110, v30
 v_add_f32 v111, v111, v31
 v_lshlrev_b32 v30, 16, v216
 v_and_b32 v31, 0xffff0000, v216
 v_add_f32 v112, v112, v30
 v_add_f32 v113, v113, v31
 v_lshlrev_b32 v30, 16, v217
 v_and_b32 v31, 0xffff0000, v217
 v_add_f32 v114, v114, v30
 v_add_f32 v115, v115, v31
 v_lshlrev_b32 v30, 16, v218
 v_and_b32 v31, 0xffff0000, v218
 v_add_f32 v116, v116, v30
 v_add_f32 v117, v117, v31
 v_lshlrev_b32 v30, 16, v219
 v_and_b32 v31, 0xffff0000, v219
 v_add_f32 v118, v118, v30
 v_add_f32 v119, v119, v31
 s_mov_b32 s39, 0x20000
 s_waitcnt vmcnt(0)
K5SB0:
 v_max3_u32 v30, v224, v225, v226
 v_max3_u32 v30, v30, v227, v228
 v_max3_u32 v30, v30, v229, v230
 v_max_u32 v30, v30, v231
 v_cmp_eq_u32 vcc, -1, v30
 s_nop 0
 s_cmp_eq_u64 vcc, 0
 s_cbranch_scc1 K5SB0_OK
 s_sleep 1
 s_add_u32 s37, s21, 24576
 buffer_load_dwordx4 v[224:227], v1, s[4:7], s37 offen offset:0 sc1
 buffer_load_dwordx4 v[228:231], v1, s[4:7], s37 offen offset:1024 sc1
 s_waitcnt vmcnt(0)
 s_sub_u32 s39, s39, 1
 s_cmp_lg_u32 s39, 0
 s_cbranch_scc1 K5SB0
K5SB0_OK:
 v_lshlrev_b32 v30, 16, v224
 v_and_b32 v31, 0xffff0000, v224
 v_add_f32 v104, v104, v30
 v_add_f32 v105, v105, v31
 v_lshlrev_b32 v30, 16, v225
 v_and_b32 v31, 0xffff0000, v225
 v_add_f32 v106, v106, v30
 v_add_f32 v107, v107, v31
 v_lshlrev_b32 v30, 16, v226
 v_and_b32 v31, 0xffff0000, v226
 v_add_f32 v108, v108, v30
 v_add_f32 v109, v109, v31
 v_lshlrev_b32 v30, 16, v227
 v_and_b32 v31, 0xffff0000, v227
 v_add_f32 v110, v110, v30
 v_add_f32 v111, v111, v31
 v_lshlrev_b32 v30, 16, v228
 v_and_b32 v31, 0xffff0000, v228
 v_add_f32 v112, v112, v30
 v_add_f32 v113, v113, v31
 v_lshlrev_b32 v30, 16, v229
 v_and_b32 v31, 0xffff0000, v229
 v_add_f32 v114, v114, v30
 v_add_f32 v115, v115, v31
 v_lshlrev_b32 v30, 16, v230
 v_and_b32 v31, 0xffff0000, v230
 v_add_f32 v116, v116, v30
 v_add_f32 v117, v117, v31
 v_lshlrev_b32 v30, 16, v231
 v_and_b32 v31, 0xffff0000, v231
 v_add_f32 v118, v118, v30
 v_add_f32 v119, v119, v31
 v_cvt_pk_bf16_f32 v16, v104, v105
 v_cvt_pk_bf16_f32 v17, v106, v107
 v_cvt_pk_bf16_f32 v18, v108, v109
 v_cvt_pk_bf16_f32 v19, v110, v111
 v_cvt_pk_bf16_f32 v20, v112, v113
 v_cvt_pk_bf16_f32 v21, v114, v115
 v_cvt_pk_bf16_f32 v22, v116, v117
 v_cvt_pk_bf16_f32 v23, v118, v119
 s_cmp_lg_u32 s40, 0
 s_cbranch_scc1 K50_FINAL
 v_bfe_u32 v28, v0, 4, 1
 v_lshlrev_b32 v28, 10, v28
 v_bfe_u32 v30, v0, 5, 1
 v_lshlrev_b32 v30, 9, v30
 v_and_b32 v31, 15, v0
 v_lshlrev_b32 v31, 4, v31
 v_add3_u32 v30, v28, v30, v31
 v_permlane16_swap_b32 v16, v18
 v_permlane16_swap_b32 v17, v19
 v_permlane16_swap_b32 v20, v22
 v_permlane16_swap_b32 v21, v23
 buffer_store_dwordx4 v[16:19], v30, s[4:7], s22 offen offset:0 sc1
 buffer_store_dwordx4 v[20:23], v30, s[4:7], s22 offen offset:2048 sc1
 v_lshlrev_b32 v104, 16, v16
 v_and_b32 v105, 0xffff0000, v16
 v_lshlrev_b32 v106, 16, v17
 v_and_b32 v107, 0xffff0000, v17
 v_lshlrev_b32 v108, 16, v18
 v_and_b32 v109, 0xffff0000, v18
 v_lshlrev_b32 v110, 16, v19
 v_and_b32 v111, 0xffff0000, v19
 v_lshlrev_b32 v112, 16, v20
 v_and_b32 v113, 0xffff0000, v20
 v_lshlrev_b32 v114, 16, v21
 v_and_b32 v115, 0xffff0000, v21
 v_lshlrev_b32 v116, 16, v22
 v_and_b32 v117, 0xffff0000, v22
 v_lshlrev_b32 v118, 16, v23
 v_and_b32 v119, 0xffff0000, v23
 v_add_f32 v26, v104, v105
 v_add_f32 v27, v106, v107
 v_add_f32 v26, v26, v108
 v_add_f32 v27, v27, v109
 v_add_f32 v26, v26, v110
 v_add_f32 v27, v27, v111
 v_add_f32 v26, v26, v112
 v_add_f32 v27, v27, v113
 v_add_f32 v26, v26, v114
 v_add_f32 v27, v27, v115
 v_add_f32 v26, v26, v116
 v_add_f32 v27, v27, v117
 v_add_f32 v26, v26, v118
 v_add_f32 v27, v27, v119
 v_add_f32 v26, v26, v27
 v_mov_b32 v28, v26
 s_nop 1
 v_permlane16_swap_b32 v26, v28
 v_add_f32 v26, v26, v28
 v_mov_b32 v28, v26
 s_nop 1
 v_permlane32_swap_b32 v26, v28
 v_add_f32 v26, v26, v28
 v_mul_f32 v26, 0x3c800000, v26
 v_mov_b32 v27, 0
 v_sub_f32 v104, v104, v26
 v_fmac_f32 v27, v104, v104
 v_sub_f32 v105, v105, v26
 v_fmac_f32 v27, v105, v105
 v_sub_f32 v106, v106, v26
 v_fmac_f32 v27, v106, v106
 v_sub_f32 v107, v107, v26
 v_fmac_f32 v27, v107, v107
 v_sub_f32 v108, v108, v26
 v_fmac_f32 v27, v108, v108
 v_sub_f32 v109, v109, v26
 v_fmac_f32 v27, v109, v109
 v_sub_f32 v110, v110, v26
 v_fmac_f32 v27, v110, v110
 v_sub_f32 v111, v111, v26
 v_fmac_f32 v27, v111, v111
 v_sub_f32 v112, v112, v26
 v_fmac_f32 v27, v112, v112
 v_sub_f32 v113, v113, v26
 v_fmac_f32 v27, v113, v113
 v_sub_f32 v114, v114, v26
 v_fmac_f32 v27, v114, v114
 v_sub_f32 v115, v115, v26
 v_fmac_f32 v27, v115, v115
 v_sub_f32 v116, v116, v26
 v_fmac_f32 v27, v116, v116
 v_sub_f32 v117, v117, v26
 v_fmac_f32 v27, v117, v117
 v_sub_f32 v118, v118, v26
 v_fmac_f32 v27, v118, v118
 v_sub_f32 v119, v119, v26
 v_fmac_f32 v27, v119, v119
 v_mov_b32 v28, v27
 s_nop 1
 v_permlane16_swap_b32 v27, v28
 v_add_f32 v27, v27, v28
 v_mov_b32 v28, v27
 s_nop 1
 v_permlane32_swap_b32 v27, v28
 v_add_f32 v27, v27, v28
 buffer_store_dwordx2 v[26:27], v15, s[4:7], s36 offen sc1
 s_branch K5_DONE
K50_FINAL:
 v_bfe_u32 v28, v0, 4, 1
 v_lshlrev_b32 v28, 5, v28
 v_bfe_u32 v30, v0, 5, 1
 v_lshlrev_b32 v30, 4, v30
 v_and_b32 v31, 15, v0
 v_mul_u32_u24 v31, 1152, v31
 v_add3_u32 v28, v28, v30, v31
 v_permlane16_swap_b32 v16, v18
 v_permlane16_swap_b32 v17, v19
 v_permlane16_swap_b32 v20, v22
 v_permlane16_swap_b32 v21, v23
 buffer_store_dwordx4 v[16:19], v28, s[8:11], s31 offen offset:0
 buffer_store_dwordx4 v[20:23], v28, s[8:11], s31 offen offset:64
 s_endpgm
K5_N1:
 ds_read_b128 v[104:107], v2 offset:37888
 ds_read_b128 v[108:111], v2 offset:38912
 ds_read_b128 v[112:115], v2 offset:39936
 ds_read_b128 v[116:119], v2 offset:40960
 ds_read_b128 v[120:123], v2 offset:41984
 ds_read_b128 v[124:127], v2 offset:43008
 ds_read_b128 v[128:131], v2 offset:44032
 ds_read_b128 v[132:135], v2 offset:45056
 ds_read_b128 v[136:139], v2 offset:46080
 ds_read_b128 v[140:143], v2 offset:47104
 s_waitcnt vmcnt(22) lgkmcnt(7)
 v_mfma_f32_16x16x32_bf16 v[32:35], v[104:107], a[0:3], 0
 s_add_u32 s30, s20, 16384
 buffer_load_dwordx4 a[48:51], v1, s[4:7], s30 offen offset:3072 sc1
 v_mfma_f32_16x16x32_bf16 v[68:71], v[104:107], a[4:7], 0
 ds_read_b128 v[144:147], v2 offset:48128
 v_mfma_f32_16x16x32_bf16 v[36:39], v[108:111], a[0:3], 0
 v_mfma_f32_16x16x32_bf16 v[72:75], v[108:111], a[4:7], 0
 ds_read_b128 v[148:151], v2 offset:49152
 v_mfma_f32_16x16x32_bf16 v[40:43], v[112:115], a[0:3], 0
 s_add_u32 s30, s12, 16384
 buffer_load_dwordx4 a[52:55], v1, s[4:7], s30 offen offset:3072 sc1
 v_mfma_f32_16x16x32_bf16 v[76:79], v[112:115], a[4:7], 0
 ds_read_b128 v[104:107], v2 offset:50176
 s_waitcnt lgkmcnt(7)
 v_mfma_f32_16x16x32_bf16 v[44:47], v[116:119], a[0:3], 0
 v_mfma_f32_16x16x32_bf16 v[80:83], v[116:119], a[4:7], 0
 ds_read_b128 v[108:111], v2 offset:51200
 v_mfma_f32_16x16x32_bf16 v[48:51], v[120:123], a[0:3], 0
 v_mfma_f32_16x16x32_bf16 v[84:87], v[120:123], a[4:7], 0
 ds_read_b128 v[112:115], v2 offset:52224
 v_mfma_f32_16x16x32_bf16 v[52:55], v[124:127], a[0:3], 0
 v_mfma_f32_16x16x32_bf16 v[88:91], v[124:127], a[4:7], 0
 ds_read_b128 v[116:119], v2 offset:53248
 s_waitcnt lgkmcnt(7)
 v_mfma_f32_16x16x32_bf16 v[56:59], v[128:131], a[0:3], 0
 v_mfma_f32_16x16x32_bf16 v[92:95], v[128:131], a[4:7], 0
 ds_read_b128 v[120:123], v2 offset:54272
 s_waitcnt vmcnt(22)
 v_mfma_f32_16x16x32_bf16 v[32:35], v[132:135], a[8:11], v[32:35]
 s_add_u32 s30, s20, 28672
 buffer_load_dwordx4 a[56:59], v1, s[4:7], s30 offen offset:0 sc1
 v_mfma_f32_16x16x32_bf16 v[68:71], v[132:135], a[12:15], v[68:71]
 ds_read_b128 v[124:127], v2 offset:55296
 v_mfma_f32_16x16x32_bf16 v[36:39], v[136:139], a[8:11], v[36:39]
 s_and_b32 s24, s2, 7
 s_lshr_b32 s25, s2, 3
 s_lshr_b32 s86, s24, 1
 s_lshl_b32 s86, s86, 2
 s_and_b32 s27, s25, 3
 s_add_u32 s86, s86, s27
 s_and_b32 s87, s24, 1
 s_lshl_b32 s87, s87, 3
 v_mfma_f32_16x16x32_bf16 v[72:75], v[136:139], a[12:15], v[72:75]
 ds_read_b128 v[128:131], v2 offset:56320
 s_waitcnt lgkmcnt(7)
 v_mfma_f32_16x16x32_bf16 v[40:43], v[140:143], a[8:11], v[40:43]
 s_add_u32 s30, s12, 28672
 buffer_load_dwordx4 a[60:63], v1, s[4:7], s30 offen offset:0 sc1
 v_mfma_f32_16x16x32_bf16 v[76:79], v[140:143], a[12:15], v[76:79]
 ds_read_b128 v[132:135], v2 offset:57344
 v_mfma_f32_16x16x32_bf16 v[44:47], v[144:147], a[8:11], v[44:47]
 s_lshr_b32 s34, s25, 2
 s_add_u32 s87, s87, s34
 s_lshl_b32 s78, s3, 10
 s_lshl_b32 s34, s87, 2
 s_mul_i32 s35, s87, 3
 s_add_u32 s35, s35, 9
 s_cmp_ge_u32 s87, 9
 s_cselect_b32 s34, s35, s34
 v_mfma_f32_16x16x32_bf16 v[80:83], v[144:147], a[12:15], v[80:83]
 ds_read_b128 v[136:139], v2 offset:58368
 v_mfma_f32_16x16x32_bf16 v[48:51], v[148:151], a[8:11], v[48:51]
 s_cmp_eq_u32 s87, 15
 s_cselect_b32 s34, 34, s34
 s_mul_i32 s76, s34, 37888
 s_add_u32 s76, s76, 56442880
 s_add_u32 s77, s76, s78
 s_lshr_b32 s32, s82, 1
 s_and_b32 s33, s82, 1
 s_lshl_b32 s34, s80, 2
 v_mfma_f32_16x16x32_bf16 v[84:87], v[148:151], a[12:15], v[84:87]
 ds_read_b128 v[140:143], v2 offset:59392
 s_waitcnt lgkmcnt(7)
 v_mfma_f32_16x16x32_bf16 v[52:55], v[104:107], a[8:11], v[52:55]
 s_add_u32 s34, s34, s3
 s_lshl_b32 s27, s80, 2
 s_add_u32 s27, s27, s81
 s_mul_i32 s21, s27, 147456
 s_mul_i32 s35, s3, 3072
 s_add_u32 s21, s21, s35
 s_add_u32 s21, s21, 46940160
 s_mul_i32 s35, s32, 12288
 v_mfma_f32_16x16x32_bf16 v[88:91], v[104:107], a[12:15], v[88:91]
 ds_read_b128 v[144:147], v2 offset:60416
 v_mfma_f32_16x16x32_bf16 v[56:59], v[108:111], a[8:11], v[56:59]
 s_add_u32 s35, s35, s21
 s_xor_b32 s36, s82, 1
 s_mul_i32 s36, s36, 36864
 s_add_u32 s16, s35, s36
 s_xor_b32 s36, s82, 3
 s_mul_i32 s36, s36, 36864
 s_add_u32 s17, s35, s36
 s_xor_b32 s36, s82, 2
 v_mfma_f32_16x16x32_bf16 v[92:95], v[108:111], a[12:15], v[92:95]
 ds_read_b128 v[148:151], v2 offset:61440
 s_waitcnt vmcnt(21)
 v_mfma_f32_16x16x32_bf16 v[32:35], v[112:115], a[16:19], v[32:35]
 s_add_u32 s30, s20, 0
 buffer_load_dwordx4 a[64:67], v1, s[4:7], s30 offen offset:2048 sc1
 v_mfma_f32_16x16x32_bf16 v[68:71], v[112:115], a[20:23], v[68:71]
 ds_read_b128 v[104:107], v2 offset:62464
 s_waitcnt lgkmcnt(7)
 v_mfma_f32_16x16x32_bf16 v[36:39], v[116:119], a[16:19], v[36:39]
 s_mul_i32 s36, s36, 36864
 s_add_u32 s18, s21, s36
 s_add_u32 s18, s18, 24576
 s_mul_i32 s36, s82, 36864
 s_add_u32 s21, s21, s36
 s_mul_i32 s13, s81, 9
 s_lshl_b32 s35, s33, 2
 s_add_u32 s13, s13, s35
 v_mfma_f32_16x16x32_bf16 v[72:75], v[116:119], a[20:23], v[72:75]
 ds_read_b128 v[108:111], v2 offset:63488
 v_mfma_f32_16x16x32_bf16 v[40:43], v[120:123], a[16:19], v[40:43]
 s_add_u32 s30, s12, 0
 buffer_load_dwordx4 a[68:71], v1, s[4:7], s30 offen offset:2048 sc1
 v_mfma_f32_16x16x32_bf16 v[76:79], v[120:123], a[20:23], v[76:79]
 ds_read_b128 v[112:115], v2 offset:64512
 v_mfma_f32_16x16x32_bf16 v[44:47], v[124:127], a[16:19], v[44:47]
 v_and_b32 v11, 15, v0
 v_lshlrev_b32 v11, 4, v11
 v_mfma_f32_16x16x32_bf16 v[80:83], v[124:127], a[20:23], v[80:83]
 ds_read_b128 v[116:119], v3 offset:0
 s_waitcnt lgkmcnt(7)
 v_mfma_f32_16x16x32_bf16 v[48:51], v[128:131], a[16:19], v[48:51]
 v_bfe_u32 v28, v0, 5, 1
 v_lshlrev_b32 v28, 9, v28
 v_mfma_f32_16x16x32_bf16 v[84:87], v[128:131], a[20:23], v[84:87]
 ds_read_b128 v[120:123], v3 offset:1024
 v_mfma_f32_16x16x32_bf16 v[52:55], v[132:135], a[16:19], v[52:55]
 v_add_u32 v11, v11, v28
 v_bfe_u32 v28, v0, 4, 1
 v_mfma_f32_16x16x32_bf16 v[88:91], v[132:135], a[20:23], v[88:91]
 ds_read_b128 v[124:127], v3 offset:2048
 v_mfma_f32_16x16x32_bf16 v[56:59], v[136:139], a[16:19], v[56:59]
 v_lshlrev_b32 v28, 3, v28
 v_add_u32 v11, v11, v28
 v_mfma_f32_16x16x32_bf16 v[92:95], v[136:139], a[20:23], v[92:95]
 ds_read_b128 v[128:131], v3 offset:3072
 s_waitcnt vmcnt(21) lgkmcnt(7)
 v_mfma_f32_16x16x32_bf16 v[32:35], v[140:143], a[24:27], v[32:35]
 s_add_u32 s30, s20, 8192
 buffer_load_dwordx4 a[72:75], v1, s[4:7], s30 offen offset:3072 sc1
 v_mfma_f32_16x16x32_bf16 v[68:71], v[140:143], a[28:31], v[68:71]
 ds_read_b128 v[132:135], v3 offset:4096
 v_mfma_f32_16x16x32_bf16 v[36:39], v[144:147], a[24:27], v[36:39]
 s_mul_i32 s28, s34, 36
 s_add_u32 s28, s28, s13
 s_lshl_b32 s28, s28, 10
 s_lshl_b32 s29, s32, 8
 s_add_u32 s28, s28, s29
 s_add_u32 s28, s28, s42
 s_add_u32 s22, s28, 4718592
 s_add_u32 s23, s22, 4096
 v_mfma_f32_16x16x32_bf16 v[72:75], v[144:147], a[28:31], v[72:75]
 ds_read_b128 v[136:139], v3 offset:5120
 v_mfma_f32_16x16x32_bf16 v[40:43], v[148:151], a[24:27], v[40:43]
 s_add_u32 s30, s12, 8192
 buffer_load_dwordx4 a[76:79], v1, s[4:7], s30 offen offset:3072 sc1
 v_mfma_f32_16x16x32_bf16 v[76:79], v[148:151], a[28:31], v[76:79]
 ds_read_b128 v[140:143], v3 offset:6144
 s_waitcnt lgkmcnt(7)
 v_mfma_f32_16x16x32_bf16 v[44:47], v[104:107], a[24:27], v[44:47]
 s_add_u32 s28, s28, 2359296
 s_add_u32 s29, s28, 4096
 v_and_b32 v15, 15, v0
 v_mfma_f32_16x16x32_bf16 v[80:83], v[104:107], a[28:31], v[80:83]
 ds_read_b128 v[144:147], v3 offset:7168
 v_mfma_f32_16x16x32_bf16 v[48:51], v[108:111], a[24:27], v[48:51]
 v_mul_u32_u24 v29, 1152, v15
 v_lshlrev_b32 v15, 3, v15
 v_mfma_f32_16x16x32_bf16 v[84:87], v[108:111], a[28:31], v[84:87]
 ds_read_b128 v[148:151], v3 offset:8192
 v_mfma_f32_16x16x32_bf16 v[52:55], v[112:115], a[24:27], v[52:55]
 s_lshl_b32 s35, s34, 1
 s_add_u32 s35, s35, s32
 s_lshl_b32 s36, s35, 10
 s_lshl_b32 s37, s81, 1
 s_add_u32 s37, s37, s33
 s_lshl_b32 s37, s37, 7
 s_add_u32 s36, s36, s37
 s_add_u32 s36, s36, s43
 v_mfma_f32_16x16x32_bf16 v[88:91], v[112:115], a[28:31], v[88:91]
 ds_read_b128 v[104:107], v3 offset:9216
 s_waitcnt lgkmcnt(7)
 v_mfma_f32_16x16x32_bf16 v[56:59], v[116:119], a[24:27], v[56:59]
 s_add_u32 s36, s36, 262144
 v_bfe_u32 v28, v0, 4, 2
 v_mfma_f32_16x16x32_bf16 v[92:95], v[116:119], a[28:31], v[92:95]
 ds_read_b128 v[108:111], v3 offset:10240
 s_waitcnt vmcnt(21)
 v_mfma_f32_16x16x32_bf16 v[32:35], v[120:123], a[32:35], v[32:35]
 s_add_u32 s30, s20, 20480
 buffer_load_dwordx4 a[80:83], v1, s[4:7], s30 offen offset:0 sc1
 v_mfma_f32_16x16x32_bf16 v[68:71], v[120:123], a[36:39], v[68:71]
 ds_read_b128 v[112:115], v3 offset:11264
 v_mfma_f32_16x16x32_bf16 v[36:39], v[124:127], a[32:35], v[36:39]
 v_lshlrev_b32 v28, 3, v28
 v_add_u32 v29, v29, v28
 v_mfma_f32_16x16x32_bf16 v[72:75], v[124:127], a[36:39], v[72:75]
 ds_read_b128 v[116:119], v3 offset:12288
 s_waitcnt lgkmcnt(7)
 v_mfma_f32_16x16x32_bf16 v[40:43], v[128:131], a[32:35], v[40:43]
 s_add_u32 s30, s12, 20480
 buffer_load_dwordx4 a[84:87], v1, s[4:7], s30 offen offset:0 sc1
 v_mfma_f32_16x16x32_bf16 v[76:79], v[128:131], a[36:39], v[76:79]
 ds_read_b128 v[120:123], v3 offset:13312
 v_mfma_f32_16x16x32_bf16 v[44:47], v[132:135], a[32:35], v[44:47]
 s_mul_i32 s31, s35, 18432
 s_lshl_b32 s37, s13, 5
 s_add_u32 s31, s31, s37
 s_sub_u32 s25, s15, 65536
 v_mfma_f32_16x16x32_bf16 v[80:83], v[132:135], a[36:39], v[80:83]
 ds_read_b128 v[124:127], v3 offset:14336
 v_mfma_f32_16x16x32_bf16 v[48:51], v[136:139], a[32:35], v[48:51]
 v_mfma_f32_16x16x32_bf16 v[84:87], v[136:139], a[36:39], v[84:87]
 ds_read_b128 v[128:131], v3 offset:15360
 s_waitcnt lgkmcnt(7)
 v_mfma_f32_16x16x32_bf16 v[52:55], v[140:143], a[32:35], v[52:55]
 v_mfma_f32_16x16x32_bf16 v[88:91], v[140:143], a[36:39], v[88:91]
 ds_read_b128 v[132:135], v3 offset:16384
 v_mfma_f32_16x16x32_bf16 v[56:59], v[144:147], a[32:35], v[56:59]
 v_mfma_f32_16x16x32_bf16 v[92:95], v[144:147], a[36:39], v[92:95]
 ds_read_b128 v[136:139], v3 offset:17408
 s_waitcnt vmcnt(21)
 v_mfma_f32_16x16x32_bf16 v[32:35], v[148:151], a[40:43], v[32:35]
 s_add_u32 s30, s20, 28672
 buffer_load_dwordx4 a[88:91], v1, s[4:7], s30 offen offset:1024 sc1
 v_mfma_f32_16x16x32_bf16 v[68:71], v[148:151], a[44:47], v[68:71]
 ds_read_b128 v[140:143], v3 offset:18432
 s_waitcnt lgkmcnt(7)
 v_mfma_f32_16x16x32_bf16 v[36:39], v[104:107], a[40:43], v[36:39]
 v_mfma_f32_16x16x32_bf16 v[72:75], v[104:107], a[44:47], v[72:75]
 ds_read_b128 v[144:147], v3 offset:19456
 v_mfma_f32_16x16x32_bf16 v[40:43], v[108:111], a[40:43], v[40:43]
 s_add_u32 s30, s12, 28672
 buffer_load_dwordx4 a[92:95], v1, s[4:7], s30 offen offset:1024 sc1
 v_mfma_f32_16x16x32_bf16 v[76:79], v[108:111], a[44:47], v[76:79]
 ds_read_b128 v[148:151], v3 offset:20480
 v_mfma_f32_16x16x32_bf16 v[44:47], v[112:115], a[40:43], v[44:47]
 v_mfma_f32_16x16x32_bf16 v[80:83], v[112:115], a[44:47], v[80:83]
 ds_read_b128 v[104:107], v3 offset:21504
 s_waitcnt lgkmcnt(7)
 v_mfma_f32_16x16x32_bf16 v[48:51], v[116:119], a[40:43], v[48:51]
 v_mfma_f32_16x16x32_bf16 v[84:87], v[116:119], a[44:47], v[84:87]
 ds_read_b128 v[108:111], v3 offset:22528
 v_mfma_f32_16x16x32_bf16 v[52:55], v[120:123], a[40:43], v[52:55]
 v_mfma_f32_16x16x32_bf16 v[88:91], v[120:123], a[44:47], v[88:91]
 ds_read_b128 v[112:115], v3 offset:23552
 v_mfma_f32_16x16x32_bf16 v[56:59], v[124:127], a[40:43], v[56:59]
 v_mfma_f32_16x16x32_bf16 v[92:95], v[124:127], a[44:47], v[92:95]
 ds_read_b128 v[116:119], v3 offset:24576
 s_waitcnt vmcnt(10) lgkmcnt(7)
 v_mfma_f32_16x16x32_bf16 v[32:35], v[128:131], a[48:51], v[32:35]
 s_add_u32 s30, s20, 4096
 buffer_load_dwordx4 a[96:99], v1, s[4:7], s30 offen offset:1024 sc1
 v_mfma_f32_16x16x32_bf16 v[68:71], v[128:131], a[52:55], v[68:71]
 ds_read_b128 v[120:123], v3 offset:25600
 v_mfma_f32_16x16x32_bf16 v[36:39], v[132:135], a[48:51], v[36:39]
 v_mfma_f32_16x16x32_bf16 v[72:75], v[132:135], a[52:55], v[72:75]
 ds_read_b128 v[124:127], v3 offset:26624
 v_mfma_f32_16x16x32_bf16 v[40:43], v[136:139], a[48:51], v[40:43]
 s_add_u32 s30, s12, 4096
 buffer_load_dwordx4 a[100:103], v1, s[4:7], s30 offen offset:1024 sc1
 v_mfma_f32_16x16x32_bf16 v[76:79], v[136:139], a[52:55], v[76:79]
 ds_read_b128 v[128:131], v3 offset:27648
 s_waitcnt lgkmcnt(7)
 v_mfma_f32_16x16x32_bf16 v[44:47], v[140:143], a[48:51], v[44:47]
 v_mfma_f32_16x16x32_bf16 v[80:83], v[140:143], a[52:55], v[80:83]
 ds_read_b128 v[132:135], v3 offset:28672
 v_mfma_f32_16x16x32_bf16 v[48:51], v[144:147], a[48:51], v[48:51]
 v_mfma_f32_16x16x32_bf16 v[84:87], v[144:147], a[52:55], v[84:87]
 s_barrier
 s_cmp_lg_u32 s3, 0
 s_cbranch_scc1 SIG5
 s_mov_b64 exec, 1
 v_mov_b32 v30, 0
 v_mov_b32 v31, 1
 s_lshl_b32 s38, s26, 5
 s_add_u32 s38, s38, 9961472
 buffer_store_dword v31, v30, s[4:7], s38 offen sc1
 s_mov_b64 exec, -1
SIG5:
 ds_read_b128 v[136:139], v3 offset:29696
 v_mfma_f32_16x16x32_bf16 v[52:55], v[148:151], a[48:51], v[52:55]
 s_add_u32 s38, s79, 3072
 s_add_u32 m0, s83, 37888
 s_nop 0
 buffer_load_dwordx4 v1, s[4:7], s38 offen sc1 lds
 v_mfma_f32_16x16x32_bf16 v[88:91], v[148:151], a[52:55], v[88:91]
 ds_read_b128 v[140:143], v3 offset:30720
 s_waitcnt lgkmcnt(7)
 v_mfma_f32_16x16x32_bf16 v[56:59], v[104:107], a[48:51], v[56:59]
 v_mfma_f32_16x16x32_bf16 v[92:95], v[104:107], a[52:55], v[92:95]
 ds_read_b128 v[144:147], v3 offset:31744
 s_waitcnt vmcnt(11)
 v_mfma_f32_16x16x32_bf16 v[32:35], v[108:111], a[56:59], v[32:35]
 s_add_u32 s30, s20, 12288
 buffer_load_dwordx4 a[104:107], v1, s[4:7], s30 offen offset:2048 sc1
 v_mfma_f32_16x16x32_bf16 v[68:71], v[108:111], a[60:63], v[68:71]
 ds_read_b128 v[148:151], v3 offset:32768
 v_mfma_f32_16x16x32_bf16 v[36:39], v[112:115], a[56:59], v[36:39]
 s_add_u32 s30, s12, 12288
 buffer_load_dwordx4 a[108:111], v1, s[4:7], s30 offen offset:2048 sc1
 v_mfma_f32_16x16x32_bf16 v[72:75], v[112:115], a[60:63], v[72:75]
 ds_read_b128 v[104:107], v3 offset:33792
 s_waitcnt lgkmcnt(7)
 v_mfma_f32_16x16x32_bf16 v[40:43], v[116:119], a[56:59], v[40:43]
 v_mfma_f32_16x16x32_bf16 v[76:79], v[116:119], a[60:63], v[76:79]
 ds_read_b128 v[108:111], v3 offset:34816
 v_mfma_f32_16x16x32_bf16 v[44:47], v[120:123], a[56:59], v[44:47]
 s_add_u32 s38, s79, 150528
 s_add_u32 m0, s83, 38912
 s_nop 0
 buffer_load_dwordx4 v1, s[4:7], s38 offen sc1 lds
 v_mfma_f32_16x16x32_bf16 v[80:83], v[120:123], a[60:63], v[80:83]
 ds_read_b128 v[112:115], v3 offset:35840
 v_mfma_f32_16x16x32_bf16 v[48:51], v[124:127], a[56:59], v[48:51]
 s_add_u32 s38, s79, 297984
 s_add_u32 m0, s83, 39936
 s_nop 0
 buffer_load_dwordx4 v1, s[4:7], s38 offen sc1 lds
 v_mfma_f32_16x16x32_bf16 v[84:87], v[124:127], a[60:63], v[84:87]
 ds_read_b128 v[116:119], v3 offset:36864
 s_waitcnt lgkmcnt(7)
 v_mfma_f32_16x16x32_bf16 v[52:55], v[128:131], a[56:59], v[52:55]
 v_mfma_f32_16x16x32_bf16 v[88:91], v[128:131], a[60:63], v[88:91]
 ds_read_b128 v[120:123], v3 offset:37888
 v_mfma_f32_16x16x32_bf16 v[56:59], v[132:135], a[56:59], v[56:59]
 s_add_u32 s38, s79, 445440
 s_add_u32 m0, s83, 40960
 s_nop 0
 buffer_load_dwordx4 v1, s[4:7], s38 offen sc1 lds
 v_mfma_f32_16x16x32_bf16 v[92:95], v[132:135], a[60:63], v[92:95]
 ds_read_b128 v[124:127], v3 offset:38912
 s_waitcnt vmcnt(14)
 v_mfma_f32_16x16x32_bf16 v[32:35], v[136:139], a[64:67], v[32:35]
 s_add_u32 s30, s20, 20480
 buffer_load_dwordx4 a[112:115], v1, s[4:7], s30 offen offset:3072 sc1
 v_mfma_f32_16x16x32_bf16 v[68:71], v[136:139], a[68:71], v[68:71]
 ds_read_b128 v[128:131], v3 offset:39936
 s_waitcnt lgkmcnt(7)
 v_mfma_f32_16x16x32_bf16 v[36:39], v[140:143], a[64:67], v[36:39]
 v_mfma_f32_16x16x32_bf16 v[72:75], v[140:143], a[68:71], v[72:75]
 ds_read_b128 v[132:135], v3 offset:40960
 v_mfma_f32_16x16x32_bf16 v[40:43], v[144:147], a[64:67], v[40:43]
 s_add_u32 s30, s12, 20480
 buffer_load_dwordx4 a[116:119], v1, s[4:7], s30 offen offset:3072 sc1
 v_mfma_f32_16x16x32_bf16 v[76:79], v[144:147], a[68:71], v[76:79]
 ds_read_b128 v[136:139], v3 offset:41984
 v_mfma_f32_16x16x32_bf16 v[44:47], v[148:151], a[64:67], v[44:47]
 s_add_u32 s38, s79, 592896
 s_add_u32 m0, s83, 41984
 s_nop 0
 buffer_load_dwordx4 v1, s[4:7], s38 offen sc1 lds
 v_mfma_f32_16x16x32_bf16 v[80:83], v[148:151], a[68:71], v[80:83]
 ds_read_b128 v[140:143], v3 offset:43008
 s_waitcnt lgkmcnt(7)
 v_mfma_f32_16x16x32_bf16 v[48:51], v[104:107], a[64:67], v[48:51]
 v_mfma_f32_16x16x32_bf16 v[84:87], v[104:107], a[68:71], v[84:87]
 ds_read_b128 v[144:147], v3 offset:44032
 v_mfma_f32_16x16x32_bf16 v[52:55], v[108:111], a[64:67], v[52:55]
 s_add_u32 s38, s19, 740352
 s_add_u32 m0, s83, 43008
 s_nop 0
 buffer_load_dwordx4 v1, s[4:7], s38 offen sc1 lds
 v_mfma_f32_16x16x32_bf16 v[88:91], v[108:111], a[68:71], v[88:91]
 ds_read_b128 v[148:151], v3 offset:45056
 v_mfma_f32_16x16x32_bf16 v[56:59], v[112:115], a[64:67], v[56:59]
 s_add_u32 s38, s19, 887808
 s_add_u32 m0, s83, 44032
 s_nop 0
 buffer_load_dwordx4 v1, s[4:7], s38 offen sc1 lds
 v_mfma_f32_16x16x32_bf16 v[92:95], v[112:115], a[68:71], v[92:95]
 ds_read_b128 v[104:107], v3 offset:46080
 s_waitcnt vmcnt(17) lgkmcnt(7)
 v_mfma_f32_16x16x32_bf16 v[32:35], v[116:119], a[72:75], v[32:35]
 s_add_u32 s30, s20, 32768
 buffer_load_dwordx4 a[120:123], v1, s[4:7], s30 offen offset:0 sc1
 v_mfma_f32_16x16x32_bf16 v[68:71], v[116:119], a[76:79], v[68:71]
 ds_read_b128 v[108:111], v3 offset:47104
 v_mfma_f32_16x16x32_bf16 v[36:39], v[120:123], a[72:75], v[36:39]
 v_mfma_f32_16x16x32_bf16 v[72:75], v[120:123], a[76:79], v[72:75]
 ds_read_b128 v[112:115], v3 offset:48128
 v_mfma_f32_16x16x32_bf16 v[40:43], v[124:127], a[72:75], v[40:43]
 s_add_u32 s30, s12, 32768
 buffer_load_dwordx4 a[124:127], v1, s[4:7], s30 offen offset:0 sc1
 v_mfma_f32_16x16x32_bf16 v[76:79], v[124:127], a[76:79], v[76:79]
 ds_read_b128 v[116:119], v3 offset:49152
 s_waitcnt lgkmcnt(7)
 v_mfma_f32_16x16x32_bf16 v[44:47], v[128:131], a[72:75], v[44:47]
 v_mfma_f32_16x16x32_bf16 v[80:83], v[128:131], a[76:79], v[80:83]
 ds_read_b128 v[120:123], v3 offset:50176
 v_mfma_f32_16x16x32_bf16 v[48:51], v[132:135], a[72:75], v[48:51]
 v_mfma_f32_16x16x32_bf16 v[84:87], v[132:135], a[76:79], v[84:87]
 ds_read_b128 v[124:127], v3 offset:51200
 v_mfma_f32_16x16x32_bf16 v[52:55], v[136:139], a[72:75], v[52:55]
 v_mfma_f32_16x16x32_bf16 v[88:91], v[136:139], a[76:79], v[88:91]
 ds_read_b128 v[128:131], v3 offset:52224
 s_waitcnt lgkmcnt(7)
 v_mfma_f32_16x16x32_bf16 v[56:59], v[140:143], a[72:75], v[56:59]
 v_mfma_f32_16x16x32_bf16 v[92:95], v[140:143], a[76:79], v[92:95]
 ds_read_b128 v[132:135], v3 offset:53248
 s_waitcnt vmcnt(17)
 v_mfma_f32_16x16x32_bf16 v[32:35], v[144:147], a[80:83], v[32:35]
 s_add_u32 s30, s20, 4096
 buffer_load_dwordx4 a[128:131], v1, s[4:7], s30 offen offset:2048 sc1
 v_mfma_f32_16x16x32_bf16 v[68:71], v[144:147], a[84:87], v[68:71]
 ds_read_b128 v[136:139], v3 offset:54272
 v_mfma_f32_16x16x32_bf16 v[36:39], v[148:151], a[80:83], v[36:39]
 v_mfma_f32_16x16x32_bf16 v[72:75], v[148:151], a[84:87], v[72:75]
 ds_read_b128 v[140:143], v3 offset:55296
 s_waitcnt lgkmcnt(7)
 v_mfma_f32_16x16x32_bf16 v[40:43], v[104:107], a[80:83], v[40:43]
 s_add_u32 s30, s12, 4096
 buffer_load_dwordx4 a[132:135], v1, s[4:7], s30 offen offset:2048 sc1
 v_mfma_f32_16x16x32_bf16 v[76:79], v[104:107], a[84:87], v[76:79]
 ds_read_b128 v[144:147], v3 offset:56320
 v_mfma_f32_16x16x32_bf16 v[44:47], v[108:111], a[80:83], v[44:47]
 v_mfma_f32_16x16x32_bf16 v[80:83], v[108:111], a[84:87], v[80:83]
 ds_read_b128 v[148:151], v3 offset:57344
 v_mfma_f32_16x16x32_bf16 v[48:51], v[112:115], a[80:83], v[48:51]
 v_mfma_f32_16x16x32_bf16 v[84:87], v[112:115], a[84:87], v[84:87]
 s_barrier
 ds_read_b128 v[104:107], v3 offset:58368
 s_waitcnt lgkmcnt(7)
 v_mfma_f32_16x16x32_bf16 v[52:55], v[116:119], a[80:83], v[52:55]
 s_add_u32 s38, s79, 7168
 s_add_u32 m0, s83, 66560
 s_nop 0
 buffer_load_dwordx4 v1, s[4:7], s38 offen sc1 lds
 v_mfma_f32_16x16x32_bf16 v[88:91], v[116:119], a[84:87], v[88:91]
 ds_read_b128 v[108:111], v3 offset:59392
 v_mfma_f32_16x16x32_bf16 v[56:59], v[120:123], a[80:83], v[56:59]
 v_mfma_f32_16x16x32_bf16 v[92:95], v[120:123], a[84:87], v[92:95]
 ds_read_b128 v[112:115], v3 offset:60416
 s_waitcnt vmcnt(18)
 v_mfma_f32_16x16x32_bf16 v[32:35], v[124:127], a[88:91], v[32:35]
 s_add_u32 s30, s20, 12288
 buffer_load_dwordx4 a[136:139], v1, s[4:7], s30 offen offset:3072 sc1
 v_mfma_f32_16x16x32_bf16 v[68:71], v[124:127], a[92:95], v[68:71]
 ds_read_b128 v[116:119], v3 offset:61440
 s_waitcnt lgkmcnt(7)
 v_mfma_f32_16x16x32_bf16 v[36:39], v[128:131], a[88:91], v[36:39]
 s_add_u32 s30, s12, 12288
 buffer_load_dwordx4 a[140:143], v1, s[4:7], s30 offen offset:3072 sc1
 v_mfma_f32_16x16x32_bf16 v[72:75], v[128:131], a[92:95], v[72:75]
 ds_read_b128 v[120:123], v3 offset:62464
 v_mfma_f32_16x16x32_bf16 v[40:43], v[132:135], a[88:91], v[40:43]
 v_mfma_f32_16x16x32_bf16 v[76:79], v[132:135], a[92:95], v[76:79]
 ds_read_b128 v[124:127], v3 offset:63488
 v_mfma_f32_16x16x32_bf16 v[44:47], v[136:139], a[88:91], v[44:47]
 s_add_u32 s38, s79, 154624
 s_add_u32 m0, s83, 67584
 s_nop 0
 buffer_load_dwordx4 v1, s[4:7], s38 offen sc1 lds
 v_mfma_f32_16x16x32_bf16 v[80:83], v[136:139], a[92:95], v[80:83]
 ds_read_b128 v[128:131], v3 offset:64512
 s_waitcnt lgkmcnt(7)
 v_mfma_f32_16x16x32_bf16 v[48:51], v[140:143], a[88:91], v[48:51]
 s_add_u32 s38, s79, 302080
 s_add_u32 m0, s83, 68608
 s_nop 0
 buffer_load_dwordx4 v1, s[4:7], s38 offen sc1 lds
 v_mfma_f32_16x16x32_bf16 v[84:87], v[140:143], a[92:95], v[84:87]
 ds_read_b128 v[132:135], v4 offset:0
 v_mfma_f32_16x16x32_bf16 v[52:55], v[144:147], a[88:91], v[52:55]
 v_mfma_f32_16x16x32_bf16 v[88:91], v[144:147], a[92:95], v[88:91]
 ds_read_b128 v[136:139], v4 offset:1024
 v_mfma_f32_16x16x32_bf16 v[56:59], v[148:151], a[88:91], v[56:59]
 s_add_u32 s38, s79, 449536
 s_add_u32 m0, s83, 69632
 s_nop 0
 buffer_load_dwordx4 v1, s[4:7], s38 offen sc1 lds
 v_mfma_f32_16x16x32_bf16 v[92:95], v[148:151], a[92:95], v[92:95]
 ds_read_b128 v[140:143], v4 offset:2048
 s_waitcnt vmcnt(21) lgkmcnt(7)
 v_mfma_f32_16x16x32_bf16 v[32:35], v[104:107], a[96:99], v[32:35]
 s_add_u32 s30, s20, 24576
 buffer_load_dwordx4 a[144:147], v1, s[4:7], s30 offen offset:0 sc1
 v_mfma_f32_16x16x32_bf16 v[68:71], v[104:107], a[100:103], v[68:71]
 ds_read_b128 v[144:147], v4 offset:3072
 v_mfma_f32_16x16x32_bf16 v[36:39], v[108:111], a[96:99], v[36:39]
 v_mfma_f32_16x16x32_bf16 v[72:75], v[108:111], a[100:103], v[72:75]
 ds_read_b128 v[148:151], v4 offset:4096
 v_mfma_f32_16x16x32_bf16 v[40:43], v[112:115], a[96:99], v[40:43]
 s_add_u32 s30, s12, 24576
 buffer_load_dwordx4 a[148:151], v1, s[4:7], s30 offen offset:0 sc1
 v_mfma_f32_16x16x32_bf16 v[76:79], v[112:115], a[100:103], v[76:79]
 ds_read_b128 v[104:107], v4 offset:5120
 s_waitcnt lgkmcnt(7)
 v_mfma_f32_16x16x32_bf16 v[44:47], v[116:119], a[96:99], v[44:47]
 s_add_u32 s38, s79, 596992
 s_add_u32 m0, s83, 70656
 s_nop 0
 buffer_load_dwordx4 v1, s[4:7], s38 offen sc1 lds
 v_mfma_f32_16x16x32_bf16 v[80:83], v[116:119], a[100:103], v[80:83]
 ds_read_b128 v[108:111], v4 offset:6144
 v_mfma_f32_16x16x32_bf16 v[48:51], v[120:123], a[96:99], v[48:51]
 v_mfma_f32_16x16x32_bf16 v[84:87], v[120:123], a[100:103], v[84:87]
 ds_read_b128 v[112:115], v4 offset:7168
 v_mfma_f32_16x16x32_bf16 v[52:55], v[124:127], a[96:99], v[52:55]
 s_add_u32 s38, s19, 744448
 s_add_u32 m0, s83, 71680
 s_nop 0
 buffer_load_dwordx4 v1, s[4:7], s38 offen sc1 lds
 v_mfma_f32_16x16x32_bf16 v[88:91], v[124:127], a[100:103], v[88:91]
 ds_read_b128 v[116:119], v4 offset:8192
 s_waitcnt lgkmcnt(7)
 v_mfma_f32_16x16x32_bf16 v[56:59], v[128:131], a[96:99], v[56:59]
 s_add_u32 s38, s19, 891904
 s_add_u32 m0, s83, 72704
 s_nop 0
 buffer_load_dwordx4 v1, s[4:7], s38 offen sc1 lds
 v_mfma_f32_16x16x32_bf16 v[92:95], v[128:131], a[100:103], v[92:95]
 buffer_load_dword v13, v14, s[4:7], s25 offen sc1
 ds_read_b128 v[120:123], v4 offset:9216
 s_waitcnt vmcnt(24)
 v_mfma_f32_16x16x32_bf16 v[32:35], v[132:135], a[104:107], v[32:35]
 s_add_u32 s30, s20, 32768
 buffer_load_dwordx4 a[152:155], v1, s[4:7], s30 offen offset:1024 sc1
 v_mfma_f32_16x16x32_bf16 v[68:71], v[132:135], a[108:111], v[68:71]
 ds_read_b128 v[124:127], v4 offset:10240
 v_mfma_f32_16x16x32_bf16 v[36:39], v[136:139], a[104:107], v[36:39]
 v_mfma_f32_16x16x32_bf16 v[72:75], v[136:139], a[108:111], v[72:75]
 ds_read_b128 v[128:131], v4 offset:11264
 s_waitcnt lgkmcnt(7)
 v_mfma_f32_16x16x32_bf16 v[40:43], v[140:143], a[104:107], v[40:43]
 s_add_u32 s30, s12, 32768
 buffer_load_dwordx4 a[156:159], v1, s[4:7], s30 offen offset:1024 sc1
 v_mfma_f32_16x16x32_bf16 v[76:79], v[140:143], a[108:111], v[76:79]
 ds_read_b128 v[132:135], v4 offset:12288
 v_mfma_f32_16x16x32_bf16 v[44:47], v[144:147], a[104:107], v[44:47]
 v_mfma_f32_16x16x32_bf16 v[80:83], v[144:147], a[108:111], v[80:83]
 ds_read_b128 v[136:139], v4 offset:13312
 v_mfma_f32_16x16x32_bf16 v[48:51], v[148:151], a[104:107], v[48:51]
 v_mfma_f32_16x16x32_bf16 v[84:87], v[148:151], a[108:111], v[84:87]
 ds_read_b128 v[140:143], v4 offset:14336
 s_waitcnt lgkmcnt(7)
 v_mfma_f32_16x16x32_bf16 v[52:55], v[104:107], a[104:107], v[52:55]
 v_mfma_f32_16x16x32_bf16 v[88:91], v[104:107], a[108:111], v[88:91]
 ds_read_b128 v[144:147], v4 offset:15360
 v_mfma_f32_16x16x32_bf16 v[56:59], v[108:111], a[104:107], v[56:59]
 v_mfma_f32_16x16x32_bf16 v[92:95], v[108:111], a[108:111], v[92:95]
 ds_read_b128 v[148:151], v4 offset:16384
 s_waitcnt vmcnt(21)
 v_mfma_f32_16x16x32_bf16 v[32:35], v[112:115], a[112:115], v[32:35]
 v_mfma_f32_16x16x32_bf16 v[68:71], v[112:115], a[116:119], v[68:71]
 ds_read_b128 v[104:107], v4 offset:17408
 s_waitcnt lgkmcnt(7)
 v_mfma_f32_16x16x32_bf16 v[36:39], v[116:119], a[112:115], v[36:39]
 v_mfma_f32_16x16x32_bf16 v[72:75], v[116:119], a[116:119], v[72:75]
 ds_read_b128 v[108:111], v4 offset:18432
 v_mfma_f32_16x16x32_bf16 v[40:43], v[120:123], a[112:115], v[40:43]
 v_mfma_f32_16x16x32_bf16 v[76:79], v[120:123], a[116:119], v[76:79]
 ds_read_b128 v[112:115], v4 offset:19456
 v_mfma_f32_16x16x32_bf16 v[44:47], v[124:127], a[112:115], v[44:47]
 v_mfma_f32_16x16x32_bf16 v[80:83], v[124:127], a[116:119], v[80:83]
 ds_read_b128 v[116:119], v4 offset:20480
 s_waitcnt lgkmcnt(7)
 v_mfma_f32_16x16x32_bf16 v[48:51], v[128:131], a[112:115], v[48:51]
 v_mfma_f32_16x16x32_bf16 v[84:87], v[128:131], a[116:119], v[84:87]
 s_barrier
 ds_read_b128 v[120:123], v2 offset:0
 v_mfma_f32_16x16x32_bf16 v[52:55], v[132:135], a[112:115], v[52:55]
 s_add_u32 s38, s79, 4096
 s_add_u32 m0, s83, 95232
 s_nop 0
 buffer_load_dwordx4 v1, s[4:7], s38 offen sc1 lds
 v_mfma_f32_16x16x32_bf16 v[88:91], v[132:135], a[116:119], v[88:91]
 ds_read_b128 v[124:127], v2 offset:1024
 v_mfma_f32_16x16x32_bf16 v[56:59], v[136:139], a[112:115], v[56:59]
 v_mfma_f32_16x16x32_bf16 v[92:95], v[136:139], a[116:119], v[92:95]
 ds_read_b128 v[128:131], v2 offset:2048
 s_waitcnt vmcnt(17) lgkmcnt(7)
 v_mfma_f32_16x16x32_bf16 v[32:35], v[140:143], a[120:123], v[32:35]
 s_add_u32 s38, s79, 151552
 s_add_u32 m0, s83, 96256
 s_nop 0
 buffer_load_dwordx4 v1, s[4:7], s38 offen sc1 lds
 v_mfma_f32_16x16x32_bf16 v[68:71], v[140:143], a[124:127], v[68:71]
 ds_read_b128 v[132:135], v2 offset:3072
 v_mfma_f32_16x16x32_bf16 v[36:39], v[144:147], a[120:123], v[36:39]
 s_add_u32 s38, s79, 299008
 s_add_u32 m0, s83, 97280
 s_nop 0
 buffer_load_dwordx4 v1, s[4:7], s38 offen sc1 lds
 v_mfma_f32_16x16x32_bf16 v[72:75], v[144:147], a[124:127], v[72:75]
 ds_read_b128 v[136:139], v2 offset:4096
 v_mfma_f32_16x16x32_bf16 v[40:43], v[148:151], a[120:123], v[40:43]
 v_mfma_f32_16x16x32_bf16 v[76:79], v[148:151], a[124:127], v[76:79]
 ds_read_b128 v[140:143], v2 offset:5120
 s_waitcnt lgkmcnt(7)
 v_mfma_f32_16x16x32_bf16 v[44:47], v[104:107], a[120:123], v[44:47]
 s_add_u32 s38, s79, 446464
 s_add_u32 m0, s83, 98304
 s_nop 0
 buffer_load_dwordx4 v1, s[4:7], s38 offen sc1 lds
 v_mfma_f32_16x16x32_bf16 v[80:83], v[104:107], a[124:127], v[80:83]
 ds_read_b128 v[144:147], v2 offset:6144
 v_mfma_f32_16x16x32_bf16 v[48:51], v[108:111], a[120:123], v[48:51]
 s_add_u32 s38, s79, 593920
 s_add_u32 m0, s83, 99328
 s_nop 0
 buffer_load_dwordx4 v1, s[4:7], s38 offen sc1 lds
 v_mfma_f32_16x16x32_bf16 v[84:87], v[108:111], a[124:127], v[84:87]
 ds_read_b128 v[148:151], v2 offset:7168
 v_mfma_f32_16x16x32_bf16 v[52:55], v[112:115], a[120:123], v[52:55]
 v_mfma_f32_16x16x32_bf16 v[88:91], v[112:115], a[124:127], v[88:91]
 ds_read_b128 v[104:107], v2 offset:8192
 s_waitcnt lgkmcnt(7)
 v_mfma_f32_16x16x32_bf16 v[56:59], v[116:119], a[120:123], v[56:59]
 s_add_u32 s38, s19, 741376
 s_add_u32 m0, s83, 100352
 s_nop 0
 buffer_load_dwordx4 v1, s[4:7], s38 offen sc1 lds
 v_mfma_f32_16x16x32_bf16 v[92:95], v[116:119], a[124:127], v[92:95]
 s_waitcnt vmcnt(8)
 v_cmp_eq_u32 vcc, 1, v13
 s_nop 0
 s_cmp_eq_u64 vcc, -1
 s_cbranch_scc1 K5L1_OK
 s_mov_b32 s39, 0x20000
K5L1:
 s_sleep 1
 buffer_load_dword v13, v14, s[4:7], s25 offen sc1
 s_waitcnt vmcnt(0)
 v_cmp_eq_u32 vcc, 1, v13
 s_nop 1
 s_cmp_eq_u64 vcc, -1
 s_cbranch_scc1 K5L1_OK
 s_sub_u32 s39, s39, 1
 s_cmp_lg_u32 s39, 0
 s_cbranch_scc1 K5L1
K5L1_OK:
 ds_read_b128 v[108:111], v2 offset:9216
 v_mfma_f32_16x16x32_bf16 v[32:35], v[120:123], a[128:131], v[32:35]
 s_add_u32 s30, s20, 0
 buffer_load_dwordx4 a[160:163], v1, s[4:7], s30 offen offset:3072 sc1
 v_mfma_f32_16x16x32_bf16 v[68:71], v[120:123], a[132:135], v[68:71]
 ds_read_b128 v[112:115], v2 offset:10240
 v_mfma_f32_16x16x32_bf16 v[36:39], v[124:127], a[128:131], v[36:39]
 v_mfma_f32_16x16x32_bf16 v[72:75], v[124:127], a[132:135], v[72:75]
 ds_read_b128 v[116:119], v2 offset:11264
 s_waitcnt lgkmcnt(7)
 v_mfma_f32_16x16x32_bf16 v[40:43], v[128:131], a[128:131], v[40:43]
 s_add_u32 s30, s12, 0
 buffer_load_dwordx4 a[164:167], v1, s[4:7], s30 offen offset:3072 sc1
 v_mfma_f32_16x16x32_bf16 v[76:79], v[128:131], a[132:135], v[76:79]
 ds_read_b128 v[120:123], v2 offset:12288
 v_mfma_f32_16x16x32_bf16 v[44:47], v[132:135], a[128:131], v[44:47]
 s_add_u32 s30, s20, 12288
 buffer_load_dwordx4 a[168:171], v1, s[4:7], s30 offen offset:0 sc1
 v_mfma_f32_16x16x32_bf16 v[80:83], v[132:135], a[132:135], v[80:83]
 ds_read_b128 v[124:127], v2 offset:13312
 v_mfma_f32_16x16x32_bf16 v[48:51], v[136:139], a[128:131], v[48:51]
 v_mfma_f32_16x16x32_bf16 v[84:87], v[136:139], a[132:135], v[84:87]
 ds_read_b128 v[128:131], v2 offset:14336
 s_waitcnt lgkmcnt(7)
 v_mfma_f32_16x16x32_bf16 v[52:55], v[140:143], a[128:131], v[52:55]
 s_add_u32 s30, s12, 12288
 buffer_load_dwordx4 a[172:175], v1, s[4:7], s30 offen offset:0 sc1
 v_mfma_f32_16x16x32_bf16 v[88:91], v[140:143], a[132:135], v[88:91]
 ds_read_b128 v[132:135], v2 offset:15360
 v_mfma_f32_16x16x32_bf16 v[56:59], v[144:147], a[128:131], v[56:59]
 s_add_u32 s38, s19, 888832
 s_add_u32 m0, s83, 101376
 s_nop 0
 buffer_load_dwordx4 v1, s[4:7], s38 offen sc1 lds
 v_mfma_f32_16x16x32_bf16 v[92:95], v[144:147], a[132:135], v[92:95]
 ds_read_b128 v[136:139], v2 offset:16384
 v_mfma_f32_16x16x32_bf16 v[32:35], v[148:151], a[136:139], v[32:35]
 v_mfma_f32_16x16x32_bf16 v[68:71], v[148:151], a[140:143], v[68:71]
 ds_read_b128 v[140:143], v2 offset:17408
 s_waitcnt lgkmcnt(7)
 v_mfma_f32_16x16x32_bf16 v[36:39], v[104:107], a[136:139], v[36:39]
 s_add_u32 s30, s20, 28672
 buffer_load_dwordx4 a[184:187], v1, s[4:7], s30 offen offset:2048 sc1
 v_mfma_f32_16x16x32_bf16 v[72:75], v[104:107], a[140:143], v[72:75]
 ds_read_b128 v[144:147], v2 offset:18432
 v_mfma_f32_16x16x32_bf16 v[40:43], v[108:111], a[136:139], v[40:43]
 s_add_u32 s30, s12, 28672
 buffer_load_dwordx4 a[188:191], v1, s[4:7], s30 offen offset:2048 sc1
 v_mfma_f32_16x16x32_bf16 v[76:79], v[108:111], a[140:143], v[76:79]
 ds_read_b128 v[148:151], v2 offset:19456
 v_mfma_f32_16x16x32_bf16 v[44:47], v[112:115], a[136:139], v[44:47]
 v_mfma_f32_16x16x32_bf16 v[80:83], v[112:115], a[140:143], v[80:83]
 ds_read_b128 v[104:107], v2 offset:20480
 s_waitcnt lgkmcnt(7)
 v_mfma_f32_16x16x32_bf16 v[48:51], v[116:119], a[136:139], v[48:51]
 s_add_u32 s30, s20, 20480
 buffer_load_dwordx4 a[176:179], v1, s[4:7], s30 offen offset:1024 sc1
 v_mfma_f32_16x16x32_bf16 v[84:87], v[116:119], a[140:143], v[84:87]
 ds_read_b128 v[108:111], v2 offset:21504
 v_mfma_f32_16x16x32_bf16 v[52:55], v[120:123], a[136:139], v[52:55]
 s_add_u32 s30, s12, 20480
 buffer_load_dwordx4 a[180:183], v1, s[4:7], s30 offen offset:1024 sc1
 v_mfma_f32_16x16x32_bf16 v[88:91], v[120:123], a[140:143], v[88:91]
 ds_read_b128 v[112:115], v2 offset:22528
 v_mfma_f32_16x16x32_bf16 v[56:59], v[124:127], a[136:139], v[56:59]
 v_mfma_f32_16x16x32_bf16 v[92:95], v[124:127], a[140:143], v[92:95]
 ds_read_b128 v[116:119], v2 offset:23552
 s_waitcnt lgkmcnt(7)
 v_mfma_f32_16x16x32_bf16 v[32:35], v[128:131], a[144:147], v[32:35]
 s_add_u32 s30, s20, 4096
 buffer_load_dwordx4 a[192:195], v1, s[4:7], s30 offen offset:3072 sc1
 v_mfma_f32_16x16x32_bf16 v[68:71], v[128:131], a[148:151], v[68:71]
 ds_read_b128 v[120:123], v2 offset:24576
 v_mfma_f32_16x16x32_bf16 v[36:39], v[132:135], a[144:147], v[36:39]
 v_mfma_f32_16x16x32_bf16 v[72:75], v[132:135], a[148:151], v[72:75]
 ds_read_b128 v[124:127], v2 offset:25600
 v_mfma_f32_16x16x32_bf16 v[40:43], v[136:139], a[144:147], v[40:43]
 s_add_u32 s30, s12, 4096
 buffer_load_dwordx4 a[196:199], v1, s[4:7], s30 offen offset:3072 sc1
 v_mfma_f32_16x16x32_bf16 v[76:79], v[136:139], a[148:151], v[76:79]
 ds_read_b128 v[128:131], v2 offset:26624
 s_waitcnt lgkmcnt(7)
 v_mfma_f32_16x16x32_bf16 v[44:47], v[140:143], a[144:147], v[44:47]
 v_mfma_f32_16x16x32_bf16 v[80:83], v[140:143], a[148:151], v[80:83]
 ds_read_b128 v[132:135], v2 offset:27648
 v_mfma_f32_16x16x32_bf16 v[48:51], v[144:147], a[144:147], v[48:51]
 v_mfma_f32_16x16x32_bf16 v[84:87], v[144:147], a[148:151], v[84:87]
 s_barrier
 ds_read_b128 v[136:139], v2 offset:37888
 v_mfma_f32_16x16x32_bf16 v[52:55], v[148:151], a[144:147], v[52:55]
 s_add_u32 s38, s79, 8192
 s_add_u32 m0, s83, 123904
 s_nop 0
 buffer_load_dwordx4 v1, s[4:7], s38 offen sc1 lds
 v_mfma_f32_16x16x32_bf16 v[88:91], v[148:151], a[148:151], v[88:91]
 ds_read_b128 v[140:143], v2 offset:38912
 s_waitcnt lgkmcnt(7)
 v_mfma_f32_16x16x32_bf16 v[56:59], v[104:107], a[144:147], v[56:59]
 v_mfma_f32_16x16x32_bf16 v[92:95], v[104:107], a[148:151], v[92:95]
 ds_read_b128 v[144:147], v2 offset:39936
 s_waitcnt vmcnt(18)
 v_mfma_f32_16x16x32_bf16 v[32:35], v[108:111], a[152:155], v[32:35]
 s_add_u32 s30, s20, 16384
 buffer_load_dwordx4 a[200:203], v1, s[4:7], s30 offen offset:0 sc1
 v_mfma_f32_16x16x32_bf16 v[68:71], v[108:111], a[156:159], v[68:71]
 ds_read_b128 v[148:151], v2 offset:40960
 v_mfma_f32_16x16x32_bf16 v[36:39], v[112:115], a[152:155], v[36:39]
 s_add_u32 s30, s12, 16384
 buffer_load_dwordx4 a[204:207], v1, s[4:7], s30 offen offset:0 sc1
 v_mfma_f32_16x16x32_bf16 v[72:75], v[112:115], a[156:159], v[72:75]
 ds_read_b128 v[104:107], v2 offset:41984
 s_waitcnt lgkmcnt(7)
 v_mfma_f32_16x16x32_bf16 v[40:43], v[116:119], a[152:155], v[40:43]
 v_mfma_f32_16x16x32_bf16 v[76:79], v[116:119], a[156:159], v[76:79]
 ds_read_b128 v[108:111], v2 offset:43008
 v_mfma_f32_16x16x32_bf16 v[44:47], v[120:123], a[152:155], v[44:47]
 s_add_u32 s38, s79, 155648
 s_add_u32 m0, s83, 124928
 s_nop 0
 buffer_load_dwordx4 v1, s[4:7], s38 offen sc1 lds
 v_mfma_f32_16x16x32_bf16 v[80:83], v[120:123], a[156:159], v[80:83]
 ds_read_b128 v[112:115], v2 offset:44032
 v_mfma_f32_16x16x32_bf16 v[48:51], v[124:127], a[152:155], v[48:51]
 s_add_u32 s38, s79, 303104
 s_add_u32 m0, s83, 125952
 s_nop 0
 buffer_load_dwordx4 v1, s[4:7], s38 offen sc1 lds
 v_mfma_f32_16x16x32_bf16 v[84:87], v[124:127], a[156:159], v[84:87]
 ds_read_b128 v[116:119], v2 offset:45056
 s_waitcnt lgkmcnt(7)
 v_mfma_f32_16x16x32_bf16 v[52:55], v[128:131], a[152:155], v[52:55]
 v_mfma_f32_16x16x32_bf16 v[88:91], v[128:131], a[156:159], v[88:91]
 ds_read_b128 v[120:123], v2 offset:46080
 v_mfma_f32_16x16x32_bf16 v[56:59], v[132:135], a[152:155], v[56:59]
 s_add_u32 s38, s79, 450560
 s_add_u32 m0, s83, 126976
 s_nop 0
 buffer_load_dwordx4 v1, s[4:7], s38 offen sc1 lds
 v_mfma_f32_16x16x32_bf16 v[92:95], v[132:135], a[156:159], v[92:95]
 ds_read_b128 v[124:127], v2 offset:47104
 s_waitcnt vmcnt(15)
 v_mfma_f32_16x16x32_bf16 v[32:35], v[136:139], a[160:163], v[32:35]
 s_add_u32 s30, s20, 24576
 buffer_load_dwordx4 a[208:211], v1, s[4:7], s30 offen offset:1024 sc1
 v_mfma_f32_16x16x32_bf16 v[68:71], v[136:139], a[164:167], v[68:71]
 ds_read_b128 v[128:131], v2 offset:48128
 s_waitcnt lgkmcnt(7)
 v_mfma_f32_16x16x32_bf16 v[36:39], v[140:143], a[160:163], v[36:39]
 v_mfma_f32_16x16x32_bf16 v[72:75], v[140:143], a[164:167], v[72:75]
 ds_read_b128 v[132:135], v2 offset:49152
 v_mfma_f32_16x16x32_bf16 v[40:43], v[144:147], a[160:163], v[40:43]
 s_add_u32 s30, s12, 24576
 buffer_load_dwordx4 a[212:215], v1, s[4:7], s30 offen offset:1024 sc1
 v_mfma_f32_16x16x32_bf16 v[76:79], v[144:147], a[164:167], v[76:79]
 ds_read_b128 v[136:139], v2 offset:50176
 v_mfma_f32_16x16x32_bf16 v[44:47], v[148:151], a[160:163], v[44:47]
 s_add_u32 s38, s79, 598016
 s_add_u32 m0, s83, 128000
 s_nop 0
 buffer_load_dwordx4 v1, s[4:7], s38 offen sc1 lds
 v_mfma_f32_16x16x32_bf16 v[80:83], v[148:151], a[164:167], v[80:83]
 ds_read_b128 v[140:143], v2 offset:51200
 s_waitcnt lgkmcnt(7)
 v_mfma_f32_16x16x32_bf16 v[48:51], v[104:107], a[160:163], v[48:51]
 v_mfma_f32_16x16x32_bf16 v[84:87], v[104:107], a[164:167], v[84:87]
 ds_read_b128 v[144:147], v2 offset:52224
 v_mfma_f32_16x16x32_bf16 v[52:55], v[108:111], a[160:163], v[52:55]
 s_add_u32 s38, s19, 745472
 s_add_u32 m0, s83, 129024
 s_nop 0
 buffer_load_dwordx4 v1, s[4:7], s38 offen sc1 lds
 v_mfma_f32_16x16x32_bf16 v[88:91], v[108:111], a[164:167], v[88:91]
 ds_read_b128 v[148:151], v2 offset:53248
 v_mfma_f32_16x16x32_bf16 v[56:59], v[112:115], a[160:163], v[56:59]
 s_add_u32 s38, s19, 892928
 s_add_u32 m0, s83, 130048
 s_nop 0
 buffer_load_dwordx4 v1, s[4:7], s38 offen sc1 lds
 v_mfma_f32_16x16x32_bf16 v[92:95], v[112:115], a[164:167], v[92:95]
 ds_read_b128 v[104:107], v2 offset:54272
 s_waitcnt vmcnt(18) lgkmcnt(7)
 v_mfma_f32_16x16x32_bf16 v[32:35], v[116:119], a[168:171], v[32:35]
 s_add_u32 s30, s20, 32768
 buffer_load_dwordx4 a[216:219], v1, s[4:7], s30 offen offset:2048 sc1
 v_mfma_f32_16x16x32_bf16 v[68:71], v[116:119], a[172:175], v[68:71]
 ds_read_b128 v[108:111], v2 offset:55296
 v_mfma_f32_16x16x32_bf16 v[36:39], v[120:123], a[168:171], v[36:39]
 v_mfma_f32_16x16x32_bf16 v[72:75], v[120:123], a[172:175], v[72:75]
 ds_read_b128 v[112:115], v2 offset:56320
 v_mfma_f32_16x16x32_bf16 v[40:43], v[124:127], a[168:171], v[40:43]
 s_add_u32 s30, s12, 32768
 buffer_load_dwordx4 a[220:223], v1, s[4:7], s30 offen offset:2048 sc1
 v_mfma_f32_16x16x32_bf16 v[76:79], v[124:127], a[172:175], v[76:79]
 ds_read_b128 v[116:119], v2 offset:57344
 s_waitcnt lgkmcnt(7)
 v_mfma_f32_16x16x32_bf16 v[44:47], v[128:131], a[168:171], v[44:47]
 v_mfma_f32_16x16x32_bf16 v[80:83], v[128:131], a[172:175], v[80:83]
 ds_read_b128 v[120:123], v2 offset:58368
 v_mfma_f32_16x16x32_bf16 v[48:51], v[132:135], a[168:171], v[48:51]
 v_mfma_f32_16x16x32_bf16 v[84:87], v[132:135], a[172:175], v[84:87]
 ds_read_b128 v[124:127], v2 offset:59392
 v_mfma_f32_16x16x32_bf16 v[52:55], v[136:139], a[168:171], v[52:55]
 v_mfma_f32_16x16x32_bf16 v[88:91], v[136:139], a[172:175], v[88:91]
 ds_read_b128 v[128:131], v2 offset:60416
 s_waitcnt lgkmcnt(7)
 v_mfma_f32_16x16x32_bf16 v[56:59], v[140:143], a[168:171], v[56:59]
 v_mfma_f32_16x16x32_bf16 v[92:95], v[140:143], a[172:175], v[92:95]
 ds_read_b128 v[132:135], v2 offset:61440
 s_waitcnt vmcnt(15)
 v_mfma_f32_16x16x32_bf16 v[32:35], v[144:147], a[176:179], v[32:35]
 s_add_u32 s30, s20, 4096
 buffer_load_dwordx4 a[224:227], v1, s[4:7], s30 offen offset:0 sc1
 v_mfma_f32_16x16x32_bf16 v[68:71], v[144:147], a[180:183], v[68:71]
 ds_read_b128 v[136:139], v2 offset:62464
 v_mfma_f32_16x16x32_bf16 v[36:39], v[148:151], a[176:179], v[36:39]
 v_mfma_f32_16x16x32_bf16 v[72:75], v[148:151], a[180:183], v[72:75]
 ds_read_b128 v[140:143], v2 offset:63488
 s_waitcnt lgkmcnt(7)
 v_mfma_f32_16x16x32_bf16 v[40:43], v[104:107], a[176:179], v[40:43]
 s_add_u32 s30, s12, 4096
 buffer_load_dwordx4 a[228:231], v1, s[4:7], s30 offen offset:0 sc1
 v_mfma_f32_16x16x32_bf16 v[76:79], v[104:107], a[180:183], v[76:79]
 ds_read_b128 v[144:147], v2 offset:64512
 v_mfma_f32_16x16x32_bf16 v[44:47], v[108:111], a[176:179], v[44:47]
 v_mfma_f32_16x16x32_bf16 v[80:83], v[108:111], a[180:183], v[80:83]
 ds_read_b128 v[148:151], v3 offset:0
 v_mfma_f32_16x16x32_bf16 v[48:51], v[112:115], a[176:179], v[48:51]
 v_mfma_f32_16x16x32_bf16 v[84:87], v[112:115], a[180:183], v[84:87]
 s_barrier
 ds_read_b128 v[104:107], v3 offset:1024
 s_waitcnt lgkmcnt(7)
 v_mfma_f32_16x16x32_bf16 v[52:55], v[116:119], a[176:179], v[52:55]
 s_add_u32 s38, s19, 1032192
 s_add_u32 m0, s14, 0
 s_nop 0
 buffer_load_dwordx4 v1, s[4:7], s38 offen sc1 lds
 v_mfma_f32_16x16x32_bf16 v[88:91], v[116:119], a[180:183], v[88:91]
 ds_read_b128 v[108:111], v3 offset:2048
 v_mfma_f32_16x16x32_bf16 v[56:59], v[120:123], a[176:179], v[56:59]
 v_mfma_f32_16x16x32_bf16 v[92:95], v[120:123], a[180:183], v[92:95]
 ds_read_b128 v[112:115], v3 offset:3072
 v_mfma_f32_16x16x32_bf16 v[32:35], v[124:127], a[184:187], v[32:35]
 s_add_u32 s30, s20, 12288
 buffer_load_dwordx4 a[232:235], v1, s[4:7], s30 offen offset:1024 sc1
 v_mfma_f32_16x16x32_bf16 v[68:71], v[124:127], a[188:191], v[68:71]
 ds_read_b128 v[116:119], v3 offset:4096
 s_waitcnt lgkmcnt(7)
 v_mfma_f32_16x16x32_bf16 v[36:39], v[128:131], a[184:187], v[36:39]
 s_add_u32 s30, s12, 12288
 buffer_load_dwordx4 a[236:239], v1, s[4:7], s30 offen offset:1024 sc1
 v_mfma_f32_16x16x32_bf16 v[72:75], v[128:131], a[188:191], v[72:75]
 ds_read_b128 v[120:123], v3 offset:5120
 v_mfma_f32_16x16x32_bf16 v[40:43], v[132:135], a[184:187], v[40:43]
 v_mfma_f32_16x16x32_bf16 v[76:79], v[132:135], a[188:191], v[76:79]
 ds_read_b128 v[124:127], v3 offset:6144
 v_mfma_f32_16x16x32_bf16 v[44:47], v[136:139], a[184:187], v[44:47]
 s_add_u32 s38, s19, 1179648
 s_add_u32 m0, s14, 1024
 s_nop 0
 buffer_load_dwordx4 v1, s[4:7], s38 offen sc1 lds
 v_mfma_f32_16x16x32_bf16 v[80:83], v[136:139], a[188:191], v[80:83]
 ds_read_b128 v[128:131], v3 offset:7168
 s_waitcnt lgkmcnt(7)
 v_mfma_f32_16x16x32_bf16 v[48:51], v[140:143], a[184:187], v[48:51]
 s_add_u32 s38, s19, 1033216
 s_add_u32 m0, s14, 8192
 s_nop 0
 buffer_load_dwordx4 v1, s[4:7], s38 offen sc1 lds
 v_mfma_f32_16x16x32_bf16 v[84:87], v[140:143], a[188:191], v[84:87]
 ds_read_b128 v[132:135], v3 offset:8192
 v_mfma_f32_16x16x32_bf16 v[52:55], v[144:147], a[184:187], v[52:55]
 v_mfma_f32_16x16x32_bf16 v[88:91], v[144:147], a[188:191], v[88:91]
 ds_read_b128 v[136:139], v3 offset:9216
 v_mfma_f32_16x16x32_bf16 v[56:59], v[148:151], a[184:187], v[56:59]
 s_add_u32 s38, s19, 1180672
 s_add_u32 m0, s14, 9216
 s_nop 0
 buffer_load_dwordx4 v1, s[4:7], s38 offen sc1 lds
 v_mfma_f32_16x16x32_bf16 v[92:95], v[148:151], a[188:191], v[92:95]
 ds_read_b128 v[140:143], v3 offset:10240
 s_waitcnt vmcnt(21) lgkmcnt(7)
 v_mfma_f32_16x16x32_bf16 v[32:35], v[104:107], a[192:195], v[32:35]
 s_add_u32 s30, s20, 20480
 buffer_load_dwordx4 a[240:243], v1, s[4:7], s30 offen offset:2048 sc1
 v_mfma_f32_16x16x32_bf16 v[68:71], v[104:107], a[196:199], v[68:71]
 ds_read_b128 v[144:147], v3 offset:11264
 v_mfma_f32_16x16x32_bf16 v[36:39], v[108:111], a[192:195], v[36:39]
 v_mfma_f32_16x16x32_bf16 v[72:75], v[108:111], a[196:199], v[72:75]
 ds_read_b128 v[148:151], v3 offset:12288
 v_mfma_f32_16x16x32_bf16 v[40:43], v[112:115], a[192:195], v[40:43]
 s_add_u32 s30, s12, 20480
 buffer_load_dwordx4 a[244:247], v1, s[4:7], s30 offen offset:2048 sc1
 v_mfma_f32_16x16x32_bf16 v[76:79], v[112:115], a[196:199], v[76:79]
 ds_read_b128 v[104:107], v3 offset:13312
 s_waitcnt lgkmcnt(7)
 v_mfma_f32_16x16x32_bf16 v[44:47], v[116:119], a[192:195], v[44:47]
 s_add_u32 s38, s19, 1034240
 s_add_u32 m0, s14, 16384
 s_nop 0
 buffer_load_dwordx4 v1, s[4:7], s38 offen sc1 lds
 v_mfma_f32_16x16x32_bf16 v[80:83], v[116:119], a[196:199], v[80:83]
 ds_read_b128 v[108:111], v3 offset:14336
 v_mfma_f32_16x16x32_bf16 v[48:51], v[120:123], a[192:195], v[48:51]
 v_mfma_f32_16x16x32_bf16 v[84:87], v[120:123], a[196:199], v[84:87]
 ds_read_b128 v[112:115], v3 offset:15360
 v_mfma_f32_16x16x32_bf16 v[52:55], v[124:127], a[192:195], v[52:55]
 s_add_u32 s38, s19, 1181696
 s_add_u32 m0, s14, 17408
 s_nop 0
 buffer_load_dwordx4 v1, s[4:7], s38 offen sc1 lds
 v_mfma_f32_16x16x32_bf16 v[88:91], v[124:127], a[196:199], v[88:91]
 ds_read_b128 v[116:119], v3 offset:16384
 s_waitcnt lgkmcnt(7)
 v_mfma_f32_16x16x32_bf16 v[56:59], v[128:131], a[192:195], v[56:59]
 v_mfma_f32_16x16x32_bf16 v[92:95], v[128:131], a[196:199], v[92:95]
 ds_read_b128 v[120:123], v3 offset:17408
 s_waitcnt vmcnt(22)
 v_mfma_f32_16x16x32_bf16 v[32:35], v[132:135], a[200:203], v[32:35]
 s_add_u32 s30, s20, 28672
 buffer_load_dwordx4 a[248:251], v1, s[4:7], s30 offen offset:3072 sc1
 v_mfma_f32_16x16x32_bf16 v[68:71], v[132:135], a[204:207], v[68:71]
 ds_read_b128 v[124:127], v3 offset:18432
 v_mfma_f32_16x16x32_bf16 v[36:39], v[136:139], a[200:203], v[36:39]
 v_mfma_f32_16x16x32_bf16 v[72:75], v[136:139], a[204:207], v[72:75]
 ds_read_b128 v[128:131], v3 offset:19456
 s_waitcnt lgkmcnt(7)
 v_mfma_f32_16x16x32_bf16 v[40:43], v[140:143], a[200:203], v[40:43]
 s_add_u32 s30, s12, 28672
 buffer_load_dwordx4 a[252:255], v1, s[4:7], s30 offen offset:3072 sc1
 v_mfma_f32_16x16x32_bf16 v[76:79], v[140:143], a[204:207], v[76:79]
 ds_read_b128 v[132:135], v3 offset:20480
 v_mfma_f32_16x16x32_bf16 v[44:47], v[144:147], a[200:203], v[44:47]
 v_mfma_f32_16x16x32_bf16 v[80:83], v[144:147], a[204:207], v[80:83]
 ds_read_b128 v[136:139], v3 offset:21504
 v_mfma_f32_16x16x32_bf16 v[48:51], v[148:151], a[200:203], v[48:51]
 v_mfma_f32_16x16x32_bf16 v[84:87], v[148:151], a[204:207], v[84:87]
 ds_read_b128 v[140:143], v3 offset:22528
 s_waitcnt lgkmcnt(7)
 v_mfma_f32_16x16x32_bf16 v[52:55], v[104:107], a[200:203], v[52:55]
 v_mfma_f32_16x16x32_bf16 v[88:91], v[104:107], a[204:207], v[88:91]
 ds_read_b128 v[144:147], v3 offset:23552
 v_mfma_f32_16x16x32_bf16 v[56:59], v[108:111], a[200:203], v[56:59]
 v_mfma_f32_16x16x32_bf16 v[92:95], v[108:111], a[204:207], v[92:95]
 ds_read_b128 v[148:151], v3 offset:24576
 s_waitcnt vmcnt(19)
 v_mfma_f32_16x16x32_bf16 v[32:35], v[112:115], a[208:211], v[32:35]
 s_add_u32 s30, s20, 8192
 buffer_load_dwordx4 v[168:171], v1, s[4:7], s30 offen offset:0 sc1
 v_mfma_f32_16x16x32_bf16 v[68:71], v[112:115], a[212:215], v[68:71]
 ds_read_b128 v[104:107], v3 offset:25600
 s_waitcnt lgkmcnt(7)
 v_mfma_f32_16x16x32_bf16 v[36:39], v[116:119], a[208:211], v[36:39]
 v_mfma_f32_16x16x32_bf16 v[72:75], v[116:119], a[212:215], v[72:75]
 ds_read_b128 v[108:111], v3 offset:26624
 v_mfma_f32_16x16x32_bf16 v[40:43], v[120:123], a[208:211], v[40:43]
 s_add_u32 s30, s12, 8192
 buffer_load_dwordx4 v[172:175], v1, s[4:7], s30 offen offset:0 sc1
 v_mfma_f32_16x16x32_bf16 v[76:79], v[120:123], a[212:215], v[76:79]
 ds_read_b128 v[112:115], v3 offset:27648
 v_mfma_f32_16x16x32_bf16 v[44:47], v[124:127], a[208:211], v[44:47]
 v_mfma_f32_16x16x32_bf16 v[80:83], v[124:127], a[212:215], v[80:83]
 ds_read_b128 v[116:119], v3 offset:28672
 s_waitcnt lgkmcnt(7)
 v_mfma_f32_16x16x32_bf16 v[48:51], v[128:131], a[208:211], v[48:51]
 v_mfma_f32_16x16x32_bf16 v[84:87], v[128:131], a[212:215], v[84:87]
 s_barrier
 ds_read_b128 v[120:123], v3 offset:29696
 v_mfma_f32_16x16x32_bf16 v[52:55], v[132:135], a[208:211], v[52:55]
 s_add_u32 s38, s19, 1037312
 s_add_u32 m0, s14, 37888
 s_nop 0
 buffer_load_dwordx4 v1, s[4:7], s38 offen sc1 lds
 v_mfma_f32_16x16x32_bf16 v[88:91], v[132:135], a[212:215], v[88:91]
 ds_read_b128 v[124:127], v3 offset:30720
 v_mfma_f32_16x16x32_bf16 v[56:59], v[136:139], a[208:211], v[56:59]
 v_mfma_f32_16x16x32_bf16 v[92:95], v[136:139], a[212:215], v[92:95]
 ds_read_b128 v[128:131], v3 offset:31744
 s_waitcnt vmcnt(17) lgkmcnt(7)
 v_mfma_f32_16x16x32_bf16 v[32:35], v[140:143], a[216:219], v[32:35]
 s_add_u32 s30, s20, 16384
 buffer_load_dwordx4 v[176:179], v1, s[4:7], s30 offen offset:1024 sc1
 v_mfma_f32_16x16x32_bf16 v[68:71], v[140:143], a[220:223], v[68:71]
 ds_read_b128 v[132:135], v3 offset:32768
 v_mfma_f32_16x16x32_bf16 v[36:39], v[144:147], a[216:219], v[36:39]
 s_add_u32 s30, s12, 16384
 buffer_load_dwordx4 v[180:183], v1, s[4:7], s30 offen offset:1024 sc1
 v_mfma_f32_16x16x32_bf16 v[72:75], v[144:147], a[220:223], v[72:75]
 ds_read_b128 v[136:139], v3 offset:33792
 v_mfma_f32_16x16x32_bf16 v[40:43], v[148:151], a[216:219], v[40:43]
 v_mfma_f32_16x16x32_bf16 v[76:79], v[148:151], a[220:223], v[76:79]
 ds_read_b128 v[140:143], v3 offset:34816
 s_waitcnt lgkmcnt(7)
 v_mfma_f32_16x16x32_bf16 v[44:47], v[104:107], a[216:219], v[44:47]
 s_add_u32 s38, s19, 1184768
 s_add_u32 m0, s14, 38912
 s_nop 0
 buffer_load_dwordx4 v1, s[4:7], s38 offen sc1 lds
 v_mfma_f32_16x16x32_bf16 v[80:83], v[104:107], a[220:223], v[80:83]
 ds_read_b128 v[144:147], v3 offset:35840
 v_mfma_f32_16x16x32_bf16 v[48:51], v[108:111], a[216:219], v[48:51]
 s_add_u32 s38, s19, 1038336
 s_add_u32 m0, s14, 46080
 s_nop 0
 buffer_load_dwordx4 v1, s[4:7], s38 offen sc1 lds
 v_mfma_f32_16x16x32_bf16 v[84:87], v[108:111], a[220:223], v[84:87]
 ds_read_b128 v[148:151], v3 offset:36864
 v_mfma_f32_16x16x32_bf16 v[52:55], v[112:115], a[216:219], v[52:55]
 v_mfma_f32_16x16x32_bf16 v[88:91], v[112:115], a[220:223], v[88:91]
 ds_read_b128 v[104:107], v3 offset:37888
 s_waitcnt lgkmcnt(7)
 v_mfma_f32_16x16x32_bf16 v[56:59], v[116:119], a[216:219], v[56:59]
 s_add_u32 s38, s19, 1185792
 s_add_u32 m0, s14, 47104
 s_nop 0
 buffer_load_dwordx4 v1, s[4:7], s38 offen sc1 lds
 v_mfma_f32_16x16x32_bf16 v[92:95], v[116:119], a[220:223], v[92:95]
 ds_read_b128 v[108:111], v3 offset:38912
 s_waitcnt vmcnt(20)
 v_mfma_f32_16x16x32_bf16 v[32:35], v[120:123], a[224:227], v[32:35]
 s_add_u32 s30, s20, 24576
 buffer_load_dwordx4 v[184:187], v1, s[4:7], s30 offen offset:2048 sc1
 v_mfma_f32_16x16x32_bf16 v[68:71], v[120:123], a[228:231], v[68:71]
 ds_read_b128 v[112:115], v3 offset:39936
 v_mfma_f32_16x16x32_bf16 v[36:39], v[124:127], a[224:227], v[36:39]
 v_mfma_f32_16x16x32_bf16 v[72:75], v[124:127], a[228:231], v[72:75]
 ds_read_b128 v[116:119], v3 offset:40960
 s_waitcnt lgkmcnt(7)
 v_mfma_f32_16x16x32_bf16 v[40:43], v[128:131], a[224:227], v[40:43]
 s_add_u32 s30, s12, 24576
 buffer_load_dwordx4 v[188:191], v1, s[4:7], s30 offen offset:2048 sc1
 v_mfma_f32_16x16x32_bf16 v[76:79], v[128:131], a[228:231], v[76:79]
 ds_read_b128 v[120:123], v3 offset:41984
 v_mfma_f32_16x16x32_bf16 v[44:47], v[132:135], a[224:227], v[44:47]
 s_add_u32 s38, s19, 1035264
 s_add_u32 m0, s14, 54272
 s_nop 0
 buffer_load_dwordx4 v1, s[4:7], s38 offen sc1 lds
 v_mfma_f32_16x16x32_bf16 v[80:83], v[132:135], a[228:231], v[80:83]
 ds_read_b128 v[124:127], v3 offset:43008
 v_mfma_f32_16x16x32_bf16 v[48:51], v[136:139], a[224:227], v[48:51]
 v_mfma_f32_16x16x32_bf16 v[84:87], v[136:139], a[228:231], v[84:87]
 ds_read_b128 v[128:131], v3 offset:44032
 s_waitcnt lgkmcnt(7)
 v_mfma_f32_16x16x32_bf16 v[52:55], v[140:143], a[224:227], v[52:55]
 s_add_u32 s38, s19, 1182720
 s_add_u32 m0, s14, 55296
 s_nop 0
 buffer_load_dwordx4 v1, s[4:7], s38 offen sc1 lds
 v_mfma_f32_16x16x32_bf16 v[88:91], v[140:143], a[228:231], v[88:91]
 ds_read_b128 v[132:135], v3 offset:45056
 v_mfma_f32_16x16x32_bf16 v[56:59], v[144:147], a[224:227], v[56:59]
 v_mfma_f32_16x16x32_bf16 v[92:95], v[144:147], a[228:231], v[92:95]
 ds_read_b128 v[136:139], v3 offset:46080
 s_waitcnt vmcnt(21)
 v_mfma_f32_16x16x32_bf16 v[32:35], v[148:151], a[232:235], v[32:35]
 s_add_u32 s30, s20, 32768
 buffer_load_dwordx4 v[192:195], v1, s[4:7], s30 offen offset:3072 sc1
 v_mfma_f32_16x16x32_bf16 v[68:71], v[148:151], a[236:239], v[68:71]
 ds_read_b128 v[140:143], v3 offset:47104
 s_waitcnt lgkmcnt(7)
 v_mfma_f32_16x16x32_bf16 v[36:39], v[104:107], a[232:235], v[36:39]
 v_mfma_f32_16x16x32_bf16 v[72:75], v[104:107], a[236:239], v[72:75]
 ds_read_b128 v[144:147], v3 offset:48128
 v_mfma_f32_16x16x32_bf16 v[40:43], v[108:111], a[232:235], v[40:43]
 s_add_u32 s30, s12, 32768
 buffer_load_dwordx4 v[196:199], v1, s[4:7], s30 offen offset:3072 sc1
 v_mfma_f32_16x16x32_bf16 v[76:79], v[108:111], a[236:239], v[76:79]
 ds_read_b128 v[148:151], v3 offset:49152
 v_mfma_f32_16x16x32_bf16 v[44:47], v[112:115], a[232:235], v[44:47]
 v_mfma_f32_16x16x32_bf16 v[80:83], v[112:115], a[236:239], v[80:83]
 ds_read_b128 v[104:107], v3 offset:50176
 s_waitcnt lgkmcnt(7)
 v_mfma_f32_16x16x32_bf16 v[48:51], v[116:119], a[232:235], v[48:51]
 v_mfma_f32_16x16x32_bf16 v[84:87], v[116:119], a[236:239], v[84:87]
 ds_read_b128 v[108:111], v3 offset:51200
 v_mfma_f32_16x16x32_bf16 v[52:55], v[120:123], a[232:235], v[52:55]
 v_mfma_f32_16x16x32_bf16 v[88:91], v[120:123], a[236:239], v[88:91]
 ds_read_b128 v[112:115], v3 offset:52224
 v_mfma_f32_16x16x32_bf16 v[56:59], v[124:127], a[232:235], v[56:59]
 v_mfma_f32_16x16x32_bf16 v[92:95], v[124:127], a[236:239], v[92:95]
 ds_read_b128 v[116:119], v3 offset:53248
 s_waitcnt vmcnt(18) lgkmcnt(7)
 v_mfma_f32_16x16x32_bf16 v[32:35], v[128:131], a[240:243], v[32:35]
 buffer_load_dwordx2 v[16:17], v11, s[4:7], s28 offen offset:0 sc1
 v_mfma_f32_16x16x32_bf16 v[68:71], v[128:131], a[244:247], v[68:71]
 ds_read_b128 v[120:123], v3 offset:54272
 v_mfma_f32_16x16x32_bf16 v[36:39], v[132:135], a[240:243], v[36:39]
 v_mfma_f32_16x16x32_bf16 v[72:75], v[132:135], a[244:247], v[72:75]
 ds_read_b128 v[124:127], v3 offset:55296
 v_mfma_f32_16x16x32_bf16 v[40:43], v[136:139], a[240:243], v[40:43]
 buffer_load_dwordx2 v[18:19], v11, s[4:7], s28 offen offset:1024 sc1
 v_mfma_f32_16x16x32_bf16 v[76:79], v[136:139], a[244:247], v[76:79]
 ds_read_b128 v[128:131], v3 offset:56320
 s_waitcnt lgkmcnt(7)
 v_mfma_f32_16x16x32_bf16 v[44:47], v[140:143], a[240:243], v[44:47]
 buffer_load_dwordx2 v[20:21], v11, s[4:7], s28 offen offset:2048 sc1
 v_mfma_f32_16x16x32_bf16 v[80:83], v[140:143], a[244:247], v[80:83]
 ds_read_b128 v[132:135], v3 offset:57344
 v_mfma_f32_16x16x32_bf16 v[48:51], v[144:147], a[240:243], v[48:51]
 v_mfma_f32_16x16x32_bf16 v[84:87], v[144:147], a[244:247], v[84:87]
 s_barrier
 ds_read_b128 v[136:139], v3 offset:58368
 v_mfma_f32_16x16x32_bf16 v[52:55], v[148:151], a[240:243], v[52:55]
 buffer_load_dwordx2 v[22:23], v11, s[4:7], s28 offen offset:3072 sc1
 v_mfma_f32_16x16x32_bf16 v[88:91], v[148:151], a[244:247], v[88:91]
 ds_read_b128 v[140:143], v3 offset:59392
 s_waitcnt lgkmcnt(7)
 v_mfma_f32_16x16x32_bf16 v[56:59], v[104:107], a[240:243], v[56:59]
 buffer_load_dwordx2 v[24:25], v11, s[4:7], s29 offen offset:0 sc1
 v_mfma_f32_16x16x32_bf16 v[92:95], v[104:107], a[244:247], v[92:95]
 ds_read_b128 v[144:147], v3 offset:60416
 s_waitcnt vmcnt(19)
 v_mfma_f32_16x16x32_bf16 v[32:35], v[108:111], a[248:251], v[32:35]
 v_mfma_f32_16x16x32_bf16 v[68:71], v[108:111], a[252:255], v[68:71]
 ds_read_b128 v[148:151], v3 offset:61440
 v_mfma_f32_16x16x32_bf16 v[36:39], v[112:115], a[248:251], v[36:39]
 s_add_u32 s38, s19, 1039360
 s_add_u32 m0, s14, 66560
 s_nop 0
 buffer_load_dwordx4 v1, s[4:7], s38 offen sc1 lds
 v_mfma_f32_16x16x32_bf16 v[72:75], v[112:115], a[252:255], v[72:75]
 ds_read_b128 v[104:107], v3 offset:62464
 s_waitcnt lgkmcnt(7)
 v_mfma_f32_16x16x32_bf16 v[40:43], v[116:119], a[248:251], v[40:43]
 s_add_u32 s38, s19, 1186816
 s_add_u32 m0, s14, 67584
 s_nop 0
 buffer_load_dwordx4 v1, s[4:7], s38 offen sc1 lds
 v_mfma_f32_16x16x32_bf16 v[76:79], v[116:119], a[252:255], v[76:79]
 ds_read_b128 v[108:111], v3 offset:63488
 v_mfma_f32_16x16x32_bf16 v[44:47], v[120:123], a[248:251], v[44:47]
 v_mfma_f32_16x16x32_bf16 v[80:83], v[120:123], a[252:255], v[80:83]
 ds_read_b128 v[112:115], v3 offset:64512
 v_mfma_f32_16x16x32_bf16 v[48:51], v[124:127], a[248:251], v[48:51]
 s_add_u32 s38, s19, 1036288
 s_add_u32 m0, s14, 74752
 s_nop 0
 buffer_load_dwordx4 v1, s[4:7], s38 offen sc1 lds
 v_mfma_f32_16x16x32_bf16 v[84:87], v[124:127], a[252:255], v[84:87]
 ds_read_b128 v[116:119], v4 offset:0
 s_waitcnt lgkmcnt(7)
 v_mfma_f32_16x16x32_bf16 v[52:55], v[128:131], a[248:251], v[52:55]
 s_add_u32 s38, s19, 1183744
 s_add_u32 m0, s14, 75776
 s_nop 0
 buffer_load_dwordx4 v1, s[4:7], s38 offen sc1 lds
 v_mfma_f32_16x16x32_bf16 v[88:91], v[128:131], a[252:255], v[88:91]
 ds_read_b128 v[120:123], v4 offset:1024
 v_mfma_f32_16x16x32_bf16 v[56:59], v[132:135], a[248:251], v[56:59]
 v_mfma_f32_16x16x32_bf16 v[92:95], v[132:135], a[252:255], v[92:95]
 ds_read_b128 v[124:127], v4 offset:2048
 s_waitcnt vmcnt(21)
 v_mfma_f32_16x16x32_bf16 v[32:35], v[136:139], v[168:171], v[32:35]
 s_add_u32 s38, s19, 1040384
 s_add_u32 m0, s14, 82944
 s_nop 0
 buffer_load_dwordx4 v1, s[4:7], s38 offen sc1 lds
 v_mfma_f32_16x16x32_bf16 v[68:71], v[136:139], v[172:175], v[68:71]
 ds_read_b128 v[128:131], v4 offset:3072
 s_waitcnt lgkmcnt(7)
 v_mfma_f32_16x16x32_bf16 v[36:39], v[140:143], v[168:171], v[36:39]
 s_add_u32 s38, s19, 1187840
 s_add_u32 m0, s14, 83968
 s_nop 0
 buffer_load_dwordx4 v1, s[4:7], s38 offen sc1 lds
 v_mfma_f32_16x16x32_bf16 v[72:75], v[140:143], v[172:175], v[72:75]
 ds_read_b128 v[132:135], v4 offset:4096
 v_mfma_f32_16x16x32_bf16 v[40:43], v[144:147], v[168:171], v[40:43]
 v_mfma_f32_16x16x32_bf16 v[76:79], v[144:147], v[172:175], v[76:79]
 ds_read_b128 v[136:139], v4 offset:5120
 v_mfma_f32_16x16x32_bf16 v[44:47], v[148:151], v[168:171], v[44:47]
 v_mfma_f32_16x16x32_bf16 v[80:83], v[148:151], v[172:175], v[80:83]
 ds_read_b128 v[140:143], v4 offset:6144
 s_waitcnt lgkmcnt(7)
 v_mfma_f32_16x16x32_bf16 v[48:51], v[104:107], v[168:171], v[48:51]
 v_mfma_f32_16x16x32_bf16 v[84:87], v[104:107], v[172:175], v[84:87]
 ds_read_b128 v[144:147], v4 offset:7168
 v_mfma_f32_16x16x32_bf16 v[52:55], v[108:111], v[168:171], v[52:55]
 v_mfma_f32_16x16x32_bf16 v[88:91], v[108:111], v[172:175], v[88:91]
 ds_read_b128 v[148:151], v4 offset:8192
 v_mfma_f32_16x16x32_bf16 v[56:59], v[112:115], v[168:171], v[56:59]
 v_mfma_f32_16x16x32_bf16 v[92:95], v[112:115], v[172:175], v[92:95]
 ds_read_b128 v[104:107], v4 offset:9216
 s_waitcnt vmcnt(20) lgkmcnt(7)
 v_mfma_f32_16x16x32_bf16 v[32:35], v[116:119], v[176:179], v[32:35]
 v_mfma_f32_16x16x32_bf16 v[68:71], v[116:119], v[180:183], v[68:71]
 ds_read_b128 v[108:111], v4 offset:10240
 v_mfma_f32_16x16x32_bf16 v[36:39], v[120:123], v[176:179], v[36:39]
 v_mfma_f32_16x16x32_bf16 v[72:75], v[120:123], v[180:183], v[72:75]
 ds_read_b128 v[112:115], v4 offset:11264
 v_mfma_f32_16x16x32_bf16 v[40:43], v[124:127], v[176:179], v[40:43]
 v_mfma_f32_16x16x32_bf16 v[76:79], v[124:127], v[180:183], v[76:79]
 ds_read_b128 v[116:119], v4 offset:12288
 s_waitcnt lgkmcnt(7)
 v_mfma_f32_16x16x32_bf16 v[44:47], v[128:131], v[176:179], v[44:47]
 v_mfma_f32_16x16x32_bf16 v[80:83], v[128:131], v[180:183], v[80:83]
 ds_read_b128 v[120:123], v4 offset:13312
 v_mfma_f32_16x16x32_bf16 v[48:51], v[132:135], v[176:179], v[48:51]
 v_mfma_f32_16x16x32_bf16 v[84:87], v[132:135], v[180:183], v[84:87]
 ds_read_b128 v[124:127], v4 offset:14336
 v_mfma_f32_16x16x32_bf16 v[52:55], v[136:139], v[176:179], v[52:55]
 v_mfma_f32_16x16x32_bf16 v[88:91], v[136:139], v[180:183], v[88:91]
 ds_read_b128 v[128:131], v4 offset:15360
 s_waitcnt lgkmcnt(7)
 v_mfma_f32_16x16x32_bf16 v[56:59], v[140:143], v[176:179], v[56:59]
 v_mfma_f32_16x16x32_bf16 v[92:95], v[140:143], v[180:183], v[92:95]
 ds_read_b128 v[132:135], v4 offset:16384
 s_waitcnt vmcnt(15)
 v_mfma_f32_16x16x32_bf16 v[32:35], v[144:147], v[184:187], v[32:35]
 v_mfma_f32_16x16x32_bf16 v[68:71], v[144:147], v[188:191], v[68:71]
 ds_read_b128 v[136:139], v4 offset:17408
 v_mfma_f32_16x16x32_bf16 v[36:39], v[148:151], v[184:187], v[36:39]
 v_mfma_f32_16x16x32_bf16 v[72:75], v[148:151], v[188:191], v[72:75]
 ds_read_b128 v[140:143], v4 offset:18432
 s_waitcnt lgkmcnt(7)
 v_mfma_f32_16x16x32_bf16 v[40:43], v[104:107], v[184:187], v[40:43]
 v_mfma_f32_16x16x32_bf16 v[76:79], v[104:107], v[188:191], v[76:79]
 ds_read_b128 v[144:147], v4 offset:19456
 v_mfma_f32_16x16x32_bf16 v[44:47], v[108:111], v[184:187], v[44:47]
 v_mfma_f32_16x16x32_bf16 v[80:83], v[108:111], v[188:191], v[80:83]
 ds_read_b128 v[148:151], v4 offset:20480
 v_mfma_f32_16x16x32_bf16 v[48:51], v[112:115], v[184:187], v[48:51]
 v_mfma_f32_16x16x32_bf16 v[84:87], v[112:115], v[188:191], v[84:87]
 s_barrier
 ds_read_b128 v[104:107], v2 offset:0
 s_waitcnt lgkmcnt(7)
 v_mfma_f32_16x16x32_bf16 v[52:55], v[116:119], v[184:187], v[52:55]
 v_mfma_f32_16x16x32_bf16 v[88:91], v[116:119], v[188:191], v[88:91]
 ds_read_b128 v[108:111], v2 offset:1024
 v_mfma_f32_16x16x32_bf16 v[56:59], v[120:123], v[184:187], v[56:59]
 v_mfma_f32_16x16x32_bf16 v[92:95], v[120:123], v[188:191], v[92:95]
 ds_read_b128 v[112:115], v2 offset:2048
 s_waitcnt vmcnt(11)
 v_mfma_f32_16x16x32_bf16 v[32:35], v[124:127], v[192:195], v[32:35]
 v_mfma_f32_16x16x32_bf16 v[68:71], v[124:127], v[196:199], v[68:71]
 ds_read_b128 v[116:119], v2 offset:3072
 s_waitcnt lgkmcnt(7)
 v_mfma_f32_16x16x32_bf16 v[36:39], v[128:131], v[192:195], v[36:39]
 v_mfma_f32_16x16x32_bf16 v[72:75], v[128:131], v[196:199], v[72:75]
 ds_read_b128 v[120:123], v2 offset:4096
 v_mfma_f32_16x16x32_bf16 v[40:43], v[132:135], v[192:195], v[40:43]
 v_mfma_f32_16x16x32_bf16 v[76:79], v[132:135], v[196:199], v[76:79]
 ds_read_b128 v[124:127], v2 offset:5120
 v_mfma_f32_16x16x32_bf16 v[44:47], v[136:139], v[192:195], v[44:47]
 v_mfma_f32_16x16x32_bf16 v[80:83], v[136:139], v[196:199], v[80:83]
 ds_read_b128 v[128:131], v2 offset:6144
 s_waitcnt lgkmcnt(7)
 v_mfma_f32_16x16x32_bf16 v[48:51], v[140:143], v[192:195], v[48:51]
 v_mfma_f32_16x16x32_bf16 v[84:87], v[140:143], v[196:199], v[84:87]
 ds_read_b128 v[132:135], v2 offset:7168
 v_mfma_f32_16x16x32_bf16 v[52:55], v[144:147], v[192:195], v[52:55]
 v_mfma_f32_16x16x32_bf16 v[88:91], v[144:147], v[196:199], v[88:91]
 ds_read_b128 v[136:139], v2 offset:8192
 v_mfma_f32_16x16x32_bf16 v[56:59], v[148:151], v[192:195], v[56:59]
 v_mfma_f32_16x16x32_bf16 v[92:95], v[148:151], v[196:199], v[92:95]
 ds_read_b128 v[140:143], v2 offset:9216
 s_waitcnt lgkmcnt(7)
 v_mfma_f32_16x16x32_bf16 v[60:63], v[104:107], a[0:3], 0
 v_mfma_f32_16x16x32_bf16 v[96:99], v[104:107], a[4:7], 0
 ds_read_b128 v[144:147], v2 offset:10240
 v_mfma_f32_16x16x32_bf16 v[64:67], v[108:111], a[0:3], 0
 v_mfma_f32_16x16x32_bf16 v[100:103], v[108:111], a[4:7], 0
 ds_read_b128 v[148:151], v2 offset:11264
 v_mfma_f32_16x16x32_bf16 v[60:63], v[112:115], a[8:11], v[60:63]
 v_mfma_f32_16x16x32_bf16 v[96:99], v[112:115], a[12:15], v[96:99]
 ds_read_b128 v[104:107], v2 offset:12288
 s_waitcnt lgkmcnt(7)
 v_mfma_f32_16x16x32_bf16 v[64:67], v[116:119], a[8:11], v[64:67]
 v_mfma_f32_16x16x32_bf16 v[100:103], v[116:119], a[12:15], v[100:103]
 ds_read_b128 v[108:111], v2 offset:13312
 v_mfma_f32_16x16x32_bf16 v[60:63], v[120:123], a[16:19], v[60:63]
 v_cvt_pk_bf16_f32 v32, v32, v33
 v_cvt_pk_bf16_f32 v33, v34, v35
 v_mfma_f32_16x16x32_bf16 v[96:99], v[120:123], a[20:23], v[96:99]
 ds_read_b128 v[112:115], v2 offset:14336
 v_mfma_f32_16x16x32_bf16 v[64:67], v[124:127], a[16:19], v[64:67]
 v_cvt_pk_bf16_f32 v34, v36, v37
 v_cvt_pk_bf16_f32 v35, v38, v39
 v_mfma_f32_16x16x32_bf16 v[100:103], v[124:127], a[20:23], v[100:103]
 ds_read_b128 v[116:119], v2 offset:15360
 s_waitcnt lgkmcnt(7)
 v_mfma_f32_16x16x32_bf16 v[60:63], v[128:131], a[24:27], v[60:63]
 buffer_store_dwordx4 v[32:35], v1, s[4:7], s16 offen offset:0 sc1
 v_mfma_f32_16x16x32_bf16 v[96:99], v[128:131], a[28:31], v[96:99]
 ds_read_b128 v[120:123], v2 offset:16384
 v_mfma_f32_16x16x32_bf16 v[64:67], v[132:135], a[24:27], v[64:67]
 v_cvt_pk_bf16_f32 v40, v40, v41
 v_cvt_pk_bf16_f32 v41, v42, v43
 v_mfma_f32_16x16x32_bf16 v[100:103], v[132:135], a[28:31], v[100:103]
 ds_read_b128 v[124:127], v2 offset:17408
 v_mfma_f32_16x16x32_bf16 v[60:63], v[136:139], a[32:35], v[60:63]
 v_cvt_pk_bf16_f32 v42, v44, v45
 v_cvt_pk_bf16_f32 v43, v46, v47
 v_mfma_f32_16x16x32_bf16 v[96:99], v[136:139], a[36:39], v[96:99]
 ds_read_b128 v[128:131], v2 offset:18432
 s_waitcnt lgkmcnt(7)
 v_mfma_f32_16x16x32_bf16 v[64:67], v[140:143], a[32:35], v[64:67]
 buffer_store_dwordx4 v[40:43], v1, s[4:7], s16 offen offset:1024 sc1
 v_mfma_f32_16x16x32_bf16 v[100:103], v[140:143], a[36:39], v[100:103]
 ds_read_b128 v[132:135], v2 offset:19456
 v_mfma_f32_16x16x32_bf16 v[60:63], v[144:147], a[40:43], v[60:63]
 v_cvt_pk_bf16_f32 v68, v68, v69
 v_cvt_pk_bf16_f32 v69, v70, v71
 v_mfma_f32_16x16x32_bf16 v[96:99], v[144:147], a[44:47], v[96:99]
 ds_read_b128 v[136:139], v2 offset:20480
 v_mfma_f32_16x16x32_bf16 v[64:67], v[148:151], a[40:43], v[64:67]
 v_cvt_pk_bf16_f32 v70, v72, v73
 v_cvt_pk_bf16_f32 v71, v74, v75
 v_mfma_f32_16x16x32_bf16 v[100:103], v[148:151], a[44:47], v[100:103]
 ds_read_b128 v[140:143], v2 offset:21504
 s_waitcnt lgkmcnt(7)
 v_mfma_f32_16x16x32_bf16 v[60:63], v[104:107], a[48:51], v[60:63]
 buffer_store_dwordx4 v[68:71], v1, s[4:7], s17 offen offset:0 sc1
 v_mfma_f32_16x16x32_bf16 v[96:99], v[104:107], a[52:55], v[96:99]
 ds_read_b128 v[144:147], v2 offset:22528
 v_mfma_f32_16x16x32_bf16 v[64:67], v[108:111], a[48:51], v[64:67]
 v_cvt_pk_bf16_f32 v76, v76, v77
 v_cvt_pk_bf16_f32 v77, v78, v79
 v_mfma_f32_16x16x32_bf16 v[100:103], v[108:111], a[52:55], v[100:103]
 ds_read_b128 v[148:151], v2 offset:23552
 v_mfma_f32_16x16x32_bf16 v[60:63], v[112:115], a[56:59], v[60:63]
 v_cvt_pk_bf16_f32 v78, v80, v81
 v_cvt_pk_bf16_f32 v79, v82, v83
 v_mfma_f32_16x16x32_bf16 v[96:99], v[112:115], a[60:63], v[96:99]
 s_barrier
 ds_read_b128 v[104:107], v2 offset:37888
 s_waitcnt lgkmcnt(7)
 v_mfma_f32_16x16x32_bf16 v[64:67], v[116:119], a[56:59], v[64:67]
 s_cmp_lg_u32 s40, 0
 s_cbranch_scc1 QSK9
 s_add_u32 s38, s77, 113664
 s_add_u32 m0, s78, 113664
 s_nop 0
 buffer_load_dwordx4 v1, s[4:7], s38 offen sc1 lds
 s_add_u32 s38, s77, 117760
 s_add_u32 m0, s78, 117760
 s_nop 0
 buffer_load_dwordx4 v1, s[4:7], s38 offen sc1 lds
 s_add_u32 s38, s77, 121856
 s_add_u32 m0, s78, 121856
 s_nop 0
 buffer_load_dwordx4 v1, s[4:7], s38 offen sc1 lds
QSK9:
 v_mfma_f32_16x16x32_bf16 v[100:103], v[116:119], a[60:63], v[100:103]
 ds_read_b128 v[108:111], v2 offset:38912
 v_mfma_f32_16x16x32_bf16 v[60:63], v[120:123], a[64:67], v[60:63]
 buffer_store_dwordx4 v[76:79], v1, s[4:7], s17 offen offset:1024 sc1
 v_mfma_f32_16x16x32_bf16 v[96:99], v[120:123], a[68:71], v[96:99]
 ds_read_b128 v[112:115], v2 offset:39936
 v_mfma_f32_16x16x32_bf16 v[64:67], v[124:127], a[64:67], v[64:67]
 v_cvt_pk_bf16_f32 v84, v84, v85
 v_cvt_pk_bf16_f32 v85, v86, v87
 v_mfma_f32_16x16x32_bf16 v[100:103], v[124:127], a[68:71], v[100:103]
 ds_read_b128 v[116:119], v2 offset:40960
 s_waitcnt lgkmcnt(7)
 v_mfma_f32_16x16x32_bf16 v[60:63], v[128:131], a[72:75], v[60:63]
 v_cvt_pk_bf16_f32 v86, v88, v89
 v_cvt_pk_bf16_f32 v87, v90, v91
 v_mfma_f32_16x16x32_bf16 v[96:99], v[128:131], a[76:79], v[96:99]
 ds_read_b128 v[120:123], v2 offset:41984
 v_mfma_f32_16x16x32_bf16 v[64:67], v[132:135], a[72:75], v[64:67]
 s_cmp_lg_u32 s40, 0
 s_cbranch_scc1 QSK10
 s_add_u32 s38, s77, 125952
 s_add_u32 m0, s78, 125952
 s_nop 0
 buffer_load_dwordx4 v1, s[4:7], s38 offen sc1 lds
 s_add_u32 s38, s77, 130048
 s_add_u32 m0, s78, 130048
 s_nop 0
 buffer_load_dwordx4 v1, s[4:7], s38 offen sc1 lds
 s_add_u32 s38, s77, 134144
 s_add_u32 m0, s78, 134144
 s_nop 0
 buffer_load_dwordx4 v1, s[4:7], s38 offen sc1 lds
QSK10:
 v_mfma_f32_16x16x32_bf16 v[100:103], v[132:135], a[76:79], v[100:103]
 ds_read_b128 v[124:127], v2 offset:43008
 v_mfma_f32_16x16x32_bf16 v[60:63], v[136:139], a[80:83], v[60:63]
 buffer_store_dwordx4 v[84:87], v1, s[4:7], s18 offen offset:0 sc1
 v_mfma_f32_16x16x32_bf16 v[96:99], v[136:139], a[84:87], v[96:99]
 ds_read_b128 v[128:131], v2 offset:44032
 s_waitcnt lgkmcnt(7)
 v_mfma_f32_16x16x32_bf16 v[64:67], v[140:143], a[80:83], v[64:67]
 v_cvt_pk_bf16_f32 v92, v92, v93
 v_cvt_pk_bf16_f32 v93, v94, v95
 v_mfma_f32_16x16x32_bf16 v[100:103], v[140:143], a[84:87], v[100:103]
 ds_read_b128 v[132:135], v2 offset:45056
 v_mfma_f32_16x16x32_bf16 v[60:63], v[144:147], a[88:91], v[60:63]
 buffer_store_dwordx2 v[92:93], v1, s[4:7], s18 offen offset:1024 sc1
 v_mfma_f32_16x16x32_bf16 v[96:99], v[144:147], a[92:95], v[96:99]
 ds_read_b128 v[136:139], v2 offset:46080
 v_mfma_f32_16x16x32_bf16 v[64:67], v[148:151], a[88:91], v[64:67]
 s_cmp_lg_u32 s40, 0
 s_cbranch_scc1 QSK11
 s_add_u32 s38, s77, 138240
 s_add_u32 m0, s78, 138240
 s_nop 0
 buffer_load_dwordx4 v1, s[4:7], s38 offen sc1 lds
 s_add_u32 s38, s77, 142336
 s_add_u32 m0, s78, 142336
 s_nop 0
 buffer_load_dwordx4 v1, s[4:7], s38 offen sc1 lds
 s_add_u32 s38, s77, 146432
 s_add_u32 m0, s78, 146432
 s_nop 0
 buffer_load_dwordx4 v1, s[4:7], s38 offen sc1 lds
QSK11:
 v_mfma_f32_16x16x32_bf16 v[100:103], v[148:151], a[92:95], v[100:103]
 ds_read_b128 v[140:143], v2 offset:47104
 s_waitcnt lgkmcnt(7)
 v_mfma_f32_16x16x32_bf16 v[60:63], v[104:107], a[96:99], v[60:63]
 v_mfma_f32_16x16x32_bf16 v[96:99], v[104:107], a[100:103], v[96:99]
 ds_read_b128 v[144:147], v2 offset:48128
 v_mfma_f32_16x16x32_bf16 v[64:67], v[108:111], a[96:99], v[64:67]
 v_mfma_f32_16x16x32_bf16 v[100:103], v[108:111], a[100:103], v[100:103]
 ds_read_b128 v[148:151], v2 offset:49152
 v_mfma_f32_16x16x32_bf16 v[60:63], v[112:115], a[104:107], v[60:63]
 v_mfma_f32_16x16x32_bf16 v[96:99], v[112:115], a[108:111], v[96:99]
 ds_read_b128 v[104:107], v2 offset:50176
 s_waitcnt lgkmcnt(7)
 v_mfma_f32_16x16x32_bf16 v[64:67], v[116:119], a[104:107], v[64:67]
 s_cmp_lg_u32 s40, 0
 s_cbranch_scc1 QSK12
 s_add_u32 s38, s76, 150528
 s_mov_b32 m0, 150528
 s_nop 0
 buffer_load_dwordx4 v1, s[4:7], s38 offen sc1 lds
QSK12:
 v_mfma_f32_16x16x32_bf16 v[100:103], v[116:119], a[108:111], v[100:103]
 ds_read_b128 v[108:111], v2 offset:51200
 v_mfma_f32_16x16x32_bf16 v[60:63], v[120:123], a[112:115], v[60:63]
 v_mfma_f32_16x16x32_bf16 v[96:99], v[120:123], a[116:119], v[96:99]
 ds_read_b128 v[112:115], v2 offset:52224
 v_mfma_f32_16x16x32_bf16 v[64:67], v[124:127], a[112:115], v[64:67]
 v_mfma_f32_16x16x32_bf16 v[100:103], v[124:127], a[116:119], v[100:103]
 ds_read_b128 v[116:119], v2 offset:53248
 s_waitcnt lgkmcnt(7)
 v_mfma_f32_16x16x32_bf16 v[60:63], v[128:131], a[120:123], v[60:63]
 v_mfma_f32_16x16x32_bf16 v[96:99], v[128:131], a[124:127], v[96:99]
 ds_read_b128 v[120:123], v2 offset:54272
 v_mfma_f32_16x16x32_bf16 v[64:67], v[132:135], a[120:123], v[64:67]
 v_mfma_f32_16x16x32_bf16 v[100:103], v[132:135], a[124:127], v[100:103]
 ds_read_b128 v[124:127], v2 offset:55296
 v_mfma_f32_16x16x32_bf16 v[60:63], v[136:139], a[128:131], v[60:63]
 v_mfma_f32_16x16x32_bf16 v[96:99], v[136:139], a[132:135], v[96:99]
 ds_read_b128 v[128:131], v2 offset:56320
 s_waitcnt lgkmcnt(7)
 v_mfma_f32_16x16x32_bf16 v[64:67], v[140:143], a[128:131], v[64:67]
 v_mfma_f32_16x16x32_bf16 v[100:103], v[140:143], a[132:135], v[100:103]
 ds_read_b128 v[132:135], v2 offset:57344
 v_mfma_f32_16x16x32_bf16 v[60:63], v[144:147], a[136:139], v[60:63]
 v_mfma_f32_16x16x32_bf16 v[96:99], v[144:147], a[140:143], v[96:99]
 ds_read_b128 v[136:139], v2 offset:58368
 v_mfma_f32_16x16x32_bf16 v[64:67], v[148:151], a[136:139], v[64:67]
 v_mfma_f32_16x16x32_bf16 v[100:103], v[148:151], a[140:143], v[100:103]
 ds_read_b128 v[140:143], v2 offset:59392
 s_waitcnt lgkmcnt(7)
 v_mfma_f32_16x16x32_bf16 v[60:63], v[104:107], a[144:147], v[60:63]
 v_mfma_f32_16x16x32_bf16 v[96:99], v[104:107], a[148:151], v[96:99]
 ds_read_b128 v[144:147], v2 offset:60416
 v_mfma_f32_16x16x32_bf16 v[64:67], v[108:111], a[144:147], v[64:67]
 v_mfma_f32_16x16x32_bf16 v[100:103], v[108:111], a[148:151], v[100:103]
 ds_read_b128 v[148:151], v2 offset:61440
 v_mfma_f32_16x16x32_bf16 v[60:63], v[112:115], a[152:155], v[60:63]
 v_mfma_f32_16x16x32_bf16 v[96:99], v[112:115], a[156:159], v[96:99]
 s_waitcnt vmcnt(6)
 s_barrier
 ds_read_b128 v[104:107], v3 offset:1024
 s_waitcnt lgkmcnt(7)
 v_mfma_f32_16x16x32_bf16 v[64:67], v[116:119], a[152:155], v[64:67]
 s_cmp_lg_u32 s40, 0
 s_cbranch_scc1 QSK13
 s_add_u32 s38, s77, 0
 s_add_u32 m0, s78, 0
 s_nop 0
 buffer_load_dwordx4 v1, s[4:7], s38 offen sc1 lds
 s_add_u32 s38, s77, 4096
 s_add_u32 m0, s78, 4096
 s_nop 0
 buffer_load_dwordx4 v1, s[4:7], s38 offen sc1 lds
 s_add_u32 s38, s77, 8192
 s_add_u32 m0, s78, 8192
 s_nop 0
 buffer_load_dwordx4 v1, s[4:7], s38 offen sc1 lds
QSK13:
 v_mfma_f32_16x16x32_bf16 v[100:103], v[116:119], a[156:159], v[100:103]
 ds_read_b128 v[108:111], v3 offset:2048
 v_mfma_f32_16x16x32_bf16 v[60:63], v[120:123], a[160:163], v[60:63]
 v_mfma_f32_16x16x32_bf16 v[96:99], v[120:123], a[164:167], v[96:99]
 ds_read_b128 v[112:115], v3 offset:3072
 v_mfma_f32_16x16x32_bf16 v[64:67], v[124:127], a[160:163], v[64:67]
 v_mfma_f32_16x16x32_bf16 v[100:103], v[124:127], a[164:167], v[100:103]
 ds_read_b128 v[116:119], v3 offset:4096
 s_waitcnt lgkmcnt(7)
 v_mfma_f32_16x16x32_bf16 v[60:63], v[128:131], a[168:171], v[60:63]
 v_mfma_f32_16x16x32_bf16 v[96:99], v[128:131], a[172:175], v[96:99]
 ds_read_b128 v[120:123], v3 offset:5120
 v_mfma_f32_16x16x32_bf16 v[64:67], v[132:135], a[168:171], v[64:67]
 s_cmp_lg_u32 s40, 0
 s_cbranch_scc1 QSK14
 s_add_u32 s38, s77, 12288
 s_add_u32 m0, s78, 12288
 s_nop 0
 buffer_load_dwordx4 v1, s[4:7], s38 offen sc1 lds
 s_add_u32 s38, s77, 16384
 s_add_u32 m0, s78, 16384
 s_nop 0
 buffer_load_dwordx4 v1, s[4:7], s38 offen sc1 lds
 s_add_u32 s38, s77, 20480
 s_add_u32 m0, s78, 20480
 s_nop 0
 buffer_load_dwordx4 v1, s[4:7], s38 offen sc1 lds
QSK14:
 v_mfma_f32_16x16x32_bf16 v[100:103], v[132:135], a[172:175], v[100:103]
 ds_read_b128 v[124:127], v3 offset:6144
 v_mfma_f32_16x16x32_bf16 v[60:63], v[136:139], a[176:179], v[60:63]
 v_mfma_f32_16x16x32_bf16 v[96:99], v[136:139], a[180:183], v[96:99]
 ds_read_b128 v[128:131], v3 offset:7168
 s_waitcnt lgkmcnt(7)
 v_mfma_f32_16x16x32_bf16 v[64:67], v[140:143], a[176:179], v[64:67]
 v_mfma_f32_16x16x32_bf16 v[100:103], v[140:143], a[180:183], v[100:103]
 ds_read_b128 v[132:135], v3 offset:8192
 v_mfma_f32_16x16x32_bf16 v[60:63], v[144:147], a[184:187], v[60:63]
 v_mfma_f32_16x16x32_bf16 v[96:99], v[144:147], a[188:191], v[96:99]
 ds_read_b128 v[136:139], v3 offset:9216
 v_mfma_f32_16x16x32_bf16 v[64:67], v[148:151], a[184:187], v[64:67]
 s_cmp_lg_u32 s40, 0
 s_cbranch_scc1 QSK15
 s_add_u32 s38, s77, 24576
 s_add_u32 m0, s78, 24576
 s_nop 0
 buffer_load_dwordx4 v1, s[4:7], s38 offen sc1 lds
 s_add_u32 s38, s77, 28672
 s_add_u32 m0, s78, 28672
 s_nop 0
 buffer_load_dwordx4 v1, s[4:7], s38 offen sc1 lds
 s_add_u32 s38, s77, 32768
 s_add_u32 m0, s78, 32768
 s_nop 0
 buffer_load_dwordx4 v1, s[4:7], s38 offen sc1 lds
QSK15:
 v_mfma_f32_16x16x32_bf16 v[100:103], v[148:151], a[188:191], v[100:103]
 ds_read_b128 v[140:143], v3 offset:10240
 s_waitcnt lgkmcnt(7)
 v_mfma_f32_16x16x32_bf16 v[60:63], v[104:107], a[192:195], v[60:63]
 v_mfma_f32_16x16x32_bf16 v[96:99], v[104:107], a[196:199], v[96:99]
 ds_read_b128 v[144:147], v3 offset:11264
 v_mfma_f32_16x16x32_bf16 v[64:67], v[108:111], a[192:195], v[64:67]
 v_mfma_f32_16x16x32_bf16 v[100:103], v[108:111], a[196:199], v[100:103]
 ds_read_b128 v[148:151], v3 offset:12288
 v_mfma_f32_16x16x32_bf16 v[60:63], v[112:115], a[200:203], v[60:63]
 v_mfma_f32_16x16x32_bf16 v[96:99], v[112:115], a[204:207], v[96:99]
 ds_read_b128 v[104:107], v3 offset:13312
 s_waitcnt lgkmcnt(7)
 v_mfma_f32_16x16x32_bf16 v[64:67], v[116:119], a[200:203], v[64:67]
 s_cmp_lg_u32 s40, 0
 s_cbranch_scc1 QSK16
 s_add_u32 s38, s76, 36864
 s_mov_b32 m0, 36864
 s_nop 0
 buffer_load_dwordx4 v1, s[4:7], s38 offen sc1 lds
QSK16:
 v_mfma_f32_16x16x32_bf16 v[100:103], v[116:119], a[204:207], v[100:103]
 ds_read_b128 v[108:111], v3 offset:14336
 v_mfma_f32_16x16x32_bf16 v[60:63], v[120:123], a[208:211], v[60:63]
 v_mfma_f32_16x16x32_bf16 v[96:99], v[120:123], a[212:215], v[96:99]
 ds_read_b128 v[112:115], v3 offset:15360
 v_mfma_f32_16x16x32_bf16 v[64:67], v[124:127], a[208:211], v[64:67]
 v_mfma_f32_16x16x32_bf16 v[100:103], v[124:127], a[212:215], v[100:103]
 ds_read_b128 v[116:119], v3 offset:16384
 s_waitcnt lgkmcnt(7)
 v_mfma_f32_16x16x32_bf16 v[60:63], v[128:131], a[216:219], v[60:63]
 v_mfma_f32_16x16x32_bf16 v[96:99], v[128:131], a[220:223], v[96:99]
 ds_read_b128 v[120:123], v3 offset:17408
 v_mfma_f32_16x16x32_bf16 v[64:67], v[132:135], a[216:219], v[64:67]
 v_mfma_f32_16x16x32_bf16 v[100:103], v[132:135], a[220:223], v[100:103]
 ds_read_b128 v[124:127], v3 offset:18432
 v_mfma_f32_16x16x32_bf16 v[60:63], v[136:139], a[224:227], v[60:63]
 v_mfma_f32_16x16x32_bf16 v[96:99], v[136:139], a[228:231], v[96:99]
 ds_read_b128 v[128:131], v3 offset:19456
 s_waitcnt lgkmcnt(7)
 v_mfma_f32_16x16x32_bf16 v[64:67], v[140:143], a[224:227], v[64:67]
 v_mfma_f32_16x16x32_bf16 v[100:103], v[140:143], a[228:231], v[100:103]
 ds_read_b128 v[132:135], v3 offset:20480
 v_mfma_f32_16x16x32_bf16 v[60:63], v[144:147], a[232:235], v[60:63]
 v_mfma_f32_16x16x32_bf16 v[96:99], v[144:147], a[236:239], v[96:99]
 ds_read_b128 v[136:139], v3 offset:21504
 v_mfma_f32_16x16x32_bf16 v[64:67], v[148:151], a[232:235], v[64:67]
 v_mfma_f32_16x16x32_bf16 v[100:103], v[148:151], a[236:239], v[100:103]
 ds_read_b128 v[140:143], v3 offset:22528
 s_waitcnt lgkmcnt(7)
 v_mfma_f32_16x16x32_bf16 v[60:63], v[104:107], a[240:243], v[60:63]
 v_mfma_f32_16x16x32_bf16 v[96:99], v[104:107], a[244:247], v[96:99]
 ds_read_b128 v[144:147], v3 offset:23552
 v_mfma_f32_16x16x32_bf16 v[64:67], v[108:111], a[240:243], v[64:67]
 v_mfma_f32_16x16x32_bf16 v[100:103], v[108:111], a[244:247], v[100:103]
 ds_read_b128 v[148:151], v3 offset:24576
 v_mfma_f32_16x16x32_bf16 v[60:63], v[112:115], a[248:251], v[60:63]
 v_mfma_f32_16x16x32_bf16 v[96:99], v[112:115], a[252:255], v[96:99]
 s_waitcnt lgkmcnt(6)
 v_mfma_f32_16x16x32_bf16 v[64:67], v[116:119], a[248:251], v[64:67]
 v_mfma_f32_16x16x32_bf16 v[100:103], v[116:119], a[252:255], v[100:103]
 v_mfma_f32_16x16x32_bf16 v[60:63], v[120:123], v[168:171], v[60:63]
 v_mfma_f32_16x16x32_bf16 v[96:99], v[120:123], v[172:175], v[96:99]
 v_mfma_f32_16x16x32_bf16 v[64:67], v[124:127], v[168:171], v[64:67]
 v_mfma_f32_16x16x32_bf16 v[100:103], v[124:127], v[172:175], v[100:103]
 s_waitcnt lgkmcnt(3)
 v_mfma_f32_16x16x32_bf16 v[60:63], v[128:131], v[176:179], v[60:63]
 v_mfma_f32_16x16x32_bf16 v[96:99], v[128:131], v[180:183], v[96:99]
 v_mfma_f32_16x16x32_bf16 v[64:67], v[132:135], v[176:179], v[64:67]
 v_mfma_f32_16x16x32_bf16 v[100:103], v[132:135], v[180:183], v[100:103]
 v_mfma_f32_16x16x32_bf16 v[60:63], v[136:139], v[184:187], v[60:63]
 v_mfma_f32_16x16x32_bf16 v[96:99], v[136:139], v[188:191], v[96:99]
 s_waitcnt lgkmcnt(0)
 v_mfma_f32_16x16x32_bf16 v[64:67], v[140:143], v[184:187], v[64:67]
 v_mfma_f32_16x16x32_bf16 v[100:103], v[140:143], v[188:191], v[100:103]
 v_mfma_f32_16x16x32_bf16 v[60:63], v[144:147], v[192:195], v[60:63]
 v_mfma_f32_16x16x32_bf16 v[96:99], v[144:147], v[196:199], v[96:99]
 v_mfma_f32_16x16x32_bf16 v[64:67], v[148:151], v[192:195], v[64:67]
 v_mfma_f32_16x16x32_bf16 v[100:103], v[148:151], v[196:199], v[100:103]
 s_nop 5
 v_cvt_pk_bf16_f32 v96, v96, v97
 v_cvt_pk_bf16_f32 v97, v98, v99
 v_cvt_pk_bf16_f32 v98, v100, v101
 v_cvt_pk_bf16_f32 v99, v102, v103
 buffer_store_dwordx4 v[96:99], v1, s[4:7], s18 offen offset:2048 sc1
 s_add_u32 s37, s21, 0
 buffer_load_dwordx4 v[200:203], v1, s[4:7], s37 offen offset:0 sc1
 buffer_load_dwordx2 v[204:205], v1, s[4:7], s37 offen offset:1024 sc1
 buffer_load_dwordx4 v[208:211], v1, s[4:7], s37 offen offset:2048 sc1
 s_add_u32 s37, s21, 12288
 buffer_load_dwordx4 v[212:215], v1, s[4:7], s37 offen offset:0 sc1
 buffer_load_dwordx2 v[216:217], v1, s[4:7], s37 offen offset:1024 sc1
 buffer_load_dwordx4 v[220:223], v1, s[4:7], s37 offen offset:2048 sc1
 s_add_u32 s37, s21, 24576
 buffer_load_dwordx4 v[224:227], v1, s[4:7], s37 offen offset:0 sc1
 buffer_load_dwordx2 v[228:229], v1, s[4:7], s37 offen offset:1024 sc1
 buffer_load_dwordx4 v[232:235], v1, s[4:7], s37 offen offset:2048 sc1
 s_barrier
 v_lshlrev_b32 v104, 16, v16
 v_and_b32 v105, 0xffff0000, v16
 v_lshlrev_b32 v106, 16, v17
 v_and_b32 v107, 0xffff0000, v17
 v_lshlrev_b32 v108, 16, v18
 v_and_b32 v109, 0xffff0000, v18
 v_lshlrev_b32 v110, 16, v19
 v_and_b32 v111, 0xffff0000, v19
 v_lshlrev_b32 v112, 16, v20
 v_and_b32 v113, 0xffff0000, v20
 v_lshlrev_b32 v114, 16, v21
 v_and_b32 v115, 0xffff0000, v21
 v_lshlrev_b32 v116, 16, v22
 v_and_b32 v117, 0xffff0000, v22
 v_lshlrev_b32 v118, 16, v23
 v_and_b32 v119, 0xffff0000, v23
 v_lshlrev_b32 v120, 16, v24
 v_and_b32 v121, 0xffff0000, v24
 v_lshlrev_b32 v122, 16, v25
 v_and_b32 v123, 0xffff0000, v25
 v_add_f32 v104, v104, v48
 v_add_f32 v105, v105, v49
 v_add_f32 v106, v106, v50
 v_add_f32 v107, v107, v51
 v_add_f32 v108, v108, v52
 v_add_f32 v109, v109, v53
 v_add_f32 v110, v110, v54
 v_add_f32 v111, v111, v55
 v_add_f32 v112, v112, v56
 v_add_f32 v113, v113, v57
 v_add_f32 v114, v114, v58
 v_add_f32 v115, v115, v59
 v_add_f32 v116, v116, v60
 v_add_f32 v117, v117, v61
 v_add_f32 v118, v118, v62
 v_add_f32 v119, v119, v63
 v_add_f32 v120, v120, v64
 v_add_f32 v121, v121, v65
 v_add_f32 v122, v122, v66
 v_add_f32 v123, v123, v67
 s_mov_b32 s39, 0x20000
 s_waitcnt vmcnt(3)
K5SA1:
 v_max3_u32 v30, v200, v201, v202
 v_max3_u32 v30, v30, v203, v204
 v_max3_u32 v30, v30, v205, v208
 v_max3_u32 v30, v30, v209, v210
 v_max3_u32 v30, v30, v211, v212
 v_max3_u32 v30, v30, v213, v214
 v_max3_u32 v30, v30, v215, v216
 v_max3_u32 v30, v30, v217, v220
 v_max3_u32 v30, v30, v221, v222
 v_max_u32 v30, v30, v223
 v_cmp_eq_u32 vcc, -1, v30
 s_nop 0
 s_cmp_eq_u64 vcc, 0
 s_cbranch_scc1 K5SA1_OK
 s_sleep 1
 s_add_u32 s37, s21, 0
 buffer_load_dwordx4 v[200:203], v1, s[4:7], s37 offen offset:0 sc1
 buffer_load_dwordx2 v[204:205], v1, s[4:7], s37 offen offset:1024 sc1
 buffer_load_dwordx4 v[208:211], v1, s[4:7], s37 offen offset:2048 sc1
 s_add_u32 s37, s21, 12288
 buffer_load_dwordx4 v[212:215], v1, s[4:7], s37 offen offset:0 sc1
 buffer_load_dwordx2 v[216:217], v1, s[4:7], s37 offen offset:1024 sc1
 buffer_load_dwordx4 v[220:223], v1, s[4:7], s37 offen offset:2048 sc1
 s_waitcnt vmcnt(0)
 s_sub_u32 s39, s39, 1
 s_cmp_lg_u32 s39, 0
 s_cbranch_scc1 K5SA1
K5SA1_OK:
 v_lshlrev_b32 v30, 16, v200
 v_and_b32 v31, 0xffff0000, v200
 v_add_f32 v104, v104, v30
 v_add_f32 v105, v105, v31
 v_lshlrev_b32 v30, 16, v201
 v_and_b32 v31, 0xffff0000, v201
 v_add_f32 v106, v106, v30
 v_add_f32 v107, v107, v31
 v_lshlrev_b32 v30, 16, v202
 v_and_b32 v31, 0xffff0000, v202
 v_add_f32 v108, v108, v30
 v_add_f32 v109, v109, v31
 v_lshlrev_b32 v30, 16, v203
 v_and_b32 v31, 0xffff0000, v203
 v_add_f32 v110, v110, v30
 v_add_f32 v111, v111, v31
 v_lshlrev_b32 v30, 16, v204
 v_and_b32 v31, 0xffff0000, v204
 v_add_f32 v112, v112, v30
 v_add_f32 v113, v113, v31
 v_lshlrev_b32 v30, 16, v205
 v_and_b32 v31, 0xffff0000, v205
 v_add_f32 v114, v114, v30
 v_add_f32 v115, v115, v31
 v_lshlrev_b32 v30, 16, v208
 v_and_b32 v31, 0xffff0000, v208
 v_add_f32 v116, v116, v30
 v_add_f32 v117, v117, v31
 v_lshlrev_b32 v30, 16, v209
 v_and_b32 v31, 0xffff0000, v209
 v_add_f32 v118, v118, v30
 v_add_f32 v119, v119, v31
 v_lshlrev_b32 v30, 16, v210
 v_and_b32 v31, 0xffff0000, v210
 v_add_f32 v120, v120, v30
 v_add_f32 v121, v121, v31
 v_lshlrev_b32 v30, 16, v211
 v_and_b32 v31, 0xffff0000, v211
 v_add_f32 v122, v122, v30
 v_add_f32 v123, v123, v31
 v_lshlrev_b32 v30, 16, v212
 v_and_b32 v31, 0xffff0000, v212
 v_add_f32 v104, v104, v30
 v_add_f32 v105, v105, v31
 v_lshlrev_b32 v30, 16, v213
 v_and_b32 v31, 0xffff0000, v213
 v_add_f32 v106, v106, v30
 v_add_f32 v107, v107, v31
 v_lshlrev_b32 v30, 16, v214
 v_and_b32 v31, 0xffff0000, v214
 v_add_f32 v108, v108, v30
 v_add_f32 v109, v109, v31
 v_lshlrev_b32 v30, 16, v215
 v_and_b32 v31, 0xffff0000, v215
 v_add_f32 v110, v110, v30
 v_add_f32 v111, v111, v31
 v_lshlrev_b32 v30, 16, v216
 v_and_b32 v31, 0xffff0000, v216
 v_add_f32 v112, v112, v30
 v_add_f32 v113, v113, v31
 v_lshlrev_b32 v30, 16, v217
 v_and_b32 v31, 0xffff0000, v217
 v_add_f32 v114, v114, v30
 v_add_f32 v115, v115, v31
 v_lshlrev_b32 v30, 16, v220
 v_and_b32 v31, 0xffff0000, v220
 v_add_f32 v116, v116, v30
 v_add_f32 v117, v117, v31
 v_lshlrev_b32 v30, 16, v221
 v_and_b32 v31, 0xffff0000, v221
 v_add_f32 v118, v118, v30
 v_add_f32 v119, v119, v31
 v_lshlrev_b32 v30, 16, v222
 v_and_b32 v31, 0xffff0000, v222
 v_add_f32 v120, v120, v30
 v_add_f32 v121, v121, v31
 v_lshlrev_b32 v30, 16, v223
 v_and_b32 v31, 0xffff0000, v223
 v_add_f32 v122, v122, v30
 v_add_f32 v123, v123, v31
 s_mov_b32 s39, 0x20000
 s_waitcnt vmcnt(0)
K5SB1:
 v_max3_u32 v30, v224, v225, v226
 v_max3_u32 v30, v30, v227, v228
 v_max3_u32 v30, v30, v229, v232
 v_max3_u32 v30, v30, v233, v234
 v_max_u32 v30, v30, v235
 v_cmp_eq_u32 vcc, -1, v30
 s_nop 0
 s_cmp_eq_u64 vcc, 0
 s_cbranch_scc1 K5SB1_OK
 s_sleep 1
 s_add_u32 s37, s21, 24576
 buffer_load_dwordx4 v[224:227], v1, s[4:7], s37 offen offset:0 sc1
 buffer_load_dwordx2 v[228:229], v1, s[4:7], s37 offen offset:1024 sc1
 buffer_load_dwordx4 v[232:235], v1, s[4:7], s37 offen offset:2048 sc1
 s_waitcnt vmcnt(0)
 s_sub_u32 s39, s39, 1
 s_cmp_lg_u32 s39, 0
 s_cbranch_scc1 K5SB1
K5SB1_OK:
 v_lshlrev_b32 v30, 16, v224
 v_and_b32 v31, 0xffff0000, v224
 v_add_f32 v104, v104, v30
 v_add_f32 v105, v105, v31
 v_lshlrev_b32 v30, 16, v225
 v_and_b32 v31, 0xffff0000, v225
 v_add_f32 v106, v106, v30
 v_add_f32 v107, v107, v31
 v_lshlrev_b32 v30, 16, v226
 v_and_b32 v31, 0xffff0000, v226
 v_add_f32 v108, v108, v30
 v_add_f32 v109, v109, v31
 v_lshlrev_b32 v30, 16, v227
 v_and_b32 v31, 0xffff0000, v227
 v_add_f32 v110, v110, v30
 v_add_f32 v111, v111, v31
 v_lshlrev_b32 v30, 16, v228
 v_and_b32 v31, 0xffff0000, v228
 v_add_f32 v112, v112, v30
 v_add_f32 v113, v113, v31
 v_lshlrev_b32 v30, 16, v229
 v_and_b32 v31, 0xffff0000, v229
 v_add_f32 v114, v114, v30
 v_add_f32 v115, v115, v31
 v_lshlrev_b32 v30, 16, v232
 v_and_b32 v31, 0xffff0000, v232
 v_add_f32 v116, v116, v30
 v_add_f32 v117, v117, v31
 v_lshlrev_b32 v30, 16, v233
 v_and_b32 v31, 0xffff0000, v233
 v_add_f32 v118, v118, v30
 v_add_f32 v119, v119, v31
 v_lshlrev_b32 v30, 16, v234
 v_and_b32 v31, 0xffff0000, v234
 v_add_f32 v120, v120, v30
 v_add_f32 v121, v121, v31
 v_lshlrev_b32 v30, 16, v235
 v_and_b32 v31, 0xffff0000, v235
 v_add_f32 v122, v122, v30
 v_add_f32 v123, v123, v31
 v_cvt_pk_bf16_f32 v16, v104, v105
 v_cvt_pk_bf16_f32 v17, v106, v107
 v_cvt_pk_bf16_f32 v18, v108, v109
 v_cvt_pk_bf16_f32 v19, v110, v111
 v_cvt_pk_bf16_f32 v20, v112, v113
 v_cvt_pk_bf16_f32 v21, v114, v115
 v_cvt_pk_bf16_f32 v22, v116, v117
 v_cvt_pk_bf16_f32 v23, v118, v119
 v_cvt_pk_bf16_f32 v24, v120, v121
 v_cvt_pk_bf16_f32 v25, v122, v123
 s_cmp_lg_u32 s40, 0
 s_cbranch_scc1 K51_FINAL
 v_bfe_u32 v28, v0, 4, 1
 v_lshlrev_b32 v28, 10, v28
 v_bfe_u32 v30, v0, 5, 1
 v_lshlrev_b32 v30, 9, v30
 v_and_b32 v31, 15, v0
 v_lshlrev_b32 v31, 4, v31
 v_add3_u32 v30, v28, v30, v31
 v_permlane16_swap_b32 v16, v18
 v_permlane16_swap_b32 v17, v19
 v_permlane16_swap_b32 v20, v22
 v_permlane16_swap_b32 v21, v23
 buffer_store_dwordx4 v[16:19], v30, s[4:7], s22 offen offset:0 sc1
 buffer_store_dwordx4 v[20:23], v30, s[4:7], s22 offen offset:2048 sc1
 buffer_store_dwordx2 v[24:25], v11, s[4:7], s23 offen sc1
 v_lshlrev_b32 v104, 16, v16
 v_and_b32 v105, 0xffff0000, v16
 v_lshlrev_b32 v106, 16, v17
 v_and_b32 v107, 0xffff0000, v17
 v_lshlrev_b32 v108, 16, v18
 v_and_b32 v109, 0xffff0000, v18
 v_lshlrev_b32 v110, 16, v19
 v_and_b32 v111, 0xffff0000, v19
 v_lshlrev_b32 v112, 16, v20
 v_and_b32 v113, 0xffff0000, v20
 v_lshlrev_b32 v114, 16, v21
 v_and_b32 v115, 0xffff0000, v21
 v_lshlrev_b32 v116, 16, v22
 v_and_b32 v117, 0xffff0000, v22
 v_lshlrev_b32 v118, 16, v23
 v_and_b32 v119, 0xffff0000, v23
 v_lshlrev_b32 v120, 16, v24
 v_and_b32 v121, 0xffff0000, v24
 v_lshlrev_b32 v122, 16, v25
 v_and_b32 v123, 0xffff0000, v25
 v_add_f32 v26, v104, v105
 v_add_f32 v27, v106, v107
 v_add_f32 v26, v26, v108
 v_add_f32 v27, v27, v109
 v_add_f32 v26, v26, v110
 v_add_f32 v27, v27, v111
 v_add_f32 v26, v26, v112
 v_add_f32 v27, v27, v113
 v_add_f32 v26, v26, v114
 v_add_f32 v27, v27, v115
 v_add_f32 v26, v26, v116
 v_add_f32 v27, v27, v117
 v_add_f32 v26, v26, v118
 v_add_f32 v27, v27, v119
 v_add_f32 v26, v26, v120
 v_add_f32 v27, v27, v121
 v_add_f32 v26, v26, v122
 v_add_f32 v27, v27, v123
 v_add_f32 v26, v26, v27
 v_mov_b32 v28, v26
 s_nop 1
 v_permlane16_swap_b32 v26, v28
 v_add_f32 v26, v26, v28
 v_mov_b32 v28, v26
 s_nop 1
 v_permlane32_swap_b32 v26, v28
 v_add_f32 v26, v26, v28
 v_mul_f32 v26, 0x3c4ccccd, v26
 v_mov_b32 v27, 0
 v_sub_f32 v104, v104, v26
 v_fmac_f32 v27, v104, v104
 v_sub_f32 v105, v105, v26
 v_fmac_f32 v27, v105, v105
 v_sub_f32 v106, v106, v26
 v_fmac_f32 v27, v106, v106
 v_sub_f32 v107, v107, v26
 v_fmac_f32 v27, v107, v107
 v_sub_f32 v108, v108, v26
 v_fmac_f32 v27, v108, v108
 v_sub_f32 v109, v109, v26
 v_fmac_f32 v27, v109, v109
 v_sub_f32 v110, v110, v26
 v_fmac_f32 v27, v110, v110
 v_sub_f32 v111, v111, v26
 v_fmac_f32 v27, v111, v111
 v_sub_f32 v112, v112, v26
 v_fmac_f32 v27, v112, v112
 v_sub_f32 v113, v113, v26
 v_fmac_f32 v27, v113, v113
 v_sub_f32 v114, v114, v26
 v_fmac_f32 v27, v114, v114
 v_sub_f32 v115, v115, v26
 v_fmac_f32 v27, v115, v115
 v_sub_f32 v116, v116, v26
 v_fmac_f32 v27, v116, v116
 v_sub_f32 v117, v117, v26
 v_fmac_f32 v27, v117, v117
 v_sub_f32 v118, v118, v26
 v_fmac_f32 v27, v118, v118
 v_sub_f32 v119, v119, v26
 v_fmac_f32 v27, v119, v119
 v_sub_f32 v120, v120, v26
 v_fmac_f32 v27, v120, v120
 v_sub_f32 v121, v121, v26
 v_fmac_f32 v27, v121, v121
 v_sub_f32 v122, v122, v26
 v_fmac_f32 v27, v122, v122
 v_sub_f32 v123, v123, v26
 v_fmac_f32 v27, v123, v123
 v_mov_b32 v28, v27
 s_nop 1
 v_permlane16_swap_b32 v27, v28
 v_add_f32 v27, v27, v28
 v_mov_b32 v28, v27
 s_nop 1
 v_permlane32_swap_b32 v27, v28
 v_add_f32 v27, v27, v28
 buffer_store_dwordx2 v[26:27], v15, s[4:7], s36 offen sc1
 s_branch K5_DONE
K51_FINAL:
 v_bfe_u32 v28, v0, 4, 1
 v_lshlrev_b32 v28, 5, v28
 v_bfe_u32 v30, v0, 5, 1
 v_lshlrev_b32 v30, 4, v30
 v_and_b32 v31, 15, v0
 v_mul_u32_u24 v31, 1152, v31
 v_add3_u32 v28, v28, v30, v31
 v_permlane16_swap_b32 v16, v18
 v_permlane16_swap_b32 v17, v19
 v_permlane16_swap_b32 v20, v22
 v_permlane16_swap_b32 v21, v23
 buffer_store_dwordx4 v[16:19], v28, s[8:11], s31 offen offset:0
 buffer_store_dwordx4 v[20:23], v28, s[8:11], s31 offen offset:64
 buffer_store_dwordx2 v[24:25], v29, s[8:11], s31 offen offset:128
 s_endpgm
K5_DONE:
 s_lshl_b32 s24, s80, 2
 s_add_u32 s24, s24, s81
 s_lshl_b32 s24, s24, 2
 s_add_u32 s24, s24, s82
 s_lshl_b32 s24, s24, 2
 s_add_u32 s24, s24, s41
 s_add_u32 s24, s24, 2048
 s_add_u32 s38, s77, 37888
 s_add_u32 m0, s78, 37888
 s_nop 0
 buffer_load_dwordx4 v1, s[4:7], s38 offen sc1 lds
 s_add_u32 s38, s77, 41984
 s_add_u32 m0, s78, 41984
 s_nop 0
 buffer_load_dwordx4 v1, s[4:7], s38 offen sc1 lds
 s_add_u32 s38, s77, 46080
 s_add_u32 m0, s78, 46080
 s_nop 0
 buffer_load_dwordx4 v1, s[4:7], s38 offen sc1 lds
 s_add_u32 s38, s77, 50176
 s_add_u32 m0, s78, 50176
 s_nop 0
 buffer_load_dwordx4 v1, s[4:7], s38 offen sc1 lds
 s_add_u32 s38, s77, 54272
 s_add_u32 m0, s78, 54272
 s_nop 0
 buffer_load_dwordx4 v1, s[4:7], s38 offen sc1 lds
 s_add_u32 s38, s77, 58368
 s_add_u32 m0, s78, 58368
 s_nop 0
 buffer_load_dwordx4 v1, s[4:7], s38 offen sc1 lds
 s_waitcnt vmcnt(6)
 s_barrier
 s_cmp_lg_u32 s3, 0
 s_cbranch_scc1 SIG6
 s_mov_b64 exec, 1
 v_mov_b32 v30, 0
 v_mov_b32 v31, 1
 s_lshl_b32 s38, s24, 5
 s_add_u32 s38, s38, 9961472
 buffer_store_dword v31, v30, s[4:7], s38 offen sc1
 s_mov_b64 exec, -1
SIG6:
 s_mov_b32 s101, s41
 s_mov_b32 s40, 1
 s_mov_b32 s41, 8192
 s_mov_b32 s42, 4718592
 s_mov_b32 s43, 9699328
 s_mov_b32 s100, 7217152
 s_add_u32 s38, s77, 62464
 s_add_u32 m0, s78, 62464
 s_nop 0
 buffer_load_dwordx4 v1, s[4:7], s38 offen sc1 lds
 s_add_u32 s38, s77, 66560
 s_add_u32 m0, s78, 66560
 s_nop 0
 buffer_load_dwordx4 v1, s[4:7], s38 offen sc1 lds
 s_add_u32 s38, s77, 70656
 s_add_u32 m0, s78, 70656
 s_nop 0
 buffer_load_dwordx4 v1, s[4:7], s38 offen sc1 lds
 s_add_u32 s38, s76, 74752
 s_mov_b32 m0, 74752
 s_nop 0
 buffer_load_dwordx4 v1, s[4:7], s38 offen sc1 lds
 s_add_u32 s38, s77, 75776
 s_add_u32 m0, s78, 75776
 s_nop 0
 buffer_load_dwordx4 v1, s[4:7], s38 offen sc1 lds
 s_add_u32 s38, s77, 79872
 s_add_u32 m0, s78, 79872
 s_nop 0
 buffer_load_dwordx4 v1, s[4:7], s38 offen sc1 lds
 s_add_u32 s38, s77, 83968
 s_add_u32 m0, s78, 83968
 s_nop 0
 buffer_load_dwordx4 v1, s[4:7], s38 offen sc1 lds
 s_add_u32 s38, s77, 88064
 s_add_u32 m0, s78, 88064
 s_nop 0
 buffer_load_dwordx4 v1, s[4:7], s38 offen sc1 lds
 s_add_u32 s38, s77, 92160
 s_add_u32 m0, s78, 92160
 s_nop 0
 buffer_load_dwordx4 v1, s[4:7], s38 offen sc1 lds
 s_add_u32 s38, s77, 96256
 s_add_u32 m0, s78, 96256
 s_nop 0
 buffer_load_dwordx4 v1, s[4:7], s38 offen sc1 lds
 s_add_u32 s38, s77, 100352
 s_add_u32 m0, s78, 100352
 s_nop 0
 buffer_load_dwordx4 v1, s[4:7], s38 offen sc1 lds
 s_add_u32 s38, s77, 104448
 s_add_u32 m0, s78, 104448
 s_nop 0
 buffer_load_dwordx4 v1, s[4:7], s38 offen sc1 lds
 s_add_u32 s38, s77, 108544
 s_add_u32 m0, s78, 108544
 s_nop 0
 buffer_load_dwordx4 v1, s[4:7], s38 offen sc1 lds
 s_add_u32 s38, s76, 112640
 s_mov_b32 m0, 112640
 s_nop 0
 buffer_load_dwordx4 v1, s[4:7], s38 offen sc1 lds
 s_lshr_b32 s29, s2, 3
 s_lshl_b32 s29, s29, 2
 s_add_u32 s29, s29, s3
 s_getpc_b64 s[12:13]
PF2:
 s_sub_u32 s12, s12, PF2-ATB_BEGIN
 s_subb_u32 s13, s13, 0
 s_and_b32 s13, s13, 0xffff
 s_mov_b32 s14, ATB_END-ATB_BEGIN
 s_mov_b32 s15, 0x00020000
 s_lshl_b32 s29, s29, 10
 buffer_load_dwordx4 v[248:251], v1, s[12:15], s29 offen
 v_mov_b32 v2, v1
 v_add_u32 v3, 0x10000, v1
 v_add_u32 v4, 0x20000, v1
 s_lshl_b32 s26, s86, 2
 s_add_u32 s26, s26, s3
 s_mov_b32 s27, s87
 s_mul_i32 s23, s26, 36864
 s_add_u32 s23, s23, s42
 s_add_u32 s23, s23, 0
 s_lshl_b32 s29, s26, 11
 s_add_u32 s29, s29, s43
 s_add_u32 s29, s29, 0
 s_lshr_b32 s31, s26, 3
 s_mul_i32 s31, s31, 18944
 s_add_u32 s31, s31, 13369344
 s_add_u32 s31, s31, s100
 s_lshr_b32 s24, s26, 1
 s_lshl_b32 s24, s24, 5
 s_add_u32 s24, s24, s41
 s_add_u32 s24, s24, 2048
 s_lshl_b32 s24, s86, 6
 s_add_u32 s24, s24, s101
 s_add_u32 s24, s24, 2048
 v_and_b32 v30, 15, v0
 v_lshlrev_b32 v30, 7, v30
 s_lshl_b32 s38, s24, 5
 s_add_u32 s38, s38, 9961472
 s_mov_b32 s39, 0x20000
 s_mov_b64 exec, 0xffff
POLL2:
 buffer_load_dword v31, v30, s[4:7], s38 offen sc1
 s_waitcnt vmcnt(0)
 v_cmp_ne_u32 vcc, 1, v31
 s_nop 1
 s_and_b64 exec, exec, vcc
 s_cbranch_scc0 POLL2_X
 s_sleep 1
 s_sub_u32 s39, s39, 1
 s_cmp_lg_u32 s39, 0
 s_cbranch_scc1 POLL2
POLL2_X:
 s_mov_b64 exec, -1
POLL2_D:
 s_waitcnt vmcnt(1)
 s_and_b32 s32, s27, 7
 s_cmp_eq_u32 s27, 8
 s_cbranch_scc1 K1C_EXT
 s_cmp_eq_u32 s27, 15
 s_cbranch_scc1 K1C_EXT
 s_cmp_ge_u32 s27, 9
 s_cbranch_scc1 K1C_V
 s_and_b32 s32, s27, 3
 s_lshl_b32 s32, s32, 3
 s_lshl_b32 s33, s26, 10
 s_add_u32 s33, s33, 11010048
 s_add_u32 s33, s33, s100
 s_and_b32 s34, s26, 7
 s_lshl_b32 s34, s34, 10
 s_add_u32 s34, s34, s31
 s_cmp_lt_u32 s27, 4
 s_cselect_b32 s33, s33, s34
 s_mov_b32 s35, 151552
 s_cselect_b32 s35, 65536, s35
 s_mov_b32 s36, 0x3eae1a93
 s_cselect_b32 s36, s36, 1.0
 s_mul_i32 s32, s32, s35
 s_add_u32 s33, s33, s32
 s_add_u32 s30, s23, 0
 buffer_load_dwordx4 a[0:3], v1, s[4:7], s30 offen offset:0 sc1
 s_add_u32 s30, s23, 0
 buffer_load_dwordx4 a[4:7], v1, s[4:7], s30 offen offset:1024 sc1
 s_add_u32 s30, s23, 0
 buffer_load_dwordx4 a[8:11], v1, s[4:7], s30 offen offset:2048 sc1
 s_add_u32 s30, s23, 0
 buffer_load_dwordx4 a[12:15], v1, s[4:7], s30 offen offset:3072 sc1
 v_and_b32 v12, 15, v0
 v_lshlrev_b32 v12, 3, v12
 v_bfe_u32 v13, v0, 4, 1
 v_lshlrev_b32 v13, 10, v13
 v_add_u32 v12, v12, v13
 buffer_load_dwordx2 v[16:17], v12, s[4:7], s29 offen offset:0 sc1
 buffer_load_dwordx2 v[18:19], v12, s[4:7], s29 offen offset:128 sc1
 buffer_load_dwordx2 v[20:21], v12, s[4:7], s29 offen offset:256 sc1
 buffer_load_dwordx2 v[22:23], v12, s[4:7], s29 offen offset:384 sc1
 buffer_load_dwordx2 v[24:25], v12, s[4:7], s29 offen offset:512 sc1
 buffer_load_dwordx2 v[26:27], v12, s[4:7], s29 offen offset:640 sc1
 buffer_load_dwordx2 v[28:29], v12, s[4:7], s29 offen offset:768 sc1
 buffer_load_dwordx2 v[30:31], v12, s[4:7], s29 offen offset:896 sc1
 s_add_u32 s30, s23, 4096
 buffer_load_dwordx4 a[16:19], v1, s[4:7], s30 offen offset:0 sc1
 s_add_u32 s30, s23, 4096
 buffer_load_dwordx4 a[20:23], v1, s[4:7], s30 offen offset:1024 sc1
 s_add_u32 s30, s23, 4096
 buffer_load_dwordx4 a[24:27], v1, s[4:7], s30 offen offset:2048 sc1
 s_add_u32 s30, s23, 4096
 buffer_load_dwordx4 a[28:31], v1, s[4:7], s30 offen offset:3072 sc1
 s_add_u32 s30, s23, 8192
 buffer_load_dwordx4 a[32:35], v1, s[4:7], s30 offen offset:0 sc1
 s_add_u32 s30, s23, 8192
 buffer_load_dwordx4 a[36:39], v1, s[4:7], s30 offen offset:1024 sc1
 s_barrier
 ds_read_b128 v[32:35], v2 offset:0
 ds_read_b128 v[36:39], v2 offset:37888
 ds_read_b128 v[40:43], v3 offset:10240
 ds_read_b128 v[44:47], v2 offset:1024
 ds_read_b128 v[48:51], v2 offset:38912
 ds_read_b128 v[52:55], v3 offset:11264
 ds_read_b128 v[56:59], v2 offset:2048
 s_waitcnt vmcnt(17) lgkmcnt(6)
 v_mfma_f32_32x32x16_bf16 v[64:79], v[32:35], a[0:3], 0
 s_add_u32 s30, s23, 8192
 buffer_load_dwordx4 a[40:43], v1, s[4:7], s30 offen offset:2048 sc1
 ds_read_b128 v[60:63], v2 offset:39936
 s_waitcnt lgkmcnt(6)
 v_mfma_f32_32x32x16_bf16 v[80:95], v[36:39], a[0:3], 0
 ds_read_b128 v[32:35], v3 offset:12288
 s_waitcnt lgkmcnt(6)
 v_mfma_f32_32x32x16_bf16 v[96:111], v[40:43], a[0:3], 0
 s_add_u32 s30, s23, 8192
 buffer_load_dwordx4 a[44:47], v1, s[4:7], s30 offen offset:3072 sc1
 ds_read_b128 v[36:39], v2 offset:3072
 s_waitcnt vmcnt(18) lgkmcnt(6)
 v_mfma_f32_32x32x16_bf16 v[64:79], v[44:47], a[4:7], v[64:79]
 ds_read_b128 v[40:43], v2 offset:40960
 s_waitcnt lgkmcnt(6)
 v_mfma_f32_32x32x16_bf16 v[80:95], v[48:51], a[4:7], v[80:95]
 s_add_u32 s30, s23, 12288
 buffer_load_dwordx4 a[48:51], v1, s[4:7], s30 offen offset:0 sc1
 ds_read_b128 v[44:47], v3 offset:13312
 s_waitcnt lgkmcnt(6)
 v_mfma_f32_32x32x16_bf16 v[96:111], v[52:55], a[4:7], v[96:111]
 ds_read_b128 v[48:51], v2 offset:4096
 s_waitcnt vmcnt(18) lgkmcnt(6)
 v_mfma_f32_32x32x16_bf16 v[64:79], v[56:59], a[8:11], v[64:79]
 ds_read_b128 v[52:55], v2 offset:41984
 s_waitcnt lgkmcnt(6)
 v_mfma_f32_32x32x16_bf16 v[80:95], v[60:63], a[8:11], v[80:95]
 s_add_u32 s30, s23, 12288
 buffer_load_dwordx4 a[52:55], v1, s[4:7], s30 offen offset:1024 sc1
 ds_read_b128 v[56:59], v3 offset:14336
 s_waitcnt lgkmcnt(6)
 v_mfma_f32_32x32x16_bf16 v[96:111], v[32:35], a[8:11], v[96:111]
 ds_read_b128 v[60:63], v2 offset:5120
 s_waitcnt vmcnt(18) lgkmcnt(6)
 v_mfma_f32_32x32x16_bf16 v[64:79], v[36:39], a[12:15], v[64:79]
 s_add_u32 s30, s23, 12288
 buffer_load_dwordx4 a[56:59], v1, s[4:7], s30 offen offset:2048 sc1
 s_waitcnt vmcnt(11)
 v_add_f32 v12, v16, v20
 ds_read_b128 v[32:35], v2 offset:43008
 s_waitcnt lgkmcnt(6)
 v_mfma_f32_32x32x16_bf16 v[80:95], v[40:43], a[12:15], v[80:95]
 v_add_f32 v13, v18, v22
 v_add_f32 v12, v12, v24
 v_add_f32 v13, v13, v26
 ds_read_b128 v[36:39], v3 offset:15360
 s_waitcnt lgkmcnt(6)
 v_mfma_f32_32x32x16_bf16 v[96:111], v[44:47], a[12:15], v[96:111]
 v_add_f32 v12, v12, v28
 v_add_f32 v13, v13, v30
 v_mul_f32 v12, 0x3de38e39, v12
 ds_read_b128 v[40:43], v2 offset:6144
 s_waitcnt vmcnt(10) lgkmcnt(6)
 v_mfma_f32_32x32x16_bf16 v[64:79], v[48:51], a[16:19], v[64:79]
 s_add_u32 s30, s23, 12288
 buffer_load_dwordx4 a[60:63], v1, s[4:7], s30 offen offset:3072 sc1
 v_mul_f32 v13, 0x3e0e38e4, v13
 ds_read_b128 v[44:47], v2 offset:44032
 s_waitcnt lgkmcnt(6)
 v_mfma_f32_32x32x16_bf16 v[80:95], v[52:55], a[16:19], v[80:95]
 v_add_f32 v5, v12, v13
 v_mov_b32 v12, 0
 v_mov_b32 v13, 0
 ds_read_b128 v[48:51], v3 offset:16384
 s_waitcnt lgkmcnt(6)
 v_mfma_f32_32x32x16_bf16 v[96:111], v[56:59], a[16:19], v[96:111]
 s_add_u32 s30, s23, 16384
 buffer_load_dwordx4 a[64:67], v1, s[4:7], s30 offen offset:0 sc1
 v_sub_f32 v16, v16, v5
 ds_read_b128 v[52:55], v2 offset:7168
 s_waitcnt vmcnt(11) lgkmcnt(6)
 v_mfma_f32_32x32x16_bf16 v[64:79], v[60:63], a[20:23], v[64:79]
 v_fmac_f32 v12, v16, v16
 v_sub_f32 v18, v18, v5
 v_fmac_f32 v13, v18, v18
 ds_read_b128 v[56:59], v2 offset:45056
 s_waitcnt lgkmcnt(6)
 v_mfma_f32_32x32x16_bf16 v[80:95], v[32:35], a[20:23], v[80:95]
 s_add_u32 s30, s23, 16384
 buffer_load_dwordx4 a[68:71], v1, s[4:7], s30 offen offset:1024 sc1
 v_sub_f32 v20, v20, v5
 ds_read_b128 v[60:63], v3 offset:17408
 s_waitcnt lgkmcnt(6)
 v_mfma_f32_32x32x16_bf16 v[96:111], v[36:39], a[20:23], v[96:111]
 v_fmac_f32 v12, v20, v20
 v_sub_f32 v22, v22, v5
 v_fmac_f32 v13, v22, v22
 ds_read_b128 v[32:35], v2 offset:8192
 s_waitcnt vmcnt(11) lgkmcnt(6)
 v_mfma_f32_32x32x16_bf16 v[64:79], v[40:43], a[24:27], v[64:79]
 v_sub_f32 v24, v24, v5
 v_fmac_f32 v12, v24, v24
 v_sub_f32 v26, v26, v5
 ds_read_b128 v[36:39], v2 offset:46080
 s_waitcnt lgkmcnt(6)
 v_mfma_f32_32x32x16_bf16 v[80:95], v[44:47], a[24:27], v[80:95]
 s_add_u32 s30, s23, 16384
 buffer_load_dwordx4 a[72:75], v1, s[4:7], s30 offen offset:2048 sc1
 v_fmac_f32 v13, v26, v26
 ds_read_b128 v[40:43], v3 offset:18432
 s_waitcnt lgkmcnt(6)
 v_mfma_f32_32x32x16_bf16 v[96:111], v[48:51], a[24:27], v[96:111]
 v_sub_f32 v28, v28, v5
 v_fmac_f32 v12, v28, v28
 v_sub_f32 v30, v30, v5
 ds_read_b128 v[44:47], v2 offset:9216
 s_waitcnt vmcnt(11) lgkmcnt(6)
 v_mfma_f32_32x32x16_bf16 v[64:79], v[52:55], a[28:31], v[64:79]
 s_add_u32 s30, s23, 16384
 buffer_load_dwordx4 a[76:79], v1, s[4:7], s30 offen offset:3072 sc1
 v_fmac_f32 v13, v30, v30
 ds_read_b128 v[48:51], v2 offset:47104
 s_waitcnt lgkmcnt(6)
 v_mfma_f32_32x32x16_bf16 v[80:95], v[56:59], a[28:31], v[80:95]
 v_mul_f32 v12, 0x42800000, v12
 v_mul_f32 v13, 0x42a00000, v13
 v_add_f32 v12, v12, v13
 ds_read_b128 v[52:55], v3 offset:19456
 s_waitcnt lgkmcnt(6)
 v_mfma_f32_32x32x16_bf16 v[96:111], v[60:63], a[28:31], v[96:111]
 v_add_f32 v12, v12, v17
 v_add_f32 v12, v12, v19
 v_add_f32 v12, v12, v21
 ds_read_b128 v[56:59], v2 offset:10240
 s_waitcnt vmcnt(11) lgkmcnt(6)
 v_mfma_f32_32x32x16_bf16 v[64:79], v[32:35], a[32:35], v[64:79]
 s_add_u32 s30, s23, 20480
 buffer_load_dwordx4 a[80:83], v1, s[4:7], s30 offen offset:0 sc1
 v_add_f32 v12, v12, v23
 ds_read_b128 v[60:63], v2 offset:48128
 s_waitcnt lgkmcnt(6)
 v_mfma_f32_32x32x16_bf16 v[80:95], v[36:39], a[32:35], v[80:95]
 v_add_f32 v12, v12, v25
 v_add_f32 v12, v12, v27
 v_add_f32 v12, v12, v29
 ds_read_b128 v[32:35], v3 offset:20480
 s_waitcnt lgkmcnt(6)
 v_mfma_f32_32x32x16_bf16 v[96:111], v[40:43], a[32:35], v[96:111]
 s_add_u32 s30, s23, 20480
 buffer_load_dwordx4 a[84:87], v1, s[4:7], s30 offen offset:1024 sc1
 v_add_f32 v12, v12, v31
 ds_read_b128 v[36:39], v2 offset:11264
 s_waitcnt vmcnt(12) lgkmcnt(6)
 v_mfma_f32_32x32x16_bf16 v[64:79], v[44:47], a[36:39], v[64:79]
 v_mov_b32 v13, 0x3727c5ac
 v_mov_b32 v6, 0x3ae38e39
 v_fma_f32 v6, v12, v6, v13
 ds_read_b128 v[40:43], v2 offset:49152
 s_waitcnt lgkmcnt(6)
 v_mfma_f32_32x32x16_bf16 v[80:95], v[48:51], a[36:39], v[80:95]
 s_add_u32 s30, s23, 20480
 buffer_load_dwordx4 a[88:91], v1, s[4:7], s30 offen offset:2048 sc1
 v_cmp_gt_u32 vcc, 512, v1
 ds_read_b128 v[44:47], v3 offset:21504
 s_waitcnt lgkmcnt(6)
 v_mfma_f32_32x32x16_bf16 v[96:111], v[52:55], a[36:39], v[96:111]
 v_cvt_pk_bf16_f32 v12, v5, v5
 v_lshlrev_b32 v12, 16, v12
 v_sub_f32 v14, v5, v12
 ds_read_b128 v[48:51], v2 offset:12288
 s_waitcnt vmcnt(12) lgkmcnt(6)
 v_mfma_f32_32x32x16_bf16 v[64:79], v[56:59], a[40:43], v[64:79]
 v_cvt_pk_bf16_f32 v13, v14, v14
 v_lshlrev_b32 v13, 16, v13
 v_sub_f32 v14, v14, v13
 ds_read_b128 v[52:55], v2 offset:50176
 s_waitcnt lgkmcnt(6)
 v_mfma_f32_32x32x16_bf16 v[80:95], v[60:63], a[40:43], v[80:95]
 s_add_u32 s30, s23, 20480
 buffer_load_dwordx4 a[92:95], v1, s[4:7], s30 offen offset:3072 sc1
 v_cvt_pk_bf16_f32 v8, v12, v12
 ds_read_b128 v[56:59], v3 offset:22528
 s_waitcnt lgkmcnt(6)
 v_mfma_f32_32x32x16_bf16 v[96:111], v[32:35], a[40:43], v[96:111]
 v_cvt_pk_bf16_f32 v9, v13, v12
 v_cvt_pk_bf16_f32 v10, v13, v14
 v_mov_b32 v11, 0
 ds_read_b128 v[60:63], v2 offset:13312
 s_waitcnt vmcnt(12) lgkmcnt(6)
 v_mfma_f32_32x32x16_bf16 v[64:79], v[36:39], a[44:47], v[64:79]
 s_add_u32 s30, s23, 24576
 buffer_load_dwordx4 a[96:99], v1, s[4:7], s30 offen offset:0 sc1
 v_cndmask_b32 v8, 0, v8, vcc
 ds_read_b128 v[32:35], v2 offset:51200
 s_waitcnt lgkmcnt(6)
 v_mfma_f32_32x32x16_bf16 v[80:95], v[40:43], a[44:47], v[80:95]
 v_cndmask_b32 v9, 0, v9, vcc
 v_cndmask_b32 v10, 0, v10, vcc
 ds_read_b128 v[36:39], v3 offset:23552
 s_waitcnt lgkmcnt(6)
 v_mfma_f32_32x32x16_bf16 v[96:111], v[44:47], a[44:47], v[96:111]
 v_rsq_f32 v6, v6
 s_nop 0
 v_mul_f32 v7, s36, v6
 ds_read_b128 v[40:43], v2 offset:14336
 s_waitcnt vmcnt(12) lgkmcnt(6)
 v_mfma_f32_32x32x16_bf16 v[64:79], v[48:51], a[48:51], v[64:79]
 s_add_u32 s30, s23, 24576
 buffer_load_dwordx4 a[100:103], v1, s[4:7], s30 offen offset:1024 sc1
 ds_read_b128 v[44:47], v2 offset:52224
 s_waitcnt lgkmcnt(6)
 v_mfma_f32_32x32x16_bf16 v[80:95], v[52:55], a[48:51], v[80:95]
 ds_read_b128 v[48:51], v3 offset:24576
 s_waitcnt lgkmcnt(6)
 v_mfma_f32_32x32x16_bf16 v[96:111], v[56:59], a[48:51], v[96:111]
 s_add_u32 s30, s23, 24576
 buffer_load_dwordx4 a[104:107], v1, s[4:7], s30 offen offset:2048 sc1
 ds_read_b128 v[52:55], v2 offset:15360
 s_waitcnt vmcnt(13) lgkmcnt(6)
 v_mfma_f32_32x32x16_bf16 v[64:79], v[60:63], a[52:55], v[64:79]
 ds_read_b128 v[56:59], v2 offset:53248
 s_waitcnt lgkmcnt(6)
 v_mfma_f32_32x32x16_bf16 v[80:95], v[32:35], a[52:55], v[80:95]
 s_add_u32 s30, s23, 24576
 buffer_load_dwordx4 a[108:111], v1, s[4:7], s30 offen offset:3072 sc1
 ds_read_b128 v[60:63], v3 offset:25600
 s_waitcnt lgkmcnt(6)
 v_mfma_f32_32x32x16_bf16 v[96:111], v[36:39], a[52:55], v[96:111]
 ds_read_b128 v[32:35], v2 offset:16384
 s_waitcnt vmcnt(13) lgkmcnt(6)
 v_mfma_f32_32x32x16_bf16 v[64:79], v[40:43], a[56:59], v[64:79]
 ds_read_b128 v[36:39], v2 offset:54272
 s_waitcnt lgkmcnt(6)
 v_mfma_f32_32x32x16_bf16 v[80:95], v[44:47], a[56:59], v[80:95]
 s_add_u32 s30, s23, 28672
 buffer_load_dwordx4 a[112:115], v1, s[4:7], s30 offen offset:0 sc1
 ds_read_b128 v[40:43], v3 offset:26624
 s_waitcnt lgkmcnt(6)
 v_mfma_f32_32x32x16_bf16 v[96:111], v[48:51], a[56:59], v[96:111]
 ds_read_b128 v[44:47], v2 offset:17408
 s_waitcnt vmcnt(13) lgkmcnt(6)
 v_mfma_f32_32x32x16_bf16 v[64:79], v[52:55], a[60:63], v[64:79]
 s_add_u32 s30, s23, 28672
 buffer_load_dwordx4 a[116:119], v1, s[4:7], s30 offen offset:1024 sc1
 ds_read_b128 v[48:51], v2 offset:55296
 s_waitcnt lgkmcnt(6)
 v_mfma_f32_32x32x16_bf16 v[80:95], v[56:59], a[60:63], v[80:95]
 ds_read_b128 v[52:55], v3 offset:27648
 s_waitcnt lgkmcnt(6)
 v_mfma_f32_32x32x16_bf16 v[96:111], v[60:63], a[60:63], v[96:111]
 ds_read_b128 v[56:59], v2 offset:18432
 s_waitcnt vmcnt(13) lgkmcnt(6)
 v_mfma_f32_32x32x16_bf16 v[64:79], v[32:35], a[64:67], v[64:79]
 s_add_u32 s30, s23, 28672
 buffer_load_dwordx4 a[120:123], v1, s[4:7], s30 offen offset:2048 sc1
 ds_read_b128 v[60:63], v2 offset:56320
 s_waitcnt lgkmcnt(6)
 v_mfma_f32_32x32x16_bf16 v[80:95], v[36:39], a[64:67], v[80:95]
 ds_read_b128 v[32:35], v3 offset:28672
 s_waitcnt lgkmcnt(6)
 v_mfma_f32_32x32x16_bf16 v[96:111], v[40:43], a[64:67], v[96:111]
 s_add_u32 s30, s23, 28672
 buffer_load_dwordx4 a[124:127], v1, s[4:7], s30 offen offset:3072 sc1
 ds_read_b128 v[36:39], v2 offset:19456
 s_waitcnt vmcnt(14) lgkmcnt(6)
 v_mfma_f32_32x32x16_bf16 v[64:79], v[44:47], a[68:71], v[64:79]
 ds_read_b128 v[40:43], v2 offset:57344
 s_waitcnt lgkmcnt(6)
 v_mfma_f32_32x32x16_bf16 v[80:95], v[48:51], a[68:71], v[80:95]
 s_add_u32 s30, s23, 32768
 buffer_load_dwordx4 a[128:131], v1, s[4:7], s30 offen offset:0 sc1
 ds_read_b128 v[44:47], v3 offset:29696
 s_waitcnt lgkmcnt(6)
 v_mfma_f32_32x32x16_bf16 v[96:111], v[52:55], a[68:71], v[96:111]
 ds_read_b128 v[48:51], v2 offset:20480
 s_waitcnt vmcnt(14) lgkmcnt(6)
 v_mfma_f32_32x32x16_bf16 v[64:79], v[56:59], a[72:75], v[64:79]
 ds_read_b128 v[52:55], v2 offset:58368
 s_waitcnt lgkmcnt(6)
 v_mfma_f32_32x32x16_bf16 v[80:95], v[60:63], a[72:75], v[80:95]
 s_add_u32 s30, s23, 32768
 buffer_load_dwordx4 a[132:135], v1, s[4:7], s30 offen offset:1024 sc1
 ds_read_b128 v[56:59], v3 offset:30720
 s_waitcnt lgkmcnt(6)
 v_mfma_f32_32x32x16_bf16 v[96:111], v[32:35], a[72:75], v[96:111]
 ds_read_b128 v[60:63], v2 offset:21504
 s_waitcnt vmcnt(14) lgkmcnt(6)
 v_mfma_f32_32x32x16_bf16 v[64:79], v[36:39], a[76:79], v[64:79]
 s_add_u32 s30, s23, 32768
 buffer_load_dwordx4 a[136:139], v1, s[4:7], s30 offen offset:2048 sc1
 ds_read_b128 v[32:35], v2 offset:59392
 s_waitcnt lgkmcnt(6)
 v_mfma_f32_32x32x16_bf16 v[80:95], v[40:43], a[76:79], v[80:95]
 ds_read_b128 v[36:39], v3 offset:31744
 s_waitcnt lgkmcnt(6)
 v_mfma_f32_32x32x16_bf16 v[96:111], v[44:47], a[76:79], v[96:111]
 ds_read_b128 v[40:43], v2 offset:22528
 s_waitcnt vmcnt(14) lgkmcnt(6)
 v_mfma_f32_32x32x16_bf16 v[64:79], v[48:51], a[80:83], v[64:79]
 s_add_u32 s30, s23, 32768
 buffer_load_dwordx4 a[140:143], v1, s[4:7], s30 offen offset:3072 sc1
 ds_read_b128 v[44:47], v2 offset:60416
 s_waitcnt lgkmcnt(6)
 v_mfma_f32_32x32x16_bf16 v[80:95], v[52:55], a[80:83], v[80:95]
 ds_read_b128 v[48:51], v3 offset:32768
 s_waitcnt lgkmcnt(6)
 v_mfma_f32_32x32x16_bf16 v[96:111], v[56:59], a[80:83], v[96:111]
 ds_read_b128 v[52:55], v2 offset:23552
 s_waitcnt vmcnt(14) lgkmcnt(6)
 v_mfma_f32_32x32x16_bf16 v[64:79], v[60:63], a[84:87], v[64:79]
 ds_read_b128 v[56:59], v2 offset:61440
 s_waitcnt lgkmcnt(6)
 v_mfma_f32_32x32x16_bf16 v[80:95], v[32:35], a[84:87], v[80:95]
 ds_read_b128 v[60:63], v3 offset:33792
 s_waitcnt lgkmcnt(6)
 v_mfma_f32_32x32x16_bf16 v[96:111], v[36:39], a[84:87], v[96:111]
 ds_read_b128 v[32:35], v2 offset:24576
 s_waitcnt vmcnt(13) lgkmcnt(6)
 v_mfma_f32_32x32x16_bf16 v[64:79], v[40:43], a[88:91], v[64:79]
 ds_read_b128 v[36:39], v2 offset:62464
 s_waitcnt lgkmcnt(6)
 v_mfma_f32_32x32x16_bf16 v[80:95], v[44:47], a[88:91], v[80:95]
 ds_read_b128 v[40:43], v3 offset:34816
 s_waitcnt lgkmcnt(6)
 v_mfma_f32_32x32x16_bf16 v[96:111], v[48:51], a[88:91], v[96:111]
 ds_read_b128 v[44:47], v2 offset:25600
 s_waitcnt vmcnt(12) lgkmcnt(6)
 v_mfma_f32_32x32x16_bf16 v[64:79], v[52:55], a[92:95], v[64:79]
 ds_read_b128 v[48:51], v2 offset:63488
 s_waitcnt lgkmcnt(6)
 v_mfma_f32_32x32x16_bf16 v[80:95], v[56:59], a[92:95], v[80:95]
 ds_read_b128 v[52:55], v3 offset:35840
 s_waitcnt lgkmcnt(6)
 v_mfma_f32_32x32x16_bf16 v[96:111], v[60:63], a[92:95], v[96:111]
 ds_read_b128 v[56:59], v2 offset:26624
 s_waitcnt vmcnt(11) lgkmcnt(6)
 v_mfma_f32_32x32x16_bf16 v[64:79], v[32:35], a[96:99], v[64:79]
 ds_read_b128 v[60:63], v2 offset:64512
 s_waitcnt lgkmcnt(6)
 v_mfma_f32_32x32x16_bf16 v[80:95], v[36:39], a[96:99], v[80:95]
 ds_read_b128 v[32:35], v3 offset:36864
 s_waitcnt lgkmcnt(6)
 v_mfma_f32_32x32x16_bf16 v[96:111], v[40:43], a[96:99], v[96:111]
 ds_read_b128 v[36:39], v2 offset:27648
 s_waitcnt vmcnt(10) lgkmcnt(6)
 v_mfma_f32_32x32x16_bf16 v[64:79], v[44:47], a[100:103], v[64:79]
 ds_read_b128 v[40:43], v3 offset:0
 s_waitcnt lgkmcnt(6)
 v_mfma_f32_32x32x16_bf16 v[80:95], v[48:51], a[100:103], v[80:95]
 ds_read_b128 v[44:47], v3 offset:37888
 s_waitcnt lgkmcnt(6)
 v_mfma_f32_32x32x16_bf16 v[96:111], v[52:55], a[100:103], v[96:111]
 ds_read_b128 v[48:51], v2 offset:28672
 s_waitcnt vmcnt(9) lgkmcnt(6)
 v_mfma_f32_32x32x16_bf16 v[64:79], v[56:59], a[104:107], v[64:79]
 ds_read_b128 v[52:55], v3 offset:1024
 s_waitcnt lgkmcnt(6)
 v_mfma_f32_32x32x16_bf16 v[80:95], v[60:63], a[104:107], v[80:95]
 ds_read_b128 v[56:59], v3 offset:38912
 s_waitcnt lgkmcnt(6)
 v_mfma_f32_32x32x16_bf16 v[96:111], v[32:35], a[104:107], v[96:111]
 ds_read_b128 v[60:63], v2 offset:29696
 s_waitcnt vmcnt(8) lgkmcnt(6)
 v_mfma_f32_32x32x16_bf16 v[64:79], v[36:39], a[108:111], v[64:79]
 ds_read_b128 v[32:35], v3 offset:2048
 s_waitcnt lgkmcnt(6)
 v_mfma_f32_32x32x16_bf16 v[80:95], v[40:43], a[108:111], v[80:95]
 ds_read_b128 v[36:39], v3 offset:39936
 s_waitcnt lgkmcnt(6)
 v_mfma_f32_32x32x16_bf16 v[96:111], v[44:47], a[108:111], v[96:111]
 ds_read_b128 v[40:43], v2 offset:30720
 s_waitcnt vmcnt(7) lgkmcnt(6)
 v_mfma_f32_32x32x16_bf16 v[64:79], v[48:51], a[112:115], v[64:79]
 ds_read_b128 v[44:47], v3 offset:3072
 s_waitcnt lgkmcnt(6)
 v_mfma_f32_32x32x16_bf16 v[80:95], v[52:55], a[112:115], v[80:95]
 ds_read_b128 v[48:51], v3 offset:40960
 s_waitcnt lgkmcnt(6)
 v_mfma_f32_32x32x16_bf16 v[96:111], v[56:59], a[112:115], v[96:111]
 ds_read_b128 v[52:55], v2 offset:31744
 s_waitcnt vmcnt(6) lgkmcnt(6)
 v_mfma_f32_32x32x16_bf16 v[64:79], v[60:63], a[116:119], v[64:79]
 ds_read_b128 v[56:59], v3 offset:4096
 s_waitcnt lgkmcnt(6)
 v_mfma_f32_32x32x16_bf16 v[80:95], v[32:35], a[116:119], v[80:95]
 ds_read_b128 v[60:63], v3 offset:41984
 s_waitcnt lgkmcnt(6)
 v_mfma_f32_32x32x16_bf16 v[96:111], v[36:39], a[116:119], v[96:111]
 ds_read_b128 v[32:35], v2 offset:32768
 s_waitcnt vmcnt(5) lgkmcnt(6)
 v_mfma_f32_32x32x16_bf16 v[64:79], v[40:43], a[120:123], v[64:79]
 ds_read_b128 v[36:39], v3 offset:5120
 s_waitcnt lgkmcnt(6)
 v_mfma_f32_32x32x16_bf16 v[80:95], v[44:47], a[120:123], v[80:95]
 ds_read_b128 v[40:43], v3 offset:43008
 s_waitcnt lgkmcnt(6)
 v_mfma_f32_32x32x16_bf16 v[96:111], v[48:51], a[120:123], v[96:111]
 ds_read_b128 v[44:47], v2 offset:33792
 s_waitcnt vmcnt(4) lgkmcnt(6)
 v_mfma_f32_32x32x16_bf16 v[64:79], v[52:55], a[124:127], v[64:79]
 ds_read_b128 v[48:51], v3 offset:6144
 s_waitcnt lgkmcnt(6)
 v_mfma_f32_32x32x16_bf16 v[80:95], v[56:59], a[124:127], v[80:95]
 ds_read_b128 v[52:55], v3 offset:44032
 s_waitcnt lgkmcnt(6)
 v_mfma_f32_32x32x16_bf16 v[96:111], v[60:63], a[124:127], v[96:111]
 ds_read_b128 v[56:59], v2 offset:34816
 s_waitcnt vmcnt(3) lgkmcnt(6)
 v_mfma_f32_32x32x16_bf16 v[64:79], v[32:35], a[128:131], v[64:79]
 ds_read_b128 v[60:63], v3 offset:7168
 s_waitcnt lgkmcnt(6)
 v_mfma_f32_32x32x16_bf16 v[80:95], v[36:39], a[128:131], v[80:95]
 ds_read_b128 v[32:35], v3 offset:45056
 s_waitcnt lgkmcnt(6)
 v_mfma_f32_32x32x16_bf16 v[96:111], v[40:43], a[128:131], v[96:111]
 ds_read_b128 v[36:39], v2 offset:35840
 s_waitcnt vmcnt(2) lgkmcnt(6)
 v_mfma_f32_32x32x16_bf16 v[64:79], v[44:47], a[132:135], v[64:79]
 ds_read_b128 v[40:43], v3 offset:8192
 s_waitcnt lgkmcnt(6)
 v_mfma_f32_32x32x16_bf16 v[80:95], v[48:51], a[132:135], v[80:95]
 ds_read_b128 v[44:47], v3 offset:46080
 s_waitcnt lgkmcnt(6)
 v_mfma_f32_32x32x16_bf16 v[96:111], v[52:55], a[132:135], v[96:111]
 ds_read_b128 v[48:51], v2 offset:36864
 s_waitcnt vmcnt(1) lgkmcnt(6)
 v_mfma_f32_32x32x16_bf16 v[64:79], v[56:59], a[136:139], v[64:79]
 ds_read_b128 v[52:55], v3 offset:9216
 s_waitcnt lgkmcnt(6)
 v_mfma_f32_32x32x16_bf16 v[80:95], v[60:63], a[136:139], v[80:95]
 ds_read_b128 v[56:59], v3 offset:47104
 s_waitcnt lgkmcnt(6)
 v_mfma_f32_32x32x16_bf16 v[96:111], v[32:35], a[136:139], v[96:111]
 ds_read_b128 v[60:63], v3 offset:48128
 s_waitcnt vmcnt(0) lgkmcnt(6)
 v_mfma_f32_32x32x16_bf16 v[64:79], v[36:39], a[140:143], v[64:79]
 ds_read_b128 v[32:35], v3 offset:49152
 s_waitcnt lgkmcnt(6)
 v_mfma_f32_32x32x16_bf16 v[80:95], v[40:43], a[140:143], v[80:95]
 ds_read_b128 v[36:39], v3 offset:50176
 s_waitcnt lgkmcnt(6)
 v_mfma_f32_32x32x16_bf16 v[96:111], v[44:47], a[140:143], v[96:111]
 ds_read_b128 v[40:43], v3 offset:51200
 s_waitcnt lgkmcnt(6)
 v_mfma_f32_32x32x16_bf16 v[64:79], v[48:51], v[8:11], v[64:79]
 ds_read_b128 v[44:47], v3 offset:52224
 s_waitcnt lgkmcnt(6)
 v_mfma_f32_32x32x16_bf16 v[80:95], v[52:55], v[8:11], v[80:95]
 ds_read_b128 v[48:51], v3 offset:53248
 s_waitcnt lgkmcnt(6)
 v_mfma_f32_32x32x16_bf16 v[96:111], v[56:59], v[8:11], v[96:111]
 ds_read_b128 v[52:55], v3 offset:54272
 s_waitcnt lgkmcnt(6)
 v_mfma_f32_32x32x16_bf16 v[112:127], v[60:63], a[0:3], 0
 ds_read_b128 v[56:59], v3 offset:55296
 s_waitcnt lgkmcnt(6)
 v_mfma_f32_32x32x16_bf16 v[112:127], v[32:35], a[4:7], v[112:127]
 ds_read_b128 v[60:63], v3 offset:56320
 s_waitcnt lgkmcnt(6)
 v_mfma_f32_32x32x16_bf16 v[112:127], v[36:39], a[8:11], v[112:127]
 v_mul_f32 v64, v64, v7
 v_mul_f32 v65, v65, v7
 v_mul_f32 v66, v66, v7
 ds_read_b128 v[32:35], v3 offset:57344
 s_waitcnt lgkmcnt(6)
 v_mfma_f32_32x32x16_bf16 v[112:127], v[40:43], a[12:15], v[112:127]
 v_mul_f32 v67, v67, v7
 v_mul_f32 v68, v68, v7
 v_mul_f32 v69, v69, v7
 ds_read_b128 v[36:39], v3 offset:58368
 s_waitcnt lgkmcnt(6)
 v_mfma_f32_32x32x16_bf16 v[112:127], v[44:47], a[16:19], v[112:127]
 v_mul_f32 v70, v70, v7
 v_mul_f32 v71, v71, v7
 v_cvt_pk_bf16_f32 v128, v64, v65
 ds_read_b128 v[40:43], v3 offset:59392
 s_waitcnt lgkmcnt(6)
 v_mfma_f32_32x32x16_bf16 v[112:127], v[48:51], a[20:23], v[112:127]
 v_cvt_pk_bf16_f32 v129, v66, v67
 v_cvt_pk_bf16_f32 v130, v68, v69
 v_cvt_pk_bf16_f32 v131, v70, v71
 ds_read_b128 v[44:47], v3 offset:60416
 s_waitcnt lgkmcnt(6)
 v_mfma_f32_32x32x16_bf16 v[112:127], v[52:55], a[24:27], v[112:127]
 buffer_store_dwordx4 v[128:131], v1, s[4:7], s33 offen sc1
 ds_read_b128 v[48:51], v3 offset:61440
 s_waitcnt lgkmcnt(6)
 v_mfma_f32_32x32x16_bf16 v[112:127], v[56:59], a[28:31], v[112:127]
 s_add_u32 s33, s33, s35
 v_mul_f32 v72, v72, v7
 v_mul_f32 v73, v73, v7
 ds_read_b128 v[52:55], v3 offset:62464
 s_waitcnt lgkmcnt(6)
 v_mfma_f32_32x32x16_bf16 v[112:127], v[60:63], a[32:35], v[112:127]
 v_mul_f32 v74, v74, v7
 v_mul_f32 v75, v75, v7
 v_mul_f32 v76, v76, v7
 ds_read_b128 v[56:59], v3 offset:63488
 s_waitcnt lgkmcnt(6)
 v_mfma_f32_32x32x16_bf16 v[112:127], v[32:35], a[36:39], v[112:127]
 v_mul_f32 v77, v77, v7
 v_mul_f32 v78, v78, v7
 v_mul_f32 v79, v79, v7
 ds_read_b128 v[60:63], v3 offset:64512
 s_waitcnt lgkmcnt(6)
 v_mfma_f32_32x32x16_bf16 v[112:127], v[36:39], a[40:43], v[112:127]
 v_cvt_pk_bf16_f32 v132, v72, v73
 v_cvt_pk_bf16_f32 v133, v74, v75
 v_cvt_pk_bf16_f32 v134, v76, v77
 ds_read_b128 v[32:35], v4 offset:0
 s_waitcnt lgkmcnt(6)
 v_mfma_f32_32x32x16_bf16 v[112:127], v[40:43], a[44:47], v[112:127]
 v_cvt_pk_bf16_f32 v135, v78, v79
 buffer_store_dwordx4 v[132:135], v1, s[4:7], s33 offen sc1
 ds_read_b128 v[36:39], v4 offset:1024
 s_waitcnt lgkmcnt(6)
 v_mfma_f32_32x32x16_bf16 v[112:127], v[44:47], a[48:51], v[112:127]
 s_add_u32 s33, s33, s35
 v_mul_f32 v80, v80, v7
 v_mul_f32 v81, v81, v7
 ds_read_b128 v[40:43], v4 offset:2048
 s_waitcnt lgkmcnt(6)
 v_mfma_f32_32x32x16_bf16 v[112:127], v[48:51], a[52:55], v[112:127]
 v_mul_f32 v82, v82, v7
 v_mul_f32 v83, v83, v7
 v_mul_f32 v84, v84, v7
 ds_read_b128 v[44:47], v4 offset:3072
 s_waitcnt lgkmcnt(6)
 v_mfma_f32_32x32x16_bf16 v[112:127], v[52:55], a[56:59], v[112:127]
 v_mul_f32 v85, v85, v7
 v_mul_f32 v86, v86, v7
 v_mul_f32 v87, v87, v7
 ds_read_b128 v[48:51], v4 offset:4096
 s_waitcnt lgkmcnt(6)
 v_mfma_f32_32x32x16_bf16 v[112:127], v[56:59], a[60:63], v[112:127]
 v_cvt_pk_bf16_f32 v136, v80, v81
 v_cvt_pk_bf16_f32 v137, v82, v83
 v_cvt_pk_bf16_f32 v138, v84, v85
 ds_read_b128 v[52:55], v4 offset:5120
 s_waitcnt lgkmcnt(6)
 v_mfma_f32_32x32x16_bf16 v[112:127], v[60:63], a[64:67], v[112:127]
 v_cvt_pk_bf16_f32 v139, v86, v87
 buffer_store_dwordx4 v[136:139], v1, s[4:7], s33 offen sc1
 ds_read_b128 v[56:59], v4 offset:6144
 s_waitcnt lgkmcnt(6)
 v_mfma_f32_32x32x16_bf16 v[112:127], v[32:35], a[68:71], v[112:127]
 s_add_u32 s33, s33, s35
 v_mul_f32 v88, v88, v7
 v_mul_f32 v89, v89, v7
 ds_read_b128 v[60:63], v4 offset:7168
 s_waitcnt lgkmcnt(6)
 v_mfma_f32_32x32x16_bf16 v[112:127], v[36:39], a[72:75], v[112:127]
 v_mul_f32 v90, v90, v7
 v_mul_f32 v91, v91, v7
 v_mul_f32 v92, v92, v7
 ds_read_b128 v[32:35], v4 offset:8192
 s_waitcnt lgkmcnt(6)
 v_mfma_f32_32x32x16_bf16 v[112:127], v[40:43], a[76:79], v[112:127]
 v_mul_f32 v93, v93, v7
 v_mul_f32 v94, v94, v7
 v_mul_f32 v95, v95, v7
 ds_read_b128 v[36:39], v4 offset:9216
 s_waitcnt lgkmcnt(6)
 v_mfma_f32_32x32x16_bf16 v[112:127], v[44:47], a[80:83], v[112:127]
 v_cvt_pk_bf16_f32 v140, v88, v89
 v_cvt_pk_bf16_f32 v141, v90, v91
 v_cvt_pk_bf16_f32 v142, v92, v93
 ds_read_b128 v[40:43], v4 offset:10240
 s_waitcnt lgkmcnt(6)
 v_mfma_f32_32x32x16_bf16 v[112:127], v[48:51], a[84:87], v[112:127]
 v_cvt_pk_bf16_f32 v143, v94, v95
 buffer_store_dwordx4 v[140:143], v1, s[4:7], s33 offen sc1
 ds_read_b128 v[44:47], v4 offset:11264
 s_waitcnt lgkmcnt(6)
 v_mfma_f32_32x32x16_bf16 v[112:127], v[52:55], a[88:91], v[112:127]
 s_add_u32 s33, s33, s35
 v_mul_f32 v96, v96, v7
 v_mul_f32 v97, v97, v7
 ds_read_b128 v[48:51], v4 offset:12288
 s_waitcnt lgkmcnt(6)
 v_mfma_f32_32x32x16_bf16 v[112:127], v[56:59], a[92:95], v[112:127]
 v_mul_f32 v98, v98, v7
 v_mul_f32 v99, v99, v7
 v_mul_f32 v100, v100, v7
 ds_read_b128 v[52:55], v4 offset:13312
 s_waitcnt lgkmcnt(6)
 v_mfma_f32_32x32x16_bf16 v[112:127], v[60:63], a[96:99], v[112:127]
 v_mul_f32 v101, v101, v7
 v_mul_f32 v102, v102, v7
 v_mul_f32 v103, v103, v7
 ds_read_b128 v[56:59], v4 offset:14336
 s_waitcnt lgkmcnt(6)
 v_mfma_f32_32x32x16_bf16 v[112:127], v[32:35], a[100:103], v[112:127]
 v_cvt_pk_bf16_f32 v144, v96, v97
 v_cvt_pk_bf16_f32 v145, v98, v99
 v_cvt_pk_bf16_f32 v146, v100, v101
 ds_read_b128 v[60:63], v4 offset:15360
 s_waitcnt lgkmcnt(6)
 v_mfma_f32_32x32x16_bf16 v[112:127], v[36:39], a[104:107], v[112:127]
 v_cvt_pk_bf16_f32 v147, v102, v103
 buffer_store_dwordx4 v[144:147], v1, s[4:7], s33 offen sc1
 ds_read_b128 v[32:35], v4 offset:16384
 s_waitcnt lgkmcnt(6)
 v_mfma_f32_32x32x16_bf16 v[112:127], v[40:43], a[108:111], v[112:127]
 s_add_u32 s33, s33, s35
 v_mul_f32 v104, v104, v7
 v_mul_f32 v105, v105, v7
 ds_read_b128 v[36:39], v4 offset:17408
 s_waitcnt lgkmcnt(6)
 v_mfma_f32_32x32x16_bf16 v[112:127], v[44:47], a[112:115], v[112:127]
 v_mul_f32 v106, v106, v7
 v_mul_f32 v107, v107, v7
 v_mul_f32 v108, v108, v7
 ds_read_b128 v[40:43], v4 offset:18432
 s_waitcnt lgkmcnt(6)
 v_mfma_f32_32x32x16_bf16 v[112:127], v[48:51], a[116:119], v[112:127]
 v_mul_f32 v109, v109, v7
 v_mul_f32 v110, v110, v7
 v_mul_f32 v111, v111, v7
 ds_read_b128 v[44:47], v4 offset:19456
 s_waitcnt lgkmcnt(6)
 v_mfma_f32_32x32x16_bf16 v[112:127], v[52:55], a[120:123], v[112:127]
 v_cvt_pk_bf16_f32 v148, v104, v105
 v_cvt_pk_bf16_f32 v149, v106, v107
 v_cvt_pk_bf16_f32 v150, v108, v109
 v_cvt_pk_bf16_f32 v151, v110, v111
 buffer_store_dwordx4 v[148:151], v1, s[4:7], s33 offen sc1
 s_waitcnt lgkmcnt(5)
 v_mfma_f32_32x32x16_bf16 v[112:127], v[56:59], a[124:127], v[112:127]
 s_add_u32 s33, s33, s35
 s_waitcnt lgkmcnt(4)
 v_mfma_f32_32x32x16_bf16 v[112:127], v[60:63], a[128:131], v[112:127]
 s_waitcnt lgkmcnt(3)
 v_mfma_f32_32x32x16_bf16 v[112:127], v[32:35], a[132:135], v[112:127]
 s_waitcnt lgkmcnt(2)
 v_mfma_f32_32x32x16_bf16 v[112:127], v[36:39], a[136:139], v[112:127]
 s_waitcnt lgkmcnt(1)
 v_mfma_f32_32x32x16_bf16 v[112:127], v[40:43], a[140:143], v[112:127]
 s_waitcnt lgkmcnt(0)
 v_mfma_f32_32x32x16_bf16 v[112:127], v[44:47], v[8:11], v[112:127]
 s_nop 11
 v_mul_f32 v112, v112, v7
 v_mul_f32 v113, v113, v7
 v_mul_f32 v114, v114, v7
 v_mul_f32 v115, v115, v7
 v_mul_f32 v116, v116, v7
 v_mul_f32 v117, v117, v7
 v_mul_f32 v118, v118, v7
 v_mul_f32 v119, v119, v7
 v_cvt_pk_bf16_f32 v152, v112, v113
 v_cvt_pk_bf16_f32 v153, v114, v115
 v_cvt_pk_bf16_f32 v154, v116, v117
 v_cvt_pk_bf16_f32 v155, v118, v119
 buffer_store_dwordx4 v[152:155], v1, s[4:7], s33 offen sc1
 s_add_u32 s33, s33, s35
 v_mul_f32 v120, v120, v7
 v_mul_f32 v121, v121, v7
 v_mul_f32 v122, v122, v7
 v_mul_f32 v123, v123, v7
 v_mul_f32 v124, v124, v7
 v_mul_f32 v125, v125, v7
 v_mul_f32 v126, v126, v7
 v_mul_f32 v127, v127, v7
 v_cvt_pk_bf16_f32 v156, v120, v121
 v_cvt_pk_bf16_f32 v157, v122, v123
 v_cvt_pk_bf16_f32 v158, v124, v125
 v_cvt_pk_bf16_f32 v159, v126, v127
 buffer_store_dwordx4 v[156:159], v1, s[4:7], s33 offen sc1
 s_add_u32 s33, s33, s35
 s_branch K1C_JOIN
K1C_EXT:
 s_add_u32 s30, s23, 0
 buffer_load_dwordx4 a[0:3], v1, s[4:7], s30 offen offset:0 sc1
 s_add_u32 s30, s23, 0
 buffer_load_dwordx4 a[4:7], v1, s[4:7], s30 offen offset:1024 sc1
 s_add_u32 s30, s23, 0
 buffer_load_dwordx4 a[8:11], v1, s[4:7], s30 offen offset:2048 sc1
 s_add_u32 s30, s23, 0
 buffer_load_dwordx4 a[12:15], v1, s[4:7], s30 offen offset:3072 sc1
 v_and_b32 v12, 15, v0
 v_lshlrev_b32 v12, 3, v12
 v_bfe_u32 v13, v0, 4, 1
 v_lshlrev_b32 v13, 10, v13
 v_add_u32 v12, v12, v13
 buffer_load_dwordx2 v[16:17], v12, s[4:7], s29 offen offset:0 sc1
 buffer_load_dwordx2 v[18:19], v12, s[4:7], s29 offen offset:128 sc1
 buffer_load_dwordx2 v[20:21], v12, s[4:7], s29 offen offset:256 sc1
 buffer_load_dwordx2 v[22:23], v12, s[4:7], s29 offen offset:384 sc1
 buffer_load_dwordx2 v[24:25], v12, s[4:7], s29 offen offset:512 sc1
 buffer_load_dwordx2 v[26:27], v12, s[4:7], s29 offen offset:640 sc1
 buffer_load_dwordx2 v[28:29], v12, s[4:7], s29 offen offset:768 sc1
 buffer_load_dwordx2 v[30:31], v12, s[4:7], s29 offen offset:896 sc1
 s_add_u32 s30, s23, 4096
 buffer_load_dwordx4 a[16:19], v1, s[4:7], s30 offen offset:0 sc1
 s_add_u32 s30, s23, 4096
 buffer_load_dwordx4 a[20:23], v1, s[4:7], s30 offen offset:1024 sc1
 s_add_u32 s30, s23, 4096
 buffer_load_dwordx4 a[24:27], v1, s[4:7], s30 offen offset:2048 sc1
 s_add_u32 s30, s23, 4096
 buffer_load_dwordx4 a[28:31], v1, s[4:7], s30 offen offset:3072 sc1
 s_add_u32 s30, s23, 8192
 buffer_load_dwordx4 a[32:35], v1, s[4:7], s30 offen offset:0 sc1
 s_add_u32 s30, s23, 8192
 buffer_load_dwordx4 a[36:39], v1, s[4:7], s30 offen offset:1024 sc1
 s_barrier
 ds_read_b128 v[32:35], v2 offset:0
 ds_read_b128 v[36:39], v2 offset:37888
 ds_read_b128 v[40:43], v2 offset:1024
 ds_read_b128 v[44:47], v2 offset:38912
 ds_read_b128 v[48:51], v2 offset:2048
 ds_read_b128 v[52:55], v2 offset:39936
 ds_read_b128 v[56:59], v2 offset:3072
 s_waitcnt vmcnt(17) lgkmcnt(6)
 v_mfma_f32_32x32x16_bf16 v[64:79], v[32:35], a[0:3], 0
 s_add_u32 s30, s23, 8192
 buffer_load_dwordx4 a[40:43], v1, s[4:7], s30 offen offset:2048 sc1
 ds_read_b128 v[60:63], v2 offset:40960
 s_waitcnt lgkmcnt(6)
 v_mfma_f32_32x32x16_bf16 v[80:95], v[36:39], a[0:3], 0
 s_add_u32 s30, s23, 8192
 buffer_load_dwordx4 a[44:47], v1, s[4:7], s30 offen offset:3072 sc1
 ds_read_b128 v[32:35], v2 offset:4096
 s_waitcnt vmcnt(18) lgkmcnt(6)
 v_mfma_f32_32x32x16_bf16 v[64:79], v[40:43], a[4:7], v[64:79]
 ds_read_b128 v[36:39], v2 offset:41984
 s_waitcnt lgkmcnt(6)
 v_mfma_f32_32x32x16_bf16 v[80:95], v[44:47], a[4:7], v[80:95]
 s_add_u32 s30, s23, 12288
 buffer_load_dwordx4 a[48:51], v1, s[4:7], s30 offen offset:0 sc1
 ds_read_b128 v[40:43], v2 offset:5120
 s_waitcnt vmcnt(18) lgkmcnt(6)
 v_mfma_f32_32x32x16_bf16 v[64:79], v[48:51], a[8:11], v[64:79]
 s_add_u32 s30, s23, 12288
 buffer_load_dwordx4 a[52:55], v1, s[4:7], s30 offen offset:1024 sc1
 ds_read_b128 v[44:47], v2 offset:43008
 s_waitcnt lgkmcnt(6)
 v_mfma_f32_32x32x16_bf16 v[80:95], v[52:55], a[8:11], v[80:95]
 ds_read_b128 v[48:51], v2 offset:6144
 s_waitcnt vmcnt(18) lgkmcnt(6)
 v_mfma_f32_32x32x16_bf16 v[64:79], v[56:59], a[12:15], v[64:79]
 s_add_u32 s30, s23, 12288
 buffer_load_dwordx4 a[56:59], v1, s[4:7], s30 offen offset:2048 sc1
 s_waitcnt vmcnt(11)
 v_add_f32 v12, v16, v20
 ds_read_b128 v[52:55], v2 offset:44032
 s_waitcnt lgkmcnt(6)
 v_mfma_f32_32x32x16_bf16 v[80:95], v[60:63], a[12:15], v[80:95]
 s_add_u32 s30, s23, 12288
 buffer_load_dwordx4 a[60:63], v1, s[4:7], s30 offen offset:3072 sc1
 v_add_f32 v13, v18, v22
 ds_read_b128 v[56:59], v2 offset:7168
 s_waitcnt vmcnt(11) lgkmcnt(6)
 v_mfma_f32_32x32x16_bf16 v[64:79], v[32:35], a[16:19], v[64:79]
 v_add_f32 v12, v12, v24
 v_add_f32 v13, v13, v26
 v_add_f32 v12, v12, v28
 ds_read_b128 v[60:63], v2 offset:45056
 s_waitcnt lgkmcnt(6)
 v_mfma_f32_32x32x16_bf16 v[80:95], v[36:39], a[16:19], v[80:95]
 s_add_u32 s30, s23, 16384
 buffer_load_dwordx4 a[64:67], v1, s[4:7], s30 offen offset:0 sc1
 v_add_f32 v13, v13, v30
 ds_read_b128 v[32:35], v2 offset:8192
 s_waitcnt vmcnt(11) lgkmcnt(6)
 v_mfma_f32_32x32x16_bf16 v[64:79], v[40:43], a[20:23], v[64:79]
 v_mul_f32 v12, 0x3de38e39, v12
 v_mul_f32 v13, 0x3e0e38e4, v13
 v_add_f32 v5, v12, v13
 ds_read_b128 v[36:39], v2 offset:46080
 s_waitcnt lgkmcnt(6)
 v_mfma_f32_32x32x16_bf16 v[80:95], v[44:47], a[20:23], v[80:95]
 s_add_u32 s30, s23, 16384
 buffer_load_dwordx4 a[68:71], v1, s[4:7], s30 offen offset:1024 sc1
 v_mov_b32 v12, 0
 ds_read_b128 v[40:43], v2 offset:9216
 s_waitcnt vmcnt(11) lgkmcnt(6)
 v_mfma_f32_32x32x16_bf16 v[64:79], v[48:51], a[24:27], v[64:79]
 s_add_u32 s30, s23, 16384
 buffer_load_dwordx4 a[72:75], v1, s[4:7], s30 offen offset:2048 sc1
 v_mov_b32 v13, 0
 ds_read_b128 v[44:47], v2 offset:47104
 s_waitcnt lgkmcnt(6)
 v_mfma_f32_32x32x16_bf16 v[80:95], v[52:55], a[24:27], v[80:95]
 v_sub_f32 v16, v16, v5
 v_fmac_f32 v12, v16, v16
 v_sub_f32 v18, v18, v5
 ds_read_b128 v[48:51], v2 offset:10240
 s_waitcnt vmcnt(11) lgkmcnt(6)
 v_mfma_f32_32x32x16_bf16 v[64:79], v[56:59], a[28:31], v[64:79]
 s_add_u32 s30, s23, 16384
 buffer_load_dwordx4 a[76:79], v1, s[4:7], s30 offen offset:3072 sc1
 v_fmac_f32 v13, v18, v18
 ds_read_b128 v[52:55], v2 offset:48128
 s_waitcnt lgkmcnt(6)
 v_mfma_f32_32x32x16_bf16 v[80:95], v[60:63], a[28:31], v[80:95]
 s_add_u32 s30, s23, 20480
 buffer_load_dwordx4 a[80:83], v1, s[4:7], s30 offen offset:0 sc1
 v_sub_f32 v20, v20, v5
 ds_read_b128 v[56:59], v2 offset:11264
 s_waitcnt vmcnt(12) lgkmcnt(6)
 v_mfma_f32_32x32x16_bf16 v[64:79], v[32:35], a[32:35], v[64:79]
 v_fmac_f32 v12, v20, v20
 v_sub_f32 v22, v22, v5
 v_fmac_f32 v13, v22, v22
 ds_read_b128 v[60:63], v2 offset:49152
 s_waitcnt lgkmcnt(6)
 v_mfma_f32_32x32x16_bf16 v[80:95], v[36:39], a[32:35], v[80:95]
 s_add_u32 s30, s23, 20480
 buffer_load_dwordx4 a[84:87], v1, s[4:7], s30 offen offset:1024 sc1
 v_sub_f32 v24, v24, v5
 ds_read_b128 v[32:35], v2 offset:12288
 s_waitcnt vmcnt(12) lgkmcnt(6)
 v_mfma_f32_32x32x16_bf16 v[64:79], v[40:43], a[36:39], v[64:79]
 v_fmac_f32 v12, v24, v24
 v_sub_f32 v26, v26, v5
 v_fmac_f32 v13, v26, v26
 ds_read_b128 v[36:39], v2 offset:50176
 s_waitcnt lgkmcnt(6)
 v_mfma_f32_32x32x16_bf16 v[80:95], v[44:47], a[36:39], v[80:95]
 s_add_u32 s30, s23, 20480
 buffer_load_dwordx4 a[88:91], v1, s[4:7], s30 offen offset:2048 sc1
 v_sub_f32 v28, v28, v5
 ds_read_b128 v[40:43], v2 offset:13312
 s_waitcnt vmcnt(12) lgkmcnt(6)
 v_mfma_f32_32x32x16_bf16 v[64:79], v[48:51], a[40:43], v[64:79]
 s_add_u32 s30, s23, 20480
 buffer_load_dwordx4 a[92:95], v1, s[4:7], s30 offen offset:3072 sc1
 v_fmac_f32 v12, v28, v28
 ds_read_b128 v[44:47], v2 offset:51200
 s_waitcnt lgkmcnt(6)
 v_mfma_f32_32x32x16_bf16 v[80:95], v[52:55], a[40:43], v[80:95]
 v_sub_f32 v30, v30, v5
 v_fmac_f32 v13, v30, v30
 v_mul_f32 v12, 0x42800000, v12
 ds_read_b128 v[48:51], v2 offset:14336
 s_waitcnt vmcnt(12) lgkmcnt(6)
 v_mfma_f32_32x32x16_bf16 v[64:79], v[56:59], a[44:47], v[64:79]
 s_add_u32 s30, s23, 24576
 buffer_load_dwordx4 a[96:99], v1, s[4:7], s30 offen offset:0 sc1
 v_mul_f32 v13, 0x42a00000, v13
 ds_read_b128 v[52:55], v2 offset:52224
 s_waitcnt lgkmcnt(6)
 v_mfma_f32_32x32x16_bf16 v[80:95], v[60:63], a[44:47], v[80:95]
 s_add_u32 s30, s23, 24576
 buffer_load_dwordx4 a[100:103], v1, s[4:7], s30 offen offset:1024 sc1
 v_add_f32 v12, v12, v13
 ds_read_b128 v[56:59], v2 offset:15360
 s_waitcnt vmcnt(13) lgkmcnt(6)
 v_mfma_f32_32x32x16_bf16 v[64:79], v[32:35], a[48:51], v[64:79]
 v_add_f32 v12, v12, v17
 v_add_f32 v12, v12, v19
 v_add_f32 v12, v12, v21
 ds_read_b128 v[60:63], v2 offset:53248
 s_waitcnt lgkmcnt(6)
 v_mfma_f32_32x32x16_bf16 v[80:95], v[36:39], a[48:51], v[80:95]
 s_add_u32 s30, s23, 24576
 buffer_load_dwordx4 a[104:107], v1, s[4:7], s30 offen offset:2048 sc1
 v_add_f32 v12, v12, v23
 ds_read_b128 v[32:35], v2 offset:16384
 s_waitcnt vmcnt(13) lgkmcnt(6)
 v_mfma_f32_32x32x16_bf16 v[64:79], v[40:43], a[52:55], v[64:79]
 v_add_f32 v12, v12, v25
 v_add_f32 v12, v12, v27
 v_add_f32 v12, v12, v29
 ds_read_b128 v[36:39], v2 offset:54272
 s_waitcnt lgkmcnt(6)
 v_mfma_f32_32x32x16_bf16 v[80:95], v[44:47], a[52:55], v[80:95]
 s_add_u32 s30, s23, 24576
 buffer_load_dwordx4 a[108:111], v1, s[4:7], s30 offen offset:3072 sc1
 v_add_f32 v12, v12, v31
 ds_read_b128 v[40:43], v2 offset:17408
 s_waitcnt vmcnt(13) lgkmcnt(6)
 v_mfma_f32_32x32x16_bf16 v[64:79], v[48:51], a[56:59], v[64:79]
 s_add_u32 s30, s23, 28672
 buffer_load_dwordx4 a[112:115], v1, s[4:7], s30 offen offset:0 sc1
 v_mov_b32 v13, 0x3727c5ac
 ds_read_b128 v[44:47], v2 offset:55296
 s_waitcnt lgkmcnt(6)
 v_mfma_f32_32x32x16_bf16 v[80:95], v[52:55], a[56:59], v[80:95]
 v_mov_b32 v6, 0x3ae38e39
 v_fma_f32 v6, v12, v6, v13
 v_cmp_gt_u32 vcc, 512, v1
 ds_read_b128 v[48:51], v2 offset:18432
 s_waitcnt vmcnt(13) lgkmcnt(6)
 v_mfma_f32_32x32x16_bf16 v[64:79], v[56:59], a[60:63], v[64:79]
 s_add_u32 s30, s23, 28672
 buffer_load_dwordx4 a[116:119], v1, s[4:7], s30 offen offset:1024 sc1
 v_cvt_pk_bf16_f32 v12, v5, v5
 ds_read_b128 v[52:55], v2 offset:56320
 s_waitcnt lgkmcnt(6)
 v_mfma_f32_32x32x16_bf16 v[80:95], v[60:63], a[60:63], v[80:95]
 s_add_u32 s30, s23, 28672
 buffer_load_dwordx4 a[120:123], v1, s[4:7], s30 offen offset:2048 sc1
 v_lshlrev_b32 v12, 16, v12
 ds_read_b128 v[56:59], v2 offset:19456
 s_waitcnt vmcnt(14) lgkmcnt(6)
 v_mfma_f32_32x32x16_bf16 v[64:79], v[32:35], a[64:67], v[64:79]
 v_sub_f32 v14, v5, v12
 v_cvt_pk_bf16_f32 v13, v14, v14
 v_lshlrev_b32 v13, 16, v13
 ds_read_b128 v[60:63], v2 offset:57344
 s_waitcnt lgkmcnt(6)
 v_mfma_f32_32x32x16_bf16 v[80:95], v[36:39], a[64:67], v[80:95]
 s_add_u32 s30, s23, 28672
 buffer_load_dwordx4 a[124:127], v1, s[4:7], s30 offen offset:3072 sc1
 v_sub_f32 v14, v14, v13
 ds_read_b128 v[32:35], v2 offset:20480
 s_waitcnt vmcnt(14) lgkmcnt(6)
 v_mfma_f32_32x32x16_bf16 v[64:79], v[40:43], a[68:71], v[64:79]
 v_cvt_pk_bf16_f32 v8, v12, v12
 v_cvt_pk_bf16_f32 v9, v13, v12
 v_cvt_pk_bf16_f32 v10, v13, v14
 ds_read_b128 v[36:39], v2 offset:58368
 s_waitcnt lgkmcnt(6)
 v_mfma_f32_32x32x16_bf16 v[80:95], v[44:47], a[68:71], v[80:95]
 s_add_u32 s30, s23, 32768
 buffer_load_dwordx4 a[128:131], v1, s[4:7], s30 offen offset:0 sc1
 v_mov_b32 v11, 0
 ds_read_b128 v[40:43], v2 offset:21504
 s_waitcnt vmcnt(14) lgkmcnt(6)
 v_mfma_f32_32x32x16_bf16 v[64:79], v[48:51], a[72:75], v[64:79]
 s_add_u32 s30, s23, 32768
 buffer_load_dwordx4 a[132:135], v1, s[4:7], s30 offen offset:1024 sc1
 v_cndmask_b32 v8, 0, v8, vcc
 ds_read_b128 v[44:47], v2 offset:59392
 s_waitcnt lgkmcnt(6)
 v_mfma_f32_32x32x16_bf16 v[80:95], v[52:55], a[72:75], v[80:95]
 v_cndmask_b32 v9, 0, v9, vcc
 v_cndmask_b32 v10, 0, v10, vcc
 ds_read_b128 v[48:51], v2 offset:22528
 s_waitcnt vmcnt(14) lgkmcnt(6)
 v_mfma_f32_32x32x16_bf16 v[64:79], v[56:59], a[76:79], v[64:79]
 s_add_u32 s30, s23, 32768
 buffer_load_dwordx4 a[136:139], v1, s[4:7], s30 offen offset:2048 sc1
 ds_read_b128 v[52:55], v2 offset:60416
 s_waitcnt lgkmcnt(6)
 v_mfma_f32_32x32x16_bf16 v[80:95], v[60:63], a[76:79], v[80:95]
 s_add_u32 s30, s23, 32768
 buffer_load_dwordx4 a[140:143], v1, s[4:7], s30 offen offset:3072 sc1
 ds_read_b128 v[56:59], v2 offset:23552
 s_waitcnt vmcnt(15) lgkmcnt(6)
 v_mfma_f32_32x32x16_bf16 v[64:79], v[32:35], a[80:83], v[64:79]
 v_rsq_f32 v6, v6
 ds_read_b128 v[60:63], v2 offset:61440
 s_waitcnt lgkmcnt(6)
 v_mfma_f32_32x32x16_bf16 v[80:95], v[36:39], a[80:83], v[80:95]
 ds_read_b128 v[32:35], v2 offset:24576
 s_waitcnt vmcnt(14) lgkmcnt(6)
 v_mfma_f32_32x32x16_bf16 v[64:79], v[40:43], a[84:87], v[64:79]
 ds_read_b128 v[36:39], v2 offset:62464
 s_waitcnt lgkmcnt(6)
 v_mfma_f32_32x32x16_bf16 v[80:95], v[44:47], a[84:87], v[80:95]
 ds_read_b128 v[40:43], v2 offset:25600
 s_waitcnt vmcnt(13) lgkmcnt(6)
 v_mfma_f32_32x32x16_bf16 v[64:79], v[48:51], a[88:91], v[64:79]
 ds_read_b128 v[44:47], v2 offset:63488
 s_waitcnt lgkmcnt(6)
 v_mfma_f32_32x32x16_bf16 v[80:95], v[52:55], a[88:91], v[80:95]
 ds_read_b128 v[48:51], v2 offset:26624
 s_waitcnt vmcnt(12) lgkmcnt(6)
 v_mfma_f32_32x32x16_bf16 v[64:79], v[56:59], a[92:95], v[64:79]
 ds_read_b128 v[52:55], v2 offset:64512
 s_waitcnt lgkmcnt(6)
 v_mfma_f32_32x32x16_bf16 v[80:95], v[60:63], a[92:95], v[80:95]
 ds_read_b128 v[56:59], v2 offset:27648
 s_waitcnt vmcnt(11) lgkmcnt(6)
 v_mfma_f32_32x32x16_bf16 v[64:79], v[32:35], a[96:99], v[64:79]
 ds_read_b128 v[60:63], v3 offset:0
 s_waitcnt lgkmcnt(6)
 v_mfma_f32_32x32x16_bf16 v[80:95], v[36:39], a[96:99], v[80:95]
 ds_read_b128 v[32:35], v2 offset:28672
 s_waitcnt vmcnt(10) lgkmcnt(6)
 v_mfma_f32_32x32x16_bf16 v[64:79], v[40:43], a[100:103], v[64:79]
 ds_read_b128 v[36:39], v3 offset:1024
 s_waitcnt lgkmcnt(6)
 v_mfma_f32_32x32x16_bf16 v[80:95], v[44:47], a[100:103], v[80:95]
 ds_read_b128 v[40:43], v2 offset:29696
 s_waitcnt vmcnt(9) lgkmcnt(6)
 v_mfma_f32_32x32x16_bf16 v[64:79], v[48:51], a[104:107], v[64:79]
 ds_read_b128 v[44:47], v3 offset:2048
 s_waitcnt lgkmcnt(6)
 v_mfma_f32_32x32x16_bf16 v[80:95], v[52:55], a[104:107], v[80:95]
 ds_read_b128 v[48:51], v2 offset:30720
 s_waitcnt vmcnt(8) lgkmcnt(6)
 v_mfma_f32_32x32x16_bf16 v[64:79], v[56:59], a[108:111], v[64:79]
 ds_read_b128 v[52:55], v3 offset:3072
 s_waitcnt lgkmcnt(6)
 v_mfma_f32_32x32x16_bf16 v[80:95], v[60:63], a[108:111], v[80:95]
 ds_read_b128 v[56:59], v2 offset:31744
 s_waitcnt vmcnt(7) lgkmcnt(6)
 v_mfma_f32_32x32x16_bf16 v[64:79], v[32:35], a[112:115], v[64:79]
 ds_read_b128 v[60:63], v3 offset:4096
 s_waitcnt lgkmcnt(6)
 v_mfma_f32_32x32x16_bf16 v[80:95], v[36:39], a[112:115], v[80:95]
 ds_read_b128 v[32:35], v2 offset:32768
 s_waitcnt vmcnt(6) lgkmcnt(6)
 v_mfma_f32_32x32x16_bf16 v[64:79], v[40:43], a[116:119], v[64:79]
 ds_read_b128 v[36:39], v3 offset:5120
 s_waitcnt lgkmcnt(6)
 v_mfma_f32_32x32x16_bf16 v[80:95], v[44:47], a[116:119], v[80:95]
 ds_read_b128 v[40:43], v2 offset:33792
 s_waitcnt vmcnt(5) lgkmcnt(6)
 v_mfma_f32_32x32x16_bf16 v[64:79], v[48:51], a[120:123], v[64:79]
 ds_read_b128 v[44:47], v3 offset:6144
 s_waitcnt lgkmcnt(6)
 v_mfma_f32_32x32x16_bf16 v[80:95], v[52:55], a[120:123], v[80:95]
 ds_read_b128 v[48:51], v2 offset:34816
 s_waitcnt vmcnt(4) lgkmcnt(6)
 v_mfma_f32_32x32x16_bf16 v[64:79], v[56:59], a[124:127], v[64:79]
 ds_read_b128 v[52:55], v3 offset:7168
 s_waitcnt lgkmcnt(6)
 v_mfma_f32_32x32x16_bf16 v[80:95], v[60:63], a[124:127], v[80:95]
 ds_read_b128 v[56:59], v2 offset:35840
 s_waitcnt vmcnt(3) lgkmcnt(6)
 v_mfma_f32_32x32x16_bf16 v[64:79], v[32:35], a[128:131], v[64:79]
 ds_read_b128 v[60:63], v3 offset:8192
 s_waitcnt lgkmcnt(6)
 v_mfma_f32_32x32x16_bf16 v[80:95], v[36:39], a[128:131], v[80:95]
 ds_read_b128 v[32:35], v2 offset:36864
 s_waitcnt vmcnt(2) lgkmcnt(6)
 v_mfma_f32_32x32x16_bf16 v[64:79], v[40:43], a[132:135], v[64:79]
 ds_read_b128 v[36:39], v3 offset:9216
 s_waitcnt lgkmcnt(6)
 v_mfma_f32_32x32x16_bf16 v[80:95], v[44:47], a[132:135], v[80:95]
 s_waitcnt vmcnt(1) lgkmcnt(5)
 v_mfma_f32_32x32x16_bf16 v[64:79], v[48:51], a[136:139], v[64:79]
 s_waitcnt lgkmcnt(4)
 v_mfma_f32_32x32x16_bf16 v[80:95], v[52:55], a[136:139], v[80:95]
 s_waitcnt vmcnt(0) lgkmcnt(3)
 v_mfma_f32_32x32x16_bf16 v[64:79], v[56:59], a[140:143], v[64:79]
 s_waitcnt lgkmcnt(2)
 v_mfma_f32_32x32x16_bf16 v[80:95], v[60:63], a[140:143], v[80:95]
 s_waitcnt lgkmcnt(1)
 v_mfma_f32_32x32x16_bf16 v[64:79], v[32:35], v[8:11], v[64:79]
 s_waitcnt lgkmcnt(0)
 v_mfma_f32_32x32x16_bf16 v[80:95], v[36:39], v[8:11], v[80:95]
 v_and_b32 v12, 31, v0
 v_bfe_u32 v13, v0, 5, 1
 v_lshlrev_b32 v13, 10, v13
 s_cmp_eq_u32 s27, 8
 s_cselect_b32 s32, 2, 4
 s_cselect_b32 s33, 7, 2
 s_mov_b32 s36, 0x3eae1a93
 s_cselect_b32 s36, s36, 1.0
 s_mov_b32 s35, 151552
 s_cselect_b32 s35, 8192, s35
 s_lshl_b32 s34, s86, 9
 s_add_u32 s34, s34, 13107200
 s_add_u32 s34, s34, s100
 s_and_b32 s37, s86, 1
 s_lshl_b32 s37, s37, 9
 s_add_u32 s37, s37, s31
 s_add_u32 s37, s37, 8192
 s_cmp_eq_u32 s27, 8
 s_cselect_b32 s34, s34, s37
 s_lshl_b32 s33, s3, s33
 v_lshlrev_b32 v16, s32, v12
 v_add3_u32 v16, v16, v13, s33
 v_lshlrev_b32 v18, 4, v0
 v_lshrrev_b32 v13, 5, v0
 v_mul_lo_u32 v19, v13, s35
 v_lshlrev_b32 v21, 4, v12
 v_add_u32 v19, v19, v21
 s_lshl_b32 s35, s35, 3
 v_add_u32 v17, 75776, v16
 v_add_u32 v22, 75776, v18
 v_mul_f32 v6, s36, v6
 v_mul_f32 v64, v64, v6
 v_mul_f32 v65, v65, v6
 v_mul_f32 v66, v66, v6
 v_mul_f32 v67, v67, v6
 v_mul_f32 v68, v68, v6
 v_mul_f32 v69, v69, v6
 v_mul_f32 v70, v70, v6
 v_mul_f32 v71, v71, v6
 v_mul_f32 v72, v72, v6
 v_mul_f32 v73, v73, v6
 v_mul_f32 v74, v74, v6
 v_mul_f32 v75, v75, v6
 v_mul_f32 v76, v76, v6
 v_mul_f32 v77, v77, v6
 v_mul_f32 v78, v78, v6
 v_mul_f32 v79, v79, v6
 v_cvt_pk_bf16_f32 v128, v64, v65
 v_cvt_pk_bf16_f32 v129, v66, v67
 v_cvt_pk_bf16_f32 v130, v68, v69
 v_cvt_pk_bf16_f32 v131, v70, v71
 v_cvt_pk_bf16_f32 v132, v72, v73
 v_cvt_pk_bf16_f32 v133, v74, v75
 v_cvt_pk_bf16_f32 v134, v76, v77
 v_cvt_pk_bf16_f32 v135, v78, v79
 ds_write_b32 v17, v128 offset:0
 ds_write_b32 v17, v129 offset:512
 ds_write_b32 v17, v130 offset:2048
 ds_write_b32 v17, v131 offset:2560
 ds_write_b32 v17, v132 offset:4096
 ds_write_b32 v17, v133 offset:4608
 ds_write_b32 v17, v134 offset:6144
 ds_write_b32 v17, v135 offset:6656
 v_mul_f32 v80, v80, v6
 v_mul_f32 v81, v81, v6
 v_mul_f32 v82, v82, v6
 v_mul_f32 v83, v83, v6
 v_mul_f32 v84, v84, v6
 v_mul_f32 v85, v85, v6
 v_mul_f32 v86, v86, v6
 v_mul_f32 v87, v87, v6
 v_mul_f32 v88, v88, v6
 v_mul_f32 v89, v89, v6
 v_mul_f32 v90, v90, v6
 v_mul_f32 v91, v91, v6
 v_mul_f32 v92, v92, v6
 v_mul_f32 v93, v93, v6
 v_mul_f32 v94, v94, v6
 v_mul_f32 v95, v95, v6
 v_cvt_pk_bf16_f32 v136, v80, v81
 v_cvt_pk_bf16_f32 v137, v82, v83
 v_cvt_pk_bf16_f32 v138, v84, v85
 v_cvt_pk_bf16_f32 v139, v86, v87
 v_cvt_pk_bf16_f32 v140, v88, v89
 v_cvt_pk_bf16_f32 v141, v90, v91
 v_cvt_pk_bf16_f32 v142, v92, v93
 v_cvt_pk_bf16_f32 v143, v94, v95
 ds_write_b32 v17, v136 offset:8192
 ds_write_b32 v17, v137 offset:8704
 ds_write_b32 v17, v138 offset:10240
 ds_write_b32 v17, v139 offset:10752
 ds_write_b32 v17, v140 offset:12288
 ds_write_b32 v17, v141 offset:12800
 ds_write_b32 v17, v142 offset:14336
 ds_write_b32 v17, v143 offset:14848
 s_waitcnt lgkmcnt(0)
 s_barrier
 ds_read_b128 v[64:67], v22 offset:0
 ds_read_b128 v[68:71], v22 offset:4096
 ds_read_b128 v[72:75], v22 offset:8192
 ds_read_b128 v[76:79], v22 offset:12288
 s_waitcnt lgkmcnt(3)
 buffer_store_dwordx4 v[64:67], v19, s[4:7], s34 offen sc1
 s_add_u32 s34, s34, s35
 s_waitcnt lgkmcnt(2)
 buffer_store_dwordx4 v[68:71], v19, s[4:7], s34 offen sc1
 s_add_u32 s34, s34, s35
 s_waitcnt lgkmcnt(1)
 buffer_store_dwordx4 v[72:75], v19, s[4:7], s34 offen sc1
 s_add_u32 s34, s34, s35
 s_waitcnt lgkmcnt(0)
 buffer_store_dwordx4 v[76:79], v19, s[4:7], s34 offen sc1
 s_add_u32 s34, s34, s35
 s_branch K1C_JOIN
K1C_V:
 s_add_u32 s30, s23, 0
 buffer_load_dwordx4 a[0:3], v1, s[4:7], s30 offen offset:0 sc1
 s_add_u32 s30, s23, 0
 buffer_load_dwordx4 a[4:7], v1, s[4:7], s30 offen offset:1024 sc1
 s_add_u32 s30, s23, 0
 buffer_load_dwordx4 a[8:11], v1, s[4:7], s30 offen offset:2048 sc1
 s_add_u32 s30, s23, 0
 buffer_load_dwordx4 a[12:15], v1, s[4:7], s30 offen offset:3072 sc1
 v_and_b32 v12, 15, v0
 v_lshlrev_b32 v12, 3, v12
 v_bfe_u32 v13, v0, 4, 1
 v_lshlrev_b32 v13, 10, v13
 v_add_u32 v12, v12, v13
 buffer_load_dwordx2 v[16:17], v12, s[4:7], s29 offen offset:0 sc1
 buffer_load_dwordx2 v[18:19], v12, s[4:7], s29 offen offset:128 sc1
 buffer_load_dwordx2 v[20:21], v12, s[4:7], s29 offen offset:256 sc1
 buffer_load_dwordx2 v[22:23], v12, s[4:7], s29 offen offset:384 sc1
 buffer_load_dwordx2 v[24:25], v12, s[4:7], s29 offen offset:512 sc1
 buffer_load_dwordx2 v[26:27], v12, s[4:7], s29 offen offset:640 sc1
 buffer_load_dwordx2 v[28:29], v12, s[4:7], s29 offen offset:768 sc1
 buffer_load_dwordx2 v[30:31], v12, s[4:7], s29 offen offset:896 sc1
 s_add_u32 s30, s23, 4096
 buffer_load_dwordx4 a[16:19], v1, s[4:7], s30 offen offset:0 sc1
 s_add_u32 s30, s23, 4096
 buffer_load_dwordx4 a[20:23], v1, s[4:7], s30 offen offset:1024 sc1
 s_add_u32 s30, s23, 4096
 buffer_load_dwordx4 a[24:27], v1, s[4:7], s30 offen offset:2048 sc1
 s_add_u32 s30, s23, 4096
 buffer_load_dwordx4 a[28:31], v1, s[4:7], s30 offen offset:3072 sc1
 s_add_u32 s30, s23, 8192
 buffer_load_dwordx4 a[32:35], v1, s[4:7], s30 offen offset:0 sc1
 s_add_u32 s30, s23, 8192
 buffer_load_dwordx4 a[36:39], v1, s[4:7], s30 offen offset:1024 sc1
 s_barrier
 ds_read_b128 v[32:35], v2 offset:0
 ds_read_b128 v[36:39], v2 offset:37888
 ds_read_b128 v[40:43], v3 offset:10240
 ds_read_b128 v[44:47], v2 offset:1024
 ds_read_b128 v[48:51], v2 offset:38912
 ds_read_b128 v[52:55], v3 offset:11264
 ds_read_b128 v[56:59], v2 offset:2048
 s_waitcnt vmcnt(17) lgkmcnt(6)
 v_mfma_f32_32x32x16_bf16 v[64:79], a[0:3], v[32:35], 0
 s_add_u32 s30, s23, 8192
 buffer_load_dwordx4 a[40:43], v1, s[4:7], s30 offen offset:2048 sc1
 ds_read_b128 v[60:63], v2 offset:39936
 s_waitcnt lgkmcnt(6)
 v_mfma_f32_32x32x16_bf16 v[80:95], a[0:3], v[36:39], 0
 ds_read_b128 v[32:35], v3 offset:12288
 s_waitcnt lgkmcnt(6)
 v_mfma_f32_32x32x16_bf16 v[96:111], a[0:3], v[40:43], 0
 s_add_u32 s30, s23, 8192
 buffer_load_dwordx4 a[44:47], v1, s[4:7], s30 offen offset:3072 sc1
 ds_read_b128 v[36:39], v2 offset:3072
 s_waitcnt vmcnt(18) lgkmcnt(6)
 v_mfma_f32_32x32x16_bf16 v[64:79], a[4:7], v[44:47], v[64:79]
 ds_read_b128 v[40:43], v2 offset:40960
 s_waitcnt lgkmcnt(6)
 v_mfma_f32_32x32x16_bf16 v[80:95], a[4:7], v[48:51], v[80:95]
 s_add_u32 s30, s23, 12288
 buffer_load_dwordx4 a[48:51], v1, s[4:7], s30 offen offset:0 sc1
 ds_read_b128 v[44:47], v3 offset:13312
 s_waitcnt lgkmcnt(6)
 v_mfma_f32_32x32x16_bf16 v[96:111], a[4:7], v[52:55], v[96:111]
 ds_read_b128 v[48:51], v2 offset:4096
 s_waitcnt vmcnt(18) lgkmcnt(6)
 v_mfma_f32_32x32x16_bf16 v[64:79], a[8:11], v[56:59], v[64:79]
 ds_read_b128 v[52:55], v2 offset:41984
 s_waitcnt lgkmcnt(6)
 v_mfma_f32_32x32x16_bf16 v[80:95], a[8:11], v[60:63], v[80:95]
 s_add_u32 s30, s23, 12288
 buffer_load_dwordx4 a[52:55], v1, s[4:7], s30 offen offset:1024 sc1
 ds_read_b128 v[56:59], v3 offset:14336
 s_waitcnt lgkmcnt(6)
 v_mfma_f32_32x32x16_bf16 v[96:111], a[8:11], v[32:35], v[96:111]
 ds_read_b128 v[60:63], v2 offset:5120
 s_waitcnt vmcnt(18) lgkmcnt(6)
 v_mfma_f32_32x32x16_bf16 v[64:79], a[12:15], v[36:39], v[64:79]
 s_add_u32 s30, s23, 12288
 buffer_load_dwordx4 a[56:59], v1, s[4:7], s30 offen offset:2048 sc1
 s_waitcnt vmcnt(11)
 v_add_f32 v12, v16, v20
 ds_read_b128 v[32:35], v2 offset:43008
 s_waitcnt lgkmcnt(6)
 v_mfma_f32_32x32x16_bf16 v[80:95], a[12:15], v[40:43], v[80:95]
 v_add_f32 v13, v18, v22
 v_add_f32 v12, v12, v24
 v_add_f32 v13, v13, v26
 ds_read_b128 v[36:39], v3 offset:15360
 s_waitcnt lgkmcnt(6)
 v_mfma_f32_32x32x16_bf16 v[96:111], a[12:15], v[44:47], v[96:111]
 v_add_f32 v12, v12, v28
 v_add_f32 v13, v13, v30
 v_mul_f32 v12, 0x3de38e39, v12
 ds_read_b128 v[40:43], v2 offset:6144
 s_waitcnt vmcnt(10) lgkmcnt(6)
 v_mfma_f32_32x32x16_bf16 v[64:79], a[16:19], v[48:51], v[64:79]
 s_add_u32 s30, s23, 12288
 buffer_load_dwordx4 a[60:63], v1, s[4:7], s30 offen offset:3072 sc1
 v_mul_f32 v13, 0x3e0e38e4, v13
 ds_read_b128 v[44:47], v2 offset:44032
 s_waitcnt lgkmcnt(6)
 v_mfma_f32_32x32x16_bf16 v[80:95], a[16:19], v[52:55], v[80:95]
 v_add_f32 v5, v12, v13
 v_mov_b32 v12, 0
 v_mov_b32 v13, 0
 ds_read_b128 v[48:51], v3 offset:16384
 s_waitcnt lgkmcnt(6)
 v_mfma_f32_32x32x16_bf16 v[96:111], a[16:19], v[56:59], v[96:111]
 s_add_u32 s30, s23, 16384
 buffer_load_dwordx4 a[64:67], v1, s[4:7], s30 offen offset:0 sc1
 v_sub_f32 v16, v16, v5
 ds_read_b128 v[52:55], v2 offset:7168
 s_waitcnt vmcnt(11) lgkmcnt(6)
 v_mfma_f32_32x32x16_bf16 v[64:79], a[20:23], v[60:63], v[64:79]
 v_fmac_f32 v12, v16, v16
 v_sub_f32 v18, v18, v5
 v_fmac_f32 v13, v18, v18
 ds_read_b128 v[56:59], v2 offset:45056
 s_waitcnt lgkmcnt(6)
 v_mfma_f32_32x32x16_bf16 v[80:95], a[20:23], v[32:35], v[80:95]
 s_add_u32 s30, s23, 16384
 buffer_load_dwordx4 a[68:71], v1, s[4:7], s30 offen offset:1024 sc1
 v_sub_f32 v20, v20, v5
 ds_read_b128 v[60:63], v3 offset:17408
 s_waitcnt lgkmcnt(6)
 v_mfma_f32_32x32x16_bf16 v[96:111], a[20:23], v[36:39], v[96:111]
 v_fmac_f32 v12, v20, v20
 v_sub_f32 v22, v22, v5
 v_fmac_f32 v13, v22, v22
 ds_read_b128 v[32:35], v2 offset:8192
 s_waitcnt vmcnt(11) lgkmcnt(6)
 v_mfma_f32_32x32x16_bf16 v[64:79], a[24:27], v[40:43], v[64:79]
 v_sub_f32 v24, v24, v5
 v_fmac_f32 v12, v24, v24
 v_sub_f32 v26, v26, v5
 ds_read_b128 v[36:39], v2 offset:46080
 s_waitcnt lgkmcnt(6)
 v_mfma_f32_32x32x16_bf16 v[80:95], a[24:27], v[44:47], v[80:95]
 s_add_u32 s30, s23, 16384
 buffer_load_dwordx4 a[72:75], v1, s[4:7], s30 offen offset:2048 sc1
 v_fmac_f32 v13, v26, v26
 ds_read_b128 v[40:43], v3 offset:18432
 s_waitcnt lgkmcnt(6)
 v_mfma_f32_32x32x16_bf16 v[96:111], a[24:27], v[48:51], v[96:111]
 v_sub_f32 v28, v28, v5
 v_fmac_f32 v12, v28, v28
 v_sub_f32 v30, v30, v5
 ds_read_b128 v[44:47], v2 offset:9216
 s_waitcnt vmcnt(11) lgkmcnt(6)
 v_mfma_f32_32x32x16_bf16 v[64:79], a[28:31], v[52:55], v[64:79]
 s_add_u32 s30, s23, 16384
 buffer_load_dwordx4 a[76:79], v1, s[4:7], s30 offen offset:3072 sc1
 v_fmac_f32 v13, v30, v30
 ds_read_b128 v[48:51], v2 offset:47104
 s_waitcnt lgkmcnt(6)
 v_mfma_f32_32x32x16_bf16 v[80:95], a[28:31], v[56:59], v[80:95]
 v_mul_f32 v12, 0x42800000, v12
 v_mul_f32 v13, 0x42a00000, v13
 v_add_f32 v12, v12, v13
 ds_read_b128 v[52:55], v3 offset:19456
 s_waitcnt lgkmcnt(6)
 v_mfma_f32_32x32x16_bf16 v[96:111], a[28:31], v[60:63], v[96:111]
 v_add_f32 v12, v12, v17
 v_add_f32 v12, v12, v19
 v_add_f32 v12, v12, v21
 ds_read_b128 v[56:59], v2 offset:10240
 s_waitcnt vmcnt(11) lgkmcnt(6)
 v_mfma_f32_32x32x16_bf16 v[64:79], a[32:35], v[32:35], v[64:79]
 s_add_u32 s30, s23, 20480
 buffer_load_dwordx4 a[80:83], v1, s[4:7], s30 offen offset:0 sc1
 v_add_f32 v12, v12, v23
 ds_read_b128 v[60:63], v2 offset:48128
 s_waitcnt lgkmcnt(6)
 v_mfma_f32_32x32x16_bf16 v[80:95], a[32:35], v[36:39], v[80:95]
 v_add_f32 v12, v12, v25
 v_add_f32 v12, v12, v27
 v_add_f32 v12, v12, v29
 ds_read_b128 v[32:35], v3 offset:20480
 s_waitcnt lgkmcnt(6)
 v_mfma_f32_32x32x16_bf16 v[96:111], a[32:35], v[40:43], v[96:111]
 s_add_u32 s30, s23, 20480
 buffer_load_dwordx4 a[84:87], v1, s[4:7], s30 offen offset:1024 sc1
 v_add_f32 v12, v12, v31
 ds_read_b128 v[36:39], v2 offset:11264
 s_waitcnt vmcnt(12) lgkmcnt(6)
 v_mfma_f32_32x32x16_bf16 v[64:79], a[36:39], v[44:47], v[64:79]
 v_mov_b32 v13, 0x3727c5ac
 v_mov_b32 v6, 0x3ae38e39
 v_fma_f32 v6, v12, v6, v13
 ds_read_b128 v[40:43], v2 offset:49152
 s_waitcnt lgkmcnt(6)
 v_mfma_f32_32x32x16_bf16 v[80:95], a[36:39], v[48:51], v[80:95]
 s_add_u32 s30, s23, 20480
 buffer_load_dwordx4 a[88:91], v1, s[4:7], s30 offen offset:2048 sc1
 v_cmp_gt_u32 vcc, 512, v1
 ds_read_b128 v[44:47], v3 offset:21504
 s_waitcnt lgkmcnt(6)
 v_mfma_f32_32x32x16_bf16 v[96:111], a[36:39], v[52:55], v[96:111]
 v_cvt_pk_bf16_f32 v12, v5, v5
 v_lshlrev_b32 v12, 16, v12
 v_sub_f32 v14, v5, v12
 ds_read_b128 v[48:51], v2 offset:12288
 s_waitcnt vmcnt(12) lgkmcnt(6)
 v_mfma_f32_32x32x16_bf16 v[64:79], a[40:43], v[56:59], v[64:79]
 v_cvt_pk_bf16_f32 v13, v14, v14
 v_lshlrev_b32 v13, 16, v13
 v_sub_f32 v14, v14, v13
 ds_read_b128 v[52:55], v2 offset:50176
 s_waitcnt lgkmcnt(6)
 v_mfma_f32_32x32x16_bf16 v[80:95], a[40:43], v[60:63], v[80:95]
 s_add_u32 s30, s23, 20480
 buffer_load_dwordx4 a[92:95], v1, s[4:7], s30 offen offset:3072 sc1
 v_cvt_pk_bf16_f32 v8, v12, v12
 ds_read_b128 v[56:59], v3 offset:22528
 s_waitcnt lgkmcnt(6)
 v_mfma_f32_32x32x16_bf16 v[96:111], a[40:43], v[32:35], v[96:111]
 v_cvt_pk_bf16_f32 v9, v13, v12
 v_cvt_pk_bf16_f32 v10, v13, v14
 v_mov_b32 v11, 0
 ds_read_b128 v[60:63], v2 offset:13312
 s_waitcnt vmcnt(12) lgkmcnt(6)
 v_mfma_f32_32x32x16_bf16 v[64:79], a[44:47], v[36:39], v[64:79]
 s_add_u32 s30, s23, 24576
 buffer_load_dwordx4 a[96:99], v1, s[4:7], s30 offen offset:0 sc1
 v_cndmask_b32 v8, 0, v8, vcc
 ds_read_b128 v[32:35], v2 offset:51200
 s_waitcnt lgkmcnt(6)
 v_mfma_f32_32x32x16_bf16 v[80:95], a[44:47], v[40:43], v[80:95]
 v_cndmask_b32 v9, 0, v9, vcc
 v_cndmask_b32 v10, 0, v10, vcc
 ds_read_b128 v[36:39], v3 offset:23552
 s_waitcnt lgkmcnt(6)
 v_mfma_f32_32x32x16_bf16 v[96:111], a[44:47], v[44:47], v[96:111]
 v_rsq_f32 v6, v6
 ds_read_b128 v[40:43], v2 offset:14336
 s_waitcnt vmcnt(12) lgkmcnt(6)
 v_mfma_f32_32x32x16_bf16 v[64:79], a[48:51], v[48:51], v[64:79]
 s_add_u32 s30, s23, 24576
 buffer_load_dwordx4 a[100:103], v1, s[4:7], s30 offen offset:1024 sc1
 ds_read_b128 v[44:47], v2 offset:52224
 s_waitcnt lgkmcnt(6)
 v_mfma_f32_32x32x16_bf16 v[80:95], a[48:51], v[52:55], v[80:95]
 ds_read_b128 v[48:51], v3 offset:24576
 s_waitcnt lgkmcnt(6)
 v_mfma_f32_32x32x16_bf16 v[96:111], a[48:51], v[56:59], v[96:111]
 s_add_u32 s30, s23, 24576
 buffer_load_dwordx4 a[104:107], v1, s[4:7], s30 offen offset:2048 sc1
 ds_read_b128 v[52:55], v2 offset:15360
 s_waitcnt vmcnt(13) lgkmcnt(6)
 v_mfma_f32_32x32x16_bf16 v[64:79], a[52:55], v[60:63], v[64:79]
 ds_read_b128 v[56:59], v2 offset:53248
 s_waitcnt lgkmcnt(6)
 v_mfma_f32_32x32x16_bf16 v[80:95], a[52:55], v[32:35], v[80:95]
 s_add_u32 s30, s23, 24576
 buffer_load_dwordx4 a[108:111], v1, s[4:7], s30 offen offset:3072 sc1
 ds_read_b128 v[60:63], v3 offset:25600
 s_waitcnt lgkmcnt(6)
 v_mfma_f32_32x32x16_bf16 v[96:111], a[52:55], v[36:39], v[96:111]
 ds_read_b128 v[32:35], v2 offset:16384
 s_waitcnt vmcnt(13) lgkmcnt(6)
 v_mfma_f32_32x32x16_bf16 v[64:79], a[56:59], v[40:43], v[64:79]
 ds_read_b128 v[36:39], v2 offset:54272
 s_waitcnt lgkmcnt(6)
 v_mfma_f32_32x32x16_bf16 v[80:95], a[56:59], v[44:47], v[80:95]
 s_add_u32 s30, s23, 28672
 buffer_load_dwordx4 a[112:115], v1, s[4:7], s30 offen offset:0 sc1
 ds_read_b128 v[40:43], v3 offset:26624
 s_waitcnt lgkmcnt(6)
 v_mfma_f32_32x32x16_bf16 v[96:111], a[56:59], v[48:51], v[96:111]
 ds_read_b128 v[44:47], v2 offset:17408
 s_waitcnt vmcnt(13) lgkmcnt(6)
 v_mfma_f32_32x32x16_bf16 v[64:79], a[60:63], v[52:55], v[64:79]
 s_add_u32 s30, s23, 28672
 buffer_load_dwordx4 a[116:119], v1, s[4:7], s30 offen offset:1024 sc1
 ds_read_b128 v[48:51], v2 offset:55296
 s_waitcnt lgkmcnt(6)
 v_mfma_f32_32x32x16_bf16 v[80:95], a[60:63], v[56:59], v[80:95]
 ds_read_b128 v[52:55], v3 offset:27648
 s_waitcnt lgkmcnt(6)
 v_mfma_f32_32x32x16_bf16 v[96:111], a[60:63], v[60:63], v[96:111]
 ds_read_b128 v[56:59], v2 offset:18432
 s_waitcnt vmcnt(13) lgkmcnt(6)
 v_mfma_f32_32x32x16_bf16 v[64:79], a[64:67], v[32:35], v[64:79]
 s_add_u32 s30, s23, 28672
 buffer_load_dwordx4 a[120:123], v1, s[4:7], s30 offen offset:2048 sc1
 ds_read_b128 v[60:63], v2 offset:56320
 s_waitcnt lgkmcnt(6)
 v_mfma_f32_32x32x16_bf16 v[80:95], a[64:67], v[36:39], v[80:95]
 ds_read_b128 v[32:35], v3 offset:28672
 s_waitcnt lgkmcnt(6)
 v_mfma_f32_32x32x16_bf16 v[96:111], a[64:67], v[40:43], v[96:111]
 s_add_u32 s30, s23, 28672
 buffer_load_dwordx4 a[124:127], v1, s[4:7], s30 offen offset:3072 sc1
 ds_read_b128 v[36:39], v2 offset:19456
 s_waitcnt vmcnt(14) lgkmcnt(6)
 v_mfma_f32_32x32x16_bf16 v[64:79], a[68:71], v[44:47], v[64:79]
 ds_read_b128 v[40:43], v2 offset:57344
 s_waitcnt lgkmcnt(6)
 v_mfma_f32_32x32x16_bf16 v[80:95], a[68:71], v[48:51], v[80:95]
 s_add_u32 s30, s23, 32768
 buffer_load_dwordx4 a[128:131], v1, s[4:7], s30 offen offset:0 sc1
 ds_read_b128 v[44:47], v3 offset:29696
 s_waitcnt lgkmcnt(6)
 v_mfma_f32_32x32x16_bf16 v[96:111], a[68:71], v[52:55], v[96:111]
 ds_read_b128 v[48:51], v2 offset:20480
 s_waitcnt vmcnt(14) lgkmcnt(6)
 v_mfma_f32_32x32x16_bf16 v[64:79], a[72:75], v[56:59], v[64:79]
 ds_read_b128 v[52:55], v2 offset:58368
 s_waitcnt lgkmcnt(6)
 v_mfma_f32_32x32x16_bf16 v[80:95], a[72:75], v[60:63], v[80:95]
 s_add_u32 s30, s23, 32768
 buffer_load_dwordx4 a[132:135], v1, s[4:7], s30 offen offset:1024 sc1
 ds_read_b128 v[56:59], v3 offset:30720
 s_waitcnt lgkmcnt(6)
 v_mfma_f32_32x32x16_bf16 v[96:111], a[72:75], v[32:35], v[96:111]
 ds_read_b128 v[60:63], v2 offset:21504
 s_waitcnt vmcnt(14) lgkmcnt(6)
 v_mfma_f32_32x32x16_bf16 v[64:79], a[76:79], v[36:39], v[64:79]
 s_add_u32 s30, s23, 32768
 buffer_load_dwordx4 a[136:139], v1, s[4:7], s30 offen offset:2048 sc1
 ds_read_b128 v[32:35], v2 offset:59392
 s_waitcnt lgkmcnt(6)
 v_mfma_f32_32x32x16_bf16 v[80:95], a[76:79], v[40:43], v[80:95]
 ds_read_b128 v[36:39], v3 offset:31744
 s_waitcnt lgkmcnt(6)
 v_mfma_f32_32x32x16_bf16 v[96:111], a[76:79], v[44:47], v[96:111]
 ds_read_b128 v[40:43], v2 offset:22528
 s_waitcnt vmcnt(14) lgkmcnt(6)
 v_mfma_f32_32x32x16_bf16 v[64:79], a[80:83], v[48:51], v[64:79]
 s_add_u32 s30, s23, 32768
 buffer_load_dwordx4 a[140:143], v1, s[4:7], s30 offen offset:3072 sc1
 ds_read_b128 v[44:47], v2 offset:60416
 s_waitcnt lgkmcnt(6)
 v_mfma_f32_32x32x16_bf16 v[80:95], a[80:83], v[52:55], v[80:95]
 ds_read_b128 v[48:51], v3 offset:32768
 s_waitcnt lgkmcnt(6)
 v_mfma_f32_32x32x16_bf16 v[96:111], a[80:83], v[56:59], v[96:111]
 ds_read_b128 v[52:55], v2 offset:23552
 s_waitcnt vmcnt(14) lgkmcnt(6)
 v_mfma_f32_32x32x16_bf16 v[64:79], a[84:87], v[60:63], v[64:79]
 ds_read_b128 v[56:59], v2 offset:61440
 s_waitcnt lgkmcnt(6)
 v_mfma_f32_32x32x16_bf16 v[80:95], a[84:87], v[32:35], v[80:95]
 ds_read_b128 v[60:63], v3 offset:33792
 s_waitcnt lgkmcnt(6)
 v_mfma_f32_32x32x16_bf16 v[96:111], a[84:87], v[36:39], v[96:111]
 ds_read_b128 v[32:35], v2 offset:24576
 s_waitcnt vmcnt(13) lgkmcnt(6)
 v_mfma_f32_32x32x16_bf16 v[64:79], a[88:91], v[40:43], v[64:79]
 ds_read_b128 v[36:39], v2 offset:62464
 s_waitcnt lgkmcnt(6)
 v_mfma_f32_32x32x16_bf16 v[80:95], a[88:91], v[44:47], v[80:95]
 ds_read_b128 v[40:43], v3 offset:34816
 s_waitcnt lgkmcnt(6)
 v_mfma_f32_32x32x16_bf16 v[96:111], a[88:91], v[48:51], v[96:111]
 ds_read_b128 v[44:47], v2 offset:25600
 s_waitcnt vmcnt(12) lgkmcnt(6)
 v_mfma_f32_32x32x16_bf16 v[64:79], a[92:95], v[52:55], v[64:79]
 ds_read_b128 v[48:51], v2 offset:63488
 s_waitcnt lgkmcnt(6)
 v_mfma_f32_32x32x16_bf16 v[80:95], a[92:95], v[56:59], v[80:95]
 ds_read_b128 v[52:55], v3 offset:35840
 s_waitcnt lgkmcnt(6)
 v_mfma_f32_32x32x16_bf16 v[96:111], a[92:95], v[60:63], v[96:111]
 ds_read_b128 v[56:59], v2 offset:26624
 s_waitcnt vmcnt(11) lgkmcnt(6)
 v_mfma_f32_32x32x16_bf16 v[64:79], a[96:99], v[32:35], v[64:79]
 ds_read_b128 v[60:63], v2 offset:64512
 s_waitcnt lgkmcnt(6)
 v_mfma_f32_32x32x16_bf16 v[80:95], a[96:99], v[36:39], v[80:95]
 ds_read_b128 v[32:35], v3 offset:36864
 s_waitcnt lgkmcnt(6)
 v_mfma_f32_32x32x16_bf16 v[96:111], a[96:99], v[40:43], v[96:111]
 ds_read_b128 v[36:39], v2 offset:27648
 s_waitcnt vmcnt(10) lgkmcnt(6)
 v_mfma_f32_32x32x16_bf16 v[64:79], a[100:103], v[44:47], v[64:79]
 ds_read_b128 v[40:43], v3 offset:0
 s_waitcnt lgkmcnt(6)
 v_mfma_f32_32x32x16_bf16 v[80:95], a[100:103], v[48:51], v[80:95]
 ds_read_b128 v[44:47], v3 offset:37888
 s_waitcnt lgkmcnt(6)
 v_mfma_f32_32x32x16_bf16 v[96:111], a[100:103], v[52:55], v[96:111]
 ds_read_b128 v[48:51], v2 offset:28672
 s_waitcnt vmcnt(9) lgkmcnt(6)
 v_mfma_f32_32x32x16_bf16 v[64:79], a[104:107], v[56:59], v[64:79]
 ds_read_b128 v[52:55], v3 offset:1024
 s_waitcnt lgkmcnt(6)
 v_mfma_f32_32x32x16_bf16 v[80:95], a[104:107], v[60:63], v[80:95]
 ds_read_b128 v[56:59], v3 offset:38912
 s_waitcnt lgkmcnt(6)
 v_mfma_f32_32x32x16_bf16 v[96:111], a[104:107], v[32:35], v[96:111]
 ds_read_b128 v[60:63], v2 offset:29696
 s_waitcnt vmcnt(8) lgkmcnt(6)
 v_mfma_f32_32x32x16_bf16 v[64:79], a[108:111], v[36:39], v[64:79]
 ds_read_b128 v[32:35], v3 offset:2048
 s_waitcnt lgkmcnt(6)
 v_mfma_f32_32x32x16_bf16 v[80:95], a[108:111], v[40:43], v[80:95]
 ds_read_b128 v[36:39], v3 offset:39936
 s_waitcnt lgkmcnt(6)
 v_mfma_f32_32x32x16_bf16 v[96:111], a[108:111], v[44:47], v[96:111]
 ds_read_b128 v[40:43], v2 offset:30720
 s_waitcnt vmcnt(7) lgkmcnt(6)
 v_mfma_f32_32x32x16_bf16 v[64:79], a[112:115], v[48:51], v[64:79]
 ds_read_b128 v[44:47], v3 offset:3072
 s_waitcnt lgkmcnt(6)
 v_mfma_f32_32x32x16_bf16 v[80:95], a[112:115], v[52:55], v[80:95]
 ds_read_b128 v[48:51], v3 offset:40960
 s_waitcnt lgkmcnt(6)
 v_mfma_f32_32x32x16_bf16 v[96:111], a[112:115], v[56:59], v[96:111]
 ds_read_b128 v[52:55], v2 offset:31744
 s_waitcnt vmcnt(6) lgkmcnt(6)
 v_mfma_f32_32x32x16_bf16 v[64:79], a[116:119], v[60:63], v[64:79]
 ds_read_b128 v[56:59], v3 offset:4096
 s_waitcnt lgkmcnt(6)
 v_mfma_f32_32x32x16_bf16 v[80:95], a[116:119], v[32:35], v[80:95]
 ds_read_b128 v[60:63], v3 offset:41984
 s_waitcnt lgkmcnt(6)
 v_mfma_f32_32x32x16_bf16 v[96:111], a[116:119], v[36:39], v[96:111]
 ds_read_b128 v[32:35], v2 offset:32768
 s_waitcnt vmcnt(5) lgkmcnt(6)
 v_mfma_f32_32x32x16_bf16 v[64:79], a[120:123], v[40:43], v[64:79]
 ds_read_b128 v[36:39], v3 offset:5120
 s_waitcnt lgkmcnt(6)
 v_mfma_f32_32x32x16_bf16 v[80:95], a[120:123], v[44:47], v[80:95]
 ds_read_b128 v[40:43], v3 offset:43008
 s_waitcnt lgkmcnt(6)
 v_mfma_f32_32x32x16_bf16 v[96:111], a[120:123], v[48:51], v[96:111]
 ds_read_b128 v[44:47], v2 offset:33792
 s_waitcnt vmcnt(4) lgkmcnt(6)
 v_mfma_f32_32x32x16_bf16 v[64:79], a[124:127], v[52:55], v[64:79]
 ds_read_b128 v[48:51], v3 offset:6144
 s_waitcnt lgkmcnt(6)
 v_mfma_f32_32x32x16_bf16 v[80:95], a[124:127], v[56:59], v[80:95]
 ds_read_b128 v[52:55], v3 offset:44032
 s_waitcnt lgkmcnt(6)
 v_mfma_f32_32x32x16_bf16 v[96:111], a[124:127], v[60:63], v[96:111]
 ds_read_b128 v[56:59], v2 offset:34816
 s_waitcnt vmcnt(3) lgkmcnt(6)
 v_mfma_f32_32x32x16_bf16 v[64:79], a[128:131], v[32:35], v[64:79]
 ds_read_b128 v[60:63], v3 offset:7168
 s_waitcnt lgkmcnt(6)
 v_mfma_f32_32x32x16_bf16 v[80:95], a[128:131], v[36:39], v[80:95]
 ds_read_b128 v[32:35], v3 offset:45056
 s_waitcnt lgkmcnt(6)
 v_mfma_f32_32x32x16_bf16 v[96:111], a[128:131], v[40:43], v[96:111]
 ds_read_b128 v[36:39], v2 offset:35840
 s_waitcnt vmcnt(2) lgkmcnt(6)
 v_mfma_f32_32x32x16_bf16 v[64:79], a[132:135], v[44:47], v[64:79]
 ds_read_b128 v[40:43], v3 offset:8192
 s_waitcnt lgkmcnt(6)
 v_mfma_f32_32x32x16_bf16 v[80:95], a[132:135], v[48:51], v[80:95]
 ds_read_b128 v[44:47], v3 offset:46080
 s_waitcnt lgkmcnt(6)
 v_mfma_f32_32x32x16_bf16 v[96:111], a[132:135], v[52:55], v[96:111]
 ds_read_b128 v[48:51], v2 offset:36864
 s_waitcnt vmcnt(1) lgkmcnt(6)
 v_mfma_f32_32x32x16_bf16 v[64:79], a[136:139], v[56:59], v[64:79]
 ds_read_b128 v[52:55], v3 offset:9216
 s_waitcnt lgkmcnt(6)
 v_mfma_f32_32x32x16_bf16 v[80:95], a[136:139], v[60:63], v[80:95]
 ds_read_b128 v[56:59], v3 offset:47104
 s_waitcnt lgkmcnt(6)
 v_mfma_f32_32x32x16_bf16 v[96:111], a[136:139], v[32:35], v[96:111]
 s_waitcnt vmcnt(0) lgkmcnt(5)
 v_mfma_f32_32x32x16_bf16 v[64:79], a[140:143], v[36:39], v[64:79]
 s_waitcnt lgkmcnt(4)
 v_mfma_f32_32x32x16_bf16 v[80:95], a[140:143], v[40:43], v[80:95]
 s_waitcnt lgkmcnt(3)
 v_mfma_f32_32x32x16_bf16 v[96:111], a[140:143], v[44:47], v[96:111]
 s_waitcnt lgkmcnt(2)
 v_mfma_f32_32x32x16_bf16 v[64:79], v[8:11], v[48:51], v[64:79]
 s_waitcnt lgkmcnt(1)
 v_mfma_f32_32x32x16_bf16 v[80:95], v[8:11], v[52:55], v[80:95]
 s_waitcnt lgkmcnt(0)
 v_mfma_f32_32x32x16_bf16 v[96:111], v[8:11], v[56:59], v[96:111]
 v_and_b32 v12, 31, v0
 v_lshlrev_b32 v13, 2, v12
 s_lshl_b32 s32, s3, 7
 s_add_u32 s32, s32, 151552
 v_add_u32 v13, s32, v13
 ds_write_b32 v13, v6
 v_bfe_u32 v14, v0, 5, 1
 v_lshlrev_b32 v13, 4, v14
 v_add_u32 v13, s32, v13
 s_waitcnt lgkmcnt(0)
 ds_read_b128 v[16:19], v13 offset:0
 ds_read_b128 v[20:23], v13 offset:32
 ds_read_b128 v[24:27], v13 offset:64
 ds_read_b128 v[28:31], v13 offset:96
 s_sub_u32 s32, s27, 9
 s_mul_i32 s32, s32, 96
 v_add_u32 v12, s32, v12
 v_mul_u32_u24 v14, 304, v14
 s_and_b32 s33, s26, 7
 s_mul_i32 s33, s33, 1216
 s_add_u32 s33, s33, s31
 s_add_u32 s33, s33, 9216
 s_mov_b32 s34, 151552
 s_waitcnt lgkmcnt(0)
 v_mul_u32_u24 v13, 3641, v12
 v_lshrrev_b32 v13, 16, v13
 v_mul_u32_u24 v15, 18, v13
 v_sub_u32 v15, v12, v15
 v_mul_lo_u32 v13, v13, s34
 v_lshlrev_b32 v15, 4, v15
 v_add3_u32 v7, v13, v15, v14
 v_add_u32 v12, 32, v12
 v_mul_f32 v64, v64, v16
 v_mul_f32 v65, v65, v17
 v_mul_f32 v66, v66, v18
 v_mul_f32 v67, v67, v19
 v_mul_f32 v68, v68, v20
 v_mul_f32 v69, v69, v21
 v_mul_f32 v70, v70, v22
 v_mul_f32 v71, v71, v23
 v_mul_f32 v72, v72, v24
 v_mul_f32 v73, v73, v25
 v_mul_f32 v74, v74, v26
 v_mul_f32 v75, v75, v27
 v_mul_f32 v76, v76, v28
 v_mul_f32 v77, v77, v29
 v_mul_f32 v78, v78, v30
 v_mul_f32 v79, v79, v31
 v_cvt_pk_bf16_f32 v128, v64, v65
 v_cvt_pk_bf16_f32 v129, v66, v67
 v_cvt_pk_bf16_f32 v130, v68, v69
 v_cvt_pk_bf16_f32 v131, v70, v71
 v_cvt_pk_bf16_f32 v132, v72, v73
 v_cvt_pk_bf16_f32 v133, v74, v75
 v_cvt_pk_bf16_f32 v134, v76, v77
 v_cvt_pk_bf16_f32 v135, v78, v79
 buffer_store_dwordx4 v[128:131], v7, s[4:7], s33 offen offset:0 sc1
 buffer_store_dwordx4 v[132:135], v7, s[4:7], s33 offen offset:608 sc1
 v_mul_u32_u24 v13, 3641, v12
 v_lshrrev_b32 v13, 16, v13
 v_mul_u32_u24 v15, 18, v13
 v_sub_u32 v15, v12, v15
 v_mul_lo_u32 v13, v13, s34
 v_lshlrev_b32 v15, 4, v15
 v_add3_u32 v8, v13, v15, v14
 v_add_u32 v12, 32, v12
 v_mul_f32 v80, v80, v16
 v_mul_f32 v81, v81, v17
 v_mul_f32 v82, v82, v18
 v_mul_f32 v83, v83, v19
 v_mul_f32 v84, v84, v20
 v_mul_f32 v85, v85, v21
 v_mul_f32 v86, v86, v22
 v_mul_f32 v87, v87, v23
 v_mul_f32 v88, v88, v24
 v_mul_f32 v89, v89, v25
 v_mul_f32 v90, v90, v26
 v_mul_f32 v91, v91, v27
 v_mul_f32 v92, v92, v28
 v_mul_f32 v93, v93, v29
 v_mul_f32 v94, v94, v30
 v_mul_f32 v95, v95, v31
 v_cvt_pk_bf16_f32 v136, v80, v81
 v_cvt_pk_bf16_f32 v137, v82, v83
 v_cvt_pk_bf16_f32 v138, v84, v85
 v_cvt_pk_bf16_f32 v139, v86, v87
 v_cvt_pk_bf16_f32 v140, v88, v89
 v_cvt_pk_bf16_f32 v141, v90, v91
 v_cvt_pk_bf16_f32 v142, v92, v93
 v_cvt_pk_bf16_f32 v143, v94, v95
 buffer_store_dwordx4 v[136:139], v8, s[4:7], s33 offen offset:0 sc1
 buffer_store_dwordx4 v[140:143], v8, s[4:7], s33 offen offset:608 sc1
 v_mul_u32_u24 v13, 3641, v12
 v_lshrrev_b32 v13, 16, v13
 v_mul_u32_u24 v15, 18, v13
 v_sub_u32 v15, v12, v15
 v_mul_lo_u32 v13, v13, s34
 v_lshlrev_b32 v15, 4, v15
 v_add3_u32 v9, v13, v15, v14
 v_add_u32 v12, 32, v12
 v_mul_f32 v96, v96, v16
 v_mul_f32 v97, v97, v17
 v_mul_f32 v98, v98, v18
 v_mul_f32 v99, v99, v19
 v_mul_f32 v100, v100, v20
 v_mul_f32 v101, v101, v21
 v_mul_f32 v102, v102, v22
 v_mul_f32 v103, v103, v23
 v_mul_f32 v104, v104, v24
 v_mul_f32 v105, v105, v25
 v_mul_f32 v106, v106, v26
 v_mul_f32 v107, v107, v27
 v_mul_f32 v108, v108, v28
 v_mul_f32 v109, v109, v29
 v_mul_f32 v110, v110, v30
 v_mul_f32 v111, v111, v31
 v_cvt_pk_bf16_f32 v144, v96, v97
 v_cvt_pk_bf16_f32 v145, v98, v99
 v_cvt_pk_bf16_f32 v146, v100, v101
 v_cvt_pk_bf16_f32 v147, v102, v103
 v_cvt_pk_bf16_f32 v148, v104, v105
 v_cvt_pk_bf16_f32 v149, v106, v107
 v_cvt_pk_bf16_f32 v150, v108, v109
 v_cvt_pk_bf16_f32 v151, v110, v111
 buffer_store_dwordx4 v[144:147], v9, s[4:7], s33 offen offset:0 sc1
 buffer_store_dwordx4 v[148:151], v9, s[4:7], s33 offen offset:608 sc1
 s_branch K1C_JOIN
K1C_JOIN:
 s_getpc_b64 s[24:25]
FARJ:
 s_sub_u32 s24, s24, FARJ-K1D_JOIN
 s_subb_u32 s25, s25, 0
 s_setpc_b64 s[24:25]
CH_END:
 s_endpgm
CODE_END:
 s_endpgm
.section .rodata,"a"
.p2align 6
.amdhsa_kernel km_kernel
  .amdhsa_next_free_vgpr 512
  .amdhsa_next_free_sgpr 102
  .amdhsa_accum_offset 256
  .amdhsa_group_segment_fixed_size 0
  .amdhsa_kernarg_size 80
  .amdhsa_user_sgpr_count 2
  .amdhsa_user_sgpr_kernarg_segment_ptr 1
  .amdhsa_system_sgpr_workgroup_id_x 1
.end_amdhsa_kernel
```
